```python
import torch

def _softmax(x, axis=-1):
    return torch.softmax(x, dim=axis)
def _gelu(x):
    return torch.nn.functional.gelu(x, approximate="tanh")
def _silu(x):
    return torch.nn.functional.silu(x)
def _sigmoid(x):
    return torch.sigmoid(x)
def _layernorm(x, axis=-1, eps=1e-5):
    m = x.mean(dim=axis, keepdim=True)
    v = x.var(dim=axis, keepdim=True, unbiased=False)
    return (x - m) / torch.sqrt(v + eps)
def _scatter_add(tgt, idx, src, axis=0):
    return tgt.clone().index_add_(axis, idx, src)
def _segment_sum(src, seg, n):
    out = torch.zeros((n,) + src.shape[1:], dtype=src.dtype)
    return out.index_add_(0, seg, src)
def _pad(x, pw):
    flat = tuple(v for pair in reversed(pw) for v in pair)
    return torch.nn.functional.pad(x, flat)

kernel_name = 'interleave_layers__ssm_conv_s5__ssm_conv_h3__prompt'

def setup_inputs():

    _w = (lambda a: (lambda t: t.to(torch.bfloat16) if t.is_floating_point() else t)(torch.as_tensor(a)))
    def _A_setup():
        B, S, D = 1, 2048, 640
        P = D
        Lambda_re = -0.5 * (lambda _x: torch.exp(torch.as_tensor(_x)))((lambda *s: torch.randn(*s, dtype=torch.bfloat16) * 0.2)(P))
        Lambda_im = (lambda *s: torch.randn(*s, dtype=torch.bfloat16) * 0.8)(P) * 1.0
        B_re = (lambda *s: torch.randn(*s, dtype=torch.bfloat16) * 0.2)(P, D) * (D ** -0.5)
        B_im = (lambda *s: torch.randn(*s, dtype=torch.bfloat16) * 0.2)(P, D) * (D ** -0.5)
        C_re = (lambda *s: torch.randn(*s, dtype=torch.bfloat16) * 0.2)(D, P) * (P ** -0.5)
        C_im = (lambda *s: torch.randn(*s, dtype=torch.bfloat16) * 0.2)(D, P) * (P ** -0.5)
        log_dt = (lambda *s: torch.randn(*s, dtype=torch.bfloat16) * 0.2)(P) * 0.3 - 2.0
        Dskip = (lambda *s: torch.randn(*s, dtype=torch.bfloat16) * 0.05)(D)
        return {
            "x": _w((lambda *s: torch.randn(*s, dtype=torch.bfloat16) * 0.05)(B, S, D)),
            "Lambda_re": _w(Lambda_re),
            "Lambda_im": _w(Lambda_im),
            "B_re": _w(B_re),
            "B_im": _w(B_im),
            "C_re": _w(C_re),
            "C_im": _w(C_im),
            "log_dt": _w(log_dt),
            "Dskip": _w(Dskip),
        }
    _A_in = _A_setup()

    def _B_setup():
        B, S, D = 1, 2048, 640
        ks = 4
        return {
            "q": _w((lambda *s: torch.randn(*s, dtype=torch.bfloat16) * 0.05)(B, S, D)),
            "k": _w((lambda *s: torch.randn(*s, dtype=torch.bfloat16) * 0.4)(B, S, D)),
            "v": _w((lambda *s: torch.randn(*s, dtype=torch.bfloat16) * 0.4)(B, S, D)),
            "shift_k": _w((lambda *s: torch.randn(*s, dtype=torch.bfloat16) * 0.4)(D, ks) * 0.5),
            "ssm_k": _w((lambda *s: torch.randn(*s, dtype=torch.bfloat16) * 0.4)(D, S) * (1.0 / S ** 0.5)),
            "ssm_D": _w((lambda *s: torch.randn(*s, dtype=torch.bfloat16) * 0.4)(D)),
        }
    _B_in = _B_setup()

    return {
        "A_x": _A_in["x"],
        "A_Lambda_re": _A_in["Lambda_re"],
        "A_Lambda_im": _A_in["Lambda_im"],
        "A_B_re": _A_in["B_re"],
        "A_B_im": _A_in["B_im"],
        "A_C_re": _A_in["C_re"],
        "A_C_im": _A_in["C_im"],
        "A_log_dt": _A_in["log_dt"],
        "A_Dskip": _A_in["Dskip"],
        "B_q": _B_in["q"],
        "B_k": _B_in["k"],
        "B_v": _B_in["v"],
        "B_shift_k": _B_in["shift_k"],
        "B_ssm_k": _B_in["ssm_k"],
        "B_ssm_D": _B_in["ssm_D"],
    }

def reference(A_x, A_Lambda_re, A_Lambda_im, A_B_re, A_B_im, A_C_re, A_C_im, A_log_dt, A_Dskip, B_q, B_k, B_v, B_shift_k, B_ssm_k, B_ssm_D):
    def _A_ref(x, Lambda_re, Lambda_im, B_re, B_im, C_re, C_im, log_dt, Dskip):
        Bsz, L, H = x.shape
        Lam = Lambda_re + 1j * Lambda_im
        Bmat = B_re + 1j * B_im
        Cmat = C_re + 1j * C_im
        dt = torch.exp(log_dt)
        Lam_bar = torch.exp(dt * Lam)
        B_bar = ((Lam_bar - 1.0) / Lam)[:, None] * Bmat
        Bu = torch.einsum("bld,pd->blp", x + 0j, B_bar)
        h = torch.zeros_like(Bu[:, 0, :])
        hs = []
        for t in range(L):
            h = Lam_bar[None, :] * h + Bu[:, t, :]
            hs.append(h)
        hseq = torch.stack(hs, 1)
        y = 2.0 * torch.einsum("blp,dp->bld", hseq, Cmat).real + x * Dskip[None, None, :]
        return y

    def _B_ref(q, k, v, shift_k, ssm_k, ssm_D):
        B, S, D = q.shape
        ks = shift_k.shape[-1]
        k_pad = _pad(k, ((0, 0), (ks - 1, 0), (0, 0)))
        k_shift = torch.zeros_like(k)
        for t in range(ks):
            k_shift = k_shift + k_pad[:, t:t + S, :] * shift_k[:, ks - 1 - t][None, None, :]
        kv = k_shift * v
        L = 2 * S
        kv_pad = _pad(kv, ((0, 0), (0, S), (0, 0)))
        kf_pad = _pad(ssm_k, ((0, 0), (0, S)))
        kv_f = (lambda x, axes=(-2,-1): torch.fft.rfft2(x.float(), dim=axes))(kv_pad[:, None, :, :], axes=(1, 2))
        kf_f = (lambda x, axes=(-2,-1): torch.fft.rfft2(x.float(), dim=axes))(kf_pad[:, None, :], axes=(1, 2))
        kf_f = (lambda x, *d: x.permute(*d))(kf_f, 1, 2, 0)
        y_f = kv_f * kf_f[None, :, :, :]
        y = (lambda x, s, axes=(-2,-1): torch.fft.irfft2(x, s=s, dim=axes).to(torch.bfloat16))(y_f, (1, L), axes=(1, 2))[:, 0, :S, :]
        y = y + kv * ssm_D[None, None, :]
        return q * y

    x = A_x
    x = x + _A_ref(_layernorm(x, axis=-1), A_Lambda_re, A_Lambda_im, A_B_re, A_B_im, A_C_re, A_C_im, A_log_dt, A_Dskip)
    x = x + _B_ref(_layernorm(x, axis=-1), B_k, B_v, B_shift_k, B_ssm_k, B_ssm_D)
    x = x + _A_ref(_layernorm(x, axis=-1), A_Lambda_re, A_Lambda_im, A_B_re, A_B_im, A_C_re, A_C_im, A_log_dt, A_Dskip)
    x = x + _B_ref(_layernorm(x, axis=-1), B_k, B_v, B_shift_k, B_ssm_k, B_ssm_D)
    return x
```

```asm
; @launch grid=(256,1,1) block=(256,1,1) lds=163840
.amdgcn_target "amdgcn-amd-amdhsa--gfx950"
.text
.globl interleave_layers__ssm_conv_s5__ssm_conv_h3__prompt_kernel
.p2align 8
.type interleave_layers__ssm_conv_s5__ssm_conv_h3__prompt_kernel,@function
interleave_layers__ssm_conv_s5__ssm_conv_h3__prompt_kernel:
    s_cmp_gt_u32 s2, 255
    s_cbranch_scc1 L_end
    s_load_dwordx16 s[32:47], s[0:1], 64
    s_load_dwordx16 s[16:31], s[0:1], 0
    s_load_dwordx4 s[48:51], s[0:1], 128
    s_memrealtime s[6:7]
    v_and_b32 v152, 63, v0
    v_lshrrev_b32 v1, 6, v0
    s_and_b32 s8, s2, 7
    s_lshr_b32 s9, s2, 3
    v_readfirstlane_b32 s77, v1
    s_getpc_b64 s[4:5]
L_pc:
    s_lshl_b32 s3, s9, 2
    s_add_u32 s3, s3, s77
    s_lshl_b32 s3, s3, 9
    v_and_b32 v2, 3, v152
    v_lshl_add_u32 v2, v2, 7, s3
    v_min_u32 v2, L_last-L_pc, v2
    global_load_dword v131, v2, s[4:5]
    s_and_b32 s78, s9, 7
    s_lshr_b32 s10, s9, 3
    s_lshl_b32 s79, s10, 3
    s_add_u32 s79, s79, s8
    v_mov_b32 v174, 0
    s_and_b32 s10, s10, 2
    s_add_u32 s10, s10, s8
    s_add_u32 s10, s10, s78
    v_lshrrev_b32 v12, 3, v152
    v_and_b32 v13, 7, v152
    v_mul_u32_u24 v158, 1280, v12
    v_lshl_add_u32 v14, v13, 4, v158
    s_mul_i32 s5, s79, 81920
    s_lshl_b32 s4, s78, 7
    s_add_u32 s4, s4, s5
    s_mul_i32 s3, s77, 20480
    s_add_u32 s3, s3, s4
    v_add_u32 v70, s3, v14
    s_sub_u32 s4, s4, 10240
    v_add_u32 v14, s4, v14
    v_lshrrev_b32 v15, 1, v152
    v_mul_u32_u24 v15, 1280, v15
    v_and_b32 v72, 1, v152
    v_lshl_add_u32 v15, v72, 4, v15
    s_mul_i32 s4, s78, 96
    s_sub_u32 s3, s3, s4
    s_add_u32 s3, s3, 2048
    v_add_u32 v72, s3, v15
    v_cmp_gt_u32 vcc, 40, v152
    v_subrev_u32 v71, 6144, v72
    s_mul_i32 s9, s77, 1536
    v_cndmask_b32 v71, v14, v71, vcc
    s_sub_u32 s9, 54272, s9
    s_mul_i32 s8, s77, 4128
    s_mov_b32 s66, 2621440
    s_mov_b32 s67, 0x20000
    s_mov_b32 s70, 2622464
    s_mov_b32 s71, 0x20000
    v_lshlrev_b32 v153, 4, v152
    v_lshrrev_b32 v145, 1, v0
    s_movk_i32 s3, 80
    v_cmp_gt_u32 s[96:97], s3, v145
    v_min_u32 v145, 79, v145
    s_mul_i32 s3, s78, 160
    v_lshl_add_u32 v147, v145, 1, s3
    s_lshl_b32 s3, s78, 9
    v_add_u32 v16, s3, v153
    s_mul_i32 s3, s78, 384
    s_sub_u32 s3, 3584, s3
    v_lshrrev_b32 v17, 5, v152
    v_mad_u32_u24 v16, v17, s3, v16
    s_mov_b32 m0, 94016
    s_mul_i32 s11, s10, 52
    s_lshr_b32 s11, s11, 8
    s_mul_i32 s11, s11, 5
    s_sub_u32 s72, s10, s11
    s_waitcnt lgkmcnt(0)
    s_mov_b64 s[64:65], s[36:37]
    s_sub_u32 s68, s38, 1024
    s_subb_u32 s69, s39, 0
    global_load_ushort v142, v147, s[18:19]
    global_load_ushort v143, v147, s[20:21]
    global_load_ushort v146, v147, s[32:33]
    global_load_ushort v144, v147, s[30:31]
    s_mov_b32 exec_hi, 0xff
    global_load_lds_dwordx4 v16, s[40:41]
    s_mov_b32 exec_hi, -1
    s_add_u32 m0, s8, 56336
    s_movk_i32 s83, 0
    buffer_load_dwordx4 v70, s[64:67], s83 offen lds
    buffer_load_dwordx4 v70, s[68:71], s83 offen offset:1024 lds
    s_add_u32 m0, s8, 58400
    s_movk_i32 s83, 10240
    buffer_load_dwordx4 v70, s[64:67], s83 offen lds
    buffer_load_dwordx4 v70, s[68:71], s83 offen offset:1024 lds
    s_mov_b32 m0, s9
    s_nop 0
    buffer_load_dwordx4 v71, s[64:67], 0 offen lds
    s_sub_u32 m0, s9, 512
    s_mov_b32 exec_hi, 0
    buffer_load_dwordx4 v72, s[68:71], 0 offen lds
    s_mov_b32 exec_hi, -1
    s_or_b32 s3, s2, s77
    s_cmp_lg_u32 s3, 0
    s_cbranch_scc1 L_par
    s_or_b32 s6, s6, 7
    v_mov_b32 v2, 0
    v_mov_b32 v3, s6
    global_store_dword v2, v3, s[48:49] sc1
L_par:
    s_and_b32 s80, s77, 1
    s_lshr_b32 s81, s77, 1
    s_lshl_b32 s84, s77, 14
    s_add_u32 s84, s84, 98304
    s_lshl_b32 s72, s72, 7
    s_mul_i32 s85, s81, 640
    s_sub_u32 s90, 640, s85
    s_lshl_b32 s100, s77, 11
    v_lshrrev_b32 v11, 4, v152
    v_xor_b32 v14, v13, v11
    v_lshlrev_b32 v14, 4, v14
    s_mul_i32 s3, s78, 102400
    s_mul_i32 s4, s77, 20480
    s_add_u32 s3, s3, s4
    v_add3_u32 v158, v158, v14, s3
    v_xor_b32 v159, 64, v158
    v_add_u32 v159, 9216, v159
    s_mov_b64 s[56:57], s[22:23]
    s_mov_b32 s58, 819200
    s_mov_b32 s59, 0x20000
    s_mov_b64 s[60:61], s[24:25]
    s_mov_b32 s62, 819200
    s_mov_b32 s63, 0x20000
    s_sub_u32 s4, 81920, s4
    s_cmp_eq_u32 s80, 0
    s_cselect_b32 s92, s22, s24
    s_cselect_b32 s93, s23, s25
    s_add_u32 s92, s92, s4
    s_addc_u32 s93, s93, 0
    s_sub_u32 s94, 819200, s4
    s_mov_b32 s95, 0x20000
    v_lshrrev_b32 v15, 5, v152
    v_mul_u32_u24 v164, 20480, v15
    v_bfe_u32 v15, v152, 3, 1
    s_movk_i32 s3, 10240
    v_mad_u32_u24 v164, v15, s3, v164
    v_and_b32 v15, 1, v11
    s_movk_i32 s3, 1280
    v_mad_u32_u24 v164, v15, s3, v164
    s_mul_i32 s4, s77, 2560
    s_add_u32 s5, s5, s4
    v_add3_u32 v164, v164, v14, s5
    v_xor_b32 v165, 64, v164
    v_add_u32 v165, 39936, v165
    s_mov_b64 s[52:53], s[16:17]
    s_mov_b32 s54, 2621440
    s_mov_b32 s55, 0x20000
    s_mul_i32 s3, s2, 3200
    s_mul_i32 s4, s77, 7
    v_min_u32 v112, 6, v152
    v_add_u32 v112, s4, v112
    v_min_u32 v112, 24, v112
    v_lshl_add_u32 v112, v112, 7, s3
    s_mul_i32 s3, s78, 10240
    s_add_u32 s3, s3, s5
    v_min_u32 v113, 19, v152
    v_lshl_add_u32 v113, v113, 7, s3
    s_lshl_b32 s4, s78, 6
    s_lshl_b32 s3, s79, 1
    global_load_dword v131, v112, s[22:23]
    s_add_u32 s3, s3, s4
    s_and_b32 s5, s79, 15
    s_lshl_b32 s4, s78, 4
    s_add_u32 s4, s4, s5
    global_load_dword v131, v112, s[24:25]
    s_add_u32 s4, s4, 512
    s_lshl_b32 s14, s3, 12
    s_lshl_b32 s15, s4, 12
    s_lshl_b32 s3, s3, 1
    global_load_dword v131, v113, s[16:17]
    s_lshl_b32 s4, s4, 1
    s_andn2_b32 s4, s4, 3
    s_load_dword s34, s[44:45], s3
    s_load_dword s35, s[44:45], s4
    s_lshl_b32 s5, s77, 10
    s_sub_u32 s5, s5, 4
    s_max_i32 s5, s5, 0
    s_add_u32 s3, s5, s14
    s_load_dword s30, s[42:43], s3
    s_add_u32 s3, s3, 4096
    s_load_dword s31, s[42:43], s3
    s_add_u32 s3, s5, s15
    s_load_dword s32, s[42:43], s3
    s_lshl_b32 s12, s77, 10
    v_add_u32 v221, s12, v153
    s_add_u32 s73, s72, 128
    s_cmp_eq_u32 s73, 640
    s_cselect_b32 s73, 0, s73
    s_add_u32 s74, s73, 128
    s_cmp_eq_u32 s74, 640
    s_cselect_b32 s74, 0, s74
    s_add_u32 s75, s74, 128
    s_cmp_eq_u32 s75, 640
    s_cselect_b32 s75, 0, s75
    s_add_u32 s76, s75, 128
    s_cmp_eq_u32 s76, 640
    s_cselect_b32 s76, 0, s76
    v_and_b32 v10, 15, v152
    v_lshrrev_b32 v14, 1, v10
    v_xor_b32 v14, v14, v11
    v_lshlrev_b32 v14, 4, v14
    v_lshl_add_u32 v14, v10, 7, v14
    v_add_u32 v156, s84, v14
    v_xor_b32 v157, 64, v156
    s_lshl_b32 s3, s81, 13
    v_add_u32 v120, s3, v14
    v_xor_b32 v121, 64, v120
    v_xor_b32 v122, 0x2000, v120
    v_xor_b32 v123, 0x2000, v121
    s_getreg_b32 s89, hwreg(HW_REG_XCC_ID, 0, 3)
    s_mov_b32 s101, 0x20000
    s_mov_b32 s86, 0xffff0000
    s_mov_b32 s87, 0x3f803f80
    v_mov_b32 v116, s87
    v_mov_b32 v117, s87
    v_mov_b32 v118, s87
    v_mov_b32 v119, s87
    v_mov_b32 v224, 0
    v_add_u32 v124, s100, v14
    v_xor_b32 v125, 64, v124
    v_lshrrev_b32 v242, 3, v152
    v_and_b32 v243, 7, v152
    s_lshl_b32 s3, s77, 5
    s_add_u32 s3, s3, 56336
    v_lshl_add_u32 v64, v242, 2, s3
    s_movk_i32 s3, 2064
    v_mad_u32_u24 v64, v243, s3, v64
    v_subrev_u32 v65, 1424, v64
    v_add_u32 v66, 1024, v64
    s_sub_u32 s3, s9, 512
    v_lshl_add_u32 v75, v243, 2, s3
    v_lshl_add_u32 v75, v242, 6, v75
    s_lshl_b32 s4, s78, 2
    s_add_u32 s4, s4, s77
    s_lshl_b32 s3, s4, 16
    s_lshl_b32 s5, s79, 7
    s_add_u32 s3, s3, s5
    s_add_u32 s3, s3, 2048
    v_lshl_add_u32 v76, v242, 13, s3
    v_lshl_add_u32 v76, v243, 4, v76
    s_lshl_b32 s4, s4, 14
    s_add_u32 s4, s4, s5
    s_add_u32 s4, s4, 2097152
    v_lshrrev_b32 v229, 4, v152
    v_lshl_add_u32 v229, v229, 12, s4
    v_and_b32 v228, 15, v152
    v_lshl_add_u32 v229, v228, 3, v229
    s_lshl_b32 s3, s77, 9
    s_add_u32 s3, s3, 79872
    v_lshl_add_u32 v228, v152, 3, s3
    s_lshl_b32 s3, s77, 7
    s_add_u32 s3, s3, 94016
    v_lshl_add_u32 v73, v242, 4, s3
    s_mov_b32 s3, 94528
    v_lshl_add_u32 v74, v243, 4, s3
    s_mov_b32 m0, s100
    s_mov_b32 s83, s72
    buffer_load_dwordx4 v164, s[52:55], s83 offen lds
    v_xor_b32 v242, 3, v242
    s_lshl_b32 s3, s77, 5
    s_add_u32 s3, s3, 79872
    v_lshl_add_u32 v77, v242, 2, s3
    v_lshl_add_u32 v77, v243, 8, v77
    v_and_b32 v168, 31, v152
    s_lshl_b32 s3, s78, 7
    s_add_u32 s3, s3, 11534336
    v_lshl_add_u32 v168, v168, 2, s3
    s_lshl_b32 s4, s79, 2
    s_add_u32 s3, s3, s4
    s_add_u32 s4, s4, 11534336
    v_and_b32 v230, 7, v152
    v_lshl_add_u32 v230, v230, 7, s4
    v_cmp_gt_u32 vcc, 32, v152
    v_mov_b32 v223, s3
    s_nop 0
    v_cndmask_b32 v168, v230, v168, vcc
    buffer_load_dwordx4 v165, s[52:55], s83 offen offset:1024 lds
    s_waitcnt vmcnt(12)
    v_lshlrev_b32 v178, 16, v144
    v_lshlrev_b32 v176, 16, v142
    v_mul_f32 v178, 0x3fb8aa3b, v178
    v_lshlrev_b32 v177, 16, v143
    v_exp_f32 v178, v178
    v_mul_f32 v185, v176, v176
    v_fmac_f32 v185, v177, v177
    v_cvt_pk_bf16_f32 v178, 0, v178
    v_rcp_f32 v185, v185
    v_mul_f32 v179, v178, v176
    v_mul_f32 v180, v178, v177
    v_mul_f32 v179, 0x3fb8aa3b, v179
    v_mul_f32 v180, 0x3e22f983, v180
    s_add_u32 m0, s100, 8192
    s_add_u32 s83, s72, 640
    buffer_load_dwordx4 v164, s[52:55], s83 offen lds
    v_and_b32 v188, 1, v152
    v_cmp_eq_u32 vcc, 1, v188
    v_mov_b32 v189, 0x44000000
    v_mov_b32 v181, 0x41000000
    v_mov_b32 v198, 0x42800000
    v_mov_b32 v199, 0x41800000
    v_cndmask_b32 v189, v189, v181, vcc
    v_cndmask_b32 v198, v198, v199, vcc
    v_mul_f32 v184, 1.0, v179
    v_mul_f32 v183, 1.0, v180
    v_exp_f32 v184, v184
    v_fract_f32 v183, v183
    v_cos_f32 v182, v183
    v_sin_f32 v183, v183
    buffer_load_dwordx4 v165, s[52:55], s83 offen offset:1024 lds
    v_mul_f32 v182, v184, v182
    v_mul_f32 v183, v184, v183
    v_mul_f32 v192, v189, v179
    v_mul_f32 v191, v189, v180
    v_exp_f32 v192, v192
    v_fract_f32 v191, v191
    v_cos_f32 v190, v191
    v_sin_f32 v191, v191
    v_mul_f32 v190, v192, v190
    v_mul_f32 v191, v192, v191
    v_add_f32 v185, v185, v185
    v_add_f32 v184, -1.0, v182
    v_mul_f32 v186, v184, v176
    v_mul_f32 v187, v183, v176
    s_mov_b32 m0, s84
    s_add_u32 s83, s72, s85
    buffer_load_dwordx4 v158, s[56:59], s83 offen lds
    v_fmac_f32 v186, v183, v177
    v_fma_f32 v187, -v184, v177, v187
    v_mul_f32 v186, v186, v185
    v_mul_f32 v187, v187, v185
    v_cndmask_b32 v186, 1.0, v186, vcc
    v_cndmask_b32 v187, 0, v187, vcc
    v_cndmask_b32 v182, v182, v190, vcc
    v_cndmask_b32 v183, v183, v191, vcc
    v_mul_u32_u24 v188, 640, v188
    v_lshlrev_b32 v181, 3, v145
    v_add_u32 v181, 81920, v181
    v_add_u32 v189, v181, v188
    s_mov_b64 exec, s[96:97]
    ds_write_b64 v189, v[182:183] offset:7680
    s_mov_b64 exec, -1
    v_sub_u32 v189, v181, v188
    buffer_load_dwordx4 v159, s[56:59], s83 offen offset:1024 lds
    v_lshlrev_b32 v188, 3, v188
    v_sub_u32 v188, v181, v188
    s_mov_b64 exec, s[96:97]
    ds_write_b64 v188, v[186:187] offset:5120
    s_mov_b64 exec, -1
    v_mul_f32 v196, v198, v179
    v_mul_f32 v195, v198, v180
    v_exp_f32 v196, v196
    v_fract_f32 v195, v195
    v_cos_f32 v194, v195
    v_sin_f32 v195, v195
    v_mul_f32 v194, v196, v194
    v_mul_f32 v195, v196, v195
    s_mov_b64 exec, s[96:97]
    ds_write_b64 v189, v[194:195] offset:9600
    s_mov_b64 exec, -1
    s_add_u32 m0, s84, 2048
    s_add_u32 s83, s72, s85
    buffer_load_dwordx4 v158, s[60:63], s83 offen lds
    v_pk_mul_f32 v[200:201], v[186:187], v[190:191] op_sel_hi:[1,0]
    v_pk_fma_f32 v[200:201], v[186:187], v[190:191], v[200:201] op_sel:[1,1,0] op_sel_hi:[0,1,1] neg_lo:[1,0,0]
    s_mov_b64 exec, s[96:97]
    ds_write_b64 v188, v[200:201] offset:5760
    s_mov_b64 exec, -1
    v_pk_mul_f32 v[186:187], v[200:201], v[190:191] op_sel_hi:[1,0]
    v_pk_fma_f32 v[186:187], v[200:201], v[190:191], v[186:187] op_sel:[1,1,0] op_sel_hi:[0,1,1] neg_lo:[1,0,0]
    s_mov_b64 exec, s[96:97]
    ds_write_b64 v188, v[186:187] offset:6400
    s_mov_b64 exec, -1
    v_pk_mul_f32 v[200:201], v[186:187], v[190:191] op_sel_hi:[1,0]
    v_pk_fma_f32 v[200:201], v[186:187], v[190:191], v[200:201] op_sel:[1,1,0] op_sel_hi:[0,1,1] neg_lo:[1,0,0]
    s_mov_b64 exec, s[96:97]
    ds_write_b64 v188, v[200:201] offset:7040
    s_mov_b64 exec, -1
    v_pk_mul_f32 v[186:187], v[200:201], v[190:191] op_sel_hi:[1,0]
    v_pk_fma_f32 v[186:187], v[200:201], v[190:191], v[186:187] op_sel:[1,1,0] op_sel_hi:[0,1,1] neg_lo:[1,0,0]
    s_and_b64 s[96:97], s[96:97], vcc
    s_mov_b64 exec, s[96:97]
    ds_write_b64 v188, v[186:187] offset:7680
    s_mov_b64 exec, -1
    buffer_load_dwordx4 v159, s[60:63], s83 offen offset:1024 lds
    v_pk_mul_f32 v[200:201], v[186:187], v[190:191] op_sel_hi:[1,0]
    v_pk_fma_f32 v[200:201], v[186:187], v[190:191], v[200:201] op_sel:[1,1,0] op_sel_hi:[0,1,1] neg_lo:[1,0,0]
    s_mov_b64 exec, s[96:97]
    ds_write_b64 v188, v[200:201] offset:8320
    s_mov_b64 exec, -1
    v_pk_mul_f32 v[186:187], v[200:201], v[190:191] op_sel_hi:[1,0]
    v_pk_fma_f32 v[186:187], v[200:201], v[190:191], v[186:187] op_sel:[1,1,0] op_sel_hi:[0,1,1] neg_lo:[1,0,0]
    s_mov_b64 exec, s[96:97]
    ds_write_b64 v188, v[186:187] offset:8960
    s_mov_b64 exec, -1
    v_pk_mul_f32 v[200:201], v[186:187], v[190:191] op_sel_hi:[1,0]
    v_pk_fma_f32 v[200:201], v[186:187], v[190:191], v[200:201] op_sel:[1,1,0] op_sel_hi:[0,1,1] neg_lo:[1,0,0]
    s_mov_b64 exec, s[96:97]
    ds_write_b64 v188, v[200:201] offset:9600
    s_mov_b64 exec, -1
    v_lshlrev_b32 v188, 2, v145
    v_add_u32 v188, 93696, v188
    v_lshlrev_b32 v189, 16, v146
    s_mov_b64 exec, s[96:97]
    ds_write_b32 v188, v189
    s_mov_b64 exec, -1
    s_add_u32 m0, s84, 4096
    s_add_u32 s83, s72, s85
    buffer_load_dwordx4 v158, s[92:95], s83 offen lds
    v_and_b32 v230, 15, v152
    v_lshrrev_b32 v231, 1, v230
    s_lshr_b32 s3, s78, 2
    s_lshl_b32 s3, s3, 13
    s_add_u32 s3, s3, s100
    v_lshl_add_u32 v230, v230, 7, s3
    s_and_b32 s3, s78, 3
    s_mul_i32 s3, s3, 10
    s_lshr_b32 s4, s72, 4
    s_sub_u32 s3, s3, s4
    v_lshrrev_b32 v242, 4, v152
    v_add_u32 v128, s3, v242
    v_add_u32 v129, 4, v128
    s_add_u32 s3, s3, 8
    v_lshrrev_b32 v242, 5, v152
    v_add_u32 v130, s3, v242
    buffer_load_dwordx4 v159, s[92:95], s83 offen offset:1024 lds
    v_add_u32 v242, 40, v128
    v_min_u32 v128, v128, v242
    v_lshrrev_b32 v242, 3, v128
    v_lshl_add_u32 v242, v242, 14, v230
    v_and_b32 v128, 7, v128
    v_xor_b32 v128, v128, v231
    v_lshl_add_u32 v128, v128, 4, v242
    v_add_u32 v242, 40, v129
    v_min_u32 v129, v129, v242
    v_lshrrev_b32 v242, 3, v129
    v_lshl_add_u32 v242, v242, 14, v230
    v_and_b32 v129, 7, v129
    v_xor_b32 v129, v129, v231
    v_lshl_add_u32 v129, v129, 4, v242
    v_add_u32 v242, 40, v130
    v_min_u32 v130, v130, v242
    s_add_u32 m0, s84, 6144
    s_add_u32 s83, s72, s90
    buffer_load_dwordx4 v158, s[56:59], s83 offen lds
    v_lshrrev_b32 v242, 3, v130
    v_lshl_add_u32 v242, v242, 14, v230
    v_and_b32 v130, 7, v130
    v_xor_b32 v130, v130, v231
    v_lshl_add_u32 v130, v130, 4, v242
    v_bfe_u32 v242, v152, 4, 1
    v_lshl_add_u32 v130, v242, 3, v130
    v_lshrrev_b32 v167, 4, v152
    s_mov_b32 s4, 93696
    v_lshl_add_u32 v166, v167, 5, s4
    v_lshl_add_u32 v167, v167, 4, s4
    s_lshl_b32 s3, s81, 12
    s_add_u32 s3, s3, s14
    s_lshl_b32 s4, s80, 10
    buffer_load_dwordx4 v159, s[56:59], s83 offen offset:1024 lds
    s_waitcnt vmcnt(15)
    s_waitcnt lgkmcnt(0)
    s_barrier
    ds_read2_b32 v[80:81], v75 offset0:136 offset1:144
    ds_read2_b32 v[82:83], v75 offset0:152 offset1:160
    ds_read_b32 v84, v75 offset:672
    ds_read2_b32 v[86:87], v75 offset0:0 offset1:8
    ds_read_b128 v[88:91], v74
    ds_read_b128 v[60:63], v73
    ds_read2_b32 v[40:41], v65 offset0:0 offset1:32
    ds_read_b32 v42, v65 offset:256
    ds_read2_b32 v[44:45], v64 offset0:0 offset1:32
    ds_read2_b32 v[46:47], v64 offset0:64 offset1:96
    ds_read2_b32 v[48:49], v64 offset0:128 offset1:160
    ds_read2_b32 v[50:51], v64 offset0:192 offset1:224
    ds_read2_b32 v[52:53], v66 offset0:0 offset1:32
    ds_read2_b32 v[54:55], v66 offset0:64 offset1:96
    ds_read2_b32 v[56:57], v66 offset0:128 offset1:160
    s_add_u32 m0, s84, 8192
    s_add_u32 s83, s72, s90
    buffer_load_dwordx4 v158, s[60:63], s83 offen lds
    ds_read2_b32 v[58:59], v66 offset0:192 offset1:224
    v_mov_b64 v[0:1], 0
    v_add_u32 v2, 3145728, v229
    global_store_dwordx2 v2, v[0:1], s[50:51] sc1
    s_waitcnt lgkmcnt(11)
    v_lshlrev_b32 v22, 16, v88
    v_and_b32 v24, s86, v88
    v_lshlrev_b32 v26, 16, v89
    v_and_b32 v28, s86, v89
    v_lshlrev_b32 v23, 16, v90
    v_and_b32 v25, s86, v90
    v_lshlrev_b32 v27, 16, v91
    v_and_b32 v29, s86, v91
    v_lshlrev_b32 v0, 16, v80
    v_and_b32 v1, s86, v80
    v_lshlrev_b32 v2, 16, v81
    buffer_load_dwordx4 v159, s[60:63], s83 offen offset:1024 lds
    v_and_b32 v3, s86, v81
    v_lshlrev_b32 v4, 16, v82
    v_and_b32 v5, s86, v82
    v_lshlrev_b32 v6, 16, v83
    v_and_b32 v7, s86, v83
    v_lshlrev_b32 v8, 16, v84
    v_and_b32 v9, s86, v84
    v_pk_mul_f32 v[30:31], v[0:1], v[28:29]
    v_pk_mul_f32 v[32:33], v[2:3], v[28:29]
    v_pk_fma_f32 v[30:31], v[2:3], v[26:27], v[30:31]
    v_pk_fma_f32 v[32:33], v[4:5], v[26:27], v[32:33]
    v_pk_fma_f32 v[30:31], v[4:5], v[24:25], v[30:31]
    v_pk_fma_f32 v[32:33], v[6:7], v[24:25], v[32:33]
    v_pk_fma_f32 v[30:31], v[6:7], v[22:23], v[30:31]
    v_pk_fma_f32 v[32:33], v[8:9], v[22:23], v[32:33]
    v_lshlrev_b32 v34, 16, v86
    s_add_u32 m0, s100, 16384
    s_mov_b32 s83, s73
    buffer_load_dwordx4 v164, s[52:55], s83 offen lds
    v_and_b32 v35, s86, v86
    v_lshlrev_b32 v36, 16, v87
    v_and_b32 v37, s86, v87
    v_pk_mul_f32 v[34:35], v[30:31], v[34:35]
    v_pk_mul_f32 v[36:37], v[32:33], v[36:37]
    v_cvt_pk_bf16_f32 v68, v36, v34
    v_cvt_pk_bf16_f32 v69, v37, v35
    s_waitcnt lgkmcnt(0)
    ds_write2_b32 v77, v68, v69 offset1:32
    v_lshlrev_b32 v22, 16, v60
    v_and_b32 v24, s86, v60
    v_lshlrev_b32 v26, 16, v61
    v_and_b32 v28, s86, v61
    v_lshlrev_b32 v23, 16, v62
    v_and_b32 v25, s86, v62
    v_lshlrev_b32 v27, 16, v63
    buffer_load_dwordx4 v165, s[52:55], s83 offen offset:1024 lds
    v_and_b32 v29, s86, v63
    v_lshlrev_b32 v0, 16, v40
    v_and_b32 v1, s86, v40
    v_lshlrev_b32 v2, 16, v41
    v_and_b32 v3, s86, v41
    v_lshlrev_b32 v4, 16, v42
    v_and_b32 v5, s86, v42
    v_lshlrev_b32 v6, 16, v44
    v_and_b32 v7, s86, v44
    v_lshlrev_b32 v8, 16, v45
    v_and_b32 v9, s86, v45
    v_lshlrev_b32 v10, 16, v46
    v_and_b32 v11, s86, v46
    v_lshlrev_b32 v12, 16, v47
    v_and_b32 v13, s86, v47
    v_lshlrev_b32 v14, 16, v48
    s_add_u32 m0, s100, 24576
    s_add_u32 s83, s73, 640
    buffer_load_dwordx4 v164, s[52:55], s83 offen lds
    v_and_b32 v15, s86, v48
    v_lshlrev_b32 v16, 16, v49
    v_and_b32 v17, s86, v49
    v_lshlrev_b32 v18, 16, v50
    v_and_b32 v19, s86, v50
    v_lshlrev_b32 v20, 16, v51
    v_and_b32 v21, s86, v51
    v_pk_mul_f32 v[30:31], v[0:1], v[28:29]
    v_pk_mul_f32 v[32:33], v[2:3], v[28:29]
    v_pk_fma_f32 v[30:31], v[2:3], v[26:27], v[30:31]
    v_pk_fma_f32 v[32:33], v[4:5], v[26:27], v[32:33]
    v_pk_fma_f32 v[30:31], v[4:5], v[24:25], v[30:31]
    v_pk_fma_f32 v[32:33], v[6:7], v[24:25], v[32:33]
    v_pk_fma_f32 v[30:31], v[6:7], v[22:23], v[30:31]
    v_pk_fma_f32 v[32:33], v[8:9], v[22:23], v[32:33]
    v_lshlrev_b32 v34, 16, v52
    buffer_load_dwordx4 v165, s[52:55], s83 offen offset:1024 lds
    v_and_b32 v35, s86, v52
    v_lshlrev_b32 v36, 16, v53
    v_and_b32 v37, s86, v53
    v_pk_mul_f32 v[34:35], v[30:31], v[34:35]
    v_pk_mul_f32 v[36:37], v[32:33], v[36:37]
    v_cvt_pk_bf16_f32 v107, v36, v34
    v_cvt_pk_bf16_f32 v111, v37, v35
    v_pk_mul_f32 v[30:31], v[4:5], v[28:29]
    v_pk_mul_f32 v[32:33], v[6:7], v[28:29]
    v_pk_fma_f32 v[30:31], v[6:7], v[26:27], v[30:31]
    v_pk_fma_f32 v[32:33], v[8:9], v[26:27], v[32:33]
    v_pk_fma_f32 v[30:31], v[8:9], v[24:25], v[30:31]
    v_pk_fma_f32 v[32:33], v[10:11], v[24:25], v[32:33]
    v_pk_fma_f32 v[30:31], v[10:11], v[22:23], v[30:31]
    v_pk_fma_f32 v[32:33], v[12:13], v[22:23], v[32:33]
    v_lshlrev_b32 v34, 16, v54
    s_add_u32 m0, s84, 10240
    s_add_u32 s83, s73, s85
    buffer_load_dwordx4 v158, s[56:59], s83 offen lds
    v_and_b32 v35, s86, v54
    v_lshlrev_b32 v36, 16, v55
    v_and_b32 v37, s86, v55
    v_pk_mul_f32 v[34:35], v[30:31], v[34:35]
    v_pk_mul_f32 v[36:37], v[32:33], v[36:37]
    v_cvt_pk_bf16_f32 v106, v36, v34
    v_cvt_pk_bf16_f32 v110, v37, v35
    v_pk_mul_f32 v[30:31], v[8:9], v[28:29]
    v_pk_mul_f32 v[32:33], v[10:11], v[28:29]
    v_pk_fma_f32 v[30:31], v[10:11], v[26:27], v[30:31]
    v_pk_fma_f32 v[32:33], v[12:13], v[26:27], v[32:33]
    v_pk_fma_f32 v[30:31], v[12:13], v[24:25], v[30:31]
    v_pk_fma_f32 v[32:33], v[14:15], v[24:25], v[32:33]
    v_pk_fma_f32 v[30:31], v[14:15], v[22:23], v[30:31]
    v_pk_fma_f32 v[32:33], v[16:17], v[22:23], v[32:33]
    v_lshlrev_b32 v34, 16, v56
    buffer_load_dwordx4 v159, s[56:59], s83 offen offset:1024 lds
    v_and_b32 v35, s86, v56
    v_lshlrev_b32 v36, 16, v57
    v_and_b32 v37, s86, v57
    v_pk_mul_f32 v[34:35], v[30:31], v[34:35]
    v_pk_mul_f32 v[36:37], v[32:33], v[36:37]
    v_cvt_pk_bf16_f32 v105, v36, v34
    v_cvt_pk_bf16_f32 v109, v37, v35
    v_pk_mul_f32 v[30:31], v[12:13], v[28:29]
    v_pk_mul_f32 v[32:33], v[14:15], v[28:29]
    v_pk_fma_f32 v[30:31], v[14:15], v[26:27], v[30:31]
    v_pk_fma_f32 v[32:33], v[16:17], v[26:27], v[32:33]
    v_pk_fma_f32 v[30:31], v[16:17], v[24:25], v[30:31]
    s_waitcnt vmcnt(15)
    ds_read_b128 a[0:3], v156 offset:0
    ds_read_b128 a[4:7], v157 offset:0
    v_pk_fma_f32 v[32:33], v[18:19], v[24:25], v[32:33]
    v_pk_fma_f32 v[30:31], v[18:19], v[22:23], v[30:31]
    v_pk_fma_f32 v[32:33], v[20:21], v[22:23], v[32:33]
    v_lshlrev_b32 v34, 16, v58
    s_add_u32 m0, s84, 12288
    s_add_u32 s83, s73, s85
    buffer_load_dwordx4 v158, s[60:63], s83 offen lds
    s_waitcnt vmcnt(14)
    ds_read_b128 a[8:11], v156 offset:2048
    v_and_b32 v35, s86, v58
    v_lshlrev_b32 v36, 16, v59
    v_and_b32 v37, s86, v59
    v_pk_mul_f32 v[34:35], v[30:31], v[34:35]
    ds_read_b128 a[12:15], v157 offset:2048
    s_waitcnt vmcnt(12)
    ds_read_b128 a[16:19], v156 offset:4096
    ds_read_b128 a[20:23], v157 offset:4096
    v_pk_mul_f32 v[36:37], v[32:33], v[36:37]
    v_cvt_pk_bf16_f32 v104, v36, v34
    v_cvt_pk_bf16_f32 v108, v37, v35
    v_and_b32 v104, -2, v104
    v_and_b32 v108, -2, v108
    global_store_dwordx4 v76, v[104:107], s[50:51] offset:-2048 sc1
    global_store_dwordx4 v76, v[108:111], s[50:51] offset:2048 sc1
    s_waitcnt lgkmcnt(0)
    s_barrier
    ds_read_b128 v[60:63], v120 offset:0
    ds_read_b128 v[64:67], v120 offset:2048
    ds_read_b128 v[68:71], v120 offset:4096
    ds_read_b128 v[72:75], v120 offset:6144
    ds_read_b128 v[76:79], v121 offset:0
    ds_read_b128 v[80:83], v121 offset:2048
    ds_read_b128 v[84:87], v121 offset:4096
    ds_read_b128 v[88:91], v121 offset:6144
    buffer_load_dwordx4 v159, s[60:63], s83 offen offset:1024 lds
    s_waitcnt lgkmcnt(6)
    v_mfma_f32_16x16x32_bf16 v[176:179], v[60:63], a[0:3], 0
    s_add_u32 s38, s3, s4
    v_mfma_f32_16x16x32_bf16 v[192:195], v[60:63], a[8:11], 0
    s_sub_u32 s39, s3, s4
    v_mfma_f32_16x16x32_bf16 v[32:35], v[60:63], a[16:19], 0
    ds_read_b128 v[60:63], v122 offset:0
    s_add_u32 s39, s39, 3072
    v_mfma_f32_16x16x32_bf16 v[48:51], v[116:119], a[0:3], 0
    ds_read_b64 v[170:171], v228
    s_add_u32 m0, s84, 14336
    s_add_u32 s83, s73, s85
    buffer_load_dwordx4 v158, s[92:95], s83 offen lds
    v_mfma_f32_16x16x32_bf16 v[180:183], v[64:67], a[0:3], 0
    s_lshr_b32 s13, s79, 4
    s_sub_u32 s4, 3, s13
    global_load_dword v224, v224, s[48:49] sc1
    v_mfma_f32_16x16x32_bf16 v[196:199], v[64:67], a[8:11], 0
    s_cmp_eq_u32 s81, 0
    s_cselect_b32 s3, s4, s13
    v_mfma_f32_16x16x32_bf16 v[36:39], v[64:67], a[16:19], 0
    ds_read_b128 v[64:67], v122 offset:2048
    buffer_load_dwordx4 v159, s[92:95], s83 offen offset:1024 lds
    v_mfma_f32_16x16x32_bf16 v[52:55], v[116:119], a[8:11], 0
    s_lshl_b32 s3, s3, 1
    s_waitcnt lgkmcnt(7)
    v_mfma_f32_16x16x32_bf16 v[184:187], v[68:71], a[0:3], 0
    s_add_u32 s3, s3, s80
    s_lshl_b32 s40, s3, 9
    v_mfma_f32_16x16x32_bf16 v[200:203], v[68:71], a[8:11], 0
    s_waitcnt lgkmcnt(1)
    global_store_dwordx2 v229, v[170:171], s[50:51] sc1
    v_mfma_f32_16x16x32_bf16 v[40:43], v[68:71], a[16:19], 0
    ds_read_b128 v[68:71], v122 offset:4096
    s_add_u32 m0, s100, 32768
    s_mov_b32 s83, s74
    buffer_load_dwordx4 v164, s[52:55], s83 offen lds
    v_mfma_f32_16x16x32_bf16 v[56:59], v[116:119], a[16:19], 0
    v_bfe_u32 v230, v152, 1, 2
    v_and_b32 v227, 1, v152
    v_mfma_f32_16x16x32_bf16 v[188:191], v[72:75], a[0:3], 0
    s_cmp_eq_u32 s77, 0
    s_cselect_b32 s30, 0, s30
    s_cselect_b32 s31, 0, s31
    s_cselect_b32 s32, 0, s32
    v_mfma_f32_16x16x32_bf16 v[204:207], v[72:75], a[8:11], 0
    v_lshlrev_b32 v230, 18, v230
    v_lshl_add_u32 v227, v227, 7, v230
    v_mfma_f32_16x16x32_bf16 v[44:47], v[72:75], a[16:19], 0
    ds_read_b128 v[72:75], v122 offset:6144
    buffer_load_dwordx4 v165, s[52:55], s83 offen offset:1024 lds
    v_mfma_f32_16x16x32_bf16 v[176:179], v[76:79], a[4:7], v[176:179]
    s_lshl_b32 s3, s79, 13
    s_add_u32 s3, s3, s100
    v_mfma_f32_16x16x32_bf16 v[192:195], v[76:79], a[12:15], v[192:195]
    s_lshl_b32 s4, s78, 8
    s_add_u32 s3, s3, s4
    ds_read_b128 v[92:95], v124 offset:0
    v_mfma_f32_16x16x32_bf16 v[32:35], v[76:79], a[20:23], v[32:35]
    ds_read_b128 v[76:79], v123 offset:0
    s_add_u32 s3, s3, 10485760
    ds_read_b128 v[96:99], v125 offset:0
    v_mfma_f32_16x16x32_bf16 v[48:51], v[116:119], a[4:7], v[48:51]
    s_add_u32 m0, s100, 40960
    s_add_u32 s83, s74, 640
    buffer_load_dwordx4 v164, s[52:55], s83 offen lds
    ds_read_b128 v[100:103], v124 offset:8192
    v_mfma_f32_16x16x32_bf16 v[180:183], v[80:83], a[4:7], v[180:183]
    ds_read_b128 v[104:107], v125 offset:8192
    v_add_u32 v227, s3, v227
    s_lshl_b32 s91, s79, 3
    v_mfma_f32_16x16x32_bf16 v[196:199], v[80:83], a[12:15], v[196:199]
    s_add_u32 s91, s91, s78
    s_lshl_b32 s91, s91, 2
    v_mfma_f32_16x16x32_bf16 v[36:39], v[80:83], a[20:23], v[36:39]
    ds_read_b128 v[80:83], v123 offset:2048
    s_add_u32 s91, s91, s77
    v_mfma_f32_16x16x32_bf16 v[52:55], v[116:119], a[12:15], v[52:55]
    buffer_load_dwordx4 v165, s[52:55], s83 offen offset:1024 lds
    v_mfma_f32_16x16x32_bf16 v[184:187], v[84:87], a[4:7], v[184:187]
    s_mul_i32 s3, s91, 5120
    s_add_u32 s3, s3, 2048
    v_mfma_f32_16x16x32_bf16 v[200:203], v[84:87], a[12:15], v[200:203]
    v_min_u32 v226, 7, v152
    v_lshl_add_u32 v226, v226, 7, s3
    v_mfma_f32_16x16x32_bf16 v[40:43], v[84:87], a[20:23], v[40:43]
    ds_read_b128 v[84:87], v123 offset:4096
    s_mov_b32 m0, s84
    s_add_u32 s83, s73, s90
    buffer_load_dwordx4 v158, s[56:59], s83 offen lds
    v_mfma_f32_16x16x32_bf16 v[56:59], v[116:119], a[20:23], v[56:59]
    v_and_b32 v225, 15, v152
    s_lshl_b32 s3, s77, 6
    s_waitcnt lgkmcnt(4)
    v_mfma_f32_16x16x32_bf16 v[108:111], v[92:95], v[92:95], 0
    s_add_u32 s3, s3, 93440
    v_lshl_add_u32 v225, v225, 2, s3
    v_mfma_f32_16x16x32_bf16 v[232:235], v[116:119], v[92:95], 0
    s_waitcnt vmcnt(22)
    ds_read_b128 a[24:27], v156 offset:6144
    ds_read_b128 a[28:31], v157 offset:6144
    v_mfma_f32_16x16x32_bf16 v[188:191], v[88:91], a[4:7], v[188:191]
    buffer_load_dwordx4 v159, s[56:59], s83 offen offset:1024 lds
    s_waitcnt vmcnt(20)
    ds_read_b128 a[32:35], v156 offset:8192
    ds_read_b128 a[36:39], v157 offset:8192
    v_mfma_f32_16x16x32_bf16 v[204:207], v[88:91], a[12:15], v[204:207]
    v_bfe_u32 v222, v152, 1, 2
    s_lshl_b32 s3, s77, 4
    v_mfma_f32_16x16x32_bf16 v[44:47], v[88:91], a[20:23], v[44:47]
    ds_read_b128 v[88:91], v123 offset:6144
    s_add_u32 s3, s3, 93440
    v_mfma_f32_16x16x32_bf16 v[108:111], v[96:99], v[96:99], v[108:111]
    v_lshl_add_u32 v222, v222, 2, s3
    v_and_b32 v230, 8, v152
    v_mfma_f32_16x16x32_bf16 v[232:235], v[116:119], v[96:99], v[232:235]
    s_add_u32 m0, s84, 2048
    s_add_u32 s83, s73, s90
    buffer_load_dwordx4 v158, s[60:63], s83 offen lds
    s_waitcnt lgkmcnt(3)
    v_mfma_f32_16x16x32_bf16 v[176:179], v[60:63], a[24:27], v[176:179]
    v_lshl_add_u32 v222, v230, 3, v222
    s_waitcnt lgkmcnt(1)
    v_mfma_f32_16x16x32_bf16 v[192:195], v[60:63], a[32:35], v[192:195]
    s_waitcnt vmcnt(17)
    s_barrier
    ds_read_b128 v[60:63], v120 offset:16384
    v_mfma_f32_16x16x32_bf16 v[48:51], v[116:119], a[24:27], v[48:51]
    s_add_u32 s3, s84, 4096
    v_and_b32 v220, 16, v152
    v_mfma_f32_16x16x32_bf16 v[108:111], v[100:103], v[100:103], v[108:111]
    buffer_load_dwordx4 v159, s[60:63], s83 offen offset:1024 lds
    v_lshlrev_b32 v220, 2, v220
    v_mfma_f32_16x16x32_bf16 v[232:235], v[116:119], v[100:103], v[232:235]
    v_xor_b32 v220, v220, v153
    v_add_u32 v220, s3, v220
    v_mfma_f32_16x16x32_bf16 v[180:183], v[64:67], a[24:27], v[180:183]
    v_bfe_u32 v230, v152, 2, 2
    s_lshl_b32 s3, s77, 4
    v_mfma_f32_16x16x32_bf16 v[196:199], v[64:67], a[32:35], v[196:199]
    ds_read_b128 v[64:67], v120 offset:18432
    s_add_u32 s3, s3, 92160
    v_mfma_f32_16x16x32_bf16 v[52:55], v[116:119], a[32:35], v[52:55]
    s_add_u32 m0, s100, 49152
    s_mov_b32 s83, s75
    buffer_load_dwordx4 v164, s[52:55], s83 offen lds
    v_mfma_f32_16x16x32_bf16 v[108:111], v[104:107], v[104:107], v[108:111]
    v_lshl_add_u32 v126, v230, 6, s3
    s_lshl_b32 s3, s77, 3
    v_mfma_f32_16x16x32_bf16 v[232:235], v[116:119], v[104:107], v[232:235]
    s_add_u32 s3, s3, 92672
    v_mfma_f32_16x16x32_bf16 v[184:187], v[68:71], a[24:27], v[184:187]
    buffer_load_dwordx4 v165, s[52:55], s83 offen offset:1024 lds
    v_lshl_add_u32 v127, v230, 6, s3
    v_mfma_f32_16x16x32_bf16 v[200:203], v[68:71], a[32:35], v[200:203]
    ds_read_b128 v[68:71], v120 offset:20480
    ds_read_b128 v[92:95], v124 offset:16384
    v_bfe_u32 v230, v152, 0, 2
    v_mfma_f32_16x16x32_bf16 v[188:191], v[72:75], a[24:27], v[188:191]
    ds_read_b128 v[96:99], v125 offset:16384
    v_lshl_add_u32 v126, v230, 2, v126
    v_bfe_u32 v230, v152, 0, 1
    v_mfma_f32_16x16x32_bf16 v[204:207], v[72:75], a[32:35], v[204:207]
    ds_read_b128 v[72:75], v120 offset:22528
    ds_read_b128 v[100:103], v124 offset:24576
    v_mfma_f32_16x16x32_bf16 v[176:179], v[76:79], a[28:31], v[176:179]
    s_add_u32 m0, s100, 57344
    s_add_u32 s83, s75, 640
    buffer_load_dwordx4 v164, s[52:55], s83 offen lds
    ds_read_b128 v[104:107], v125 offset:24576
    v_mfma_f32_16x16x32_bf16 v[192:195], v[76:79], a[36:39], v[192:195]
    ds_read_b128 v[76:79], v121 offset:16384
    v_lshl_add_u32 v127, v230, 5, v127
    v_mfma_f32_16x16x32_bf16 v[48:51], v[116:119], a[28:31], v[48:51]
    v_bfe_u32 v230, v152, 1, 1
    v_lshl_add_u32 v127, v230, 2, v127
    v_mfma_f32_16x16x32_bf16 v[180:183], v[80:83], a[28:31], v[180:183]
    v_and_b32 v230, 15, v152
    s_lshl_b32 s3, s77, 7
    v_mfma_f32_16x16x32_bf16 v[196:199], v[80:83], a[36:39], v[196:199]
    ds_read_b128 v[80:83], v121 offset:18432
    buffer_load_dwordx4 v165, s[52:55], s83 offen offset:1024 lds
    v_mfma_f32_16x16x32_bf16 v[52:55], v[116:119], a[36:39], v[52:55]
    s_add_u32 s3, s3, 81920
    s_waitcnt lgkmcnt(10)
    v_mfma_f32_16x16x32_bf16 v[184:187], v[84:87], a[28:31], v[184:187]
    v_lshl_add_u32 v154, v230, 3, s3
    v_bfe_u32 v155, v152, 1, 2
    v_mfma_f32_16x16x32_bf16 v[200:203], v[84:87], a[36:39], v[200:203]
    ds_read_b128 v[84:87], v121 offset:20480
    s_lshl_b32 s3, s77, 5
    s_waitcnt lgkmcnt(6)
    v_mfma_f32_16x16x32_bf16 v[108:111], v[92:95], v[92:95], v[108:111]
    s_add_u32 m0, s84, 4096
    s_add_u32 s83, s74, s85
    buffer_load_dwordx4 v158, s[56:59], s83 offen lds
    s_waitcnt vmcnt(21)
    ds_read_b128 a[40:43], v156 offset:10240
    v_mfma_f32_16x16x32_bf16 v[232:235], v[116:119], v[92:95], v[232:235]
    ds_read_b128 a[44:47], v157 offset:10240
    s_waitcnt vmcnt(17)
    ds_read_b128 a[48:51], v156 offset:12288
    ds_read_b128 a[52:55], v157 offset:12288
    v_mfma_f32_16x16x32_bf16 v[188:191], v[88:91], a[28:31], v[188:191]
    s_waitcnt vmcnt(14)
    ds_read_b128 a[56:59], v156 offset:14336
    ds_read_b128 a[60:63], v157 offset:14336
    v_mfma_f32_16x16x32_bf16 v[204:207], v[88:91], a[36:39], v[204:207]
    ds_read_b128 v[88:91], v121 offset:22528
    s_add_u32 s3, s3, 82432
    v_mfma_f32_16x16x32_bf16 v[108:111], v[96:99], v[96:99], v[108:111]
    buffer_load_dwordx4 v159, s[56:59], s83 offen offset:1024 lds
    v_lshl_add_u32 v155, v155, 3, s3
    v_mfma_f32_16x16x32_bf16 v[232:235], v[116:119], v[96:99], v[232:235]
    s_waitcnt lgkmcnt(5)
    v_mfma_f32_16x16x32_bf16 v[176:179], v[60:63], a[40:43], v[176:179]
    v_not_b32 v230, v152
    s_waitcnt lgkmcnt(3)
    v_mfma_f32_16x16x32_bf16 v[192:195], v[60:63], a[48:51], v[192:195]
    s_add_u32 m0, s84, 6144
    s_add_u32 s83, s74, s85
    buffer_load_dwordx4 v158, s[60:63], s83 offen lds
    s_waitcnt lgkmcnt(1)
    v_mfma_f32_16x16x32_bf16 v[32:35], v[60:63], a[56:59], v[32:35]
    ds_read_b128 v[60:63], v122 offset:16384
    v_lshlrev_b32 v230, 28, v230
    v_mfma_f32_16x16x32_bf16 v[48:51], v[116:119], a[40:43], v[48:51]
    v_and_b32 v163, 0x80000000, v230
    v_lshrrev_b32 v230, 4, v152
    v_mfma_f32_16x16x32_bf16 v[108:111], v[100:103], v[100:103], v[108:111]
    s_mov_b32 s3, 92160
    v_lshl_add_u32 v216, v230, 6, s3
    v_mfma_f32_16x16x32_bf16 v[232:235], v[116:119], v[100:103], v[232:235]
    buffer_load_dwordx4 v159, s[60:63], s83 offen offset:1024 lds
    v_and_b32 v218, 1, v152
    v_mfma_f32_16x16x32_bf16 v[180:183], v[64:67], a[40:43], v[180:183]
    v_lshl_add_u32 v217, v218, 5, v216
    v_lshlrev_b32 v218, 2, v218
    v_mfma_f32_16x16x32_bf16 v[196:199], v[64:67], a[48:51], v[196:199]
    v_lshl_add_u32 v218, v230, 8, v218
    v_and_b32 v230, 1, v230
    v_mfma_f32_16x16x32_bf16 v[36:39], v[64:67], a[56:59], v[36:39]
    ds_read_b128 v[64:67], v122 offset:18432
    v_xor_b32 v230, s77, v230
    v_mfma_f32_16x16x32_bf16 v[52:55], v[116:119], a[48:51], v[52:55]
    s_add_u32 m0, s84, 8192
    s_add_u32 s83, s74, s85
    buffer_load_dwordx4 v158, s[92:95], s83 offen lds
    v_mfma_f32_16x16x32_bf16 v[108:111], v[104:107], v[104:107], v[108:111]
    v_lshl_add_u32 v218, v230, 6, v218
    v_bfe_u32 v230, v152, 1, 2
    v_mfma_f32_16x16x32_bf16 v[232:235], v[116:119], v[104:107], v[232:235]
    v_lshl_add_u32 v218, v230, 4, v218
    v_mfma_f32_16x16x32_bf16 v[184:187], v[68:71], a[40:43], v[184:187]
    v_bfe_u32 v230, v152, 3, 1
    v_lshlrev_b32 v230, 14, v230
    v_mfma_f32_16x16x32_bf16 v[200:203], v[68:71], a[48:51], v[200:203]
    buffer_load_dwordx4 v159, s[92:95], s83 offen offset:1024 lds
    s_mov_b32 s3, 102400
    v_mfma_f32_16x16x32_bf16 v[40:43], v[68:71], a[56:59], v[40:43]
    ds_read_b128 v[68:71], v122 offset:20480
    v_add3_u32 v218, v230, v218, s3
    v_mfma_f32_16x16x32_bf16 v[56:59], v[116:119], a[56:59], v[56:59]
    v_xor_b32 v219, 8, v218
    s_mul_i32 s3, s79, 163840
    v_mfma_f32_16x16x32_bf16 v[188:191], v[72:75], a[40:43], v[188:191]
    s_mul_i32 s4, s78, 5120
    s_add_u32 s3, s3, s4
    v_mfma_f32_16x16x32_bf16 v[204:207], v[72:75], a[48:51], v[204:207]
    s_add_u32 m0, s100, 65536
    s_mov_b32 s83, s76
    buffer_load_dwordx4 v164, s[52:55], s83 offen lds
    v_mfma_f32_16x16x32_bf16 v[44:47], v[72:75], a[56:59], v[44:47]
    ds_read_b128 v[72:75], v122 offset:22528
    v_mfma_f32_16x16x32_bf16 v[176:179], v[76:79], a[44:47], v[176:179]
    s_lshl_b32 s4, s77, 10
    s_add_u32 s36, s3, s4
    s_waitcnt vmcnt(15)
    v_mfma_f32_16x16x32_bf16 v[192:195], v[76:79], a[52:55], v[192:195]
    buffer_load_dwordx4 v165, s[52:55], s83 offen offset:1024 lds
    s_add_u32 s18, s36, 40960
    ds_read_b128 v[92:95], v124 offset:32768
    v_mfma_f32_16x16x32_bf16 v[32:35], v[76:79], a[60:63], v[32:35]
    ds_read_b128 v[76:79], v123 offset:16384
    s_add_u32 s19, s36, 81920
    ds_read_b128 v[96:99], v125 offset:32768
    v_mfma_f32_16x16x32_bf16 v[48:51], v[116:119], a[44:47], v[48:51]
    s_add_u32 s20, s36, 122880
    s_lshl_b32 s4, s81, 8
    ds_read_b128 v[100:103], v124 offset:40960
    v_mfma_f32_16x16x32_bf16 v[180:183], v[80:83], a[44:47], v[180:183]
    s_add_u32 s3, s3, s4
    s_lshl_b32 s4, s80, 3
    ds_read_b128 v[104:107], v125 offset:40960
    v_mfma_f32_16x16x32_bf16 v[196:199], v[80:83], a[52:55], v[196:199]
    s_add_u32 m0, s100, 73728
    s_add_u32 s83, s76, 640
    buffer_load_dwordx4 v164, s[52:55], s83 offen lds
    v_mfma_f32_16x16x32_bf16 v[36:39], v[80:83], a[60:63], v[36:39]
    ds_read_b128 v[80:83], v123 offset:18432
    s_add_u32 s3, s3, s4
    v_mfma_f32_16x16x32_bf16 v[52:55], v[116:119], a[52:55], v[52:55]
    s_add_u32 s37, s3, 4096
    s_waitcnt lgkmcnt(10)
    v_mfma_f32_16x16x32_bf16 v[184:187], v[84:87], a[44:47], v[184:187]
    v_mfma_f32_16x16x32_bf16 v[200:203], v[84:87], a[52:55], v[200:203]
    buffer_load_dwordx4 v165, s[52:55], s83 offen offset:1024 lds
    v_mfma_f32_16x16x32_bf16 v[40:43], v[84:87], a[60:63], v[40:43]
    ds_read_b128 v[84:87], v123 offset:20480
    v_and_b32 v165, 15, v152
    v_mfma_f32_16x16x32_bf16 v[56:59], v[116:119], a[60:63], v[56:59]
    v_lshrrev_b32 v230, 4, v152
    v_add_u32 v164, 1, v165
    s_waitcnt lgkmcnt(4)
    v_mfma_f32_16x16x32_bf16 v[108:111], v[92:95], v[92:95], v[108:111]
    v_and_b32 v231, 1, v164
    v_sub_u32 v164, v164, v231
    v_mfma_f32_16x16x32_bf16 v[232:235], v[116:119], v[92:95], v[232:235]
    s_add_u32 m0, s84, 10240
    s_add_u32 s83, s74, s90
    buffer_load_dwordx4 v158, s[56:59], s83 offen lds
    s_waitcnt vmcnt(17)
    ds_read_b128 a[64:67], v156 offset:0
    v_mfma_f32_16x16x32_bf16 v[188:191], v[88:91], a[44:47], v[188:191]
    ds_read_b128 a[68:71], v157 offset:0
    s_waitcnt vmcnt(15)
    ds_read_b128 a[72:75], v156 offset:2048
    ds_read_b128 a[76:79], v157 offset:2048
    v_mfma_f32_16x16x32_bf16 v[204:207], v[88:91], a[52:55], v[204:207]
    v_mul_u32_u24 v231, 4164, v231
    v_lshl_add_u32 v164, v164, 1, v231
    v_mfma_f32_16x16x32_bf16 v[44:47], v[88:91], a[60:63], v[44:47]
    ds_read_b128 v[88:91], v123 offset:22528
    v_lshlrev_b32 v231, 4, v230
    v_mfma_f32_16x16x32_bf16 v[108:111], v[96:99], v[96:99], v[108:111]
    buffer_load_dwordx4 v159, s[56:59], s83 offen offset:1024 lds
    v_sub_u32 v164, v164, v231
    v_mfma_f32_16x16x32_bf16 v[232:235], v[116:119], v[96:99], v[232:235]
    s_waitcnt lgkmcnt(3)
    v_mfma_f32_16x16x32_bf16 v[176:179], v[60:63], a[64:67], v[176:179]
    v_lshl_add_u32 v165, v165, 5, v231
    s_waitcnt lgkmcnt(1)
    v_mfma_f32_16x16x32_bf16 v[192:195], v[60:63], a[72:75], v[192:195]
    s_barrier
    ds_read_b128 v[60:63], v120 offset:32768
    v_mfma_f32_16x16x32_bf16 v[48:51], v[116:119], a[64:67], v[48:51]
    s_add_u32 m0, s84, 12288
    s_add_u32 s83, s74, s90
    buffer_load_dwordx4 v158, s[60:63], s83 offen lds
    v_mfma_f32_16x16x32_bf16 v[108:111], v[100:103], v[100:103], v[108:111]
    s_lshl_b32 s3, s77, 7
    s_add_u32 s4, s3, 13872
    L_nonce:
    v_readfirstlane_b32 s82, v224
    s_cmp_eq_u32 s82, 0
    s_cbranch_scc1 L_nonce_re
    s_cmp_lg_u32 s77, 0
    s_cbranch_scc1 L_nokf
    s_xor_b32 s8, s82, s89
    v_mov_b32 v224, s8
    global_store_dword v223, v224, s[50:51] sc1
    L_nokf:

    v_mfma_f32_16x16x32_bf16 v[232:235], v[116:119], v[100:103], v[232:235]
    s_sub_u32 s3, 9632, s3
    v_add_u32 v164, s4, v164
    v_mfma_f32_16x16x32_bf16 v[180:183], v[64:67], a[64:67], v[180:183]
    buffer_load_dwordx4 v159, s[60:63], s83 offen offset:1024 lds
    v_add_u32 v165, s3, v165
    v_mfma_f32_16x16x32_bf16 v[196:199], v[64:67], a[72:75], v[196:199]
    ds_read_b128 v[64:67], v120 offset:34816
    s_min_u32 s4, s77, 2
    v_mfma_f32_16x16x32_bf16 v[52:55], v[116:119], a[72:75], v[52:55]
    s_mul_i32 s3, s4, 4608
    s_add_u32 s3, s3, 0
    v_mfma_f32_16x16x32_bf16 v[108:111], v[104:107], v[104:107], v[108:111]
    v_lshl_add_u32 v173, v152, 3, s3
    s_mul_i32 s4, s4, 8320
    v_mfma_f32_16x16x32_bf16 v[232:235], v[116:119], v[104:107], v[232:235]
    s_add_u32 m0, s84, 14336
    s_add_u32 s83, s75, s85
    buffer_load_dwordx4 v158, s[56:59], s83 offen lds
    v_mfma_f32_16x16x32_bf16 v[184:187], v[68:71], a[64:67], v[184:187]
    s_add_u32 s4, s4, 13824
    s_waitcnt vmcnt(15)
    v_lshrrev_b32 v172, 3, v152
    v_mfma_f32_16x16x32_bf16 v[200:203], v[68:71], a[72:75], v[200:203]
    ds_read_b128 v[68:71], v120 offset:36864
    ds_read_b128 v[92:95], v124 offset:49152
    v_mul_u32_u24 v172, 4132, v172
    v_mfma_f32_16x16x32_bf16 v[188:191], v[72:75], a[64:67], v[188:191]
    ds_read_b128 v[96:99], v125 offset:49152
    v_lshl_add_u32 v172, v152, 2, v172
    v_add_u32 v172, s4, v172
    v_mfma_f32_16x16x32_bf16 v[204:207], v[72:75], a[72:75], v[204:207]
    ds_read_b128 v[72:75], v120 offset:38912
    buffer_load_dwordx4 v159, s[56:59], s83 offen offset:1024 lds
    ds_read_b128 v[100:103], v124 offset:57344
    v_mfma_f32_16x16x32_bf16 v[176:179], v[76:79], a[68:71], v[176:179]
    s_and_b32 s3, s79, 1
    s_lshl_b32 s3, s3, 4
    ds_read_b128 v[104:107], v125 offset:57344
    v_mfma_f32_16x16x32_bf16 v[192:195], v[76:79], a[76:79], v[192:195]
    ds_read_b128 v[76:79], v121 offset:32768
    s_lshr_b32 s35, s35, s3
    v_mfma_f32_16x16x32_bf16 v[48:51], v[116:119], a[68:71], v[48:51]
    s_lshl_b32 s35, s35, 16
    s_lshl_b32 s3, s81, 4
    v_mfma_f32_16x16x32_bf16 v[180:183], v[80:83], a[68:71], v[180:183]
    s_mov_b32 m0, s84
    s_add_u32 s83, s75, s85
    buffer_load_dwordx4 v158, s[60:63], s83 offen lds
    v_mfma_f32_16x16x32_bf16 v[196:199], v[80:83], a[76:79], v[196:199]
    ds_read_b128 v[80:83], v121 offset:34816
    s_lshr_b32 s34, s34, s3
    v_mfma_f32_16x16x32_bf16 v[52:55], v[116:119], a[76:79], v[52:55]
    s_lshl_b32 s34, s34, 16
    s_waitcnt lgkmcnt(10)
    v_mfma_f32_16x16x32_bf16 v[184:187], v[84:87], a[68:71], v[184:187]
    s_mov_b64 s[68:69], s[50:51]
    s_mov_b32 s70, 5767168
    v_mfma_f32_16x16x32_bf16 v[200:203], v[84:87], a[76:79], v[200:203]
    ds_read_b128 v[84:87], v121 offset:36864
    buffer_load_dwordx4 v159, s[60:63], s83 offen offset:1024 lds
    s_waitcnt lgkmcnt(6)
    v_mfma_f32_16x16x32_bf16 v[108:111], v[92:95], v[92:95], v[108:111]
    s_waitcnt vmcnt(16)
    ds_read_b128 a[80:83], v156 offset:4096
    ds_read_b128 a[84:87], v157 offset:4096
    v_mfma_f32_16x16x32_bf16 v[232:235], v[116:119], v[92:95], v[232:235]
    s_waitcnt vmcnt(14)
    ds_read_b128 a[88:91], v156 offset:6144
    ds_read_b128 a[92:95], v157 offset:6144
    v_mfma_f32_16x16x32_bf16 v[188:191], v[88:91], a[68:71], v[188:191]
    s_waitcnt vmcnt(12)
    ds_read_b128 a[96:99], v156 offset:8192
    ds_read_b128 a[100:103], v157 offset:8192
    v_mfma_f32_16x16x32_bf16 v[204:207], v[88:91], a[76:79], v[204:207]
    ds_read_b128 v[88:91], v121 offset:38912
    s_mov_b64 s[64:65], s[46:47]
    v_mfma_f32_16x16x32_bf16 v[108:111], v[96:99], v[96:99], v[108:111]
    s_mov_b32 s66, 5242880
    v_mov_b64 v[228:229], 0
    v_mfma_f32_16x16x32_bf16 v[232:235], v[116:119], v[96:99], v[232:235]
    s_waitcnt lgkmcnt(5)
    v_mfma_f32_16x16x32_bf16 v[176:179], v[60:63], a[80:83], v[176:179]
    s_waitcnt lgkmcnt(3)
    v_mfma_f32_16x16x32_bf16 v[192:195], v[60:63], a[88:91], v[192:195]
    s_waitcnt lgkmcnt(1)
    v_mfma_f32_16x16x32_bf16 v[32:35], v[60:63], a[96:99], v[32:35]
    ds_read_b128 v[60:63], v122 offset:32768
    v_mfma_f32_16x16x32_bf16 v[48:51], v[116:119], a[80:83], v[48:51]
    v_mfma_f32_16x16x32_bf16 v[108:111], v[100:103], v[100:103], v[108:111]
    v_mfma_f32_16x16x32_bf16 v[232:235], v[116:119], v[100:103], v[232:235]
    v_mfma_f32_16x16x32_bf16 v[180:183], v[64:67], a[80:83], v[180:183]
    v_mfma_f32_16x16x32_bf16 v[196:199], v[64:67], a[88:91], v[196:199]
    v_mfma_f32_16x16x32_bf16 v[36:39], v[64:67], a[96:99], v[36:39]
    ds_read_b128 v[64:67], v122 offset:34816
    v_mfma_f32_16x16x32_bf16 v[52:55], v[116:119], a[88:91], v[52:55]
    v_mfma_f32_16x16x32_bf16 v[108:111], v[104:107], v[104:107], v[108:111]
    v_mfma_f32_16x16x32_bf16 v[232:235], v[116:119], v[104:107], v[232:235]
    v_mfma_f32_16x16x32_bf16 v[184:187], v[68:71], a[80:83], v[184:187]
    global_load_dword v131, v112, s[26:27]
    v_mfma_f32_16x16x32_bf16 v[200:203], v[68:71], a[88:91], v[200:203]
    v_mfma_f32_16x16x32_bf16 v[40:43], v[68:71], a[96:99], v[40:43]
    ds_read_b128 v[68:71], v122 offset:36864
    global_load_dword v131, v112, s[28:29]
    v_mfma_f32_16x16x32_bf16 v[56:59], v[116:119], a[96:99], v[56:59]
    v_add_u32 v124, 0x10000, v124
    v_mfma_f32_16x16x32_bf16 v[188:191], v[72:75], a[80:83], v[188:191]
    s_add_u32 m0, s84, 2048
    s_add_u32 s83, s75, s85
    buffer_load_dwordx4 v158, s[92:95], s83 offen lds
    v_add_u32 v125, 0x10000, v125
    v_mfma_f32_16x16x32_bf16 v[204:207], v[72:75], a[88:91], v[204:207]
    s_waitcnt vmcnt(11)
    v_mfma_f32_16x16x32_bf16 v[44:47], v[72:75], a[96:99], v[44:47]
    ds_read_b128 v[72:75], v122 offset:38912
    ds_read_b128 v[92:95], v124 offset:0
    v_mfma_f32_16x16x32_bf16 v[176:179], v[76:79], a[84:87], v[176:179]
    buffer_load_dwordx4 v159, s[92:95], s83 offen offset:1024 lds
    ds_read_b128 v[96:99], v125 offset:0
    v_mfma_f32_16x16x32_bf16 v[192:195], v[76:79], a[92:95], v[192:195]
    ds_read_b128 v[100:103], v124 offset:8192
    v_mfma_f32_16x16x32_bf16 v[32:35], v[76:79], a[100:103], v[32:35]
    ds_read_b128 v[76:79], v123 offset:32768
    ds_read_b128 v[104:107], v125 offset:8192
    v_mfma_f32_16x16x32_bf16 v[48:51], v[116:119], a[84:87], v[48:51]
    ds_read_b128 v[142:145], v128
    v_mfma_f32_16x16x32_bf16 v[180:183], v[80:83], a[84:87], v[180:183]
    s_add_u32 m0, s84, 4096
    s_add_u32 s83, s76, s85
    buffer_load_dwordx4 v158, s[56:59], s83 offen lds
    ds_read_b128 v[146:149], v129
    v_mfma_f32_16x16x32_bf16 v[196:199], v[80:83], a[92:95], v[196:199]
    ds_read_b64 v[150:151], v130
    v_mfma_f32_16x16x32_bf16 v[36:39], v[80:83], a[100:103], v[36:39]
    ds_read_b128 v[80:83], v123 offset:34816
    v_mfma_f32_16x16x32_bf16 v[52:55], v[116:119], a[92:95], v[52:55]
    s_waitcnt lgkmcnt(7)
    v_mfma_f32_16x16x32_bf16 v[108:111], v[92:95], v[92:95], v[108:111]
    buffer_load_dwordx4 v159, s[56:59], s83 offen offset:1024 lds
    v_mfma_f32_16x16x32_bf16 v[232:235], v[116:119], v[92:95], v[232:235]
    v_mfma_f32_16x16x32_bf16 v[184:187], v[84:87], a[84:87], v[184:187]
    v_mfma_f32_16x16x32_bf16 v[200:203], v[84:87], a[92:95], v[200:203]
    v_mfma_f32_16x16x32_bf16 v[40:43], v[84:87], a[100:103], v[40:43]
    ds_read_b128 v[84:87], v123 offset:36864
    s_add_u32 m0, s84, 6144
    s_add_u32 s83, s76, s85
    buffer_load_dwordx4 v158, s[60:63], s83 offen lds
    v_mfma_f32_16x16x32_bf16 v[56:59], v[116:119], a[100:103], v[56:59]
    s_waitcnt lgkmcnt(2)
    ds_read_b128 v[0:3], v166 offset:0
    ds_read_b128 v[4:7], v166 offset:16
    v_mfma_f32_16x16x32_bf16 v[108:111], v[96:99], v[96:99], v[108:111]
    ds_read_b128 v[8:11], v166 offset:128
    ds_read_b128 v[12:15], v166 offset:144
    ds_read_b128 v[16:19], v167 offset:256
    v_mfma_f32_16x16x32_bf16 v[232:235], v[116:119], v[96:99], v[232:235]
    s_waitcnt vmcnt(13)
    ds_read_b128 a[104:107], v156 offset:10240
    ds_read_b128 a[108:111], v157 offset:10240
    v_mfma_f32_16x16x32_bf16 v[188:191], v[88:91], a[84:87], v[188:191]
    buffer_load_dwordx4 v159, s[60:63], s83 offen offset:1024 lds
    s_waitcnt vmcnt(12)
    ds_read_b128 a[112:115], v156 offset:12288
    ds_read_b128 a[116:119], v157 offset:12288
    v_mfma_f32_16x16x32_bf16 v[204:207], v[88:91], a[92:95], v[204:207]
    v_lshlrev_b32 v132, 16, v142
    v_and_b32 v133, s86, v142
    v_mfma_f32_16x16x32_bf16 v[44:47], v[88:91], a[100:103], v[44:47]
    ds_read_b128 v[88:91], v123 offset:38912
    v_lshlrev_b32 v134, 16, v143
    v_mfma_f32_16x16x32_bf16 v[108:111], v[100:103], v[100:103], v[108:111]
    s_add_u32 m0, s84, 8192
    s_add_u32 s83, s76, s85
    buffer_load_dwordx4 v158, s[92:95], s83 offen lds
    v_mfma_f32_16x16x32_bf16 v[232:235], v[116:119], v[100:103], v[232:235]
    v_and_b32 v135, s86, v143
    s_waitcnt lgkmcnt(3)
    v_mfma_f32_16x16x32_bf16 v[176:179], v[60:63], a[104:107], v[176:179]
    v_lshlrev_b32 v136, 16, v144
    v_and_b32 v137, s86, v144
    s_waitcnt lgkmcnt(1)
    v_mfma_f32_16x16x32_bf16 v[192:195], v[60:63], a[112:115], v[192:195]
    s_waitcnt lgkmcnt(0)
    s_barrier
    ds_read_b128 v[60:63], v120 offset:49152
    v_mfma_f32_16x16x32_bf16 v[48:51], v[116:119], a[104:107], v[48:51]
    buffer_load_dwordx4 v159, s[92:95], s83 offen offset:1024 lds
    v_lshlrev_b32 v138, 16, v145
    v_and_b32 v139, s86, v145
    v_mfma_f32_16x16x32_bf16 v[108:111], v[104:107], v[104:107], v[108:111]
    v_lshlrev_b32 v140, 16, v146
    v_and_b32 v141, s86, v146
    v_mfma_f32_16x16x32_bf16 v[232:235], v[116:119], v[104:107], v[232:235]
    v_lshlrev_b32 v142, 16, v147
    v_and_b32 v143, s86, v147
    v_mfma_f32_16x16x32_bf16 v[180:183], v[64:67], a[104:107], v[180:183]
    v_lshlrev_b32 v144, 16, v148
    v_and_b32 v145, s86, v148
    v_mfma_f32_16x16x32_bf16 v[196:199], v[64:67], a[112:115], v[196:199]
    ds_read_b128 v[64:67], v120 offset:51200
    s_add_u32 m0, s84, 10240
    s_add_u32 s83, s75, s90
    buffer_load_dwordx4 v158, s[56:59], s83 offen lds
    v_mfma_f32_16x16x32_bf16 v[52:55], v[116:119], a[112:115], v[52:55]
    s_mov_b32 vcc_lo, 0xaaaaaaaa
    s_mov_b32 vcc_hi, 0xaaaaaaaa
    v_cndmask_b32 v108, v108, v109, vcc
    v_cndmask_b32 v110, v110, v111, vcc
    v_mfma_f32_16x16x32_bf16 v[184:187], v[68:71], a[104:107], v[184:187]
    s_mov_b32 vcc_lo, 0xcccccccc
    s_mov_b32 vcc_hi, 0xcccccccc
    v_cndmask_b32 v108, v108, v110, vcc
    v_mfma_f32_16x16x32_bf16 v[200:203], v[68:71], a[112:115], v[200:203]
    ds_read_b128 v[68:71], v120 offset:53248
    s_mov_b32 vcc_lo, 0x00f0000f
    s_mov_b32 vcc_hi, 0xf0000f00
    v_cndmask_b32 v108, 0, v108, vcc
    v_mfma_f32_16x16x32_bf16 v[188:191], v[72:75], a[104:107], v[188:191]
    buffer_load_dwordx4 v159, s[56:59], s83 offen offset:1024 lds
    v_mov_b32 v109, v108
    s_nop 1
    v_permlane32_swap_b32 v108, v109
    v_mfma_f32_16x16x32_bf16 v[204:207], v[72:75], a[112:115], v[204:207]
    ds_read_b128 v[72:75], v120 offset:55296
    v_add_f32 v108, v108, v109
    v_mov_b32 v109, v108
    v_mfma_f32_16x16x32_bf16 v[176:179], v[76:79], a[108:111], v[176:179]
    s_nop 0
    v_permlane16_swap_b32 v108, v109
    v_add_f32 v108, v108, v109
    v_mfma_f32_16x16x32_bf16 v[192:195], v[76:79], a[116:119], v[192:195]
    ds_read_b128 v[76:79], v121 offset:49152
    s_waitcnt vmcnt(14)
    ds_read_b128 a[120:123], v156 offset:14336
    ds_read_b128 a[124:127], v157 offset:14336
    v_mul_f32 v232, 0x3acccccd, v232
    v_mul_f32 v108, 0x3acccccd, v108
    v_mfma_f32_16x16x32_bf16 v[48:51], v[116:119], a[108:111], v[48:51]
    s_add_u32 m0, s84, 12288
    s_add_u32 s83, s75, s90
    buffer_load_dwordx4 v158, s[60:63], s83 offen lds
    v_fma_f32 v108, -v232, v232, v108
    v_max_f32 v108, 0, v108
    v_mfma_f32_16x16x32_bf16 v[180:183], v[80:83], a[108:111], v[180:183]
    v_cvt_pk_bf16_f32 v232, 0, v232
    v_cvt_pk_bf16_f32 v108, 0, v108
    v_mfma_f32_16x16x32_bf16 v[196:199], v[80:83], a[116:119], v[196:199]
    ds_read_b128 v[80:83], v121 offset:51200
    v_add_f32 v108, 0x3727c5ac, v108
    v_cvt_pk_bf16_f32 v108, 0, v108
    v_mfma_f32_16x16x32_bf16 v[52:55], v[116:119], a[116:119], v[52:55]
    buffer_load_dwordx4 v159, s[60:63], s83 offen offset:1024 lds
    s_waitcnt vmcnt(14)
    ds_read_b128 a[128:131], v156 offset:0
    ds_read_b128 a[132:135], v157 offset:0
    v_sqrt_f32 v108, v108
    v_xor_b32 v233, 0x80000000, v232
    v_mfma_f32_16x16x32_bf16 v[184:187], v[84:87], a[108:111], v[184:187]
    s_waitcnt vmcnt(10)
    ds_read_b128 a[136:139], v156 offset:2048
    ds_read_b128 a[140:143], v157 offset:2048
    v_cvt_pk_bf16_f32 v108, 0, v108
    v_rcp_f32 v108, v108
    v_mfma_f32_16x16x32_bf16 v[200:203], v[84:87], a[116:119], v[200:203]
    ds_read_b128 v[84:87], v121 offset:53248
    v_lshlrev_b32 v146, 16, v149
    v_and_b32 v147, s86, v149
    v_mfma_f32_16x16x32_bf16 v[188:191], v[88:91], a[108:111], v[188:191]
    v_lshlrev_b32 v148, 16, v150
    v_and_b32 v149, s86, v150
    v_mfma_f32_16x16x32_bf16 v[204:207], v[88:91], a[116:119], v[204:207]
    ds_read_b128 v[88:91], v121 offset:55296
    s_waitcnt lgkmcnt(7)
    s_add_u32 m0, s84, 14336
    s_add_u32 s83, s76, s90
    buffer_load_dwordx4 v158, s[56:59], s83 offen lds
    v_mfma_f32_16x16x32_bf16 v[176:179], v[60:63], a[120:123], v[176:179]
    v_lshlrev_b32 v150, 16, v151
    v_and_b32 v151, s86, v151
    s_waitcnt lgkmcnt(4)
    v_mfma_f32_16x16x32_bf16 v[192:195], v[60:63], a[128:131], v[192:195]
    v_add_f32 v132, v233, v132
    s_waitcnt lgkmcnt(2)
    v_mfma_f32_16x16x32_bf16 v[32:35], v[60:63], a[136:139], v[32:35]
    v_add_u32 v120, 0x10000, v120
    v_add_u32 v121, 0x10000, v121
    ds_read_b128 v[60:63], v120 offset:0
    v_add_f32 v133, v233, v133
    v_add_f32 v134, v233, v134
    v_mfma_f32_16x16x32_bf16 v[48:51], v[116:119], a[120:123], v[48:51]
    buffer_load_dwordx4 v159, s[56:59], s83 offen offset:1024 lds
    v_add_f32 v135, v233, v135
    v_add_f32 v136, v233, v136
    v_mfma_f32_16x16x32_bf16 v[180:183], v[64:67], a[120:123], v[180:183]
    v_add_f32 v137, v233, v137
    v_add_f32 v138, v233, v138
    v_mfma_f32_16x16x32_bf16 v[196:199], v[64:67], a[128:131], v[196:199]
    v_add_f32 v139, v233, v139
    v_add_f32 v140, v233, v140
    v_mfma_f32_16x16x32_bf16 v[36:39], v[64:67], a[136:139], v[36:39]
    ds_read_b128 v[64:67], v121 offset:0
    v_add_f32 v141, v233, v141
    v_add_f32 v142, v233, v142
    v_mfma_f32_16x16x32_bf16 v[52:55], v[116:119], a[128:131], v[52:55]
    s_mov_b32 m0, s84
    s_add_u32 s83, s76, s90
    buffer_load_dwordx4 v158, s[60:63], s83 offen lds
    v_mfma_f32_16x16x32_bf16 v[184:187], v[68:71], a[120:123], v[184:187]
    v_add_f32 v143, v233, v143
    v_add_f32 v144, v233, v144
    v_mfma_f32_16x16x32_bf16 v[200:203], v[68:71], a[128:131], v[200:203]
    v_add_f32 v145, v233, v145
    v_add_f32 v146, v233, v146
    v_mfma_f32_16x16x32_bf16 v[40:43], v[68:71], a[136:139], v[40:43]
    ds_read_b128 v[68:71], v120 offset:2048
    v_add_f32 v147, v233, v147
    v_add_f32 v148, v233, v148
    v_mfma_f32_16x16x32_bf16 v[56:59], v[116:119], a[136:139], v[56:59]
    buffer_load_dwordx4 v159, s[60:63], s83 offen offset:1024 lds
    v_add_f32 v149, v233, v149
    v_add_f32 v150, v233, v150
    v_mfma_f32_16x16x32_bf16 v[188:191], v[72:75], a[120:123], v[188:191]
    s_mov_b64 s[56:57], s[26:27]
    s_sub_u32 s60, s28, 2048
    s_subb_u32 s61, s29, 0
    v_mfma_f32_16x16x32_bf16 v[204:207], v[72:75], a[128:131], v[204:207]
    s_mov_b32 s62, 821248
    v_bfe_u32 v230, v152, 4, 1
    v_lshlrev_b32 v159, 1, v230
    v_mfma_f32_16x16x32_bf16 v[44:47], v[72:75], a[136:139], v[44:47]
    ds_read_b128 v[72:75], v121 offset:2048
    s_add_u32 s83, s12, s15
    v_add_u32 v175, s83, v153
    global_load_dwordx4 v[252:255], v175, s[42:43]
    v_and_b32 v231, 3, v152
    v_xor_b32 v159, v159, v231
    v_mfma_f32_16x16x32_bf16 v[176:179], v[76:79], a[124:127], v[176:179]
    v_lshrrev_b32 v231, 5, v152
    v_lshl_add_u32 v159, v231, 2, v159
    s_mul_i32 s3, s78, 102400
    s_mul_i32 s4, s77, 320
    s_add_u32 s3, s3, s4
    v_mfma_f32_16x16x32_bf16 v[192:195], v[76:79], a[132:135], v[192:195]
    s_waitcnt vmcnt(13)
    ds_read_b128 a[160:163], v156 offset:4096
    ds_read_b128 a[164:167], v157 offset:4096
    v_lshl_add_u32 v159, v159, 4, s3
    v_bfe_u32 v231, v152, 2, 2
    v_mfma_f32_16x16x32_bf16 v[32:35], v[76:79], a[140:143], v[32:35]
    ds_read_b128 v[76:79], v120 offset:4096
    v_lshl_add_u32 v231, v230, 3, v231
    s_movk_i32 s4, 1280
    v_mad_u32_u24 v159, v231, s4, v159
    s_movk_i32 s4, 10240
    v_mfma_f32_16x16x32_bf16 v[48:51], v[116:119], a[124:127], v[48:51]
    v_mad_u32_u24 v158, v230, s4, v159
    s_lshl_b32 s3, s79, 4
    s_and_b32 s3, s3, 128
    s_lshl_b32 s4, s80, 6
    v_mfma_f32_16x16x32_bf16 v[180:183], v[80:83], a[124:127], v[180:183]
    s_add_u32 s16, s3, s4
    s_xor_b32 s17, s16, 128
    s_lshl_b32 s4, s4, 2
    v_mfma_f32_16x16x32_bf16 v[196:199], v[80:83], a[132:135], v[196:199]
    s_xor_b32 s44, s4, 256
    s_add_u32 s83, s12, s14
    v_add_u32 v175, s83, v153
    global_load_dwordx4 v[244:247], v175, s[42:43]
    v_add_f32 v151, v233, v151
    v_fma_f32 v0, v0, v108, 1.0
    v_mfma_f32_16x16x32_bf16 v[36:39], v[80:83], a[140:143], v[36:39]
    ds_read_b128 v[80:83], v121 offset:4096
    s_add_u32 s83, s12, s14
    v_add_u32 v175, s83, v153
    v_add_u32 v175, 4096, v175
    global_load_dwordx4 v[248:251], v175, s[42:43]
    v_fma_f32 v1, v1, v108, 1.0
    v_fma_f32 v2, v2, v108, 1.0
    v_mfma_f32_16x16x32_bf16 v[52:55], v[116:119], a[132:135], v[52:55]
    global_load_dword v170, v168, s[50:51] sc1
    v_fma_f32 v3, v3, v108, 1.0
    v_fma_f32 v4, v4, v108, 1.0
    s_waitcnt lgkmcnt(8)
    v_mfma_f32_16x16x32_bf16 v[184:187], v[84:87], a[124:127], v[184:187]
    v_fma_f32 v5, v5, v108, 1.0
    v_fma_f32 v6, v6, v108, 1.0
    v_mfma_f32_16x16x32_bf16 v[200:203], v[84:87], a[132:135], v[200:203]
    s_waitcnt vmcnt(14)
    ds_read_b128 a[168:171], v156 offset:6144
    ds_read_b128 a[172:175], v157 offset:6144
    global_load_dword v131, v227, s[50:51] sc1
    v_mfma_f32_16x16x32_bf16 v[40:43], v[84:87], a[140:143], v[40:43]
    ds_read_b128 v[84:87], v120 offset:6144
    v_fma_f32 v7, v7, v108, 1.0
    v_fma_f32 v8, v8, v108, 1.0
    v_mfma_f32_16x16x32_bf16 v[56:59], v[116:119], a[140:143], v[56:59]
    s_waitcnt vmcnt(13)
    ds_read_b128 a[176:179], v156 offset:8192
    ds_read_b128 a[180:183], v157 offset:8192
    global_load_dword v131, v226, s[46:47] offset:-2048
    v_mfma_f32_16x16x32_bf16 v[188:191], v[88:91], a[124:127], v[188:191]
    v_fma_f32 v9, v9, v108, 1.0
    v_fma_f32 v10, v10, v108, 1.0
    v_mfma_f32_16x16x32_bf16 v[204:207], v[88:91], a[132:135], v[204:207]
    v_fma_f32 v11, v11, v108, 1.0
    v_fma_f32 v12, v12, v108, 1.0
    v_mfma_f32_16x16x32_bf16 v[44:47], v[88:91], a[140:143], v[44:47]
    ds_read_b128 v[88:91], v121 offset:6144
    s_waitcnt lgkmcnt(8)
    v_mfma_f32_16x16x32_bf16 v[176:179], v[60:63], a[160:163], v[176:179]
    ds_read_b64 v[112:113], v154 offset:7680
    global_load_dword v131, v226, s[46:47] offset:-1024
    v_fma_f32 v13, v13, v108, 1.0
    v_fma_f32 v14, v14, v108, 1.0
    s_waitcnt lgkmcnt(5)
    v_mfma_f32_16x16x32_bf16 v[192:195], v[60:63], a[168:171], v[192:195]
    ds_read_b64 v[114:115], v155 offset:7680
    v_fma_f32 v15, v15, v108, 1.0
    v_fma_f32 v16, v16, v108, 1.0
    s_waitcnt lgkmcnt(3)
    v_mfma_f32_16x16x32_bf16 v[32:35], v[60:63], a[176:179], v[32:35]
    ds_read_b128 v[60:63], v122 offset:49152
    ds_read_b64 v[100:101], v154 offset:8320
    v_fma_f32 v17, v17, v108, 1.0
    v_fma_f32 v18, v18, v108, 1.0
    v_mfma_f32_16x16x32_bf16 v[48:51], v[116:119], a[160:163], v[48:51]
    ds_read_b64 v[102:103], v154 offset:8960
    v_fma_f32 v19, v19, v108, 1.0
    v_mul_f32 v132, v0, v132
    v_mfma_f32_16x16x32_bf16 v[176:179], v[64:67], a[164:167], v[176:179]
    ds_read_b64 v[104:105], v155 offset:8320
    global_load_dword v131, v226, s[46:47] offset:0
    v_mul_f32 v133, v1, v133
    v_mul_f32 v134, v2, v134
    v_mfma_f32_16x16x32_bf16 v[192:195], v[64:67], a[172:175], v[192:195]
    ds_read_b64 v[106:107], v155 offset:8960
    v_mul_f32 v135, v3, v135
    v_mul_f32 v136, v4, v136
    v_mfma_f32_16x16x32_bf16 v[32:35], v[64:67], a[180:183], v[32:35]
    ds_read_b128 v[64:67], v122 offset:51200
    v_mul_f32 v137, v5, v137
    v_mul_f32 v138, v6, v138
    v_mfma_f32_16x16x32_bf16 v[48:51], v[116:119], a[164:167], v[48:51]
    v_mul_f32 v139, v7, v139
    v_mul_f32 v140, v8, v140
    v_mfma_f32_16x16x32_bf16 v[180:183], v[68:71], a[160:163], v[180:183]
    s_nop 0
    ds_write_b128 v220, v[32:35] offset:0
    global_load_dword v131, v226, s[46:47] offset:1024
    v_mul_f32 v141, v9, v141
    v_mul_f32 v142, v10, v142
    v_mfma_f32_16x16x32_bf16 v[196:199], v[68:71], a[168:171], v[196:199]
    s_waitcnt vmcnt(15)
    ds_read_b128 a[144:147], v156 offset:10240
    ds_read_b128 a[148:151], v157 offset:10240
    v_mfma_f32_16x16x32_bf16 v[36:39], v[68:71], a[176:179], v[36:39]
    ds_read_b128 v[68:71], v122 offset:53248
    v_mul_f32 v143, v11, v143
    v_mul_f32 v144, v12, v144
    v_mfma_f32_16x16x32_bf16 v[52:55], v[116:119], a[168:171], v[52:55]
    v_mul_f32 v145, v13, v145
    v_mul_f32 v146, v14, v146
    v_mfma_f32_16x16x32_bf16 v[180:183], v[72:75], a[164:167], v[180:183]
    s_mov_b64 exec, 0xffff
    ds_write_b32 v126, v232 offset:1024
    ds_write2st64_b32 v126, v233, v108 offset1:1
    ds_write2st64_b32 v127, v233, v108 offset1:1
    s_mov_b64 exec, -1
    v_mfma_f32_16x16x32_bf16 v[196:199], v[72:75], a[172:175], v[196:199]
    s_waitcnt lgkmcnt(13)
    global_load_dword v131, v226, s[46:47] offset:2048
    v_mul_f32 v147, v15, v147
    v_mul_f32 v148, v16, v148
    v_mfma_f32_16x16x32_bf16 v[36:39], v[72:75], a[180:183], v[36:39]
    ds_read_b128 v[72:75], v122 offset:55296
    v_mul_f32 v149, v17, v149
    v_mul_f32 v150, v18, v150
    v_mfma_f32_16x16x32_bf16 v[52:55], v[116:119], a[172:175], v[52:55]
    v_mul_f32 v151, v19, v151
    v_xor_b32 v115, v163, v115
    v_mfma_f32_16x16x32_bf16 v[184:187], v[76:79], a[160:163], v[184:187]
    s_waitcnt vmcnt(14)
    ds_read_b128 a[152:155], v156 offset:12288
    ds_read_b128 a[156:159], v157 offset:12288
    v_mfma_f32_16x16x32_bf16 v[200:203], v[76:79], a[168:171], v[200:203]
    ds_write_b128 v220, v[36:39] offset:1024
    s_waitcnt lgkmcnt(12)
    v_xor_b32 v105, v163, v105
    v_xor_b32 v107, v163, v107
    v_mfma_f32_16x16x32_bf16 v[40:43], v[76:79], a[176:179], v[40:43]
    ds_read_b128 v[76:79], v123 offset:49152
    v_mfma_f32_16x16x32_bf16 v[56:59], v[116:119], a[176:179], v[56:59]
    v_mfma_f32_16x16x32_bf16 v[184:187], v[80:83], a[164:167], v[184:187]
    v_mfma_f32_16x16x32_bf16 v[200:203], v[80:83], a[172:175], v[200:203]
    v_mfma_f32_16x16x32_bf16 v[40:43], v[80:83], a[180:183], v[40:43]
    ds_read_b128 v[80:83], v123 offset:51200
    v_mfma_f32_16x16x32_bf16 v[56:59], v[116:119], a[180:183], v[56:59]
    v_mfma_f32_16x16x32_bf16 v[188:191], v[84:87], a[160:163], v[188:191]
    s_waitcnt vmcnt(12)
    ds_read_b128 a[184:187], v156 offset:14336
    ds_read_b128 a[188:191], v157 offset:14336
    v_mfma_f32_16x16x32_bf16 v[204:207], v[84:87], a[168:171], v[204:207]
    s_nop 0
    ds_write_b128 v220, v[40:43] offset:2048
    v_mfma_f32_16x16x32_bf16 v[44:47], v[84:87], a[176:179], v[44:47]
    ds_read_b128 v[84:87], v123 offset:53248
    v_mfma_f32_16x16x32_bf16 v[188:191], v[88:91], a[164:167], v[188:191]
    v_mfma_f32_16x16x32_bf16 v[204:207], v[88:91], a[172:175], v[204:207]
    v_mfma_f32_16x16x32_bf16 v[44:47], v[88:91], a[180:183], v[44:47]
    ds_read_b128 v[88:91], v123 offset:55296
    s_waitcnt lgkmcnt(15)
    v_mfma_f32_16x16x32_bf16 v[176:179], v[60:63], a[144:147], v[176:179]
    s_waitcnt lgkmcnt(8)
    v_mfma_f32_16x16x32_bf16 v[192:195], v[60:63], a[152:155], v[192:195]
    v_add_u32 v122, 0x10000, v122
    v_add_u32 v123, 0x10000, v123
    ds_read_b128 v[60:63], v122 offset:0
    ds_write_b128 v220, v[44:47] offset:3072
    v_mfma_f32_16x16x32_bf16 v[48:51], v[116:119], a[144:147], v[48:51]
    s_waitcnt vmcnt(10)
    ds_read_b128 a[192:195], v156 offset:0
    ds_read_b128 a[196:199], v157 offset:0
    v_mfma_f32_16x16x32_bf16 v[180:183], v[64:67], a[144:147], v[180:183]
    v_and_b32 v242, 3, v152
    v_lshl_add_u32 v156, v242, 6, s84
    v_mfma_f32_16x16x32_bf16 v[196:199], v[64:67], a[152:155], v[196:199]
    ds_read_b128 v[64:67], v123 offset:0
    s_mov_b64 exec, 0xffff
    ds_write_b32 v225, v56
    s_mov_b64 exec, -1
    v_bfe_u32 v242, v152, 2, 1
    v_lshl_add_u32 v156, v242, 10, v156
    v_mfma_f32_16x16x32_bf16 v[52:55], v[116:119], a[152:155], v[52:55]
    v_bfe_u32 v242, v152, 3, 1
    v_lshl_add_u32 v156, v242, 8, v156
    v_mfma_f32_16x16x32_bf16 v[184:187], v[68:71], a[144:147], v[184:187]
    v_lshlrev_b32 v242, 1, v242
    v_bfe_u32 v243, v152, 4, 1
    v_mfma_f32_16x16x32_bf16 v[200:203], v[68:71], a[152:155], v[200:203]
    ds_read_b128 v[68:71], v122 offset:2048
    v_xor_b32 v242, v242, v243
    v_lshl_add_u32 v156, v242, 4, v156
    v_mfma_f32_16x16x32_bf16 v[188:191], v[72:75], a[144:147], v[188:191]
    v_lshrrev_b32 v242, 5, v152
    v_lshl_add_u32 v156, v242, 11, v156
    v_mfma_f32_16x16x32_bf16 v[204:207], v[72:75], a[152:155], v[204:207]
    ds_read_b128 v[72:75], v123 offset:2048
    v_xor_b32 v157, 32, v156
    s_waitcnt lgkmcnt(13)
    v_mfma_f32_16x16x32_bf16 v[176:179], v[76:79], a[148:151], v[176:179]
    s_lshl_b32 s3, s78, 2
    s_add_u32 s3, s3, s77
    s_lshl_b32 s3, s3, 13
    s_waitcnt lgkmcnt(0)
    s_barrier
    v_mfma_f32_16x16x32_bf16 v[192:195], v[76:79], a[156:159], v[192:195]
    ds_read_b128 v[76:79], v122 offset:4096
    s_add_u32 s3, s3, 9437184
    ds_read2st64_b32 v[16:17], v218 offset0:0 offset1:128
    v_mov_b32 v36, s30
    v_mfma_f32_16x16x32_bf16 v[48:51], v[116:119], a[148:151], v[48:51]
    s_add_u32 s92, s50, s3
    s_addc_u32 s93, s51, 0
    s_movk_i32 s94, 8192
    s_waitcnt vmcnt(8)
    v_mov_b32_dpp v36, v247 wave_shr:1 row_mask:0xf bank_mask:0xf
    v_alignbit_b32 v33, v245, v244, 16
    v_mfma_f32_16x16x32_bf16 v[180:183], v[80:83], a[148:151], v[180:183]
    s_sub_u32 s21, 31, s79
    s_lshl_b32 s21, s21, 8
    ds_read2st64_b32 v[18:19], v219 offset0:0 offset1:128
    v_alignbit_b32 v34, v246, v245, 16
    v_alignbit_b32 v35, v247, v246, 16
    v_mfma_f32_16x16x32_bf16 v[196:199], v[80:83], a[156:159], v[196:199]
    ds_read_b128 v[80:83], v123 offset:4096
    v_alignbit_b32 v32, v244, v36, 16
    v_mov_b32 v40, s31
    v_mfma_f32_16x16x32_bf16 v[52:55], v[116:119], a[156:159], v[52:55]
    ds_read2st64_b32 v[20:21], v218 offset0:4 offset1:132
    s_waitcnt vmcnt(7)
    v_mov_b32_dpp v40, v251 wave_shr:1 row_mask:0xf bank_mask:0xf
    v_alignbit_b32 v37, v249, v248, 16
    v_mfma_f32_16x16x32_bf16 v[184:187], v[84:87], a[148:151], v[184:187]
    s_waitcnt vmcnt(6)
    L_kf:
    v_xor_b32 v171, s82, v170
    v_cmp_lt_u32 vcc, 7, v171
    s_cbranch_vccnz L_kf_re
    v_cmp_ne_u32 vcc, s89, v171
    s_lshl_b32 s5, s77, 10
    s_cmp_eq_u32 vcc_hi, 0
    s_cselect_b32 s88, 1, 0

    s_add_u32 m0, s5, 9728
    s_add_u32 s83, s5, s15
    buffer_load_dwordx4 v153, s[68:71], s83 offen sc1 lds
    v_alignbit_b32 v38, v250, v249, 16
    v_alignbit_b32 v39, v251, v250, 16
    v_mfma_f32_16x16x32_bf16 v[200:203], v[84:87], a[156:159], v[200:203]
    ds_read_b128 v[84:87], v122 offset:6144
    ds_read2st64_b32 v[22:23], v219 offset0:4 offset1:132
    v_alignbit_b32 v36, v248, v40, 16
    v_mov_b32 v44, s32
    v_mfma_f32_16x16x32_bf16 v[188:191], v[88:91], a[148:151], v[188:191]
    s_nop 0
    v_mov_b32_dpp v44, v255 wave_shr:1 row_mask:0xf bank_mask:0xf
    v_alignbit_b32 v41, v253, v252, 16
    v_mfma_f32_16x16x32_bf16 v[204:207], v[88:91], a[156:159], v[204:207]
    ds_read_b128 v[88:91], v123 offset:6144
    ds_read2st64_b32 v[24:25], v218 offset0:8 offset1:136
    v_alignbit_b32 v42, v254, v253, 16
    v_alignbit_b32 v43, v255, v254, 16
    v_mfma_f32_16x16x32_bf16 v[176:179], v[60:63], a[184:187], v[176:179]
    s_add_u32 m0, s5, 512
    s_add_u32 s83, s5, s14
    buffer_load_dwordx4 v153, s[68:71], s83 offen sc1 lds
    v_alignbit_b32 v40, v252, v44, 16
    v_mfma_f32_16x16x32_bf16 v[192:195], v[60:63], a[192:195], v[192:195]
    ds_read2st64_b32 v[26:27], v219 offset0:8 offset1:136
    v_mfma_f32_16x16x32_bf16 v[48:51], v[116:119], a[184:187], v[48:51]
    v_mfma_f32_16x16x32_bf16 v[176:179], v[64:67], a[188:191], v[176:179]
    ds_read2st64_b32 v[28:29], v218 offset0:12 offset1:140
    s_add_u32 m0, s5, 5120
    s_add_u32 s83, s5, s14
    s_add_u32 s83, s83, 4096
    buffer_load_dwordx4 v153, s[68:71], s83 offen sc1 lds
    v_mfma_f32_16x16x32_bf16 v[192:195], v[64:67], a[196:199], v[192:195]
    v_mfma_f32_16x16x32_bf16 v[48:51], v[116:119], a[188:191], v[48:51]
    ds_read2st64_b32 v[30:31], v219 offset0:12 offset1:140
    v_mfma_f32_16x16x32_bf16 v[180:183], v[68:71], a[184:187], v[180:183]
    ds_read2_b32 v[230:231], v222 offset1:32
    v_mfma_f32_16x16x32_bf16 v[196:199], v[68:71], a[192:195], v[196:199]
    ds_read_b128 v[92:95], v217 offset:768
    s_add_u32 m0, s84, 0
    s_add_u32 s83, s16, 81920
    buffer_load_dwordx4 v159, s[56:59], s83 offen offset:0 lds
    v_mfma_f32_16x16x32_bf16 v[52:55], v[116:119], a[192:195], v[52:55]
    ds_read_b128 v[96:99], v217 offset:784
    v_mfma_f32_16x16x32_bf16 v[180:183], v[72:75], a[188:191], v[180:183]
    ds_read_b128 v[212:215], v217 offset:528
    v_mfma_f32_16x16x32_bf16 v[196:199], v[72:75], a[196:199], v[196:199]
    ds_read_b128 v[208:211], v217 offset:512
    s_waitcnt lgkmcnt(5)
    v_add_f32 v16, v16, v17
    v_add_f32 v18, v18, v19
    v_mfma_f32_16x16x32_bf16 v[52:55], v[116:119], a[196:199], v[52:55]
    ds_read_b128 v[0:3], v216 offset:0
    buffer_load_dwordx4 v159, s[60:63], s83 offen offset:2048 lds
    v_add_f32 v20, v20, v21
    v_add_f32 v22, v22, v23
    v_mfma_f32_16x16x32_bf16 v[184:187], v[76:79], a[184:187], v[184:187]
    ds_read_b128 v[4:7], v216 offset:256
    ds_write_b64 v173, v[228:229]
    v_add_f32 v24, v24, v25
    v_add_f32 v26, v26, v27
    v_mfma_f32_16x16x32_bf16 v[200:203], v[76:79], a[192:195], v[200:203]
    ds_read_b128 v[8:11], v216 offset:16
    v_add_f32 v28, v28, v29
    v_add_f32 v30, v30, v31
    v_mfma_f32_16x16x32_bf16 v[184:187], v[80:83], a[188:191], v[184:187]
    ds_read_b128 v[12:15], v216 offset:272
    s_waitcnt lgkmcnt(5)
    v_add_f32 v162, v230, v231
    v_fma_f32 v208, v208, v162, v16
    v_mfma_f32_16x16x32_bf16 v[200:203], v[80:83], a[196:199], v[200:203]
    s_add_u32 s83, s83, 4096
    buffer_load_dwordx4 v159, s[56:59], s83 offen offset:1024 lds
    v_fma_f32 v209, v209, v162, v18
    v_fma_f32 v210, v210, v162, v20
    v_mfma_f32_16x16x32_bf16 v[188:191], v[84:87], a[184:187], v[188:191]
    v_fma_f32 v211, v211, v162, v22
    v_fma_f32 v212, v212, v162, v24
    v_mfma_f32_16x16x32_bf16 v[204:207], v[84:87], a[192:195], v[204:207]
    v_fma_f32 v213, v213, v162, v26
    v_fma_f32 v214, v214, v162, v28
    v_mfma_f32_16x16x32_bf16 v[188:191], v[88:91], a[188:191], v[188:191]
    s_mov_b64 exec, 0x7fff
    ds_write_b32 v172, v228
    s_mov_b64 exec, -1
    v_fma_f32 v215, v215, v162, v30
    v_mul_f32 v208, v92, v208
    v_mfma_f32_16x16x32_bf16 v[204:207], v[88:91], a[196:199], v[204:207]
    buffer_load_dwordx4 v159, s[60:63], s83 offen offset:3072 lds
    v_mul_f32 v209, v93, v209
    v_mul_f32 v210, v94, v210
    v_mul_f32 v211, v95, v211
    v_mul_f32 v212, v96, v212
    v_mul_f32 v213, v97, v213
    v_mul_f32 v214, v98, v214
    v_mul_f32 v215, v99, v215
    v_mov_b32 v160, v48
    v_mov_b32 v161, v52
    ds_write_b128 v221, v[244:247] offset:22176
    s_waitcnt lgkmcnt(5)
    v_pk_fma_f32 v[176:177], v[0:1], v[160:161], v[176:177] op_sel_hi:[1,0,1]
    v_pk_fma_f32 v[192:193], v[0:1], v[160:161], v[192:193] op_sel:[0,1,0]
    v_fma_f32 v241, v114, v208, v209
    v_pk_fma_f32 v[178:179], v[2:3], v[160:161], v[178:179] op_sel_hi:[1,0,1]
    v_pk_fma_f32 v[194:195], v[2:3], v[160:161], v[194:195] op_sel:[0,1,0]
    v_pk_mul_f32 v[176:177], v[4:5], v[176:177]
    v_fmac_f32_dpp v241, v208, v115 row_ror:8 row_mask:0xf bank_mask:0xf
    v_pk_mul_f32 v[192:193], v[4:5], v[192:193]
    v_pk_mul_f32 v[178:179], v[6:7], v[178:179]
    v_pk_mul_f32 v[194:195], v[6:7], v[194:195]
    v_fma_f32 v240, v114, v241, v210
    ds_write_b128 v221, v[32:35] offset:26336
    ds_read_b128 v[0:3], v216 offset:32
    ds_read_b128 v[4:7], v216 offset:288
    v_pk_fma_f32 v[236:237], v[176:177], v[112:113], v[178:179] op_sel_hi:[1,0,1]
    v_fmac_f32_dpp v240, v241, v115 row_ror:8 row_mask:0xf bank_mask:0xf
    v_pk_fma_f32 v[238:239], v[192:193], v[112:113], v[194:195] op_sel_hi:[1,0,1]
    v_pk_fma_f32 v[236:237], v[192:193], v[112:113], v[236:237] op_sel:[0,1,0] neg_lo:[1,0,0] neg_hi:[1,0,0]
    v_pk_fma_f32 v[238:239], v[176:177], v[112:113], v[238:239] op_sel:[0,1,0]
    s_waitcnt lgkmcnt(5)
    v_pk_fma_f32 v[180:181], v[8:9], v[160:161], v[180:181] op_sel_hi:[1,0,1]
    v_pk_fma_f32 v[196:197], v[8:9], v[160:161], v[196:197] op_sel:[0,1,0]
    v_fma_f32 v241, v114, v240, v211
    v_pk_fma_f32 v[182:183], v[10:11], v[160:161], v[182:183] op_sel_hi:[1,0,1]
    v_pk_fma_f32 v[198:199], v[10:11], v[160:161], v[198:199] op_sel:[0,1,0]
    v_pk_mul_f32 v[180:181], v[12:13], v[180:181]
    ds_write_b128 v221, v[248:251] offset:30496
    v_fmac_f32_dpp v241, v240, v115 row_ror:8 row_mask:0xf bank_mask:0xf
    v_pk_mul_f32 v[196:197], v[12:13], v[196:197]
    v_pk_mul_f32 v[182:183], v[14:15], v[182:183]
    v_pk_mul_f32 v[198:199], v[14:15], v[198:199]
    v_fma_f32 v240, v114, v241, v212
    ds_read_b128 v[8:11], v216 offset:48
    ds_read_b128 v[12:15], v216 offset:304
    v_pk_fma_f32 v[232:233], v[236:237], v[112:113], v[180:181] op_sel_hi:[1,0,1]
    v_fmac_f32_dpp v240, v241, v115 row_ror:8 row_mask:0xf bank_mask:0xf
    v_pk_fma_f32 v[234:235], v[238:239], v[112:113], v[196:197] op_sel_hi:[1,0,1]
    v_pk_fma_f32 v[232:233], v[238:239], v[112:113], v[232:233] op_sel:[0,1,0] neg_lo:[1,0,0] neg_hi:[1,0,0]
    v_pk_fma_f32 v[234:235], v[236:237], v[112:113], v[234:235] op_sel:[0,1,0]
    v_pk_fma_f32 v[236:237], v[232:233], v[112:113], v[182:183] op_sel_hi:[1,0,1]
    ds_write_b128 v221, v[36:39] offset:34656
    v_pk_fma_f32 v[238:239], v[234:235], v[112:113], v[198:199] op_sel_hi:[1,0,1]
    v_pk_fma_f32 v[236:237], v[234:235], v[112:113], v[236:237] op_sel:[0,1,0] neg_lo:[1,0,0] neg_hi:[1,0,0]
    v_pk_fma_f32 v[238:239], v[232:233], v[112:113], v[238:239] op_sel:[0,1,0]
    s_waitcnt lgkmcnt(4)
    v_pk_fma_f32 v[184:185], v[0:1], v[160:161], v[184:185] op_sel_hi:[1,0,1]
    v_pk_fma_f32 v[200:201], v[0:1], v[160:161], v[200:201] op_sel:[0,1,0]
    v_fma_f32 v241, v114, v240, v213
    v_pk_fma_f32 v[186:187], v[2:3], v[160:161], v[186:187] op_sel_hi:[1,0,1]
    v_pk_fma_f32 v[202:203], v[2:3], v[160:161], v[202:203] op_sel:[0,1,0]
    v_pk_mul_f32 v[184:185], v[4:5], v[184:185]
    v_fmac_f32_dpp v241, v240, v115 row_ror:8 row_mask:0xf bank_mask:0xf
    v_pk_mul_f32 v[200:201], v[4:5], v[200:201]
    ds_write_b128 v221, v[252:255] offset:13856
    v_pk_mul_f32 v[186:187], v[6:7], v[186:187]
    v_pk_mul_f32 v[202:203], v[6:7], v[202:203]
    v_fma_f32 v240, v114, v241, v214
    v_pk_fma_f32 v[232:233], v[236:237], v[112:113], v[184:185] op_sel_hi:[1,0,1]
    v_pk_fma_f32 v[234:235], v[238:239], v[112:113], v[200:201] op_sel_hi:[1,0,1]
    v_pk_fma_f32 v[232:233], v[238:239], v[112:113], v[232:233] op_sel:[0,1,0] neg_lo:[1,0,0] neg_hi:[1,0,0]
    v_fmac_f32_dpp v240, v241, v115 row_ror:8 row_mask:0xf bank_mask:0xf
    v_pk_fma_f32 v[234:235], v[236:237], v[112:113], v[234:235] op_sel:[0,1,0]
    v_pk_fma_f32 v[236:237], v[232:233], v[112:113], v[186:187] op_sel_hi:[1,0,1]
    v_pk_fma_f32 v[238:239], v[234:235], v[112:113], v[202:203] op_sel_hi:[1,0,1]
    v_pk_fma_f32 v[236:237], v[234:235], v[112:113], v[236:237] op_sel:[0,1,0] neg_lo:[1,0,0] neg_hi:[1,0,0]
    v_pk_fma_f32 v[238:239], v[232:233], v[112:113], v[238:239] op_sel:[0,1,0]
    ds_write_b128 v221, v[40:43] offset:18016
    s_waitcnt lgkmcnt(3)
    v_pk_fma_f32 v[188:189], v[8:9], v[160:161], v[188:189] op_sel_hi:[1,0,1]
    v_pk_fma_f32 v[204:205], v[8:9], v[160:161], v[204:205] op_sel:[0,1,0]
    v_fma_f32 v241, v114, v240, v215
    v_pk_fma_f32 v[190:191], v[10:11], v[160:161], v[190:191] op_sel_hi:[1,0,1]
    v_pk_fma_f32 v[206:207], v[10:11], v[160:161], v[206:207] op_sel:[0,1,0]
    v_pk_mul_f32 v[188:189], v[12:13], v[188:189]
    v_fmac_f32_dpp v241, v240, v115 row_ror:8 row_mask:0xf bank_mask:0xf
    v_pk_mul_f32 v[204:205], v[12:13], v[204:205]
    v_pk_mul_f32 v[190:191], v[14:15], v[190:191]
    v_pk_mul_f32 v[206:207], v[14:15], v[206:207]
    v_pk_fma_f32 v[232:233], v[236:237], v[112:113], v[188:189] op_sel_hi:[1,0,1]
    v_pk_fma_f32 v[234:235], v[238:239], v[112:113], v[204:205] op_sel_hi:[1,0,1]
    v_pk_fma_f32 v[232:233], v[238:239], v[112:113], v[232:233] op_sel:[0,1,0] neg_lo:[1,0,0] neg_hi:[1,0,0]
    v_pk_fma_f32 v[234:235], v[236:237], v[112:113], v[234:235] op_sel:[0,1,0]
    v_pk_fma_f32 v[236:237], v[232:233], v[112:113], v[190:191] op_sel_hi:[1,0,1]
    v_pk_fma_f32 v[238:239], v[234:235], v[112:113], v[206:207] op_sel_hi:[1,0,1]
    v_pk_fma_f32 v[236:237], v[234:235], v[112:113], v[236:237] op_sel:[0,1,0] neg_lo:[1,0,0] neg_hi:[1,0,0]
    v_pk_fma_f32 v[238:239], v[232:233], v[112:113], v[238:239] op_sel:[0,1,0]
    v_mul_f32 v219, v104, v241
    v_fma_f32 v216, v100, v236, v237
    v_fma_f32 v217, v100, v238, v239
    v_fmac_f32_dpp v219, v241, v105 row_ror:8 row_mask:0xf bank_mask:0xf
    v_mov_b32_dpp v218, v241 quad_perm:[1,1,3,3] row_mask:0xf bank_mask:0xf
    v_fma_f32 v216, -v101, v238, v216
    v_fmac_f32 v217, v101, v236
    v_add_f32_dpp v218, v219, v218 quad_perm:[0,0,2,2] row_mask:0xf bank_mask:0xf
    v_mov_b64 v[224:225], v[216:217]
    v_mov_b32 v226, v218
    v_mov_b32 v231, s82
    v_permlane32_swap_b32 v216, v224
    v_permlane32_swap_b32 v217, v225
    v_permlane32_swap_b32 v218, v226
    v_mov_b64 v[220:221], v[216:217]
    v_mov_b32 v222, v218
    v_mov_b64 v[228:229], v[224:225]
    v_mov_b32 v230, v226

    v_permlane16_swap_b32 v218, v222
    v_permlane16_swap_b32 v216, v220
    v_permlane16_swap_b32 v217, v221
    v_permlane16_swap_b32 v226, v230
    v_fmac_f32 v222, v106, v218
    v_pk_fma_f32 v[220:221], v[216:217], v[102:103], v[220:221] op_sel_hi:[1,0,1]
    v_permlane16_swap_b32 v224, v228
    v_fmac_f32_dpp v222, v218, v107 row_ror:8 row_mask:0xf bank_mask:0xf
    v_pk_fma_f32 v[220:221], v[216:217], v[102:103], v[220:221] op_sel:[1,1,0] op_sel_hi:[0,1,1] neg_lo:[1,0,0]
    v_permlane16_swap_b32 v225, v229
    v_fmac_f32 v226, v106, v222
    v_pk_fma_f32 v[224:225], v[220:221], v[102:103], v[224:225] op_sel_hi:[1,0,1]
    s_nop 0
    v_fmac_f32_dpp v226, v222, v107 row_ror:8 row_mask:0xf bank_mask:0xf
    v_pk_fma_f32 v[224:225], v[220:221], v[102:103], v[224:225] op_sel:[1,1,0] op_sel_hi:[0,1,1] neg_lo:[1,0,0]
    v_fmac_f32 v230, v106, v226
    v_pk_fma_f32 v[228:229], v[224:225], v[102:103], v[228:229] op_sel_hi:[1,0,1]
    s_nop 0
    v_fmac_f32_dpp v230, v226, v107 row_ror:8 row_mask:0xf bank_mask:0xf
    v_pk_fma_f32 v[228:229], v[224:225], v[102:103], v[228:229] op_sel:[1,1,0] op_sel_hi:[0,1,1] neg_lo:[1,0,0]
    s_mov_b64 exec, 0xffff
    buffer_store_dwordx4 v[228:231], v153, s[92:95], s21 offen sc1
    s_mov_b64 exec, -1
    s_add_u32 m0, s84, 8192
    s_add_u32 s83, s17, 81920
    buffer_load_dwordx4 v159, s[56:59], s83 offen offset:0 lds
    buffer_load_dwordx4 v159, s[60:63], s83 offen offset:2048 lds
    s_add_u32 s83, s83, 4096
    buffer_load_dwordx4 v159, s[56:59], s83 offen offset:1024 lds
    buffer_load_dwordx4 v159, s[60:63], s83 offen offset:3072 lds
    s_waitcnt vmcnt(9)
    v_and_b32 v0, 1, v152
    v_mul_u32_u24 v0, 640, v0
    v_add_u32 v0, v155, v0
    ds_read2_b32 v[124:125], v154 offset1:160
    ds_read2_b32 v[126:127], v154 offset0:1 offset1:161
    ds_read_b64 v[128:129], v155 offset:0
    ds_read_b64 v[130:131], v0 offset:0
    s_mul_i32 s3, s81, 8064
    s_lshl_b32 s4, s80, 7
    s_add_u32 s3, s3, s4
    s_add_u32 s3, s3, 8320
    v_add_u32 v166, s3, v164
    s_mul_i32 s3, s81, 4864
    s_sub_u32 s3, s3, s4
    s_sub_u32 s3, s3, 9344
    v_add_u32 v167, s3, v165
    v_add_u32 v48, 1024, v164
    v_add_u32 v49, 2048, v164
    v_add_u32 v50, 3072, v164
    s_waitcnt lgkmcnt(0)
    s_barrier
    ds_read2_b32 v[60:61], v164 offset0:128 offset1:129
    v_mov_b32 v219, 0
    ds_read2_b32 v[62:63], v164 offset0:130 offset1:131
    s_add_u32 m0, s84, 12288
    s_add_u32 s83, s17, 0
    buffer_load_dwordx4 v158, s[56:59], s83 offen offset:0 lds
    v_xor_b32 v128, v163, v128
    v_xor_b32 v130, v163, v130
    ds_read_b128 v[64:67], v165 offset:3136
    v_mov_b32_dpp v216, v220 quad_perm:[0,1,2,3] row_mask:4 bank_mask:0xf
    v_mov_b32_dpp v217, v221 quad_perm:[0,1,2,3] row_mask:4 bank_mask:0xf
    ds_read2_b32 v[68:69], v164 offset0:0 offset1:1
    v_mov_b32_dpp v218, v222 quad_perm:[0,1,2,3] row_mask:4 bank_mask:0xf
    v_mov_b32_dpp v216, v224 quad_perm:[0,1,2,3] row_mask:8 bank_mask:0xf
    ds_read2_b32 v[70:71], v164 offset0:2 offset1:3
    v_mov_b32_dpp v217, v225 quad_perm:[0,1,2,3] row_mask:8 bank_mask:0xf
    v_mov_b32_dpp v218, v226 quad_perm:[0,1,2,3] row_mask:8 bank_mask:0xf
    buffer_load_dwordx4 v158, s[60:63], s83 offen offset:2048 lds
    ds_read_b128 v[72:75], v165 offset:2624
    v_mov_b32_dpp v216, v219 quad_perm:[0,1,2,3] row_mask:1 bank_mask:0xf
    v_mov_b32_dpp v217, v219 quad_perm:[0,1,2,3] row_mask:1 bank_mask:0xf
    ds_read_b128 v[76:79], v165 offset:1600
    v_mov_b32_dpp v218, v219 quad_perm:[0,1,2,3] row_mask:1 bank_mask:0xf
    v_mul_f32_dpp v223, -v241, v129 row_ror:8 row_mask:0xf bank_mask:0xf
    ds_read_b128 v[80:83], v165 offset:3648
    v_fma_f32 v223, -v128, v241, v223
    v_mul_f32_dpp v252, -v218, v131 row_ror:8 row_mask:0xf bank_mask:0xf
    ds_read_b128 v[84:87], v165 offset:1088
    v_pk_mul_f32 v[248:249], v[124:125], v[216:217] op_sel_hi:[1,0]
    s_add_u32 s83, s83, 9216
    buffer_load_dwordx4 v158, s[56:59], s83 offen offset:1024 lds
    v_pk_mul_f32 v[250:251], v[124:125], v[216:217] op_sel:[0,1]
    ds_read2_b32 v[88:89], v48 offset0:0 offset1:1
    v_pk_fma_f32 v[248:249], v[126:127], v[216:217], v[248:249] op_sel:[0,1,0] neg_lo:[1,0,0] neg_hi:[1,0,0]
    v_pk_fma_f32 v[250:251], v[126:127], v[216:217], v[250:251] op_sel_hi:[1,0,1]
    ds_read2_b32 v[90:91], v48 offset0:2 offset1:3
    v_fma_f32 v252, -v130, v218, v252
    v_fmac_f32 v249, v124, v236
    ds_read_b128 v[92:95], v165 offset:2112
    v_fmac_f32 v251, v124, v238
    v_fma_f32 v249, -v126, v238, v249
    ds_read2_b32 v[96:97], v49 offset0:0 offset1:1
    buffer_load_dwordx4 v158, s[60:63], s83 offen offset:3072 lds
    v_fmac_f32 v251, v126, v236
    v_mov_b32_dpp v219, v223 quad_perm:[0,0,2,2] row_mask:0xf bank_mask:0xf
    ds_read2_b32 v[98:99], v49 offset0:2 offset1:3
    s_mov_b32 exec_lo, 0xaaaaaaaa
    s_mov_b32 exec_hi, 0xaaaaaaaa
    v_add_f32 v252, v252, v219
    s_mov_b64 exec, -1
    v_lshrrev_b32 v29, 4, v152
    ds_read_b128 v[100:103], v165 offset:576
    v_and_b32 v253, 0xf0, v153
    v_lshl_add_u32 v253, v29, 11, v253
    ds_read2_b32 v[104:105], v48 offset0:128 offset1:129
    v_add_u32 v253, s21, v253
    v_lshlrev_b32 v29, 3, v29
    s_waitcnt vmcnt(9)
    ds_read_b128 a[200:203], v156 offset:0
    ds_read_b128 a[204:207], v157 offset:0
    ds_read_b128 a[208:211], v156 offset:512
    ds_read_b128 a[212:215], v157 offset:512
    ds_read2_b32 v[106:107], v48 offset0:130 offset1:131
    v_sub_u32 v29, s79, v29
    v_med3_i32 v29, v29, 0, 8
    ds_read_b128 v[108:111], v165 offset:64
    v_mul_lo_u32 v254, v29, s82
    v_add_u32 v255, 1024, v166
    ds_read2_b32 v[112:113], v49 offset0:128 offset1:129
    v_add_u32 v130, 2048, v166
    v_add_u32 v131, 3072, v166
    ds_read2_b32 v[114:115], v49 offset0:130 offset1:131
    v_mul_f32_dpp v2, -v208, v129 row_ror:8 row_mask:0xf bank_mask:0xf
    s_waitcnt lgkmcnt(4)
    s_add_u32 m0, s84, 0
    s_add_u32 s83, s17, 5120
    buffer_load_dwordx4 v158, s[56:59], s83 offen offset:0 lds
    v_pk_mul_f32 v[0:1], v[176:177], v[126:127] op_sel_hi:[1,0]
    ds_read2_b32 v[116:117], v50 offset0:0 offset1:1
    v_pk_mul_f32 v[176:177], v[176:177], v[124:125] op_sel_hi:[1,0]
    v_pk_fma_f32 v[176:177], v[192:193], v[126:127], v[176:177] op_sel_hi:[1,0,1] neg_lo:[1,0,0] neg_hi:[1,0,0]
    ds_read2_b32 v[118:119], v50 offset0:2 offset1:3
    v_pk_fma_f32 v[192:193], v[192:193], v[124:125], v[0:1] op_sel_hi:[1,0,1]
    v_fma_f32 v208, -v128, v208, v2
    ds_read2_b32 v[120:121], v50 offset0:128 offset1:129
    v_mul_f32_dpp v2, -v209, v129 row_ror:8 row_mask:0xf bank_mask:0xf
    v_pk_mul_f32 v[0:1], v[178:179], v[126:127] op_sel_hi:[1,0]
    ds_read2_b32 v[122:123], v50 offset0:130 offset1:131
    buffer_load_dwordx4 v158, s[60:63], s83 offen offset:2048 lds
    v_pk_mul_f32 v[178:179], v[178:179], v[124:125] op_sel_hi:[1,0]
    v_pk_fma_f32 v[178:179], v[194:195], v[126:127], v[178:179] op_sel_hi:[1,0,1] neg_lo:[1,0,0] neg_hi:[1,0,0]
    v_pk_fma_f32 v[194:195], v[194:195], v[124:125], v[0:1] op_sel_hi:[1,0,1]
    v_fma_f32 v209, -v128, v209, v2
    v_mul_f32_dpp v2, -v210, v129 row_ror:8 row_mask:0xf bank_mask:0xf
    v_pk_mul_f32 v[0:1], v[180:181], v[126:127] op_sel_hi:[1,0]
    v_pk_mul_f32 v[180:181], v[180:181], v[124:125] op_sel_hi:[1,0]
    v_pk_fma_f32 v[180:181], v[196:197], v[126:127], v[180:181] op_sel_hi:[1,0,1] neg_lo:[1,0,0] neg_hi:[1,0,0]
    v_pk_fma_f32 v[196:197], v[196:197], v[124:125], v[0:1] op_sel_hi:[1,0,1]
    v_fma_f32 v210, -v128, v210, v2
    v_mul_f32_dpp v2, -v211, v129 row_ror:8 row_mask:0xf bank_mask:0xf
    v_pk_mul_f32 v[0:1], v[182:183], v[126:127] op_sel_hi:[1,0]
    v_pk_mul_f32 v[182:183], v[182:183], v[124:125] op_sel_hi:[1,0]
    v_pk_fma_f32 v[182:183], v[198:199], v[126:127], v[182:183] op_sel_hi:[1,0,1] neg_lo:[1,0,0] neg_hi:[1,0,0]
    v_pk_fma_f32 v[198:199], v[198:199], v[124:125], v[0:1] op_sel_hi:[1,0,1]
    v_fma_f32 v211, -v128, v211, v2
    v_mul_f32_dpp v2, -v212, v129 row_ror:8 row_mask:0xf bank_mask:0xf
    v_pk_mul_f32 v[0:1], v[184:185], v[126:127] op_sel_hi:[1,0]
    s_add_u32 s83, s83, 9216
    buffer_load_dwordx4 v158, s[56:59], s83 offen offset:1024 lds
    v_pk_mul_f32 v[184:185], v[184:185], v[124:125] op_sel_hi:[1,0]
    v_pk_fma_f32 v[184:185], v[200:201], v[126:127], v[184:185] op_sel_hi:[1,0,1] neg_lo:[1,0,0] neg_hi:[1,0,0]
    v_pk_fma_f32 v[200:201], v[200:201], v[124:125], v[0:1] op_sel_hi:[1,0,1]
    v_fma_f32 v212, -v128, v212, v2
    v_mul_f32_dpp v2, -v213, v129 row_ror:8 row_mask:0xf bank_mask:0xf
    v_pk_mul_f32 v[0:1], v[186:187], v[126:127] op_sel_hi:[1,0]
    v_pk_mul_f32 v[186:187], v[186:187], v[124:125] op_sel_hi:[1,0]
    v_pk_fma_f32 v[186:187], v[202:203], v[126:127], v[186:187] op_sel_hi:[1,0,1] neg_lo:[1,0,0] neg_hi:[1,0,0]
    v_pk_fma_f32 v[202:203], v[202:203], v[124:125], v[0:1] op_sel_hi:[1,0,1]
    v_fma_f32 v213, -v128, v213, v2
    v_mul_f32_dpp v2, -v214, v129 row_ror:8 row_mask:0xf bank_mask:0xf
    v_pk_mul_f32 v[0:1], v[188:189], v[126:127] op_sel_hi:[1,0]
    buffer_load_dwordx4 v158, s[60:63], s83 offen offset:3072 lds
    v_pk_mul_f32 v[188:189], v[188:189], v[124:125] op_sel_hi:[1,0]
    v_pk_fma_f32 v[188:189], v[204:205], v[126:127], v[188:189] op_sel_hi:[1,0,1] neg_lo:[1,0,0] neg_hi:[1,0,0]
    v_pk_fma_f32 v[204:205], v[204:205], v[124:125], v[0:1] op_sel_hi:[1,0,1]
    v_fma_f32 v214, -v128, v214, v2
    v_mul_f32_dpp v2, -v215, v129 row_ror:8 row_mask:0xf bank_mask:0xf
    v_pk_mul_f32 v[0:1], v[190:191], v[126:127] op_sel_hi:[1,0]
    v_pk_mul_f32 v[190:191], v[190:191], v[124:125] op_sel_hi:[1,0]
    v_pk_fma_f32 v[190:191], v[206:207], v[126:127], v[190:191] op_sel_hi:[1,0,1] neg_lo:[1,0,0] neg_hi:[1,0,0]
    v_pk_fma_f32 v[206:207], v[206:207], v[124:125], v[0:1] op_sel_hi:[1,0,1]
    v_fma_f32 v215, -v128, v215, v2
    s_cmp_lg_u32 s13, 0
    s_cbranch_scc1 Lv_1
    v_mfma_f32_16x16x32_bf16 v[44:47], v[68:71], v[100:103], 0
    buffer_load_dwordx4 v[216:219], v253, s[92:95], 0 offen offset:256 sc1
    v_lshrrev_b32 v29, 4, v152
    v_mul_u32_u24 v29, 640, v29
    v_mfma_f32_16x16x32_bf16 v[32:35], v[60:63], v[72:75], 0
    v_add_u32 v30, v154, v29
    v_add_u32 v31, v155, v29
    s_waitcnt lgkmcnt(2)
    v_mfma_f32_16x16x32_bf16 v[32:35], v[116:119], v[108:111], v[32:35]
    ds_read_b64 v[4:5], v154 offset:9600
    ds_read_b64 v[6:7], v155 offset:9600
    ds_read_b64 v[8:9], v30 offset:5120
    ds_read_b64 v[10:11], v31 offset:5120
    buffer_load_dwordx4 v[220:223], v253, s[92:95], 0 offen offset:512 sc1
    v_add_u32 v30, v30, v29
    v_add_u32 v31, v31, v29
    v_mfma_f32_16x16x32_bf16 v[32:35], v[68:71], v[64:67], v[32:35]
    v_and_b32 v29, 1, v152
    v_mul_u32_u24 v29, 640, v29
    v_mfma_f32_16x16x32_bf16 v[36:39], v[60:63], v[64:67], 0
    ds_read_b128 v[64:67], v165 offset:3072
    buffer_load_dwordx4 v[224:227], v253, s[92:95], 0 offen offset:768 sc1
    v_add_u32 v31, v31, v29
    v_mfma_f32_16x16x32_bf16 v[36:39], v[88:91], v[72:75], v[36:39]
    ds_read_b128 v[72:75], v165 offset:2560
    ds_read2_b32 v[12:13], v30 offset1:160
    ds_read2_b32 v[14:15], v30 offset0:1 offset1:161
    ds_read_b64 v[16:17], v31 offset:0
    s_waitcnt lgkmcnt(9)
    v_mfma_f32_16x16x32_bf16 v[36:39], v[120:123], v[108:111], v[36:39]
    ds_read2_b32 v[120:121], v50 offset0:144 offset1:145
    ds_read2_b32 v[122:123], v50 offset0:146 offset1:147
    ds_read_b64 v[18:19], v154 offset:7680
    ds_read_b64 v[20:21], v155 offset:7680
    buffer_load_dwordx4 v[228:231], v253, s[92:95], 0 offen offset:1024 sc1
    v_mfma_f32_16x16x32_bf16 v[44:47], v[60:63], v[108:111], v[44:47]
    ds_read2_b32 v[60:61], v164 offset0:144 offset1:145
    ds_read2_b32 v[62:63], v164 offset0:146 offset1:147
    s_add_u32 s6, s100, 71680
    v_bfe_u32 v29, v152, 4, 1
    v_lshlrev_b32 v29, 6, v29
    v_mfma_f32_16x16x32_bf16 v[40:43], v[68:71], v[108:111], 0
    ds_read_b128 v[108:111], v165 offset:0
    buffer_load_dwordx4 v[232:235], v253, s[92:95], 0 offen offset:1280 sc1
    v_xor_b32 v22, v29, v153
    v_add_u32 v22, s6, v22
    v_mfma_f32_16x16x32_bf16 v[36:39], v[68:71], v[80:83], v[36:39]
    ds_read2_b32 v[68:69], v164 offset0:16 offset1:17
    ds_read2_b32 v[70:71], v164 offset0:18 offset1:19
    ds_read_b128 v[80:83], v165 offset:3584
    v_and_b32 v24, 3, v152
    v_lshl_add_u32 v24, v24, 8, s6
    v_mfma_f32_16x16x32_bf16 v[32:35], v[88:91], v[92:95], v[32:35]
    ds_read2_b32 v[88:89], v48 offset0:16 offset1:17
    ds_read2_b32 v[90:91], v48 offset0:18 offset1:19
    buffer_load_dwordx4 v[236:239], v253, s[92:95], 0 offen offset:1536 sc1
    v_lshl_add_u32 v24, v29, 1, v24
    v_bfe_u32 v29, v152, 2, 2
    v_mfma_f32_16x16x32_bf16 v[36:39], v[104:107], v[92:95], v[36:39]
    ds_read_b128 v[92:95], v165 offset:2048
    v_lshl_add_u32 v24, v29, 4, v24
    v_lshrrev_b32 v23, 5, v152
    v_mfma_f32_16x16x32_bf16 v[36:39], v[96:99], v[76:79], v[36:39]
    buffer_load_dwordx4 v[240:243], v253, s[92:95], 0 offen offset:1792 sc1
    v_lshl_add_u32 v24, v23, 3, v24
    v_and_b32 v29, 1, v152
    v_mfma_f32_16x16x32_bf16 v[32:35], v[104:107], v[76:79], v[32:35]
    ds_read2_b32 v[104:105], v48 offset0:144 offset1:145
    ds_read2_b32 v[106:107], v48 offset0:146 offset1:147
    ds_read_b128 v[76:79], v165 offset:1536
    v_lshl_add_u32 v24, v29, 6, v24
    v_xor_b32 v25, 64, v24
    v_mfma_f32_16x16x32_bf16 v[36:39], v[112:115], v[84:87], v[36:39]
    s_lshl_b32 s3, s77, 10
    s_add_u32 s3, s3, 94016
    buffer_load_dwordx4 v[244:247], v253, s[92:95], 0 offen offset:2048 sc1
    v_lshl_add_u32 v26, v29, 2, s3
    v_lshlrev_b32 v28, 5, v29
    v_mfma_f32_16x16x32_bf16 v[32:35], v[96:99], v[84:87], v[32:35]
    ds_read2_b32 v[96:97], v49 offset0:16 offset1:17
    ds_read2_b32 v[98:99], v49 offset0:18 offset1:19
    ds_read_b128 v[84:87], v165 offset:1024
    v_bfe_u32 v29, v152, 1, 3
    v_lshl_add_u32 v26, v29, 5, v26
    v_mfma_f32_16x16x32_bf16 v[36:39], v[116:119], v[100:103], v[36:39]
    ds_read2_b32 v[116:117], v50 offset0:16 offset1:17
    ds_read2_b32 v[118:119], v50 offset0:18 offset1:19
    s_add_u32 m0, s84, 4096
    s_add_u32 s83, s44, 81920
    s_mov_b32 exec_hi, 0
    buffer_load_dwordx4 v159, s[56:59], s83 offen offset:0 lds
    s_mov_b32 exec_hi, -1
    v_and_b32 v29, 1, v29
    v_lshl_add_u32 v28, v29, 4, v28
    v_mfma_f32_16x16x32_bf16 v[32:35], v[112:115], v[100:103], v[32:35]
    ds_read2_b32 v[112:113], v49 offset0:144 offset1:145
    ds_read2_b32 v[114:115], v49 offset0:146 offset1:147
    ds_read_b128 v[100:103], v165 offset:512
    v_and_b32 v29, 0xc0, v153
    v_add_u32 v28, v29, v28
    s_waitcnt lgkmcnt(15)
    v_mfma_f32_16x16x32_bf16 v[32:35], v[60:63], v[72:75], v[32:35]
    v_lshrrev_b32 v29, 4, v152
    v_lshl_add_u32 v26, v29, 3, v26
    v_mfma_f32_16x16x32_bf16 v[40:43], v[68:71], v[108:111], v[40:43]
    v_lshl_add_u32 v27, v29, 7, s3
    v_lshl_add_u32 v27, v152, 3, v27
    s_waitcnt lgkmcnt(14)
    v_mfma_f32_16x16x32_bf16 v[36:39], v[68:71], v[80:83], v[36:39]
    ds_read_b128 v[80:83], v167 offset:3776
    s_mov_b32 exec_hi, 0
    buffer_load_dwordx4 v159, s[60:63], s83 offen offset:2048 lds
    s_mov_b32 exec_hi, -1
    v_mul_u32_u24 v29, 40960, v29
    v_add_u32 v28, v29, v28
    v_mfma_f32_16x16x32_bf16 v[32:35], v[68:71], v[64:67], v[32:35]
    v_xor_b32 v7, v163, v7
    v_xor_b32 v11, v163, v11
    v_mfma_f32_16x16x32_bf16 v[36:39], v[60:63], v[64:67], v[36:39]
    ds_read_b128 v[64:67], v167 offset:3264
    v_xor_b32 v16, v163, v16
    v_xor_b32 v21, v163, v21
    v_mfma_f32_16x16x32_bf16 v[44:47], v[60:63], v[108:111], v[44:47]
    ds_read2_b32 v[60:61], v166 offset0:128 offset1:129
    ds_read2_b32 v[62:63], v166 offset0:130 offset1:131
    s_lshl_b32 s3, s77, 10
    s_add_u32 s3, s3, 38912
    v_add_u32 v170, s3, v153
    s_waitcnt lgkmcnt(15)
    v_mfma_f32_16x16x32_bf16 v[36:39], v[88:91], v[72:75], v[36:39]
    ds_read_b128 v[72:75], v167 offset:2752
    s_add_u32 s83, s83, 4096
    s_mov_b32 exec_hi, 0
    buffer_load_dwordx4 v159, s[56:59], s83 offen offset:1024 lds
    s_mov_b32 exec_hi, -1
    s_waitcnt lgkmcnt(11)
    v_mfma_f32_16x16x32_bf16 v[36:39], v[96:99], v[76:79], v[36:39]
    s_waitcnt lgkmcnt(8)
    v_mfma_f32_16x16x32_bf16 v[32:35], v[116:119], v[108:111], v[32:35]
    s_waitcnt lgkmcnt(5)
    v_mfma_f32_16x16x32_bf16 v[44:47], v[68:71], v[100:103], v[44:47]
    ds_read2_b32 v[68:69], v166 offset0:0 offset1:1
    ds_read2_b32 v[70:71], v166 offset0:2 offset1:3
    v_mfma_f32_16x16x32_bf16 v[32:35], v[104:107], v[76:79], v[32:35]
    ds_read_b128 v[76:79], v167 offset:1728
    s_mov_b32 exec_hi, 0
    buffer_load_dwordx4 v159, s[60:63], s83 offen offset:3072 lds
    s_mov_b32 exec_hi, -1
    v_lshrrev_b32 v159, 5, v152
    v_mul_u32_u24 v159, 5056, v159
    v_add_u32 v159, v158, v159
    v_mfma_f32_16x16x32_bf16 v[32:35], v[96:99], v[84:87], v[32:35]
    ds_read2_b32 v[96:97], v130 offset0:0 offset1:1
    ds_read2_b32 v[98:99], v130 offset0:2 offset1:3
    v_mfma_f32_16x16x32_bf16 v[36:39], v[112:115], v[84:87], v[36:39]
    ds_read_b128 v[84:87], v167 offset:1216
    v_mfma_f32_16x16x32_bf16 v[32:35], v[88:91], v[92:95], v[32:35]
    ds_read2_b32 v[88:89], v255 offset0:0 offset1:1
    ds_read2_b32 v[90:91], v255 offset0:2 offset1:3
    v_mfma_f32_16x16x32_bf16 v[36:39], v[120:123], v[108:111], v[36:39]
    ds_read_b128 v[108:111], v167 offset:192
    ds_read2_b32 v[120:121], v131 offset0:128 offset1:129
    ds_read2_b32 v[122:123], v131 offset0:130 offset1:131
    v_mfma_f32_16x16x32_bf16 v[36:39], v[104:107], v[92:95], v[36:39]
    ds_read_b128 v[92:95], v167 offset:2240
    ds_read2_b32 v[104:105], v255 offset0:128 offset1:129
    ds_read2_b32 v[106:107], v255 offset0:130 offset1:131
    v_mfma_f32_16x16x32_bf16 v[32:35], v[112:115], v[100:103], v[32:35]
    ds_read2_b32 v[112:113], v130 offset0:128 offset1:129
    ds_read2_b32 v[114:115], v130 offset0:130 offset1:131
    v_mfma_f32_16x16x32_bf16 v[36:39], v[116:119], v[100:103], v[36:39]
    ds_read_b128 v[100:103], v167 offset:704
    ds_read2_b32 v[116:117], v131 offset0:0 offset1:1
    ds_read2_b32 v[118:119], v131 offset0:2 offset1:3
    s_branch Lw_2
Lv_1:
    v_mfma_f32_16x16x32_bf16 v[32:35], v[60:63], v[76:79], 0
    buffer_load_dwordx4 v[216:219], v253, s[92:95], 0 offen offset:256 sc1
    v_lshrrev_b32 v29, 4, v152
    v_mul_u32_u24 v29, 640, v29
    v_mfma_f32_16x16x32_bf16 v[44:47], v[60:63], v[84:87], 0
    v_add_u32 v30, v154, v29
    v_add_u32 v31, v155, v29
    v_mfma_f32_16x16x32_bf16 v[36:39], v[68:71], v[72:75], 0
    ds_read_b128 v[72:75], v165 offset:2560
    ds_read_b128 v[64:67], v167 offset:3264
    ds_read_b128 v[80:83], v167 offset:3776
    ds_read2_b32 v[116:117], v131 offset0:0 offset1:1
    ds_read2_b32 v[118:119], v131 offset0:2 offset1:3
    ds_read2_b32 v[120:121], v131 offset0:128 offset1:129
    ds_read2_b32 v[122:123], v131 offset0:130 offset1:131
    buffer_load_dwordx4 v[220:223], v253, s[92:95], 0 offen offset:512 sc1
    v_mfma_f32_16x16x32_bf16 v[44:47], v[68:71], v[76:79], v[44:47]
    ds_read_b64 v[4:5], v154 offset:9600
    ds_read_b64 v[6:7], v155 offset:9600
    ds_read_b64 v[8:9], v30 offset:5120
    ds_read_b64 v[10:11], v31 offset:5120
    v_add_u32 v30, v30, v29
    v_add_u32 v31, v31, v29
    v_mfma_f32_16x16x32_bf16 v[40:43], v[60:63], v[100:103], 0
    buffer_load_dwordx4 v[224:227], v253, s[92:95], 0 offen offset:768 sc1
    v_and_b32 v29, 1, v152
    v_mul_u32_u24 v29, 640, v29
    v_mfma_f32_16x16x32_bf16 v[36:39], v[60:63], v[92:95], v[36:39]
    ds_read2_b32 v[60:61], v164 offset0:144 offset1:145
    ds_read2_b32 v[62:63], v164 offset0:146 offset1:147
    v_add_u32 v31, v31, v29
    s_waitcnt lgkmcnt(15)
    v_mfma_f32_16x16x32_bf16 v[36:39], v[104:107], v[84:87], v[36:39]
    ds_read2_b32 v[12:13], v30 offset1:160
    ds_read2_b32 v[14:15], v30 offset0:1 offset1:161
    ds_read_b64 v[16:17], v31 offset:0
    ds_read_b64 v[18:19], v154 offset:7680
    buffer_load_dwordx4 v[228:231], v253, s[92:95], 0 offen offset:1024 sc1
    v_mfma_f32_16x16x32_bf16 v[40:43], v[68:71], v[84:87], v[40:43]
    ds_read_b64 v[20:21], v155 offset:7680
    s_add_u32 s6, s100, 71680
    v_bfe_u32 v29, v152, 4, 1
    v_lshlrev_b32 v29, 6, v29
    v_mfma_f32_16x16x32_bf16 v[36:39], v[88:91], v[76:79], v[36:39]
    ds_read_b128 v[76:79], v165 offset:1536
    buffer_load_dwordx4 v[232:235], v253, s[92:95], 0 offen offset:1280 sc1
    v_xor_b32 v22, v29, v153
    v_add_u32 v22, s6, v22
    v_mfma_f32_16x16x32_bf16 v[32:35], v[68:71], v[92:95], v[32:35]
    ds_read2_b32 v[68:69], v164 offset0:16 offset1:17
    ds_read2_b32 v[70:71], v164 offset0:18 offset1:19
    ds_read_b128 v[92:95], v165 offset:2048
    v_and_b32 v24, 3, v152
    v_lshl_add_u32 v24, v24, 8, s6
    v_mfma_f32_16x16x32_bf16 v[32:35], v[104:107], v[100:103], v[32:35]
    buffer_load_dwordx4 v[236:239], v253, s[92:95], 0 offen offset:1536 sc1
    v_lshl_add_u32 v24, v29, 1, v24
    v_bfe_u32 v29, v152, 2, 2
    v_mfma_f32_16x16x32_bf16 v[40:43], v[88:91], v[108:111], v[40:43]
    v_lshl_add_u32 v24, v29, 4, v24
    v_lshrrev_b32 v23, 5, v152
    v_mfma_f32_16x16x32_bf16 v[32:35], v[88:91], v[84:87], v[32:35]
    ds_read_b128 v[84:87], v165 offset:1024
    buffer_load_dwordx4 v[240:243], v253, s[92:95], 0 offen offset:1792 sc1
    v_lshl_add_u32 v24, v23, 3, v24
    v_and_b32 v29, 1, v152
    v_mfma_f32_16x16x32_bf16 v[36:39], v[96:99], v[100:103], v[36:39]
    v_lshl_add_u32 v24, v29, 6, v24
    v_xor_b32 v25, 64, v24
    v_mfma_f32_16x16x32_bf16 v[44:47], v[88:91], v[100:103], v[44:47]
    ds_read2_b32 v[88:89], v48 offset0:16 offset1:17
    ds_read2_b32 v[90:91], v48 offset0:18 offset1:19
    ds_read_b128 v[100:103], v165 offset:512
    s_lshl_b32 s3, s77, 10
    buffer_load_dwordx4 v[244:247], v253, s[92:95], 0 offen offset:2048 sc1
    v_mfma_f32_16x16x32_bf16 v[32:35], v[96:99], v[108:111], v[32:35]
    ds_read2_b32 v[96:97], v49 offset0:16 offset1:17
    ds_read2_b32 v[98:99], v49 offset0:18 offset1:19
    s_add_u32 s3, s3, 94016
    v_lshl_add_u32 v26, v29, 2, s3
    v_lshlrev_b32 v28, 5, v29
    v_mfma_f32_16x16x32_bf16 v[36:39], v[112:115], v[108:111], v[36:39]
    ds_read2_b32 v[112:113], v49 offset0:144 offset1:145
    ds_read2_b32 v[114:115], v49 offset0:146 offset1:147
    s_add_u32 m0, s84, 4096
    s_add_u32 s83, s44, 81920
    s_mov_b32 exec_hi, 0
    buffer_load_dwordx4 v159, s[56:59], s83 offen offset:0 lds
    s_mov_b32 exec_hi, -1
    v_bfe_u32 v29, v152, 1, 3
    v_lshl_add_u32 v26, v29, 5, v26
    v_mfma_f32_16x16x32_bf16 v[44:47], v[104:107], v[108:111], v[44:47]
    ds_read2_b32 v[104:105], v48 offset0:144 offset1:145
    ds_read2_b32 v[106:107], v48 offset0:146 offset1:147
    ds_read_b128 v[108:111], v165 offset:0
    v_and_b32 v29, 1, v29
    v_lshl_add_u32 v28, v29, 4, v28
    s_waitcnt lgkmcnt(15)
    s_waitcnt lgkmcnt(14)
    v_mfma_f32_16x16x32_bf16 v[32:35], v[60:63], v[76:79], v[32:35]
    v_and_b32 v29, 0xc0, v153
    v_add_u32 v28, v29, v28
    s_waitcnt lgkmcnt(12)
    v_mfma_f32_16x16x32_bf16 v[36:39], v[68:71], v[72:75], v[36:39]
    ds_read_b128 v[72:75], v167 offset:2752
    v_lshrrev_b32 v29, 4, v152
    v_lshl_add_u32 v26, v29, 3, v26
    s_waitcnt lgkmcnt(12)
    v_mfma_f32_16x16x32_bf16 v[32:35], v[68:71], v[92:95], v[32:35]
    s_mov_b32 exec_hi, 0
    buffer_load_dwordx4 v159, s[60:63], s83 offen offset:2048 lds
    s_mov_b32 exec_hi, -1
    v_lshl_add_u32 v27, v29, 7, s3
    v_lshl_add_u32 v27, v152, 3, v27
    v_mfma_f32_16x16x32_bf16 v[36:39], v[60:63], v[92:95], v[36:39]
    ds_read_b128 v[92:95], v167 offset:2240
    v_mul_u32_u24 v29, 40960, v29
    v_add_u32 v28, v29, v28
    s_waitcnt lgkmcnt(12)
    v_mfma_f32_16x16x32_bf16 v[40:43], v[68:71], v[84:87], v[40:43]
    v_xor_b32 v7, v163, v7
    v_xor_b32 v11, v163, v11
    v_mfma_f32_16x16x32_bf16 v[44:47], v[68:71], v[76:79], v[44:47]
    ds_read2_b32 v[68:69], v166 offset0:0 offset1:1
    ds_read2_b32 v[70:71], v166 offset0:2 offset1:3
    v_xor_b32 v16, v163, v16
    v_xor_b32 v21, v163, v21
    s_waitcnt lgkmcnt(12)
    v_mfma_f32_16x16x32_bf16 v[36:39], v[88:91], v[76:79], v[36:39]
    ds_read_b128 v[76:79], v167 offset:1728
    s_lshl_b32 s3, s77, 10
    s_add_u32 s3, s3, 38912
    s_add_u32 s83, s83, 4096
    s_mov_b32 exec_hi, 0
    buffer_load_dwordx4 v159, s[56:59], s83 offen offset:1024 lds
    s_mov_b32 exec_hi, -1
    v_add_u32 v170, s3, v153
    v_mfma_f32_16x16x32_bf16 v[44:47], v[60:63], v[84:87], v[44:47]
    s_waitcnt lgkmcnt(12)
    v_mfma_f32_16x16x32_bf16 v[40:43], v[60:63], v[100:103], v[40:43]
    ds_read2_b32 v[60:61], v166 offset0:128 offset1:129
    ds_read2_b32 v[62:63], v166 offset0:130 offset1:131
    v_mfma_f32_16x16x32_bf16 v[44:47], v[88:91], v[100:103], v[44:47]
    s_waitcnt lgkmcnt(8)
    s_waitcnt lgkmcnt(7)
    v_mfma_f32_16x16x32_bf16 v[44:47], v[104:107], v[108:111], v[44:47]
    s_mov_b32 exec_hi, 0
    buffer_load_dwordx4 v159, s[60:63], s83 offen offset:3072 lds
    s_mov_b32 exec_hi, -1
    v_lshrrev_b32 v159, 5, v152
    v_mul_u32_u24 v159, 5056, v159
    v_add_u32 v159, v158, v159
    v_mfma_f32_16x16x32_bf16 v[40:43], v[88:91], v[108:111], v[40:43]
    v_mfma_f32_16x16x32_bf16 v[32:35], v[88:91], v[84:87], v[32:35]
    ds_read2_b32 v[88:89], v255 offset0:0 offset1:1
    ds_read2_b32 v[90:91], v255 offset0:2 offset1:3
    v_mfma_f32_16x16x32_bf16 v[36:39], v[104:107], v[84:87], v[36:39]
    ds_read_b128 v[84:87], v167 offset:1216
    v_mfma_f32_16x16x32_bf16 v[32:35], v[96:99], v[108:111], v[32:35]
    v_mfma_f32_16x16x32_bf16 v[32:35], v[104:107], v[100:103], v[32:35]
    ds_read2_b32 v[104:105], v255 offset0:128 offset1:129
    ds_read2_b32 v[106:107], v255 offset0:130 offset1:131
    v_mfma_f32_16x16x32_bf16 v[36:39], v[112:115], v[108:111], v[36:39]
    ds_read_b128 v[108:111], v167 offset:192
    ds_read2_b32 v[112:113], v130 offset0:128 offset1:129
    ds_read2_b32 v[114:115], v130 offset0:130 offset1:131
    v_mfma_f32_16x16x32_bf16 v[36:39], v[96:99], v[100:103], v[36:39]
    ds_read2_b32 v[96:97], v130 offset0:0 offset1:1
    ds_read2_b32 v[98:99], v130 offset0:2 offset1:3
    ds_read_b128 v[100:103], v167 offset:704
Lw_2:
    s_waitcnt vmcnt(4)
    L_cchk0:
    v_add3_u32 v169, v219, v223, v227
    v_add3_u32 v168, v231, v235, v239
    v_add3_u32 v169, v169, v243, v247
    v_add_u32 v169, v169, v168
    v_cmp_ne_u32 vcc, v169, v254

    s_cbranch_vccnz L_cre0
    v_fmac_f32 v242, v6, v246
    v_pk_fma_f32 v[240:241], v[244:245], v[4:5], v[240:241] op_sel_hi:[1,0,1]
    s_nop 0
    v_fmac_f32_dpp v242, v246, v7 row_ror:8 row_mask:0xf bank_mask:0xf
    v_pk_fma_f32 v[240:241], v[244:245], v[4:5], v[240:241] op_sel:[1,1,0] op_sel_hi:[0,1,1] neg_lo:[1,0,0]
    ds_write_b128 v170, v[32:35] offset:0
    v_fmac_f32 v238, v6, v242
    v_pk_fma_f32 v[236:237], v[240:241], v[4:5], v[236:237] op_sel_hi:[1,0,1]
    s_nop 0
    v_fmac_f32_dpp v238, v242, v7 row_ror:8 row_mask:0xf bank_mask:0xf
    v_pk_fma_f32 v[236:237], v[240:241], v[4:5], v[236:237] op_sel:[1,1,0] op_sel_hi:[0,1,1] neg_lo:[1,0,0]
    v_fmac_f32 v234, v6, v238
    v_pk_fma_f32 v[232:233], v[236:237], v[4:5], v[232:233] op_sel_hi:[1,0,1]
    s_nop 0
    v_fmac_f32_dpp v234, v238, v7 row_ror:8 row_mask:0xf bank_mask:0xf
    v_pk_fma_f32 v[232:233], v[236:237], v[4:5], v[232:233] op_sel:[1,1,0] op_sel_hi:[0,1,1] neg_lo:[1,0,0]
    ds_write_b128 v170, v[36:39] offset:4096
    v_fmac_f32 v230, v6, v234
    v_pk_fma_f32 v[228:229], v[232:233], v[4:5], v[228:229] op_sel_hi:[1,0,1]
    s_nop 0
    v_fmac_f32_dpp v230, v234, v7 row_ror:8 row_mask:0xf bank_mask:0xf
    v_pk_fma_f32 v[228:229], v[232:233], v[4:5], v[228:229] op_sel:[1,1,0] op_sel_hi:[0,1,1] neg_lo:[1,0,0]
    v_fmac_f32 v226, v6, v230
    v_pk_fma_f32 v[224:225], v[228:229], v[4:5], v[224:225] op_sel_hi:[1,0,1]
    s_nop 0
    v_fmac_f32_dpp v226, v230, v7 row_ror:8 row_mask:0xf bank_mask:0xf
    v_pk_fma_f32 v[224:225], v[228:229], v[4:5], v[224:225] op_sel:[1,1,0] op_sel_hi:[0,1,1] neg_lo:[1,0,0]
    ds_write_b128 v170, v[40:43] offset:8192
    v_fmac_f32 v222, v6, v226
    v_pk_fma_f32 v[220:221], v[224:225], v[4:5], v[220:221] op_sel_hi:[1,0,1]
    s_nop 0
    v_fmac_f32_dpp v222, v226, v7 row_ror:8 row_mask:0xf bank_mask:0xf
    v_pk_fma_f32 v[220:221], v[224:225], v[4:5], v[220:221] op_sel:[1,1,0] op_sel_hi:[0,1,1] neg_lo:[1,0,0]
    v_fmac_f32 v218, v6, v222
    v_pk_fma_f32 v[216:217], v[220:221], v[4:5], v[216:217] op_sel_hi:[1,0,1]
    s_nop 0
    v_fmac_f32_dpp v218, v222, v7 row_ror:8 row_mask:0xf bank_mask:0xf
    v_pk_fma_f32 v[216:217], v[220:221], v[4:5], v[216:217] op_sel:[1,1,0] op_sel_hi:[0,1,1] neg_lo:[1,0,0]
    ds_write_b128 v170, v[44:47] offset:12288
    v_mul_f32 v222, v10, v218
    v_pk_mul_f32 v[220:221], v[216:217], v[8:9] op_sel_hi:[1,0]
    s_nop 0
    v_fmac_f32_dpp v222, v218, v11 row_ror:8 row_mask:0xf bank_mask:0xf
    v_pk_fma_f32 v[220:221], v[216:217], v[8:9], v[220:221] op_sel:[1,1,0] op_sel_hi:[0,1,1] neg_lo:[1,0,0]

    v_mov_b32 v226, v222
    v_mov_b64 v[224:225], v[220:221]
    s_nop 0
    v_permlane32_swap_b32 v222, v226
    v_permlane32_swap_b32 v220, v224
    v_permlane32_swap_b32 v221, v225
    v_add_f32 v222, v222, v226
    v_pk_add_f32 v[220:221], v[220:221], v[224:225]

    v_mov_b32 v226, v222
    v_mov_b64 v[224:225], v[220:221]
    s_nop 0
    v_permlane16_swap_b32 v222, v226
    v_permlane16_swap_b32 v220, v224
    v_permlane16_swap_b32 v221, v225
    v_add_f32 v222, v222, v226
    v_pk_add_f32 v[220:221], v[220:221], v[224:225]

    v_fma_f32 v252, -v16, v222, v252
    v_pk_fma_f32 v[248:249], v[12:13], v[220:221], v[248:249] op_sel_hi:[1,0,1]
    v_pk_fma_f32 v[250:251], v[12:13], v[220:221], v[250:251] op_sel:[0,1,0]
    v_fmac_f32_dpp v252, -v222, v17 row_ror:8 row_mask:0xf bank_mask:0xf
    v_pk_fma_f32 v[248:249], v[14:15], v[220:221], v[248:249] op_sel:[0,1,0] neg_lo:[1,0,0] neg_hi:[1,0,0]
    v_pk_fma_f32 v[250:251], v[14:15], v[220:221], v[250:251] op_sel_hi:[1,0,1]

    v_fmac_f32 v208, v20, v252
    v_pk_fma_f32 v[176:177], v[248:249], v[18:19], v[176:177] op_sel_hi:[1,0,1]
    v_pk_fma_f32 v[192:193], v[250:251], v[18:19], v[192:193] op_sel_hi:[1,0,1]
    v_fmac_f32_dpp v208, -v252, v21 row_ror:8 row_mask:0xf bank_mask:0xf
    v_pk_fma_f32 v[176:177], v[250:251], v[18:19], v[176:177] op_sel:[0,1,0] neg_lo:[1,0,0] neg_hi:[1,0,0]
    v_fmac_f32 v209, v20, v208
    v_pk_fma_f32 v[192:193], v[248:249], v[18:19], v[192:193] op_sel:[0,1,0]
    s_nop 0
    v_fmac_f32_dpp v209, -v208, v21 row_ror:8 row_mask:0xf bank_mask:0xf
    v_fmac_f32 v210, v20, v209
    v_pk_fma_f32 v[178:179], v[176:177], v[18:19], v[178:179] op_sel_hi:[1,0,1]
    v_pk_fma_f32 v[194:195], v[192:193], v[18:19], v[194:195] op_sel_hi:[1,0,1]
    v_fmac_f32_dpp v210, -v209, v21 row_ror:8 row_mask:0xf bank_mask:0xf
    v_pk_fma_f32 v[178:179], v[192:193], v[18:19], v[178:179] op_sel:[0,1,0] neg_lo:[1,0,0] neg_hi:[1,0,0]
    v_fmac_f32 v211, v20, v210
    v_pk_fma_f32 v[194:195], v[176:177], v[18:19], v[194:195] op_sel:[0,1,0]
    s_nop 0
    v_fmac_f32_dpp v211, -v210, v21 row_ror:8 row_mask:0xf bank_mask:0xf
    v_cvt_pk_bf16_f32 v232, v176, v177
    v_cvt_pk_bf16_f32 v233, v178, v179
    v_cvt_pk_bf16_f32 v234, -v192, -v193
    v_cvt_pk_bf16_f32 v235, -v194, -v195

    ds_write_b128 v22, v[232:235] offset:0
    ds_read_b64_tr_b16 v[216:217], v24 offset:0
    ds_read_b64_tr_b16 v[218:219], v25 offset:0
    v_fmac_f32 v212, v20, v211
    v_pk_fma_f32 v[180:181], v[178:179], v[18:19], v[180:181] op_sel_hi:[1,0,1]
    v_pk_fma_f32 v[196:197], v[194:195], v[18:19], v[196:197] op_sel_hi:[1,0,1]
    v_fmac_f32_dpp v212, -v211, v21 row_ror:8 row_mask:0xf bank_mask:0xf
    v_pk_fma_f32 v[180:181], v[194:195], v[18:19], v[180:181] op_sel:[0,1,0] neg_lo:[1,0,0] neg_hi:[1,0,0]
    v_fmac_f32 v213, v20, v212
    v_pk_fma_f32 v[196:197], v[178:179], v[18:19], v[196:197] op_sel:[0,1,0]
    s_nop 0
    v_fmac_f32_dpp v213, -v212, v21 row_ror:8 row_mask:0xf bank_mask:0xf
    v_fmac_f32 v214, v20, v213
    v_pk_fma_f32 v[182:183], v[180:181], v[18:19], v[182:183] op_sel_hi:[1,0,1]
    v_pk_fma_f32 v[198:199], v[196:197], v[18:19], v[198:199] op_sel_hi:[1,0,1]
    v_fmac_f32_dpp v214, -v213, v21 row_ror:8 row_mask:0xf bank_mask:0xf
    v_pk_fma_f32 v[182:183], v[196:197], v[18:19], v[182:183] op_sel:[0,1,0] neg_lo:[1,0,0] neg_hi:[1,0,0]
    v_fmac_f32 v215, v20, v214
    v_pk_fma_f32 v[198:199], v[180:181], v[18:19], v[198:199] op_sel:[0,1,0]
    s_nop 0
    v_fmac_f32_dpp v215, -v214, v21 row_ror:8 row_mask:0xf bank_mask:0xf
    v_cvt_pk_bf16_f32 v236, v180, v181
    v_cvt_pk_bf16_f32 v237, v182, v183
    v_cvt_pk_bf16_f32 v238, -v196, -v197
    v_cvt_pk_bf16_f32 v239, -v198, -v199

    ds_write_b128 v22, v[236:239] offset:1024
    ds_read_b64_tr_b16 v[220:221], v24 offset:1024
    ds_read_b64_tr_b16 v[222:223], v25 offset:1024
    v_pk_fma_f32 v[184:185], v[182:183], v[18:19], v[184:185] op_sel_hi:[1,0,1]
    v_pk_fma_f32 v[200:201], v[198:199], v[18:19], v[200:201] op_sel_hi:[1,0,1]
    v_pk_fma_f32 v[184:185], v[198:199], v[18:19], v[184:185] op_sel:[0,1,0] neg_lo:[1,0,0] neg_hi:[1,0,0]
    v_pk_fma_f32 v[200:201], v[182:183], v[18:19], v[200:201] op_sel:[0,1,0]
    v_cvt_pk_bf16_f32 v240, v208, v209
    v_cvt_pk_bf16_f32 v241, v210, v211
    v_cvt_pk_bf16_f32 v242, v212, v213
    v_cvt_pk_bf16_f32 v243, v214, v215
    ds_write2st64_b32 v26, v240, v241 offset0:0 offset1:1
    ds_write2st64_b32 v26, v242, v243 offset0:2 offset1:3
    ds_read_b64_tr_b16 v[244:245], v27 offset:0
    ds_read_b64_tr_b16 v[246:247], v27 offset:128
    v_pk_fma_f32 v[186:187], v[184:185], v[18:19], v[186:187] op_sel_hi:[1,0,1]
    v_pk_fma_f32 v[202:203], v[200:201], v[18:19], v[202:203] op_sel_hi:[1,0,1]
    v_pk_fma_f32 v[186:187], v[200:201], v[18:19], v[186:187] op_sel:[0,1,0] neg_lo:[1,0,0] neg_hi:[1,0,0]
    v_pk_fma_f32 v[202:203], v[184:185], v[18:19], v[202:203] op_sel:[0,1,0]
    v_cvt_pk_bf16_f32 v232, v184, v185
    v_cvt_pk_bf16_f32 v233, v186, v187
    v_cvt_pk_bf16_f32 v234, -v200, -v201
    v_cvt_pk_bf16_f32 v235, -v202, -v203

    ds_write_b128 v22, v[232:235] offset:0
    ds_read_b64_tr_b16 v[224:225], v24 offset:0
    ds_read_b64_tr_b16 v[226:227], v25 offset:0
    s_waitcnt lgkmcnt(10)
    v_and_b32 v216, -2, v216
    v_and_b32 v218, -2, v218
    s_cmp_eq_u32 s88, 0
    s_cbranch_scc1 Lss_3
    buffer_store_dwordx4 v[216:219], v153, s[64:67], s36 offen
Lsd_4:
    v_pk_fma_f32 v[188:189], v[186:187], v[18:19], v[188:189] op_sel_hi:[1,0,1]
    v_pk_fma_f32 v[204:205], v[202:203], v[18:19], v[204:205] op_sel_hi:[1,0,1]
    v_pk_fma_f32 v[188:189], v[202:203], v[18:19], v[188:189] op_sel:[0,1,0] neg_lo:[1,0,0] neg_hi:[1,0,0]
    v_pk_fma_f32 v[204:205], v[186:187], v[18:19], v[204:205] op_sel:[0,1,0]
    v_pk_fma_f32 v[190:191], v[188:189], v[18:19], v[190:191] op_sel_hi:[1,0,1]
    v_pk_fma_f32 v[206:207], v[204:205], v[18:19], v[206:207] op_sel_hi:[1,0,1]
    v_pk_fma_f32 v[190:191], v[204:205], v[18:19], v[190:191] op_sel:[0,1,0] neg_lo:[1,0,0] neg_hi:[1,0,0]
    v_pk_fma_f32 v[206:207], v[188:189], v[18:19], v[206:207] op_sel:[0,1,0]
    v_cvt_pk_bf16_f32 v236, v188, v189
    v_cvt_pk_bf16_f32 v237, v190, v191
    v_cvt_pk_bf16_f32 v238, -v204, -v205
    v_cvt_pk_bf16_f32 v239, -v206, -v207

    ds_write_b128 v22, v[236:239] offset:1024
    ds_read_b64_tr_b16 v[228:229], v24 offset:1024
    ds_read_b64_tr_b16 v[230:231], v25 offset:1024
    s_waitcnt lgkmcnt(10)
    v_and_b32 v220, -2, v220
    v_and_b32 v222, -2, v222
    s_cmp_eq_u32 s88, 0
    s_cbranch_scc1 Lss_5
    buffer_store_dwordx4 v[220:223], v153, s[64:67], s18 offen
Lsd_6:
    s_waitcnt lgkmcnt(6)
    v_and_or_b32 v244, v244, -2, v23
    v_and_or_b32 v246, v246, -2, v23
    s_cmp_eq_u32 s88, 0
    s_cbranch_scc1 Lss_7
    buffer_store_dwordx2 v[244:245], v28, s[64:67], s37 offen offset:0
    buffer_store_dwordx2 v[246:247], v28, s[64:67], s37 offen offset:512
Lsd_8:
    s_waitcnt lgkmcnt(3)
    v_or_b32 v224, 1, v224
    v_or_b32 v226, 1, v226
    s_cmp_eq_u32 s88, 0
    s_cbranch_scc1 Lss_9
    buffer_store_dwordx4 v[224:227], v153, s[64:67], s19 offen
Lsd_10:
    s_waitcnt lgkmcnt(0)
    v_or_b32 v228, 1, v228
    v_or_b32 v230, 1, v230
    s_cmp_eq_u32 s88, 0
    s_cbranch_scc1 Lss_11
    buffer_store_dwordx4 v[228:231], v153, s[64:67], s20 offen
Lsd_12:
    v_mfma_f32_16x16x32_bf16 v[28:31], v[60:63], v[64:67], 0
    v_and_b32 v172, 15, v152
    v_lshrrev_b32 v164, 4, v152
    v_mfma_f32_16x16x32_bf16 v[20:23], v[68:71], v[72:75], 0
    s_lshl_b32 s8, s79, 13
    s_and_b32 s7, s91, 31
    s_lshl_b32 s7, s7, 2
    s_add_u32 s8, s8, 11272192
    s_add_u32 s7, s7, s8
    ds_read_b128 a[216:219], v156 offset:8192
    v_lshlrev_b32 v164, 3, v164
    v_lshl_add_u32 v164, v172, 5, v164
    v_mfma_f32_16x16x32_bf16 v[16:19], v[60:63], v[76:79], 0
    ds_read_b128 a[220:223], v157 offset:8192
    v_xor_b32 v172, 8, v164
    v_mov_b32 v169, s7
    v_mfma_f32_16x16x32_bf16 v[12:15], v[68:71], v[76:79], 0
    s_lshl_b32 s6, s77, 12
    s_add_u32 s6, s6, 38912
    ds_read_b128 a[224:227], v156 offset:8704
    v_add_u32 v170, s6, v153
    v_mov_b32 v173, s82
    v_mfma_f32_16x16x32_bf16 v[28:31], v[68:71], v[80:83], v[28:31]
    ds_read_b128 v[80:83], v167 offset:3712
    s_add_u32 s3, s40, 9728
    ds_read_b128 a[228:231], v157 offset:8704
    v_add_u32 v171, s3, v172
    v_mfma_f32_16x16x32_bf16 v[8:11], v[68:71], v[84:87], 0
    v_mfma_f32_16x16x32_bf16 v[16:19], v[88:91], v[84:87], v[16:19]
    v_mfma_f32_16x16x32_bf16 v[20:23], v[60:63], v[92:95], v[20:23]
    v_mfma_f32_16x16x32_bf16 v[28:31], v[88:91], v[72:75], v[28:31]
    s_waitcnt lgkmcnt(0)
    s_add_u32 m0, s84, 8192
    s_add_u32 s83, s17, 40960
    buffer_load_dwordx4 v158, s[56:59], s83 offen offset:0 lds
    s_barrier
    v_mfma_f32_16x16x32_bf16 v[24:27], v[68:71], v[64:67], 0
    ds_read_b128 v[64:67], v167 offset:3200
    ds_read_b128 v[32:35], v170 offset:0
    v_mfma_f32_16x16x32_bf16 v[16:19], v[68:71], v[92:95], v[16:19]
    ds_read_b128 v[36:39], v170 offset:1024
    v_mfma_f32_16x16x32_bf16 v[28:31], v[96:99], v[76:79], v[28:31]
    ds_read_b128 v[40:43], v170 offset:2048
    v_mfma_f32_16x16x32_bf16 v[12:15], v[60:63], v[84:87], v[12:15]
    ds_read_b128 v[44:47], v170 offset:3072
    buffer_load_dwordx4 v158, s[60:63], s83 offen offset:2048 lds
    v_mfma_f32_16x16x32_bf16 v[24:27], v[88:91], v[92:95], v[24:27]
    ds_read_b64 v[48:49], v171
    ds_read_b128 a[232:235], v156 offset:12288
    v_mfma_f32_16x16x32_bf16 v[8:11], v[60:63], v[100:103], v[8:11]
    s_add_u32 s3, s40, s15
    s_add_u32 s3, s3, 3145728
    ds_read_b128 a[236:239], v157 offset:12288
    v_add_u32 v171, s3, v164
    v_and_b32 v57, 8, v164
    v_mfma_f32_16x16x32_bf16 v[20:23], v[88:91], v[76:79], v[20:23]
    ds_read_b128 a[240:243], v156 offset:12800
    v_and_b32 v164, 0x1f0, v164
    v_lshl_add_u32 v164, v57, 6, v164
    v_mfma_f32_16x16x32_bf16 v[12:15], v[88:91], v[100:103], v[12:15]
    s_add_u32 s83, s83, 9216
    buffer_load_dwordx4 v158, s[56:59], s83 offen offset:1024 lds
    ds_read_b128 a[244:247], v157 offset:12800
    v_mfma_f32_16x16x32_bf16 v[24:27], v[60:63], v[72:75], v[24:27]
    ds_read_b128 v[72:75], v167 offset:2688
    v_mfma_f32_16x16x32_bf16 v[24:27], v[104:107], v[76:79], v[24:27]
    ds_read_b128 v[76:79], v167 offset:1664
    v_mfma_f32_16x16x32_bf16 v[4:7], v[60:63], v[108:111], 0
    ds_read2_b32 v[60:61], v166 offset0:144 offset1:145
    ds_read2_b32 v[62:63], v166 offset0:146 offset1:147
    s_waitcnt lgkmcnt(9)
    v_add_f32 v32, v32, v36
    v_add_f32 v33, v33, v37
    v_mfma_f32_16x16x32_bf16 v[4:7], v[68:71], v[100:103], v[4:7]
    buffer_load_dwordx4 v158, s[60:63], s83 offen offset:3072 lds
    v_add_f32 v34, v34, v38
    v_add_f32 v35, v35, v39
    v_mfma_f32_16x16x32_bf16 v[0:3], v[68:71], v[108:111], 0
    ds_read2_b32 v[68:69], v166 offset0:16 offset1:17
    ds_read2_b32 v[70:71], v166 offset0:18 offset1:19
    v_add_f32 v40, v40, v44
    v_add_f32 v41, v41, v45
    v_mfma_f32_16x16x32_bf16 v[28:31], v[112:115], v[84:87], v[28:31]
    v_add_f32 v42, v42, v46
    v_add_f32 v43, v43, v47
    v_mfma_f32_16x16x32_bf16 v[28:31], v[116:119], v[100:103], v[28:31]
    v_add_f32 v32, v32, v40
    v_add_f32 v33, v33, v41
    v_mfma_f32_16x16x32_bf16 v[24:27], v[96:99], v[84:87], v[24:27]
    s_waitcnt lgkmcnt(6)
    s_add_u32 m0, s84, 12288
    s_add_u32 s83, s17, 46080
    buffer_load_dwordx4 v158, s[56:59], s83 offen offset:0 lds
    v_add_f32 v34, v34, v42
    v_add_f32 v35, v35, v43
    v_mfma_f32_16x16x32_bf16 v[20:23], v[104:107], v[84:87], v[20:23]
    ds_read_b128 v[84:87], v167 offset:1152
    v_and_b32 v36, s86, v49
    v_lshlrev_b32 v37, 16, v49
    v_mfma_f32_16x16x32_bf16 v[8:11], v[88:91], v[108:111], v[8:11]
    ds_read2_b32 v[88:89], v255 offset0:16 offset1:17
    ds_read2_b32 v[90:91], v255 offset0:18 offset1:19
    v_and_b32 v38, s86, v48
    v_lshlrev_b32 v39, 16, v48
    v_mfma_f32_16x16x32_bf16 v[28:31], v[104:107], v[92:95], v[28:31]
    ds_read_b128 v[92:95], v167 offset:2176
    v_mul_f32 v36, s35, v36
    v_mul_f32 v37, s35, v37
    v_mfma_f32_16x16x32_bf16 v[20:23], v[112:115], v[108:111], v[20:23]
    buffer_load_dwordx4 v158, s[60:63], s83 offen offset:2048 lds
    s_waitcnt vmcnt(12)
    v_mul_f32 v38, s35, v38
    v_mul_f32 v39, s35, v39
    v_mfma_f32_16x16x32_bf16 v[16:19], v[96:99], v[108:111], v[16:19]
    ds_read_b128 a[248:251], v156 offset:4096
    v_cvt_pk_bf16_f32 v36, 0, v36
    v_cvt_pk_bf16_f32 v37, 0, v37
    v_mfma_f32_16x16x32_bf16 v[24:27], v[116:119], v[108:111], v[24:27]
    ds_read2_b32 v[116:117], v131 offset0:16 offset1:17
    ds_read2_b32 v[118:119], v131 offset0:18 offset1:19
    s_waitcnt vmcnt(6)
    s_cmp_eq_u32 s88, 0
    s_cbranch_scc1 Lss_13
    global_store_dword v169, v173, s[50:51]
Lsd_14:
    ds_read_b128 a[252:255], v157 offset:4096
    v_cvt_pk_bf16_f32 v38, 0, v38
    v_cvt_pk_bf16_f32 v39, 0, v39
    v_mfma_f32_16x16x32_bf16 v[20:23], v[96:99], v[100:103], v[20:23]
    ds_read2_b32 v[96:97], v130 offset0:16 offset1:17
    ds_read2_b32 v[98:99], v130 offset0:18 offset1:19
    v_cvt_pk_bf16_f32 v32, 0, v32
    v_cvt_pk_bf16_f32 v33, 0, v33
    v_mfma_f32_16x16x32_bf16 v[16:19], v[104:107], v[100:103], v[16:19]
    s_add_u32 s83, s83, 9216
    buffer_load_dwordx4 v158, s[56:59], s83 offen offset:1024 lds
    v_cvt_pk_bf16_f32 v34, 0, v34
    v_cvt_pk_bf16_f32 v35, 0, v35
    v_mfma_f32_16x16x32_bf16 v[12:15], v[104:107], v[108:111], v[12:15]
    ds_read2_b32 v[104:105], v255 offset0:144 offset1:145
    ds_read2_b32 v[106:107], v255 offset0:146 offset1:147
    v_add_f32 v32, v32, v36
    v_add_f32 v33, v33, v37
    v_mfma_f32_16x16x32_bf16 v[24:27], v[112:115], v[100:103], v[24:27]
    ds_read2_b32 v[112:113], v130 offset0:144 offset1:145
    ds_read2_b32 v[114:115], v130 offset0:146 offset1:147
    ds_read_b128 v[100:103], v167 offset:640
    v_add_f32 v34, v34, v38
    v_add_f32 v35, v35, v39
    v_mfma_f32_16x16x32_bf16 v[28:31], v[120:123], v[108:111], v[28:31]
    ds_read2_b32 v[120:121], v131 offset0:144 offset1:145
    ds_read2_b32 v[122:123], v131 offset0:146 offset1:147
    ds_read_b128 v[108:111], v167 offset:128
    v_cvt_pk_bf16_f32 v58, v32, v33
    v_cvt_pk_bf16_f32 v59, v34, v35
    s_waitcnt lgkmcnt(15)
    v_mfma_f32_16x16x32_bf16 v[28:31], v[60:63], v[64:67], v[28:31]
    buffer_load_dwordx4 v158, s[60:63], s83 offen offset:3072 lds
    s_add_u32 s5, s77, 0
    v_or_b32 v58, 1, v58
    v_and_b32 v173, 31, v152
    v_mfma_f32_16x16x32_bf16 v[20:23], v[68:71], v[72:75], v[20:23]
    global_store_dwordx2 v171, v[58:59], s[50:51] sc1
    s_and_b32 s5, s5, 3
    v_lshl_add_u32 v173, v173, 2, s8
    v_mfma_f32_16x16x32_bf16 v[16:19], v[60:63], v[76:79], v[16:19]
    s_mul_i32 s3, s81, 4608
    s_lshl_b32 s4, s80, 10
    s_add_u32 s3, s3, 512
    v_mfma_f32_16x16x32_bf16 v[12:15], v[68:71], v[76:79], v[12:15]
    s_add_u32 s9, s3, s4
    s_sub_u32 s3, s3, s4
    v_add_u32 v57, s9, v172
    v_add_u32 v171, s3, v172
    v_mfma_f32_16x16x32_bf16 v[28:31], v[68:71], v[80:83], v[28:31]
    ds_read_b128 v[80:83], v167 offset:3648
    s_waitcnt lgkmcnt(11)
    s_add_u32 m0, s84, 4096
    s_add_u32 s83, s44, 0
    buffer_load_dwordx4 v159, s[56:59], s83 offen offset:0 lds
    v_mfma_f32_16x16x32_bf16 v[8:11], v[68:71], v[84:87], v[8:11]
    ds_read_b64 v[44:45], v57 offset:0
    ds_read_b64 v[46:47], v57 offset:512
    ds_read_b64 v[48:49], v171 offset:3072
    v_mfma_f32_16x16x32_bf16 v[16:19], v[88:91], v[84:87], v[16:19]
    ds_read_b64 v[50:51], v171 offset:3584
    s_lshl_b32 s3, s80, 13
    s_sub_u32 s3, 0x1000, s3
    v_add_u32 v171, s3, v170
    v_mfma_f32_16x16x32_bf16 v[20:23], v[60:63], v[92:95], v[20:23]
    s_mul_i32 s3, s79, 163840
    s_mul_i32 s4, s77, 10240
    s_add_u32 s3, s3, s4
    v_add_u32 v175, s3, v153
    v_mfma_f32_16x16x32_bf16 v[28:31], v[88:91], v[72:75], v[28:31]
    buffer_load_dwordx4 v159, s[60:63], s83 offen offset:2048 lds
    s_waitcnt lgkmcnt(2)
    v_and_b32 v52, s86, v45
    v_lshlrev_b32 v53, 16, v45
    v_mfma_f32_16x16x32_bf16 v[24:27], v[68:71], v[64:67], v[24:27]
    ds_read_b128 v[64:67], v167 offset:3136
    s_mul_i32 s5, s5, 1280
    v_and_b32 v54, s86, v44
    v_lshlrev_b32 v55, 16, v44
    v_mfma_f32_16x16x32_bf16 v[16:19], v[68:71], v[92:95], v[16:19]
    s_add_u32 s22, s5, s16
    s_lshl_b32 s22, s22, 5
    v_and_b32 v56, s86, v47
    v_lshlrev_b32 v57, 16, v47
    v_mfma_f32_16x16x32_bf16 v[28:31], v[96:99], v[76:79], v[28:31]
    s_add_u32 s23, s5, s17
    s_lshl_b32 s23, s23, 5
    v_and_b32 v58, s86, v46
    v_lshlrev_b32 v59, 16, v46
    v_mfma_f32_16x16x32_bf16 v[12:15], v[60:63], v[84:87], v[12:15]
    s_add_u32 s83, s83, 9216
    buffer_load_dwordx4 v159, s[56:59], s83 offen offset:1024 lds
    v_mul_f32 v52, s34, v52
    v_mul_f32 v53, s34, v53
    v_mfma_f32_16x16x32_bf16 v[24:27], v[88:91], v[92:95], v[24:27]
    s_add_u32 s24, s5, s44
    s_lshl_b32 s24, s24, 5
    v_mul_f32 v54, s34, v54
    v_mul_f32 v55, s34, v55
    v_mfma_f32_16x16x32_bf16 v[8:11], v[60:63], v[100:103], v[8:11]
    s_add_u32 s5, s77, 1
    s_and_b32 s5, s5, 3
    v_mul_f32 v56, s34, v56
    v_mul_f32 v57, s34, v57
    v_mfma_f32_16x16x32_bf16 v[20:23], v[88:91], v[76:79], v[20:23]
    s_mul_i32 s5, s5, 1280
    s_add_u32 s25, s5, s16
    v_mul_f32 v58, s34, v58
    v_mul_f32 v59, s34, v59
    v_mfma_f32_16x16x32_bf16 v[12:15], v[88:91], v[100:103], v[12:15]
    buffer_load_dwordx4 v159, s[60:63], s83 offen offset:3072 lds
    s_lshl_b32 s25, s25, 5
    v_cvt_pk_bf16_f32 v52, 0, v52
    v_cvt_pk_bf16_f32 v53, 0, v53
    v_mfma_f32_16x16x32_bf16 v[24:27], v[60:63], v[72:75], v[24:27]
    ds_read_b128 v[72:75], v167 offset:2624
    s_add_u32 s26, s5, s17
    v_cvt_pk_bf16_f32 v54, 0, v54
    v_cvt_pk_bf16_f32 v55, 0, v55
    v_mfma_f32_16x16x32_bf16 v[24:27], v[104:107], v[76:79], v[24:27]
    ds_read_b128 v[76:79], v167 offset:1600
    s_lshl_b32 s26, s26, 5
    v_cvt_pk_bf16_f32 v56, 0, v56
    v_cvt_pk_bf16_f32 v57, 0, v57
    v_mfma_f32_16x16x32_bf16 v[4:7], v[60:63], v[108:111], v[4:7]
    ds_read2_b32 v[60:61], v166 offset0:160 offset1:161
    ds_read2_b32 v[62:63], v166 offset0:162 offset1:163
    v_cvt_pk_bf16_f32 v58, 0, v58
    v_cvt_pk_bf16_f32 v59, 0, v59
    v_mfma_f32_16x16x32_bf16 v[4:7], v[68:71], v[100:103], v[4:7]
    s_lshl_b32 m0, s77, 12
    s_add_u32 m0, m0, 55296
    s_add_u32 s83, s44, 40960
    buffer_load_dwordx4 v159, s[56:59], s83 offen offset:0 lds
    v_mfma_f32_16x16x32_bf16 v[0:3], v[68:71], v[108:111], v[0:3]
    ds_read2_b32 v[68:69], v166 offset0:32 offset1:33
    ds_read2_b32 v[70:71], v166 offset0:34 offset1:35
    s_waitcnt lgkmcnt(7)
    v_and_b32 v32, s86, v49
    v_lshlrev_b32 v33, 16, v49
    v_mfma_f32_16x16x32_bf16 v[28:31], v[112:115], v[84:87], v[28:31]
    s_add_u32 s27, s5, s44
    s_lshl_b32 s27, s27, 5
    v_and_b32 v34, s86, v48
    v_lshlrev_b32 v35, 16, v48
    v_mfma_f32_16x16x32_bf16 v[28:31], v[116:119], v[100:103], v[28:31]
    s_add_u32 s5, s77, 2
    s_and_b32 s5, s5, 3
    v_and_b32 v36, s86, v51
    v_lshlrev_b32 v37, 16, v51
    v_mfma_f32_16x16x32_bf16 v[24:27], v[96:99], v[84:87], v[24:27]
    buffer_load_dwordx4 v159, s[60:63], s83 offen offset:2048 lds
    v_and_b32 v38, s86, v50
    v_lshlrev_b32 v39, 16, v50
    v_mfma_f32_16x16x32_bf16 v[20:23], v[104:107], v[84:87], v[20:23]
    ds_read_b128 v[84:87], v167 offset:1088
    ds_read_b128 v[176:179], v156 offset:0
    v_mul_f32 v32, s34, v32
    v_mul_f32 v33, s34, v33
    v_mfma_f32_16x16x32_bf16 v[8:11], v[88:91], v[108:111], v[8:11]
    ds_read2_b32 v[88:89], v255 offset0:32 offset1:33
    ds_read2_b32 v[90:91], v255 offset0:34 offset1:35
    ds_read_b128 v[180:183], v157 offset:0
    v_mul_f32 v34, s34, v34
    v_mul_f32 v35, s34, v35
    v_mfma_f32_16x16x32_bf16 v[28:31], v[104:107], v[92:95], v[28:31]
    ds_read_b128 v[92:95], v167 offset:2112
    ds_read_b128 v[184:187], v156 offset:512
    v_mul_f32 v36, s34, v36
    v_mul_f32 v37, s34, v37
    v_mfma_f32_16x16x32_bf16 v[20:23], v[112:115], v[108:111], v[20:23]
    s_add_u32 s83, s83, 9216
    buffer_load_dwordx4 v159, s[56:59], s83 offen offset:1024 lds
    ds_read_b128 v[188:191], v157 offset:512
    v_mul_f32 v38, s34, v38
    v_mul_f32 v39, s34, v39
    v_mfma_f32_16x16x32_bf16 v[16:19], v[96:99], v[108:111], v[16:19]
    s_mul_i32 s5, s5, 1280
    s_add_u32 s28, s5, s16
    global_load_dword v169, v173, s[50:51] sc1
    v_cvt_pk_bf16_f32 v32, 0, v32
    v_cvt_pk_bf16_f32 v33, 0, v33
    v_mfma_f32_16x16x32_bf16 v[24:27], v[116:119], v[108:111], v[24:27]
    ds_read2_b32 v[116:117], v131 offset0:32 offset1:33
    ds_read2_b32 v[118:119], v131 offset0:34 offset1:35
    v_cvt_pk_bf16_f32 v34, 0, v34
    v_cvt_pk_bf16_f32 v35, 0, v35
    v_mfma_f32_16x16x32_bf16 v[20:23], v[96:99], v[100:103], v[20:23]
    ds_read2_b32 v[96:97], v130 offset0:32 offset1:33
    ds_read2_b32 v[98:99], v130 offset0:34 offset1:35
    v_cvt_pk_bf16_f32 v36, 0, v36
    v_cvt_pk_bf16_f32 v37, 0, v37
    v_mfma_f32_16x16x32_bf16 v[16:19], v[104:107], v[100:103], v[16:19]
    buffer_load_dwordx4 v159, s[60:63], s83 offen offset:3072 lds
    s_lshl_b32 s28, s28, 5
    v_cvt_pk_bf16_f32 v38, 0, v38
    v_cvt_pk_bf16_f32 v39, 0, v39
    v_mfma_f32_16x16x32_bf16 v[12:15], v[104:107], v[108:111], v[12:15]
    ds_read2_b32 v[104:105], v255 offset0:160 offset1:161
    ds_read2_b32 v[106:107], v255 offset0:162 offset1:163
    v_mfma_f32_16x16x32_bf16 v[24:27], v[112:115], v[100:103], v[24:27]
    ds_read2_b32 v[112:113], v130 offset0:160 offset1:161
    ds_read2_b32 v[114:115], v130 offset0:162 offset1:163
    ds_read_b128 v[100:103], v167 offset:576
    v_mfma_f32_16x16x32_bf16 v[28:31], v[120:123], v[108:111], v[28:31]
    ds_read2_b32 v[120:121], v131 offset0:160 offset1:161
    ds_read2_b32 v[122:123], v131 offset0:162 offset1:163
    ds_read_b128 v[108:111], v167 offset:64
    s_waitcnt lgkmcnt(15)
    v_mfma_f32_16x16x32_bf16 v[28:31], v[60:63], v[64:67], v[28:31]
    s_waitcnt lgkmcnt(12)
    s_add_u32 m0, s84, 0
    s_add_u32 s83, s16, 0
    buffer_load_dwordx4 v158, s[56:59], s83 offen offset:0 lds
    v_mfma_f32_16x16x32_bf16 v[20:23], v[68:71], v[72:75], v[20:23]
    s_add_u32 s29, s5, s17
    s_lshl_b32 s29, s29, 5
    v_mfma_f32_16x16x32_bf16 v[16:19], v[60:63], v[76:79], v[16:19]
    s_add_u32 s30, s5, s44
    s_lshl_b32 s30, s30, 5
    v_mfma_f32_16x16x32_bf16 v[12:15], v[68:71], v[76:79], v[12:15]
    s_add_u32 s5, s77, 3
    s_and_b32 s5, s5, 3
    v_mfma_f32_16x16x32_bf16 v[28:31], v[68:71], v[80:83], v[28:31]
    ds_read_b128 v[80:83], v167 offset:3584
    buffer_load_dwordx4 v158, s[60:63], s83 offen offset:2048 lds
    s_waitcnt vmcnt(17)
    v_mfma_f32_16x16x32_bf16 v[8:11], v[68:71], v[84:87], v[8:11]
    ds_read_b128 v[192:195], v156 offset:8192
    s_mul_i32 s5, s5, 1280
    v_mfma_f32_16x16x32_bf16 v[16:19], v[88:91], v[84:87], v[16:19]
    ds_read_b128 v[196:199], v157 offset:8192
    s_add_u32 s31, s5, s16
    v_mfma_f32_16x16x32_bf16 v[20:23], v[60:63], v[92:95], v[20:23]
    ds_read_b128 v[200:203], v156 offset:8704
    s_lshl_b32 s31, s31, 5
    v_mfma_f32_16x16x32_bf16 v[28:31], v[88:91], v[72:75], v[28:31]
    s_add_u32 s83, s83, 9216
    buffer_load_dwordx4 v158, s[56:59], s83 offen offset:1024 lds
    ds_read_b128 v[204:207], v157 offset:8704
    v_mfma_f32_16x16x32_bf16 v[24:27], v[68:71], v[64:67], v[24:27]
    ds_read_b128 v[64:67], v167 offset:3072
    s_add_u32 s32, s5, s17
    v_mfma_f32_16x16x32_bf16 v[16:19], v[68:71], v[92:95], v[16:19]
    s_lshl_b32 s32, s32, 5
    s_add_u32 s33, s5, s44
    s_waitcnt lgkmcnt(14)
    v_mfma_f32_16x16x32_bf16 v[28:31], v[96:99], v[76:79], v[28:31]
    s_lshl_b32 s33, s33, 5
    v_mfma_f32_16x16x32_bf16 v[12:15], v[60:63], v[84:87], v[12:15]
    buffer_load_dwordx4 v158, s[60:63], s83 offen offset:3072 lds
    v_mfma_f32_16x16x32_bf16 v[24:27], v[88:91], v[92:95], v[24:27]
    s_getpc_b64 s[4:5]
L_pc2:
    s_lshr_b32 s3, s2, 3
    s_lshl_b32 s3, s3, 2
    s_add_u32 s3, s3, s77
    s_lshl_b32 s3, s3, 8
    v_and_b32 v168, 1, v152
    v_lshl_add_u32 v168, v168, 7, s3
    v_min_u32 v168, L_last-L_pc2, v168
    global_load_dword v168, v168, s[4:5]
    s_waitcnt lgkmcnt(9)
    v_mfma_f32_16x16x32_bf16 v[8:11], v[60:63], v[100:103], v[8:11]
    v_mfma_f32_16x16x32_bf16 v[20:23], v[88:91], v[76:79], v[20:23]
    v_mfma_f32_16x16x32_bf16 v[12:15], v[88:91], v[100:103], v[12:15]
    s_waitcnt lgkmcnt(1)
    s_add_u32 m0, s84, 8192
    s_add_u32 s83, s16, 40960
    buffer_load_dwordx4 v158, s[56:59], s83 offen offset:0 lds
    v_mfma_f32_16x16x32_bf16 v[24:27], v[60:63], v[72:75], v[24:27]
    ds_read_b128 v[72:75], v167 offset:2560
    v_mfma_f32_16x16x32_bf16 v[24:27], v[104:107], v[76:79], v[24:27]
    ds_read_b128 v[76:79], v167 offset:1536
    v_mfma_f32_16x16x32_bf16 v[4:7], v[60:63], v[108:111], v[4:7]
    ds_read2_b32 v[60:61], v166 offset0:176 offset1:177
    ds_read2_b32 v[62:63], v166 offset0:178 offset1:179
    v_mfma_f32_16x16x32_bf16 v[4:7], v[68:71], v[100:103], v[4:7]
    buffer_load_dwordx4 v158, s[60:63], s83 offen offset:2048 lds
    v_mfma_f32_16x16x32_bf16 v[0:3], v[68:71], v[108:111], v[0:3]
    ds_read2_b32 v[68:69], v166 offset0:48 offset1:49
    ds_read2_b32 v[70:71], v166 offset0:50 offset1:51
    v_mfma_f32_16x16x32_bf16 v[28:31], v[112:115], v[84:87], v[28:31]
    v_mfma_f32_16x16x32_bf16 v[28:31], v[116:119], v[100:103], v[28:31]
    v_mfma_f32_16x16x32_bf16 v[24:27], v[96:99], v[84:87], v[24:27]
    s_add_u32 s83, s83, 9216
    buffer_load_dwordx4 v158, s[56:59], s83 offen offset:1024 lds
    v_mfma_f32_16x16x32_bf16 v[20:23], v[104:107], v[84:87], v[20:23]
    ds_read_b128 v[84:87], v167 offset:1024
    v_mfma_f32_16x16x32_bf16 v[8:11], v[88:91], v[108:111], v[8:11]
    ds_read2_b32 v[88:89], v255 offset0:48 offset1:49
    ds_read2_b32 v[90:91], v255 offset0:50 offset1:51
    v_mfma_f32_16x16x32_bf16 v[28:31], v[104:107], v[92:95], v[28:31]
    ds_read_b128 v[92:95], v167 offset:2048
    v_mfma_f32_16x16x32_bf16 v[20:23], v[112:115], v[108:111], v[20:23]
    buffer_load_dwordx4 v158, s[60:63], s83 offen offset:3072 lds
    v_mfma_f32_16x16x32_bf16 v[16:19], v[96:99], v[108:111], v[16:19]
    v_mfma_f32_16x16x32_bf16 v[24:27], v[116:119], v[108:111], v[24:27]
    ds_read2_b32 v[116:117], v131 offset0:48 offset1:49
    ds_read2_b32 v[118:119], v131 offset0:50 offset1:51
    v_mfma_f32_16x16x32_bf16 v[20:23], v[96:99], v[100:103], v[20:23]
    ds_read2_b32 v[96:97], v130 offset0:48 offset1:49
    ds_read2_b32 v[98:99], v130 offset0:50 offset1:51
    v_mfma_f32_16x16x32_bf16 v[16:19], v[104:107], v[100:103], v[16:19]
    v_mfma_f32_16x16x32_bf16 v[12:15], v[104:107], v[108:111], v[12:15]
    ds_read2_b32 v[104:105], v255 offset0:176 offset1:177
    ds_read2_b32 v[106:107], v255 offset0:178 offset1:179
    v_mfma_f32_16x16x32_bf16 v[24:27], v[112:115], v[100:103], v[24:27]
    ds_read2_b32 v[112:113], v130 offset0:176 offset1:177
    ds_read2_b32 v[114:115], v130 offset0:178 offset1:179
    ds_read_b128 v[100:103], v167 offset:512
    v_mfma_f32_16x16x32_bf16 v[28:31], v[120:123], v[108:111], v[28:31]
    ds_read2_b32 v[120:121], v131 offset0:176 offset1:177
    ds_read2_b32 v[122:123], v131 offset0:178 offset1:179
    ds_read_b128 v[108:111], v167 offset:0
    s_cmp_lg_u32 s80, 0
    s_cbranch_scc1 Lv_15
    s_waitcnt lgkmcnt(15)
    v_mfma_f32_16x16x32_bf16 v[16:19], v[60:63], v[76:79], v[16:19]
    s_waitcnt vmcnt(19)
    v_mfma_f32_16x16x32_bf16 v[20:23], v[68:71], v[72:75], v[20:23]
    ds_read_b128 v[208:211], v156 offset:12288
    v_mfma_f32_16x16x32_bf16 v[12:15], v[68:71], v[76:79], v[12:15]
    ds_read_b128 v[212:215], v157 offset:12288
    v_mfma_f32_16x16x32_bf16 v[12:15], v[60:63], v[84:87], v[12:15]
    ds_read_b128 v[216:219], v156 offset:12800
    s_waitcnt lgkmcnt(15)
    v_mfma_f32_16x16x32_bf16 v[20:23], v[88:91], v[76:79], v[20:23]
    ds_read_b128 v[220:223], v157 offset:12800
    v_mfma_f32_16x16x32_bf16 v[20:23], v[60:63], v[92:95], v[20:23]
    v_mfma_f32_16x16x32_bf16 v[8:11], v[68:71], v[84:87], v[8:11]
    v_mfma_f32_16x16x32_bf16 v[16:19], v[88:91], v[84:87], v[16:19]
    s_waitcnt lgkmcnt(0)
    s_add_u32 m0, s84, 12288
    s_add_u32 s83, s16, 46080
    buffer_load_dwordx4 v158, s[56:59], s83 offen offset:0 lds
    v_mfma_f32_16x16x32_bf16 v[16:19], v[68:71], v[92:95], v[16:19]
    v_mfma_f32_16x16x32_bf16 v[20:23], v[104:107], v[84:87], v[20:23]
    v_mfma_f32_16x16x32_bf16 v[20:23], v[96:99], v[100:103], v[20:23]
    v_mfma_f32_16x16x32_bf16 v[16:19], v[104:107], v[100:103], v[16:19]
    buffer_load_dwordx4 v158, s[60:63], s83 offen offset:2048 lds
    s_waitcnt vmcnt(16)
    v_mfma_f32_16x16x32_bf16 v[8:11], v[60:63], v[100:103], v[8:11]
    ds_read_b128 v[224:227], v156 offset:4096
    s_waitcnt vmcnt(12)
L_fh0:
    v_cmp_ne_u32 vcc, s82, v169
    s_cbranch_vccnz L_fh_re0
    v_mfma_f32_16x16x32_bf16 v[16:19], v[96:99], v[108:111], v[16:19]
    ds_read_b128 v[232:235], v156 offset:4608
    v_mfma_f32_16x16x32_bf16 v[12:15], v[88:91], v[100:103], v[12:15]
    ds_read_b128 v[228:231], v157 offset:4096
    buffer_load_dwordx4 v[40:43], v175, s[64:67], s23 offen offset:0 sc1
    v_mfma_f32_16x16x32_bf16 v[8:11], v[88:91], v[108:111], v[8:11]
    s_add_u32 s83, s83, 9216
    buffer_load_dwordx4 v158, s[56:59], s83 offen offset:1024 lds
    ds_read_b128 v[236:239], v157 offset:4608
    v_mfma_f32_16x16x32_bf16 v[12:15], v[104:107], v[108:111], v[12:15]
    ds_write_b128 v170, v[16:19] offset:2048
    buffer_load_dwordx4 v[44:47], v175, s[64:67], s23 offen offset:1024 sc1
    v_mfma_f32_16x16x32_bf16 v[20:23], v[112:115], v[108:111], v[20:23]
    v_mfma_f32_16x16x32_bf16 v[28:31], v[120:123], v[108:111], v[28:31]
    ds_write_b128 v170, v[8:11] offset:0
    buffer_load_dwordx4 v[48:51], v175, s[64:67], s23 offen offset:2048 sc1
    v_mfma_f32_16x16x32_bf16 v[28:31], v[68:71], v[80:83], v[28:31]
    s_nop 0
    ds_write_b128 v170, v[12:15] offset:1024
    buffer_load_dwordx4 v158, s[60:63], s83 offen offset:3072 lds
    v_mfma_f32_16x16x32_bf16 v[24:27], v[116:119], v[108:111], v[24:27]
    ds_write_b128 v170, v[20:23] offset:3072
    buffer_load_dwordx4 v[120:123], v175, s[64:67], s22 offen offset:0 sc1
    v_mfma_f32_16x16x32_bf16 v[28:31], v[116:119], v[100:103], v[28:31]
    v_mfma_f32_16x16x32_bf16 v[24:27], v[68:71], v[64:67], v[24:27]
    v_mfma_f32_16x16x32_bf16 v[28:31], v[60:63], v[64:67], v[28:31]
    s_waitcnt lgkmcnt(4)
    s_add_u32 m0, s84, 4096
    s_add_u32 s83, s16, 5120
    buffer_load_dwordx4 v158, s[56:59], s83 offen offset:0 lds
    buffer_load_dwordx4 v[80:83], v175, s[64:67], s25 offen offset:0 sc1
    v_mfma_f32_16x16x32_bf16 v[0:3], v[68:71], v[108:111], v[0:3]
    v_mfma_f32_16x16x32_bf16 v[4:7], v[68:71], v[100:103], v[4:7]
    v_mfma_f32_16x16x32_bf16 v[4:7], v[60:63], v[108:111], v[4:7]
    buffer_load_dwordx4 v[116:119], v175, s[64:67], s28 offen offset:0 sc1
    s_waitcnt lgkmcnt(0)
    s_barrier
    v_mfma_f32_16x16x32_bf16 v[24:27], v[112:115], v[100:103], v[24:27]
    ds_read_b128 v[8:11], v171 offset:0
    buffer_load_dwordx4 v158, s[60:63], s83 offen offset:2048 lds
    v_mfma_f32_16x16x32_bf16 v[24:27], v[60:63], v[72:75], v[24:27]
    ds_read_b128 v[12:15], v171 offset:1024
    v_mfma_f32_16x16x32_bf16 v[28:31], v[112:115], v[84:87], v[28:31]
    ds_read_b128 v[16:19], v171 offset:2048
    buffer_load_dwordx4 v[64:67], v175, s[64:67], s31 offen offset:0 sc1
    v_mfma_f32_16x16x32_bf16 v[28:31], v[88:91], v[72:75], v[28:31]
    ds_read_b128 v[20:23], v171 offset:3072
    v_mfma_f32_16x16x32_bf16 v[24:27], v[96:99], v[84:87], v[24:27]
    s_add_u32 s83, s83, 9216
    buffer_load_dwordx4 v158, s[56:59], s83 offen offset:1024 lds
    v_mfma_f32_16x16x32_bf16 v[24:27], v[88:91], v[92:95], v[24:27]
    v_mfma_f32_16x16x32_bf16 v[24:27], v[104:107], v[76:79], v[24:27]
    v_mfma_f32_16x16x32_bf16 v[28:31], v[96:99], v[76:79], v[28:31]
    v_mfma_f32_16x16x32_bf16 v[28:31], v[104:107], v[92:95], v[28:31]
    buffer_load_dwordx4 v158, s[60:63], s83 offen offset:3072 lds
    s_branch Lw_16
Lv_15:
    s_waitcnt lgkmcnt(15)
    v_mfma_f32_16x16x32_bf16 v[24:27], v[68:71], v[64:67], v[24:27]
    s_waitcnt vmcnt(19)
    v_mfma_f32_16x16x32_bf16 v[28:31], v[60:63], v[64:67], v[28:31]
    ds_read_b128 v[208:211], v156 offset:12288
    v_mfma_f32_16x16x32_bf16 v[24:27], v[60:63], v[72:75], v[24:27]
    ds_read_b128 v[212:215], v157 offset:12288
    v_mfma_f32_16x16x32_bf16 v[28:31], v[68:71], v[80:83], v[28:31]
    ds_read_b128 v[216:219], v156 offset:12800
    s_waitcnt lgkmcnt(15)
    v_mfma_f32_16x16x32_bf16 v[28:31], v[88:91], v[72:75], v[28:31]
    ds_read_b128 v[220:223], v157 offset:12800
    v_mfma_f32_16x16x32_bf16 v[24:27], v[88:91], v[92:95], v[24:27]
    s_waitcnt lgkmcnt(12)
    v_mfma_f32_16x16x32_bf16 v[28:31], v[96:99], v[76:79], v[28:31]
    v_mfma_f32_16x16x32_bf16 v[24:27], v[96:99], v[84:87], v[24:27]
    s_waitcnt lgkmcnt(0)
    s_add_u32 m0, s84, 12288
    s_add_u32 s83, s16, 46080
    buffer_load_dwordx4 v158, s[56:59], s83 offen offset:0 lds
    v_mfma_f32_16x16x32_bf16 v[24:27], v[104:107], v[76:79], v[24:27]
    v_mfma_f32_16x16x32_bf16 v[28:31], v[104:107], v[92:95], v[28:31]
    v_mfma_f32_16x16x32_bf16 v[4:7], v[68:71], v[100:103], v[4:7]
    v_mfma_f32_16x16x32_bf16 v[28:31], v[116:119], v[100:103], v[28:31]
    buffer_load_dwordx4 v158, s[60:63], s83 offen offset:2048 lds
    s_waitcnt vmcnt(16)
    v_mfma_f32_16x16x32_bf16 v[4:7], v[60:63], v[108:111], v[4:7]
    ds_read_b128 v[224:227], v156 offset:4096
    s_waitcnt vmcnt(12)
L_fh1:
    v_cmp_ne_u32 vcc, s82, v169
    s_cbranch_vccnz L_fh_re1
    v_mfma_f32_16x16x32_bf16 v[0:3], v[68:71], v[108:111], v[0:3]
    ds_read_b128 v[232:235], v156 offset:4608
    v_mfma_f32_16x16x32_bf16 v[24:27], v[112:115], v[100:103], v[24:27]
    ds_read_b128 v[228:231], v157 offset:4096
    buffer_load_dwordx4 v[40:43], v175, s[64:67], s23 offen offset:0 sc1
    v_mfma_f32_16x16x32_bf16 v[24:27], v[116:119], v[108:111], v[24:27]
    ds_write_b128 v170, v[4:7] offset:1024
    s_add_u32 s83, s83, 9216
    buffer_load_dwordx4 v158, s[56:59], s83 offen offset:1024 lds
    ds_read_b128 v[236:239], v157 offset:4608
    v_mfma_f32_16x16x32_bf16 v[28:31], v[120:123], v[108:111], v[28:31]
    ds_write_b128 v170, v[0:3] offset:0
    buffer_load_dwordx4 v[44:47], v175, s[64:67], s23 offen offset:1024 sc1
    v_mfma_f32_16x16x32_bf16 v[28:31], v[112:115], v[84:87], v[28:31]
    v_mfma_f32_16x16x32_bf16 v[12:15], v[60:63], v[84:87], v[12:15]
    ds_write_b128 v170, v[24:27] offset:2048
    buffer_load_dwordx4 v[48:51], v175, s[64:67], s23 offen offset:2048 sc1
    v_mfma_f32_16x16x32_bf16 v[12:15], v[88:91], v[100:103], v[12:15]
    buffer_load_dwordx4 v158, s[60:63], s83 offen offset:3072 lds
    v_mfma_f32_16x16x32_bf16 v[12:15], v[104:107], v[108:111], v[12:15]
    s_nop 1
    ds_write_b128 v170, v[28:31] offset:3072
    buffer_load_dwordx4 v[120:123], v175, s[64:67], s22 offen offset:0 sc1
    v_mfma_f32_16x16x32_bf16 v[8:11], v[88:91], v[108:111], v[8:11]
    v_mfma_f32_16x16x32_bf16 v[8:11], v[68:71], v[84:87], v[8:11]
    v_mfma_f32_16x16x32_bf16 v[12:15], v[68:71], v[76:79], v[12:15]
    s_waitcnt lgkmcnt(3)
    s_add_u32 m0, s84, 4096
    s_add_u32 s83, s16, 5120
    buffer_load_dwordx4 v158, s[56:59], s83 offen offset:0 lds
    buffer_load_dwordx4 v[80:83], v175, s[64:67], s25 offen offset:0 sc1
    v_mfma_f32_16x16x32_bf16 v[8:11], v[60:63], v[100:103], v[8:11]
    v_mfma_f32_16x16x32_bf16 v[16:19], v[96:99], v[108:111], v[16:19]
    v_mfma_f32_16x16x32_bf16 v[16:19], v[68:71], v[92:95], v[16:19]
    buffer_load_dwordx4 v[116:119], v175, s[64:67], s28 offen offset:0 sc1
    s_waitcnt lgkmcnt(0)
    s_barrier
    v_mfma_f32_16x16x32_bf16 v[20:23], v[104:107], v[84:87], v[20:23]
    ds_read_b128 v[0:3], v171 offset:0
    buffer_load_dwordx4 v158, s[60:63], s83 offen offset:2048 lds
    v_mfma_f32_16x16x32_bf16 v[20:23], v[88:91], v[76:79], v[20:23]
    ds_read_b128 v[4:7], v171 offset:1024
    v_mfma_f32_16x16x32_bf16 v[20:23], v[60:63], v[92:95], v[20:23]
    ds_read_b128 v[24:27], v171 offset:2048
    buffer_load_dwordx4 v[64:67], v175, s[64:67], s31 offen offset:0 sc1
    v_mfma_f32_16x16x32_bf16 v[16:19], v[104:107], v[100:103], v[16:19]
    ds_read_b128 v[28:31], v171 offset:3072
    v_mfma_f32_16x16x32_bf16 v[16:19], v[60:63], v[76:79], v[16:19]
    s_add_u32 s83, s83, 9216
    buffer_load_dwordx4 v158, s[56:59], s83 offen offset:1024 lds
    v_mfma_f32_16x16x32_bf16 v[20:23], v[68:71], v[72:75], v[20:23]
    v_mfma_f32_16x16x32_bf16 v[16:19], v[88:91], v[84:87], v[16:19]
    v_mfma_f32_16x16x32_bf16 v[20:23], v[112:115], v[108:111], v[20:23]
    v_mfma_f32_16x16x32_bf16 v[20:23], v[96:99], v[100:103], v[20:23]
    buffer_load_dwordx4 v158, s[60:63], s83 offen offset:3072 lds
Lw_16:
    s_waitcnt vmcnt(12)
    v_mfma_f32_16x16x32_bf16 v[132:135], a[232:235], v[40:43], v[132:135]
    s_waitcnt lgkmcnt(2)
    v_add_f32 v0, v0, v8
    v_add_f32 v1, v1, v9
    v_mfma_f32_16x16x32_bf16 v[136:139], v[176:179], v[40:43], v[136:139]
    v_add_f32 v2, v2, v10
    v_add_f32 v3, v3, v11
    v_mfma_f32_16x16x32_bf16 v[140:143], v[192:195], v[40:43], v[140:143]
    buffer_load_dwordx4 v[60:63], v175, s[64:67], s22 offen offset:1024 sc1
    v_add_f32 v4, v4, v12
    v_add_f32 v5, v5, v13
    v_mfma_f32_16x16x32_bf16 v[144:147], v[208:211], v[40:43], v[144:147]
    v_add_f32 v6, v6, v14
    v_add_f32 v7, v7, v15
    v_mfma_f32_16x16x32_bf16 v[148:151], a[216:219], v[40:43], v[148:151]
    v_cvt_pk_bf16_f32 v0, 0, v0
    v_cvt_pk_bf16_f32 v1, 0, v1
    s_waitcnt vmcnt(11)
    v_mfma_f32_16x16x32_bf16 v[132:135], a[236:239], v[44:47], v[132:135]
    v_cvt_pk_bf16_f32 v2, 0, v2
    v_cvt_pk_bf16_f32 v3, 0, v3
    v_mfma_f32_16x16x32_bf16 v[136:139], v[180:183], v[44:47], v[136:139]
    buffer_load_dwordx4 v[68:71], v175, s[64:67], s25 offen offset:1024 sc1
    v_cvt_pk_bf16_f32 v4, 0, v4
    v_cvt_pk_bf16_f32 v5, 0, v5
    v_mfma_f32_16x16x32_bf16 v[140:143], v[196:199], v[44:47], v[140:143]
    v_cvt_pk_bf16_f32 v6, 0, v6
    v_cvt_pk_bf16_f32 v7, 0, v7
    v_mfma_f32_16x16x32_bf16 v[144:147], v[212:215], v[44:47], v[144:147]
    ds_read_b128 v[124:127], v156 offset:0
    v_add_f32 v0, v0, v52
    v_add_f32 v1, v1, v53
    v_mfma_f32_16x16x32_bf16 v[148:151], a[220:223], v[44:47], v[148:151]
    v_add_f32 v2, v2, v54
    v_add_f32 v3, v3, v55
    s_waitcnt vmcnt(11)
    v_mfma_f32_16x16x32_bf16 v[132:135], a[240:243], v[48:51], v[132:135]
    buffer_load_dwordx4 v[72:75], v175, s[64:67], s28 offen offset:1024 sc1
    v_add_f32 v4, v4, v56
    v_add_f32 v5, v5, v57
    v_mfma_f32_16x16x32_bf16 v[136:139], v[184:187], v[48:51], v[136:139]
    v_add_f32 v6, v6, v58
    v_add_f32 v7, v7, v59
    v_mfma_f32_16x16x32_bf16 v[140:143], v[200:203], v[48:51], v[140:143]
    ds_read_b128 v[128:131], v156 offset:8192
    v_cvt_pk_bf16_f32 v170, v0, v1
    v_cvt_pk_bf16_f32 v171, v2, v3
    v_mfma_f32_16x16x32_bf16 v[144:147], v[216:219], v[48:51], v[144:147]
    v_cvt_pk_bf16_f32 v172, v4, v5
    v_cvt_pk_bf16_f32 v173, v6, v7
    v_mfma_f32_16x16x32_bf16 v[148:151], a[224:227], v[48:51], v[148:151]
    buffer_load_dwordx4 v[76:79], v175, s[64:67], s31 offen offset:1024 sc1
    v_permlane16_swap_b32 v170, v172
    s_waitcnt vmcnt(11)
    v_mfma_f32_16x16x32_bf16 v[148:151], a[200:203], v[120:123], v[148:151]
    v_permlane16_swap_b32 v171, v173
    s_waitcnt vmcnt(9)
    v_mfma_f32_16x16x32_bf16 v[40:43], a[200:203], v[80:83], 0
    ds_read_b128 v[112:115], v156 offset:12288
    v_or_b32 v170, 1, v170
    v_or_b32 v172, 1, v172
    s_waitcnt vmcnt(8)
    v_mfma_f32_16x16x32_bf16 v[44:47], a[200:203], v[116:119], 0
    s_waitcnt lgkmcnt(3)
    v_add_f32 v16, v16, v24
    v_add_f32 v17, v17, v25
    s_waitcnt vmcnt(6)
    v_mfma_f32_16x16x32_bf16 v[48:51], a[200:203], v[64:67], 0
    buffer_load_dwordx4 v[84:87], v175, s[64:67], s22 offen offset:2048 sc1
    v_add_f32 v18, v18, v26
    v_add_f32 v19, v19, v27
    s_waitcnt lgkmcnt(2)
    v_mfma_f32_16x16x32_bf16 v[132:135], v[124:127], v[120:123], v[132:135]
    v_add_f32 v20, v20, v28
    v_add_f32 v21, v21, v29
    v_mfma_f32_16x16x32_bf16 v[52:55], v[124:127], v[80:83], 0
    v_add_f32 v22, v22, v30
    v_add_f32 v23, v23, v31
    v_mfma_f32_16x16x32_bf16 v[56:59], v[124:127], v[116:119], 0
    v_cvt_pk_bf16_f32 v16, 0, v16
    v_cvt_pk_bf16_f32 v17, 0, v17
    v_mfma_f32_16x16x32_bf16 v[0:3], v[124:127], v[64:67], 0
    s_waitcnt vmcnt(5)
    ds_read_b128 v[124:127], v156 offset:4096
    buffer_load_dwordx4 v[88:91], v175, s[64:67], s25 offen offset:2048 sc1
    v_cvt_pk_bf16_f32 v18, 0, v18
    v_cvt_pk_bf16_f32 v19, 0, v19
    s_waitcnt lgkmcnt(2)
    v_mfma_f32_16x16x32_bf16 v[140:143], v[128:131], v[120:123], v[140:143]
    v_cvt_pk_bf16_f32 v20, 0, v20
    v_cvt_pk_bf16_f32 v21, 0, v21
    v_mfma_f32_16x16x32_bf16 v[4:7], v[128:131], v[80:83], 0
    v_cvt_pk_bf16_f32 v22, 0, v22
    v_cvt_pk_bf16_f32 v23, 0, v23
    v_mfma_f32_16x16x32_bf16 v[8:11], v[128:131], v[116:119], 0
    v_add_f32 v16, v16, v32
    v_add_f32 v17, v17, v33
    v_mfma_f32_16x16x32_bf16 v[12:15], v[128:131], v[64:67], 0
    ds_read_b128 v[128:131], v157 offset:0
    buffer_load_dwordx4 v[92:95], v175, s[64:67], s28 offen offset:2048 sc1
    v_add_f32 v18, v18, v34
    v_add_f32 v19, v19, v35
    s_waitcnt lgkmcnt(2)
    v_mfma_f32_16x16x32_bf16 v[144:147], v[112:115], v[120:123], v[144:147]
    v_add_f32 v20, v20, v36
    v_add_f32 v21, v21, v37
    v_mfma_f32_16x16x32_bf16 v[28:31], v[112:115], v[80:83], 0
    v_add_f32 v22, v22, v38
    v_add_f32 v23, v23, v39
    v_mfma_f32_16x16x32_bf16 v[32:35], v[112:115], v[116:119], 0
    v_cvt_pk_bf16_f32 v166, v16, v17
    v_cvt_pk_bf16_f32 v167, v18, v19
    v_mfma_f32_16x16x32_bf16 v[36:39], v[112:115], v[64:67], 0
    ds_read_b128 v[112:115], v157 offset:8192
    buffer_load_dwordx4 v[96:99], v175, s[64:67], s31 offen offset:2048 sc1
    v_cvt_pk_bf16_f32 v168, v20, v21
    v_cvt_pk_bf16_f32 v169, v22, v23
    s_waitcnt lgkmcnt(2)
    v_mfma_f32_16x16x32_bf16 v[136:139], v[124:127], v[120:123], v[136:139]
    v_permlane16_swap_b32 v166, v168
    v_mfma_f32_16x16x32_bf16 v[16:19], v[124:127], v[80:83], 0
    v_permlane16_swap_b32 v167, v169
    v_mfma_f32_16x16x32_bf16 v[20:23], v[124:127], v[116:119], 0
    v_or_b32 v166, 1, v166
    v_or_b32 v168, 1, v168
    v_mfma_f32_16x16x32_bf16 v[24:27], v[124:127], v[64:67], 0
    ds_read_b128 v[124:127], v157 offset:12288
    buffer_load_dwordx4 v[100:103], v175, s[64:67], s22 offen offset:3072 sc1
    s_waitcnt vmcnt(8)
    v_mfma_f32_16x16x32_bf16 v[148:151], a[204:207], v[60:63], v[148:151]
    s_waitcnt vmcnt(7)
    v_mfma_f32_16x16x32_bf16 v[40:43], a[204:207], v[68:71], v[40:43]
    buffer_store_dwordx4 v[170:173], v164, s[68:71], s38 offen sc1
    buffer_store_dwordx4 v[166:169], v164, s[68:71], s39 offen sc1
    s_waitcnt vmcnt(8)
    v_mfma_f32_16x16x32_bf16 v[44:47], a[204:207], v[72:75], v[44:47]
    s_waitcnt vmcnt(7)
    v_mfma_f32_16x16x32_bf16 v[48:51], a[204:207], v[76:79], v[48:51]
    buffer_load_dwordx4 v[104:107], v175, s[64:67], s25 offen offset:3072 sc1
    s_waitcnt lgkmcnt(2)
    v_mfma_f32_16x16x32_bf16 v[132:135], v[128:131], v[60:63], v[132:135]
    s_movk_i32 s9, 0x70
    v_lshrrev_b32 v164, 3, v152
    v_lshlrev_b32 v164, 12, v164
    v_mfma_f32_16x16x32_bf16 v[52:55], v[128:131], v[68:71], v[52:55]
    v_and_or_b32 v164, v153, s9, v164
    v_mfma_f32_16x16x32_bf16 v[56:59], v[128:131], v[72:75], v[56:59]
    s_mul_i32 s6, s78, 327680
    s_lshl_b32 s5, s79, 7
    s_add_u32 s6, s6, s5
    v_mfma_f32_16x16x32_bf16 v[0:3], v[128:131], v[76:79], v[0:3]
    ds_read_b128 v[128:131], v157 offset:4096
    buffer_load_dwordx4 v[108:111], v175, s[64:67], s28 offen offset:3072 sc1
    s_lshl_b32 s5, s77, 14
    s_waitcnt lgkmcnt(2)
    v_mfma_f32_16x16x32_bf16 v[140:143], v[112:115], v[60:63], v[140:143]
    s_add_u32 s7, s6, s5
    s_add_u32 s7, s7, 262144
    s_lshl_b32 s5, s77, 16
    v_mfma_f32_16x16x32_bf16 v[4:7], v[112:115], v[68:71], v[4:7]
    s_add_u32 s6, s6, s5
    s_cmp_ge_u32 s6, 2097152
    s_cselect_b32 s5, 3145728, 0
    v_mfma_f32_16x16x32_bf16 v[8:11], v[112:115], v[72:75], v[8:11]
    s_add_u32 s6, s6, s5
    s_cmp_ge_u32 s7, 2097152
    s_cselect_b32 s5, 3145728, 0
    v_mfma_f32_16x16x32_bf16 v[12:15], v[112:115], v[76:79], v[12:15]
    ds_read_b128 v[112:115], v156 offset:512
    buffer_load_dwordx4 v[120:123], v175, s[64:67], s31 offen offset:3072 sc1
    s_add_u32 s7, s7, s5
    s_waitcnt lgkmcnt(2)
    v_mfma_f32_16x16x32_bf16 v[144:147], v[124:127], v[60:63], v[144:147]
    s_lshl_b32 s5, s77, 9
    s_mul_i32 s4, s77, 15360
    v_add_u32 v154, s4, v153
    v_and_b32 v155, 0xf0, v153
    v_mfma_f32_16x16x32_bf16 v[28:31], v[124:127], v[68:71], v[28:31]
    v_lshrrev_b32 v163, 4, v152
    v_lshl_add_u32 v163, v163, 9, v155
    v_mfma_f32_16x16x32_bf16 v[32:35], v[124:127], v[72:75], v[32:35]
    v_lshrrev_b32 v172, 5, v152
    v_lshl_add_u32 v155, v172, 3, v155
    v_mfma_f32_16x16x32_bf16 v[36:39], v[124:127], v[76:79], v[36:39]
    ds_read_b128 v[124:127], v156 offset:8704
    buffer_load_dwordx4 v[80:83], v175, s[64:67], s26 offen offset:0 sc1
    s_lshl_b32 s4, s78, 8
    v_add_u32 v155, s4, v155
    s_waitcnt lgkmcnt(2)
    v_mfma_f32_16x16x32_bf16 v[136:139], v[128:131], v[60:63], v[136:139]
    s_lshl_b32 s4, s79, 13
    s_add_u32 s4, s4, s100
    s_add_u32 s4, s4, 10485760
    v_mfma_f32_16x16x32_bf16 v[16:19], v[128:131], v[68:71], v[16:19]
    s_add_u32 s98, s50, s4
    s_addc_u32 s99, s51, 0
    s_add_u32 s4, s100, 61440
    v_lshl_add_u32 v170, v152, 3, s4
    v_mfma_f32_16x16x32_bf16 v[20:23], v[128:131], v[72:75], v[20:23]
    s_add_u32 s4, s5, 69632
    v_lshl_add_u32 v171, v152, 3, s4
    v_mfma_f32_16x16x32_bf16 v[24:27], v[128:131], v[76:79], v[24:27]
    ds_read_b128 v[128:131], v156 offset:12800
    buffer_load_dwordx4 v[116:119], v175, s[64:67], s26 offen offset:1024 sc1
    s_waitcnt vmcnt(11)
    v_mfma_f32_16x16x32_bf16 v[148:151], a[208:211], v[84:87], v[148:151]
    s_waitcnt vmcnt(10)
    v_mfma_f32_16x16x32_bf16 v[40:43], a[208:211], v[88:91], v[40:43]
    s_waitcnt vmcnt(9)
    v_mfma_f32_16x16x32_bf16 v[44:47], a[208:211], v[92:95], v[44:47]
    s_waitcnt vmcnt(8)
    v_mfma_f32_16x16x32_bf16 v[48:51], a[208:211], v[96:99], v[48:51]
    buffer_load_dwordx4 v[64:67], v175, s[64:67], s26 offen offset:2048 sc1
    s_waitcnt lgkmcnt(2)
    v_mfma_f32_16x16x32_bf16 v[132:135], v[112:115], v[84:87], v[132:135]
    v_mfma_f32_16x16x32_bf16 v[52:55], v[112:115], v[88:91], v[52:55]
    s_mul_i32 s9, s77, 12288
    s_add_u32 s9, s9, 43008
    v_subrev_u32 v166, s9, v156
    v_subrev_u32 v167, s9, v157
    v_mfma_f32_16x16x32_bf16 v[56:59], v[112:115], v[92:95], v[56:59]
    ds_read_b128 v[240:243], v166 offset:0
    ds_read_b128 v[248:251], v166 offset:512
    ds_read_b128 v[244:247], v167 offset:0
    v_mfma_f32_16x16x32_bf16 v[0:3], v[112:115], v[96:99], v[0:3]
    ds_read_b128 v[112:115], v156 offset:4608
    buffer_load_dwordx4 v[60:63], v175, s[64:67], s26 offen offset:3072 sc1
    ds_read_b128 v[252:255], v167 offset:512
    s_waitcnt lgkmcnt(6)
    v_mfma_f32_16x16x32_bf16 v[140:143], v[124:127], v[84:87], v[140:143]
    v_mfma_f32_16x16x32_bf16 v[4:7], v[124:127], v[88:91], v[4:7]
    v_mfma_f32_16x16x32_bf16 v[8:11], v[124:127], v[92:95], v[8:11]
    v_mfma_f32_16x16x32_bf16 v[12:15], v[124:127], v[96:99], v[12:15]
    ds_read_b128 v[124:127], v157 offset:512
    buffer_load_dwordx4 v[68:71], v175, s[64:67], s27 offen offset:0 sc1
    s_waitcnt lgkmcnt(6)
    v_mfma_f32_16x16x32_bf16 v[144:147], v[128:131], v[84:87], v[144:147]
    v_mfma_f32_16x16x32_bf16 v[28:31], v[128:131], v[88:91], v[28:31]
    v_mfma_f32_16x16x32_bf16 v[32:35], v[128:131], v[92:95], v[32:35]
    v_mfma_f32_16x16x32_bf16 v[36:39], v[128:131], v[96:99], v[36:39]
    ds_read_b128 v[128:131], v157 offset:8704
    buffer_load_dwordx4 v[72:75], v175, s[64:67], s27 offen offset:1024 sc1
    s_waitcnt lgkmcnt(3)
    v_mfma_f32_16x16x32_bf16 v[136:139], v[112:115], v[84:87], v[136:139]
    v_mfma_f32_16x16x32_bf16 v[16:19], v[112:115], v[88:91], v[16:19]
    v_mfma_f32_16x16x32_bf16 v[20:23], v[112:115], v[92:95], v[20:23]
    v_mfma_f32_16x16x32_bf16 v[24:27], v[112:115], v[96:99], v[24:27]
    ds_read_b128 v[112:115], v157 offset:12800
    buffer_load_dwordx4 v[76:79], v175, s[64:67], s29 offen offset:0 sc1
    s_waitcnt vmcnt(12)
    v_mfma_f32_16x16x32_bf16 v[148:151], a[212:215], v[100:103], v[148:151]
    s_waitcnt vmcnt(9)
    v_mfma_f32_16x16x32_bf16 v[40:43], a[212:215], v[104:107], v[40:43]
    s_waitcnt vmcnt(8)
    v_mfma_f32_16x16x32_bf16 v[44:47], a[212:215], v[108:111], v[44:47]
    s_waitcnt vmcnt(7)
    v_mfma_f32_16x16x32_bf16 v[48:51], a[212:215], v[120:123], v[48:51]
    buffer_load_dwordx4 v[84:87], v175, s[64:67], s29 offen offset:1024 sc1
    s_waitcnt lgkmcnt(2)
    v_mfma_f32_16x16x32_bf16 v[132:135], v[124:127], v[100:103], v[132:135]
    v_mfma_f32_16x16x32_bf16 v[52:55], v[124:127], v[104:107], v[52:55]
    v_mfma_f32_16x16x32_bf16 v[56:59], v[124:127], v[108:111], v[56:59]
    v_mfma_f32_16x16x32_bf16 v[0:3], v[124:127], v[120:123], v[0:3]
    ds_read_b128 v[124:127], v157 offset:4608
    buffer_load_dwordx4 v[88:91], v175, s[64:67], s29 offen offset:2048 sc1
    s_waitcnt lgkmcnt(2)
    v_mfma_f32_16x16x32_bf16 v[140:143], v[128:131], v[100:103], v[140:143]
    v_mfma_f32_16x16x32_bf16 v[4:7], v[128:131], v[104:107], v[4:7]
    v_mfma_f32_16x16x32_bf16 v[8:11], v[128:131], v[108:111], v[8:11]
    v_mfma_f32_16x16x32_bf16 v[12:15], v[128:131], v[120:123], v[12:15]
    buffer_load_dwordx4 v[92:95], v175, s[64:67], s29 offen offset:3072 sc1
    s_waitcnt lgkmcnt(1)
    v_mfma_f32_16x16x32_bf16 v[144:147], v[112:115], v[100:103], v[144:147]
    v_mfma_f32_16x16x32_bf16 v[28:31], v[112:115], v[104:107], v[28:31]
    s_barrier
    v_mfma_f32_16x16x32_bf16 v[32:35], v[112:115], v[108:111], v[32:35]
    v_mfma_f32_16x16x32_bf16 v[36:39], v[112:115], v[120:123], v[36:39]
    buffer_load_dwordx4 v[96:99], v175, s[64:67], s30 offen offset:0 sc1
    s_waitcnt lgkmcnt(0)
    v_mfma_f32_16x16x32_bf16 v[136:139], v[124:127], v[100:103], v[136:139]
    v_mfma_f32_16x16x32_bf16 v[16:19], v[124:127], v[104:107], v[16:19]
    v_mfma_f32_16x16x32_bf16 v[20:23], v[124:127], v[108:111], v[20:23]
    v_mfma_f32_16x16x32_bf16 v[24:27], v[124:127], v[120:123], v[24:27]
    buffer_load_dwordx4 v[100:103], v175, s[64:67], s30 offen offset:1024 sc1
    s_waitcnt vmcnt(11)
    v_mfma_f32_16x16x32_bf16 v[52:55], a[232:235], v[80:83], v[52:55]
    s_waitcnt vmcnt(10)
    v_mfma_f32_16x16x32_bf16 v[52:55], a[236:239], v[116:119], v[52:55]
    s_waitcnt vmcnt(9)
    v_mfma_f32_16x16x32_bf16 v[52:55], a[240:243], v[64:67], v[52:55]
    s_waitcnt vmcnt(8)
    v_mfma_f32_16x16x32_bf16 v[52:55], a[244:247], v[60:63], v[52:55]
    s_add_u32 s3, s77, 1
    s_and_b32 s3, s3, 3
    s_mul_i32 s3, s3, 15360
    buffer_load_dwordx4 v[104:107], v175, s[64:67], s32 offen offset:0 sc1
    v_add_u32 v165, s3, v153
    s_waitcnt vmcnt(8)
    v_mfma_f32_16x16x32_bf16 v[52:55], v[224:227], v[68:71], v[52:55]
    s_waitcnt vmcnt(7)
    v_mfma_f32_16x16x32_bf16 v[52:55], v[228:231], v[72:75], v[52:55]
    v_mfma_f32_16x16x32_bf16 v[16:19], v[176:179], v[80:83], v[16:19]
    v_mfma_f32_16x16x32_bf16 v[16:19], v[180:183], v[116:119], v[16:19]
    buffer_load_dwordx4 v[108:111], v175, s[64:67], s32 offen offset:1024 sc1
    s_mul_i32 s8, s79, 163840
    v_mov_b64 v[112:113], 0
    v_mov_b64 v[114:115], 0
    v_mfma_f32_16x16x32_bf16 v[16:19], v[184:187], v[64:67], v[16:19]
    s_nop 0
    ds_write_b128 v165, v[52:55] offset:0
    s_mul_i32 s12, s77, 20480
    v_mov_b64 v[124:125], 0
    v_mov_b64 v[126:127], 0
    v_mfma_f32_16x16x32_bf16 v[16:19], v[188:191], v[60:63], v[16:19]
    s_mul_i32 s9, s78, 2560
    s_add_u32 s9, s9, s8
    v_mov_b64 v[128:129], 0
    v_mov_b64 v[130:131], 0
    v_mfma_f32_16x16x32_bf16 v[16:19], v[232:235], v[68:71], v[16:19]
    s_lshl_b32 s85, s85, 4
    s_lshl_b32 s90, s90, 4
    v_mfma_f32_16x16x32_bf16 v[16:19], v[236:239], v[72:75], v[16:19]
    buffer_load_dwordx4 v[120:123], v175, s[64:67], s32 offen offset:2048 sc1
    s_lshl_b32 s72, s72, 4
    v_mfma_f32_16x16x32_bf16 v[4:7], v[192:195], v[80:83], v[4:7]
    s_add_u32 s72, s72, s8
    s_lshl_b32 s73, s73, 4
    v_mfma_f32_16x16x32_bf16 v[4:7], v[196:199], v[116:119], v[4:7]
    s_add_u32 s73, s73, s8
    s_lshl_b32 s74, s74, 4
    v_mfma_f32_16x16x32_bf16 v[4:7], v[200:203], v[64:67], v[4:7]
    ds_write_b128 v165, v[16:19] offset:1024
    s_add_u32 s74, s74, s8
    v_mfma_f32_16x16x32_bf16 v[4:7], v[204:207], v[60:63], v[4:7]
    s_lshl_b32 s75, s75, 4
    s_add_u32 s75, s75, s8
    v_mfma_f32_16x16x32_bf16 v[4:7], v[240:243], v[68:71], v[4:7]
    s_lshl_b32 s76, s76, 4
    s_add_u32 s76, s76, s8
    v_mfma_f32_16x16x32_bf16 v[4:7], v[244:247], v[72:75], v[4:7]
    s_lshl_b32 s8, s81, 13
    v_add_u32 v158, s8, v153
    v_xor_b32 v159, 0x2000, v158
    v_mfma_f32_16x16x32_bf16 v[28:31], v[208:211], v[80:83], v[28:31]
    v_add_u32 v173, s12, v153
    v_mfma_f32_16x16x32_bf16 v[28:31], v[212:215], v[116:119], v[28:31]
    s_add_u32 s12, s12, s9
    v_mfma_f32_16x16x32_bf16 v[28:31], v[216:219], v[64:67], v[28:31]
    ds_write_b128 v165, v[4:7] offset:2048
    v_mfma_f32_16x16x32_bf16 v[28:31], v[220:223], v[60:63], v[28:31]
    v_mfma_f32_16x16x32_bf16 v[28:31], v[248:251], v[68:71], v[28:31]
    v_mfma_f32_16x16x32_bf16 v[28:31], v[252:255], v[72:75], v[28:31]
    v_mfma_f32_16x16x32_bf16 v[40:43], a[216:219], v[80:83], v[40:43]
    buffer_load_dwordx4 v[80:83], v175, s[64:67], s32 offen offset:3072 sc1
    v_mfma_f32_16x16x32_bf16 v[40:43], a[220:223], v[116:119], v[40:43]
    v_mfma_f32_16x16x32_bf16 v[40:43], a[224:227], v[64:67], v[40:43]
    s_nop 3
    ds_write_b128 v165, v[28:31] offset:3072
    v_mfma_f32_16x16x32_bf16 v[40:43], a[228:231], v[60:63], v[40:43]
    v_mfma_f32_16x16x32_bf16 v[40:43], a[248:251], v[68:71], v[40:43]
    buffer_load_dwordx4 v[116:119], v175, s[64:67], s33 offen offset:0 sc1
    v_mfma_f32_16x16x32_bf16 v[40:43], a[252:255], v[72:75], v[40:43]
    s_waitcnt vmcnt(10)
    v_mfma_f32_16x16x32_bf16 v[56:59], a[232:235], v[76:79], v[56:59]
    s_waitcnt vmcnt(9)
    v_mfma_f32_16x16x32_bf16 v[56:59], a[236:239], v[84:87], v[56:59]
    s_waitcnt vmcnt(8)
    v_mfma_f32_16x16x32_bf16 v[56:59], a[240:243], v[88:91], v[56:59]
    s_nop 1
    ds_write_b128 v165, v[40:43] offset:4096
    buffer_load_dwordx4 v[64:67], v175, s[64:67], s33 offen offset:1024 sc1
    s_waitcnt vmcnt(8)
    v_mfma_f32_16x16x32_bf16 v[56:59], a[244:247], v[92:95], v[56:59]
    s_add_u32 s3, s77, 2
    s_and_b32 s3, s3, 3
    s_mul_i32 s3, s3, 15360
    v_add_u32 v165, s3, v153
    s_waitcnt vmcnt(7)
    v_mfma_f32_16x16x32_bf16 v[56:59], v[224:227], v[96:99], v[56:59]
    s_waitcnt vmcnt(6)
    v_mfma_f32_16x16x32_bf16 v[56:59], v[228:231], v[100:103], v[56:59]
    v_mfma_f32_16x16x32_bf16 v[20:23], v[176:179], v[76:79], v[20:23]
    buffer_load_dwordx4 v[60:63], v175, s[64:67], s23 offen offset:3072 sc1
    v_mfma_f32_16x16x32_bf16 v[20:23], v[180:183], v[84:87], v[20:23]
    v_mfma_f32_16x16x32_bf16 v[20:23], v[184:187], v[88:91], v[20:23]
    s_nop 3
    ds_write_b128 v165, v[56:59] offset:5120
    v_mfma_f32_16x16x32_bf16 v[20:23], v[188:191], v[92:95], v[20:23]
    v_mfma_f32_16x16x32_bf16 v[20:23], v[232:235], v[96:99], v[20:23]
    buffer_load_dwordx4 v[68:71], v175, s[64:67], s24 offen offset:0 sc1
    v_mfma_f32_16x16x32_bf16 v[20:23], v[236:239], v[100:103], v[20:23]
    v_mfma_f32_16x16x32_bf16 v[8:11], v[192:195], v[76:79], v[8:11]
    v_mfma_f32_16x16x32_bf16 v[8:11], v[196:199], v[84:87], v[8:11]
    v_mfma_f32_16x16x32_bf16 v[8:11], v[200:203], v[88:91], v[8:11]
    s_nop 4
    ds_write_b128 v165, v[20:23] offset:6144
    buffer_load_dwordx4 v[72:75], v175, s[64:67], s24 offen offset:1024 sc1
    v_mfma_f32_16x16x32_bf16 v[8:11], v[204:207], v[92:95], v[8:11]
    s_lshl_b32 s8, s77, 2
    s_add_u32 s8, s8, 61440
    v_bfe_u32 v172, v152, 2, 2
    v_lshl_add_u32 v166, v172, 5, s8
    v_mfma_f32_16x16x32_bf16 v[8:11], v[240:243], v[96:99], v[8:11]
    v_bfe_u32 v172, v152, 0, 1
    v_lshl_add_u32 v166, v172, 4, v166
    v_mfma_f32_16x16x32_bf16 v[8:11], v[244:247], v[100:103], v[8:11]
    v_bfe_u32 v172, v152, 1, 1
    v_lshl_add_u32 v166, v172, 1, v166
    v_mfma_f32_16x16x32_bf16 v[32:35], v[208:211], v[76:79], v[32:35]
    v_lshrrev_b32 v172, 4, v152
    v_lshl_add_u32 v167, v172, 9, v166
    v_mfma_f32_16x16x32_bf16 v[32:35], v[212:215], v[84:87], v[32:35]
    v_lshl_add_u32 v166, v172, 10, v166
    v_mfma_f32_16x16x32_bf16 v[32:35], v[216:219], v[88:91], v[32:35]
    ds_write_b128 v165, v[8:11] offset:7168
    v_mfma_f32_16x16x32_bf16 v[32:35], v[220:223], v[92:95], v[32:35]
    v_mfma_f32_16x16x32_bf16 v[32:35], v[248:251], v[96:99], v[32:35]
    v_mfma_f32_16x16x32_bf16 v[32:35], v[252:255], v[100:103], v[32:35]
    v_mfma_f32_16x16x32_bf16 v[44:47], a[216:219], v[76:79], v[44:47]
    v_mfma_f32_16x16x32_bf16 v[44:47], a[220:223], v[84:87], v[44:47]
    v_mfma_f32_16x16x32_bf16 v[44:47], a[224:227], v[88:91], v[44:47]
    s_nop 4
    ds_write_b128 v165, v[32:35] offset:8192
    v_mfma_f32_16x16x32_bf16 v[44:47], a[228:231], v[92:95], v[44:47]
    v_mfma_f32_16x16x32_bf16 v[44:47], a[248:251], v[96:99], v[44:47]
    v_mfma_f32_16x16x32_bf16 v[44:47], a[252:255], v[100:103], v[44:47]
    s_waitcnt vmcnt(8)
    v_mfma_f32_16x16x32_bf16 v[0:3], a[232:235], v[104:107], v[0:3]
    s_waitcnt vmcnt(7)
    v_mfma_f32_16x16x32_bf16 v[0:3], a[236:239], v[108:111], v[0:3]
    s_waitcnt vmcnt(6)
    v_mfma_f32_16x16x32_bf16 v[0:3], a[240:243], v[120:123], v[0:3]
    s_nop 1
    ds_write_b128 v165, v[44:47] offset:9216
    s_waitcnt vmcnt(5)
    v_mfma_f32_16x16x32_bf16 v[0:3], a[244:247], v[80:83], v[0:3]
    s_add_u32 s3, s77, 3
    s_and_b32 s3, s3, 3
    s_mul_i32 s3, s3, 15360
    v_add_u32 v165, s3, v153
    s_waitcnt vmcnt(4)
    v_mfma_f32_16x16x32_bf16 v[0:3], v[224:227], v[116:119], v[0:3]
    s_waitcnt vmcnt(3)
    v_mfma_f32_16x16x32_bf16 v[0:3], v[228:231], v[64:67], v[0:3]
    v_mfma_f32_16x16x32_bf16 v[24:27], v[176:179], v[104:107], v[24:27]
    v_mfma_f32_16x16x32_bf16 v[24:27], v[180:183], v[108:111], v[24:27]
    v_mfma_f32_16x16x32_bf16 v[24:27], v[184:187], v[120:123], v[24:27]
    s_nop 4
    ds_write_b128 v165, v[0:3] offset:10240
    v_mfma_f32_16x16x32_bf16 v[24:27], v[188:191], v[80:83], v[24:27]
    v_mfma_f32_16x16x32_bf16 v[24:27], v[232:235], v[116:119], v[24:27]
    s_add_u32 m0, s100, 61440
    s_nop 0
    buffer_load_dwordx4 v164, s[68:71], s6 offen sc1 lds
    v_mfma_f32_16x16x32_bf16 v[24:27], v[236:239], v[64:67], v[24:27]
    s_waitcnt lgkmcnt(1)
    s_barrier
    v_mfma_f32_16x16x32_bf16 v[12:15], v[192:195], v[104:107], v[12:15]
    ds_read_b128 v[52:55], v154 offset:0
    v_mfma_f32_16x16x32_bf16 v[12:15], v[196:199], v[108:111], v[12:15]
    ds_read_b128 v[16:19], v154 offset:1024
    s_add_u32 m0, s100, 62464
    s_add_u32 s83, s6, 32768
    buffer_load_dwordx4 v164, s[68:71], s83 offen sc1 lds
    v_mfma_f32_16x16x32_bf16 v[12:15], v[200:203], v[120:123], v[12:15]
    ds_read_b128 v[4:7], v154 offset:2048
    ds_write_b128 v165, v[24:27] offset:11264
    v_mfma_f32_16x16x32_bf16 v[12:15], v[204:207], v[80:83], v[12:15]
    ds_read_b128 v[28:31], v154 offset:3072
    v_mfma_f32_16x16x32_bf16 v[12:15], v[240:243], v[116:119], v[12:15]
    ds_read_b128 v[40:43], v154 offset:4096
    s_add_u32 m0, s5, 69632
    s_mov_b32 exec_hi, 0
    buffer_load_dwordx4 v164, s[68:71], s7 offen sc1 lds
    s_mov_b32 exec_hi, -1
    v_mfma_f32_16x16x32_bf16 v[12:15], v[244:247], v[64:67], v[12:15]
    ds_read_b128 v[56:59], v154 offset:5120
    v_mfma_f32_16x16x32_bf16 v[36:39], v[208:211], v[104:107], v[36:39]
    ds_read_b128 v[20:23], v154 offset:6144
    s_waitcnt lgkmcnt(7)
    v_add_f32 v132, v132, v52
    v_add_f32 v133, v133, v53
    v_mfma_f32_16x16x32_bf16 v[36:39], v[212:215], v[108:111], v[36:39]
    ds_read_b128 v[8:11], v154 offset:7168
    v_add_f32 v134, v134, v54
    v_add_f32 v135, v135, v55
    v_mfma_f32_16x16x32_bf16 v[36:39], v[216:219], v[120:123], v[36:39]
    ds_read_b128 v[32:35], v154 offset:8192
    s_waitcnt lgkmcnt(8)
    ds_write_b128 v165, v[12:15] offset:12288
    v_add_f32 v136, v136, v16
    v_add_f32 v137, v137, v17
    v_mfma_f32_16x16x32_bf16 v[36:39], v[220:223], v[80:83], v[36:39]
    ds_read_b128 v[44:47], v154 offset:9216
    v_add_f32 v138, v138, v18
    v_add_f32 v139, v139, v19
    v_mfma_f32_16x16x32_bf16 v[36:39], v[248:251], v[116:119], v[36:39]
    s_waitcnt lgkmcnt(9)
    v_add_f32 v140, v140, v4
    v_add_f32 v141, v141, v5
    v_mfma_f32_16x16x32_bf16 v[36:39], v[252:255], v[64:67], v[36:39]
    v_add_f32 v142, v142, v6
    v_add_f32 v143, v143, v7
    v_mfma_f32_16x16x32_bf16 v[48:51], a[216:219], v[104:107], v[48:51]
    s_waitcnt lgkmcnt(7)
    v_add_f32 v144, v144, v28
    v_add_f32 v145, v145, v29
    v_mfma_f32_16x16x32_bf16 v[48:51], a[220:223], v[108:111], v[48:51]
    v_add_f32 v146, v146, v30
    v_add_f32 v147, v147, v31
    v_mfma_f32_16x16x32_bf16 v[48:51], a[224:227], v[120:123], v[48:51]
    s_waitcnt lgkmcnt(6)
    ds_write_b128 v165, v[36:39] offset:13312
    v_add_f32 v148, v148, v40
    v_add_f32 v149, v149, v41
    v_mfma_f32_16x16x32_bf16 v[48:51], a[228:231], v[80:83], v[48:51]
    v_add_f32 v150, v150, v42
    v_add_f32 v151, v151, v43
    v_mfma_f32_16x16x32_bf16 v[48:51], a[248:251], v[116:119], v[48:51]
    v_mfma_f32_16x16x32_bf16 v[48:51], a[252:255], v[64:67], v[48:51]
    s_waitcnt lgkmcnt(6)
    s_waitcnt vmcnt(5)
    v_mfma_f32_16x16x32_bf16 v[56:59], a[244:247], v[60:63], v[56:59]
    s_waitcnt vmcnt(4)
    v_mfma_f32_16x16x32_bf16 v[56:59], v[224:227], v[68:71], v[56:59]
    s_waitcnt vmcnt(3)
    v_mfma_f32_16x16x32_bf16 v[56:59], v[228:231], v[72:75], v[56:59]
    s_nop 0
    ds_write_b128 v165, v[48:51] offset:14336
    v_mov_b64 v[116:117], 0
    v_mov_b64 v[118:119], 0
    s_waitcnt lgkmcnt(6)
    v_mfma_f32_16x16x32_bf16 v[20:23], v[188:191], v[60:63], v[20:23]
    v_mov_b64 v[120:121], 0
    v_mov_b64 v[122:123], 0
    v_mfma_f32_16x16x32_bf16 v[20:23], v[232:235], v[68:71], v[20:23]
    v_mfma_f32_16x16x32_bf16 v[20:23], v[236:239], v[72:75], v[20:23]
    s_waitcnt lgkmcnt(5)
    v_mfma_f32_16x16x32_bf16 v[8:11], v[204:207], v[60:63], v[8:11]
    v_mfma_f32_16x16x32_bf16 v[8:11], v[240:243], v[68:71], v[8:11]
    s_waitcnt lgkmcnt(0)
    s_barrier
    v_mfma_f32_16x16x32_bf16 v[8:11], v[244:247], v[72:75], v[8:11]
    ds_read_b128 v[52:55], v154 offset:10240
    v_mfma_f32_16x16x32_bf16 v[32:35], v[220:223], v[60:63], v[32:35]
    ds_read_b128 v[16:19], v154 offset:11264
    v_mfma_f32_16x16x32_bf16 v[32:35], v[248:251], v[68:71], v[32:35]
    ds_read_b128 v[4:7], v154 offset:12288
    v_mfma_f32_16x16x32_bf16 v[32:35], v[252:255], v[72:75], v[32:35]
    ds_read_b128 v[28:31], v154 offset:13312
    v_mfma_f32_16x16x32_bf16 v[44:47], a[228:231], v[60:63], v[44:47]
    ds_read_b128 v[40:43], v154 offset:14336
    v_mfma_f32_16x16x32_bf16 v[44:47], a[248:251], v[68:71], v[44:47]
    v_mfma_f32_16x16x32_bf16 v[44:47], a[252:255], v[72:75], v[44:47]
    v_pk_add_f32 v[132:133], v[132:133], v[56:57]
    v_pk_add_f32 v[134:135], v[134:135], v[58:59]
    v_pk_add_f32 v[136:137], v[136:137], v[20:21]
    v_pk_add_f32 v[138:139], v[138:139], v[22:23]
    v_pk_add_f32 v[140:141], v[140:141], v[8:9]
    v_pk_add_f32 v[142:143], v[142:143], v[10:11]
    v_pk_add_f32 v[144:145], v[144:145], v[32:33]
    v_pk_add_f32 v[146:147], v[146:147], v[34:35]
    v_pk_add_f32 v[148:149], v[148:149], v[44:45]
    v_pk_add_f32 v[150:151], v[150:151], v[46:47]
    s_waitcnt lgkmcnt(4)
    v_pk_add_f32 v[132:133], v[132:133], v[52:53]
    v_pk_add_f32 v[134:135], v[134:135], v[54:55]
    s_waitcnt lgkmcnt(3)
    v_pk_add_f32 v[136:137], v[136:137], v[16:17]
    v_pk_add_f32 v[138:139], v[138:139], v[18:19]
    s_waitcnt lgkmcnt(2)
    v_pk_add_f32 v[140:141], v[140:141], v[4:5]
    v_pk_add_f32 v[142:143], v[142:143], v[6:7]
    s_waitcnt lgkmcnt(1)
    v_pk_add_f32 v[144:145], v[144:145], v[28:29]
    v_pk_add_f32 v[146:147], v[146:147], v[30:31]
    s_waitcnt lgkmcnt(0)
    v_pk_add_f32 v[148:149], v[148:149], v[40:41]
    v_pk_add_f32 v[150:151], v[150:151], v[42:43]
    v_pk_add_f32 v[4:5], v[132:133], v[134:135]
    v_pk_mul_f32 v[6:7], v[132:133], v[132:133]
    v_pk_fma_f32 v[6:7], v[134:135], v[134:135], v[6:7]
    v_pk_fma_f32 v[6:7], v[136:137], v[136:137], v[6:7]
    v_pk_add_f32 v[4:5], v[4:5], v[136:137]
    v_pk_fma_f32 v[6:7], v[138:139], v[138:139], v[6:7]
    v_pk_add_f32 v[4:5], v[4:5], v[138:139]
    v_pk_fma_f32 v[6:7], v[140:141], v[140:141], v[6:7]
    v_pk_add_f32 v[4:5], v[4:5], v[140:141]
    v_pk_fma_f32 v[6:7], v[142:143], v[142:143], v[6:7]
    v_pk_add_f32 v[4:5], v[4:5], v[142:143]
    v_pk_fma_f32 v[6:7], v[144:145], v[144:145], v[6:7]
    v_pk_add_f32 v[4:5], v[4:5], v[144:145]
    v_pk_fma_f32 v[6:7], v[146:147], v[146:147], v[6:7]
    v_pk_add_f32 v[4:5], v[4:5], v[146:147]
    v_pk_fma_f32 v[6:7], v[148:149], v[148:149], v[6:7]
    v_pk_add_f32 v[4:5], v[4:5], v[148:149]
    v_pk_fma_f32 v[6:7], v[150:151], v[150:151], v[6:7]
    v_pk_add_f32 v[4:5], v[4:5], v[150:151]
    v_add_f32 v6, v6, v7
    v_add_f32 v4, v4, v5
    v_mov_b32 v1, s82
    s_nop 0
    v_permlane32_swap_b32 v4, v6
    v_add_f32 v4, v4, v6
    v_mov_b32 v6, v4
    s_nop 1
    v_permlane16_swap_b32 v4, v6
    v_add_f32 v0, v4, v6

    s_cmp_eq_u32 s88, 0
    s_cbranch_scc1 Lss_17
    global_store_dwordx2 v155, v[0:1], s[98:99]
Lsd_18:
    s_waitcnt vmcnt(1)
    ds_read2st64_b32 v[8:9], v170 offset1:2
    ds_read2st64_b32 v[10:11], v170 offset0:4 offset1:6
    ds_read_b32 v12, v171
    v_and_b32 v84, 0xf0, v153
    v_lshrrev_b32 v85, 5, v152
    v_lshl_add_u32 v84, v85, 8, v84
    v_bfe_u32 v85, v152, 2, 3
    v_mul_u32_u24 v85, 2560, v85
    v_and_b32 v86, 3, v152
    v_min_u32 v86, 2, v86
    v_lshl_add_u32 v85, v86, 10, v85
    s_mul_i32 s3, s78, 2560
    s_sub_u32 s3, s12, s3
    v_add_u32 v85, s3, v85
    s_waitcnt lgkmcnt(0)
    v_bitop3_b32 v169, v8, v9, v10 bitop3:128
    v_bitop3_b32 v169, v169, v11, v12 bitop3:128
    v_and_b32 v169, 1, v169
    v_cmp_ne_u32 s[96:97], 1, v169
    s_cmp_lg_u64 s[96:97], 0
    s_cbranch_scc1 L_gcr
L_gc:
    s_barrier
    ds_read_u16_d16_hi v112, v166 offset:0
    ds_read_u16_d16_hi v113, v166 offset:128
    ds_read_u16_d16_hi v114, v166 offset:256
    ds_read_u16_d16_hi v115, v166 offset:384
    ds_read_u16_d16_hi v116, v166 offset:512
    ds_read_u16_d16_hi v117, v166 offset:640
    ds_read_u16_d16_hi v118, v166 offset:768
    ds_read_u16_d16_hi v119, v166 offset:896
    global_load_dwordx4 v[0:3], v163, s[98:99] sc1
    global_load_dwordx4 v[4:7], v163, s[98:99] offset:256 sc1
    ds_read_u16_d16_hi v120, v166 offset:4096
    ds_read_u16_d16_hi v121, v166 offset:4224
    ds_read_u16_d16_hi v122, v166 offset:4352
    ds_read_u16_d16_hi v123, v166 offset:4480
    ds_read_u16_d16_hi v124, v166 offset:4608
    ds_read_u16_d16_hi v125, v166 offset:4736
    ds_read_u16_d16_hi v126, v166 offset:4864
    ds_read_u16_d16_hi v127, v166 offset:4992
    ds_read_u16_d16_hi v128, v167 offset:8192
    ds_read_u16_d16_hi v129, v167 offset:8320
    ds_read_u16_d16_hi v130, v167 offset:8448
    ds_read_u16_d16_hi v131, v167 offset:8576
    s_waitcnt lgkmcnt(0)
    s_waitcnt vmcnt(0)
    L_s1:
    v_min3_u32 v168, v1, v3, v5
    v_max3_u32 v1, v1, v3, v5
    v_min3_u32 v168, v168, v7, s82
    v_max3_u32 v1, v1, v7, s82
    v_cmp_ne_u32 vcc, v168, v1

    s_cbranch_vccnz L_s1r
    v_add_f32 v0, v0, v4
    v_add_f32 v2, v2, v6
    s_nop 1
    v_permlane32_swap_b32 v0, v2
    v_add_f32 v0, v0, v2
    v_mov_b32 v2, v0
    s_nop 1
    v_permlane16_swap_b32 v0, v2
    v_add_f32 v0, v0, v2
    v_mov_b32 v2, v0
    s_nop 1
    v_permlane32_swap_b32 v0, v2
    v_mul_f32 v0, 0x3acccccd, v0
    v_mov_b32 v166, 0x3727c5ac
    v_fmac_f32 v166, 0x3acccccd, v2
    v_fma_f32 v166, -v0, v0, v166
    v_max_f32 v166, 0x3727c5ac, v166
    v_rsq_f32 v166, v166
    s_nop 0
    v_mul_f32_e64 v167, -v0, v166
    v_pk_fma_f32 v[32:33], v[148:149], v[166:167], v[166:167] op_sel:[0,0,1] op_sel_hi:[1,0,1]
    v_pk_fma_f32 v[34:35], v[150:151], v[166:167], v[166:167] op_sel:[0,0,1] op_sel_hi:[1,0,1]
    v_pk_fma_f32 v[16:17], v[132:133], v[166:167], v[166:167] op_sel:[0,0,1] op_sel_hi:[1,0,1]
    v_pk_fma_f32 v[18:19], v[134:135], v[166:167], v[166:167] op_sel:[0,0,1] op_sel_hi:[1,0,1]
    v_pk_fma_f32 v[20:21], v[136:137], v[166:167], v[166:167] op_sel:[0,0,1] op_sel_hi:[1,0,1]
    v_pk_fma_f32 v[22:23], v[138:139], v[166:167], v[166:167] op_sel:[0,0,1] op_sel_hi:[1,0,1]
    v_pk_fma_f32 v[24:25], v[140:141], v[166:167], v[166:167] op_sel:[0,0,1] op_sel_hi:[1,0,1]
    v_pk_fma_f32 v[26:27], v[142:143], v[166:167], v[166:167] op_sel:[0,0,1] op_sel_hi:[1,0,1]
    v_pk_fma_f32 v[28:29], v[144:145], v[166:167], v[166:167] op_sel:[0,0,1] op_sel_hi:[1,0,1]
    v_pk_fma_f32 v[30:31], v[146:147], v[166:167], v[166:167] op_sel:[0,0,1] op_sel_hi:[1,0,1]
    v_pk_fma_f32 v[148:149], v[32:33], v[128:129], v[148:149]
    v_pk_fma_f32 v[150:151], v[34:35], v[130:131], v[150:151]
    v_pk_fma_f32 v[132:133], v[16:17], v[112:113], v[132:133]
    v_pk_fma_f32 v[134:135], v[18:19], v[114:115], v[134:135]
    v_pk_fma_f32 v[136:137], v[20:21], v[116:117], v[136:137]
    v_pk_fma_f32 v[138:139], v[22:23], v[118:119], v[138:139]
    v_pk_fma_f32 v[140:141], v[24:25], v[120:121], v[140:141]
    v_pk_fma_f32 v[142:143], v[26:27], v[122:123], v[142:143]
    v_pk_fma_f32 v[144:145], v[28:29], v[124:125], v[144:145]
    v_pk_fma_f32 v[146:147], v[30:31], v[126:127], v[146:147]
    v_cvt_pk_bf16_f32 v44, v148, v149
    v_cvt_pk_bf16_f32 v45, v150, v151
    v_or_b32 v44, 1, v44
    v_cvt_pk_bf16_f32 v36, v132, v133
    v_cvt_pk_bf16_f32 v37, v134, v135
    v_or_b32 v36, 1, v36
    v_permlane16_swap_b32 v44, v46
    v_permlane16_swap_b32 v45, v47
    v_cvt_pk_bf16_f32 v38, v136, v137
    v_cvt_pk_bf16_f32 v39, v138, v139
    v_or_b32 v38, 1, v38
    v_cvt_pk_bf16_f32 v40, v140, v141
    v_cvt_pk_bf16_f32 v41, v142, v143
    v_or_b32 v40, 1, v40
    v_cvt_pk_bf16_f32 v42, v144, v145
    v_cvt_pk_bf16_f32 v43, v146, v147
    v_or_b32 v42, 1, v42
    s_cmp_eq_u32 s88, 0
    s_cbranch_scc1 Lss_19
    buffer_store_dwordx4 v[36:39], v153, s[64:67], s12 offen
    buffer_store_dwordx4 v[40:43], v153, s[64:67], s12 offen offset:1024
    s_mov_b32 exec_lo, 0xffff
    s_mov_b32 exec_hi, 0xffff
    buffer_store_dwordx4 v[44:47], v84, s[64:67], s12 offen offset:2048
Lsd_20:
    s_mov_b64 exec, -1
    s_barrier
    v_pk_add_f32 v[4:5], v[132:133], v[134:135]
    v_pk_mul_f32 v[6:7], v[132:133], v[132:133]
    v_pk_fma_f32 v[6:7], v[134:135], v[134:135], v[6:7]
    v_pk_fma_f32 v[6:7], v[136:137], v[136:137], v[6:7]
    v_pk_add_f32 v[4:5], v[4:5], v[136:137]
    v_pk_fma_f32 v[6:7], v[138:139], v[138:139], v[6:7]
    v_pk_add_f32 v[4:5], v[4:5], v[138:139]
    v_pk_fma_f32 v[6:7], v[140:141], v[140:141], v[6:7]
    v_pk_add_f32 v[4:5], v[4:5], v[140:141]
    v_pk_fma_f32 v[6:7], v[142:143], v[142:143], v[6:7]
    v_pk_add_f32 v[4:5], v[4:5], v[142:143]
    v_pk_fma_f32 v[6:7], v[144:145], v[144:145], v[6:7]
    v_pk_add_f32 v[4:5], v[4:5], v[144:145]
    v_pk_fma_f32 v[6:7], v[146:147], v[146:147], v[6:7]
    v_pk_add_f32 v[4:5], v[4:5], v[146:147]
    v_pk_fma_f32 v[6:7], v[148:149], v[148:149], v[6:7]
    v_pk_add_f32 v[4:5], v[4:5], v[148:149]
    v_pk_fma_f32 v[6:7], v[150:151], v[150:151], v[6:7]
    v_pk_add_f32 v[4:5], v[4:5], v[150:151]
    v_add_f32 v6, v6, v7
    v_add_f32 v4, v4, v5
    v_mov_b32 v1, s82
    s_nop 0
    v_permlane32_swap_b32 v4, v6
    v_add_f32 v4, v4, v6
    v_mov_b32 v6, v4
    s_nop 1
    v_permlane16_swap_b32 v4, v6
    v_add_f32 v0, v4, v6

    s_add_u32 s98, s98, 0x40000
    s_addc_u32 s99, s99, 0
    s_cmp_eq_u32 s88, 0
    s_cbranch_scc1 Lss_21
    global_store_dwordx2 v155, v[0:1], s[98:99]
Lsd_22:
    v_bfe_u32 v122, v152, 2, 2
    s_lshl_b32 s3, s77, 4
    s_add_u32 s3, s3, 92160
    v_lshl_add_u32 v120, v122, 6, s3
    s_lshl_b32 s3, s77, 3
    s_add_u32 s3, s3, 92672
    v_lshl_add_u32 v121, v122, 6, s3
    v_bfe_u32 v122, v152, 0, 2
    v_lshl_add_u32 v120, v122, 2, v120
    v_bfe_u32 v122, v152, 0, 1
    v_lshl_add_u32 v121, v122, 5, v121
    v_bfe_u32 v122, v152, 1, 1
    v_lshl_add_u32 v121, v122, 2, v121
    v_and_b32 v122, 15, v152
    s_lshl_b32 s3, s77, 7
    s_add_u32 s3, s3, 81920
    v_lshl_add_u32 v165, v122, 3, s3
    v_bfe_u32 v171, v152, 1, 2
    s_lshl_b32 s3, s77, 5
    s_add_u32 s3, s3, 82432
    v_lshl_add_u32 v171, v171, 3, s3
    v_not_b32 v122, v152
    v_lshlrev_b32 v122, 28, v122
    v_and_b32 v170, 0x80000000, v122
    v_lshrrev_b32 v122, 4, v152
    s_mov_b32 s3, 92160
    v_lshl_add_u32 v164, v122, 6, s3
    v_and_b32 v48, 1, v152
    v_lshl_add_u32 v50, v48, 5, v164
    v_lshlrev_b32 v48, 2, v48
    v_lshl_add_u32 v48, v122, 8, v48
    v_and_b32 v122, 1, v122
    v_xor_b32 v122, s77, v122
    v_lshl_add_u32 v48, v122, 6, v48
    v_bfe_u32 v122, v152, 1, 2
    v_lshl_add_u32 v48, v122, 4, v48
    v_bfe_u32 v122, v152, 3, 1
    v_lshlrev_b32 v122, 12, v122
    s_mov_b32 s3, 0
    v_add3_u32 v48, v122, v48, s3
    v_xor_b32 v49, 8, v48
L_xp:
    s_sub_u32 s101, s101, 1
    s_cbranch_scc1 L_end
    buffer_load_dword v168, v85, s[64:67], 0 offen sc1
    s_add_u32 m0, s100, 0
    s_nop 0
    buffer_load_dwordx4 v173, s[64:67], s72 offen offset:0 sc1 lds
    s_add_u32 m0, s100, 8192
    s_add_u32 s83, s72, 10240
    buffer_load_dwordx4 v173, s[64:67], s83 offen offset:0 sc1 lds
    s_add_u32 m0, s100, 0
    s_nop 0
    buffer_load_dwordx4 v173, s[64:67], s72 offen offset:1024 sc1 lds
    s_add_u32 m0, s100, 8192
    s_add_u32 s83, s72, 10240
    buffer_load_dwordx4 v173, s[64:67], s83 offen offset:1024 sc1 lds
    s_waitcnt vmcnt(4)
    v_and_b32 v168, 1, v168
    v_cmp_ne_u32 vcc, 1, v168
    s_cbranch_vccnz L_xp
    s_waitcnt vmcnt(2)
    s_barrier
    ds_read_b128 v[56:59], v158 offset:0
    ds_read_b128 v[60:63], v158 offset:2048
    ds_read_b128 v[64:67], v158 offset:4096
    ds_read_b128 v[68:71], v158 offset:6144
    s_add_u32 m0, s100, 16384
    s_nop 0
    buffer_load_dwordx4 v173, s[64:67], s73 offen offset:0 sc1 lds
    s_add_u32 m0, s100, 16384
    s_nop 0
    buffer_load_dwordx4 v173, s[64:67], s73 offen offset:1024 sc1 lds
    s_waitcnt vmcnt(2)
    s_barrier
    ds_read_b128 v[72:75], v158 offset:1024
    ds_read_b128 v[76:79], v158 offset:3072
    ds_read_b128 v[80:83], v158 offset:5120
    ds_read_b128 v[84:87], v158 offset:7168
    ds_read_b128 v[88:91], v159 offset:0
    ds_read_b128 v[92:95], v159 offset:2048
    ds_read_b128 v[96:99], v159 offset:4096
    ds_read_b128 v[100:103], v159 offset:6144
    s_waitcnt lgkmcnt(8)
    v_bitop3_b32 v169, v56, v60, v64 bitop3:128
    v_bitop3_b32 v169, v169, v68, 1 bitop3:128
    v_cmp_ne_u32 s[96:97], 1, v169
    s_cmp_lg_u64 s[96:97], 0
    s_cbranch_scc1 L_xc0r
L_xc0:
    v_mfma_f32_16x16x32_bf16 v[0:3], v[56:59], a[0:3], 0
    s_add_u32 m0, s100, 24576
    s_add_u32 s83, s73, 10240
    buffer_load_dwordx4 v173, s[64:67], s83 offen offset:0 sc1 lds
    v_mfma_f32_16x16x32_bf16 v[16:19], v[56:59], a[8:11], 0
    v_mfma_f32_16x16x32_bf16 v[32:35], v[56:59], a[16:19], 0
    ds_read_b128 v[56:59], v159 offset:1024
    v_mfma_f32_16x16x32_bf16 v[4:7], v[60:63], a[0:3], 0
    s_add_u32 m0, s100, 24576
    s_add_u32 s83, s73, 10240
    buffer_load_dwordx4 v173, s[64:67], s83 offen offset:1024 sc1 lds
    v_mfma_f32_16x16x32_bf16 v[20:23], v[60:63], a[8:11], 0
    v_mfma_f32_16x16x32_bf16 v[36:39], v[60:63], a[16:19], 0
    ds_read_b128 v[60:63], v159 offset:3072
    v_mfma_f32_16x16x32_bf16 v[8:11], v[64:67], a[0:3], 0
    s_add_u32 m0, s100, 32768
    s_nop 0
    buffer_load_dwordx4 v173, s[64:67], s74 offen offset:0 sc1 lds
    v_mfma_f32_16x16x32_bf16 v[24:27], v[64:67], a[8:11], 0
    s_waitcnt lgkmcnt(6)
    v_bitop3_b32 v169, v72, v76, v80 bitop3:128
    v_bitop3_b32 v169, v169, v84, 1 bitop3:128
    v_cmp_ne_u32 s[96:97], 1, v169
    v_mfma_f32_16x16x32_bf16 v[40:43], v[64:67], a[16:19], 0
    ds_read_b128 v[64:67], v159 offset:5120
    v_mfma_f32_16x16x32_bf16 v[12:15], v[68:71], a[0:3], 0
    s_add_u32 m0, s100, 32768
    s_nop 0
    buffer_load_dwordx4 v173, s[64:67], s74 offen offset:1024 sc1 lds
    v_mfma_f32_16x16x32_bf16 v[28:31], v[68:71], a[8:11], 0
    v_mfma_f32_16x16x32_bf16 v[44:47], v[68:71], a[16:19], 0
    ds_read_b128 v[68:71], v159 offset:7168
    s_cmp_lg_u64 s[96:97], 0
    s_cbranch_scc1 L_xc1r
L_xc1:
    v_mfma_f32_16x16x32_bf16 v[0:3], v[72:75], a[4:7], v[0:3]
    s_add_u32 m0, s100, 40960
    s_add_u32 s83, s74, 10240
    buffer_load_dwordx4 v173, s[64:67], s83 offen offset:0 sc1 lds
    v_mfma_f32_16x16x32_bf16 v[16:19], v[72:75], a[12:15], v[16:19]
    v_mfma_f32_16x16x32_bf16 v[32:35], v[72:75], a[20:23], v[32:35]
    v_mfma_f32_16x16x32_bf16 v[4:7], v[76:79], a[4:7], v[4:7]
    s_add_u32 m0, s100, 40960
    s_add_u32 s83, s74, 10240
    buffer_load_dwordx4 v173, s[64:67], s83 offen offset:1024 sc1 lds
    v_mfma_f32_16x16x32_bf16 v[20:23], v[76:79], a[12:15], v[20:23]
    v_mfma_f32_16x16x32_bf16 v[36:39], v[76:79], a[20:23], v[36:39]
    v_mfma_f32_16x16x32_bf16 v[8:11], v[80:83], a[4:7], v[8:11]
    global_load_dwordx4 v[104:107], v163, s[98:99] sc1
    v_mfma_f32_16x16x32_bf16 v[24:27], v[80:83], a[12:15], v[24:27]
    s_waitcnt lgkmcnt(4)
    v_bitop3_b32 v169, v88, v92, v96 bitop3:128
    v_bitop3_b32 v169, v169, v100, 1 bitop3:128
    v_cmp_ne_u32 s[96:97], 1, v169
    v_mfma_f32_16x16x32_bf16 v[40:43], v[80:83], a[20:23], v[40:43]
    global_load_dwordx4 v[108:111], v163, s[98:99] offset:256 sc1
    v_mfma_f32_16x16x32_bf16 v[12:15], v[84:87], a[4:7], v[12:15]
    v_mfma_f32_16x16x32_bf16 v[28:31], v[84:87], a[12:15], v[28:31]
    v_mfma_f32_16x16x32_bf16 v[44:47], v[84:87], a[20:23], v[44:47]
    s_cmp_lg_u64 s[96:97], 0
    s_cbranch_scc1 L_xc2r
L_xc2:
    v_mfma_f32_16x16x32_bf16 v[0:3], v[88:91], a[24:27], v[0:3]
    v_mfma_f32_16x16x32_bf16 v[16:19], v[88:91], a[32:35], v[16:19]
    v_mfma_f32_16x16x32_bf16 v[4:7], v[92:95], a[24:27], v[4:7]
    v_mfma_f32_16x16x32_bf16 v[20:23], v[92:95], a[32:35], v[20:23]
    s_waitcnt lgkmcnt(0)
    v_bitop3_b32 v169, v56, v60, v64 bitop3:128
    v_bitop3_b32 v169, v169, v68, 1 bitop3:128
    v_cmp_ne_u32 s[96:97], 1, v169
    v_mfma_f32_16x16x32_bf16 v[8:11], v[96:99], a[24:27], v[8:11]
    v_mfma_f32_16x16x32_bf16 v[24:27], v[96:99], a[32:35], v[24:27]
    v_mfma_f32_16x16x32_bf16 v[12:15], v[100:103], a[24:27], v[12:15]
    s_add_u32 m0, s100, 49152
    s_nop 0
    buffer_load_dwordx4 v173, s[64:67], s75 offen offset:0 sc1 lds
    s_waitcnt vmcnt(3)
    s_barrier
    ds_read_b128 v[72:75], v158 offset:16384
    ds_read_b128 v[76:79], v158 offset:18432
    v_mfma_f32_16x16x32_bf16 v[28:31], v[100:103], a[32:35], v[28:31]
    ds_read_b128 v[80:83], v158 offset:20480
    ds_read_b128 v[84:87], v158 offset:22528
    s_cmp_lg_u64 s[96:97], 0
    s_cbranch_scc1 L_xc3r
L_xc3:
    v_mfma_f32_16x16x32_bf16 v[0:3], v[56:59], a[28:31], v[0:3]
    ds_read_b128 v[88:91], v158 offset:17408
    ds_read_b128 v[92:95], v158 offset:19456
    v_mfma_f32_16x16x32_bf16 v[16:19], v[56:59], a[36:39], v[16:19]
    s_add_u32 m0, s100, 49152
    s_nop 0
    buffer_load_dwordx4 v173, s[64:67], s75 offen offset:1024 sc1 lds
    ds_read_b128 v[96:99], v158 offset:21504
    ds_read_b128 v[100:103], v158 offset:23552
    v_mfma_f32_16x16x32_bf16 v[4:7], v[60:63], a[28:31], v[4:7]
    ds_read_b128 v[56:59], v158 offset:32768
    v_mfma_f32_16x16x32_bf16 v[20:23], v[60:63], a[36:39], v[20:23]
    ds_read_b128 v[60:63], v158 offset:34816
    s_waitcnt lgkmcnt(6)
    v_bitop3_b32 v169, v72, v76, v80 bitop3:128
    v_bitop3_b32 v169, v169, v84, 1 bitop3:128
    v_cmp_ne_u32 s[96:97], 1, v169
    v_mfma_f32_16x16x32_bf16 v[8:11], v[64:67], a[28:31], v[8:11]
    s_add_u32 m0, s100, 57344
    s_add_u32 s83, s75, 10240
    buffer_load_dwordx4 v173, s[64:67], s83 offen offset:0 sc1 lds
    v_mfma_f32_16x16x32_bf16 v[24:27], v[64:67], a[36:39], v[24:27]
    ds_read_b128 v[64:67], v158 offset:36864
    v_mfma_f32_16x16x32_bf16 v[12:15], v[68:71], a[28:31], v[12:15]
    v_mfma_f32_16x16x32_bf16 v[28:31], v[68:71], a[36:39], v[28:31]
    s_add_u32 m0, s100, 57344
    s_add_u32 s83, s75, 10240
    buffer_load_dwordx4 v173, s[64:67], s83 offen offset:1024 sc1 lds
    ds_read_b128 v[68:71], v158 offset:38912
    s_cmp_lg_u64 s[96:97], 0
    s_cbranch_scc1 L_xc4r
L_xc4:
    v_mfma_f32_16x16x32_bf16 v[0:3], v[72:75], a[40:43], v[0:3]
    v_mfma_f32_16x16x32_bf16 v[16:19], v[72:75], a[48:51], v[16:19]
    v_mfma_f32_16x16x32_bf16 v[32:35], v[72:75], a[56:59], v[32:35]
    s_add_u32 m0, s100, 65536
    s_nop 0
    buffer_load_dwordx4 v173, s[64:67], s76 offen offset:0 sc1 lds
    ds_read_b128 v[72:75], v158 offset:33792
    v_mfma_f32_16x16x32_bf16 v[4:7], v[76:79], a[40:43], v[4:7]
    v_mfma_f32_16x16x32_bf16 v[20:23], v[76:79], a[48:51], v[20:23]
    v_mfma_f32_16x16x32_bf16 v[36:39], v[76:79], a[56:59], v[36:39]
    s_add_u32 m0, s100, 65536
    s_nop 0
    buffer_load_dwordx4 v173, s[64:67], s76 offen offset:1024 sc1 lds
    ds_read_b128 v[76:79], v158 offset:35840
    v_mfma_f32_16x16x32_bf16 v[8:11], v[80:83], a[40:43], v[8:11]
    v_mfma_f32_16x16x32_bf16 v[24:27], v[80:83], a[48:51], v[24:27]
    s_waitcnt lgkmcnt(6)
    v_bitop3_b32 v169, v88, v92, v96 bitop3:128
    v_bitop3_b32 v169, v169, v100, 1 bitop3:128
    v_cmp_ne_u32 s[96:97], 1, v169
    v_mfma_f32_16x16x32_bf16 v[40:43], v[80:83], a[56:59], v[40:43]
    s_add_u32 m0, s100, 73728
    s_add_u32 s83, s76, 10240
    buffer_load_dwordx4 v173, s[64:67], s83 offen offset:0 sc1 lds
    ds_read_b128 v[80:83], v158 offset:37888
    v_mfma_f32_16x16x32_bf16 v[12:15], v[84:87], a[40:43], v[12:15]
    v_mfma_f32_16x16x32_bf16 v[28:31], v[84:87], a[48:51], v[28:31]
    v_mfma_f32_16x16x32_bf16 v[44:47], v[84:87], a[56:59], v[44:47]
    s_add_u32 m0, s100, 73728
    s_add_u32 s83, s76, 10240
    buffer_load_dwordx4 v173, s[64:67], s83 offen offset:1024 sc1 lds
    ds_read_b128 v[84:87], v158 offset:39936
    s_cmp_lg_u64 s[96:97], 0
    s_cbranch_scc1 L_xc5r
L_xc5:
    v_mfma_f32_16x16x32_bf16 v[0:3], v[88:91], a[44:47], v[0:3]
    v_mfma_f32_16x16x32_bf16 v[16:19], v[88:91], a[52:55], v[16:19]
    v_mfma_f32_16x16x32_bf16 v[32:35], v[88:91], a[60:63], v[32:35]
    v_mfma_f32_16x16x32_bf16 v[4:7], v[92:95], a[44:47], v[4:7]
    v_mfma_f32_16x16x32_bf16 v[20:23], v[92:95], a[52:55], v[20:23]
    s_waitcnt vmcnt(8)
    L_s2:
    v_min3_u32 v168, v105, v107, v109
    v_max3_u32 v105, v105, v107, v109
    v_min3_u32 v168, v168, v111, s82
    v_max3_u32 v105, v105, v111, s82
    v_cmp_ne_u32 vcc, v168, v105

    s_cbranch_vccnz L_s2r
    v_mfma_f32_16x16x32_bf16 v[36:39], v[92:95], a[60:63], v[36:39]
    v_add_f32 v104, v104, v108
    v_add_f32 v106, v106, v110
    v_mfma_f32_16x16x32_bf16 v[8:11], v[96:99], a[44:47], v[8:11]
    s_nop 0
    v_permlane32_swap_b32 v104, v106
    v_add_f32 v104, v104, v106
    v_mfma_f32_16x16x32_bf16 v[24:27], v[96:99], a[52:55], v[24:27]
    s_waitcnt lgkmcnt(4)
    v_bitop3_b32 v169, v56, v60, v64 bitop3:128
    v_bitop3_b32 v169, v169, v68, 1 bitop3:128
    v_cmp_ne_u32 s[96:97], 1, v169
    v_mfma_f32_16x16x32_bf16 v[40:43], v[96:99], a[60:63], v[40:43]
    v_mov_b32 v106, v104
    s_nop 1
    v_permlane16_swap_b32 v104, v106
    v_mfma_f32_16x16x32_bf16 v[12:15], v[100:103], a[44:47], v[12:15]
    v_add_f32 v104, v104, v106
    v_mov_b32 v106, v104
    v_mfma_f32_16x16x32_bf16 v[28:31], v[100:103], a[52:55], v[28:31]
    s_nop 0
    v_permlane32_swap_b32 v104, v106
    v_mul_f32 v104, 0x3acccccd, v104
    v_mfma_f32_16x16x32_bf16 v[44:47], v[100:103], a[60:63], v[44:47]
    v_mov_b32 v166, 0x3727c5ac
    v_fmac_f32 v166, 0x3acccccd, v106
    s_cmp_lg_u64 s[96:97], 0
    s_cbranch_scc1 L_xc6r
L_xc6:
    v_mfma_f32_16x16x32_bf16 v[0:3], v[56:59], a[80:83], v[0:3]
    v_fma_f32 v166, -v104, v104, v166
    v_max_f32 v166, 0x3727c5ac, v166
    v_mfma_f32_16x16x32_bf16 v[16:19], v[56:59], a[88:91], v[16:19]
    v_rsq_f32 v166, v166
    s_nop 0
    v_mul_f32_e64 v167, -v104, v166
    v_mfma_f32_16x16x32_bf16 v[32:35], v[56:59], a[96:99], v[32:35]
    v_xor_b32 v104, 0x80000000, v104
    v_mfma_f32_16x16x32_bf16 v[4:7], v[60:63], a[80:83], v[4:7]
    s_mov_b64 exec, 0xffff
    ds_write2st64_b32 v120, v104, v166 offset1:1
    ds_write2st64_b32 v121, v104, v166 offset1:1
    s_mov_b64 exec, -1
    v_mfma_f32_16x16x32_bf16 v[20:23], v[60:63], a[88:91], v[20:23]
    s_add_u32 s98, s98, 0x40000
    s_addc_u32 s99, s99, 0
    v_mfma_f32_16x16x32_bf16 v[36:39], v[60:63], a[96:99], v[36:39]
    v_mfma_f32_16x16x32_bf16 v[8:11], v[64:67], a[80:83], v[8:11]
    v_mfma_f32_16x16x32_bf16 v[24:27], v[64:67], a[88:91], v[24:27]
    s_waitcnt lgkmcnt(2)
    v_bitop3_b32 v169, v72, v76, v80 bitop3:128
    v_bitop3_b32 v169, v169, v84, 1 bitop3:128
    v_cmp_ne_u32 s[96:97], 1, v169
    v_mfma_f32_16x16x32_bf16 v[40:43], v[64:67], a[96:99], v[40:43]
    v_mfma_f32_16x16x32_bf16 v[12:15], v[68:71], a[80:83], v[12:15]
    v_mfma_f32_16x16x32_bf16 v[28:31], v[68:71], a[88:91], v[28:31]
    v_mfma_f32_16x16x32_bf16 v[44:47], v[68:71], a[96:99], v[44:47]
    s_cmp_lg_u64 s[96:97], 0
    s_cbranch_scc1 L_xc7r
L_xc7:
    s_waitcnt lgkmcnt(0)
    v_mfma_f32_16x16x32_bf16 v[0:3], v[72:75], a[84:87], v[0:3]
    s_waitcnt vmcnt(0)
    s_barrier
    ds_read_b128 v[88:91], v158 offset:49152
    ds_read_b128 v[92:95], v158 offset:51200
    v_mfma_f32_16x16x32_bf16 v[16:19], v[72:75], a[92:95], v[16:19]
    ds_read_b128 v[96:99], v158 offset:53248
    ds_read_b128 v[100:103], v158 offset:55296
    v_mfma_f32_16x16x32_bf16 v[32:35], v[72:75], a[100:103], v[32:35]
    ds_read_b128 v[56:59], v158 offset:50176
    ds_read_b128 v[60:63], v158 offset:52224
    v_mfma_f32_16x16x32_bf16 v[4:7], v[76:79], a[84:87], v[4:7]
    ds_read_b128 v[64:67], v158 offset:54272
    ds_read_b128 v[68:71], v158 offset:56320
    v_mfma_f32_16x16x32_bf16 v[20:23], v[76:79], a[92:95], v[20:23]
    v_add_u32 v158, 0x10000, v158
    ds_read_b128 v[72:75], v158 offset:0
    v_mfma_f32_16x16x32_bf16 v[36:39], v[76:79], a[100:103], v[36:39]
    ds_read_b128 v[76:79], v158 offset:1024
    v_mfma_f32_16x16x32_bf16 v[8:11], v[80:83], a[84:87], v[8:11]
    v_mfma_f32_16x16x32_bf16 v[24:27], v[80:83], a[92:95], v[24:27]
    s_waitcnt lgkmcnt(6)
    v_bitop3_b32 v169, v88, v92, v96 bitop3:128
    v_bitop3_b32 v169, v169, v100, 1 bitop3:128
    v_cmp_ne_u32 s[96:97], 1, v169
    v_mfma_f32_16x16x32_bf16 v[40:43], v[80:83], a[100:103], v[40:43]
    ds_read_b128 v[80:83], v158 offset:2048
    v_mfma_f32_16x16x32_bf16 v[12:15], v[84:87], a[84:87], v[12:15]
    v_mfma_f32_16x16x32_bf16 v[28:31], v[84:87], a[92:95], v[28:31]
    s_lshl_b32 s3, s78, 2
    s_add_u32 s3, s3, s77
    s_lshl_b32 s3, s3, 13
    v_mfma_f32_16x16x32_bf16 v[44:47], v[84:87], a[100:103], v[44:47]
    ds_read_b128 v[84:87], v158 offset:3072
    s_add_u32 s3, s3, 9699328
    s_cmp_lg_u64 s[96:97], 0
    s_cbranch_scc1 L_xc8r
L_xc8:
    v_mfma_f32_16x16x32_bf16 v[0:3], v[88:91], a[120:123], v[0:3]
    s_add_u32 s92, s50, s3
    s_addc_u32 s93, s51, 0
    s_movk_i32 s94, 8192
    v_mfma_f32_16x16x32_bf16 v[16:19], v[88:91], a[128:131], v[16:19]
    s_sub_u32 s21, 31, s79
    s_lshl_b32 s21, s21, 8
    s_lshl_b32 s3, s77, 12
    v_and_b32 v52, 16, v152
    v_lshlrev_b32 v52, 2, v52
    v_mfma_f32_16x16x32_bf16 v[32:35], v[88:91], a[136:139], v[32:35]
    ds_read_b128 v[88:91], v158 offset:4096
    v_xor_b32 v52, v52, v153
    v_add_u32 v52, s3, v52
    v_mfma_f32_16x16x32_bf16 v[4:7], v[92:95], a[120:123], v[4:7]
    ds_read_b64 v[128:129], v165 offset:7680
    ds_read_b64 v[130:131], v171 offset:7680
    ds_read_b128 v[104:107], v164 offset:0
    v_mfma_f32_16x16x32_bf16 v[20:23], v[92:95], a[128:131], v[20:23]
    ds_read_b128 v[108:111], v164 offset:256
    ds_read_b128 v[112:115], v164 offset:16
    ds_read_b128 v[116:119], v164 offset:272
    v_mfma_f32_16x16x32_bf16 v[36:39], v[92:95], a[136:139], v[36:39]
    ds_read_b128 v[92:95], v158 offset:5120
    v_mfma_f32_16x16x32_bf16 v[8:11], v[96:99], a[120:123], v[8:11]
    v_mfma_f32_16x16x32_bf16 v[24:27], v[96:99], a[128:131], v[24:27]
    s_waitcnt lgkmcnt(12)
    v_bitop3_b32 v169, v56, v60, v64 bitop3:128
    v_bitop3_b32 v169, v169, v68, 1 bitop3:128
    v_cmp_ne_u32 s[96:97], 1, v169
    v_mfma_f32_16x16x32_bf16 v[40:43], v[96:99], a[136:139], v[40:43]
    ds_read_b128 v[96:99], v158 offset:6144
    v_mfma_f32_16x16x32_bf16 v[12:15], v[100:103], a[120:123], v[12:15]
    v_mfma_f32_16x16x32_bf16 v[28:31], v[100:103], a[128:131], v[28:31]
    v_mfma_f32_16x16x32_bf16 v[44:47], v[100:103], a[136:139], v[44:47]
    ds_read_b128 v[100:103], v158 offset:7168
    s_waitcnt lgkmcnt(7)
    v_xor_b32 v131, v170, v131
    s_cmp_lg_u64 s[96:97], 0
    s_cbranch_scc1 L_xc9r
L_xc9:
    v_mfma_f32_16x16x32_bf16 v[0:3], v[56:59], a[124:127], v[0:3]
    v_mfma_f32_16x16x32_bf16 v[16:19], v[56:59], a[132:135], v[16:19]
    v_mfma_f32_16x16x32_bf16 v[32:35], v[56:59], a[140:143], v[32:35]
    v_add_u32 v159, 0x4000, v159
    ds_read_b128 v[56:59], v159 offset:0
    v_mfma_f32_16x16x32_bf16 v[4:7], v[60:63], a[124:127], v[4:7]
    v_mfma_f32_16x16x32_bf16 v[20:23], v[60:63], a[132:135], v[20:23]
    v_mfma_f32_16x16x32_bf16 v[36:39], v[60:63], a[140:143], v[36:39]
    ds_read_b128 v[60:63], v159 offset:1024
    v_mfma_f32_16x16x32_bf16 v[8:11], v[64:67], a[124:127], v[8:11]
    v_mfma_f32_16x16x32_bf16 v[24:27], v[64:67], a[132:135], v[24:27]
    v_bitop3_b32 v169, v72, v76, v80 bitop3:128
    v_bitop3_b32 v169, v169, v84, 1 bitop3:128
    v_cmp_ne_u32 s[96:97], 1, v169
    v_mfma_f32_16x16x32_bf16 v[40:43], v[64:67], a[140:143], v[40:43]
    ds_read_b128 v[64:67], v159 offset:16384
    v_mfma_f32_16x16x32_bf16 v[12:15], v[68:71], a[124:127], v[12:15]
    v_mfma_f32_16x16x32_bf16 v[28:31], v[68:71], a[132:135], v[28:31]
    v_mfma_f32_16x16x32_bf16 v[44:47], v[68:71], a[140:143], v[44:47]
    ds_read_b128 v[68:71], v159 offset:17408
    s_cmp_lg_u64 s[96:97], 0
    s_cbranch_scc1 L_xc10r
L_xc10:
    v_mfma_f32_16x16x32_bf16 v[0:3], v[72:75], a[160:163], v[0:3]
    v_mfma_f32_16x16x32_bf16 v[16:19], v[72:75], a[168:171], v[16:19]
    v_mfma_f32_16x16x32_bf16 v[32:35], v[72:75], a[176:179], v[32:35]
    ds_read_b128 v[72:75], v159 offset:32768
    v_mfma_f32_16x16x32_bf16 v[0:3], v[76:79], a[164:167], v[0:3]
    v_mfma_f32_16x16x32_bf16 v[16:19], v[76:79], a[172:175], v[16:19]
    v_mfma_f32_16x16x32_bf16 v[32:35], v[76:79], a[180:183], v[32:35]
    ds_read_b128 v[76:79], v159 offset:33792
    v_mfma_f32_16x16x32_bf16 v[4:7], v[80:83], a[160:163], v[4:7]
    v_mfma_f32_16x16x32_bf16 v[20:23], v[80:83], a[168:171], v[20:23]
    s_nop 4
    ds_write_b128 v52, v[32:35] offset:0
    s_waitcnt lgkmcnt(7)
    v_bitop3_b32 v169, v88, v92, v96 bitop3:128
    v_bitop3_b32 v169, v169, v100, 1 bitop3:128
    v_cmp_ne_u32 s[96:97], 1, v169
    v_mfma_f32_16x16x32_bf16 v[36:39], v[80:83], a[176:179], v[36:39]
    ds_read_b128 v[80:83], v159 offset:49152
    v_mfma_f32_16x16x32_bf16 v[4:7], v[84:87], a[164:167], v[4:7]
    v_mfma_f32_16x16x32_bf16 v[20:23], v[84:87], a[172:175], v[20:23]
    v_mfma_f32_16x16x32_bf16 v[36:39], v[84:87], a[180:183], v[36:39]
    ds_read_b128 v[84:87], v159 offset:50176
    s_cmp_lg_u64 s[96:97], 0
    s_cbranch_scc1 L_xc11r
L_xc11:
    v_mfma_f32_16x16x32_bf16 v[8:11], v[88:91], a[160:163], v[8:11]
    v_mfma_f32_16x16x32_bf16 v[24:27], v[88:91], a[168:171], v[24:27]
    s_nop 2
    ds_write_b128 v52, v[36:39] offset:1024
    v_mfma_f32_16x16x32_bf16 v[40:43], v[88:91], a[176:179], v[40:43]
    v_mfma_f32_16x16x32_bf16 v[8:11], v[92:95], a[164:167], v[8:11]
    v_mfma_f32_16x16x32_bf16 v[24:27], v[92:95], a[172:175], v[24:27]
    v_mfma_f32_16x16x32_bf16 v[40:43], v[92:95], a[180:183], v[40:43]
    v_mfma_f32_16x16x32_bf16 v[12:15], v[96:99], a[160:163], v[12:15]
    v_mfma_f32_16x16x32_bf16 v[28:31], v[96:99], a[168:171], v[28:31]
    s_nop 5
    ds_write_b128 v52, v[40:43] offset:2048
    s_waitcnt lgkmcnt(7)
    v_bitop3_b32 v169, v56, v60, v64 bitop3:128
    v_bitop3_b32 v169, v169, v68, 1 bitop3:128
    v_cmp_ne_u32 s[96:97], 1, v169
    v_mfma_f32_16x16x32_bf16 v[44:47], v[96:99], a[176:179], v[44:47]
    v_mfma_f32_16x16x32_bf16 v[12:15], v[100:103], a[164:167], v[12:15]
    v_mfma_f32_16x16x32_bf16 v[28:31], v[100:103], a[172:175], v[28:31]
    v_mfma_f32_16x16x32_bf16 v[44:47], v[100:103], a[180:183], v[44:47]
    s_cmp_lg_u64 s[96:97], 0
    s_cbranch_scc1 L_xc12r
L_xc12:
    v_mfma_f32_16x16x32_bf16 v[0:3], v[56:59], a[64:67], v[0:3]
    v_mfma_f32_16x16x32_bf16 v[16:19], v[56:59], a[72:75], v[16:19]
    s_nop 3
    ds_write_b128 v52, v[44:47] offset:3072
    ds_read_b128 v[56:59], v159 offset:2048
    v_mfma_f32_16x16x32_bf16 v[0:3], v[60:63], a[68:71], v[0:3]
    v_mfma_f32_16x16x32_bf16 v[16:19], v[60:63], a[76:79], v[16:19]
    ds_read_b128 v[60:63], v159 offset:3072
    s_waitcnt lgkmcnt(5)
    v_bitop3_b32 v169, v72, v76, v80 bitop3:128
    v_bitop3_b32 v169, v169, v84, 1 bitop3:128
    v_cmp_ne_u32 s[96:97], 1, v169
    v_mfma_f32_16x16x32_bf16 v[0:3], v[64:67], a[104:107], v[0:3]
    v_mfma_f32_16x16x32_bf16 v[16:19], v[64:67], a[112:115], v[16:19]
    ds_read_b128 v[64:67], v159 offset:18432
    v_mfma_f32_16x16x32_bf16 v[0:3], v[68:71], a[108:111], v[0:3]
    v_mfma_f32_16x16x32_bf16 v[16:19], v[68:71], a[116:119], v[16:19]
    ds_read_b128 v[68:71], v159 offset:19456
    s_cmp_lg_u64 s[96:97], 0
    s_cbranch_scc1 L_xc13r
L_xc13:
    v_mfma_f32_16x16x32_bf16 v[0:3], v[72:75], a[144:147], v[0:3]
    v_mfma_f32_16x16x32_bf16 v[16:19], v[72:75], a[152:155], v[16:19]
    ds_read_b128 v[72:75], v159 offset:34816
    v_mfma_f32_16x16x32_bf16 v[0:3], v[76:79], a[148:151], v[0:3]
    s_waitcnt lgkmcnt(5)
    s_barrier
    v_mfma_f32_16x16x32_bf16 v[16:19], v[76:79], a[156:159], v[16:19]
    ds_read_b128 v[76:79], v159 offset:35840
    s_waitcnt lgkmcnt(2)
    ds_read2st64_b32 v[32:33], v48 offset0:0 offset1:32
    v_bitop3_b32 v169, v56, v60, v64 bitop3:128
    v_bitop3_b32 v169, v169, v68, 1 bitop3:128
    v_cmp_ne_u32 s[96:97], 1, v169
    v_mfma_f32_16x16x32_bf16 v[0:3], v[80:83], a[184:187], v[0:3]
    v_mfma_f32_16x16x32_bf16 v[16:19], v[80:83], a[192:195], v[16:19]
    ds_read_b128 v[80:83], v159 offset:51200
    ds_read2st64_b32 v[34:35], v49 offset0:0 offset1:32
    v_mfma_f32_16x16x32_bf16 v[0:3], v[84:87], a[188:191], v[0:3]
    v_mfma_f32_16x16x32_bf16 v[16:19], v[84:87], a[196:199], v[16:19]
    ds_read_b128 v[84:87], v159 offset:52224
    ds_read2st64_b32 v[36:37], v48 offset0:4 offset1:36
    s_cmp_lg_u64 s[96:97], 0
    s_cbranch_scc1 L_xc14r
L_xc14:
    v_mfma_f32_16x16x32_bf16 v[4:7], v[56:59], a[64:67], v[4:7]
    v_mfma_f32_16x16x32_bf16 v[20:23], v[56:59], a[72:75], v[20:23]
    ds_read_b128 v[56:59], v159 offset:4096
    ds_read2st64_b32 v[38:39], v49 offset0:4 offset1:36
    v_mfma_f32_16x16x32_bf16 v[4:7], v[60:63], a[68:71], v[4:7]
    v_fmac_f32 v0, v104, v160
    v_fmac_f32 v1, v105, v160
    v_mfma_f32_16x16x32_bf16 v[20:23], v[60:63], a[76:79], v[20:23]
    ds_read_b128 v[60:63], v159 offset:5120
    s_waitcnt lgkmcnt(4)
    ds_read2st64_b32 v[40:41], v48 offset0:8 offset1:40
    v_bitop3_b32 v169, v72, v76, v80 bitop3:128
    v_bitop3_b32 v169, v169, v84, 1 bitop3:128
    v_cmp_ne_u32 s[96:97], 1, v169
    v_mfma_f32_16x16x32_bf16 v[4:7], v[64:67], a[104:107], v[4:7]
    v_fmac_f32 v16, v104, v161
    v_fmac_f32 v17, v105, v161
    v_mfma_f32_16x16x32_bf16 v[20:23], v[64:67], a[112:115], v[20:23]
    ds_read_b128 v[64:67], v159 offset:20480
    ds_read2st64_b32 v[42:43], v49 offset0:8 offset1:40
    v_mul_f32 v0, v108, v0
    v_mul_f32 v1, v109, v1
    v_mfma_f32_16x16x32_bf16 v[4:7], v[68:71], a[108:111], v[4:7]
    v_mul_f32 v16, v108, v16
    v_mul_f32 v17, v109, v17
    v_mfma_f32_16x16x32_bf16 v[20:23], v[68:71], a[116:119], v[20:23]
    ds_read_b128 v[68:71], v159 offset:21504
    ds_read2st64_b32 v[44:45], v48 offset0:12 offset1:44
    v_fmac_f32 v2, v106, v160
    v_fmac_f32 v3, v107, v160
    s_cmp_lg_u64 s[96:97], 0
    s_cbranch_scc1 L_xc15r
L_xc15:
    v_mfma_f32_16x16x32_bf16 v[4:7], v[72:75], a[144:147], v[4:7]
    v_fmac_f32 v18, v106, v161
    v_fmac_f32 v19, v107, v161
    v_mfma_f32_16x16x32_bf16 v[20:23], v[72:75], a[152:155], v[20:23]
    ds_read_b128 v[72:75], v159 offset:36864
    ds_read2st64_b32 v[46:47], v49 offset0:12 offset1:44
    v_mul_f32 v2, v110, v2
    v_mul_f32 v3, v111, v3
    v_mfma_f32_16x16x32_bf16 v[4:7], v[76:79], a[148:151], v[4:7]
    ds_read_b128 v[88:91], v50 offset:768
    v_mul_f32 v18, v110, v18
    v_mul_f32 v19, v111, v19
    v_mfma_f32_16x16x32_bf16 v[20:23], v[76:79], a[156:159], v[20:23]
    ds_read_b128 v[76:79], v159 offset:37888
    ds_read_b128 v[92:95], v50 offset:784
    ds_read_b128 v[104:107], v164 offset:32
    v_mfma_f32_16x16x32_bf16 v[4:7], v[80:83], a[184:187], v[4:7]
    ds_read_b128 v[52:55], v50 offset:528
    ds_read_b128 v[108:111], v164 offset:288
    v_fma_f32 v124, v0, v128, v2
    v_fma_f32 v125, v1, v128, v3
    v_mfma_f32_16x16x32_bf16 v[20:23], v[80:83], a[192:195], v[20:23]
    ds_read_b128 v[80:83], v159 offset:53248
    ds_read_b128 v[48:51], v50 offset:512
    v_fma_f32 v126, v16, v128, v18
    v_fma_f32 v127, v17, v128, v19
    v_mfma_f32_16x16x32_bf16 v[4:7], v[84:87], a[188:191], v[4:7]
    ds_read_b64 v[96:97], v165 offset:8320
    v_fma_f32 v124, -v16, v129, v124
    v_fma_f32 v125, -v17, v129, v125
    v_mfma_f32_16x16x32_bf16 v[20:23], v[84:87], a[196:199], v[20:23]
    ds_read_b128 v[84:87], v159 offset:54272
    ds_read_b64 v[98:99], v165 offset:8960
    v_fmac_f32 v126, v0, v129
    v_fmac_f32 v127, v1, v129
    s_waitcnt lgkmcnt(15)
    v_mfma_f32_16x16x32_bf16 v[8:11], v[56:59], a[64:67], v[8:11]
    ds_read_b64 v[100:101], v171 offset:8320
    v_mfma_f32_16x16x32_bf16 v[24:27], v[56:59], a[72:75], v[24:27]
    ds_read_b128 v[56:59], v159 offset:6144
    ds_read_b64 v[102:103], v171 offset:8960
    v_mfma_f32_16x16x32_bf16 v[8:11], v[60:63], a[68:71], v[8:11]
    v_fmac_f32 v4, v112, v160
    v_fmac_f32 v5, v113, v160
    v_mfma_f32_16x16x32_bf16 v[24:27], v[60:63], a[76:79], v[24:27]
    ds_read_b128 v[60:63], v159 offset:7168
    v_fmac_f32 v20, v112, v161
    v_fmac_f32 v21, v113, v161
    v_mfma_f32_16x16x32_bf16 v[8:11], v[64:67], a[104:107], v[8:11]
    v_mul_f32 v4, v116, v4
    v_mul_f32 v5, v117, v5
    v_mfma_f32_16x16x32_bf16 v[24:27], v[64:67], a[112:115], v[24:27]
    ds_read_b128 v[64:67], v159 offset:22528
    s_waitcnt lgkmcnt(15)
    v_mul_f32 v20, v116, v20
    v_mul_f32 v21, v117, v21
    v_add_f32 v32, v32, v33
    v_mfma_f32_16x16x32_bf16 v[8:11], v[68:71], a[108:111], v[8:11]
    v_fmac_f32 v6, v114, v160
    v_fmac_f32 v7, v115, v160
    v_add_f32 v34, v34, v35
    v_mfma_f32_16x16x32_bf16 v[24:27], v[68:71], a[116:119], v[24:27]
    ds_read_b128 v[68:71], v159 offset:23552
    v_fmac_f32 v22, v114, v161
    v_fmac_f32 v23, v115, v161
    v_add_f32 v36, v36, v37
    v_mfma_f32_16x16x32_bf16 v[8:11], v[72:75], a[144:147], v[8:11]
    v_mul_f32 v6, v118, v6
    v_mul_f32 v7, v119, v7
    v_add_f32 v38, v38, v39
    v_mfma_f32_16x16x32_bf16 v[24:27], v[72:75], a[152:155], v[24:27]
    ds_read_b128 v[72:75], v159 offset:38912
    v_mul_f32 v22, v118, v22
    v_mul_f32 v23, v119, v23
    v_add_f32 v40, v40, v41
    s_waitcnt lgkmcnt(15)
    v_mfma_f32_16x16x32_bf16 v[8:11], v[76:79], a[148:151], v[8:11]
    ds_read_b128 v[112:115], v164 offset:48
    ds_read_b128 v[116:119], v164 offset:304
    v_fma_f32 v120, v124, v128, v4
    v_fma_f32 v121, v125, v128, v5
    v_add_f32 v42, v42, v43
    v_mfma_f32_16x16x32_bf16 v[24:27], v[76:79], a[156:159], v[24:27]
    ds_read_b128 v[76:79], v159 offset:39936
    v_fma_f32 v122, v126, v128, v20
    v_fma_f32 v123, v127, v128, v21
    v_add_f32 v44, v44, v45
    s_waitcnt lgkmcnt(14)
    v_mfma_f32_16x16x32_bf16 v[8:11], v[80:83], a[184:187], v[8:11]
    v_fma_f32 v120, -v126, v129, v120
    v_fma_f32 v121, -v127, v129, v121
    v_add_f32 v46, v46, v47
    v_mfma_f32_16x16x32_bf16 v[24:27], v[80:83], a[192:195], v[24:27]
    ds_read_b128 v[80:83], v159 offset:55296
    s_waitcnt lgkmcnt(14)
    v_fmac_f32 v122, v124, v129
    v_fmac_f32 v123, v125, v129
    v_fma_f32 v48, v48, v162, v32
    s_waitcnt lgkmcnt(12)
    v_mfma_f32_16x16x32_bf16 v[8:11], v[84:87], a[188:191], v[8:11]
    v_fma_f32 v124, v120, v128, v6
    v_fma_f32 v125, v121, v128, v7
    v_fma_f32 v49, v49, v162, v34
    v_mfma_f32_16x16x32_bf16 v[24:27], v[84:87], a[196:199], v[24:27]
    ds_read_b128 v[84:87], v159 offset:56320
    v_fma_f32 v126, v122, v128, v22
    v_fma_f32 v127, v123, v128, v23
    v_fma_f32 v50, v50, v162, v36
    s_waitcnt lgkmcnt(10)
    v_mfma_f32_16x16x32_bf16 v[12:15], v[56:59], a[64:67], v[12:15]
    v_fma_f32 v124, -v122, v129, v124
    v_fma_f32 v125, -v123, v129, v125
    v_fma_f32 v51, v51, v162, v38
    v_mfma_f32_16x16x32_bf16 v[28:31], v[56:59], a[72:75], v[28:31]
    v_fmac_f32 v126, v120, v129
    v_fmac_f32 v127, v121, v129
    v_fma_f32 v52, v52, v162, v40
    s_waitcnt lgkmcnt(8)
    v_mfma_f32_16x16x32_bf16 v[12:15], v[60:63], a[68:71], v[12:15]
    v_fma_f32 v53, v53, v162, v42
    v_fma_f32 v54, v54, v162, v44
    v_fma_f32 v55, v55, v162, v46
    v_mfma_f32_16x16x32_bf16 v[28:31], v[60:63], a[76:79], v[28:31]
    v_mul_f32 v48, v88, v48
    v_mul_f32 v49, v89, v49
    v_mul_f32 v50, v90, v50
    s_waitcnt lgkmcnt(7)
    v_mfma_f32_16x16x32_bf16 v[12:15], v[64:67], a[104:107], v[12:15]
    v_mul_f32 v51, v91, v51
    v_mul_f32 v52, v92, v52
    v_mul_f32 v53, v93, v53
    v_mfma_f32_16x16x32_bf16 v[28:31], v[64:67], a[112:115], v[28:31]
    v_mul_f32 v54, v94, v54
    v_mul_f32 v55, v95, v55
    v_fmac_f32 v8, v104, v160
    s_waitcnt lgkmcnt(6)
    v_mfma_f32_16x16x32_bf16 v[12:15], v[68:71], a[108:111], v[12:15]
    v_xor_b32 v101, v170, v101
    v_xor_b32 v103, v170, v103
    v_fma_f32 v173, v130, v48, v49
    v_mfma_f32_16x16x32_bf16 v[28:31], v[68:71], a[116:119], v[28:31]
    s_nop 0
    v_fmac_f32_dpp v173, v48, v131 row_ror:8 row_mask:0xf bank_mask:0xf
    v_fma_f32 v172, v130, v173, v50
    s_nop 1
    v_fmac_f32_dpp v172, v173, v131 row_ror:8 row_mask:0xf bank_mask:0xf
    s_waitcnt lgkmcnt(5)
    v_mfma_f32_16x16x32_bf16 v[12:15], v[72:75], a[144:147], v[12:15]
    v_fma_f32 v173, v130, v172, v51
    s_nop 1
    v_fmac_f32_dpp v173, v172, v131 row_ror:8 row_mask:0xf bank_mask:0xf
    v_fma_f32 v172, v130, v173, v52
    v_mfma_f32_16x16x32_bf16 v[28:31], v[72:75], a[152:155], v[28:31]
    s_nop 0
    v_fmac_f32_dpp v172, v173, v131 row_ror:8 row_mask:0xf bank_mask:0xf
    v_fma_f32 v173, v130, v172, v53
    s_nop 1
    v_fmac_f32_dpp v173, v172, v131 row_ror:8 row_mask:0xf bank_mask:0xf
    s_waitcnt lgkmcnt(2)
    v_mfma_f32_16x16x32_bf16 v[12:15], v[76:79], a[148:151], v[12:15]
    v_fma_f32 v172, v130, v173, v54
    s_nop 1
    v_fmac_f32_dpp v172, v173, v131 row_ror:8 row_mask:0xf bank_mask:0xf
    v_fma_f32 v173, v130, v172, v55
    v_mfma_f32_16x16x32_bf16 v[28:31], v[76:79], a[156:159], v[28:31]
    s_nop 0
    v_fmac_f32_dpp v173, v172, v131 row_ror:8 row_mask:0xf bank_mask:0xf
    v_fmac_f32 v9, v105, v160
    v_fmac_f32 v24, v104, v161
    s_waitcnt lgkmcnt(1)
    v_mfma_f32_16x16x32_bf16 v[12:15], v[80:83], a[184:187], v[12:15]
    v_fmac_f32 v25, v105, v161
    v_mul_f32 v8, v108, v8
    v_mul_f32 v9, v109, v9
    v_mfma_f32_16x16x32_bf16 v[28:31], v[80:83], a[192:195], v[28:31]
    v_mul_f32 v24, v108, v24
    v_mul_f32 v25, v109, v25
    v_fmac_f32 v10, v106, v160
    s_waitcnt lgkmcnt(0)
    v_mfma_f32_16x16x32_bf16 v[12:15], v[84:87], a[188:191], v[12:15]
    v_fmac_f32 v11, v107, v160
    v_fmac_f32 v26, v106, v161
    v_fmac_f32 v27, v107, v161
    v_mfma_f32_16x16x32_bf16 v[28:31], v[84:87], a[196:199], v[28:31]
    v_mul_f32 v10, v110, v10
    v_mul_f32 v11, v111, v11
    v_mul_f32 v26, v110, v26
    v_mul_f32 v27, v111, v27
    v_pk_fma_f32 v[120:121], v[124:125], v[128:129], v[8:9] op_sel_hi:[1,0,1]
    v_pk_fma_f32 v[122:123], v[126:127], v[128:129], v[24:25] op_sel_hi:[1,0,1]
    v_pk_fma_f32 v[120:121], v[126:127], v[128:129], v[120:121] op_sel:[0,1,0] neg_lo:[1,0,0] neg_hi:[1,0,0]
    v_pk_fma_f32 v[122:123], v[124:125], v[128:129], v[122:123] op_sel:[0,1,0]
    v_pk_fma_f32 v[124:125], v[120:121], v[128:129], v[10:11] op_sel_hi:[1,0,1]
    v_pk_fma_f32 v[126:127], v[122:123], v[128:129], v[26:27] op_sel_hi:[1,0,1]
    v_pk_fma_f32 v[124:125], v[122:123], v[128:129], v[124:125] op_sel:[0,1,0] neg_lo:[1,0,0] neg_hi:[1,0,0]
    v_pk_fma_f32 v[126:127], v[120:121], v[128:129], v[126:127] op_sel:[0,1,0]
    v_pk_fma_f32 v[12:13], v[112:113], v[160:161], v[12:13] op_sel_hi:[1,0,1]
    v_pk_fma_f32 v[28:29], v[112:113], v[160:161], v[28:29] op_sel:[0,1,0]
    v_pk_fma_f32 v[14:15], v[114:115], v[160:161], v[14:15] op_sel_hi:[1,0,1]
    v_pk_fma_f32 v[30:31], v[114:115], v[160:161], v[30:31] op_sel:[0,1,0]
    v_pk_mul_f32 v[12:13], v[116:117], v[12:13]
    v_pk_mul_f32 v[28:29], v[116:117], v[28:29]
    v_pk_mul_f32 v[14:15], v[118:119], v[14:15]
    v_pk_mul_f32 v[30:31], v[118:119], v[30:31]
    v_pk_fma_f32 v[120:121], v[124:125], v[128:129], v[12:13] op_sel_hi:[1,0,1]
    v_pk_fma_f32 v[122:123], v[126:127], v[128:129], v[28:29] op_sel_hi:[1,0,1]
    v_pk_fma_f32 v[120:121], v[126:127], v[128:129], v[120:121] op_sel:[0,1,0] neg_lo:[1,0,0] neg_hi:[1,0,0]
    v_pk_fma_f32 v[122:123], v[124:125], v[128:129], v[122:123] op_sel:[0,1,0]
    v_pk_fma_f32 v[124:125], v[120:121], v[128:129], v[14:15] op_sel_hi:[1,0,1]
    v_pk_fma_f32 v[126:127], v[122:123], v[128:129], v[30:31] op_sel_hi:[1,0,1]
    v_pk_fma_f32 v[124:125], v[122:123], v[128:129], v[124:125] op_sel:[0,1,0] neg_lo:[1,0,0] neg_hi:[1,0,0]
    v_pk_fma_f32 v[126:127], v[120:121], v[128:129], v[126:127] op_sel:[0,1,0]
    v_mul_f32 v59, v100, v173
    v_fma_f32 v56, v96, v124, v125
    v_fma_f32 v57, v96, v126, v127
    v_fmac_f32_dpp v59, v173, v101 row_ror:8 row_mask:0xf bank_mask:0xf
    v_mov_b32_dpp v58, v173 quad_perm:[1,1,3,3] row_mask:0xf bank_mask:0xf
    v_fma_f32 v56, -v97, v126, v56
    v_fmac_f32 v57, v97, v124
    v_add_f32_dpp v58, v59, v58 quad_perm:[0,0,2,2] row_mask:0xf bank_mask:0xf
    v_mov_b64 v[64:65], v[56:57]
    v_mov_b32 v66, v58
    v_mov_b32 v71, s82
    v_permlane32_swap_b32 v56, v64
    v_permlane32_swap_b32 v57, v65
    v_permlane32_swap_b32 v58, v66
    v_mov_b64 v[60:61], v[56:57]
    v_mov_b32 v62, v58
    v_mov_b64 v[68:69], v[64:65]
    v_mov_b32 v70, v66

    v_permlane16_swap_b32 v58, v62
    v_permlane16_swap_b32 v56, v60
    v_permlane16_swap_b32 v57, v61
    v_permlane16_swap_b32 v66, v70
    v_fmac_f32 v62, v102, v58
    v_pk_fma_f32 v[60:61], v[56:57], v[98:99], v[60:61] op_sel_hi:[1,0,1]
    v_permlane16_swap_b32 v64, v68
    v_fmac_f32_dpp v62, v58, v103 row_ror:8 row_mask:0xf bank_mask:0xf
    v_pk_fma_f32 v[60:61], v[56:57], v[98:99], v[60:61] op_sel:[1,1,0] op_sel_hi:[0,1,1] neg_lo:[1,0,0]
    v_permlane16_swap_b32 v65, v69
    v_fmac_f32 v66, v102, v62
    v_pk_fma_f32 v[64:65], v[60:61], v[98:99], v[64:65] op_sel_hi:[1,0,1]
    s_nop 0
    v_fmac_f32_dpp v66, v62, v103 row_ror:8 row_mask:0xf bank_mask:0xf
    v_pk_fma_f32 v[64:65], v[60:61], v[98:99], v[64:65] op_sel:[1,1,0] op_sel_hi:[0,1,1] neg_lo:[1,0,0]
    v_fmac_f32 v70, v102, v66
    v_pk_fma_f32 v[68:69], v[64:65], v[98:99], v[68:69] op_sel_hi:[1,0,1]
    s_nop 0
    v_fmac_f32_dpp v70, v66, v103 row_ror:8 row_mask:0xf bank_mask:0xf
    v_pk_fma_f32 v[68:69], v[64:65], v[98:99], v[68:69] op_sel:[1,1,0] op_sel_hi:[0,1,1] neg_lo:[1,0,0]
    s_mov_b64 exec, 0xffff
    buffer_store_dwordx4 v[68:71], v153, s[92:95], s21 offen sc1
    s_mov_b64 exec, -1
    v_and_b32 v110, 1, v152
    v_mul_u32_u24 v110, 640, v110
    v_add_u32 v110, v171, v110
    ds_read2_b32 v[72:73], v165 offset1:160
    ds_read2_b32 v[74:75], v165 offset0:1 offset1:161
    ds_read_b64 v[76:77], v171 offset:0
    ds_read_b64 v[78:79], v110 offset:0
    v_lshrrev_b32 v109, 4, v152
    s_mov_b32 s4, 93696
    v_lshl_add_u32 v108, v109, 5, s4
    v_lshl_add_u32 v109, v109, 4, s4
    ds_read_b128 v[88:91], v108 offset:0
    ds_read_b128 v[92:95], v108 offset:16
    ds_read_b128 v[96:99], v108 offset:128
    ds_read_b128 v[100:103], v108 offset:144
    ds_read_b128 v[104:107], v109 offset:256
    s_lshl_b32 s8, s79, 13
    s_add_u32 s8, s8, 11272192
    s_and_b32 s4, s91, 31
    s_lshl_b32 s4, s4, 2
    s_add_u32 s4, s4, s8
    v_mov_b32 v110, s4
    s_not_b32 s13, s82
    v_mov_b32 v111, s13
    v_and_b32 v87, 31, v152
    v_lshl_add_u32 v87, v87, 2, s8
    s_cmp_eq_u32 s88, 0
    s_cbranch_scc1 Lss_23
    global_store_dword v110, v111, s[50:51]
Lsd_24:
    s_movk_i32 s9, 0x70
    v_lshrrev_b32 v164, 3, v152
    v_lshlrev_b32 v164, 12, v164
    v_and_or_b32 v164, v153, s9, v164
    s_mul_i32 s6, s78, 327680
    s_lshl_b32 s5, s79, 7
    s_add_u32 s6, s6, s5
    s_lshl_b32 s5, s77, 14
    s_add_u32 s7, s6, s5
    s_add_u32 s7, s7, 262144
    s_lshl_b32 s5, s77, 16
    s_add_u32 s6, s6, s5
    s_cmp_ge_u32 s6, 2097152
    s_cselect_b32 s5, 3145728, 0
    s_add_u32 s6, s6, s5
    s_cmp_ge_u32 s7, 2097152
    s_cselect_b32 s5, 3145728, 0
    s_add_u32 s7, s7, s5
    s_lshl_b32 s5, s77, 9
    s_barrier
    s_add_u32 m0, s100, 61440
    s_nop 0
    buffer_load_dwordx4 v164, s[68:71], s6 offen sc1 lds
    s_add_u32 m0, s100, 62464
    s_add_u32 s83, s6, 32768
    buffer_load_dwordx4 v164, s[68:71], s83 offen sc1 lds
    s_add_u32 m0, s5, 69632
    s_mov_b32 exec_hi, 0
    buffer_load_dwordx4 v164, s[68:71], s7 offen sc1 lds
    s_mov_b32 exec_hi, -1
    v_mov_b32 v59, 0
    s_waitcnt lgkmcnt(5)
    v_xor_b32 v76, v170, v76
    v_xor_b32 v78, v170, v78
    v_mov_b32_dpp v56, v60 quad_perm:[0,1,2,3] row_mask:4 bank_mask:0xf
    v_mov_b32_dpp v57, v61 quad_perm:[0,1,2,3] row_mask:4 bank_mask:0xf
    v_mov_b32_dpp v58, v62 quad_perm:[0,1,2,3] row_mask:4 bank_mask:0xf
    v_mov_b32_dpp v56, v64 quad_perm:[0,1,2,3] row_mask:8 bank_mask:0xf
    v_mov_b32_dpp v57, v65 quad_perm:[0,1,2,3] row_mask:8 bank_mask:0xf
    v_mov_b32_dpp v58, v66 quad_perm:[0,1,2,3] row_mask:8 bank_mask:0xf
    v_mov_b32_dpp v56, v59 quad_perm:[0,1,2,3] row_mask:1 bank_mask:0xf
    v_mov_b32_dpp v57, v59 quad_perm:[0,1,2,3] row_mask:1 bank_mask:0xf
    v_mov_b32_dpp v58, v59 quad_perm:[0,1,2,3] row_mask:1 bank_mask:0xf
    v_mul_f32_dpp v63, -v173, v77 row_ror:8 row_mask:0xf bank_mask:0xf
    v_fma_f32 v63, -v76, v173, v63
    v_mul_f32_dpp v84, -v58, v79 row_ror:8 row_mask:0xf bank_mask:0xf
    v_pk_mul_f32 v[80:81], v[72:73], v[56:57] op_sel_hi:[1,0]
    v_pk_mul_f32 v[82:83], v[72:73], v[56:57] op_sel:[0,1]
    v_pk_fma_f32 v[80:81], v[74:75], v[56:57], v[80:81] op_sel:[0,1,0] neg_lo:[1,0,0] neg_hi:[1,0,0]
    v_pk_fma_f32 v[82:83], v[74:75], v[56:57], v[82:83] op_sel_hi:[1,0,1]
    v_fma_f32 v84, -v78, v58, v84
    v_fmac_f32 v81, v72, v124
    v_fmac_f32 v83, v72, v126
    v_fma_f32 v81, -v74, v126, v81
    v_fmac_f32 v83, v74, v124
    v_mov_b32_dpp v59, v63 quad_perm:[0,0,2,2] row_mask:0xf bank_mask:0xf
    s_mov_b32 exec_lo, 0xaaaaaaaa
    s_mov_b32 exec_hi, 0xaaaaaaaa
    v_add_f32 v84, v84, v59
    s_mov_b64 exec, -1
    s_waitcnt lgkmcnt(0)
    v_pk_fma_f32 v[112:113], v[132:133], v[166:167], v[166:167] op_sel:[0,0,1] op_sel_hi:[1,0,1]
    v_pk_fma_f32 v[114:115], v[134:135], v[166:167], v[166:167] op_sel:[0,0,1] op_sel_hi:[1,0,1]
    v_pk_fma_f32 v[132:133], v[112:113], v[88:89], v[132:133]
    v_pk_fma_f32 v[134:135], v[114:115], v[90:91], v[134:135]
    v_pk_fma_f32 v[112:113], v[136:137], v[166:167], v[166:167] op_sel:[0,0,1] op_sel_hi:[1,0,1]
    v_pk_fma_f32 v[114:115], v[138:139], v[166:167], v[166:167] op_sel:[0,0,1] op_sel_hi:[1,0,1]
    v_pk_fma_f32 v[136:137], v[112:113], v[92:93], v[136:137]
    v_pk_fma_f32 v[138:139], v[114:115], v[94:95], v[138:139]
    v_pk_fma_f32 v[112:113], v[140:141], v[166:167], v[166:167] op_sel:[0,0,1] op_sel_hi:[1,0,1]
    v_pk_fma_f32 v[114:115], v[142:143], v[166:167], v[166:167] op_sel:[0,0,1] op_sel_hi:[1,0,1]
    v_pk_fma_f32 v[140:141], v[112:113], v[96:97], v[140:141]
    v_pk_fma_f32 v[142:143], v[114:115], v[98:99], v[142:143]
    v_pk_fma_f32 v[112:113], v[144:145], v[166:167], v[166:167] op_sel:[0,0,1] op_sel_hi:[1,0,1]
    v_pk_fma_f32 v[114:115], v[146:147], v[166:167], v[166:167] op_sel:[0,0,1] op_sel_hi:[1,0,1]
    v_pk_fma_f32 v[144:145], v[112:113], v[100:101], v[144:145]
    v_pk_fma_f32 v[146:147], v[114:115], v[102:103], v[146:147]
    v_pk_fma_f32 v[112:113], v[148:149], v[166:167], v[166:167] op_sel:[0,0,1] op_sel_hi:[1,0,1]
    v_pk_fma_f32 v[114:115], v[150:151], v[166:167], v[166:167] op_sel:[0,0,1] op_sel_hi:[1,0,1]
    v_pk_fma_f32 v[148:149], v[112:113], v[104:105], v[148:149]
    v_pk_fma_f32 v[150:151], v[114:115], v[106:107], v[150:151]
    v_lshrrev_b32 v120, 4, v152
    v_and_b32 v85, 0xf0, v153
    v_lshl_add_u32 v85, v120, 11, v85
    v_add_u32 v85, s21, v85
    v_lshlrev_b32 v120, 3, v120
    v_sub_u32 v120, s79, v120
    v_med3_i32 v120, v120, 0, 8
    v_mul_lo_u32 v86, v120, s82
    v_lshrrev_b32 v120, 4, v152
    v_mul_u32_u24 v120, 640, v120
    v_add_u32 v121, v165, v120
    v_add_u32 v122, v171, v120
    ds_read_b64 v[32:33], v165 offset:9600
    ds_read_b64 v[34:35], v171 offset:9600
    ds_read_b64 v[36:37], v121 offset:5120
    ds_read_b64 v[38:39], v122 offset:5120
    v_add_u32 v121, v121, v120
    v_add_u32 v122, v122, v120
    v_and_b32 v120, 1, v152
    v_mul_u32_u24 v120, 640, v120
    v_add_u32 v122, v122, v120
    ds_read2_b32 v[40:41], v121 offset1:160
    ds_read2_b32 v[42:43], v121 offset0:1 offset1:161
    ds_read_b64 v[44:45], v122 offset:0
    v_mul_f32_dpp v126, -v48, v77 row_ror:8 row_mask:0xf bank_mask:0xf
    v_pk_mul_f32 v[124:125], v[0:1], v[74:75] op_sel_hi:[1,0]
    v_pk_mul_f32 v[0:1], v[0:1], v[72:73] op_sel_hi:[1,0]
    v_pk_fma_f32 v[0:1], v[16:17], v[74:75], v[0:1] op_sel_hi:[1,0,1] neg_lo:[1,0,0] neg_hi:[1,0,0]
    v_pk_fma_f32 v[16:17], v[16:17], v[72:73], v[124:125] op_sel_hi:[1,0,1]
    v_fma_f32 v48, -v76, v48, v126
    v_mul_f32_dpp v126, -v49, v77 row_ror:8 row_mask:0xf bank_mask:0xf
    v_pk_mul_f32 v[124:125], v[2:3], v[74:75] op_sel_hi:[1,0]
    v_pk_mul_f32 v[2:3], v[2:3], v[72:73] op_sel_hi:[1,0]
    v_pk_fma_f32 v[2:3], v[18:19], v[74:75], v[2:3] op_sel_hi:[1,0,1] neg_lo:[1,0,0] neg_hi:[1,0,0]
    v_pk_fma_f32 v[18:19], v[18:19], v[72:73], v[124:125] op_sel_hi:[1,0,1]
    v_fma_f32 v49, -v76, v49, v126
    v_mul_f32_dpp v126, -v50, v77 row_ror:8 row_mask:0xf bank_mask:0xf
    v_pk_mul_f32 v[124:125], v[4:5], v[74:75] op_sel_hi:[1,0]
    v_pk_mul_f32 v[4:5], v[4:5], v[72:73] op_sel_hi:[1,0]
    v_pk_fma_f32 v[4:5], v[20:21], v[74:75], v[4:5] op_sel_hi:[1,0,1] neg_lo:[1,0,0] neg_hi:[1,0,0]
    buffer_load_dwordx4 v[88:91], v85, s[92:95], 0 offen offset:256 sc1
    v_pk_fma_f32 v[20:21], v[20:21], v[72:73], v[124:125] op_sel_hi:[1,0,1]
    v_fma_f32 v50, -v76, v50, v126
    v_mul_f32_dpp v126, -v51, v77 row_ror:8 row_mask:0xf bank_mask:0xf
    v_pk_mul_f32 v[124:125], v[6:7], v[74:75] op_sel_hi:[1,0]
    v_pk_mul_f32 v[6:7], v[6:7], v[72:73] op_sel_hi:[1,0]
    v_pk_fma_f32 v[6:7], v[22:23], v[74:75], v[6:7] op_sel_hi:[1,0,1] neg_lo:[1,0,0] neg_hi:[1,0,0]
    v_pk_fma_f32 v[22:23], v[22:23], v[72:73], v[124:125] op_sel_hi:[1,0,1]
    v_fma_f32 v51, -v76, v51, v126
    v_mul_f32_dpp v126, -v52, v77 row_ror:8 row_mask:0xf bank_mask:0xf
    buffer_load_dwordx4 v[92:95], v85, s[92:95], 0 offen offset:512 sc1
    v_pk_mul_f32 v[124:125], v[8:9], v[74:75] op_sel_hi:[1,0]
    v_pk_mul_f32 v[8:9], v[8:9], v[72:73] op_sel_hi:[1,0]
    v_pk_fma_f32 v[8:9], v[24:25], v[74:75], v[8:9] op_sel_hi:[1,0,1] neg_lo:[1,0,0] neg_hi:[1,0,0]
    v_pk_fma_f32 v[24:25], v[24:25], v[72:73], v[124:125] op_sel_hi:[1,0,1]
    v_fma_f32 v52, -v76, v52, v126
    v_mul_f32_dpp v126, -v53, v77 row_ror:8 row_mask:0xf bank_mask:0xf
    v_pk_mul_f32 v[124:125], v[10:11], v[74:75] op_sel_hi:[1,0]
    v_pk_mul_f32 v[10:11], v[10:11], v[72:73] op_sel_hi:[1,0]
    v_pk_fma_f32 v[10:11], v[26:27], v[74:75], v[10:11] op_sel_hi:[1,0,1] neg_lo:[1,0,0] neg_hi:[1,0,0]
    buffer_load_dwordx4 v[96:99], v85, s[92:95], 0 offen offset:768 sc1
    v_pk_fma_f32 v[26:27], v[26:27], v[72:73], v[124:125] op_sel_hi:[1,0,1]
    v_fma_f32 v53, -v76, v53, v126
    v_mul_f32_dpp v126, -v54, v77 row_ror:8 row_mask:0xf bank_mask:0xf
    v_pk_mul_f32 v[124:125], v[12:13], v[74:75] op_sel_hi:[1,0]
    v_pk_mul_f32 v[12:13], v[12:13], v[72:73] op_sel_hi:[1,0]
    v_pk_fma_f32 v[12:13], v[28:29], v[74:75], v[12:13] op_sel_hi:[1,0,1] neg_lo:[1,0,0] neg_hi:[1,0,0]
    v_pk_fma_f32 v[28:29], v[28:29], v[72:73], v[124:125] op_sel_hi:[1,0,1]
    v_fma_f32 v54, -v76, v54, v126
    v_mul_f32_dpp v126, -v55, v77 row_ror:8 row_mask:0xf bank_mask:0xf
    buffer_load_dwordx4 v[100:103], v85, s[92:95], 0 offen offset:1024 sc1
    v_pk_mul_f32 v[124:125], v[14:15], v[74:75] op_sel_hi:[1,0]
    v_pk_mul_f32 v[14:15], v[14:15], v[72:73] op_sel_hi:[1,0]
    v_pk_fma_f32 v[14:15], v[30:31], v[74:75], v[14:15] op_sel_hi:[1,0,1] neg_lo:[1,0,0] neg_hi:[1,0,0]
    v_pk_fma_f32 v[30:31], v[30:31], v[72:73], v[124:125] op_sel_hi:[1,0,1]
    v_fma_f32 v55, -v76, v55, v126
    s_waitcnt lgkmcnt(0)
    v_xor_b32 v35, v170, v35
    v_xor_b32 v39, v170, v39
    v_xor_b32 v44, v170, v44
    buffer_load_dwordx4 v[104:107], v85, s[92:95], 0 offen offset:1280 sc1
    s_add_u32 s6, s100, 71680
    v_bfe_u32 v63, v152, 4, 1
    v_lshlrev_b32 v63, 6, v63
    v_xor_b32 v56, v63, v153
    v_add_u32 v56, s6, v56
    v_and_b32 v58, 3, v152
    v_lshl_add_u32 v58, v58, 8, s6
    v_lshl_add_u32 v58, v63, 1, v58
    v_bfe_u32 v63, v152, 2, 2
    buffer_load_dwordx4 v[108:111], v85, s[92:95], 0 offen offset:1536 sc1
    v_lshl_add_u32 v58, v63, 4, v58
    v_lshrrev_b32 v57, 5, v152
    v_lshl_add_u32 v58, v57, 3, v58
    v_and_b32 v63, 1, v152
    v_lshl_add_u32 v58, v63, 6, v58
    v_xor_b32 v59, 64, v58
    s_lshl_b32 s3, s77, 10
    s_add_u32 s3, s3, 94016
    v_lshl_add_u32 v60, v63, 2, s3
    buffer_load_dwordx4 v[112:115], v85, s[92:95], 0 offen offset:1792 sc1
    v_lshlrev_b32 v62, 5, v63
    v_bfe_u32 v63, v152, 1, 3
    v_lshl_add_u32 v60, v63, 5, v60
    v_and_b32 v63, 1, v63
    v_lshl_add_u32 v62, v63, 4, v62
    v_and_b32 v63, 0xc0, v153
    v_add_u32 v62, v63, v62
    v_lshrrev_b32 v63, 4, v152
    v_lshl_add_u32 v60, v63, 3, v60
    buffer_load_dwordx4 v[116:119], v85, s[92:95], 0 offen offset:2048 sc1
    v_lshl_add_u32 v61, v63, 7, s3
    v_lshl_add_u32 v61, v152, 3, v61
    v_mul_u32_u24 v63, 40960, v63
    v_add_u32 v62, v63, v62
    v_and_b32 v120, 15, v152
    v_min_u32 v120, 9, v120
    v_lshrrev_b32 v121, 4, v152
    v_mul_u32_u24 v121, 40960, v121
    v_lshl_add_u32 v120, v120, 10, v121
    global_load_dword v64, v87, s[50:51] sc1
    v_sub_u32 v121, v175, v153
    v_add_u32 v158, v120, v121
    s_waitcnt vmcnt(1)
    L_cchk1:
    v_add3_u32 v169, v91, v95, v99
    v_add3_u32 v168, v103, v107, v111
    v_add3_u32 v169, v169, v115, v119
    v_add_u32 v169, v169, v168
    v_cmp_ne_u32 vcc, v169, v86

    s_cbranch_vccnz L_cre1
    v_fmac_f32 v114, v34, v118
    v_pk_fma_f32 v[112:113], v[116:117], v[32:33], v[112:113] op_sel_hi:[1,0,1]
    s_nop 0
    v_fmac_f32_dpp v114, v118, v35 row_ror:8 row_mask:0xf bank_mask:0xf
    v_pk_fma_f32 v[112:113], v[116:117], v[32:33], v[112:113] op_sel:[1,1,0] op_sel_hi:[0,1,1] neg_lo:[1,0,0]
    v_fmac_f32 v110, v34, v114
    v_pk_fma_f32 v[108:109], v[112:113], v[32:33], v[108:109] op_sel_hi:[1,0,1]
    s_nop 0
    v_fmac_f32_dpp v110, v114, v35 row_ror:8 row_mask:0xf bank_mask:0xf
    v_pk_fma_f32 v[108:109], v[112:113], v[32:33], v[108:109] op_sel:[1,1,0] op_sel_hi:[0,1,1] neg_lo:[1,0,0]
    v_fmac_f32 v106, v34, v110
    v_pk_fma_f32 v[104:105], v[108:109], v[32:33], v[104:105] op_sel_hi:[1,0,1]
    s_nop 0
    v_fmac_f32_dpp v106, v110, v35 row_ror:8 row_mask:0xf bank_mask:0xf
    v_pk_fma_f32 v[104:105], v[108:109], v[32:33], v[104:105] op_sel:[1,1,0] op_sel_hi:[0,1,1] neg_lo:[1,0,0]
    v_fmac_f32 v102, v34, v106
    v_pk_fma_f32 v[100:101], v[104:105], v[32:33], v[100:101] op_sel_hi:[1,0,1]
    s_nop 0
    v_fmac_f32_dpp v102, v106, v35 row_ror:8 row_mask:0xf bank_mask:0xf
    v_pk_fma_f32 v[100:101], v[104:105], v[32:33], v[100:101] op_sel:[1,1,0] op_sel_hi:[0,1,1] neg_lo:[1,0,0]
    v_fmac_f32 v98, v34, v102
    v_pk_fma_f32 v[96:97], v[100:101], v[32:33], v[96:97] op_sel_hi:[1,0,1]
    s_nop 0
    v_fmac_f32_dpp v98, v102, v35 row_ror:8 row_mask:0xf bank_mask:0xf
    v_pk_fma_f32 v[96:97], v[100:101], v[32:33], v[96:97] op_sel:[1,1,0] op_sel_hi:[0,1,1] neg_lo:[1,0,0]
    v_fmac_f32 v94, v34, v98
    v_pk_fma_f32 v[92:93], v[96:97], v[32:33], v[92:93] op_sel_hi:[1,0,1]
    s_nop 0
    v_fmac_f32_dpp v94, v98, v35 row_ror:8 row_mask:0xf bank_mask:0xf
    v_pk_fma_f32 v[92:93], v[96:97], v[32:33], v[92:93] op_sel:[1,1,0] op_sel_hi:[0,1,1] neg_lo:[1,0,0]
    v_fmac_f32 v90, v34, v94
    v_pk_fma_f32 v[88:89], v[92:93], v[32:33], v[88:89] op_sel_hi:[1,0,1]
    s_nop 0
    v_fmac_f32_dpp v90, v94, v35 row_ror:8 row_mask:0xf bank_mask:0xf
    v_pk_fma_f32 v[88:89], v[92:93], v[32:33], v[88:89] op_sel:[1,1,0] op_sel_hi:[0,1,1] neg_lo:[1,0,0]
    v_mul_f32 v94, v38, v90
    v_pk_mul_f32 v[92:93], v[88:89], v[36:37] op_sel_hi:[1,0]
    s_nop 0
    v_fmac_f32_dpp v94, v90, v39 row_ror:8 row_mask:0xf bank_mask:0xf
    v_pk_fma_f32 v[92:93], v[88:89], v[36:37], v[92:93] op_sel:[1,1,0] op_sel_hi:[0,1,1] neg_lo:[1,0,0]

    v_mov_b32 v98, v94
    v_mov_b64 v[96:97], v[92:93]
    s_nop 0
    v_permlane32_swap_b32 v94, v98
    v_permlane32_swap_b32 v92, v96
    v_permlane32_swap_b32 v93, v97
    v_add_f32 v94, v94, v98
    v_pk_add_f32 v[92:93], v[92:93], v[96:97]

    v_mov_b32 v98, v94
    v_mov_b64 v[96:97], v[92:93]
    s_nop 0
    v_permlane16_swap_b32 v94, v98
    v_permlane16_swap_b32 v92, v96
    v_permlane16_swap_b32 v93, v97
    v_add_f32 v94, v94, v98
    v_pk_add_f32 v[92:93], v[92:93], v[96:97]

    v_fma_f32 v84, -v44, v94, v84
    v_pk_fma_f32 v[80:81], v[40:41], v[92:93], v[80:81] op_sel_hi:[1,0,1]
    v_pk_fma_f32 v[82:83], v[40:41], v[92:93], v[82:83] op_sel:[0,1,0]
    v_fmac_f32_dpp v84, -v94, v45 row_ror:8 row_mask:0xf bank_mask:0xf
    v_pk_fma_f32 v[80:81], v[42:43], v[92:93], v[80:81] op_sel:[0,1,0] neg_lo:[1,0,0] neg_hi:[1,0,0]
    v_pk_fma_f32 v[82:83], v[42:43], v[92:93], v[82:83] op_sel_hi:[1,0,1]

    v_fmac_f32 v48, v130, v84
    v_pk_fma_f32 v[0:1], v[80:81], v[128:129], v[0:1] op_sel_hi:[1,0,1]
    v_pk_fma_f32 v[16:17], v[82:83], v[128:129], v[16:17] op_sel_hi:[1,0,1]
    v_fmac_f32_dpp v48, -v84, v131 row_ror:8 row_mask:0xf bank_mask:0xf
    v_pk_fma_f32 v[0:1], v[82:83], v[128:129], v[0:1] op_sel:[0,1,0] neg_lo:[1,0,0] neg_hi:[1,0,0]
    v_fmac_f32 v49, v130, v48
    v_pk_fma_f32 v[16:17], v[80:81], v[128:129], v[16:17] op_sel:[0,1,0]
    s_nop 0
    v_fmac_f32_dpp v49, -v48, v131 row_ror:8 row_mask:0xf bank_mask:0xf
    v_fmac_f32 v50, v130, v49
    v_pk_fma_f32 v[2:3], v[0:1], v[128:129], v[2:3] op_sel_hi:[1,0,1]
    v_pk_fma_f32 v[18:19], v[16:17], v[128:129], v[18:19] op_sel_hi:[1,0,1]
    v_fmac_f32_dpp v50, -v49, v131 row_ror:8 row_mask:0xf bank_mask:0xf
    v_pk_fma_f32 v[2:3], v[16:17], v[128:129], v[2:3] op_sel:[0,1,0] neg_lo:[1,0,0] neg_hi:[1,0,0]
    v_fmac_f32 v51, v130, v50
    v_pk_fma_f32 v[18:19], v[0:1], v[128:129], v[18:19] op_sel:[0,1,0]
    s_nop 0
    v_fmac_f32_dpp v51, -v50, v131 row_ror:8 row_mask:0xf bank_mask:0xf
    v_cvt_pk_bf16_f32 v104, v0, v1
    v_cvt_pk_bf16_f32 v105, v2, v3
    v_cvt_pk_bf16_f32 v106, -v16, -v17
    v_cvt_pk_bf16_f32 v107, -v18, -v19

    ds_write_b128 v56, v[104:107] offset:0
    ds_read_b64_tr_b16 v[88:89], v58 offset:0
    ds_read_b64_tr_b16 v[90:91], v59 offset:0
    v_fmac_f32 v52, v130, v51
    v_pk_fma_f32 v[4:5], v[2:3], v[128:129], v[4:5] op_sel_hi:[1,0,1]
    v_pk_fma_f32 v[20:21], v[18:19], v[128:129], v[20:21] op_sel_hi:[1,0,1]
    v_fmac_f32_dpp v52, -v51, v131 row_ror:8 row_mask:0xf bank_mask:0xf
    v_pk_fma_f32 v[4:5], v[18:19], v[128:129], v[4:5] op_sel:[0,1,0] neg_lo:[1,0,0] neg_hi:[1,0,0]
    v_fmac_f32 v53, v130, v52
    v_pk_fma_f32 v[20:21], v[2:3], v[128:129], v[20:21] op_sel:[0,1,0]
    s_nop 0
    v_fmac_f32_dpp v53, -v52, v131 row_ror:8 row_mask:0xf bank_mask:0xf
    v_fmac_f32 v54, v130, v53
    v_pk_fma_f32 v[6:7], v[4:5], v[128:129], v[6:7] op_sel_hi:[1,0,1]
    v_pk_fma_f32 v[22:23], v[20:21], v[128:129], v[22:23] op_sel_hi:[1,0,1]
    v_fmac_f32_dpp v54, -v53, v131 row_ror:8 row_mask:0xf bank_mask:0xf
    v_pk_fma_f32 v[6:7], v[20:21], v[128:129], v[6:7] op_sel:[0,1,0] neg_lo:[1,0,0] neg_hi:[1,0,0]
    v_fmac_f32 v55, v130, v54
    v_pk_fma_f32 v[22:23], v[4:5], v[128:129], v[22:23] op_sel:[0,1,0]
    s_nop 0
    v_fmac_f32_dpp v55, -v54, v131 row_ror:8 row_mask:0xf bank_mask:0xf
    v_cvt_pk_bf16_f32 v108, v4, v5
    v_cvt_pk_bf16_f32 v109, v6, v7
    v_cvt_pk_bf16_f32 v110, -v20, -v21
    v_cvt_pk_bf16_f32 v111, -v22, -v23

    ds_write_b128 v56, v[108:111] offset:1024
    ds_read_b64_tr_b16 v[92:93], v58 offset:1024
    ds_read_b64_tr_b16 v[94:95], v59 offset:1024
    v_pk_fma_f32 v[8:9], v[6:7], v[128:129], v[8:9] op_sel_hi:[1,0,1]
    v_pk_fma_f32 v[24:25], v[22:23], v[128:129], v[24:25] op_sel_hi:[1,0,1]
    v_pk_fma_f32 v[8:9], v[22:23], v[128:129], v[8:9] op_sel:[0,1,0] neg_lo:[1,0,0] neg_hi:[1,0,0]
    v_pk_fma_f32 v[24:25], v[6:7], v[128:129], v[24:25] op_sel:[0,1,0]
    v_cvt_pk_bf16_f32 v112, v48, v49
    v_cvt_pk_bf16_f32 v113, v50, v51
    v_cvt_pk_bf16_f32 v114, v52, v53
    v_cvt_pk_bf16_f32 v115, v54, v55
    ds_write2st64_b32 v60, v112, v113 offset0:0 offset1:1
    ds_write2st64_b32 v60, v114, v115 offset0:2 offset1:3
    ds_read_b64_tr_b16 v[116:117], v61 offset:0
    ds_read_b64_tr_b16 v[118:119], v61 offset:128
    v_pk_fma_f32 v[10:11], v[8:9], v[128:129], v[10:11] op_sel_hi:[1,0,1]
    v_pk_fma_f32 v[26:27], v[24:25], v[128:129], v[26:27] op_sel_hi:[1,0,1]
    v_pk_fma_f32 v[10:11], v[24:25], v[128:129], v[10:11] op_sel:[0,1,0] neg_lo:[1,0,0] neg_hi:[1,0,0]
    v_pk_fma_f32 v[26:27], v[8:9], v[128:129], v[26:27] op_sel:[0,1,0]
    v_cvt_pk_bf16_f32 v104, v8, v9
    v_cvt_pk_bf16_f32 v105, v10, v11
    v_cvt_pk_bf16_f32 v106, -v24, -v25
    v_cvt_pk_bf16_f32 v107, -v26, -v27

    ds_write_b128 v56, v[104:107] offset:0
    ds_read_b64_tr_b16 v[96:97], v58 offset:0
    ds_read_b64_tr_b16 v[98:99], v59 offset:0
    s_waitcnt vmcnt(0)
L_xr:
    v_cmp_ne_u32 vcc, s13, v64
    s_cbranch_vccnz L_xr_re
    s_waitcnt lgkmcnt(10)
    v_and_b32 v88, -2, v88
    v_and_b32 v90, -2, v90
    s_cmp_eq_u32 s88, 0
    s_cbranch_scc1 Lss_25
    buffer_store_dwordx4 v[88:91], v153, s[64:67], s36 offen
Lsd_26:
    v_pk_fma_f32 v[12:13], v[10:11], v[128:129], v[12:13] op_sel_hi:[1,0,1]
    v_pk_fma_f32 v[28:29], v[26:27], v[128:129], v[28:29] op_sel_hi:[1,0,1]
    v_pk_fma_f32 v[12:13], v[26:27], v[128:129], v[12:13] op_sel:[0,1,0] neg_lo:[1,0,0] neg_hi:[1,0,0]
    v_pk_fma_f32 v[28:29], v[10:11], v[128:129], v[28:29] op_sel:[0,1,0]
    v_pk_fma_f32 v[14:15], v[12:13], v[128:129], v[14:15] op_sel_hi:[1,0,1]
    v_pk_fma_f32 v[30:31], v[28:29], v[128:129], v[30:31] op_sel_hi:[1,0,1]
    v_pk_fma_f32 v[14:15], v[28:29], v[128:129], v[14:15] op_sel:[0,1,0] neg_lo:[1,0,0] neg_hi:[1,0,0]
    v_pk_fma_f32 v[30:31], v[12:13], v[128:129], v[30:31] op_sel:[0,1,0]
    v_cvt_pk_bf16_f32 v108, v12, v13
    v_cvt_pk_bf16_f32 v109, v14, v15
    v_cvt_pk_bf16_f32 v110, -v28, -v29
    v_cvt_pk_bf16_f32 v111, -v30, -v31

    ds_write_b128 v56, v[108:111] offset:1024
    ds_read_b64_tr_b16 v[100:101], v58 offset:1024
    ds_read_b64_tr_b16 v[102:103], v59 offset:1024
    s_waitcnt lgkmcnt(10)
    v_and_b32 v92, -2, v92
    v_and_b32 v94, -2, v94
    s_cmp_eq_u32 s88, 0
    s_cbranch_scc1 Lss_27
    buffer_store_dwordx4 v[92:95], v153, s[64:67], s18 offen
Lsd_28:
    s_waitcnt lgkmcnt(6)
    v_and_b32 v116, -2, v116
    v_and_b32 v118, -2, v118
    s_cmp_eq_u32 s88, 0
    s_cbranch_scc1 Lss_29
    buffer_store_dwordx2 v[116:117], v62, s[64:67], s37 offen offset:0
    buffer_store_dwordx2 v[118:119], v62, s[64:67], s37 offen offset:512
Lsd_30:
    s_waitcnt lgkmcnt(3)
    v_and_b32 v96, -2, v96
    v_and_b32 v98, -2, v98
    s_cmp_eq_u32 s88, 0
    s_cbranch_scc1 Lss_31
    buffer_store_dwordx4 v[96:99], v153, s[64:67], s19 offen
Lsd_32:
    s_waitcnt lgkmcnt(0)
    v_and_b32 v100, -2, v100
    v_and_b32 v102, -2, v102
    s_cmp_eq_u32 s88, 0
    s_cbranch_scc1 Lss_33
    buffer_store_dwordx4 v[100:103], v153, s[64:67], s20 offen
Lsd_34:
    s_lshl_b32 s8, s77, 2
    s_add_u32 s8, s8, 61440
    v_bfe_u32 v121, v152, 4, 2
    v_lshl_add_u32 v120, v121, 5, s8
    v_bfe_u32 v121, v152, 2, 1
    v_lshl_add_u32 v120, v121, 4, v120
    v_bfe_u32 v121, v152, 3, 1
    v_lshl_add_u32 v120, v121, 1, v120
    v_and_b32 v121, 3, v152
    v_lshl_add_u32 v120, v121, 9, v120
    s_barrier
    v_accvgpr_write_b32 a0, 0
    v_accvgpr_write_b32 a1, 0
    v_accvgpr_write_b32 a2, 0
    ds_read_u16_d16_hi a0, v120 offset:0
    v_accvgpr_write_b32 a3, 0
    ds_read_u16_d16_hi a1, v120 offset:128
    v_accvgpr_write_b32 a4, 0
    ds_read_u16_d16_hi a2, v120 offset:256
    v_accvgpr_write_b32 a5, 0
    ds_read_u16_d16_hi a3, v120 offset:384
    v_accvgpr_write_b32 a6, 0
    ds_read_u16_d16_hi a4, v120 offset:2048
    v_accvgpr_write_b32 a7, 0
    ds_read_u16_d16_hi a5, v120 offset:2176
    v_accvgpr_write_b32 a8, 0
    ds_read_u16_d16_hi a6, v120 offset:2304
    v_accvgpr_write_b32 a9, 0
    ds_read_u16_d16_hi a7, v120 offset:2432
    v_accvgpr_write_b32 a10, 0
    ds_read_u16_d16_hi a8, v120 offset:4096
    v_accvgpr_write_b32 a11, 0
    ds_read_u16_d16_hi a9, v120 offset:4224
    v_accvgpr_write_b32 a12, 0
    ds_read_u16_d16_hi a10, v120 offset:4352
    v_accvgpr_write_b32 a13, 0
    ds_read_u16_d16_hi a11, v120 offset:4480
    v_accvgpr_write_b32 a14, 0
    ds_read_u16_d16_hi a12, v120 offset:6144
    v_accvgpr_write_b32 a15, 0
    ds_read_u16_d16_hi a13, v120 offset:6272
    v_accvgpr_write_b32 a16, 0
    ds_read_u16_d16_hi a14, v120 offset:6400
    v_accvgpr_write_b32 a17, 0
    ds_read_u16_d16_hi a15, v120 offset:6528
    v_accvgpr_write_b32 a18, 0
    ds_read_u16_d16_hi a16, v120 offset:8192
    v_accvgpr_write_b32 a19, 0
    ds_read_u16_d16_hi a17, v120 offset:8320
    ds_read_u16_d16_hi a18, v120 offset:8448
    ds_read_u16_d16_hi a19, v120 offset:8576
L_hp:
    s_sub_u32 s101, s101, 1
    s_cbranch_scc1 L_end
    buffer_load_dwordx4 v[40:43], v175, s[64:67], s23 offen offset:0 sc1
    buffer_load_dwordx4 v[44:47], v175, s[64:67], s23 offen offset:1024 sc1
    buffer_load_dwordx4 v[48:51], v175, s[64:67], s23 offen offset:2048 sc1
    buffer_load_dwordx4 v[120:123], v175, s[64:67], s22 offen offset:0 sc1
    buffer_load_dwordx4 v[80:83], v175, s[64:67], s25 offen offset:0 sc1
    buffer_load_dwordx4 v[116:119], v175, s[64:67], s28 offen offset:0 sc1
    buffer_load_dwordx4 v[64:67], v175, s[64:67], s31 offen offset:0 sc1
    s_waitcnt vmcnt(4)
    v_bitop3_b32 v169, v40, v42, v44 bitop3:254
    v_bitop3_b32 v169, v169, v46, v48 bitop3:254
    v_bitop3_b32 v169, v169, v50, 1 bitop3:168
    v_cmp_ne_u32 vcc, 0, v169
    s_cbranch_vccnz L_hp
    v_mfma_f32_16x16x32_bf16 v[132:135], a[232:235], v[40:43], v[132:135]
    buffer_load_dwordx4 v[60:63], v175, s[64:67], s22 offen offset:1024 sc1
    v_mfma_f32_16x16x32_bf16 v[136:139], v[176:179], v[40:43], v[136:139]
    v_mfma_f32_16x16x32_bf16 v[140:143], v[192:195], v[40:43], v[140:143]
    v_mfma_f32_16x16x32_bf16 v[144:147], v[208:211], v[40:43], v[144:147]
    v_mfma_f32_16x16x32_bf16 v[148:151], a[216:219], v[40:43], v[148:151]
    buffer_load_dwordx4 v[68:71], v175, s[64:67], s25 offen offset:1024 sc1
    v_mfma_f32_16x16x32_bf16 v[132:135], a[236:239], v[44:47], v[132:135]
    v_mfma_f32_16x16x32_bf16 v[136:139], v[180:183], v[44:47], v[136:139]
    v_mfma_f32_16x16x32_bf16 v[140:143], v[196:199], v[44:47], v[140:143]
    v_mfma_f32_16x16x32_bf16 v[144:147], v[212:215], v[44:47], v[144:147]
    ds_read_b128 v[124:127], v156 offset:0
    buffer_load_dwordx4 v[72:75], v175, s[64:67], s28 offen offset:1024 sc1
    s_waitcnt vmcnt(3)
    v_bitop3_b32 v169, v120, v122, v80 bitop3:254
    v_bitop3_b32 v169, v169, v82, v116 bitop3:254
    v_bitop3_b32 v169, v169, v118, v64 bitop3:254
    v_mfma_f32_16x16x32_bf16 v[148:151], a[220:223], v[44:47], v[148:151]
    v_bitop3_b32 v169, v169, v66, 1 bitop3:168
    v_cmp_ne_u32 s[96:97], 0, v169
    v_mfma_f32_16x16x32_bf16 v[132:135], a[240:243], v[48:51], v[132:135]
    v_mfma_f32_16x16x32_bf16 v[136:139], v[184:187], v[48:51], v[136:139]
    v_mfma_f32_16x16x32_bf16 v[140:143], v[200:203], v[48:51], v[140:143]
    ds_read_b128 v[128:131], v156 offset:8192
    buffer_load_dwordx4 v[76:79], v175, s[64:67], s31 offen offset:1024 sc1
    v_mfma_f32_16x16x32_bf16 v[144:147], v[216:219], v[48:51], v[144:147]
    v_mfma_f32_16x16x32_bf16 v[148:151], a[224:227], v[48:51], v[148:151]
    s_cmp_lg_u64 s[96:97], 0
    s_cbranch_scc1 Lh1c1r
Lh1c1:
    v_mfma_f32_16x16x32_bf16 v[148:151], a[200:203], v[120:123], v[148:151]
    v_mfma_f32_16x16x32_bf16 v[40:43], a[200:203], v[80:83], 0
    ds_read_b128 v[112:115], v156 offset:12288
    buffer_load_dwordx4 v[84:87], v175, s[64:67], s22 offen offset:2048 sc1
    v_mfma_f32_16x16x32_bf16 v[44:47], a[200:203], v[116:119], 0
    v_mfma_f32_16x16x32_bf16 v[48:51], a[200:203], v[64:67], 0
    s_waitcnt lgkmcnt(2)
    v_mfma_f32_16x16x32_bf16 v[132:135], v[124:127], v[120:123], v[132:135]
    v_mfma_f32_16x16x32_bf16 v[52:55], v[124:127], v[80:83], 0
    buffer_load_dwordx4 v[88:91], v175, s[64:67], s25 offen offset:2048 sc1
    v_mfma_f32_16x16x32_bf16 v[56:59], v[124:127], v[116:119], 0
    v_mfma_f32_16x16x32_bf16 v[0:3], v[124:127], v[64:67], 0
    ds_read_b128 v[124:127], v156 offset:4096
    s_waitcnt lgkmcnt(2)
    v_mfma_f32_16x16x32_bf16 v[140:143], v[128:131], v[120:123], v[140:143]
    v_mfma_f32_16x16x32_bf16 v[4:7], v[128:131], v[80:83], 0
    buffer_load_dwordx4 v[92:95], v175, s[64:67], s28 offen offset:2048 sc1
    v_mfma_f32_16x16x32_bf16 v[8:11], v[128:131], v[116:119], 0
    v_mfma_f32_16x16x32_bf16 v[12:15], v[128:131], v[64:67], 0
    ds_read_b128 v[128:131], v157 offset:0
    s_waitcnt lgkmcnt(2)
    v_mfma_f32_16x16x32_bf16 v[144:147], v[112:115], v[120:123], v[144:147]
    v_mfma_f32_16x16x32_bf16 v[28:31], v[112:115], v[80:83], 0
    buffer_load_dwordx4 v[96:99], v175, s[64:67], s31 offen offset:2048 sc1
    s_waitcnt vmcnt(4)
    v_bitop3_b32 v169, v60, v62, v68 bitop3:254
    v_bitop3_b32 v169, v169, v70, v72 bitop3:254
    v_bitop3_b32 v169, v169, v74, v76 bitop3:254
    v_mfma_f32_16x16x32_bf16 v[32:35], v[112:115], v[116:119], 0
    v_bitop3_b32 v169, v169, v78, 1 bitop3:168
    v_cmp_ne_u32 s[96:97], 0, v169
    v_mfma_f32_16x16x32_bf16 v[36:39], v[112:115], v[64:67], 0
    ds_read_b128 v[112:115], v157 offset:8192
    s_waitcnt lgkmcnt(2)
    v_mfma_f32_16x16x32_bf16 v[136:139], v[124:127], v[120:123], v[136:139]
    v_mfma_f32_16x16x32_bf16 v[16:19], v[124:127], v[80:83], 0
    buffer_load_dwordx4 v[100:103], v175, s[64:67], s22 offen offset:3072 sc1
    v_mfma_f32_16x16x32_bf16 v[20:23], v[124:127], v[116:119], 0
    v_mfma_f32_16x16x32_bf16 v[24:27], v[124:127], v[64:67], 0
    ds_read_b128 v[124:127], v157 offset:12288
    s_cmp_lg_u64 s[96:97], 0
    s_cbranch_scc1 Lh1c2r
Lh1c2:
    v_mfma_f32_16x16x32_bf16 v[148:151], a[204:207], v[60:63], v[148:151]
    v_mfma_f32_16x16x32_bf16 v[40:43], a[204:207], v[68:71], v[40:43]
    buffer_load_dwordx4 v[104:107], v175, s[64:67], s25 offen offset:3072 sc1
    v_mfma_f32_16x16x32_bf16 v[44:47], a[204:207], v[72:75], v[44:47]
    v_mfma_f32_16x16x32_bf16 v[48:51], a[204:207], v[76:79], v[48:51]
    s_waitcnt lgkmcnt(2)
    v_mfma_f32_16x16x32_bf16 v[132:135], v[128:131], v[60:63], v[132:135]
    v_mfma_f32_16x16x32_bf16 v[52:55], v[128:131], v[68:71], v[52:55]
    buffer_load_dwordx4 v[108:111], v175, s[64:67], s28 offen offset:3072 sc1
    v_mfma_f32_16x16x32_bf16 v[56:59], v[128:131], v[72:75], v[56:59]
    v_mfma_f32_16x16x32_bf16 v[0:3], v[128:131], v[76:79], v[0:3]
    ds_read_b128 v[128:131], v157 offset:4096
    s_waitcnt lgkmcnt(2)
    v_mfma_f32_16x16x32_bf16 v[140:143], v[112:115], v[60:63], v[140:143]
    v_mfma_f32_16x16x32_bf16 v[4:7], v[112:115], v[68:71], v[4:7]
    buffer_load_dwordx4 v[120:123], v175, s[64:67], s31 offen offset:3072 sc1
    v_mfma_f32_16x16x32_bf16 v[8:11], v[112:115], v[72:75], v[8:11]
    v_mfma_f32_16x16x32_bf16 v[12:15], v[112:115], v[76:79], v[12:15]
    ds_read_b128 v[112:115], v156 offset:512
    s_waitcnt lgkmcnt(2)
    v_mfma_f32_16x16x32_bf16 v[144:147], v[124:127], v[60:63], v[144:147]
    v_mfma_f32_16x16x32_bf16 v[28:31], v[124:127], v[68:71], v[28:31]
    buffer_load_dwordx4 v[80:83], v175, s[64:67], s26 offen offset:0 sc1
    s_waitcnt vmcnt(5)
    v_bitop3_b32 v169, v84, v86, v88 bitop3:254
    v_bitop3_b32 v169, v169, v90, v92 bitop3:254
    v_bitop3_b32 v169, v169, v94, v96 bitop3:254
    v_mfma_f32_16x16x32_bf16 v[32:35], v[124:127], v[72:75], v[32:35]
    v_bitop3_b32 v169, v169, v98, 1 bitop3:168
    v_cmp_ne_u32 s[96:97], 0, v169
    v_mfma_f32_16x16x32_bf16 v[36:39], v[124:127], v[76:79], v[36:39]
    ds_read_b128 v[124:127], v156 offset:8704
    s_waitcnt lgkmcnt(2)
    v_mfma_f32_16x16x32_bf16 v[136:139], v[128:131], v[60:63], v[136:139]
    v_mfma_f32_16x16x32_bf16 v[16:19], v[128:131], v[68:71], v[16:19]
    buffer_load_dwordx4 v[116:119], v175, s[64:67], s26 offen offset:1024 sc1
    v_mfma_f32_16x16x32_bf16 v[20:23], v[128:131], v[72:75], v[20:23]
    v_mfma_f32_16x16x32_bf16 v[24:27], v[128:131], v[76:79], v[24:27]
    ds_read_b128 v[128:131], v156 offset:12800
    s_cmp_lg_u64 s[96:97], 0
    s_cbranch_scc1 Lh1c3r
Lh1c3:
    v_mfma_f32_16x16x32_bf16 v[148:151], a[208:211], v[84:87], v[148:151]
    v_mfma_f32_16x16x32_bf16 v[40:43], a[208:211], v[88:91], v[40:43]
    buffer_load_dwordx4 v[64:67], v175, s[64:67], s26 offen offset:2048 sc1
    v_mfma_f32_16x16x32_bf16 v[44:47], a[208:211], v[92:95], v[44:47]
    v_mfma_f32_16x16x32_bf16 v[48:51], a[208:211], v[96:99], v[48:51]
    s_waitcnt lgkmcnt(2)
    v_mfma_f32_16x16x32_bf16 v[132:135], v[112:115], v[84:87], v[132:135]
    v_mfma_f32_16x16x32_bf16 v[52:55], v[112:115], v[88:91], v[52:55]
    buffer_load_dwordx4 v[60:63], v175, s[64:67], s26 offen offset:3072 sc1
    v_mfma_f32_16x16x32_bf16 v[56:59], v[112:115], v[92:95], v[56:59]
    v_mfma_f32_16x16x32_bf16 v[0:3], v[112:115], v[96:99], v[0:3]
    ds_read_b128 v[112:115], v156 offset:4608
    s_waitcnt lgkmcnt(2)
    v_mfma_f32_16x16x32_bf16 v[140:143], v[124:127], v[84:87], v[140:143]
    v_mfma_f32_16x16x32_bf16 v[4:7], v[124:127], v[88:91], v[4:7]
    buffer_load_dwordx4 v[68:71], v175, s[64:67], s27 offen offset:0 sc1
    v_mfma_f32_16x16x32_bf16 v[8:11], v[124:127], v[92:95], v[8:11]
    v_mfma_f32_16x16x32_bf16 v[12:15], v[124:127], v[96:99], v[12:15]
    ds_read_b128 v[124:127], v157 offset:512
    s_waitcnt lgkmcnt(2)
    v_mfma_f32_16x16x32_bf16 v[144:147], v[128:131], v[84:87], v[144:147]
    v_mfma_f32_16x16x32_bf16 v[28:31], v[128:131], v[88:91], v[28:31]
    buffer_load_dwordx4 v[72:75], v175, s[64:67], s27 offen offset:1024 sc1
    s_waitcnt vmcnt(6)
    v_bitop3_b32 v169, v100, v102, v104 bitop3:254
    v_bitop3_b32 v169, v169, v106, v108 bitop3:254
    v_bitop3_b32 v169, v169, v110, v120 bitop3:254
    v_mfma_f32_16x16x32_bf16 v[32:35], v[128:131], v[92:95], v[32:35]
    v_bitop3_b32 v169, v169, v122, 1 bitop3:168
    v_cmp_ne_u32 s[96:97], 0, v169
    v_mfma_f32_16x16x32_bf16 v[36:39], v[128:131], v[96:99], v[36:39]
    ds_read_b128 v[128:131], v157 offset:8704
    s_waitcnt lgkmcnt(2)
    v_mfma_f32_16x16x32_bf16 v[136:139], v[112:115], v[84:87], v[136:139]
    v_mfma_f32_16x16x32_bf16 v[16:19], v[112:115], v[88:91], v[16:19]
    buffer_load_dwordx4 v[76:79], v175, s[64:67], s29 offen offset:0 sc1
    v_mfma_f32_16x16x32_bf16 v[20:23], v[112:115], v[92:95], v[20:23]
    v_mfma_f32_16x16x32_bf16 v[24:27], v[112:115], v[96:99], v[24:27]
    ds_read_b128 v[112:115], v157 offset:12800
    s_cmp_lg_u64 s[96:97], 0
    s_cbranch_scc1 Lh1c4r
Lh1c4:
    v_mfma_f32_16x16x32_bf16 v[148:151], a[212:215], v[100:103], v[148:151]
    v_mfma_f32_16x16x32_bf16 v[40:43], a[212:215], v[104:107], v[40:43]
    buffer_load_dwordx4 v[84:87], v175, s[64:67], s29 offen offset:1024 sc1
    v_mfma_f32_16x16x32_bf16 v[44:47], a[212:215], v[108:111], v[44:47]
    v_mfma_f32_16x16x32_bf16 v[48:51], a[212:215], v[120:123], v[48:51]
    s_waitcnt lgkmcnt(2)
    v_mfma_f32_16x16x32_bf16 v[132:135], v[124:127], v[100:103], v[132:135]
    v_mfma_f32_16x16x32_bf16 v[52:55], v[124:127], v[104:107], v[52:55]
    buffer_load_dwordx4 v[88:91], v175, s[64:67], s29 offen offset:2048 sc1
    v_mfma_f32_16x16x32_bf16 v[56:59], v[124:127], v[108:111], v[56:59]
    v_mfma_f32_16x16x32_bf16 v[0:3], v[124:127], v[120:123], v[0:3]
    ds_read_b128 v[124:127], v157 offset:4608
    s_waitcnt lgkmcnt(2)
    v_mfma_f32_16x16x32_bf16 v[140:143], v[128:131], v[100:103], v[140:143]
    v_mfma_f32_16x16x32_bf16 v[4:7], v[128:131], v[104:107], v[4:7]
    buffer_load_dwordx4 v[92:95], v175, s[64:67], s29 offen offset:3072 sc1
    v_mfma_f32_16x16x32_bf16 v[8:11], v[128:131], v[108:111], v[8:11]
    v_mfma_f32_16x16x32_bf16 v[12:15], v[128:131], v[120:123], v[12:15]
    s_waitcnt lgkmcnt(1)
    v_mfma_f32_16x16x32_bf16 v[144:147], v[112:115], v[100:103], v[144:147]
    v_mfma_f32_16x16x32_bf16 v[28:31], v[112:115], v[104:107], v[28:31]
    buffer_load_dwordx4 v[96:99], v175, s[64:67], s30 offen offset:0 sc1
    s_waitcnt vmcnt(5)
    v_bitop3_b32 v169, v80, v82, v116 bitop3:254
    v_bitop3_b32 v169, v169, v118, v64 bitop3:254
    v_bitop3_b32 v169, v169, v66, v60 bitop3:254
    v_mfma_f32_16x16x32_bf16 v[32:35], v[112:115], v[108:111], v[32:35]
    v_bitop3_b32 v169, v169, v62, v68 bitop3:254
    v_bitop3_b32 v169, v169, v70, v72 bitop3:254
    v_bitop3_b32 v169, v169, v74, 1 bitop3:168
    v_mfma_f32_16x16x32_bf16 v[36:39], v[112:115], v[120:123], v[36:39]
    v_cmp_ne_u32 s[96:97], 0, v169
    s_waitcnt lgkmcnt(0)
    v_mfma_f32_16x16x32_bf16 v[136:139], v[124:127], v[100:103], v[136:139]
    v_mfma_f32_16x16x32_bf16 v[16:19], v[124:127], v[104:107], v[16:19]
    buffer_load_dwordx4 v[100:103], v175, s[64:67], s30 offen offset:1024 sc1
    v_mfma_f32_16x16x32_bf16 v[20:23], v[124:127], v[108:111], v[20:23]
    v_mfma_f32_16x16x32_bf16 v[24:27], v[124:127], v[120:123], v[24:27]
    s_cmp_lg_u64 s[96:97], 0
    s_cbranch_scc1 Lh1c5r
Lh1c5:
    v_mfma_f32_16x16x32_bf16 v[52:55], a[232:235], v[80:83], v[52:55]
    v_mfma_f32_16x16x32_bf16 v[52:55], a[236:239], v[116:119], v[52:55]
    buffer_load_dwordx4 v[104:107], v175, s[64:67], s32 offen offset:0 sc1
    v_mfma_f32_16x16x32_bf16 v[52:55], a[240:243], v[64:67], v[52:55]
    v_mfma_f32_16x16x32_bf16 v[52:55], a[244:247], v[60:63], v[52:55]
    s_add_u32 s3, s77, 1
    s_and_b32 s3, s3, 3
    s_mul_i32 s3, s3, 15360
    v_add_u32 v165, s3, v153
    v_mfma_f32_16x16x32_bf16 v[52:55], v[224:227], v[68:71], v[52:55]
    s_mul_i32 s8, s77, 15360
    s_movk_i32 s9, 320
    v_and_b32 v124, 15, v152
    v_lshrrev_b32 v112, 4, v152
    v_mfma_f32_16x16x32_bf16 v[52:55], v[228:231], v[72:75], v[52:55]
    buffer_load_dwordx4 v[108:111], v175, s[64:67], s32 offen offset:1024 sc1
    v_bfe_u32 v113, v152, 1, 2
    v_mov_b32 v114, s8
    v_mfma_f32_16x16x32_bf16 v[16:19], v[176:179], v[80:83], v[16:19]
    v_mad_u32_u24 v124, v124, s9, v114
    v_xor_b32 v126, v112, v113
    v_mfma_f32_16x16x32_bf16 v[16:19], v[180:183], v[116:119], v[16:19]
    v_lshl_add_u32 v126, v126, 4, v124
    v_lshrrev_b32 v115, 1, v112
    v_mfma_f32_16x16x32_bf16 v[16:19], v[184:187], v[64:67], v[16:19]
    ds_write_b128 v165, v[52:55] offset:0
    v_lshl_add_u32 v124, v115, 6, v124
    v_and_b32 v115, 1, v112
    v_mfma_f32_16x16x32_bf16 v[16:19], v[188:191], v[60:63], v[16:19]
    buffer_load_dwordx4 v[120:123], v175, s[64:67], s32 offen offset:2048 sc1
    v_lshlrev_b32 v115, 1, v115
    v_xor_b32 v115, v115, v113
    v_mfma_f32_16x16x32_bf16 v[16:19], v[232:235], v[68:71], v[16:19]
    v_lshl_add_u32 v124, v115, 4, v124
    v_xor_b32 v125, 16, v124
    v_mfma_f32_16x16x32_bf16 v[16:19], v[236:239], v[72:75], v[16:19]
    v_lshrrev_b32 v115, 2, v152
    v_mad_u32_u24 v127, v115, s9, v114
    v_mfma_f32_16x16x32_bf16 v[4:7], v[192:195], v[80:83], v[4:7]
    v_bfe_u32 v113, v152, 3, 2
    v_and_b32 v114, 3, v152
    v_mfma_f32_16x16x32_bf16 v[4:7], v[196:199], v[116:119], v[4:7]
    v_xor_b32 v113, v113, v114
    v_lshl_add_u32 v127, v113, 4, v127
    v_mfma_f32_16x16x32_bf16 v[4:7], v[200:203], v[64:67], v[4:7]
    ds_write_b128 v165, v[16:19] offset:1024
    s_lshl_b32 s8, s77, 4
    s_add_u32 s8, s8, 93184
    v_lshl_add_u32 v128, v112, 6, s8
    v_and_b32 v115, 3, v115
    v_mfma_f32_16x16x32_bf16 v[4:7], v[204:207], v[60:63], v[4:7]
    v_lshl_add_u32 v128, v115, 2, v128
    v_lshl_add_u32 v112, v112, 2, v114
    v_mfma_f32_16x16x32_bf16 v[4:7], v[240:243], v[68:71], v[4:7]
    v_lshlrev_b32 v163, 4, v112
    v_lshl_add_u32 v163, v115, 9, v163
    v_mfma_f32_16x16x32_bf16 v[4:7], v[244:247], v[72:75], v[4:7]
    ds_read_b32 v128, v128
    s_lshl_b32 s8, s77, 2
    s_add_u32 s8, s8, 0
    v_bfe_u32 v113, v152, 4, 2
    v_lshl_add_u32 v131, v113, 5, s8
    v_mfma_f32_16x16x32_bf16 v[28:31], v[208:211], v[80:83], v[28:31]
    v_bfe_u32 v113, v152, 2, 1
    v_lshl_add_u32 v131, v113, 4, v131
    v_mfma_f32_16x16x32_bf16 v[28:31], v[212:215], v[116:119], v[28:31]
    v_bfe_u32 v113, v152, 3, 1
    v_lshl_add_u32 v131, v113, 1, v131
    v_mfma_f32_16x16x32_bf16 v[28:31], v[216:219], v[64:67], v[28:31]
    ds_write_b128 v165, v[4:7] offset:2048
    s_mul_i32 s8, s79, 163840
    s_mul_i32 s9, s78, 320
    v_mfma_f32_16x16x32_bf16 v[28:31], v[220:223], v[60:63], v[28:31]
    s_add_u32 s8, s8, s9
    v_mul_u32_u24 v131, 1280, v131
    v_lshl_add_u32 v131, v114, 4, v131
    v_mfma_f32_16x16x32_bf16 v[28:31], v[248:251], v[68:71], v[28:31]
    v_add_u32 v131, s8, v131
    v_mfma_f32_16x16x32_bf16 v[28:31], v[252:255], v[72:75], v[28:31]
    s_waitcnt vmcnt(3)
    v_bitop3_b32 v169, v76, v78, v84 bitop3:254
    v_bitop3_b32 v169, v169, v86, v88 bitop3:254
    v_bitop3_b32 v169, v169, v90, v92 bitop3:254
    v_mfma_f32_16x16x32_bf16 v[40:43], a[216:219], v[80:83], v[40:43]
    buffer_load_dwordx4 v[80:83], v175, s[64:67], s32 offen offset:3072 sc1
    v_bitop3_b32 v169, v169, v94, v96 bitop3:254
    v_bitop3_b32 v169, v169, v98, v100 bitop3:254
    v_bitop3_b32 v169, v169, v102, 1 bitop3:168
    v_mfma_f32_16x16x32_bf16 v[40:43], a[220:223], v[116:119], v[40:43]
    v_cmp_ne_u32 s[96:97], 0, v169
    v_mfma_f32_16x16x32_bf16 v[40:43], a[224:227], v[64:67], v[40:43]
    ds_write_b128 v165, v[28:31] offset:3072
    v_mfma_f32_16x16x32_bf16 v[40:43], a[228:231], v[60:63], v[40:43]
    v_mfma_f32_16x16x32_bf16 v[40:43], a[248:251], v[68:71], v[40:43]
    buffer_load_dwordx4 v[116:119], v175, s[64:67], s33 offen offset:0 sc1
    v_mfma_f32_16x16x32_bf16 v[40:43], a[252:255], v[72:75], v[40:43]
    s_cmp_lg_u64 s[96:97], 0
    s_cbranch_scc1 Lh1c6r
Lh1c6:
    v_mfma_f32_16x16x32_bf16 v[56:59], a[232:235], v[76:79], v[56:59]
    v_mfma_f32_16x16x32_bf16 v[56:59], a[236:239], v[84:87], v[56:59]
    v_mfma_f32_16x16x32_bf16 v[56:59], a[240:243], v[88:91], v[56:59]
    s_nop 2
    ds_write_b128 v165, v[40:43] offset:4096
    buffer_load_dwordx4 v[64:67], v175, s[64:67], s33 offen offset:1024 sc1
    v_mfma_f32_16x16x32_bf16 v[56:59], a[244:247], v[92:95], v[56:59]
    s_add_u32 s3, s77, 2
    s_and_b32 s3, s3, 3
    s_mul_i32 s3, s3, 15360
    v_add_u32 v165, s3, v153
    v_mfma_f32_16x16x32_bf16 v[56:59], v[224:227], v[96:99], v[56:59]
    v_mfma_f32_16x16x32_bf16 v[56:59], v[228:231], v[100:103], v[56:59]
    v_mfma_f32_16x16x32_bf16 v[20:23], v[176:179], v[76:79], v[20:23]
    buffer_load_dwordx4 v[60:63], v175, s[64:67], s23 offen offset:3072 sc1
    v_mfma_f32_16x16x32_bf16 v[20:23], v[180:183], v[84:87], v[20:23]
    v_mfma_f32_16x16x32_bf16 v[20:23], v[184:187], v[88:91], v[20:23]
    s_nop 3
    ds_write_b128 v165, v[56:59] offset:5120
    v_mfma_f32_16x16x32_bf16 v[20:23], v[188:191], v[92:95], v[20:23]
    v_mfma_f32_16x16x32_bf16 v[20:23], v[232:235], v[96:99], v[20:23]
    buffer_load_dwordx4 v[68:71], v175, s[64:67], s24 offen offset:0 sc1
    v_mfma_f32_16x16x32_bf16 v[20:23], v[236:239], v[100:103], v[20:23]
    v_mfma_f32_16x16x32_bf16 v[8:11], v[192:195], v[76:79], v[8:11]
    v_mfma_f32_16x16x32_bf16 v[8:11], v[196:199], v[84:87], v[8:11]
    v_mfma_f32_16x16x32_bf16 v[8:11], v[200:203], v[88:91], v[8:11]
    s_nop 4
    ds_write_b128 v165, v[20:23] offset:6144
    buffer_load_dwordx4 v[72:75], v175, s[64:67], s24 offen offset:1024 sc1
    v_mfma_f32_16x16x32_bf16 v[8:11], v[204:207], v[92:95], v[8:11]
    v_mfma_f32_16x16x32_bf16 v[8:11], v[240:243], v[96:99], v[8:11]
    v_mfma_f32_16x16x32_bf16 v[8:11], v[244:247], v[100:103], v[8:11]
    v_mfma_f32_16x16x32_bf16 v[32:35], v[208:211], v[76:79], v[32:35]
    v_mfma_f32_16x16x32_bf16 v[32:35], v[212:215], v[84:87], v[32:35]
    v_mfma_f32_16x16x32_bf16 v[32:35], v[216:219], v[88:91], v[32:35]
    s_nop 4
    ds_write_b128 v165, v[8:11] offset:7168
    v_mfma_f32_16x16x32_bf16 v[32:35], v[220:223], v[92:95], v[32:35]
    v_mfma_f32_16x16x32_bf16 v[32:35], v[248:251], v[96:99], v[32:35]
    v_mfma_f32_16x16x32_bf16 v[32:35], v[252:255], v[100:103], v[32:35]
    s_waitcnt vmcnt(3)
    v_bitop3_b32 v169, v104, v106, v108 bitop3:254
    v_bitop3_b32 v169, v169, v110, v120 bitop3:254
    v_bitop3_b32 v169, v169, v122, v80 bitop3:254
    v_mfma_f32_16x16x32_bf16 v[44:47], a[216:219], v[76:79], v[44:47]
    v_bitop3_b32 v169, v169, v82, v116 bitop3:254
    v_bitop3_b32 v169, v169, v118, v64 bitop3:254
    v_bitop3_b32 v169, v169, v66, 1 bitop3:168
    v_mfma_f32_16x16x32_bf16 v[44:47], a[220:223], v[84:87], v[44:47]
    v_cmp_ne_u32 s[96:97], 0, v169
    v_mfma_f32_16x16x32_bf16 v[44:47], a[224:227], v[88:91], v[44:47]
    ds_write_b128 v165, v[32:35] offset:8192
    v_mfma_f32_16x16x32_bf16 v[44:47], a[228:231], v[92:95], v[44:47]
    v_mfma_f32_16x16x32_bf16 v[44:47], a[248:251], v[96:99], v[44:47]
    v_mfma_f32_16x16x32_bf16 v[44:47], a[252:255], v[100:103], v[44:47]
    s_cmp_lg_u64 s[96:97], 0
    s_cbranch_scc1 Lh1c7r
Lh1c7:
    v_mfma_f32_16x16x32_bf16 v[0:3], a[232:235], v[104:107], v[0:3]
    v_mfma_f32_16x16x32_bf16 v[0:3], a[236:239], v[108:111], v[0:3]
    v_mfma_f32_16x16x32_bf16 v[0:3], a[240:243], v[120:123], v[0:3]
    s_nop 2
    ds_write_b128 v165, v[44:47] offset:9216
    v_mfma_f32_16x16x32_bf16 v[0:3], a[244:247], v[80:83], v[0:3]
    s_add_u32 s3, s77, 3
    s_and_b32 s3, s3, 3
    s_mul_i32 s3, s3, 15360
    v_add_u32 v165, s3, v153
    v_mfma_f32_16x16x32_bf16 v[0:3], v[224:227], v[116:119], v[0:3]
    v_mfma_f32_16x16x32_bf16 v[0:3], v[228:231], v[64:67], v[0:3]
    v_mfma_f32_16x16x32_bf16 v[24:27], v[176:179], v[104:107], v[24:27]
    v_mfma_f32_16x16x32_bf16 v[24:27], v[180:183], v[108:111], v[24:27]
    v_mfma_f32_16x16x32_bf16 v[24:27], v[184:187], v[120:123], v[24:27]
    s_nop 4
    ds_write_b128 v165, v[0:3] offset:10240
    v_mfma_f32_16x16x32_bf16 v[24:27], v[188:191], v[80:83], v[24:27]
    v_mfma_f32_16x16x32_bf16 v[24:27], v[232:235], v[116:119], v[24:27]
    v_mfma_f32_16x16x32_bf16 v[24:27], v[236:239], v[64:67], v[24:27]
    s_waitcnt lgkmcnt(1)
    s_barrier
    v_mfma_f32_16x16x32_bf16 v[12:15], v[192:195], v[104:107], v[12:15]
    ds_read_b128 v[52:55], v154 offset:0
    v_mfma_f32_16x16x32_bf16 v[12:15], v[196:199], v[108:111], v[12:15]
    ds_read_b128 v[16:19], v154 offset:1024
    v_mfma_f32_16x16x32_bf16 v[12:15], v[200:203], v[120:123], v[12:15]
    ds_read_b128 v[4:7], v154 offset:2048
    ds_write_b128 v165, v[24:27] offset:11264
    v_mfma_f32_16x16x32_bf16 v[12:15], v[204:207], v[80:83], v[12:15]
    ds_read_b128 v[28:31], v154 offset:3072
    v_mfma_f32_16x16x32_bf16 v[12:15], v[240:243], v[116:119], v[12:15]
    ds_read_b128 v[40:43], v154 offset:4096
    v_mfma_f32_16x16x32_bf16 v[12:15], v[244:247], v[64:67], v[12:15]
    ds_read_b128 v[56:59], v154 offset:5120
    v_mfma_f32_16x16x32_bf16 v[36:39], v[208:211], v[104:107], v[36:39]
    ds_read_b128 v[20:23], v154 offset:6144
    s_waitcnt lgkmcnt(7)
    v_add_f32 v132, v132, v52
    v_add_f32 v133, v133, v53
    v_mfma_f32_16x16x32_bf16 v[36:39], v[212:215], v[108:111], v[36:39]
    ds_read_b128 v[8:11], v154 offset:7168
    v_add_f32 v134, v134, v54
    v_add_f32 v135, v135, v55
    v_mfma_f32_16x16x32_bf16 v[36:39], v[216:219], v[120:123], v[36:39]
    ds_read_b128 v[32:35], v154 offset:8192
    s_waitcnt lgkmcnt(8)
    ds_write_b128 v165, v[12:15] offset:12288
    v_add_f32 v136, v136, v16
    v_add_f32 v137, v137, v17
    v_mfma_f32_16x16x32_bf16 v[36:39], v[220:223], v[80:83], v[36:39]
    ds_read_b128 v[44:47], v154 offset:9216
    v_add_f32 v138, v138, v18
    v_add_f32 v139, v139, v19
    v_mfma_f32_16x16x32_bf16 v[36:39], v[248:251], v[116:119], v[36:39]
    s_waitcnt lgkmcnt(9)
    v_add_f32 v140, v140, v4
    v_add_f32 v141, v141, v5
    v_mfma_f32_16x16x32_bf16 v[36:39], v[252:255], v[64:67], v[36:39]
    s_waitcnt vmcnt(0)
    v_add_f32 v142, v142, v6
    v_add_f32 v143, v143, v7
    v_bitop3_b32 v169, v60, v62, v68 bitop3:254
    v_mfma_f32_16x16x32_bf16 v[48:51], a[216:219], v[104:107], v[48:51]
    s_waitcnt lgkmcnt(7)
    v_add_f32 v144, v144, v28
    v_add_f32 v145, v145, v29
    v_bitop3_b32 v169, v169, v70, v72 bitop3:254
    v_mfma_f32_16x16x32_bf16 v[48:51], a[220:223], v[108:111], v[48:51]
    v_add_f32 v146, v146, v30
    v_add_f32 v147, v147, v31
    v_bitop3_b32 v169, v169, v74, 1 bitop3:168
    v_mfma_f32_16x16x32_bf16 v[48:51], a[224:227], v[120:123], v[48:51]
    s_waitcnt lgkmcnt(6)
    ds_write_b128 v165, v[36:39] offset:13312
    v_add_f32 v148, v148, v40
    v_add_f32 v149, v149, v41
    v_cmp_ne_u32 s[96:97], 0, v169
    v_mfma_f32_16x16x32_bf16 v[48:51], a[228:231], v[80:83], v[48:51]
    v_add_f32 v150, v150, v42
    v_add_f32 v151, v151, v43
    v_mfma_f32_16x16x32_bf16 v[48:51], a[248:251], v[116:119], v[48:51]
    v_mfma_f32_16x16x32_bf16 v[48:51], a[252:255], v[64:67], v[48:51]
    s_cmp_lg_u64 s[96:97], 0
    s_cbranch_scc1 Lh1c8r
Lh1c8:
    s_waitcnt lgkmcnt(6)
    v_mfma_f32_16x16x32_bf16 v[56:59], a[244:247], v[60:63], v[56:59]
    v_mfma_f32_16x16x32_bf16 v[56:59], v[224:227], v[68:71], v[56:59]
    v_mfma_f32_16x16x32_bf16 v[56:59], v[228:231], v[72:75], v[56:59]
    s_nop 1
    ds_write_b128 v165, v[48:51] offset:14336
    s_waitcnt lgkmcnt(6)
    v_mfma_f32_16x16x32_bf16 v[20:23], v[188:191], v[60:63], v[20:23]
    v_mfma_f32_16x16x32_bf16 v[20:23], v[232:235], v[68:71], v[20:23]
    v_mfma_f32_16x16x32_bf16 v[20:23], v[236:239], v[72:75], v[20:23]
    s_waitcnt lgkmcnt(5)
    v_mfma_f32_16x16x32_bf16 v[8:11], v[204:207], v[60:63], v[8:11]
    v_mfma_f32_16x16x32_bf16 v[8:11], v[240:243], v[68:71], v[8:11]
    s_waitcnt lgkmcnt(0)
    s_barrier
    v_mfma_f32_16x16x32_bf16 v[8:11], v[244:247], v[72:75], v[8:11]
    ds_read_b128 v[52:55], v154 offset:10240
    v_mfma_f32_16x16x32_bf16 v[32:35], v[220:223], v[60:63], v[32:35]
    ds_read_b128 v[16:19], v154 offset:11264
    v_mfma_f32_16x16x32_bf16 v[32:35], v[248:251], v[68:71], v[32:35]
    ds_read_b128 v[4:7], v154 offset:12288
    v_mfma_f32_16x16x32_bf16 v[32:35], v[252:255], v[72:75], v[32:35]
    ds_read_b128 v[28:31], v154 offset:13312
    v_mfma_f32_16x16x32_bf16 v[44:47], a[228:231], v[60:63], v[44:47]
    ds_read_b128 v[40:43], v154 offset:14336
    v_mfma_f32_16x16x32_bf16 v[44:47], a[248:251], v[68:71], v[44:47]
    v_mfma_f32_16x16x32_bf16 v[44:47], a[252:255], v[72:75], v[44:47]
    v_pk_add_f32 v[132:133], v[132:133], v[56:57]
    v_pk_add_f32 v[134:135], v[134:135], v[58:59]
    v_pk_add_f32 v[136:137], v[136:137], v[20:21]
    v_pk_add_f32 v[138:139], v[138:139], v[22:23]
    v_pk_add_f32 v[140:141], v[140:141], v[8:9]
    v_pk_add_f32 v[142:143], v[142:143], v[10:11]
    v_pk_add_f32 v[144:145], v[144:145], v[32:33]
    v_pk_add_f32 v[146:147], v[146:147], v[34:35]
    v_pk_add_f32 v[148:149], v[148:149], v[44:45]
    v_pk_add_f32 v[150:151], v[150:151], v[46:47]
    s_waitcnt lgkmcnt(4)
    v_pk_add_f32 v[132:133], v[132:133], v[52:53]
    v_pk_add_f32 v[134:135], v[134:135], v[54:55]
    s_waitcnt lgkmcnt(3)
    v_pk_add_f32 v[136:137], v[136:137], v[16:17]
    v_pk_add_f32 v[138:139], v[138:139], v[18:19]
    s_waitcnt lgkmcnt(2)
    v_pk_add_f32 v[140:141], v[140:141], v[4:5]
    v_pk_add_f32 v[142:143], v[142:143], v[6:7]
    s_waitcnt lgkmcnt(1)
    v_pk_add_f32 v[144:145], v[144:145], v[28:29]
    v_pk_add_f32 v[146:147], v[146:147], v[30:31]
    s_waitcnt lgkmcnt(0)
    v_pk_add_f32 v[148:149], v[148:149], v[40:41]
    v_pk_add_f32 v[150:151], v[150:151], v[42:43]
    v_pk_add_f32 v[4:5], v[132:133], v[134:135]
    v_pk_mul_f32 v[6:7], v[132:133], v[132:133]
    v_pk_fma_f32 v[6:7], v[134:135], v[134:135], v[6:7]
    v_pk_fma_f32 v[6:7], v[136:137], v[136:137], v[6:7]
    v_pk_add_f32 v[4:5], v[4:5], v[136:137]
    v_pk_fma_f32 v[6:7], v[138:139], v[138:139], v[6:7]
    v_pk_add_f32 v[4:5], v[4:5], v[138:139]
    v_pk_fma_f32 v[6:7], v[140:141], v[140:141], v[6:7]
    v_pk_add_f32 v[4:5], v[4:5], v[140:141]
    v_pk_fma_f32 v[6:7], v[142:143], v[142:143], v[6:7]
    v_pk_add_f32 v[4:5], v[4:5], v[142:143]
    v_pk_fma_f32 v[6:7], v[144:145], v[144:145], v[6:7]
    v_pk_add_f32 v[4:5], v[4:5], v[144:145]
    v_pk_fma_f32 v[6:7], v[146:147], v[146:147], v[6:7]
    v_pk_add_f32 v[4:5], v[4:5], v[146:147]
    v_pk_fma_f32 v[6:7], v[148:149], v[148:149], v[6:7]
    v_pk_add_f32 v[4:5], v[4:5], v[148:149]
    v_pk_fma_f32 v[6:7], v[150:151], v[150:151], v[6:7]
    v_pk_add_f32 v[4:5], v[4:5], v[150:151]
    v_add_f32 v6, v6, v7
    v_add_f32 v4, v4, v5
    v_mov_b32 v1, s82
    s_nop 0
    v_permlane32_swap_b32 v4, v6
    v_add_f32 v4, v4, v6
    v_mov_b32 v6, v4
    s_nop 1
    v_permlane16_swap_b32 v4, v6
    v_add_f32 v0, v4, v6

    s_cmp_eq_u32 s88, 0
    s_cbranch_scc1 Lss_35
    global_store_dwordx2 v155, v[0:1], s[98:99]
Lsd_36:
    ds_write_b128 v124, v[132:135] offset:0
    v_accvgpr_read_b32 v84, a0
    v_accvgpr_read_b32 v85, a1
    ds_write_b128 v125, v[136:139] offset:0
    v_accvgpr_read_b32 v88, a4
    v_accvgpr_read_b32 v89, a5
    ds_write_b128 v124, v[140:143] offset:128
    v_accvgpr_read_b32 v92, a8
    v_accvgpr_read_b32 v93, a9
    ds_write_b128 v125, v[144:147] offset:128
    v_accvgpr_read_b32 v96, a12
    v_accvgpr_read_b32 v97, a13
    ds_write_b128 v126, v[148:151] offset:256
    v_accvgpr_read_b32 v100, a16
    v_accvgpr_read_b32 v101, a17
    ds_read_b128 v[20:23], v127 offset:0
    ds_read_b128 v[24:27], v127 offset:64
    ds_read_b128 v[28:31], v127 offset:128
    ds_read_b128 v[32:35], v127 offset:192
    ds_read_b128 v[36:39], v127 offset:256
    v_accvgpr_read_b32 v86, a2
    v_accvgpr_read_b32 v87, a3
    v_accvgpr_read_b32 v90, a6
    v_accvgpr_read_b32 v91, a7
    v_accvgpr_read_b32 v94, a10
    v_accvgpr_read_b32 v95, a11
    v_accvgpr_read_b32 v98, a14
    v_accvgpr_read_b32 v99, a15
    v_accvgpr_read_b32 v102, a18
    v_accvgpr_read_b32 v103, a19
    global_load_dwordx4 v[0:3], v163, s[98:99] sc1
    global_load_dwordx4 v[4:7], v163, s[98:99] offset:256 sc1
    s_waitcnt lgkmcnt(4)
    v_pk_add_f32 v[60:61], v[20:21], v[128:129] op_sel_hi:[1,0]
    v_pk_add_f32 v[62:63], v[22:23], v[128:129] op_sel_hi:[1,0]
    s_waitcnt lgkmcnt(3)
    v_pk_add_f32 v[64:65], v[24:25], v[128:129] op_sel_hi:[1,0]
    v_pk_add_f32 v[66:67], v[26:27], v[128:129] op_sel_hi:[1,0]
    s_waitcnt lgkmcnt(2)
    v_pk_add_f32 v[68:69], v[28:29], v[128:129] op_sel_hi:[1,0]
    v_pk_add_f32 v[70:71], v[30:31], v[128:129] op_sel_hi:[1,0]
    s_waitcnt lgkmcnt(1)
    v_pk_add_f32 v[72:73], v[32:33], v[128:129] op_sel_hi:[1,0]
    v_pk_add_f32 v[74:75], v[34:35], v[128:129] op_sel_hi:[1,0]
    s_waitcnt lgkmcnt(0)
    v_pk_add_f32 v[76:77], v[36:37], v[128:129] op_sel_hi:[1,0]
    v_pk_add_f32 v[78:79], v[38:39], v[128:129] op_sel_hi:[1,0]
    s_waitcnt vmcnt(0)
    L_s3:
    v_min3_u32 v168, v1, v3, v5
    v_max3_u32 v1, v1, v3, v5
    v_min3_u32 v168, v168, v7, s82
    v_max3_u32 v1, v1, v7, s82
    v_cmp_ne_u32 vcc, v168, v1

    s_cbranch_vccnz L_s3r
    v_add_f32 v0, v0, v4
    v_add_f32 v2, v2, v6
    s_nop 0
    v_add_f32_dpp v0, v0, v0 row_ror:4 row_mask:0xf bank_mask:0xf
    v_add_f32_dpp v2, v2, v2 row_ror:4 row_mask:0xf bank_mask:0xf
    s_nop 0
    v_add_f32_dpp v0, v0, v0 row_ror:8 row_mask:0xf bank_mask:0xf
    v_add_f32_dpp v2, v2, v2 row_ror:8 row_mask:0xf bank_mask:0xf
    s_nop 0
    v_mov_b32_dpp v4, v0 quad_perm:[0,0,0,0] row_mask:0xf bank_mask:1
    v_mov_b32_dpp v6, v2 quad_perm:[0,0,0,0] row_mask:0xf bank_mask:1
    s_nop 0
    v_mov_b32_dpp v4, v0 quad_perm:[1,1,1,1] row_mask:0xf bank_mask:2
    v_mov_b32_dpp v6, v2 quad_perm:[1,1,1,1] row_mask:0xf bank_mask:2
    s_nop 0
    v_mov_b32_dpp v4, v0 quad_perm:[2,2,2,2] row_mask:0xf bank_mask:4
    v_mov_b32_dpp v6, v2 quad_perm:[2,2,2,2] row_mask:0xf bank_mask:4
    s_nop 0
    v_mov_b32_dpp v4, v0 quad_perm:[3,3,3,3] row_mask:0xf bank_mask:8
    v_mov_b32_dpp v6, v2 quad_perm:[3,3,3,3] row_mask:0xf bank_mask:8
    v_mul_f32 v4, 0x3acccccd, v4
    v_mov_b32 v166, 0x3727c5ac
    v_fmac_f32 v166, 0x3acccccd, v6
    v_fma_f32 v166, -v4, v4, v166
    v_max_f32 v166, 0x3727c5ac, v166
    v_rsq_f32 v166, v166
    s_nop 0
    v_mul_f32_e64 v167, -v4, v166
    v_pk_fma_f32 v[20:21], v[20:21], v[166:167], v[166:167] op_sel:[0,0,1] op_sel_hi:[1,0,1]
    v_pk_fma_f32 v[22:23], v[22:23], v[166:167], v[166:167] op_sel:[0,0,1] op_sel_hi:[1,0,1]
    v_pk_fma_f32 v[60:61], v[20:21], v[84:85], v[60:61]
    v_pk_fma_f32 v[62:63], v[22:23], v[86:87], v[62:63]
    global_store_dwordx4 v131, v[60:63], s[46:47] offset:0
    v_pk_fma_f32 v[24:25], v[24:25], v[166:167], v[166:167] op_sel:[0,0,1] op_sel_hi:[1,0,1]
    v_pk_fma_f32 v[26:27], v[26:27], v[166:167], v[166:167] op_sel:[0,0,1] op_sel_hi:[1,0,1]
    v_pk_fma_f32 v[64:65], v[24:25], v[88:89], v[64:65]
    v_pk_fma_f32 v[66:67], v[26:27], v[90:91], v[66:67]
    global_store_dwordx4 v131, v[64:67], s[46:47] offset:64
    v_pk_fma_f32 v[28:29], v[28:29], v[166:167], v[166:167] op_sel:[0,0,1] op_sel_hi:[1,0,1]
    v_pk_fma_f32 v[30:31], v[30:31], v[166:167], v[166:167] op_sel:[0,0,1] op_sel_hi:[1,0,1]
    v_pk_fma_f32 v[68:69], v[28:29], v[92:93], v[68:69]
    v_pk_fma_f32 v[70:71], v[30:31], v[94:95], v[70:71]
    global_store_dwordx4 v131, v[68:71], s[46:47] offset:128
    v_pk_fma_f32 v[32:33], v[32:33], v[166:167], v[166:167] op_sel:[0,0,1] op_sel_hi:[1,0,1]
    v_pk_fma_f32 v[34:35], v[34:35], v[166:167], v[166:167] op_sel:[0,0,1] op_sel_hi:[1,0,1]
    v_pk_fma_f32 v[72:73], v[32:33], v[96:97], v[72:73]
    v_pk_fma_f32 v[74:75], v[34:35], v[98:99], v[74:75]
    global_store_dwordx4 v131, v[72:75], s[46:47] offset:192
    v_pk_fma_f32 v[36:37], v[36:37], v[166:167], v[166:167] op_sel:[0,0,1] op_sel_hi:[1,0,1]
    v_pk_fma_f32 v[38:39], v[38:39], v[166:167], v[166:167] op_sel:[0,0,1] op_sel_hi:[1,0,1]
    v_pk_fma_f32 v[76:77], v[36:37], v[100:101], v[76:77]
    v_pk_fma_f32 v[78:79], v[38:39], v[102:103], v[78:79]
    global_store_dwordx4 v131, v[76:79], s[46:47] offset:256
L_end:
    s_endpgm
L_nonce_re:
    s_sub_u32 s101, s101, 1
    s_cbranch_scc1 L_end
    global_load_dword v224, v224, s[48:49] sc1
    s_waitcnt vmcnt(0)
    s_branch L_nonce
L_kf_re:
    s_sub_u32 s101, s101, 1
    s_cbranch_scc1 L_end
    global_load_dword v170, v168, s[50:51] sc1
    s_waitcnt vmcnt(0)
    s_branch L_kf
L_cre0:
    s_sub_u32 s101, s101, 1
    s_cbranch_scc1 L_end
    buffer_load_dwordx4 v[216:219], v253, s[92:95], 0 offen offset:256 sc1
    buffer_load_dwordx4 v[220:223], v253, s[92:95], 0 offen offset:512 sc1
    buffer_load_dwordx4 v[224:227], v253, s[92:95], 0 offen offset:768 sc1
    buffer_load_dwordx4 v[228:231], v253, s[92:95], 0 offen offset:1024 sc1
    buffer_load_dwordx4 v[232:235], v253, s[92:95], 0 offen offset:1280 sc1
    buffer_load_dwordx4 v[236:239], v253, s[92:95], 0 offen offset:1536 sc1
    buffer_load_dwordx4 v[240:243], v253, s[92:95], 0 offen offset:1792 sc1
    buffer_load_dwordx4 v[244:247], v253, s[92:95], 0 offen offset:2048 sc1
    s_waitcnt vmcnt(0)
    s_branch L_cchk0
Lss_3:
    buffer_store_dwordx4 v[216:219], v153, s[64:67], s36 offen sc1
    s_branch Lsd_4
Lss_5:
    buffer_store_dwordx4 v[220:223], v153, s[64:67], s18 offen sc1
    s_branch Lsd_6
Lss_7:
    buffer_store_dwordx2 v[244:245], v28, s[64:67], s37 offen offset:0 sc1
    buffer_store_dwordx2 v[246:247], v28, s[64:67], s37 offen offset:512 sc1
    s_branch Lsd_8
Lss_9:
    buffer_store_dwordx4 v[224:227], v153, s[64:67], s19 offen sc1
    s_branch Lsd_10
Lss_11:
    buffer_store_dwordx4 v[228:231], v153, s[64:67], s20 offen sc1
    s_branch Lsd_12
Lss_13:
    global_store_dword v169, v173, s[50:51] sc1
    s_branch Lsd_14
L_fh_re0:
    s_sub_u32 s101, s101, 1
    s_cbranch_scc1 L_end
    global_load_dword v169, v173, s[50:51] sc1
    s_waitcnt vmcnt(0)
    s_branch L_fh0
L_fh_re1:
    s_sub_u32 s101, s101, 1
    s_cbranch_scc1 L_end
    global_load_dword v169, v173, s[50:51] sc1
    s_waitcnt vmcnt(0)
    s_branch L_fh1
Lss_17:
    global_store_dwordx2 v155, v[0:1], s[98:99] sc1
    s_branch Lsd_18
L_gcr:
    s_sub_u32 s101, s101, 1
    s_cbranch_scc1 L_end
    s_add_u32 m0, s100, 61440
    s_nop 0
    buffer_load_dwordx4 v164, s[68:71], s6 offen sc1 lds
    s_add_u32 m0, s100, 62464
    s_add_u32 s83, s6, 32768
    buffer_load_dwordx4 v164, s[68:71], s83 offen sc1 lds
    s_add_u32 m0, s5, 69632
    s_mov_b32 exec_hi, 0
    buffer_load_dwordx4 v164, s[68:71], s7 offen sc1 lds
    s_mov_b32 exec_hi, -1
    s_waitcnt vmcnt(0)
    ds_read2st64_b32 v[8:9], v170 offset1:2
    ds_read2st64_b32 v[10:11], v170 offset0:4 offset1:6
    ds_read_b32 v12, v171
    s_waitcnt lgkmcnt(0)
    v_bitop3_b32 v169, v8, v9, v10 bitop3:128
    v_bitop3_b32 v169, v169, v11, v12 bitop3:128
    v_and_b32 v169, 1, v169
    v_cmp_ne_u32 vcc, 1, v169
    s_cbranch_vccnz L_gcr
    s_branch L_gc
L_s1r:
    s_sub_u32 s101, s101, 1
    s_cbranch_scc1 L_end
    global_load_dwordx4 v[0:3], v163, s[98:99] sc1
    global_load_dwordx4 v[4:7], v163, s[98:99] offset:256 sc1
    s_waitcnt vmcnt(0)
    s_branch L_s1
Lss_19:
    buffer_store_dwordx4 v[36:39], v153, s[64:67], s12 offen sc1
    buffer_store_dwordx4 v[40:43], v153, s[64:67], s12 offen offset:1024 sc1
    s_mov_b32 exec_lo, 0xffff
    s_mov_b32 exec_hi, 0xffff
    buffer_store_dwordx4 v[44:47], v84, s[64:67], s12 offen offset:2048 sc1
    s_branch Lsd_20
Lss_21:
    global_store_dwordx2 v155, v[0:1], s[98:99] sc1
    s_branch Lsd_22
L_xc0r:
    s_sub_u32 s101, s101, 1
    s_cbranch_scc1 L_end
    s_lshl_b32 m0, s81, 13
    s_add_u32 m0, m0, 0
    s_add_u32 s83, s72, s85
    s_add_u32 s83, s83, 0
    buffer_load_dwordx4 v153, s[64:67], s83 offen offset:0 sc1 lds
    s_lshl_b32 m0, s81, 13
    s_add_u32 m0, m0, 2048
    s_add_u32 s83, s72, s85
    s_add_u32 s83, s83, 20480
    buffer_load_dwordx4 v153, s[64:67], s83 offen offset:0 sc1 lds
    s_lshl_b32 m0, s81, 13
    s_add_u32 m0, m0, 4096
    s_add_u32 s83, s72, s85
    s_add_u32 s83, s83, 40960
    buffer_load_dwordx4 v153, s[64:67], s83 offen offset:0 sc1 lds
    s_lshl_b32 m0, s81, 13
    s_add_u32 m0, m0, 6144
    s_add_u32 s83, s72, s85
    s_add_u32 s83, s83, 61440
    buffer_load_dwordx4 v153, s[64:67], s83 offen offset:0 sc1 lds
    s_waitcnt vmcnt(0)
    v_and_b32 v169, 0x23ff, v158
    v_add_u32 v169, 0, v169
    ds_read_b128 v[56:59], v169 offset:0
    v_and_b32 v169, 0x23ff, v158
    v_add_u32 v169, 0, v169
    ds_read_b128 v[60:63], v169 offset:2048
    v_and_b32 v169, 0x23ff, v158
    v_add_u32 v169, 0, v169
    ds_read_b128 v[64:67], v169 offset:4096
    v_and_b32 v169, 0x23ff, v158
    v_add_u32 v169, 0, v169
    ds_read_b128 v[68:71], v169 offset:6144
    s_waitcnt lgkmcnt(0)
    v_bitop3_b32 v169, v56, v60, v64 bitop3:128
    v_bitop3_b32 v169, v169, v68, 1 bitop3:128
    v_cmp_ne_u32 vcc, 1, v169
    s_cbranch_vccnz L_xc0r
    s_branch L_xc0
L_xc1r:
    s_sub_u32 s101, s101, 1
    s_cbranch_scc1 L_end
    s_lshl_b32 m0, s81, 13
    s_add_u32 m0, m0, 0
    s_add_u32 s83, s72, s85
    s_add_u32 s83, s83, 0
    buffer_load_dwordx4 v153, s[64:67], s83 offen offset:1024 sc1 lds
    s_lshl_b32 m0, s81, 13
    s_add_u32 m0, m0, 2048
    s_add_u32 s83, s72, s85
    s_add_u32 s83, s83, 20480
    buffer_load_dwordx4 v153, s[64:67], s83 offen offset:1024 sc1 lds
    s_lshl_b32 m0, s81, 13
    s_add_u32 m0, m0, 4096
    s_add_u32 s83, s72, s85
    s_add_u32 s83, s83, 40960
    buffer_load_dwordx4 v153, s[64:67], s83 offen offset:1024 sc1 lds
    s_lshl_b32 m0, s81, 13
    s_add_u32 m0, m0, 6144
    s_add_u32 s83, s72, s85
    s_add_u32 s83, s83, 61440
    buffer_load_dwordx4 v153, s[64:67], s83 offen offset:1024 sc1 lds
    s_waitcnt vmcnt(0)
    v_and_b32 v169, 0x23ff, v158
    v_add_u32 v169, 0, v169
    ds_read_b128 v[72:75], v169 offset:1024
    v_and_b32 v169, 0x23ff, v158
    v_add_u32 v169, 0, v169
    ds_read_b128 v[76:79], v169 offset:3072
    v_and_b32 v169, 0x23ff, v158
    v_add_u32 v169, 0, v169
    ds_read_b128 v[80:83], v169 offset:5120
    v_and_b32 v169, 0x23ff, v158
    v_add_u32 v169, 0, v169
    ds_read_b128 v[84:87], v169 offset:7168
    s_waitcnt lgkmcnt(0)
    v_bitop3_b32 v169, v72, v76, v80 bitop3:128
    v_bitop3_b32 v169, v169, v84, 1 bitop3:128
    v_cmp_ne_u32 vcc, 1, v169
    s_cbranch_vccnz L_xc1r
    s_branch L_xc1
L_xc2r:
    s_sub_u32 s101, s101, 1
    s_cbranch_scc1 L_end
    s_lshl_b32 m0, s81, 13
    s_xor_b32 m0, m0, 0x2000
    s_add_u32 m0, m0, 0
    s_add_u32 s83, s72, s90
    s_add_u32 s83, s83, 0
    buffer_load_dwordx4 v153, s[64:67], s83 offen offset:0 sc1 lds
    s_lshl_b32 m0, s81, 13
    s_xor_b32 m0, m0, 0x2000
    s_add_u32 m0, m0, 2048
    s_add_u32 s83, s72, s90
    s_add_u32 s83, s83, 20480
    buffer_load_dwordx4 v153, s[64:67], s83 offen offset:0 sc1 lds
    s_lshl_b32 m0, s81, 13
    s_xor_b32 m0, m0, 0x2000
    s_add_u32 m0, m0, 4096
    s_add_u32 s83, s72, s90
    s_add_u32 s83, s83, 40960
    buffer_load_dwordx4 v153, s[64:67], s83 offen offset:0 sc1 lds
    s_lshl_b32 m0, s81, 13
    s_xor_b32 m0, m0, 0x2000
    s_add_u32 m0, m0, 6144
    s_add_u32 s83, s72, s90
    s_add_u32 s83, s83, 61440
    buffer_load_dwordx4 v153, s[64:67], s83 offen offset:0 sc1 lds
    s_waitcnt vmcnt(0)
    v_and_b32 v169, 0x23ff, v159
    v_add_u32 v169, 0, v169
    ds_read_b128 v[88:91], v169 offset:0
    v_and_b32 v169, 0x23ff, v159
    v_add_u32 v169, 0, v169
    ds_read_b128 v[92:95], v169 offset:2048
    v_and_b32 v169, 0x23ff, v159
    v_add_u32 v169, 0, v169
    ds_read_b128 v[96:99], v169 offset:4096
    v_and_b32 v169, 0x23ff, v159
    v_add_u32 v169, 0, v169
    ds_read_b128 v[100:103], v169 offset:6144
    s_waitcnt lgkmcnt(0)
    v_bitop3_b32 v169, v88, v92, v96 bitop3:128
    v_bitop3_b32 v169, v169, v100, 1 bitop3:128
    v_cmp_ne_u32 vcc, 1, v169
    s_cbranch_vccnz L_xc2r
    s_branch L_xc2
L_xc3r:
    s_sub_u32 s101, s101, 1
    s_cbranch_scc1 L_end
    s_lshl_b32 m0, s81, 13
    s_xor_b32 m0, m0, 0x2000
    s_add_u32 m0, m0, 0
    s_add_u32 s83, s72, s90
    s_add_u32 s83, s83, 0
    buffer_load_dwordx4 v153, s[64:67], s83 offen offset:1024 sc1 lds
    s_lshl_b32 m0, s81, 13
    s_xor_b32 m0, m0, 0x2000
    s_add_u32 m0, m0, 2048
    s_add_u32 s83, s72, s90
    s_add_u32 s83, s83, 20480
    buffer_load_dwordx4 v153, s[64:67], s83 offen offset:1024 sc1 lds
    s_lshl_b32 m0, s81, 13
    s_xor_b32 m0, m0, 0x2000
    s_add_u32 m0, m0, 4096
    s_add_u32 s83, s72, s90
    s_add_u32 s83, s83, 40960
    buffer_load_dwordx4 v153, s[64:67], s83 offen offset:1024 sc1 lds
    s_lshl_b32 m0, s81, 13
    s_xor_b32 m0, m0, 0x2000
    s_add_u32 m0, m0, 6144
    s_add_u32 s83, s72, s90
    s_add_u32 s83, s83, 61440
    buffer_load_dwordx4 v153, s[64:67], s83 offen offset:1024 sc1 lds
    s_waitcnt vmcnt(0)
    v_and_b32 v169, 0x23ff, v159
    v_add_u32 v169, 0, v169
    ds_read_b128 v[56:59], v169 offset:1024
    v_and_b32 v169, 0x23ff, v159
    v_add_u32 v169, 0, v169
    ds_read_b128 v[60:63], v169 offset:3072
    v_and_b32 v169, 0x23ff, v159
    v_add_u32 v169, 0, v169
    ds_read_b128 v[64:67], v169 offset:5120
    v_and_b32 v169, 0x23ff, v159
    v_add_u32 v169, 0, v169
    ds_read_b128 v[68:71], v169 offset:7168
    s_waitcnt lgkmcnt(0)
    v_bitop3_b32 v169, v56, v60, v64 bitop3:128
    v_bitop3_b32 v169, v169, v68, 1 bitop3:128
    v_cmp_ne_u32 vcc, 1, v169
    s_cbranch_vccnz L_xc3r
    s_branch L_xc3
L_xc4r:
    s_sub_u32 s101, s101, 1
    s_cbranch_scc1 L_end
    s_lshl_b32 m0, s81, 13
    s_add_u32 m0, m0, 16384
    s_add_u32 s83, s73, s85
    s_add_u32 s83, s83, 0
    buffer_load_dwordx4 v153, s[64:67], s83 offen offset:0 sc1 lds
    s_lshl_b32 m0, s81, 13
    s_add_u32 m0, m0, 18432
    s_add_u32 s83, s73, s85
    s_add_u32 s83, s83, 20480
    buffer_load_dwordx4 v153, s[64:67], s83 offen offset:0 sc1 lds
    s_lshl_b32 m0, s81, 13
    s_add_u32 m0, m0, 20480
    s_add_u32 s83, s73, s85
    s_add_u32 s83, s83, 40960
    buffer_load_dwordx4 v153, s[64:67], s83 offen offset:0 sc1 lds
    s_lshl_b32 m0, s81, 13
    s_add_u32 m0, m0, 22528
    s_add_u32 s83, s73, s85
    s_add_u32 s83, s83, 61440
    buffer_load_dwordx4 v153, s[64:67], s83 offen offset:0 sc1 lds
    s_waitcnt vmcnt(0)
    v_and_b32 v169, 0x23ff, v158
    v_add_u32 v169, 16384, v169
    ds_read_b128 v[72:75], v169 offset:0
    v_and_b32 v169, 0x23ff, v158
    v_add_u32 v169, 16384, v169
    ds_read_b128 v[76:79], v169 offset:2048
    v_and_b32 v169, 0x23ff, v158
    v_add_u32 v169, 16384, v169
    ds_read_b128 v[80:83], v169 offset:4096
    v_and_b32 v169, 0x23ff, v158
    v_add_u32 v169, 16384, v169
    ds_read_b128 v[84:87], v169 offset:6144
    s_waitcnt lgkmcnt(0)
    v_bitop3_b32 v169, v72, v76, v80 bitop3:128
    v_bitop3_b32 v169, v169, v84, 1 bitop3:128
    v_cmp_ne_u32 vcc, 1, v169
    s_cbranch_vccnz L_xc4r
    s_branch L_xc4
L_xc5r:
    s_sub_u32 s101, s101, 1
    s_cbranch_scc1 L_end
    s_lshl_b32 m0, s81, 13
    s_add_u32 m0, m0, 16384
    s_add_u32 s83, s73, s85
    s_add_u32 s83, s83, 0
    buffer_load_dwordx4 v153, s[64:67], s83 offen offset:1024 sc1 lds
    s_lshl_b32 m0, s81, 13
    s_add_u32 m0, m0, 18432
    s_add_u32 s83, s73, s85
    s_add_u32 s83, s83, 20480
    buffer_load_dwordx4 v153, s[64:67], s83 offen offset:1024 sc1 lds
    s_lshl_b32 m0, s81, 13
    s_add_u32 m0, m0, 20480
    s_add_u32 s83, s73, s85
    s_add_u32 s83, s83, 40960
    buffer_load_dwordx4 v153, s[64:67], s83 offen offset:1024 sc1 lds
    s_lshl_b32 m0, s81, 13
    s_add_u32 m0, m0, 22528
    s_add_u32 s83, s73, s85
    s_add_u32 s83, s83, 61440
    buffer_load_dwordx4 v153, s[64:67], s83 offen offset:1024 sc1 lds
    s_waitcnt vmcnt(0)
    v_and_b32 v169, 0x23ff, v158
    v_add_u32 v169, 16384, v169
    ds_read_b128 v[88:91], v169 offset:1024
    v_and_b32 v169, 0x23ff, v158
    v_add_u32 v169, 16384, v169
    ds_read_b128 v[92:95], v169 offset:3072
    v_and_b32 v169, 0x23ff, v158
    v_add_u32 v169, 16384, v169
    ds_read_b128 v[96:99], v169 offset:5120
    v_and_b32 v169, 0x23ff, v158
    v_add_u32 v169, 16384, v169
    ds_read_b128 v[100:103], v169 offset:7168
    s_waitcnt lgkmcnt(0)
    v_bitop3_b32 v169, v88, v92, v96 bitop3:128
    v_bitop3_b32 v169, v169, v100, 1 bitop3:128
    v_cmp_ne_u32 vcc, 1, v169
    s_cbranch_vccnz L_xc5r
    s_branch L_xc5
L_s2r:
    s_sub_u32 s101, s101, 1
    s_cbranch_scc1 L_end
    global_load_dwordx4 v[104:107], v163, s[98:99] sc1
    global_load_dwordx4 v[108:111], v163, s[98:99] offset:256 sc1
    s_waitcnt vmcnt(0)
    s_branch L_s2
L_xc6r:
    s_sub_u32 s101, s101, 1
    s_cbranch_scc1 L_end
    s_lshl_b32 m0, s81, 13
    s_add_u32 m0, m0, 32768
    s_add_u32 s83, s74, s85
    s_add_u32 s83, s83, 0
    buffer_load_dwordx4 v153, s[64:67], s83 offen offset:0 sc1 lds
    s_lshl_b32 m0, s81, 13
    s_add_u32 m0, m0, 34816
    s_add_u32 s83, s74, s85
    s_add_u32 s83, s83, 20480
    buffer_load_dwordx4 v153, s[64:67], s83 offen offset:0 sc1 lds
    s_lshl_b32 m0, s81, 13
    s_add_u32 m0, m0, 36864
    s_add_u32 s83, s74, s85
    s_add_u32 s83, s83, 40960
    buffer_load_dwordx4 v153, s[64:67], s83 offen offset:0 sc1 lds
    s_lshl_b32 m0, s81, 13
    s_add_u32 m0, m0, 38912
    s_add_u32 s83, s74, s85
    s_add_u32 s83, s83, 61440
    buffer_load_dwordx4 v153, s[64:67], s83 offen offset:0 sc1 lds
    s_waitcnt vmcnt(0)
    v_and_b32 v169, 0x23ff, v158
    v_add_u32 v169, 32768, v169
    ds_read_b128 v[56:59], v169 offset:0
    v_and_b32 v169, 0x23ff, v158
    v_add_u32 v169, 32768, v169
    ds_read_b128 v[60:63], v169 offset:2048
    v_and_b32 v169, 0x23ff, v158
    v_add_u32 v169, 32768, v169
    ds_read_b128 v[64:67], v169 offset:4096
    v_and_b32 v169, 0x23ff, v158
    v_add_u32 v169, 32768, v169
    ds_read_b128 v[68:71], v169 offset:6144
    s_waitcnt lgkmcnt(0)
    v_bitop3_b32 v169, v56, v60, v64 bitop3:128
    v_bitop3_b32 v169, v169, v68, 1 bitop3:128
    v_cmp_ne_u32 vcc, 1, v169
    s_cbranch_vccnz L_xc6r
    s_branch L_xc6
L_xc7r:
    s_sub_u32 s101, s101, 1
    s_cbranch_scc1 L_end
    s_lshl_b32 m0, s81, 13
    s_add_u32 m0, m0, 32768
    s_add_u32 s83, s74, s85
    s_add_u32 s83, s83, 0
    buffer_load_dwordx4 v153, s[64:67], s83 offen offset:1024 sc1 lds
    s_lshl_b32 m0, s81, 13
    s_add_u32 m0, m0, 34816
    s_add_u32 s83, s74, s85
    s_add_u32 s83, s83, 20480
    buffer_load_dwordx4 v153, s[64:67], s83 offen offset:1024 sc1 lds
    s_lshl_b32 m0, s81, 13
    s_add_u32 m0, m0, 36864
    s_add_u32 s83, s74, s85
    s_add_u32 s83, s83, 40960
    buffer_load_dwordx4 v153, s[64:67], s83 offen offset:1024 sc1 lds
    s_lshl_b32 m0, s81, 13
    s_add_u32 m0, m0, 38912
    s_add_u32 s83, s74, s85
    s_add_u32 s83, s83, 61440
    buffer_load_dwordx4 v153, s[64:67], s83 offen offset:1024 sc1 lds
    s_waitcnt vmcnt(0)
    v_and_b32 v169, 0x23ff, v158
    v_add_u32 v169, 32768, v169
    ds_read_b128 v[72:75], v169 offset:1024
    v_and_b32 v169, 0x23ff, v158
    v_add_u32 v169, 32768, v169
    ds_read_b128 v[76:79], v169 offset:3072
    v_and_b32 v169, 0x23ff, v158
    v_add_u32 v169, 32768, v169
    ds_read_b128 v[80:83], v169 offset:5120
    v_and_b32 v169, 0x23ff, v158
    v_add_u32 v169, 32768, v169
    ds_read_b128 v[84:87], v169 offset:7168
    s_waitcnt lgkmcnt(0)
    v_bitop3_b32 v169, v72, v76, v80 bitop3:128
    v_bitop3_b32 v169, v169, v84, 1 bitop3:128
    v_cmp_ne_u32 vcc, 1, v169
    s_cbranch_vccnz L_xc7r
    s_branch L_xc7
L_xc8r:
    s_sub_u32 s101, s101, 1
    s_cbranch_scc1 L_end
    s_lshl_b32 m0, s81, 13
    s_add_u32 m0, m0, 49152
    s_add_u32 s83, s75, s85
    s_add_u32 s83, s83, 0
    buffer_load_dwordx4 v153, s[64:67], s83 offen offset:0 sc1 lds
    s_lshl_b32 m0, s81, 13
    s_add_u32 m0, m0, 51200
    s_add_u32 s83, s75, s85
    s_add_u32 s83, s83, 20480
    buffer_load_dwordx4 v153, s[64:67], s83 offen offset:0 sc1 lds
    s_lshl_b32 m0, s81, 13
    s_add_u32 m0, m0, 53248
    s_add_u32 s83, s75, s85
    s_add_u32 s83, s83, 40960
    buffer_load_dwordx4 v153, s[64:67], s83 offen offset:0 sc1 lds
    s_lshl_b32 m0, s81, 13
    s_add_u32 m0, m0, 55296
    s_add_u32 s83, s75, s85
    s_add_u32 s83, s83, 61440
    buffer_load_dwordx4 v153, s[64:67], s83 offen offset:0 sc1 lds
    s_waitcnt vmcnt(0)
    v_and_b32 v169, 0x23ff, v158
    v_add_u32 v169, 49152, v169
    ds_read_b128 v[88:91], v169 offset:0
    v_and_b32 v169, 0x23ff, v158
    v_add_u32 v169, 49152, v169
    ds_read_b128 v[92:95], v169 offset:2048
    v_and_b32 v169, 0x23ff, v158
    v_add_u32 v169, 49152, v169
    ds_read_b128 v[96:99], v169 offset:4096
    v_and_b32 v169, 0x23ff, v158
    v_add_u32 v169, 49152, v169
    ds_read_b128 v[100:103], v169 offset:6144
    s_waitcnt lgkmcnt(0)
    v_bitop3_b32 v169, v88, v92, v96 bitop3:128
    v_bitop3_b32 v169, v169, v100, 1 bitop3:128
    v_cmp_ne_u32 vcc, 1, v169
    s_cbranch_vccnz L_xc8r
    s_branch L_xc8
L_xc9r:
    s_sub_u32 s101, s101, 1
    s_cbranch_scc1 L_end
    s_lshl_b32 m0, s81, 13
    s_add_u32 m0, m0, 49152
    s_add_u32 s83, s75, s85
    s_add_u32 s83, s83, 0
    buffer_load_dwordx4 v153, s[64:67], s83 offen offset:1024 sc1 lds
    s_lshl_b32 m0, s81, 13
    s_add_u32 m0, m0, 51200
    s_add_u32 s83, s75, s85
    s_add_u32 s83, s83, 20480
    buffer_load_dwordx4 v153, s[64:67], s83 offen offset:1024 sc1 lds
    s_lshl_b32 m0, s81, 13
    s_add_u32 m0, m0, 53248
    s_add_u32 s83, s75, s85
    s_add_u32 s83, s83, 40960
    buffer_load_dwordx4 v153, s[64:67], s83 offen offset:1024 sc1 lds
    s_lshl_b32 m0, s81, 13
    s_add_u32 m0, m0, 55296
    s_add_u32 s83, s75, s85
    s_add_u32 s83, s83, 61440
    buffer_load_dwordx4 v153, s[64:67], s83 offen offset:1024 sc1 lds
    s_waitcnt vmcnt(0)
    v_and_b32 v169, 0x23ff, v158
    v_add_u32 v169, 49152, v169
    ds_read_b128 v[56:59], v169 offset:1024
    v_and_b32 v169, 0x23ff, v158
    v_add_u32 v169, 49152, v169
    ds_read_b128 v[60:63], v169 offset:3072
    v_and_b32 v169, 0x23ff, v158
    v_add_u32 v169, 49152, v169
    ds_read_b128 v[64:67], v169 offset:5120
    v_and_b32 v169, 0x23ff, v158
    v_add_u32 v169, 49152, v169
    ds_read_b128 v[68:71], v169 offset:7168
    s_waitcnt lgkmcnt(0)
    v_bitop3_b32 v169, v56, v60, v64 bitop3:128
    v_bitop3_b32 v169, v169, v68, 1 bitop3:128
    v_cmp_ne_u32 vcc, 1, v169
    s_cbranch_vccnz L_xc9r
    s_branch L_xc9
L_xc10r:
    s_sub_u32 s101, s101, 1
    s_cbranch_scc1 L_end
    s_lshl_b32 m0, s81, 13
    s_add_u32 m0, m0, 65536
    s_add_u32 s83, s76, s85
    s_add_u32 s83, s83, 0
    buffer_load_dwordx4 v153, s[64:67], s83 offen offset:0 sc1 lds
    s_lshl_b32 m0, s81, 13
    s_add_u32 m0, m0, 65536
    s_add_u32 s83, s76, s85
    s_add_u32 s83, s83, 0
    buffer_load_dwordx4 v153, s[64:67], s83 offen offset:1024 sc1 lds
    s_lshl_b32 m0, s81, 13
    s_add_u32 m0, m0, 67584
    s_add_u32 s83, s76, s85
    s_add_u32 s83, s83, 20480
    buffer_load_dwordx4 v153, s[64:67], s83 offen offset:0 sc1 lds
    s_lshl_b32 m0, s81, 13
    s_add_u32 m0, m0, 67584
    s_add_u32 s83, s76, s85
    s_add_u32 s83, s83, 20480
    buffer_load_dwordx4 v153, s[64:67], s83 offen offset:1024 sc1 lds
    s_waitcnt vmcnt(0)
    v_and_b32 v169, 0x23ff, v158
    v_add_u32 v169, 65536, v169
    ds_read_b128 v[72:75], v169 offset:0
    v_and_b32 v169, 0x23ff, v158
    v_add_u32 v169, 65536, v169
    ds_read_b128 v[76:79], v169 offset:1024
    v_and_b32 v169, 0x23ff, v158
    v_add_u32 v169, 65536, v169
    ds_read_b128 v[80:83], v169 offset:2048
    v_and_b32 v169, 0x23ff, v158
    v_add_u32 v169, 65536, v169
    ds_read_b128 v[84:87], v169 offset:3072
    s_waitcnt lgkmcnt(0)
    v_bitop3_b32 v169, v72, v76, v80 bitop3:128
    v_bitop3_b32 v169, v169, v84, 1 bitop3:128
    v_cmp_ne_u32 vcc, 1, v169
    s_cbranch_vccnz L_xc10r
    s_branch L_xc10
L_xc11r:
    s_sub_u32 s101, s101, 1
    s_cbranch_scc1 L_end
    s_lshl_b32 m0, s81, 13
    s_add_u32 m0, m0, 69632
    s_add_u32 s83, s76, s85
    s_add_u32 s83, s83, 40960
    buffer_load_dwordx4 v153, s[64:67], s83 offen offset:0 sc1 lds
    s_lshl_b32 m0, s81, 13
    s_add_u32 m0, m0, 69632
    s_add_u32 s83, s76, s85
    s_add_u32 s83, s83, 40960
    buffer_load_dwordx4 v153, s[64:67], s83 offen offset:1024 sc1 lds
    s_lshl_b32 m0, s81, 13
    s_add_u32 m0, m0, 71680
    s_add_u32 s83, s76, s85
    s_add_u32 s83, s83, 61440
    buffer_load_dwordx4 v153, s[64:67], s83 offen offset:0 sc1 lds
    s_lshl_b32 m0, s81, 13
    s_add_u32 m0, m0, 71680
    s_add_u32 s83, s76, s85
    s_add_u32 s83, s83, 61440
    buffer_load_dwordx4 v153, s[64:67], s83 offen offset:1024 sc1 lds
    s_waitcnt vmcnt(0)
    v_and_b32 v169, 0x23ff, v158
    v_add_u32 v169, 65536, v169
    ds_read_b128 v[88:91], v169 offset:4096
    v_and_b32 v169, 0x23ff, v158
    v_add_u32 v169, 65536, v169
    ds_read_b128 v[92:95], v169 offset:5120
    v_and_b32 v169, 0x23ff, v158
    v_add_u32 v169, 65536, v169
    ds_read_b128 v[96:99], v169 offset:6144
    v_and_b32 v169, 0x23ff, v158
    v_add_u32 v169, 65536, v169
    ds_read_b128 v[100:103], v169 offset:7168
    s_waitcnt lgkmcnt(0)
    v_bitop3_b32 v169, v88, v92, v96 bitop3:128
    v_bitop3_b32 v169, v169, v100, 1 bitop3:128
    v_cmp_ne_u32 vcc, 1, v169
    s_cbranch_vccnz L_xc11r
    s_branch L_xc11
L_xc12r:
    s_sub_u32 s101, s101, 1
    s_cbranch_scc1 L_end
    s_lshl_b32 m0, s81, 13
    s_xor_b32 m0, m0, 0x2000
    s_add_u32 m0, m0, 16384
    s_add_u32 s83, s73, s90
    s_add_u32 s83, s83, 0
    buffer_load_dwordx4 v153, s[64:67], s83 offen offset:0 sc1 lds
    s_lshl_b32 m0, s81, 13
    s_xor_b32 m0, m0, 0x2000
    s_add_u32 m0, m0, 16384
    s_add_u32 s83, s73, s90
    s_add_u32 s83, s83, 0
    buffer_load_dwordx4 v153, s[64:67], s83 offen offset:1024 sc1 lds
    s_lshl_b32 m0, s81, 13
    s_xor_b32 m0, m0, 0x2000
    s_add_u32 m0, m0, 32768
    s_add_u32 s83, s74, s90
    s_add_u32 s83, s83, 0
    buffer_load_dwordx4 v153, s[64:67], s83 offen offset:0 sc1 lds
    s_lshl_b32 m0, s81, 13
    s_xor_b32 m0, m0, 0x2000
    s_add_u32 m0, m0, 32768
    s_add_u32 s83, s74, s90
    s_add_u32 s83, s83, 0
    buffer_load_dwordx4 v153, s[64:67], s83 offen offset:1024 sc1 lds
    s_waitcnt vmcnt(0)
    v_and_b32 v169, 0x23ff, v159
    v_add_u32 v169, 16384, v169
    ds_read_b128 v[56:59], v169 offset:0
    v_and_b32 v169, 0x23ff, v159
    v_add_u32 v169, 16384, v169
    ds_read_b128 v[60:63], v169 offset:1024
    v_and_b32 v169, 0x23ff, v159
    v_add_u32 v169, 32768, v169
    ds_read_b128 v[64:67], v169 offset:0
    v_and_b32 v169, 0x23ff, v159
    v_add_u32 v169, 32768, v169
    ds_read_b128 v[68:71], v169 offset:1024
    s_waitcnt lgkmcnt(0)
    v_bitop3_b32 v169, v56, v60, v64 bitop3:128
    v_bitop3_b32 v169, v169, v68, 1 bitop3:128
    v_cmp_ne_u32 vcc, 1, v169
    s_cbranch_vccnz L_xc12r
    s_branch L_xc12
L_xc13r:
    s_sub_u32 s101, s101, 1
    s_cbranch_scc1 L_end
    s_lshl_b32 m0, s81, 13
    s_xor_b32 m0, m0, 0x2000
    s_add_u32 m0, m0, 49152
    s_add_u32 s83, s75, s90
    s_add_u32 s83, s83, 0
    buffer_load_dwordx4 v153, s[64:67], s83 offen offset:0 sc1 lds
    s_lshl_b32 m0, s81, 13
    s_xor_b32 m0, m0, 0x2000
    s_add_u32 m0, m0, 49152
    s_add_u32 s83, s75, s90
    s_add_u32 s83, s83, 0
    buffer_load_dwordx4 v153, s[64:67], s83 offen offset:1024 sc1 lds
    s_lshl_b32 m0, s81, 13
    s_xor_b32 m0, m0, 0x2000
    s_add_u32 m0, m0, 65536
    s_add_u32 s83, s76, s90
    s_add_u32 s83, s83, 0
    buffer_load_dwordx4 v153, s[64:67], s83 offen offset:0 sc1 lds
    s_lshl_b32 m0, s81, 13
    s_xor_b32 m0, m0, 0x2000
    s_add_u32 m0, m0, 65536
    s_add_u32 s83, s76, s90
    s_add_u32 s83, s83, 0
    buffer_load_dwordx4 v153, s[64:67], s83 offen offset:1024 sc1 lds
    s_waitcnt vmcnt(0)
    v_and_b32 v169, 0x23ff, v159
    v_add_u32 v169, 49152, v169
    ds_read_b128 v[72:75], v169 offset:0
    v_and_b32 v169, 0x23ff, v159
    v_add_u32 v169, 49152, v169
    ds_read_b128 v[76:79], v169 offset:1024
    v_and_b32 v169, 0x23ff, v159
    v_add_u32 v169, 65536, v169
    ds_read_b128 v[80:83], v169 offset:0
    v_and_b32 v169, 0x23ff, v159
    v_add_u32 v169, 65536, v169
    ds_read_b128 v[84:87], v169 offset:1024
    s_waitcnt lgkmcnt(0)
    v_bitop3_b32 v169, v72, v76, v80 bitop3:128
    v_bitop3_b32 v169, v169, v84, 1 bitop3:128
    v_cmp_ne_u32 vcc, 1, v169
    s_cbranch_vccnz L_xc13r
    s_branch L_xc13
L_xc14r:
    s_sub_u32 s101, s101, 1
    s_cbranch_scc1 L_end
    s_lshl_b32 m0, s81, 13
    s_xor_b32 m0, m0, 0x2000
    s_add_u32 m0, m0, 18432
    s_add_u32 s83, s73, s90
    s_add_u32 s83, s83, 20480
    buffer_load_dwordx4 v153, s[64:67], s83 offen offset:0 sc1 lds
    s_lshl_b32 m0, s81, 13
    s_xor_b32 m0, m0, 0x2000
    s_add_u32 m0, m0, 18432
    s_add_u32 s83, s73, s90
    s_add_u32 s83, s83, 20480
    buffer_load_dwordx4 v153, s[64:67], s83 offen offset:1024 sc1 lds
    s_lshl_b32 m0, s81, 13
    s_xor_b32 m0, m0, 0x2000
    s_add_u32 m0, m0, 34816
    s_add_u32 s83, s74, s90
    s_add_u32 s83, s83, 20480
    buffer_load_dwordx4 v153, s[64:67], s83 offen offset:0 sc1 lds
    s_lshl_b32 m0, s81, 13
    s_xor_b32 m0, m0, 0x2000
    s_add_u32 m0, m0, 34816
    s_add_u32 s83, s74, s90
    s_add_u32 s83, s83, 20480
    buffer_load_dwordx4 v153, s[64:67], s83 offen offset:1024 sc1 lds
    s_waitcnt vmcnt(0)
    v_and_b32 v169, 0x23ff, v159
    v_add_u32 v169, 16384, v169
    ds_read_b128 v[56:59], v169 offset:2048
    v_and_b32 v169, 0x23ff, v159
    v_add_u32 v169, 16384, v169
    ds_read_b128 v[60:63], v169 offset:3072
    v_and_b32 v169, 0x23ff, v159
    v_add_u32 v169, 32768, v169
    ds_read_b128 v[64:67], v169 offset:2048
    v_and_b32 v169, 0x23ff, v159
    v_add_u32 v169, 32768, v169
    ds_read_b128 v[68:71], v169 offset:3072
    s_waitcnt lgkmcnt(0)
    v_bitop3_b32 v169, v56, v60, v64 bitop3:128
    v_bitop3_b32 v169, v169, v68, 1 bitop3:128
    v_cmp_ne_u32 vcc, 1, v169
    s_cbranch_vccnz L_xc14r
    s_branch L_xc14
L_xc15r:
    s_sub_u32 s101, s101, 1
    s_cbranch_scc1 L_end
    s_lshl_b32 m0, s81, 13
    s_xor_b32 m0, m0, 0x2000
    s_add_u32 m0, m0, 51200
    s_add_u32 s83, s75, s90
    s_add_u32 s83, s83, 20480
    buffer_load_dwordx4 v153, s[64:67], s83 offen offset:0 sc1 lds
    s_lshl_b32 m0, s81, 13
    s_xor_b32 m0, m0, 0x2000
    s_add_u32 m0, m0, 51200
    s_add_u32 s83, s75, s90
    s_add_u32 s83, s83, 20480
    buffer_load_dwordx4 v153, s[64:67], s83 offen offset:1024 sc1 lds
    s_lshl_b32 m0, s81, 13
    s_xor_b32 m0, m0, 0x2000
    s_add_u32 m0, m0, 67584
    s_add_u32 s83, s76, s90
    s_add_u32 s83, s83, 20480
    buffer_load_dwordx4 v153, s[64:67], s83 offen offset:0 sc1 lds
    s_lshl_b32 m0, s81, 13
    s_xor_b32 m0, m0, 0x2000
    s_add_u32 m0, m0, 67584
    s_add_u32 s83, s76, s90
    s_add_u32 s83, s83, 20480
    buffer_load_dwordx4 v153, s[64:67], s83 offen offset:1024 sc1 lds
    s_waitcnt vmcnt(0)
    v_and_b32 v169, 0x23ff, v159
    v_add_u32 v169, 49152, v169
    ds_read_b128 v[72:75], v169 offset:2048
    v_and_b32 v169, 0x23ff, v159
    v_add_u32 v169, 49152, v169
    ds_read_b128 v[76:79], v169 offset:3072
    v_and_b32 v169, 0x23ff, v159
    v_add_u32 v169, 65536, v169
    ds_read_b128 v[80:83], v169 offset:2048
    v_and_b32 v169, 0x23ff, v159
    v_add_u32 v169, 65536, v169
    ds_read_b128 v[84:87], v169 offset:3072
    s_waitcnt lgkmcnt(0)
    v_bitop3_b32 v169, v72, v76, v80 bitop3:128
    v_bitop3_b32 v169, v169, v84, 1 bitop3:128
    v_cmp_ne_u32 vcc, 1, v169
    s_cbranch_vccnz L_xc15r
    s_branch L_xc15
Lss_23:
    global_store_dword v110, v111, s[50:51] sc1
    s_branch Lsd_24
L_cre1:
    s_sub_u32 s101, s101, 1
    s_cbranch_scc1 L_end
    buffer_load_dwordx4 v[88:91], v85, s[92:95], 0 offen offset:256 sc1
    buffer_load_dwordx4 v[92:95], v85, s[92:95], 0 offen offset:512 sc1
    buffer_load_dwordx4 v[96:99], v85, s[92:95], 0 offen offset:768 sc1
    buffer_load_dwordx4 v[100:103], v85, s[92:95], 0 offen offset:1024 sc1
    buffer_load_dwordx4 v[104:107], v85, s[92:95], 0 offen offset:1280 sc1
    buffer_load_dwordx4 v[108:111], v85, s[92:95], 0 offen offset:1536 sc1
    buffer_load_dwordx4 v[112:115], v85, s[92:95], 0 offen offset:1792 sc1
    buffer_load_dwordx4 v[116:119], v85, s[92:95], 0 offen offset:2048 sc1
    s_waitcnt vmcnt(0)
    s_branch L_cchk1
L_xr_re:
    s_sub_u32 s101, s101, 1
    s_cbranch_scc1 L_end
    global_load_dword v64, v87, s[50:51] sc1
    s_waitcnt vmcnt(0)
    s_branch L_xr
Lss_25:
    buffer_store_dwordx4 v[88:91], v153, s[64:67], s36 offen sc1
    s_branch Lsd_26
Lss_27:
    buffer_store_dwordx4 v[92:95], v153, s[64:67], s18 offen sc1
    s_branch Lsd_28
Lss_29:
    buffer_store_dwordx2 v[116:117], v62, s[64:67], s37 offen offset:0 sc1
    buffer_store_dwordx2 v[118:119], v62, s[64:67], s37 offen offset:512 sc1
    s_branch Lsd_30
Lss_31:
    buffer_store_dwordx4 v[96:99], v153, s[64:67], s19 offen sc1
    s_branch Lsd_32
Lss_33:
    buffer_store_dwordx4 v[100:103], v153, s[64:67], s20 offen sc1
    s_branch Lsd_34
Lh1c1r:
    s_sub_u32 s101, s101, 1
    s_cbranch_scc1 L_end
    buffer_load_dwordx4 v[120:123], v175, s[64:67], s22 offen offset:0 sc1
    buffer_load_dwordx4 v[80:83], v175, s[64:67], s25 offen offset:0 sc1
    buffer_load_dwordx4 v[116:119], v175, s[64:67], s28 offen offset:0 sc1
    buffer_load_dwordx4 v[64:67], v175, s[64:67], s31 offen offset:0 sc1
    buffer_load_dwordx4 v[60:63], v175, s[64:67], s22 offen offset:1024 sc1
    buffer_load_dwordx4 v[68:71], v175, s[64:67], s25 offen offset:1024 sc1
    buffer_load_dwordx4 v[72:75], v175, s[64:67], s28 offen offset:1024 sc1
    buffer_load_dwordx4 v[76:79], v175, s[64:67], s31 offen offset:1024 sc1
    s_waitcnt vmcnt(0)
    v_bitop3_b32 v169, v120, v122, v80 bitop3:254
    v_bitop3_b32 v169, v169, v82, v116 bitop3:254
    v_bitop3_b32 v169, v169, v118, v64 bitop3:254
    v_bitop3_b32 v169, v169, v66, 1 bitop3:168
    v_cmp_ne_u32 vcc, 0, v169
    s_cbranch_vccnz Lh1c1r
    s_branch Lh1c1
Lh1c2r:
    s_sub_u32 s101, s101, 1
    s_cbranch_scc1 L_end
    buffer_load_dwordx4 v[60:63], v175, s[64:67], s22 offen offset:1024 sc1
    buffer_load_dwordx4 v[68:71], v175, s[64:67], s25 offen offset:1024 sc1
    buffer_load_dwordx4 v[72:75], v175, s[64:67], s28 offen offset:1024 sc1
    buffer_load_dwordx4 v[76:79], v175, s[64:67], s31 offen offset:1024 sc1
    buffer_load_dwordx4 v[84:87], v175, s[64:67], s22 offen offset:2048 sc1
    buffer_load_dwordx4 v[88:91], v175, s[64:67], s25 offen offset:2048 sc1
    buffer_load_dwordx4 v[92:95], v175, s[64:67], s28 offen offset:2048 sc1
    buffer_load_dwordx4 v[96:99], v175, s[64:67], s31 offen offset:2048 sc1
    buffer_load_dwordx4 v[100:103], v175, s[64:67], s22 offen offset:3072 sc1
    s_waitcnt vmcnt(0)
    v_bitop3_b32 v169, v60, v62, v68 bitop3:254
    v_bitop3_b32 v169, v169, v70, v72 bitop3:254
    v_bitop3_b32 v169, v169, v74, v76 bitop3:254
    v_bitop3_b32 v169, v169, v78, 1 bitop3:168
    v_cmp_ne_u32 vcc, 0, v169
    s_cbranch_vccnz Lh1c2r
    s_branch Lh1c2
Lh1c3r:
    s_sub_u32 s101, s101, 1
    s_cbranch_scc1 L_end
    buffer_load_dwordx4 v[84:87], v175, s[64:67], s22 offen offset:2048 sc1
    buffer_load_dwordx4 v[88:91], v175, s[64:67], s25 offen offset:2048 sc1
    buffer_load_dwordx4 v[92:95], v175, s[64:67], s28 offen offset:2048 sc1
    buffer_load_dwordx4 v[96:99], v175, s[64:67], s31 offen offset:2048 sc1
    buffer_load_dwordx4 v[100:103], v175, s[64:67], s22 offen offset:3072 sc1
    buffer_load_dwordx4 v[104:107], v175, s[64:67], s25 offen offset:3072 sc1
    buffer_load_dwordx4 v[108:111], v175, s[64:67], s28 offen offset:3072 sc1
    buffer_load_dwordx4 v[120:123], v175, s[64:67], s31 offen offset:3072 sc1
    buffer_load_dwordx4 v[80:83], v175, s[64:67], s26 offen offset:0 sc1
    buffer_load_dwordx4 v[116:119], v175, s[64:67], s26 offen offset:1024 sc1
    s_waitcnt vmcnt(0)
    v_bitop3_b32 v169, v84, v86, v88 bitop3:254
    v_bitop3_b32 v169, v169, v90, v92 bitop3:254
    v_bitop3_b32 v169, v169, v94, v96 bitop3:254
    v_bitop3_b32 v169, v169, v98, 1 bitop3:168
    v_cmp_ne_u32 vcc, 0, v169
    s_cbranch_vccnz Lh1c3r
    s_branch Lh1c3
Lh1c4r:
    s_sub_u32 s101, s101, 1
    s_cbranch_scc1 L_end
    buffer_load_dwordx4 v[100:103], v175, s[64:67], s22 offen offset:3072 sc1
    buffer_load_dwordx4 v[104:107], v175, s[64:67], s25 offen offset:3072 sc1
    buffer_load_dwordx4 v[108:111], v175, s[64:67], s28 offen offset:3072 sc1
    buffer_load_dwordx4 v[120:123], v175, s[64:67], s31 offen offset:3072 sc1
    buffer_load_dwordx4 v[80:83], v175, s[64:67], s26 offen offset:0 sc1
    buffer_load_dwordx4 v[116:119], v175, s[64:67], s26 offen offset:1024 sc1
    buffer_load_dwordx4 v[64:67], v175, s[64:67], s26 offen offset:2048 sc1
    buffer_load_dwordx4 v[60:63], v175, s[64:67], s26 offen offset:3072 sc1
    buffer_load_dwordx4 v[68:71], v175, s[64:67], s27 offen offset:0 sc1
    buffer_load_dwordx4 v[72:75], v175, s[64:67], s27 offen offset:1024 sc1
    buffer_load_dwordx4 v[76:79], v175, s[64:67], s29 offen offset:0 sc1
    s_waitcnt vmcnt(0)
    v_bitop3_b32 v169, v100, v102, v104 bitop3:254
    v_bitop3_b32 v169, v169, v106, v108 bitop3:254
    v_bitop3_b32 v169, v169, v110, v120 bitop3:254
    v_bitop3_b32 v169, v169, v122, 1 bitop3:168
    v_cmp_ne_u32 vcc, 0, v169
    s_cbranch_vccnz Lh1c4r
    s_branch Lh1c4
Lh1c5r:
    s_sub_u32 s101, s101, 1
    s_cbranch_scc1 L_end
    buffer_load_dwordx4 v[80:83], v175, s[64:67], s26 offen offset:0 sc1
    buffer_load_dwordx4 v[116:119], v175, s[64:67], s26 offen offset:1024 sc1
    buffer_load_dwordx4 v[64:67], v175, s[64:67], s26 offen offset:2048 sc1
    buffer_load_dwordx4 v[60:63], v175, s[64:67], s26 offen offset:3072 sc1
    buffer_load_dwordx4 v[68:71], v175, s[64:67], s27 offen offset:0 sc1
    buffer_load_dwordx4 v[72:75], v175, s[64:67], s27 offen offset:1024 sc1
    buffer_load_dwordx4 v[76:79], v175, s[64:67], s29 offen offset:0 sc1
    buffer_load_dwordx4 v[84:87], v175, s[64:67], s29 offen offset:1024 sc1
    buffer_load_dwordx4 v[88:91], v175, s[64:67], s29 offen offset:2048 sc1
    buffer_load_dwordx4 v[92:95], v175, s[64:67], s29 offen offset:3072 sc1
    buffer_load_dwordx4 v[96:99], v175, s[64:67], s30 offen offset:0 sc1
    buffer_load_dwordx4 v[100:103], v175, s[64:67], s30 offen offset:1024 sc1
    s_waitcnt vmcnt(0)
    v_bitop3_b32 v169, v80, v82, v116 bitop3:254
    v_bitop3_b32 v169, v169, v118, v64 bitop3:254
    v_bitop3_b32 v169, v169, v66, v60 bitop3:254
    v_bitop3_b32 v169, v169, v62, v68 bitop3:254
    v_bitop3_b32 v169, v169, v70, v72 bitop3:254
    v_bitop3_b32 v169, v169, v74, 1 bitop3:168
    v_cmp_ne_u32 vcc, 0, v169
    s_cbranch_vccnz Lh1c5r
    s_branch Lh1c5
Lh1c6r:
    s_sub_u32 s101, s101, 1
    s_cbranch_scc1 L_end
    buffer_load_dwordx4 v[76:79], v175, s[64:67], s29 offen offset:0 sc1
    buffer_load_dwordx4 v[84:87], v175, s[64:67], s29 offen offset:1024 sc1
    buffer_load_dwordx4 v[88:91], v175, s[64:67], s29 offen offset:2048 sc1
    buffer_load_dwordx4 v[92:95], v175, s[64:67], s29 offen offset:3072 sc1
    buffer_load_dwordx4 v[96:99], v175, s[64:67], s30 offen offset:0 sc1
    buffer_load_dwordx4 v[100:103], v175, s[64:67], s30 offen offset:1024 sc1
    buffer_load_dwordx4 v[104:107], v175, s[64:67], s32 offen offset:0 sc1
    buffer_load_dwordx4 v[108:111], v175, s[64:67], s32 offen offset:1024 sc1
    buffer_load_dwordx4 v[120:123], v175, s[64:67], s32 offen offset:2048 sc1
    buffer_load_dwordx4 v[80:83], v175, s[64:67], s32 offen offset:3072 sc1
    buffer_load_dwordx4 v[116:119], v175, s[64:67], s33 offen offset:0 sc1
    s_waitcnt vmcnt(0)
    v_bitop3_b32 v169, v76, v78, v84 bitop3:254
    v_bitop3_b32 v169, v169, v86, v88 bitop3:254
    v_bitop3_b32 v169, v169, v90, v92 bitop3:254
    v_bitop3_b32 v169, v169, v94, v96 bitop3:254
    v_bitop3_b32 v169, v169, v98, v100 bitop3:254
    v_bitop3_b32 v169, v169, v102, 1 bitop3:168
    v_cmp_ne_u32 vcc, 0, v169
    s_cbranch_vccnz Lh1c6r
    s_branch Lh1c6
Lh1c7r:
    s_sub_u32 s101, s101, 1
    s_cbranch_scc1 L_end
    buffer_load_dwordx4 v[104:107], v175, s[64:67], s32 offen offset:0 sc1
    buffer_load_dwordx4 v[108:111], v175, s[64:67], s32 offen offset:1024 sc1
    buffer_load_dwordx4 v[120:123], v175, s[64:67], s32 offen offset:2048 sc1
    buffer_load_dwordx4 v[80:83], v175, s[64:67], s32 offen offset:3072 sc1
    buffer_load_dwordx4 v[116:119], v175, s[64:67], s33 offen offset:0 sc1
    buffer_load_dwordx4 v[64:67], v175, s[64:67], s33 offen offset:1024 sc1
    buffer_load_dwordx4 v[60:63], v175, s[64:67], s23 offen offset:3072 sc1
    buffer_load_dwordx4 v[68:71], v175, s[64:67], s24 offen offset:0 sc1
    buffer_load_dwordx4 v[72:75], v175, s[64:67], s24 offen offset:1024 sc1
    s_waitcnt vmcnt(0)
    v_bitop3_b32 v169, v104, v106, v108 bitop3:254
    v_bitop3_b32 v169, v169, v110, v120 bitop3:254
    v_bitop3_b32 v169, v169, v122, v80 bitop3:254
    v_bitop3_b32 v169, v169, v82, v116 bitop3:254
    v_bitop3_b32 v169, v169, v118, v64 bitop3:254
    v_bitop3_b32 v169, v169, v66, 1 bitop3:168
    v_cmp_ne_u32 vcc, 0, v169
    s_cbranch_vccnz Lh1c7r
    s_branch Lh1c7
Lh1c8r:
    s_sub_u32 s101, s101, 1
    s_cbranch_scc1 L_end
    buffer_load_dwordx4 v[60:63], v175, s[64:67], s23 offen offset:3072 sc1
    buffer_load_dwordx4 v[68:71], v175, s[64:67], s24 offen offset:0 sc1
    buffer_load_dwordx4 v[72:75], v175, s[64:67], s24 offen offset:1024 sc1
    s_waitcnt vmcnt(0)
    v_bitop3_b32 v169, v60, v62, v68 bitop3:254
    v_bitop3_b32 v169, v169, v70, v72 bitop3:254
    v_bitop3_b32 v169, v169, v74, 1 bitop3:168
    v_cmp_ne_u32 vcc, 0, v169
    s_cbranch_vccnz Lh1c8r
    s_branch Lh1c8
Lss_35:
    global_store_dwordx2 v155, v[0:1], s[98:99] sc1
    s_branch Lsd_36
L_s3r:
    s_sub_u32 s101, s101, 1
    s_cbranch_scc1 L_end
    global_load_dwordx4 v[0:3], v163, s[98:99] sc1
    global_load_dwordx4 v[4:7], v163, s[98:99] offset:256 sc1
    s_waitcnt vmcnt(0)
    s_branch L_s3
L_last:
    s_endpgm
.section .rodata,"a"
.p2align 6
.amdhsa_kernel interleave_layers__ssm_conv_s5__ssm_conv_h3__prompt_kernel
  .amdhsa_next_free_vgpr 512
  .amdhsa_next_free_sgpr 102
  .amdhsa_accum_offset 256
  .amdhsa_group_segment_fixed_size 0
  .amdhsa_kernarg_size 144
  .amdhsa_user_sgpr_count 2
  .amdhsa_user_sgpr_kernarg_segment_ptr 1
  .amdhsa_system_sgpr_workgroup_id_x 1
.end_amdhsa_kernel
```

```asm
; @launch grid=(256,1,1) block=(256,1,1) lds=163840
.amdgcn_target "amdgcn-amd-amdhsa--gfx950"
.text
.globl interleave_layers__ssm_conv_s5__ssm_conv_h3__prompt_kernel
.p2align 8
.type interleave_layers__ssm_conv_s5__ssm_conv_h3__prompt_kernel,@function
interleave_layers__ssm_conv_s5__ssm_conv_h3__prompt_kernel:
    s_cmp_gt_u32 s2, 255
    s_cbranch_scc1 L_end
    s_load_dwordx16 s[32:47], s[0:1], 64
    s_load_dwordx16 s[16:31], s[0:1], 0
    s_load_dwordx4 s[48:51], s[0:1], 128
    s_memrealtime s[6:7]
    v_and_b32 v152, 63, v0
    v_lshrrev_b32 v1, 6, v0
    s_and_b32 s8, s2, 7
    s_lshr_b32 s9, s2, 3
    v_readfirstlane_b32 s77, v1
    s_getpc_b64 s[4:5]
L_pc:
    s_lshl_b32 s3, s9, 2
    s_add_u32 s3, s3, s77
    s_lshl_b32 s3, s3, 9
    v_and_b32 v2, 3, v152
    v_lshl_add_u32 v2, v2, 7, s3
    v_min_u32 v2, L_last-L_pc, v2
    global_load_dword a255, v2, s[4:5]
    s_and_b32 s78, s9, 7
    s_lshr_b32 s10, s9, 3
    s_lshl_b32 s79, s10, 3
    s_add_u32 s79, s79, s8
    v_mov_b32 v174, 0
    s_and_b32 s10, s10, 2
    s_add_u32 s10, s10, s8
    s_add_u32 s10, s10, s78
    v_lshrrev_b32 v12, 3, v152
    v_and_b32 v13, 7, v152
    v_mul_u32_u24 v158, 1280, v12
    v_lshl_add_u32 v14, v13, 4, v158
    s_mul_i32 s5, s79, 81920
    s_lshl_b32 s4, s78, 7
    s_add_u32 s4, s4, s5
    s_mul_i32 s3, s77, 20480
    s_add_u32 s3, s3, s4
    v_add_u32 v70, s3, v14
    s_sub_u32 s4, s4, 10240
    v_add_u32 v14, s4, v14
    v_lshrrev_b32 v15, 1, v152
    v_mul_u32_u24 v15, 1280, v15
    v_and_b32 v72, 1, v152
    v_lshl_add_u32 v15, v72, 4, v15
    s_mul_i32 s4, s78, 96
    s_sub_u32 s3, s3, s4
    s_add_u32 s3, s3, 2048
    v_add_u32 v72, s3, v15
    v_cmp_gt_u32 vcc, 40, v152
    v_subrev_u32 v71, 6144, v72
    s_mul_i32 s9, s77, 1536
    v_cndmask_b32 v71, v14, v71, vcc
    s_sub_u32 s9, 54272, s9
    s_mul_i32 s8, s77, 4128
    s_mov_b32 s66, 2621440
    s_mov_b32 s67, 0x20000
    s_mov_b32 s70, 2622464
    s_mov_b32 s71, 0x20000
    v_lshlrev_b32 v153, 4, v152
    v_lshrrev_b32 v145, 1, v0
    s_movk_i32 s3, 80
    v_cmp_gt_u32 s[96:97], s3, v145
    v_min_u32 v145, 79, v145
    s_mul_i32 s3, s78, 160
    v_lshl_add_u32 v147, v145, 1, s3
    s_lshl_b32 s3, s78, 9
    v_add_u32 v16, s3, v153
    s_mul_i32 s3, s78, 384
    s_sub_u32 s3, 3584, s3
    v_lshrrev_b32 v17, 5, v152
    v_mad_u32_u24 v16, v17, s3, v16
    s_mov_b32 m0, 94016
    s_mul_i32 s11, s10, 52
    s_lshr_b32 s11, s11, 8
    s_mul_i32 s11, s11, 5
    s_sub_u32 s72, s10, s11
    s_waitcnt lgkmcnt(0)
    s_mov_b64 s[64:65], s[36:37]
    s_sub_u32 s68, s38, 1024
    s_subb_u32 s69, s39, 0
    global_load_ushort v142, v147, s[18:19]
    global_load_ushort v143, v147, s[20:21]
    global_load_ushort v146, v147, s[32:33]
    global_load_ushort v144, v147, s[30:31]
    s_mov_b32 exec_hi, 0xff
    global_load_lds_dwordx4 v16, s[40:41]
    s_mov_b32 exec_hi, -1
    s_add_u32 m0, s8, 56336
    s_movk_i32 s83, 0
    buffer_load_dwordx4 v70, s[64:67], s83 offen nt lds
    buffer_load_dwordx4 v70, s[68:71], s83 offen offset:1024 nt lds
    s_add_u32 m0, s8, 58400
    s_movk_i32 s83, 10240
    buffer_load_dwordx4 v70, s[64:67], s83 offen nt lds
    buffer_load_dwordx4 v70, s[68:71], s83 offen offset:1024 nt lds
    s_mov_b32 m0, s9
    s_nop 0
    buffer_load_dwordx4 v71, s[64:67], 0 offen nt lds
    s_sub_u32 m0, s9, 512
    s_mov_b32 exec_hi, 0
    buffer_load_dwordx4 v72, s[68:71], 0 offen nt lds
    s_mov_b32 exec_hi, -1
    s_or_b32 s3, s2, s77
    s_cmp_lg_u32 s3, 0
    s_cbranch_scc1 L_par
    s_or_b32 s6, s6, 7
    v_mov_b32 v2, 0
    v_mov_b32 v3, s6
    global_store_dword v2, v3, s[48:49] sc1
L_par:
    s_and_b32 s80, s77, 1
    s_lshr_b32 s81, s77, 1
    s_lshl_b32 s84, s77, 14
    s_add_u32 s84, s84, 98304
    s_lshl_b32 s72, s72, 7
    s_mul_i32 s85, s81, 640
    s_sub_u32 s90, 640, s85
    s_lshl_b32 s100, s77, 11
    v_lshrrev_b32 v11, 4, v152
    v_xor_b32 v14, v13, v11
    v_lshlrev_b32 v14, 4, v14
    s_mul_i32 s3, s78, 102400
    s_mul_i32 s4, s77, 20480
    s_add_u32 s3, s3, s4
    v_add3_u32 v158, v158, v14, s3
    v_xor_b32 v159, 64, v158
    v_add_u32 v159, 9216, v159
    s_mov_b64 s[56:57], s[22:23]
    s_mov_b32 s58, 819200
    s_mov_b32 s59, 0x20000
    s_mov_b64 s[60:61], s[24:25]
    s_mov_b32 s62, 819200
    s_mov_b32 s63, 0x20000
    s_sub_u32 s4, 81920, s4
    s_cmp_eq_u32 s80, 0
    s_cselect_b32 s92, s22, s24
    s_cselect_b32 s93, s23, s25
    s_add_u32 s92, s92, s4
    s_addc_u32 s93, s93, 0
    s_sub_u32 s94, 819200, s4
    s_mov_b32 s95, 0x20000
    v_lshrrev_b32 v15, 5, v152
    v_mul_u32_u24 v164, 20480, v15
    v_bfe_u32 v15, v152, 3, 1
    s_movk_i32 s3, 10240
    v_mad_u32_u24 v164, v15, s3, v164
    v_and_b32 v15, 1, v11
    s_movk_i32 s3, 1280
    v_mad_u32_u24 v164, v15, s3, v164
    s_mul_i32 s4, s77, 2560
    s_add_u32 s5, s5, s4
    v_add3_u32 v164, v164, v14, s5
    v_xor_b32 v165, 64, v164
    v_add_u32 v165, 39936, v165
    s_mov_b64 s[52:53], s[16:17]
    s_mov_b32 s54, 2621440
    s_mov_b32 s55, 0x20000
    s_mul_i32 s3, s2, 3200
    s_mul_i32 s4, s77, 7
    v_min_u32 v112, 6, v152
    v_add_u32 v112, s4, v112
    v_min_u32 v112, 24, v112
    v_lshl_add_u32 v112, v112, 7, s3
    s_mul_i32 s3, s78, 10240
    s_add_u32 s3, s3, s5
    v_min_u32 v113, 19, v152
    v_lshl_add_u32 v113, v113, 7, s3
    s_lshl_b32 s4, s78, 6
    s_lshl_b32 s3, s79, 1
    global_load_dword a255, v112, s[22:23]
    s_add_u32 s3, s3, s4
    s_and_b32 s5, s79, 15
    s_lshl_b32 s4, s78, 4
    s_add_u32 s4, s4, s5
    global_load_dword a255, v112, s[24:25]
    s_add_u32 s4, s4, 512
    s_lshl_b32 s14, s3, 12
    s_lshl_b32 s15, s4, 12
    s_lshl_b32 s3, s3, 1
    global_load_dword a255, v113, s[16:17]
    s_lshl_b32 s4, s4, 1
    s_andn2_b32 s4, s4, 3
    s_load_dword s34, s[44:45], s3
    s_load_dword s35, s[44:45], s4
    s_lshl_b32 s5, s77, 10
    s_sub_u32 s5, s5, 4
    s_max_i32 s5, s5, 0
    s_add_u32 s3, s5, s14
    s_load_dword s30, s[42:43], s3
    s_add_u32 s3, s3, 4096
    s_load_dword s31, s[42:43], s3
    s_add_u32 s3, s5, s15
    s_load_dword s32, s[42:43], s3
    s_lshl_b32 s12, s77, 10
    v_add_u32 v221, s12, v153
    s_add_u32 s73, s72, 128
    s_cmp_eq_u32 s73, 640
    s_cselect_b32 s73, 0, s73
    s_add_u32 s74, s73, 128
    s_cmp_eq_u32 s74, 640
    s_cselect_b32 s74, 0, s74
    s_add_u32 s75, s74, 128
    s_cmp_eq_u32 s75, 640
    s_cselect_b32 s75, 0, s75
    s_add_u32 s76, s75, 128
    s_cmp_eq_u32 s76, 640
    s_cselect_b32 s76, 0, s76
    v_and_b32 v10, 15, v152
    v_lshrrev_b32 v14, 1, v10
    v_xor_b32 v14, v14, v11
    v_lshlrev_b32 v14, 4, v14
    v_lshl_add_u32 v14, v10, 7, v14
    v_add_u32 v156, s84, v14
    v_xor_b32 v157, 64, v156
    s_lshl_b32 s3, s81, 13
    v_add_u32 v120, s3, v14
    v_xor_b32 v121, 64, v120
    v_xor_b32 v122, 0x2000, v120
    v_xor_b32 v123, 0x2000, v121
    s_getreg_b32 s89, hwreg(HW_REG_XCC_ID, 0, 3)
    s_mov_b32 s101, 0x20000
    s_mov_b32 s86, 0xffff0000
    s_mov_b32 s87, 0x3f803f80
    v_mov_b32 v116, s87
    v_mov_b32 v117, s87
    v_mov_b32 v118, s87
    v_mov_b32 v119, s87
    v_mov_b32 v224, 0
    v_add_u32 v124, s100, v14
    v_xor_b32 v125, 64, v124
    v_lshrrev_b32 v242, 3, v152
    v_and_b32 v243, 7, v152
    s_lshl_b32 s3, s77, 5
    s_add_u32 s3, s3, 56336
    v_lshl_add_u32 v64, v242, 2, s3
    s_movk_i32 s3, 2064
    v_mad_u32_u24 v64, v243, s3, v64
    v_subrev_u32 v65, 1424, v64
    v_add_u32 v66, 1024, v64
    s_sub_u32 s3, s9, 512
    v_lshl_add_u32 v75, v243, 2, s3
    v_lshl_add_u32 v75, v242, 6, v75
    s_lshl_b32 s4, s78, 2
    s_add_u32 s4, s4, s77
    s_lshl_b32 s3, s4, 16
    s_lshl_b32 s5, s79, 7
    s_add_u32 s3, s3, s5
    s_add_u32 s3, s3, 2048
    v_lshl_add_u32 v76, v242, 13, s3
    v_lshl_add_u32 v76, v243, 4, v76
    s_lshl_b32 s4, s4, 14
    s_add_u32 s4, s4, s5
    s_add_u32 s4, s4, 2097152
    v_lshrrev_b32 v229, 4, v152
    v_lshl_add_u32 v229, v229, 12, s4
    v_and_b32 v228, 15, v152
    v_lshl_add_u32 v229, v228, 3, v229
    s_lshl_b32 s3, s77, 9
    s_add_u32 s3, s3, 79872
    v_lshl_add_u32 v228, v152, 3, s3
    s_lshl_b32 s3, s77, 7
    s_add_u32 s3, s3, 94016
    v_lshl_add_u32 v73, v242, 4, s3
    s_mov_b32 s3, 94528
    v_lshl_add_u32 v74, v243, 4, s3
    v_xor_b32 v242, 3, v242
    s_lshl_b32 s3, s77, 5
    s_add_u32 s3, s3, 79872
    v_lshl_add_u32 v77, v242, 2, s3
    v_lshl_add_u32 v77, v243, 8, v77
    s_lshl_b32 s3, s78, 9
    s_add_u32 s3, s3, 11534336
    v_lshl_add_u32 v168, v152, 3, s3
    s_lshl_b32 s4, s79, 4
    s_add_u32 s3, s3, s4
    s_add_u32 s4, s4, 11534336
    v_and_b32 v169, 7, v152
    v_lshl_add_u32 v169, v169, 9, s4
    s_lshl_b32 s4, s77, 2
    s_add_u32 s3, s3, s4
    v_mov_b32 v223, s3
    s_waitcnt vmcnt(10)
    v_lshlrev_b32 v178, 16, v144
    v_lshlrev_b32 v176, 16, v142
    v_mul_f32 v178, 0x3fb8aa3b, v178
    s_mov_b32 m0, s100
    s_mov_b32 s83, s72
    buffer_load_dwordx4 v164, s[52:55], s83 offen lds
    v_lshlrev_b32 v177, 16, v143
    v_exp_f32 v178, v178
    v_mul_f32 v185, v176, v176
    v_fmac_f32 v185, v177, v177
    v_cvt_pk_bf16_f32 v178, 0, v178
    v_rcp_f32 v185, v185
    v_mul_f32 v179, v178, v176
    v_mul_f32 v180, v178, v177
    v_mul_f32 v179, 0x3fb8aa3b, v179
    v_mul_f32 v180, 0x3e22f983, v180
    v_and_b32 v188, 1, v152
    v_cmp_eq_u32 vcc, 1, v188
    v_mov_b32 v189, 0x44000000
    v_mov_b32 v181, 0x41000000
    v_mov_b32 v198, 0x42800000
    v_mov_b32 v199, 0x41800000
    v_cndmask_b32 v189, v189, v181, vcc
    v_cndmask_b32 v198, v198, v199, vcc
    v_mul_f32 v184, 1.0, v179
    v_mul_f32 v183, 1.0, v180
    v_exp_f32 v184, v184
    buffer_load_dwordx4 v165, s[52:55], s83 offen offset:1024 lds
    v_fract_f32 v183, v183
    v_cos_f32 v182, v183
    v_sin_f32 v183, v183
    v_mul_f32 v182, v184, v182
    v_mul_f32 v183, v184, v183
    v_mul_f32 v192, v189, v179
    v_mul_f32 v191, v189, v180
    v_exp_f32 v192, v192
    v_fract_f32 v191, v191
    v_cos_f32 v190, v191
    v_sin_f32 v191, v191
    v_mul_f32 v190, v192, v190
    v_mul_f32 v191, v192, v191
    v_add_f32 v185, v185, v185
    v_add_f32 v184, -1.0, v182
    v_mul_f32 v186, v184, v176
    v_mul_f32 v187, v183, v176
    v_fmac_f32 v186, v183, v177
    v_fma_f32 v187, -v184, v177, v187
    v_mul_f32 v186, v186, v185
    v_mul_f32 v187, v187, v185
    s_add_u32 m0, s100, 8192
    s_add_u32 s83, s72, 640
    buffer_load_dwordx4 v164, s[52:55], s83 offen lds
    v_cndmask_b32 v186, 1.0, v186, vcc
    v_cndmask_b32 v187, 0, v187, vcc
    v_cndmask_b32 v182, v182, v190, vcc
    v_cndmask_b32 v183, v183, v191, vcc
    v_mul_u32_u24 v188, 640, v188
    v_lshlrev_b32 v181, 3, v145
    v_add_u32 v181, 81920, v181
    v_add_u32 v189, v181, v188
    s_mov_b64 exec, s[96:97]
    ds_write_b64 v189, v[182:183] offset:7680
    s_mov_b64 exec, -1
    v_sub_u32 v189, v181, v188
    v_lshlrev_b32 v188, 3, v188
    v_sub_u32 v188, v181, v188
    s_mov_b64 exec, s[96:97]
    ds_write_b64 v188, v[186:187] offset:5120
    s_mov_b64 exec, -1
    v_mul_f32 v196, v198, v179
    v_mul_f32 v195, v198, v180
    v_exp_f32 v196, v196
    v_fract_f32 v195, v195
    v_cos_f32 v194, v195
    v_sin_f32 v195, v195
    buffer_load_dwordx4 v165, s[52:55], s83 offen offset:1024 lds
    v_mul_f32 v194, v196, v194
    v_mul_f32 v195, v196, v195
    s_mov_b64 exec, s[96:97]
    ds_write_b64 v189, v[194:195] offset:9600
    s_mov_b64 exec, -1
    v_pk_mul_f32 v[200:201], v[186:187], v[190:191] op_sel_hi:[1,0]
    v_pk_fma_f32 v[200:201], v[186:187], v[190:191], v[200:201] op_sel:[1,1,0] op_sel_hi:[0,1,1] neg_lo:[1,0,0]
    s_mov_b64 exec, s[96:97]
    ds_write_b64 v188, v[200:201] offset:5760
    s_mov_b64 exec, -1
    v_pk_mul_f32 v[186:187], v[200:201], v[190:191] op_sel_hi:[1,0]
    v_pk_fma_f32 v[186:187], v[200:201], v[190:191], v[186:187] op_sel:[1,1,0] op_sel_hi:[0,1,1] neg_lo:[1,0,0]
    s_mov_b64 exec, s[96:97]
    ds_write_b64 v188, v[186:187] offset:6400
    s_mov_b64 exec, -1
    v_pk_mul_f32 v[200:201], v[186:187], v[190:191] op_sel_hi:[1,0]
    v_pk_fma_f32 v[200:201], v[186:187], v[190:191], v[200:201] op_sel:[1,1,0] op_sel_hi:[0,1,1] neg_lo:[1,0,0]
    s_mov_b64 exec, s[96:97]
    ds_write_b64 v188, v[200:201] offset:7040
    s_mov_b64 exec, -1
    v_pk_mul_f32 v[186:187], v[200:201], v[190:191] op_sel_hi:[1,0]
    v_pk_fma_f32 v[186:187], v[200:201], v[190:191], v[186:187] op_sel:[1,1,0] op_sel_hi:[0,1,1] neg_lo:[1,0,0]
    s_and_b64 s[96:97], s[96:97], vcc
    s_mov_b64 exec, s[96:97]
    ds_write_b64 v188, v[186:187] offset:7680
    s_mov_b64 exec, -1
    v_pk_mul_f32 v[200:201], v[186:187], v[190:191] op_sel_hi:[1,0]
    v_pk_fma_f32 v[200:201], v[186:187], v[190:191], v[200:201] op_sel:[1,1,0] op_sel_hi:[0,1,1] neg_lo:[1,0,0]
    s_mov_b64 exec, s[96:97]
    ds_write_b64 v188, v[200:201] offset:8320
    s_mov_b64 exec, -1
    s_mov_b32 m0, s84
    s_add_u32 s83, s72, s85
    buffer_load_dwordx4 v158, s[56:59], s83 offen lds
    v_pk_mul_f32 v[186:187], v[200:201], v[190:191] op_sel_hi:[1,0]
    v_pk_fma_f32 v[186:187], v[200:201], v[190:191], v[186:187] op_sel:[1,1,0] op_sel_hi:[0,1,1] neg_lo:[1,0,0]
    s_mov_b64 exec, s[96:97]
    ds_write_b64 v188, v[186:187] offset:8960
    s_mov_b64 exec, -1
    v_pk_mul_f32 v[200:201], v[186:187], v[190:191] op_sel_hi:[1,0]
    v_pk_fma_f32 v[200:201], v[186:187], v[190:191], v[200:201] op_sel:[1,1,0] op_sel_hi:[0,1,1] neg_lo:[1,0,0]
    s_mov_b64 exec, s[96:97]
    ds_write_b64 v188, v[200:201] offset:9600
    s_mov_b64 exec, -1
    v_lshlrev_b32 v188, 2, v145
    v_add_u32 v188, 93696, v188
    v_lshlrev_b32 v189, 16, v146
    s_mov_b64 exec, s[96:97]
    ds_write_b32 v188, v189
    s_mov_b64 exec, -1
    v_and_b32 v230, 15, v152
    v_lshrrev_b32 v231, 1, v230
    s_lshr_b32 s3, s78, 2
    s_lshl_b32 s3, s3, 13
    s_add_u32 s3, s3, s100
    v_lshl_add_u32 v230, v230, 7, s3
    s_and_b32 s3, s78, 3
    s_mul_i32 s3, s3, 10
    s_lshr_b32 s4, s72, 4
    s_sub_u32 s3, s3, s4
    v_lshrrev_b32 v242, 4, v152
    v_add_u32 v128, s3, v242
    buffer_load_dwordx4 v159, s[56:59], s83 offen offset:1024 lds
    v_add_u32 v129, 4, v128
    s_add_u32 s3, s3, 8
    v_lshrrev_b32 v242, 5, v152
    v_add_u32 v130, s3, v242
    v_add_u32 v242, 40, v128
    v_min_u32 v128, v128, v242
    v_lshrrev_b32 v242, 3, v128
    v_lshl_add_u32 v242, v242, 14, v230
    v_and_b32 v128, 7, v128
    v_xor_b32 v128, v128, v231
    v_lshl_add_u32 v128, v128, 4, v242
    v_add_u32 v242, 40, v129
    v_min_u32 v129, v129, v242
    s_waitcnt vmcnt(9)
    s_waitcnt lgkmcnt(0)
    s_barrier
    ds_read2_b32 v[80:81], v75 offset0:136 offset1:144
    ds_read2_b32 v[82:83], v75 offset0:152 offset1:160
    ds_read_b32 v84, v75 offset:672
    ds_read2_b32 v[86:87], v75 offset0:0 offset1:8
    ds_read_b128 v[88:91], v74
    ds_read_b128 v[60:63], v73
    ds_read2_b32 v[40:41], v65 offset0:0 offset1:32
    s_add_u32 m0, s84, 2048
    s_add_u32 s83, s72, s85
    buffer_load_dwordx4 v158, s[60:63], s83 offen lds
    ds_read_b32 v42, v65 offset:256
    ds_read2_b32 v[44:45], v64 offset0:0 offset1:32
    ds_read2_b32 v[46:47], v64 offset0:64 offset1:96
    ds_read2_b32 v[48:49], v64 offset0:128 offset1:160
    ds_read2_b32 v[50:51], v64 offset0:192 offset1:224
    ds_read2_b32 v[52:53], v66 offset0:0 offset1:32
    ds_read2_b32 v[54:55], v66 offset0:64 offset1:96
    ds_read2_b32 v[56:57], v66 offset0:128 offset1:160
    ds_read2_b32 v[58:59], v66 offset0:192 offset1:224
    v_mov_b64 v[208:209], -1
    v_add_u32 v212, 3145728, v229
    v_mov_b64 v[210:211], -1
    v_add_u32 v213, 3145728, v76
    s_waitcnt lgkmcnt(11)
    v_lshlrev_b32 v22, 16, v88
    v_and_b32 v24, s86, v88
    v_lshlrev_b32 v26, 16, v89
    v_and_b32 v28, s86, v89
    v_lshlrev_b32 v23, 16, v90
    v_and_b32 v25, s86, v90
    v_lshlrev_b32 v27, 16, v91
    v_and_b32 v29, s86, v91
    v_lshlrev_b32 v0, 16, v80
    v_and_b32 v1, s86, v80
    buffer_load_dwordx4 v159, s[60:63], s83 offen offset:1024 lds
    v_lshlrev_b32 v2, 16, v81
    v_and_b32 v3, s86, v81
    v_lshlrev_b32 v4, 16, v82
    v_and_b32 v5, s86, v82
    v_lshlrev_b32 v6, 16, v83
    v_and_b32 v7, s86, v83
    v_lshlrev_b32 v8, 16, v84
    v_and_b32 v9, s86, v84
    v_pk_mul_f32 v[30:31], v[0:1], v[28:29]
    v_pk_mul_f32 v[32:33], v[2:3], v[28:29]
    v_pk_mul_f32 v[34:35], v[2:3], v[26:27]
    v_pk_mul_f32 v[36:37], v[4:5], v[26:27]
    v_cvt_pk_bf16_f32 v34, v30, v34
    v_cvt_pk_bf16_f32 v35, v31, v35
    v_cvt_pk_bf16_f32 v36, v32, v36
    v_cvt_pk_bf16_f32 v37, v33, v37
    v_dot2_f32_bf16 v30, v34, s87, 0
    v_dot2_f32_bf16 v31, v35, s87, 0
    v_dot2_f32_bf16 v32, v36, s87, 0
    v_dot2_f32_bf16 v33, v37, s87, 0
    v_pk_mul_f32 v[34:35], v[4:5], v[24:25]
    v_pk_mul_f32 v[36:37], v[6:7], v[24:25]
    v_cvt_pk_bf16_f32 v34, v30, v34
    v_cvt_pk_bf16_f32 v35, v31, v35
    s_add_u32 m0, s84, 4096
    s_add_u32 s83, s72, s85
    buffer_load_dwordx4 v158, s[92:95], s83 offen lds
    v_cvt_pk_bf16_f32 v36, v32, v36
    v_cvt_pk_bf16_f32 v37, v33, v37
    v_dot2_f32_bf16 v30, v34, s87, 0
    v_dot2_f32_bf16 v31, v35, s87, 0
    v_dot2_f32_bf16 v32, v36, s87, 0
    v_dot2_f32_bf16 v33, v37, s87, 0
    v_pk_mul_f32 v[34:35], v[6:7], v[22:23]
    v_pk_mul_f32 v[36:37], v[8:9], v[22:23]
    v_cvt_pk_bf16_f32 v34, v30, v34
    v_cvt_pk_bf16_f32 v35, v31, v35
    v_cvt_pk_bf16_f32 v36, v32, v36
    v_cvt_pk_bf16_f32 v37, v33, v37
    v_dot2_f32_bf16 v30, v34, s87, 0
    v_dot2_f32_bf16 v31, v35, s87, 0
    v_dot2_f32_bf16 v32, v36, s87, 0
    v_dot2_f32_bf16 v33, v37, s87, 0
    v_and_b32 v34, 0xffff, v86
    v_and_b32 v35, s86, v86
    v_and_b32 v36, 0xffff, v87
    v_and_b32 v37, s86, v87
    v_cvt_pk_bf16_f32 v38, v30, v31
    v_cvt_pk_bf16_f32 v39, v32, v33
    v_dot2_f32_bf16 v34, v38, v34, 0
    v_dot2_f32_bf16 v36, v39, v36, 0
    buffer_load_dwordx4 v159, s[92:95], s83 offen offset:1024 lds
    v_dot2_f32_bf16 v35, v38, v35, 0
    v_dot2_f32_bf16 v37, v39, v37, 0
    v_cvt_pk_bf16_f32 v68, v36, v34
    s_nop 1
    v_cvt_pk_bf16_f32 v69, v37, v35
    s_waitcnt lgkmcnt(0)
    ds_write2_b32 v77, v68, v69 offset1:32
    v_lshlrev_b32 v22, 16, v60
    v_and_b32 v24, s86, v60
    v_lshlrev_b32 v26, 16, v61
    v_and_b32 v28, s86, v61
    v_lshlrev_b32 v23, 16, v62
    v_and_b32 v25, s86, v62
    v_lshlrev_b32 v27, 16, v63
    v_and_b32 v29, s86, v63
    v_lshlrev_b32 v0, 16, v40
    v_and_b32 v1, s86, v40
    v_lshlrev_b32 v2, 16, v41
    v_and_b32 v3, s86, v41
    v_lshlrev_b32 v4, 16, v42
    v_and_b32 v5, s86, v42
    v_lshlrev_b32 v6, 16, v44
    v_and_b32 v7, s86, v44
    v_lshlrev_b32 v8, 16, v45
    v_and_b32 v9, s86, v45
    s_add_u32 m0, s84, 6144
    s_add_u32 s83, s72, s90
    buffer_load_dwordx4 v158, s[56:59], s83 offen lds
    v_lshlrev_b32 v10, 16, v46
    v_and_b32 v11, s86, v46
    v_lshlrev_b32 v12, 16, v47
    v_and_b32 v13, s86, v47
    v_lshlrev_b32 v14, 16, v48
    v_and_b32 v15, s86, v48
    v_lshlrev_b32 v16, 16, v49
    v_and_b32 v17, s86, v49
    v_lshlrev_b32 v18, 16, v50
    v_and_b32 v19, s86, v50
    v_lshlrev_b32 v20, 16, v51
    v_and_b32 v21, s86, v51
    v_pk_mul_f32 v[30:31], v[0:1], v[28:29]
    v_pk_mul_f32 v[32:33], v[2:3], v[28:29]
    v_pk_mul_f32 v[34:35], v[2:3], v[26:27]
    v_pk_mul_f32 v[36:37], v[4:5], v[26:27]
    v_cvt_pk_bf16_f32 v34, v30, v34
    v_cvt_pk_bf16_f32 v35, v31, v35
    v_cvt_pk_bf16_f32 v36, v32, v36
    v_cvt_pk_bf16_f32 v37, v33, v37
    v_dot2_f32_bf16 v30, v34, s87, 0
    v_dot2_f32_bf16 v31, v35, s87, 0
    v_dot2_f32_bf16 v32, v36, s87, 0
    v_dot2_f32_bf16 v33, v37, s87, 0
    buffer_load_dwordx4 v159, s[56:59], s83 offen offset:1024 lds
    v_pk_mul_f32 v[34:35], v[4:5], v[24:25]
    v_pk_mul_f32 v[36:37], v[6:7], v[24:25]
    v_cvt_pk_bf16_f32 v34, v30, v34
    v_cvt_pk_bf16_f32 v35, v31, v35
    v_cvt_pk_bf16_f32 v36, v32, v36
    v_cvt_pk_bf16_f32 v37, v33, v37
    v_dot2_f32_bf16 v30, v34, s87, 0
    v_dot2_f32_bf16 v31, v35, s87, 0
    v_dot2_f32_bf16 v32, v36, s87, 0
    v_dot2_f32_bf16 v33, v37, s87, 0
    v_pk_mul_f32 v[34:35], v[6:7], v[22:23]
    v_pk_mul_f32 v[36:37], v[8:9], v[22:23]
    v_cvt_pk_bf16_f32 v34, v30, v34
    v_cvt_pk_bf16_f32 v35, v31, v35
    v_cvt_pk_bf16_f32 v36, v32, v36
    v_cvt_pk_bf16_f32 v37, v33, v37
    v_dot2_f32_bf16 v30, v34, s87, 0
    v_dot2_f32_bf16 v31, v35, s87, 0
    v_dot2_f32_bf16 v32, v36, s87, 0
    v_dot2_f32_bf16 v33, v37, s87, 0
    v_and_b32 v34, 0xffff, v52
    v_and_b32 v35, s86, v52
    v_and_b32 v36, 0xffff, v53
    v_and_b32 v37, s86, v53
    s_add_u32 m0, s84, 8192
    s_add_u32 s83, s72, s90
    buffer_load_dwordx4 v158, s[60:63], s83 offen lds
    v_cvt_pk_bf16_f32 v38, v30, v31
    v_cvt_pk_bf16_f32 v39, v32, v33
    v_dot2_f32_bf16 v34, v38, v34, 0
    v_dot2_f32_bf16 v36, v39, v36, 0
    v_dot2_f32_bf16 v35, v38, v35, 0
    v_dot2_f32_bf16 v37, v39, v37, 0
    s_nop 0
    v_cvt_pk_bf16_f32 v107, v36, v34
    s_nop 0
    v_cvt_pk_bf16_f32 v111, v37, v35
    v_pk_mul_f32 v[30:31], v[4:5], v[28:29]
    v_pk_mul_f32 v[32:33], v[6:7], v[28:29]
    v_pk_mul_f32 v[34:35], v[6:7], v[26:27]
    v_pk_mul_f32 v[36:37], v[8:9], v[26:27]
    v_cvt_pk_bf16_f32 v34, v30, v34
    v_cvt_pk_bf16_f32 v35, v31, v35
    v_cvt_pk_bf16_f32 v36, v32, v36
    v_cvt_pk_bf16_f32 v37, v33, v37
    v_dot2_f32_bf16 v30, v34, s87, 0
    v_dot2_f32_bf16 v31, v35, s87, 0
    v_dot2_f32_bf16 v32, v36, s87, 0
    v_dot2_f32_bf16 v33, v37, s87, 0
    v_pk_mul_f32 v[34:35], v[8:9], v[24:25]
    v_pk_mul_f32 v[36:37], v[10:11], v[24:25]
    v_cvt_pk_bf16_f32 v34, v30, v34
    v_cvt_pk_bf16_f32 v35, v31, v35
    buffer_load_dwordx4 v159, s[60:63], s83 offen offset:1024 lds
    v_cvt_pk_bf16_f32 v36, v32, v36
    v_cvt_pk_bf16_f32 v37, v33, v37
    v_dot2_f32_bf16 v30, v34, s87, 0
    v_dot2_f32_bf16 v31, v35, s87, 0
    v_dot2_f32_bf16 v32, v36, s87, 0
    v_dot2_f32_bf16 v33, v37, s87, 0
    v_pk_mul_f32 v[34:35], v[10:11], v[22:23]
    v_pk_mul_f32 v[36:37], v[12:13], v[22:23]
    v_cvt_pk_bf16_f32 v34, v30, v34
    v_cvt_pk_bf16_f32 v35, v31, v35
    v_cvt_pk_bf16_f32 v36, v32, v36
    v_cvt_pk_bf16_f32 v37, v33, v37
    v_dot2_f32_bf16 v30, v34, s87, 0
    v_dot2_f32_bf16 v31, v35, s87, 0
    v_dot2_f32_bf16 v32, v36, s87, 0
    v_dot2_f32_bf16 v33, v37, s87, 0
    v_and_b32 v34, 0xffff, v54
    v_and_b32 v35, s86, v54
    v_and_b32 v36, 0xffff, v55
    v_and_b32 v37, s86, v55
    v_cvt_pk_bf16_f32 v38, v30, v31
    v_cvt_pk_bf16_f32 v39, v32, v33
    v_dot2_f32_bf16 v34, v38, v34, 0
    v_dot2_f32_bf16 v36, v39, v36, 0
    s_add_u32 m0, s100, 16384
    s_mov_b32 s83, s73
    buffer_load_dwordx4 v164, s[52:55], s83 offen lds
    v_dot2_f32_bf16 v35, v38, v35, 0
    v_dot2_f32_bf16 v37, v39, v37, 0
    v_cvt_pk_bf16_f32 v106, v36, v34
    s_nop 1
    v_cvt_pk_bf16_f32 v110, v37, v35
    v_pk_mul_f32 v[30:31], v[8:9], v[28:29]
    v_pk_mul_f32 v[32:33], v[10:11], v[28:29]
    v_pk_mul_f32 v[34:35], v[10:11], v[26:27]
    v_pk_mul_f32 v[36:37], v[12:13], v[26:27]
    v_cvt_pk_bf16_f32 v34, v30, v34
    v_cvt_pk_bf16_f32 v35, v31, v35
    v_cvt_pk_bf16_f32 v36, v32, v36
    v_cvt_pk_bf16_f32 v37, v33, v37
    v_dot2_f32_bf16 v30, v34, s87, 0
    v_dot2_f32_bf16 v31, v35, s87, 0
    v_dot2_f32_bf16 v32, v36, s87, 0
    v_dot2_f32_bf16 v33, v37, s87, 0
    v_pk_mul_f32 v[34:35], v[12:13], v[24:25]
    v_pk_mul_f32 v[36:37], v[14:15], v[24:25]
    v_cvt_pk_bf16_f32 v34, v30, v34
    v_cvt_pk_bf16_f32 v35, v31, v35
    v_cvt_pk_bf16_f32 v36, v32, v36
    v_cvt_pk_bf16_f32 v37, v33, v37
    v_dot2_f32_bf16 v30, v34, s87, 0
    v_dot2_f32_bf16 v31, v35, s87, 0
    buffer_load_dwordx4 v165, s[52:55], s83 offen offset:1024 lds
    v_dot2_f32_bf16 v32, v36, s87, 0
    v_dot2_f32_bf16 v33, v37, s87, 0
    v_pk_mul_f32 v[34:35], v[14:15], v[22:23]
    v_pk_mul_f32 v[36:37], v[16:17], v[22:23]
    v_cvt_pk_bf16_f32 v34, v30, v34
    v_cvt_pk_bf16_f32 v35, v31, v35
    v_cvt_pk_bf16_f32 v36, v32, v36
    v_cvt_pk_bf16_f32 v37, v33, v37
    v_dot2_f32_bf16 v30, v34, s87, 0
    v_dot2_f32_bf16 v31, v35, s87, 0
    v_dot2_f32_bf16 v32, v36, s87, 0
    v_dot2_f32_bf16 v33, v37, s87, 0
    v_and_b32 v34, 0xffff, v56
    v_and_b32 v35, s86, v56
    v_and_b32 v36, 0xffff, v57
    v_and_b32 v37, s86, v57
    v_cvt_pk_bf16_f32 v38, v30, v31
    v_cvt_pk_bf16_f32 v39, v32, v33
    v_dot2_f32_bf16 v34, v38, v34, 0
    v_dot2_f32_bf16 v36, v39, v36, 0
    v_dot2_f32_bf16 v35, v38, v35, 0
    v_dot2_f32_bf16 v37, v39, v37, 0
    s_nop 0
    v_cvt_pk_bf16_f32 v105, v36, v34
    s_nop 0
    v_cvt_pk_bf16_f32 v109, v37, v35
    s_add_u32 m0, s100, 24576
    s_add_u32 s83, s73, 640
    buffer_load_dwordx4 v164, s[52:55], s83 offen lds
    v_pk_mul_f32 v[30:31], v[12:13], v[28:29]
    v_pk_mul_f32 v[32:33], v[14:15], v[28:29]
    v_pk_mul_f32 v[34:35], v[14:15], v[26:27]
    v_pk_mul_f32 v[36:37], v[16:17], v[26:27]
    v_cvt_pk_bf16_f32 v34, v30, v34
    v_cvt_pk_bf16_f32 v35, v31, v35
    v_cvt_pk_bf16_f32 v36, v32, v36
    v_cvt_pk_bf16_f32 v37, v33, v37
    v_dot2_f32_bf16 v30, v34, s87, 0
    v_dot2_f32_bf16 v31, v35, s87, 0
    v_dot2_f32_bf16 v32, v36, s87, 0
    v_dot2_f32_bf16 v33, v37, s87, 0
    v_pk_mul_f32 v[34:35], v[16:17], v[24:25]
    v_pk_mul_f32 v[36:37], v[18:19], v[24:25]
    v_cvt_pk_bf16_f32 v34, v30, v34
    v_cvt_pk_bf16_f32 v35, v31, v35
    v_cvt_pk_bf16_f32 v36, v32, v36
    v_cvt_pk_bf16_f32 v37, v33, v37
    v_dot2_f32_bf16 v30, v34, s87, 0
    v_dot2_f32_bf16 v31, v35, s87, 0
    v_dot2_f32_bf16 v32, v36, s87, 0
    v_dot2_f32_bf16 v33, v37, s87, 0
    v_pk_mul_f32 v[34:35], v[18:19], v[22:23]
    v_pk_mul_f32 v[36:37], v[20:21], v[22:23]
    buffer_load_dwordx4 v165, s[52:55], s83 offen offset:1024 lds
    v_cvt_pk_bf16_f32 v34, v30, v34
    v_cvt_pk_bf16_f32 v35, v31, v35
    v_cvt_pk_bf16_f32 v36, v32, v36
    v_cvt_pk_bf16_f32 v37, v33, v37
    v_dot2_f32_bf16 v30, v34, s87, 0
    v_dot2_f32_bf16 v31, v35, s87, 0
    v_dot2_f32_bf16 v32, v36, s87, 0
    v_dot2_f32_bf16 v33, v37, s87, 0
    s_waitcnt vmcnt(12)
    ds_read_b128 a[0:3], v156 offset:0
    ds_read_b128 a[4:7], v157 offset:0
    v_and_b32 v34, 0xffff, v58
    v_and_b32 v35, s86, v58
    v_and_b32 v36, 0xffff, v59
    v_and_b32 v37, s86, v59
    s_waitcnt vmcnt(10)
    ds_read_b128 a[8:11], v156 offset:2048
    ds_read_b128 a[12:15], v157 offset:2048
    v_cvt_pk_bf16_f32 v38, v30, v31
    v_cvt_pk_bf16_f32 v39, v32, v33
    v_dot2_f32_bf16 v34, v38, v34, 0
    v_dot2_f32_bf16 v36, v39, v36, 0
    s_waitcnt vmcnt(8)
    ds_read_b128 a[16:19], v156 offset:4096
    ds_read_b128 a[20:23], v157 offset:4096
    v_dot2_f32_bf16 v35, v38, v35, 0
    v_dot2_f32_bf16 v37, v39, v37, 0
    v_cvt_pk_bf16_f32 v104, v36, v34
    s_nop 1
    v_cvt_pk_bf16_f32 v108, v37, v35
    global_store_dwordx4 v76, v[104:107], s[50:51] offset:-2048 sc1
    global_store_dwordx4 v76, v[108:111], s[50:51] offset:2048 sc1
    s_add_u32 m0, s84, 10240
    s_add_u32 s83, s73, s85
    buffer_load_dwordx4 v158, s[56:59], s83 offen lds
    s_waitcnt lgkmcnt(0)
    s_barrier
    ds_read_b128 v[60:63], v120 offset:0
    ds_read_b128 v[64:67], v120 offset:2048
    ds_read_b128 v[68:71], v120 offset:4096
    ds_read_b128 v[72:75], v120 offset:6144
    ds_read_b128 v[76:79], v121 offset:0
    ds_read_b128 v[80:83], v121 offset:2048
    ds_read_b128 v[84:87], v121 offset:4096
    ds_read_b128 v[88:91], v121 offset:6144
    s_waitcnt lgkmcnt(6)
    v_mfma_f32_16x16x32_bf16 v[176:179], v[60:63], a[0:3], 0
    v_lshrrev_b32 v242, 3, v129
    v_mfma_f32_16x16x32_bf16 v[192:195], v[60:63], a[8:11], 0
    v_lshl_add_u32 v242, v242, 14, v230
    v_mfma_f32_16x16x32_bf16 v[32:35], v[60:63], a[16:19], 0
    ds_read_b128 v[60:63], v122 offset:0
    v_and_b32 v129, 7, v129
    v_mfma_f32_16x16x32_bf16 v[48:51], v[116:119], a[0:3], 0
    ds_read_b64 v[170:171], v228
    v_xor_b32 v129, v129, v231
    v_mfma_f32_16x16x32_bf16 v[180:183], v[64:67], a[0:3], 0
    buffer_load_dwordx4 v159, s[56:59], s83 offen offset:1024 lds
    global_load_dword v224, v224, s[48:49] sc1
    v_lshl_add_u32 v129, v129, 4, v242
    v_mfma_f32_16x16x32_bf16 v[196:199], v[64:67], a[8:11], 0
    v_add_u32 v242, 40, v130
    v_min_u32 v130, v130, v242
    v_mfma_f32_16x16x32_bf16 v[36:39], v[64:67], a[16:19], 0
    ds_read_b128 v[64:67], v122 offset:2048
    v_lshrrev_b32 v242, 3, v130
    v_mfma_f32_16x16x32_bf16 v[52:55], v[116:119], a[8:11], 0
    s_add_u32 m0, s84, 12288
    s_add_u32 s83, s73, s85
    buffer_load_dwordx4 v158, s[60:63], s83 offen lds
    s_waitcnt lgkmcnt(7)
    v_mfma_f32_16x16x32_bf16 v[184:187], v[68:71], a[0:3], 0
    v_lshl_add_u32 v242, v242, 14, v230
    v_and_b32 v130, 7, v130
    v_mfma_f32_16x16x32_bf16 v[200:203], v[68:71], a[8:11], 0
    s_waitcnt lgkmcnt(1)
    global_store_dwordx2 v229, v[170:171], s[50:51] sc1
    v_mfma_f32_16x16x32_bf16 v[40:43], v[68:71], a[16:19], 0
    ds_read_b128 v[68:71], v122 offset:4096
    v_xor_b32 v130, v130, v231
    v_mfma_f32_16x16x32_bf16 v[56:59], v[116:119], a[16:19], 0
    buffer_load_dwordx4 v159, s[60:63], s83 offen offset:1024 lds
    v_lshl_add_u32 v130, v130, 4, v242
    v_mfma_f32_16x16x32_bf16 v[188:191], v[72:75], a[0:3], 0
    s_cmp_eq_u32 s77, 0
    s_cselect_b32 s30, 0, s30
    s_cselect_b32 s31, 0, s31
    s_cselect_b32 s32, 0, s32
    v_mfma_f32_16x16x32_bf16 v[204:207], v[72:75], a[8:11], 0
    v_bfe_u32 v242, v152, 4, 1
    v_lshl_add_u32 v130, v242, 3, v130
    v_mfma_f32_16x16x32_bf16 v[44:47], v[72:75], a[16:19], 0
    ds_read_b128 v[72:75], v122 offset:6144
    v_mfma_f32_16x16x32_bf16 v[176:179], v[76:79], a[4:7], v[176:179]
    s_add_u32 m0, s84, 14336
    s_add_u32 s83, s73, s85
    buffer_load_dwordx4 v158, s[92:95], s83 offen lds
    v_mfma_f32_16x16x32_bf16 v[192:195], v[76:79], a[12:15], v[192:195]
    ds_read_b128 v[92:95], v124 offset:0
    v_lshrrev_b32 v167, 4, v152
    s_mov_b32 s4, 93696
    v_mfma_f32_16x16x32_bf16 v[32:35], v[76:79], a[20:23], v[32:35]
    ds_read_b128 v[76:79], v123 offset:0
    ds_read_b128 v[96:99], v125 offset:0
    v_lshl_add_u32 v166, v167, 5, s4
    v_mfma_f32_16x16x32_bf16 v[48:51], v[116:119], a[4:7], v[48:51]
    ds_read_b128 v[100:103], v124 offset:8192
    v_lshl_add_u32 v167, v167, 4, s4
    s_lshl_b32 s3, s81, 12
    v_mfma_f32_16x16x32_bf16 v[180:183], v[80:83], a[4:7], v[180:183]
    buffer_load_dwordx4 v159, s[92:95], s83 offen offset:1024 lds
    s_add_u32 s3, s3, s14
    ds_read_b128 v[104:107], v125 offset:8192
    v_mfma_f32_16x16x32_bf16 v[196:199], v[80:83], a[12:15], v[196:199]
    s_add_u32 s3, s3, 3145728
    s_lshl_b32 s4, s80, 10
    v_mfma_f32_16x16x32_bf16 v[36:39], v[80:83], a[20:23], v[36:39]
    ds_read_b128 v[80:83], v123 offset:2048
    s_add_u32 s38, s3, s4
    v_mfma_f32_16x16x32_bf16 v[52:55], v[116:119], a[12:15], v[52:55]
    s_sub_u32 s39, s3, s4
    v_mfma_f32_16x16x32_bf16 v[184:187], v[84:87], a[4:7], v[184:187]
    s_add_u32 m0, s100, 32768
    s_mov_b32 s83, s74
    buffer_load_dwordx4 v164, s[52:55], s83 offen lds
    v_mfma_f32_16x16x32_bf16 v[200:203], v[84:87], a[12:15], v[200:203]
    s_add_u32 s39, s39, 3072
    s_lshr_b32 s13, s79, 4
    v_mfma_f32_16x16x32_bf16 v[40:43], v[84:87], a[20:23], v[40:43]
    ds_read_b128 v[84:87], v123 offset:4096
    s_sub_u32 s4, 3, s13
    v_mfma_f32_16x16x32_bf16 v[56:59], v[116:119], a[20:23], v[56:59]
    buffer_load_dwordx4 v165, s[52:55], s83 offen offset:1024 lds
    s_waitcnt lgkmcnt(4)
    v_mfma_f32_16x16x32_bf16 v[108:111], v[92:95], v[92:95], 0
    s_cmp_eq_u32 s81, 0
    s_cselect_b32 s3, s4, s13
    v_mfma_f32_16x16x32_bf16 v[232:235], v[116:119], v[92:95], 0
    s_waitcnt vmcnt(18)
    ds_read_b128 a[24:27], v156 offset:6144
    ds_read_b128 a[28:31], v157 offset:6144
    v_mfma_f32_16x16x32_bf16 v[188:191], v[88:91], a[4:7], v[188:191]
    s_waitcnt vmcnt(16)
    ds_read_b128 a[32:35], v156 offset:8192
    ds_read_b128 a[36:39], v157 offset:8192
    v_mfma_f32_16x16x32_bf16 v[204:207], v[88:91], a[12:15], v[204:207]
    s_add_u32 m0, s100, 40960
    s_add_u32 s83, s74, 640
    buffer_load_dwordx4 v164, s[52:55], s83 offen lds
    v_mfma_f32_16x16x32_bf16 v[44:47], v[88:91], a[20:23], v[44:47]
    ds_read_b128 v[88:91], v123 offset:6144
    s_lshl_b32 s3, s3, 1
    v_mfma_f32_16x16x32_bf16 v[108:111], v[96:99], v[96:99], v[108:111]
    s_add_u32 s3, s3, s80
    s_lshl_b32 s40, s3, 9
    v_mfma_f32_16x16x32_bf16 v[232:235], v[116:119], v[96:99], v[232:235]
    s_waitcnt lgkmcnt(3)
    v_mfma_f32_16x16x32_bf16 v[176:179], v[60:63], a[24:27], v[176:179]
    buffer_load_dwordx4 v165, s[52:55], s83 offen offset:1024 lds
    s_waitcnt lgkmcnt(1)
    v_mfma_f32_16x16x32_bf16 v[192:195], v[60:63], a[32:35], v[192:195]
    s_waitcnt vmcnt(14)
    s_barrier
    ds_read_b128 v[60:63], v120 offset:16384
    v_mfma_f32_16x16x32_bf16 v[48:51], v[116:119], a[24:27], v[48:51]
    v_bfe_u32 v230, v152, 1, 2
    v_and_b32 v227, 1, v152
    v_mfma_f32_16x16x32_bf16 v[108:111], v[100:103], v[100:103], v[108:111]
    v_lshlrev_b32 v230, 18, v230
    v_lshl_add_u32 v227, v227, 7, v230
    v_mfma_f32_16x16x32_bf16 v[232:235], v[116:119], v[100:103], v[232:235]
    s_mov_b32 m0, s84
    s_add_u32 s83, s73, s90
    buffer_load_dwordx4 v158, s[56:59], s83 offen lds
    v_mfma_f32_16x16x32_bf16 v[180:183], v[64:67], a[24:27], v[180:183]
    s_lshl_b32 s3, s79, 13
    s_add_u32 s3, s3, s100
    v_mfma_f32_16x16x32_bf16 v[196:199], v[64:67], a[32:35], v[196:199]
    ds_read_b128 v[64:67], v120 offset:18432
    global_store_dwordx2 v212, v[208:209], s[50:51] sc1
    v_mfma_f32_16x16x32_bf16 v[52:55], v[116:119], a[32:35], v[52:55]
    s_lshl_b32 s4, s78, 8
    s_add_u32 s3, s3, s4
    v_mfma_f32_16x16x32_bf16 v[108:111], v[104:107], v[104:107], v[108:111]
    buffer_load_dwordx4 v159, s[56:59], s83 offen offset:1024 lds
    s_add_u32 s3, s3, 10485760
    v_mfma_f32_16x16x32_bf16 v[232:235], v[116:119], v[104:107], v[232:235]
    v_add_u32 v227, s3, v227
    v_mfma_f32_16x16x32_bf16 v[184:187], v[68:71], a[24:27], v[184:187]
    s_lshl_b32 s91, s79, 3
    s_add_u32 s91, s91, s78
    v_mfma_f32_16x16x32_bf16 v[200:203], v[68:71], a[32:35], v[200:203]
    ds_read_b128 v[68:71], v120 offset:20480
    s_add_u32 m0, s84, 2048
    s_add_u32 s83, s73, s90
    buffer_load_dwordx4 v158, s[60:63], s83 offen lds
    ds_read_b128 v[92:95], v124 offset:16384
    v_mfma_f32_16x16x32_bf16 v[188:191], v[72:75], a[24:27], v[188:191]
    s_lshl_b32 s91, s91, 2
    s_add_u32 s91, s91, s77
    ds_read_b128 v[96:99], v125 offset:16384
    v_mfma_f32_16x16x32_bf16 v[204:207], v[72:75], a[32:35], v[204:207]
    ds_read_b128 v[72:75], v120 offset:22528
    ds_read_b128 v[100:103], v124 offset:24576
    v_mfma_f32_16x16x32_bf16 v[176:179], v[76:79], a[28:31], v[176:179]
    s_mul_i32 s3, s91, 5120
    s_add_u32 s3, s3, 2048
    ds_read_b128 v[104:107], v125 offset:24576
    v_mfma_f32_16x16x32_bf16 v[192:195], v[76:79], a[36:39], v[192:195]
    ds_read_b128 v[76:79], v121 offset:16384
    buffer_load_dwordx4 v159, s[60:63], s83 offen offset:1024 lds
    v_mfma_f32_16x16x32_bf16 v[48:51], v[116:119], a[28:31], v[48:51]
    v_min_u32 v226, 7, v152
    v_lshl_add_u32 v226, v226, 7, s3
    v_mfma_f32_16x16x32_bf16 v[180:183], v[80:83], a[28:31], v[180:183]
    v_and_b32 v225, 15, v152
    s_lshl_b32 s3, s77, 6
    v_mfma_f32_16x16x32_bf16 v[196:199], v[80:83], a[36:39], v[196:199]
    ds_read_b128 v[80:83], v121 offset:18432
    s_add_u32 s3, s3, 93440
    v_mfma_f32_16x16x32_bf16 v[52:55], v[116:119], a[36:39], v[52:55]
    s_add_u32 m0, s100, 49152
    s_mov_b32 s83, s75
    buffer_load_dwordx4 v164, s[52:55], s83 offen lds
    s_waitcnt lgkmcnt(10)
    v_mfma_f32_16x16x32_bf16 v[184:187], v[84:87], a[28:31], v[184:187]
    v_lshl_add_u32 v225, v225, 2, s3
    v_bfe_u32 v222, v152, 1, 2
    v_mfma_f32_16x16x32_bf16 v[200:203], v[84:87], a[36:39], v[200:203]
    ds_read_b128 v[84:87], v121 offset:20480
    global_store_dwordx4 v213, v[208:211], s[50:51] offset:-2048 sc1
    s_waitcnt lgkmcnt(6)
    v_mfma_f32_16x16x32_bf16 v[108:111], v[92:95], v[92:95], v[108:111]
    s_waitcnt vmcnt(17)
    ds_read_b128 a[40:43], v156 offset:10240
    ds_read_b128 a[44:47], v157 offset:10240
    v_mfma_f32_16x16x32_bf16 v[232:235], v[116:119], v[92:95], v[232:235]
    buffer_load_dwordx4 v165, s[52:55], s83 offen offset:1024 lds
    s_waitcnt vmcnt(14)
    ds_read_b128 a[48:51], v156 offset:12288
    ds_read_b128 a[52:55], v157 offset:12288
    v_mfma_f32_16x16x32_bf16 v[188:191], v[88:91], a[28:31], v[188:191]
    s_waitcnt vmcnt(12)
    ds_read_b128 a[56:59], v156 offset:14336
    ds_read_b128 a[60:63], v157 offset:14336
    v_mfma_f32_16x16x32_bf16 v[204:207], v[88:91], a[36:39], v[204:207]
    ds_read_b128 v[88:91], v121 offset:22528
    s_lshl_b32 s3, s77, 4
    v_mfma_f32_16x16x32_bf16 v[108:111], v[96:99], v[96:99], v[108:111]
    s_add_u32 s3, s3, 93440
    v_lshl_add_u32 v222, v222, 2, s3
    v_mfma_f32_16x16x32_bf16 v[232:235], v[116:119], v[96:99], v[232:235]
    s_add_u32 m0, s100, 57344
    s_add_u32 s83, s75, 640
    buffer_load_dwordx4 v164, s[52:55], s83 offen lds
    s_waitcnt lgkmcnt(5)
    v_mfma_f32_16x16x32_bf16 v[176:179], v[60:63], a[40:43], v[176:179]
    v_and_b32 v230, 8, v152
    s_waitcnt lgkmcnt(3)
    v_mfma_f32_16x16x32_bf16 v[192:195], v[60:63], a[48:51], v[192:195]
    v_lshl_add_u32 v222, v230, 3, v222
    s_waitcnt lgkmcnt(1)
    v_mfma_f32_16x16x32_bf16 v[32:35], v[60:63], a[56:59], v[32:35]
    ds_read_b128 v[60:63], v122 offset:16384
    buffer_load_dwordx4 v165, s[52:55], s83 offen offset:1024 lds
    v_mfma_f32_16x16x32_bf16 v[48:51], v[116:119], a[40:43], v[48:51]
    s_lshl_b32 s3, s77, 12
    v_and_b32 v220, 16, v152
    v_mfma_f32_16x16x32_bf16 v[108:111], v[100:103], v[100:103], v[108:111]
    v_lshlrev_b32 v220, 2, v220
    v_xor_b32 v220, v220, v153
    v_mfma_f32_16x16x32_bf16 v[232:235], v[116:119], v[100:103], v[232:235]
    v_add_u32 v220, s3, v220
    v_bfe_u32 v230, v152, 2, 2
    v_mfma_f32_16x16x32_bf16 v[180:183], v[64:67], a[40:43], v[180:183]
    s_add_u32 m0, s84, 4096
    s_add_u32 s83, s74, s85
    buffer_load_dwordx4 v158, s[56:59], s83 offen lds
    v_mfma_f32_16x16x32_bf16 v[196:199], v[64:67], a[48:51], v[196:199]
    s_lshl_b32 s3, s77, 4
    s_add_u32 s3, s3, 92160
    v_mfma_f32_16x16x32_bf16 v[36:39], v[64:67], a[56:59], v[36:39]
    ds_read_b128 v[64:67], v122 offset:18432
    global_store_dwordx4 v213, v[208:211], s[50:51] offset:2048 sc1
    v_mfma_f32_16x16x32_bf16 v[52:55], v[116:119], a[48:51], v[52:55]
    v_lshl_add_u32 v126, v230, 6, s3
    s_lshl_b32 s3, s77, 3
    v_mfma_f32_16x16x32_bf16 v[108:111], v[104:107], v[104:107], v[108:111]
    buffer_load_dwordx4 v159, s[56:59], s83 offen offset:1024 lds
    s_add_u32 s3, s3, 92672
    v_mfma_f32_16x16x32_bf16 v[232:235], v[116:119], v[104:107], v[232:235]
    v_lshl_add_u32 v127, v230, 6, s3
    v_mfma_f32_16x16x32_bf16 v[184:187], v[68:71], a[40:43], v[184:187]
    v_bfe_u32 v230, v152, 0, 2
    v_lshl_add_u32 v126, v230, 2, v126
    v_mfma_f32_16x16x32_bf16 v[200:203], v[68:71], a[48:51], v[200:203]
    v_bfe_u32 v230, v152, 0, 1
    v_lshl_add_u32 v127, v230, 5, v127
    v_mfma_f32_16x16x32_bf16 v[40:43], v[68:71], a[56:59], v[40:43]
    ds_read_b128 v[68:71], v122 offset:20480
    s_add_u32 m0, s84, 6144
    s_add_u32 s83, s74, s85
    buffer_load_dwordx4 v158, s[60:63], s83 offen lds
    v_mfma_f32_16x16x32_bf16 v[56:59], v[116:119], a[56:59], v[56:59]
    v_bfe_u32 v230, v152, 1, 1
    v_lshl_add_u32 v127, v230, 2, v127
    v_mfma_f32_16x16x32_bf16 v[188:191], v[72:75], a[40:43], v[188:191]
    v_and_b32 v230, 15, v152
    s_lshl_b32 s3, s77, 7
    v_mfma_f32_16x16x32_bf16 v[204:207], v[72:75], a[48:51], v[204:207]
    s_add_u32 s3, s3, 81920
    v_lshl_add_u32 v154, v230, 3, s3
    v_mfma_f32_16x16x32_bf16 v[44:47], v[72:75], a[56:59], v[44:47]
    ds_read_b128 v[72:75], v122 offset:22528
    buffer_load_dwordx4 v159, s[60:63], s83 offen offset:1024 lds
    v_mfma_f32_16x16x32_bf16 v[176:179], v[76:79], a[44:47], v[176:179]
    s_waitcnt vmcnt(15)
    v_bfe_u32 v155, v152, 1, 2
    s_lshl_b32 s3, s77, 5
    v_mfma_f32_16x16x32_bf16 v[192:195], v[76:79], a[52:55], v[192:195]
    s_add_u32 s3, s3, 82432
    ds_read_b128 v[92:95], v124 offset:32768
    v_lshl_add_u32 v155, v155, 3, s3
    v_mfma_f32_16x16x32_bf16 v[32:35], v[76:79], a[60:63], v[32:35]
    ds_read_b128 v[76:79], v123 offset:16384
    s_add_u32 m0, s84, 8192
    s_add_u32 s83, s74, s85
    buffer_load_dwordx4 v158, s[92:95], s83 offen lds
    ds_read_b128 v[96:99], v125 offset:32768
    v_mfma_f32_16x16x32_bf16 v[48:51], v[116:119], a[44:47], v[48:51]
    ds_read_b128 v[100:103], v124 offset:40960
    v_not_b32 v230, v152
    v_lshlrev_b32 v230, 28, v230
    v_mfma_f32_16x16x32_bf16 v[180:183], v[80:83], a[44:47], v[180:183]
    ds_read_b128 v[104:107], v125 offset:40960
    v_and_b32 v163, 0x80000000, v230
    v_lshrrev_b32 v230, 4, v152
    v_mfma_f32_16x16x32_bf16 v[196:199], v[80:83], a[52:55], v[196:199]
    s_mov_b32 s3, 92160
    v_lshl_add_u32 v216, v230, 6, s3
    v_mfma_f32_16x16x32_bf16 v[36:39], v[80:83], a[60:63], v[36:39]
    ds_read_b128 v[80:83], v123 offset:18432
    buffer_load_dwordx4 v159, s[92:95], s83 offen offset:1024 lds
    v_mfma_f32_16x16x32_bf16 v[52:55], v[116:119], a[52:55], v[52:55]
    v_and_b32 v218, 1, v152
    s_waitcnt lgkmcnt(10)
    v_mfma_f32_16x16x32_bf16 v[184:187], v[84:87], a[44:47], v[184:187]
    v_lshl_add_u32 v217, v218, 5, v216
    v_lshlrev_b32 v218, 2, v218
    v_mfma_f32_16x16x32_bf16 v[200:203], v[84:87], a[52:55], v[200:203]
    v_lshl_add_u32 v218, v230, 8, v218
    v_and_b32 v230, 1, v230
    v_mfma_f32_16x16x32_bf16 v[40:43], v[84:87], a[60:63], v[40:43]
    ds_read_b128 v[84:87], v123 offset:20480
    s_add_u32 m0, s100, 65536
    s_mov_b32 s83, s76
    buffer_load_dwordx4 v164, s[52:55], s83 offen lds
    v_mfma_f32_16x16x32_bf16 v[56:59], v[116:119], a[60:63], v[56:59]
    v_xor_b32 v230, s77, v230
    v_lshl_add_u32 v218, v230, 6, v218
    s_waitcnt lgkmcnt(4)
    v_mfma_f32_16x16x32_bf16 v[108:111], v[92:95], v[92:95], v[108:111]
    v_bfe_u32 v230, v152, 1, 2
    v_lshl_add_u32 v218, v230, 4, v218
    v_mfma_f32_16x16x32_bf16 v[232:235], v[116:119], v[92:95], v[232:235]
    s_waitcnt vmcnt(15)
    ds_read_b128 a[64:67], v156 offset:0
    ds_read_b128 a[68:71], v157 offset:0
    v_mfma_f32_16x16x32_bf16 v[188:191], v[88:91], a[44:47], v[188:191]
    buffer_load_dwordx4 v165, s[52:55], s83 offen offset:1024 lds
    s_waitcnt vmcnt(14)
    ds_read_b128 a[72:75], v156 offset:2048
    ds_read_b128 a[76:79], v157 offset:2048
    v_mfma_f32_16x16x32_bf16 v[204:207], v[88:91], a[52:55], v[204:207]
    v_bfe_u32 v230, v152, 3, 1
    v_lshlrev_b32 v230, 12, v230
    v_mfma_f32_16x16x32_bf16 v[44:47], v[88:91], a[60:63], v[44:47]
    ds_read_b128 v[88:91], v123 offset:22528
    s_mov_b32 s3, 0
    v_mfma_f32_16x16x32_bf16 v[108:111], v[96:99], v[96:99], v[108:111]
    v_add3_u32 v218, v230, v218, s3
    v_xor_b32 v219, 8, v218
    v_mfma_f32_16x16x32_bf16 v[232:235], v[116:119], v[96:99], v[232:235]
    s_add_u32 m0, s100, 73728
    s_add_u32 s83, s76, 640
    buffer_load_dwordx4 v164, s[52:55], s83 offen lds
    s_waitcnt lgkmcnt(3)
    v_mfma_f32_16x16x32_bf16 v[176:179], v[60:63], a[64:67], v[176:179]
    s_mul_i32 s3, s79, 163840
    s_waitcnt lgkmcnt(1)
    v_mfma_f32_16x16x32_bf16 v[192:195], v[60:63], a[72:75], v[192:195]
    s_barrier
    ds_read_b128 v[60:63], v120 offset:32768
    v_mfma_f32_16x16x32_bf16 v[48:51], v[116:119], a[64:67], v[48:51]
    buffer_load_dwordx4 v165, s[52:55], s83 offen offset:1024 lds
    s_mul_i32 s4, s78, 5120
    v_mfma_f32_16x16x32_bf16 v[108:111], v[100:103], v[100:103], v[108:111]
    s_add_u32 s3, s3, s4
    s_lshl_b32 s4, s77, 10
    v_mfma_f32_16x16x32_bf16 v[232:235], v[116:119], v[100:103], v[232:235]
    s_add_u32 s36, s3, s4
    s_add_u32 s18, s36, 40960
    v_mfma_f32_16x16x32_bf16 v[180:183], v[64:67], a[64:67], v[180:183]
    s_add_u32 s19, s36, 81920
    s_add_u32 s20, s36, 122880
    v_mfma_f32_16x16x32_bf16 v[196:199], v[64:67], a[72:75], v[196:199]
    ds_read_b128 v[64:67], v120 offset:34816
    s_add_u32 m0, s84, 10240
    s_add_u32 s83, s74, s90
    buffer_load_dwordx4 v158, s[56:59], s83 offen lds
    v_mfma_f32_16x16x32_bf16 v[52:55], v[116:119], a[72:75], v[52:55]
    s_lshl_b32 s4, s81, 8
    s_add_u32 s3, s3, s4
    v_mfma_f32_16x16x32_bf16 v[108:111], v[104:107], v[104:107], v[108:111]
    s_lshl_b32 s4, s80, 3
    s_add_u32 s3, s3, s4
    v_mfma_f32_16x16x32_bf16 v[232:235], v[116:119], v[104:107], v[232:235]
    s_add_u32 s37, s3, 4096
    v_mfma_f32_16x16x32_bf16 v[184:187], v[68:71], a[64:67], v[184:187]
    buffer_load_dwordx4 v159, s[56:59], s83 offen offset:1024 lds
    s_waitcnt vmcnt(13)
    v_and_b32 v165, 15, v152
    v_mfma_f32_16x16x32_bf16 v[200:203], v[68:71], a[72:75], v[200:203]
    ds_read_b128 v[68:71], v120 offset:36864
    ds_read_b128 v[92:95], v124 offset:49152
    v_lshrrev_b32 v230, 4, v152
    v_mfma_f32_16x16x32_bf16 v[188:191], v[72:75], a[64:67], v[188:191]
    ds_read_b128 v[96:99], v125 offset:49152
    v_add_u32 v164, 1, v165
    v_and_b32 v231, 1, v164
    v_mfma_f32_16x16x32_bf16 v[204:207], v[72:75], a[72:75], v[204:207]
    ds_read_b128 v[72:75], v120 offset:38912
    ds_read_b128 v[100:103], v124 offset:57344
    v_mfma_f32_16x16x32_bf16 v[176:179], v[76:79], a[68:71], v[176:179]
    s_add_u32 m0, s84, 12288
    s_add_u32 s83, s74, s90
    buffer_load_dwordx4 v158, s[60:63], s83 offen lds
    ds_read_b128 v[104:107], v125 offset:57344
    v_mfma_f32_16x16x32_bf16 v[192:195], v[76:79], a[76:79], v[192:195]
    ds_read_b128 v[76:79], v121 offset:32768
    v_sub_u32 v164, v164, v231
    v_mfma_f32_16x16x32_bf16 v[48:51], v[116:119], a[68:71], v[48:51]
    v_mul_u32_u24 v231, 4164, v231
    v_lshl_add_u32 v164, v164, 1, v231
    v_mfma_f32_16x16x32_bf16 v[180:183], v[80:83], a[68:71], v[180:183]
    v_lshlrev_b32 v231, 4, v230
    v_sub_u32 v164, v164, v231
    v_mfma_f32_16x16x32_bf16 v[196:199], v[80:83], a[76:79], v[196:199]
    ds_read_b128 v[80:83], v121 offset:34816
    buffer_load_dwordx4 v159, s[60:63], s83 offen offset:1024 lds
    v_mfma_f32_16x16x32_bf16 v[52:55], v[116:119], a[76:79], v[52:55]
    v_lshl_add_u32 v165, v165, 5, v231
    s_waitcnt lgkmcnt(10)
    v_mfma_f32_16x16x32_bf16 v[184:187], v[84:87], a[68:71], v[184:187]
    s_lshl_b32 s3, s77, 7
    s_add_u32 s4, s3, 30256
    v_mfma_f32_16x16x32_bf16 v[200:203], v[84:87], a[76:79], v[200:203]
    ds_read_b128 v[84:87], v121 offset:36864
    s_add_u32 m0, s84, 14336
    s_add_u32 s83, s75, s85
    buffer_load_dwordx4 v158, s[56:59], s83 offen lds
    s_waitcnt lgkmcnt(6)
    v_mfma_f32_16x16x32_bf16 v[108:111], v[92:95], v[92:95], v[108:111]
    s_waitcnt vmcnt(13)
    ds_read_b128 a[80:83], v156 offset:4096
    ds_read_b128 a[84:87], v157 offset:4096
    v_mfma_f32_16x16x32_bf16 v[232:235], v[116:119], v[92:95], v[232:235]
    s_waitcnt vmcnt(11)
    ds_read_b128 a[88:91], v156 offset:6144
    ds_read_b128 a[92:95], v157 offset:6144
    v_mfma_f32_16x16x32_bf16 v[188:191], v[88:91], a[68:71], v[188:191]
    s_waitcnt vmcnt(9)
    ds_read_b128 a[96:99], v156 offset:8192
    ds_read_b128 a[100:103], v157 offset:8192
    v_mfma_f32_16x16x32_bf16 v[204:207], v[88:91], a[76:79], v[204:207]
    ds_read_b128 v[88:91], v121 offset:38912
    buffer_load_dwordx4 v159, s[56:59], s83 offen offset:1024 lds
    v_mfma_f32_16x16x32_bf16 v[108:111], v[96:99], v[96:99], v[108:111]
    s_sub_u32 s3, 26016, s3
    v_add_u32 v164, s4, v164
    v_mfma_f32_16x16x32_bf16 v[232:235], v[116:119], v[96:99], v[232:235]
    s_waitcnt lgkmcnt(5)
    v_mfma_f32_16x16x32_bf16 v[176:179], v[60:63], a[80:83], v[176:179]
    v_add_u32 v165, s3, v165
    s_waitcnt lgkmcnt(3)
    v_mfma_f32_16x16x32_bf16 v[192:195], v[60:63], a[88:91], v[192:195]
    s_mov_b32 m0, s84
    s_add_u32 s83, s75, s85
    buffer_load_dwordx4 v158, s[60:63], s83 offen lds
    s_waitcnt lgkmcnt(1)
    v_mfma_f32_16x16x32_bf16 v[32:35], v[60:63], a[96:99], v[32:35]
    ds_read_b128 v[60:63], v122 offset:32768
    s_min_u32 s4, s77, 2
    L_nonce:
    v_readfirstlane_b32 s82, v224
    s_cmp_eq_u32 s82, 0
    s_cbranch_scc1 L_nonce_re
    s_xor_b32 s8, s82, s89
    v_mov_b32 v224, s8
    s_mov_b64 exec, 1

    global_store_dword v223, v224, s[50:51] sc1
    s_mov_b64 exec, -1
    v_mfma_f32_16x16x32_bf16 v[48:51], v[116:119], a[80:83], v[48:51]
    s_mul_i32 s3, s4, 4608
    s_add_u32 s3, s3, 16384
    v_mfma_f32_16x16x32_bf16 v[108:111], v[100:103], v[100:103], v[108:111]
    v_lshl_add_u32 v173, v152, 3, s3
    s_mul_i32 s4, s4, 8320
    v_mfma_f32_16x16x32_bf16 v[232:235], v[116:119], v[100:103], v[232:235]
    buffer_load_dwordx4 v159, s[60:63], s83 offen offset:1024 lds
    s_add_u32 s4, s4, 30208
    v_mfma_f32_16x16x32_bf16 v[180:183], v[64:67], a[80:83], v[180:183]
    v_lshrrev_b32 v172, 3, v152
    v_mul_u32_u24 v172, 4132, v172
    v_mfma_f32_16x16x32_bf16 v[196:199], v[64:67], a[88:91], v[196:199]
    v_lshl_add_u32 v172, v152, 2, v172
    v_add_u32 v172, s4, v172
    v_mfma_f32_16x16x32_bf16 v[36:39], v[64:67], a[96:99], v[36:39]
    ds_read_b128 v[64:67], v122 offset:34816
    s_and_b32 s3, s79, 1
    v_mfma_f32_16x16x32_bf16 v[52:55], v[116:119], a[88:91], v[52:55]
    s_lshl_b32 s3, s3, 4
    s_lshr_b32 s35, s35, s3
    v_mfma_f32_16x16x32_bf16 v[108:111], v[104:107], v[104:107], v[108:111]
    s_lshl_b32 s35, s35, 16
    s_lshl_b32 s3, s81, 4
    v_mfma_f32_16x16x32_bf16 v[232:235], v[116:119], v[104:107], v[232:235]
    s_lshr_b32 s34, s34, s3
    v_mfma_f32_16x16x32_bf16 v[184:187], v[68:71], a[80:83], v[184:187]
    global_load_dword a255, v112, s[26:27]
    s_lshl_b32 s34, s34, 16
    v_mfma_f32_16x16x32_bf16 v[200:203], v[68:71], a[88:91], v[200:203]
    s_mov_b64 s[68:69], s[50:51]
    s_mov_b32 s70, 5767168
    v_mfma_f32_16x16x32_bf16 v[40:43], v[68:71], a[96:99], v[40:43]
    ds_read_b128 v[68:71], v122 offset:36864
    global_load_dword a255, v112, s[28:29]
    v_mfma_f32_16x16x32_bf16 v[56:59], v[116:119], a[96:99], v[56:59]
    s_mov_b64 s[64:65], s[46:47]
    s_mov_b32 s66, 5242880
    v_add_u32 v124, 0x10000, v124
    v_mfma_f32_16x16x32_bf16 v[188:191], v[72:75], a[80:83], v[188:191]
    s_add_u32 m0, s84, 2048
    s_add_u32 s83, s75, s85
    buffer_load_dwordx4 v158, s[92:95], s83 offen lds
    v_add_u32 v125, 0x10000, v125
    v_mfma_f32_16x16x32_bf16 v[204:207], v[72:75], a[88:91], v[204:207]
    s_waitcnt vmcnt(12)
    v_mov_b64 v[228:229], 0
    v_mfma_f32_16x16x32_bf16 v[44:47], v[72:75], a[96:99], v[44:47]
    ds_read_b128 v[72:75], v122 offset:38912
    ds_read_b128 v[92:95], v124 offset:0
    v_mfma_f32_16x16x32_bf16 v[176:179], v[76:79], a[84:87], v[176:179]
    buffer_load_dwordx4 v159, s[92:95], s83 offen offset:1024 lds
    ds_read_b128 v[96:99], v125 offset:0
    v_mfma_f32_16x16x32_bf16 v[192:195], v[76:79], a[92:95], v[192:195]
    ds_read_b128 v[100:103], v124 offset:8192
    v_mfma_f32_16x16x32_bf16 v[32:35], v[76:79], a[100:103], v[32:35]
    ds_read_b128 v[76:79], v123 offset:32768
    ds_read_b128 v[104:107], v125 offset:8192
    v_mfma_f32_16x16x32_bf16 v[48:51], v[116:119], a[84:87], v[48:51]
    ds_read_b128 v[142:145], v128
    v_mfma_f32_16x16x32_bf16 v[180:183], v[80:83], a[84:87], v[180:183]
    s_add_u32 m0, s84, 4096
    s_add_u32 s83, s76, s85
    buffer_load_dwordx4 v158, s[56:59], s83 offen lds
    ds_read_b128 v[146:149], v129
    v_mfma_f32_16x16x32_bf16 v[196:199], v[80:83], a[92:95], v[196:199]
    ds_read_b64 v[150:151], v130
    v_mfma_f32_16x16x32_bf16 v[36:39], v[80:83], a[100:103], v[36:39]
    ds_read_b128 v[80:83], v123 offset:34816
    v_mfma_f32_16x16x32_bf16 v[52:55], v[116:119], a[92:95], v[52:55]
    s_waitcnt lgkmcnt(7)
    v_mfma_f32_16x16x32_bf16 v[108:111], v[92:95], v[92:95], v[108:111]
    buffer_load_dwordx4 v159, s[56:59], s83 offen offset:1024 lds
    v_mfma_f32_16x16x32_bf16 v[232:235], v[116:119], v[92:95], v[232:235]
    v_mfma_f32_16x16x32_bf16 v[184:187], v[84:87], a[84:87], v[184:187]
    v_mfma_f32_16x16x32_bf16 v[200:203], v[84:87], a[92:95], v[200:203]
    v_mfma_f32_16x16x32_bf16 v[40:43], v[84:87], a[100:103], v[40:43]
    ds_read_b128 v[84:87], v123 offset:36864
    s_add_u32 m0, s84, 6144
    s_add_u32 s83, s76, s85
    buffer_load_dwordx4 v158, s[60:63], s83 offen lds
    v_mfma_f32_16x16x32_bf16 v[56:59], v[116:119], a[100:103], v[56:59]
    s_waitcnt lgkmcnt(2)
    ds_read_b128 v[0:3], v166 offset:0
    ds_read_b128 v[4:7], v166 offset:16
    v_mfma_f32_16x16x32_bf16 v[108:111], v[96:99], v[96:99], v[108:111]
    ds_read_b128 v[8:11], v166 offset:128
    ds_read_b128 v[12:15], v166 offset:144
    ds_read_b128 v[16:19], v167 offset:256
    v_mfma_f32_16x16x32_bf16 v[232:235], v[116:119], v[96:99], v[232:235]
    s_waitcnt vmcnt(14)
    ds_read_b128 a[104:107], v156 offset:10240
    ds_read_b128 a[108:111], v157 offset:10240
    v_mfma_f32_16x16x32_bf16 v[188:191], v[88:91], a[84:87], v[188:191]
    buffer_load_dwordx4 v159, s[60:63], s83 offen offset:1024 lds
    s_waitcnt vmcnt(13)
    ds_read_b128 a[112:115], v156 offset:12288
    ds_read_b128 a[116:119], v157 offset:12288
    v_mfma_f32_16x16x32_bf16 v[204:207], v[88:91], a[92:95], v[204:207]
    v_lshlrev_b32 v132, 16, v142
    v_and_b32 v133, s86, v142
    v_mfma_f32_16x16x32_bf16 v[44:47], v[88:91], a[100:103], v[44:47]
    ds_read_b128 v[88:91], v123 offset:38912
    v_lshlrev_b32 v134, 16, v143
    v_mfma_f32_16x16x32_bf16 v[108:111], v[100:103], v[100:103], v[108:111]
    s_add_u32 m0, s84, 8192
    s_add_u32 s83, s76, s85
    buffer_load_dwordx4 v158, s[92:95], s83 offen lds
    v_mfma_f32_16x16x32_bf16 v[232:235], v[116:119], v[100:103], v[232:235]
    v_and_b32 v135, s86, v143
    s_waitcnt lgkmcnt(3)
    v_mfma_f32_16x16x32_bf16 v[176:179], v[60:63], a[104:107], v[176:179]
    v_lshlrev_b32 v136, 16, v144
    v_and_b32 v137, s86, v144
    s_waitcnt lgkmcnt(1)
    v_mfma_f32_16x16x32_bf16 v[192:195], v[60:63], a[112:115], v[192:195]
    s_waitcnt lgkmcnt(0)
    s_barrier
    ds_read_b128 v[60:63], v120 offset:49152
    v_mfma_f32_16x16x32_bf16 v[48:51], v[116:119], a[104:107], v[48:51]
    buffer_load_dwordx4 v159, s[92:95], s83 offen offset:1024 lds
    v_lshlrev_b32 v138, 16, v145
    v_and_b32 v139, s86, v145
    v_mfma_f32_16x16x32_bf16 v[108:111], v[104:107], v[104:107], v[108:111]
    v_lshlrev_b32 v140, 16, v146
    v_and_b32 v141, s86, v146
    v_mfma_f32_16x16x32_bf16 v[232:235], v[116:119], v[104:107], v[232:235]
    v_lshlrev_b32 v142, 16, v147
    v_and_b32 v143, s86, v147
    v_mfma_f32_16x16x32_bf16 v[180:183], v[64:67], a[104:107], v[180:183]
    v_lshlrev_b32 v144, 16, v148
    v_and_b32 v145, s86, v148
    v_mfma_f32_16x16x32_bf16 v[196:199], v[64:67], a[112:115], v[196:199]
    ds_read_b128 v[64:67], v120 offset:51200
    s_add_u32 m0, s84, 10240
    s_add_u32 s83, s75, s90
    buffer_load_dwordx4 v158, s[56:59], s83 offen lds
    v_mfma_f32_16x16x32_bf16 v[52:55], v[116:119], a[112:115], v[52:55]
    s_mov_b32 vcc_lo, 0xaaaaaaaa
    s_mov_b32 vcc_hi, 0xaaaaaaaa
    v_cndmask_b32 v108, v108, v109, vcc
    v_cndmask_b32 v110, v110, v111, vcc
    v_mfma_f32_16x16x32_bf16 v[184:187], v[68:71], a[104:107], v[184:187]
    s_mov_b32 vcc_lo, 0xcccccccc
    s_mov_b32 vcc_hi, 0xcccccccc
    v_cndmask_b32 v108, v108, v110, vcc
    v_mfma_f32_16x16x32_bf16 v[200:203], v[68:71], a[112:115], v[200:203]
    ds_read_b128 v[68:71], v120 offset:53248
    s_mov_b32 vcc_lo, 0x00f0000f
    s_mov_b32 vcc_hi, 0xf0000f00
    v_cndmask_b32 v108, 0, v108, vcc
    v_mfma_f32_16x16x32_bf16 v[188:191], v[72:75], a[104:107], v[188:191]
    buffer_load_dwordx4 v159, s[56:59], s83 offen offset:1024 lds
    v_mov_b32 v109, v108
    s_nop 1
    v_permlane32_swap_b32 v108, v109
    v_mfma_f32_16x16x32_bf16 v[204:207], v[72:75], a[112:115], v[204:207]
    ds_read_b128 v[72:75], v120 offset:55296
    v_add_f32 v108, v108, v109
    v_mov_b32 v109, v108
    v_mfma_f32_16x16x32_bf16 v[176:179], v[76:79], a[108:111], v[176:179]
    s_nop 0
    v_permlane16_swap_b32 v108, v109
    v_add_f32 v108, v108, v109
    v_mfma_f32_16x16x32_bf16 v[192:195], v[76:79], a[116:119], v[192:195]
    ds_read_b128 v[76:79], v121 offset:49152
    s_waitcnt vmcnt(15)
    ds_read_b128 a[120:123], v156 offset:14336
    ds_read_b128 a[124:127], v157 offset:14336
    v_mul_f32 v232, 0x3acccccd, v232
    v_mul_f32 v108, 0x3acccccd, v108
    v_mfma_f32_16x16x32_bf16 v[48:51], v[116:119], a[108:111], v[48:51]
    s_add_u32 m0, s84, 12288
    s_add_u32 s83, s75, s90
    buffer_load_dwordx4 v158, s[60:63], s83 offen lds
    v_fma_f32 v108, -v232, v232, v108
    v_max_f32 v108, 0, v108
    v_mfma_f32_16x16x32_bf16 v[180:183], v[80:83], a[108:111], v[180:183]
    v_cvt_pk_bf16_f32 v232, 0, v232
    v_cvt_pk_bf16_f32 v108, 0, v108
    v_mfma_f32_16x16x32_bf16 v[196:199], v[80:83], a[116:119], v[196:199]
    ds_read_b128 v[80:83], v121 offset:51200
    v_add_f32 v108, 0x3727c5ac, v108
    v_cvt_pk_bf16_f32 v108, 0, v108
    v_mfma_f32_16x16x32_bf16 v[52:55], v[116:119], a[116:119], v[52:55]
    buffer_load_dwordx4 v159, s[60:63], s83 offen offset:1024 lds
    s_waitcnt vmcnt(14)
    ds_read_b128 a[128:131], v156 offset:0
    ds_read_b128 a[132:135], v157 offset:0
    v_sqrt_f32 v108, v108
    v_xor_b32 v233, 0x80000000, v232
    v_mfma_f32_16x16x32_bf16 v[184:187], v[84:87], a[108:111], v[184:187]
    s_waitcnt vmcnt(10)
    ds_read_b128 a[136:139], v156 offset:2048
    ds_read_b128 a[140:143], v157 offset:2048
    v_cvt_pk_bf16_f32 v108, 0, v108
    v_rcp_f32 v108, v108
    v_mfma_f32_16x16x32_bf16 v[200:203], v[84:87], a[116:119], v[200:203]
    ds_read_b128 v[84:87], v121 offset:53248
    v_lshlrev_b32 v146, 16, v149
    v_and_b32 v147, s86, v149
    v_mfma_f32_16x16x32_bf16 v[188:191], v[88:91], a[108:111], v[188:191]
    v_lshlrev_b32 v148, 16, v150
    v_and_b32 v149, s86, v150
    v_mfma_f32_16x16x32_bf16 v[204:207], v[88:91], a[116:119], v[204:207]
    ds_read_b128 v[88:91], v121 offset:55296
    s_waitcnt lgkmcnt(7)
    s_add_u32 m0, s84, 14336
    s_add_u32 s83, s76, s90
    buffer_load_dwordx4 v158, s[56:59], s83 offen lds
    v_mfma_f32_16x16x32_bf16 v[176:179], v[60:63], a[120:123], v[176:179]
    v_lshlrev_b32 v150, 16, v151
    v_and_b32 v151, s86, v151
    s_waitcnt lgkmcnt(4)
    v_mfma_f32_16x16x32_bf16 v[192:195], v[60:63], a[128:131], v[192:195]
    v_add_f32 v132, v233, v132
    s_waitcnt lgkmcnt(2)
    v_mfma_f32_16x16x32_bf16 v[32:35], v[60:63], a[136:139], v[32:35]
    v_add_u32 v120, 0x10000, v120
    v_add_u32 v121, 0x10000, v121
    ds_read_b128 v[60:63], v120 offset:0
    v_add_f32 v133, v233, v133
    v_add_f32 v134, v233, v134
    v_mfma_f32_16x16x32_bf16 v[48:51], v[116:119], a[120:123], v[48:51]
    buffer_load_dwordx4 v159, s[56:59], s83 offen offset:1024 lds
    v_add_f32 v135, v233, v135
    v_add_f32 v136, v233, v136
    v_mfma_f32_16x16x32_bf16 v[180:183], v[64:67], a[120:123], v[180:183]
    v_add_f32 v137, v233, v137
    v_add_f32 v138, v233, v138
    v_mfma_f32_16x16x32_bf16 v[196:199], v[64:67], a[128:131], v[196:199]
    v_add_f32 v139, v233, v139
    v_add_f32 v140, v233, v140
    v_mfma_f32_16x16x32_bf16 v[36:39], v[64:67], a[136:139], v[36:39]
    ds_read_b128 v[64:67], v121 offset:0
    v_add_f32 v141, v233, v141
    v_add_f32 v142, v233, v142
    v_mfma_f32_16x16x32_bf16 v[52:55], v[116:119], a[128:131], v[52:55]
    s_mov_b32 m0, s84
    s_add_u32 s83, s76, s90
    buffer_load_dwordx4 v158, s[60:63], s83 offen lds
    v_mfma_f32_16x16x32_bf16 v[184:187], v[68:71], a[120:123], v[184:187]
    v_add_f32 v143, v233, v143
    v_add_f32 v144, v233, v144
    v_mfma_f32_16x16x32_bf16 v[200:203], v[68:71], a[128:131], v[200:203]
    v_add_f32 v145, v233, v145
    v_add_f32 v146, v233, v146
    v_mfma_f32_16x16x32_bf16 v[40:43], v[68:71], a[136:139], v[40:43]
    ds_read_b128 v[68:71], v120 offset:2048
    v_add_f32 v147, v233, v147
    v_add_f32 v148, v233, v148
    v_mfma_f32_16x16x32_bf16 v[56:59], v[116:119], a[136:139], v[56:59]
    buffer_load_dwordx4 v159, s[60:63], s83 offen offset:1024 lds
    v_add_f32 v149, v233, v149
    v_add_f32 v150, v233, v150
    v_mfma_f32_16x16x32_bf16 v[188:191], v[72:75], a[120:123], v[188:191]
    s_mov_b64 s[56:57], s[26:27]
    s_sub_u32 s60, s28, 2048
    s_subb_u32 s61, s29, 0
    v_mfma_f32_16x16x32_bf16 v[204:207], v[72:75], a[128:131], v[204:207]
    s_mov_b32 s62, 821248
    v_bfe_u32 v230, v152, 4, 1
    v_lshlrev_b32 v159, 1, v230
    v_mfma_f32_16x16x32_bf16 v[44:47], v[72:75], a[136:139], v[44:47]
    ds_read_b128 v[72:75], v121 offset:2048
    s_add_u32 s83, s12, s15
    v_add_u32 v175, s83, v153
    global_load_dwordx4 v[252:255], v175, s[42:43]
    v_and_b32 v231, 3, v152
    v_xor_b32 v159, v159, v231
    v_mfma_f32_16x16x32_bf16 v[176:179], v[76:79], a[124:127], v[176:179]
    v_lshrrev_b32 v231, 5, v152
    v_lshl_add_u32 v159, v231, 2, v159
    s_mul_i32 s3, s78, 102400
    s_mul_i32 s4, s77, 320
    s_add_u32 s3, s3, s4
    v_mfma_f32_16x16x32_bf16 v[192:195], v[76:79], a[132:135], v[192:195]
    s_waitcnt vmcnt(13)
    ds_read_b128 a[160:163], v156 offset:4096
    ds_read_b128 a[164:167], v157 offset:4096
    v_lshl_add_u32 v159, v159, 4, s3
    v_bfe_u32 v231, v152, 2, 2
    v_mfma_f32_16x16x32_bf16 v[32:35], v[76:79], a[140:143], v[32:35]
    ds_read_b128 v[76:79], v120 offset:4096
    v_lshl_add_u32 v231, v230, 3, v231
    s_movk_i32 s4, 1280
    v_mad_u32_u24 v159, v231, s4, v159
    s_movk_i32 s4, 10240
    v_mfma_f32_16x16x32_bf16 v[48:51], v[116:119], a[124:127], v[48:51]
    v_mad_u32_u24 v158, v230, s4, v159
    s_lshl_b32 s3, s79, 4
    s_and_b32 s3, s3, 128
    s_lshl_b32 s4, s80, 6
    v_mfma_f32_16x16x32_bf16 v[180:183], v[80:83], a[124:127], v[180:183]
    s_add_u32 s16, s3, s4
    s_xor_b32 s17, s16, 128
    s_lshl_b32 s4, s4, 2
    v_mfma_f32_16x16x32_bf16 v[196:199], v[80:83], a[132:135], v[196:199]
    s_xor_b32 s44, s4, 256
    s_add_u32 s83, s12, s14
    v_add_u32 v175, s83, v153
    global_load_dwordx4 v[244:247], v175, s[42:43]
    v_add_f32 v151, v233, v151
    v_fma_f32 v0, v0, v108, 1.0
    v_mfma_f32_16x16x32_bf16 v[36:39], v[80:83], a[140:143], v[36:39]
    ds_read_b128 v[80:83], v121 offset:4096
    s_add_u32 s83, s12, s14
    v_add_u32 v175, s83, v153
    v_add_u32 v175, 4096, v175
    global_load_dwordx4 v[248:251], v175, s[42:43]
    v_fma_f32 v1, v1, v108, 1.0
    v_fma_f32 v2, v2, v108, 1.0
    v_mfma_f32_16x16x32_bf16 v[52:55], v[116:119], a[132:135], v[52:55]
    global_load_dword v224, v169, s[50:51] sc1
    v_fma_f32 v3, v3, v108, 1.0
    v_fma_f32 v4, v4, v108, 1.0
    s_waitcnt lgkmcnt(8)
    v_mfma_f32_16x16x32_bf16 v[184:187], v[84:87], a[124:127], v[184:187]
    global_load_dwordx2 v[170:171], v168, s[50:51] sc1
    v_fma_f32 v5, v5, v108, 1.0
    v_fma_f32 v6, v6, v108, 1.0
    v_mfma_f32_16x16x32_bf16 v[200:203], v[84:87], a[132:135], v[200:203]
    s_waitcnt vmcnt(15)
    ds_read_b128 a[168:171], v156 offset:6144
    ds_read_b128 a[172:175], v157 offset:6144
    global_load_dword a255, v227, s[50:51] sc1
    v_mfma_f32_16x16x32_bf16 v[40:43], v[84:87], a[140:143], v[40:43]
    ds_read_b128 v[84:87], v120 offset:6144
    v_fma_f32 v7, v7, v108, 1.0
    v_fma_f32 v8, v8, v108, 1.0
    v_mfma_f32_16x16x32_bf16 v[56:59], v[116:119], a[140:143], v[56:59]
    s_waitcnt vmcnt(14)
    ds_read_b128 a[176:179], v156 offset:8192
    ds_read_b128 a[180:183], v157 offset:8192
    global_load_dword a255, v226, s[46:47] offset:-2048
    v_mfma_f32_16x16x32_bf16 v[188:191], v[88:91], a[124:127], v[188:191]
    v_fma_f32 v9, v9, v108, 1.0
    v_fma_f32 v10, v10, v108, 1.0
    v_mfma_f32_16x16x32_bf16 v[204:207], v[88:91], a[132:135], v[204:207]
    v_fma_f32 v11, v11, v108, 1.0
    v_fma_f32 v12, v12, v108, 1.0
    v_mfma_f32_16x16x32_bf16 v[44:47], v[88:91], a[140:143], v[44:47]
    ds_read_b128 v[88:91], v121 offset:6144
    s_waitcnt lgkmcnt(8)
    v_mfma_f32_16x16x32_bf16 v[176:179], v[60:63], a[160:163], v[176:179]
    ds_read_b64 v[112:113], v154 offset:7680
    global_load_dword a255, v226, s[46:47] offset:-1024
    v_fma_f32 v13, v13, v108, 1.0
    v_fma_f32 v14, v14, v108, 1.0
    s_waitcnt lgkmcnt(5)
    v_mfma_f32_16x16x32_bf16 v[192:195], v[60:63], a[168:171], v[192:195]
    ds_read_b64 v[114:115], v155 offset:7680
    v_fma_f32 v15, v15, v108, 1.0
    v_fma_f32 v16, v16, v108, 1.0
    s_waitcnt lgkmcnt(3)
    v_mfma_f32_16x16x32_bf16 v[32:35], v[60:63], a[176:179], v[32:35]
    ds_read_b128 v[60:63], v122 offset:49152
    ds_read_b64 v[100:101], v154 offset:8320
    v_fma_f32 v17, v17, v108, 1.0
    v_fma_f32 v18, v18, v108, 1.0
    v_mfma_f32_16x16x32_bf16 v[48:51], v[116:119], a[160:163], v[48:51]
    ds_read_b64 v[102:103], v154 offset:8960
    v_fma_f32 v19, v19, v108, 1.0
    v_mul_f32 v132, v0, v132
    v_mfma_f32_16x16x32_bf16 v[176:179], v[64:67], a[164:167], v[176:179]
    ds_read_b64 v[104:105], v155 offset:8320
    global_load_dword a255, v226, s[46:47] offset:0
    v_mul_f32 v133, v1, v133
    v_mul_f32 v134, v2, v134
    v_mfma_f32_16x16x32_bf16 v[192:195], v[64:67], a[172:175], v[192:195]
    ds_read_b64 v[106:107], v155 offset:8960
    v_mul_f32 v135, v3, v135
    v_mul_f32 v136, v4, v136
    v_mfma_f32_16x16x32_bf16 v[32:35], v[64:67], a[180:183], v[32:35]
    ds_read_b128 v[64:67], v122 offset:51200
    v_mul_f32 v137, v5, v137
    v_mul_f32 v138, v6, v138
    v_mfma_f32_16x16x32_bf16 v[48:51], v[116:119], a[164:167], v[48:51]
    v_mul_f32 v139, v7, v139
    v_mul_f32 v140, v8, v140
    v_mfma_f32_16x16x32_bf16 v[180:183], v[68:71], a[160:163], v[180:183]
    s_nop 0
    ds_write_b128 v220, v[32:35] offset:0
    global_load_dword a255, v226, s[46:47] offset:1024
    v_mul_f32 v141, v9, v141
    v_mul_f32 v142, v10, v142
    v_mfma_f32_16x16x32_bf16 v[196:199], v[68:71], a[168:171], v[196:199]
    s_waitcnt vmcnt(16)
    ds_read_b128 a[144:147], v156 offset:10240
    ds_read_b128 a[148:151], v157 offset:10240
    v_mfma_f32_16x16x32_bf16 v[36:39], v[68:71], a[176:179], v[36:39]
    ds_read_b128 v[68:71], v122 offset:53248
    v_mul_f32 v143, v11, v143
    v_mul_f32 v144, v12, v144
    v_mfma_f32_16x16x32_bf16 v[52:55], v[116:119], a[168:171], v[52:55]
    v_mul_f32 v145, v13, v145
    v_mul_f32 v146, v14, v146
    v_mfma_f32_16x16x32_bf16 v[180:183], v[72:75], a[164:167], v[180:183]
    s_mov_b64 exec, 0xffff
    ds_write_b32 v126, v232 offset:1024
    ds_write2st64_b32 v126, v233, v108 offset1:1
    ds_write2st64_b32 v127, v233, v108 offset1:1
    s_mov_b64 exec, -1
    v_mfma_f32_16x16x32_bf16 v[196:199], v[72:75], a[172:175], v[196:199]
    s_waitcnt lgkmcnt(13)
    global_load_dword a255, v226, s[46:47] offset:2048
    v_mul_f32 v147, v15, v147
    v_mul_f32 v148, v16, v148
    v_mfma_f32_16x16x32_bf16 v[36:39], v[72:75], a[180:183], v[36:39]
    ds_read_b128 v[72:75], v122 offset:55296
    v_mul_f32 v149, v17, v149
    v_mul_f32 v150, v18, v150
    v_mfma_f32_16x16x32_bf16 v[52:55], v[116:119], a[172:175], v[52:55]
    v_mul_f32 v151, v19, v151
    v_xor_b32 v115, v163, v115
    v_mfma_f32_16x16x32_bf16 v[184:187], v[76:79], a[160:163], v[184:187]
    s_waitcnt vmcnt(15)
    ds_read_b128 a[152:155], v156 offset:12288
    ds_read_b128 a[156:159], v157 offset:12288
    v_mfma_f32_16x16x32_bf16 v[200:203], v[76:79], a[168:171], v[200:203]
    ds_write_b128 v220, v[36:39] offset:1024
    s_waitcnt lgkmcnt(12)
    v_xor_b32 v105, v163, v105
    v_xor_b32 v107, v163, v107
    v_mfma_f32_16x16x32_bf16 v[40:43], v[76:79], a[176:179], v[40:43]
    ds_read_b128 v[76:79], v123 offset:49152
    v_mfma_f32_16x16x32_bf16 v[56:59], v[116:119], a[176:179], v[56:59]
    v_mfma_f32_16x16x32_bf16 v[184:187], v[80:83], a[164:167], v[184:187]
    v_mfma_f32_16x16x32_bf16 v[200:203], v[80:83], a[172:175], v[200:203]
    v_mfma_f32_16x16x32_bf16 v[40:43], v[80:83], a[180:183], v[40:43]
    ds_read_b128 v[80:83], v123 offset:51200
    v_mfma_f32_16x16x32_bf16 v[56:59], v[116:119], a[180:183], v[56:59]
    v_mfma_f32_16x16x32_bf16 v[188:191], v[84:87], a[160:163], v[188:191]
    s_waitcnt vmcnt(13)
    ds_read_b128 a[184:187], v156 offset:14336
    ds_read_b128 a[188:191], v157 offset:14336
    v_mfma_f32_16x16x32_bf16 v[204:207], v[84:87], a[168:171], v[204:207]
    s_nop 0
    ds_write_b128 v220, v[40:43] offset:2048
    v_mfma_f32_16x16x32_bf16 v[44:47], v[84:87], a[176:179], v[44:47]
    ds_read_b128 v[84:87], v123 offset:53248
    v_mfma_f32_16x16x32_bf16 v[188:191], v[88:91], a[164:167], v[188:191]
    v_mfma_f32_16x16x32_bf16 v[204:207], v[88:91], a[172:175], v[204:207]
    v_mfma_f32_16x16x32_bf16 v[44:47], v[88:91], a[180:183], v[44:47]
    ds_read_b128 v[88:91], v123 offset:55296
    s_waitcnt lgkmcnt(15)
    v_mfma_f32_16x16x32_bf16 v[176:179], v[60:63], a[144:147], v[176:179]
    s_waitcnt lgkmcnt(8)
    v_mfma_f32_16x16x32_bf16 v[192:195], v[60:63], a[152:155], v[192:195]
    v_add_u32 v122, 0x10000, v122
    v_add_u32 v123, 0x10000, v123
    ds_read_b128 v[60:63], v122 offset:0
    ds_write_b128 v220, v[44:47] offset:3072
    v_mfma_f32_16x16x32_bf16 v[48:51], v[116:119], a[144:147], v[48:51]
    s_waitcnt vmcnt(11)
    ds_read_b128 a[192:195], v156 offset:0
    ds_read_b128 a[196:199], v157 offset:0
    v_mfma_f32_16x16x32_bf16 v[180:183], v[64:67], a[144:147], v[180:183]
    v_and_b32 v242, 3, v152
    v_lshl_add_u32 v156, v242, 6, s84
    v_mfma_f32_16x16x32_bf16 v[196:199], v[64:67], a[152:155], v[196:199]
    ds_read_b128 v[64:67], v123 offset:0
    s_mov_b64 exec, 0xffff
    ds_write_b32 v225, v56
    s_mov_b64 exec, -1
    v_bfe_u32 v242, v152, 2, 1
    v_lshl_add_u32 v156, v242, 10, v156
    v_mfma_f32_16x16x32_bf16 v[52:55], v[116:119], a[152:155], v[52:55]
    v_bfe_u32 v242, v152, 3, 1
    v_lshl_add_u32 v156, v242, 8, v156
    v_mfma_f32_16x16x32_bf16 v[184:187], v[68:71], a[144:147], v[184:187]
    v_lshlrev_b32 v242, 1, v242
    v_bfe_u32 v243, v152, 4, 1
    v_mfma_f32_16x16x32_bf16 v[200:203], v[68:71], a[152:155], v[200:203]
    ds_read_b128 v[68:71], v122 offset:2048
    v_xor_b32 v242, v242, v243
    v_lshl_add_u32 v156, v242, 4, v156
    v_mfma_f32_16x16x32_bf16 v[188:191], v[72:75], a[144:147], v[188:191]
    v_lshrrev_b32 v242, 5, v152
    v_lshl_add_u32 v156, v242, 11, v156
    v_mfma_f32_16x16x32_bf16 v[204:207], v[72:75], a[152:155], v[204:207]
    ds_read_b128 v[72:75], v123 offset:2048
    v_xor_b32 v157, 32, v156
    s_waitcnt lgkmcnt(13)
    v_mfma_f32_16x16x32_bf16 v[176:179], v[76:79], a[148:151], v[176:179]
    s_lshl_b32 s3, s78, 2
    s_add_u32 s3, s3, s77
    s_lshl_b32 s3, s3, 13
    s_waitcnt lgkmcnt(0)
    s_barrier
    v_mfma_f32_16x16x32_bf16 v[192:195], v[76:79], a[156:159], v[192:195]
    ds_read_b128 v[76:79], v122 offset:4096
    s_add_u32 s3, s3, 9437184
    ds_read2st64_b32 v[16:17], v218 offset0:0 offset1:32
    v_mov_b32 v36, s30
    v_mfma_f32_16x16x32_bf16 v[48:51], v[116:119], a[148:151], v[48:51]
    s_add_u32 s92, s50, s3
    s_addc_u32 s93, s51, 0
    s_movk_i32 s94, 8192
    s_waitcnt vmcnt(9)
    v_mov_b32_dpp v36, v247 wave_shr:1 row_mask:0xf bank_mask:0xf
    v_alignbit_b32 v33, v245, v244, 16
    v_mfma_f32_16x16x32_bf16 v[180:183], v[80:83], a[148:151], v[180:183]
    s_sub_u32 s21, 31, s79
    s_lshl_b32 s21, s21, 8
    ds_read2st64_b32 v[18:19], v219 offset0:0 offset1:32
    v_alignbit_b32 v34, v246, v245, 16
    v_alignbit_b32 v35, v247, v246, 16
    v_mfma_f32_16x16x32_bf16 v[196:199], v[80:83], a[156:159], v[196:199]
    ds_read_b128 v[80:83], v123 offset:4096
    v_alignbit_b32 v32, v244, v36, 16
    v_mov_b32 v40, s31
    v_mfma_f32_16x16x32_bf16 v[52:55], v[116:119], a[156:159], v[52:55]
    ds_read2st64_b32 v[20:21], v218 offset0:4 offset1:36
    s_waitcnt vmcnt(8)
    v_mov_b32_dpp v40, v251 wave_shr:1 row_mask:0xf bank_mask:0xf
    v_alignbit_b32 v37, v249, v248, 16
    v_mfma_f32_16x16x32_bf16 v[184:187], v[84:87], a[148:151], v[184:187]
    s_waitcnt vmcnt(6)
    L_kf:
    v_xor_b32 v224, s82, v224
    v_xor_b32 v170, s82, v170
    v_xor_b32 v171, s82, v171
    v_max3_u32 v170, v170, v171, v224
    v_cmp_lt_u32 vcc, 7, v170
    s_cbranch_vccnz L_kf_re
    v_cmp_ne_u32 vcc, s89, v224
    s_lshl_b32 s5, s77, 10
    s_cmp_eq_u32 vcc_hi, 0
    s_cselect_b32 s88, 1, 0

    s_add_u32 m0, s5, 26112
    s_add_u32 s83, s5, s15
    buffer_load_dwordx4 v153, s[68:71], s83 offen sc1 lds
    v_alignbit_b32 v38, v250, v249, 16
    v_alignbit_b32 v39, v251, v250, 16
    v_mfma_f32_16x16x32_bf16 v[200:203], v[84:87], a[156:159], v[200:203]
    ds_read_b128 v[84:87], v122 offset:6144
    ds_read2st64_b32 v[22:23], v219 offset0:4 offset1:36
    v_alignbit_b32 v36, v248, v40, 16
    v_mov_b32 v44, s32
    v_mfma_f32_16x16x32_bf16 v[188:191], v[88:91], a[148:151], v[188:191]
    s_nop 0
    v_mov_b32_dpp v44, v255 wave_shr:1 row_mask:0xf bank_mask:0xf
    v_alignbit_b32 v41, v253, v252, 16
    v_mfma_f32_16x16x32_bf16 v[204:207], v[88:91], a[156:159], v[204:207]
    ds_read_b128 v[88:91], v123 offset:6144
    ds_read2st64_b32 v[24:25], v218 offset0:8 offset1:40
    v_alignbit_b32 v42, v254, v253, 16
    v_alignbit_b32 v43, v255, v254, 16
    v_mfma_f32_16x16x32_bf16 v[176:179], v[60:63], a[184:187], v[176:179]
    s_add_u32 m0, s5, 16896
    s_add_u32 s83, s5, s14
    buffer_load_dwordx4 v153, s[68:71], s83 offen sc1 lds
    v_alignbit_b32 v40, v252, v44, 16
    v_mfma_f32_16x16x32_bf16 v[192:195], v[60:63], a[192:195], v[192:195]
    ds_read2st64_b32 v[26:27], v219 offset0:8 offset1:40
    v_mfma_f32_16x16x32_bf16 v[48:51], v[116:119], a[184:187], v[48:51]
    v_mfma_f32_16x16x32_bf16 v[176:179], v[64:67], a[188:191], v[176:179]
    ds_read2st64_b32 v[28:29], v218 offset0:12 offset1:44
    s_add_u32 m0, s5, 21504
    s_add_u32 s83, s5, s14
    s_add_u32 s83, s83, 4096
    buffer_load_dwordx4 v153, s[68:71], s83 offen sc1 lds
    v_mfma_f32_16x16x32_bf16 v[192:195], v[64:67], a[196:199], v[192:195]
    v_mfma_f32_16x16x32_bf16 v[48:51], v[116:119], a[188:191], v[48:51]
    ds_read2st64_b32 v[30:31], v219 offset0:12 offset1:44
    v_mfma_f32_16x16x32_bf16 v[180:183], v[68:71], a[184:187], v[180:183]
    ds_read2_b32 v[230:231], v222 offset1:32
    v_and_b32 v120, 1, v152
    v_mul_u32_u24 v120, 640, v120
    v_add_u32 v120, v155, v120
    v_mfma_f32_16x16x32_bf16 v[196:199], v[68:71], a[192:195], v[196:199]
    ds_read_b128 v[92:95], v217 offset:768
    s_add_u32 m0, s84, 4096
    s_add_u32 s83, s16, 81920
    buffer_load_dwordx4 v159, s[56:59], s83 offen offset:0 lds
    v_mfma_f32_16x16x32_bf16 v[52:55], v[116:119], a[192:195], v[52:55]
    ds_read_b128 v[96:99], v217 offset:784
    ds_read2_b32 v[124:125], v154 offset1:160
    ds_read2_b32 v[126:127], v154 offset0:1 offset1:161
    ds_read_b64 v[128:129], v155 offset:0
    v_mfma_f32_16x16x32_bf16 v[180:183], v[72:75], a[188:191], v[180:183]
    ds_read_b128 v[212:215], v217 offset:528
    ds_read_b64 v[130:131], v120 offset:0
    v_mfma_f32_16x16x32_bf16 v[196:199], v[72:75], a[196:199], v[196:199]
    ds_read_b128 v[208:211], v217 offset:512
    s_waitcnt lgkmcnt(9)
    v_add_f32 v16, v16, v17
    v_add_f32 v18, v18, v19
    v_mfma_f32_16x16x32_bf16 v[52:55], v[116:119], a[196:199], v[52:55]
    ds_read_b128 v[0:3], v216 offset:0
    buffer_load_dwordx4 v159, s[60:63], s83 offen offset:2048 lds
    v_add_f32 v20, v20, v21
    v_add_f32 v22, v22, v23
    v_mfma_f32_16x16x32_bf16 v[184:187], v[76:79], a[184:187], v[184:187]
    ds_read_b128 v[4:7], v216 offset:256
    ds_write_b64 v173, v[228:229]
    v_add_f32 v24, v24, v25
    v_add_f32 v26, v26, v27
    v_mfma_f32_16x16x32_bf16 v[200:203], v[76:79], a[192:195], v[200:203]
    ds_read_b128 v[8:11], v216 offset:16
    v_add_f32 v28, v28, v29
    v_add_f32 v30, v30, v31
    v_mfma_f32_16x16x32_bf16 v[184:187], v[80:83], a[188:191], v[184:187]
    ds_read_b128 v[12:15], v216 offset:272
    s_waitcnt lgkmcnt(5)
    v_add_f32 v162, v230, v231
    v_fma_f32 v208, v208, v162, v16
    v_mfma_f32_16x16x32_bf16 v[200:203], v[80:83], a[196:199], v[200:203]
    s_add_u32 s83, s83, 4096
    buffer_load_dwordx4 v159, s[56:59], s83 offen offset:1024 lds
    v_fma_f32 v209, v209, v162, v18
    v_fma_f32 v210, v210, v162, v20
    v_mfma_f32_16x16x32_bf16 v[188:191], v[84:87], a[184:187], v[188:191]
    v_fma_f32 v211, v211, v162, v22
    v_fma_f32 v212, v212, v162, v24
    v_mfma_f32_16x16x32_bf16 v[204:207], v[84:87], a[192:195], v[204:207]
    v_fma_f32 v213, v213, v162, v26
    v_fma_f32 v214, v214, v162, v28
    v_mfma_f32_16x16x32_bf16 v[188:191], v[88:91], a[188:191], v[188:191]
    s_mov_b64 exec, 0x7fff
    ds_write_b32 v172, v228
    s_mov_b64 exec, -1
    v_fma_f32 v215, v215, v162, v30
    v_mul_f32 v208, v92, v208
    v_mfma_f32_16x16x32_bf16 v[204:207], v[88:91], a[196:199], v[204:207]
    buffer_load_dwordx4 v159, s[60:63], s83 offen offset:3072 lds
    v_mul_f32 v209, v93, v209
    v_mul_f32 v210, v94, v210
    v_mul_f32 v211, v95, v211
    v_mul_f32 v212, v96, v212
    v_mul_f32 v213, v97, v213
    v_mul_f32 v214, v98, v214
    v_mul_f32 v215, v99, v215
    v_mov_b32 v160, v48
    v_mov_b32 v161, v52
    ds_write_b128 v221, v[244:247] offset:38560
    s_waitcnt lgkmcnt(5)
    v_pk_fma_f32 v[176:177], v[0:1], v[160:161], v[176:177] op_sel_hi:[1,0,1]
    v_pk_fma_f32 v[192:193], v[0:1], v[160:161], v[192:193] op_sel:[0,1,0]
    v_fma_f32 v241, v114, v208, v209
    v_pk_fma_f32 v[178:179], v[2:3], v[160:161], v[178:179] op_sel_hi:[1,0,1]
    v_pk_fma_f32 v[194:195], v[2:3], v[160:161], v[194:195] op_sel:[0,1,0]
    v_pk_mul_f32 v[176:177], v[4:5], v[176:177]
    v_fmac_f32_dpp v241, v208, v115 row_ror:8 row_mask:0xf bank_mask:0xf
    v_pk_mul_f32 v[192:193], v[4:5], v[192:193]
    v_pk_mul_f32 v[178:179], v[6:7], v[178:179]
    v_pk_mul_f32 v[194:195], v[6:7], v[194:195]
    v_fma_f32 v240, v114, v241, v210
    ds_write_b128 v221, v[32:35] offset:42720
    ds_read_b128 v[0:3], v216 offset:32
    ds_read_b128 v[4:7], v216 offset:288
    v_pk_fma_f32 v[236:237], v[176:177], v[112:113], v[178:179] op_sel_hi:[1,0,1]
    v_fmac_f32_dpp v240, v241, v115 row_ror:8 row_mask:0xf bank_mask:0xf
    v_pk_fma_f32 v[238:239], v[192:193], v[112:113], v[194:195] op_sel_hi:[1,0,1]
    v_pk_fma_f32 v[236:237], v[192:193], v[112:113], v[236:237] op_sel:[0,1,0] neg_lo:[1,0,0] neg_hi:[1,0,0]
    v_pk_fma_f32 v[238:239], v[176:177], v[112:113], v[238:239] op_sel:[0,1,0]
    s_waitcnt lgkmcnt(5)
    v_pk_fma_f32 v[180:181], v[8:9], v[160:161], v[180:181] op_sel_hi:[1,0,1]
    v_pk_fma_f32 v[196:197], v[8:9], v[160:161], v[196:197] op_sel:[0,1,0]
    v_fma_f32 v241, v114, v240, v211
    v_pk_fma_f32 v[182:183], v[10:11], v[160:161], v[182:183] op_sel_hi:[1,0,1]
    v_pk_fma_f32 v[198:199], v[10:11], v[160:161], v[198:199] op_sel:[0,1,0]
    v_pk_mul_f32 v[180:181], v[12:13], v[180:181]
    ds_write_b128 v221, v[248:251] offset:46880
    v_fmac_f32_dpp v241, v240, v115 row_ror:8 row_mask:0xf bank_mask:0xf
    v_pk_mul_f32 v[196:197], v[12:13], v[196:197]
    v_pk_mul_f32 v[182:183], v[14:15], v[182:183]
    v_pk_mul_f32 v[198:199], v[14:15], v[198:199]
    v_fma_f32 v240, v114, v241, v212
    ds_read_b128 v[8:11], v216 offset:48
    ds_read_b128 v[12:15], v216 offset:304
    v_pk_fma_f32 v[232:233], v[236:237], v[112:113], v[180:181] op_sel_hi:[1,0,1]
    v_fmac_f32_dpp v240, v241, v115 row_ror:8 row_mask:0xf bank_mask:0xf
    v_pk_fma_f32 v[234:235], v[238:239], v[112:113], v[196:197] op_sel_hi:[1,0,1]
    v_pk_fma_f32 v[232:233], v[238:239], v[112:113], v[232:233] op_sel:[0,1,0] neg_lo:[1,0,0] neg_hi:[1,0,0]
    v_pk_fma_f32 v[234:235], v[236:237], v[112:113], v[234:235] op_sel:[0,1,0]
    v_pk_fma_f32 v[236:237], v[232:233], v[112:113], v[182:183] op_sel_hi:[1,0,1]
    ds_write_b128 v221, v[36:39] offset:51040
    v_pk_fma_f32 v[238:239], v[234:235], v[112:113], v[198:199] op_sel_hi:[1,0,1]
    v_pk_fma_f32 v[236:237], v[234:235], v[112:113], v[236:237] op_sel:[0,1,0] neg_lo:[1,0,0] neg_hi:[1,0,0]
    v_pk_fma_f32 v[238:239], v[232:233], v[112:113], v[238:239] op_sel:[0,1,0]
    s_waitcnt lgkmcnt(4)
    v_pk_fma_f32 v[184:185], v[0:1], v[160:161], v[184:185] op_sel_hi:[1,0,1]
    v_pk_fma_f32 v[200:201], v[0:1], v[160:161], v[200:201] op_sel:[0,1,0]
    v_fma_f32 v241, v114, v240, v213
    v_pk_fma_f32 v[186:187], v[2:3], v[160:161], v[186:187] op_sel_hi:[1,0,1]
    v_pk_fma_f32 v[202:203], v[2:3], v[160:161], v[202:203] op_sel:[0,1,0]
    v_pk_mul_f32 v[184:185], v[4:5], v[184:185]
    v_fmac_f32_dpp v241, v240, v115 row_ror:8 row_mask:0xf bank_mask:0xf
    v_pk_mul_f32 v[200:201], v[4:5], v[200:201]
    ds_write_b128 v221, v[252:255] offset:30240
    v_pk_mul_f32 v[186:187], v[6:7], v[186:187]
    v_pk_mul_f32 v[202:203], v[6:7], v[202:203]
    v_fma_f32 v240, v114, v241, v214
    v_pk_fma_f32 v[232:233], v[236:237], v[112:113], v[184:185] op_sel_hi:[1,0,1]
    v_pk_fma_f32 v[234:235], v[238:239], v[112:113], v[200:201] op_sel_hi:[1,0,1]
    v_pk_fma_f32 v[232:233], v[238:239], v[112:113], v[232:233] op_sel:[0,1,0] neg_lo:[1,0,0] neg_hi:[1,0,0]
    v_fmac_f32_dpp v240, v241, v115 row_ror:8 row_mask:0xf bank_mask:0xf
    v_pk_fma_f32 v[234:235], v[236:237], v[112:113], v[234:235] op_sel:[0,1,0]
    v_pk_fma_f32 v[236:237], v[232:233], v[112:113], v[186:187] op_sel_hi:[1,0,1]
    v_pk_fma_f32 v[238:239], v[234:235], v[112:113], v[202:203] op_sel_hi:[1,0,1]
    v_pk_fma_f32 v[236:237], v[234:235], v[112:113], v[236:237] op_sel:[0,1,0] neg_lo:[1,0,0] neg_hi:[1,0,0]
    v_pk_fma_f32 v[238:239], v[232:233], v[112:113], v[238:239] op_sel:[0,1,0]
    ds_write_b128 v221, v[40:43] offset:34400
    s_waitcnt lgkmcnt(3)
    v_pk_fma_f32 v[188:189], v[8:9], v[160:161], v[188:189] op_sel_hi:[1,0,1]
    v_pk_fma_f32 v[204:205], v[8:9], v[160:161], v[204:205] op_sel:[0,1,0]
    v_fma_f32 v241, v114, v240, v215
    v_pk_fma_f32 v[190:191], v[10:11], v[160:161], v[190:191] op_sel_hi:[1,0,1]
    v_pk_fma_f32 v[206:207], v[10:11], v[160:161], v[206:207] op_sel:[0,1,0]
    v_pk_mul_f32 v[188:189], v[12:13], v[188:189]
    v_fmac_f32_dpp v241, v240, v115 row_ror:8 row_mask:0xf bank_mask:0xf
    v_pk_mul_f32 v[204:205], v[12:13], v[204:205]
    v_pk_mul_f32 v[190:191], v[14:15], v[190:191]
    v_pk_mul_f32 v[206:207], v[14:15], v[206:207]
    v_pk_fma_f32 v[232:233], v[236:237], v[112:113], v[188:189] op_sel_hi:[1,0,1]
    v_pk_fma_f32 v[234:235], v[238:239], v[112:113], v[204:205] op_sel_hi:[1,0,1]
    v_pk_fma_f32 v[232:233], v[238:239], v[112:113], v[232:233] op_sel:[0,1,0] neg_lo:[1,0,0] neg_hi:[1,0,0]
    v_pk_fma_f32 v[234:235], v[236:237], v[112:113], v[234:235] op_sel:[0,1,0]
    v_pk_fma_f32 v[236:237], v[232:233], v[112:113], v[190:191] op_sel_hi:[1,0,1]
    v_pk_fma_f32 v[238:239], v[234:235], v[112:113], v[206:207] op_sel_hi:[1,0,1]
    v_pk_fma_f32 v[236:237], v[234:235], v[112:113], v[236:237] op_sel:[0,1,0] neg_lo:[1,0,0] neg_hi:[1,0,0]
    v_pk_fma_f32 v[238:239], v[232:233], v[112:113], v[238:239] op_sel:[0,1,0]
    v_mul_f32 v219, v104, v241
    v_fma_f32 v216, v100, v236, v237
    v_fma_f32 v217, v100, v238, v239
    v_fmac_f32_dpp v219, v241, v105 row_ror:8 row_mask:0xf bank_mask:0xf
    v_mov_b32_dpp v218, v241 quad_perm:[1,1,3,3] row_mask:0xf bank_mask:0xf
    v_fma_f32 v216, -v101, v238, v216
    v_fmac_f32 v217, v101, v236
    v_add_f32_dpp v218, v219, v218 quad_perm:[0,0,2,2] row_mask:0xf bank_mask:0xf
    v_mov_b64 v[224:225], v[216:217]
    v_mov_b32 v226, v218
    v_mov_b32 v231, s82
    v_permlane32_swap_b32 v216, v224
    v_permlane32_swap_b32 v217, v225
    v_permlane32_swap_b32 v218, v226
    v_mov_b64 v[220:221], v[216:217]
    v_mov_b32 v222, v218
    v_mov_b64 v[228:229], v[224:225]
    v_mov_b32 v230, v226

    v_permlane16_swap_b32 v218, v222
    v_permlane16_swap_b32 v216, v220
    v_permlane16_swap_b32 v217, v221
    v_permlane16_swap_b32 v226, v230
    v_fmac_f32_dpp v222, v218, v107 row_ror:8 row_mask:0xf bank_mask:0xf
    v_pk_fma_f32 v[220:221], v[216:217], v[102:103], v[220:221] op_sel_hi:[1,0,1]
    v_permlane16_swap_b32 v224, v228
    v_fmac_f32 v222, v106, v218
    v_pk_fma_f32 v[220:221], v[216:217], v[102:103], v[220:221] op_sel:[1,1,0] op_sel_hi:[0,1,1] neg_lo:[1,0,0]
    v_permlane16_swap_b32 v225, v229
    v_fmac_f32_dpp v226, v222, v107 row_ror:8 row_mask:0xf bank_mask:0xf
    v_fmac_f32 v226, v106, v222
    v_pk_fma_f32 v[224:225], v[220:221], v[102:103], v[224:225] op_sel_hi:[1,0,1]
    v_pk_fma_f32 v[224:225], v[220:221], v[102:103], v[224:225] op_sel:[1,1,0] op_sel_hi:[0,1,1] neg_lo:[1,0,0]
    v_fmac_f32_dpp v230, v226, v107 row_ror:8 row_mask:0xf bank_mask:0xf
    v_fmac_f32 v230, v106, v226
    v_pk_fma_f32 v[228:229], v[224:225], v[102:103], v[228:229] op_sel_hi:[1,0,1]
    v_pk_fma_f32 v[228:229], v[224:225], v[102:103], v[228:229] op_sel:[1,1,0] op_sel_hi:[0,1,1] neg_lo:[1,0,0]
    s_mov_b64 exec, 0xffff
    buffer_store_dwordx4 v[228:231], v153, s[92:95], s21 offen sc1
    s_mov_b64 exec, -1
    s_add_u32 m0, s84, 8192
    s_add_u32 s83, s17, 81920
    buffer_load_dwordx4 v159, s[56:59], s83 offen offset:0 lds
    buffer_load_dwordx4 v159, s[60:63], s83 offen offset:2048 lds
    s_add_u32 s83, s83, 4096
    buffer_load_dwordx4 v159, s[56:59], s83 offen offset:1024 lds
    buffer_load_dwordx4 v159, s[60:63], s83 offen offset:3072 lds
    s_waitcnt vmcnt(9)
    s_mul_i32 s3, s81, 8064
    s_lshl_b32 s4, s80, 7
    s_add_u32 s3, s3, s4
    s_add_u32 s3, s3, 8320
    v_add_u32 v166, s3, v164
    s_mul_i32 s3, s81, 4864
    s_sub_u32 s3, s3, s4
    s_sub_u32 s3, s3, 9344
    v_add_u32 v167, s3, v165
    v_add_u32 v48, 1024, v164
    v_add_u32 v49, 2048, v164
    v_add_u32 v50, 3072, v164
    s_waitcnt lgkmcnt(0)
    s_barrier
    ds_read2_b32 v[60:61], v164 offset0:128 offset1:129
    v_mov_b32 v219, 0
    ds_read2_b32 v[62:63], v164 offset0:130 offset1:131
    s_add_u32 m0, s84, 12288
    s_add_u32 s83, s44, 81920
    s_mov_b32 exec_hi, 0
    buffer_load_dwordx4 v159, s[56:59], s83 offen offset:0 lds
    s_mov_b32 exec_hi, -1
    v_xor_b32 v128, v163, v128
    v_xor_b32 v130, v163, v130
    ds_read_b128 v[64:67], v165 offset:3136
    v_mov_b32_dpp v216, v220 quad_perm:[0,1,2,3] row_mask:4 bank_mask:0xf
    v_mov_b32_dpp v217, v221 quad_perm:[0,1,2,3] row_mask:4 bank_mask:0xf
    ds_read2_b32 v[68:69], v164 offset0:0 offset1:1
    v_mov_b32_dpp v218, v222 quad_perm:[0,1,2,3] row_mask:4 bank_mask:0xf
    v_mov_b32_dpp v216, v224 quad_perm:[0,1,2,3] row_mask:8 bank_mask:0xf
    ds_read2_b32 v[70:71], v164 offset0:2 offset1:3
    v_mov_b32_dpp v217, v225 quad_perm:[0,1,2,3] row_mask:8 bank_mask:0xf
    v_mov_b32_dpp v218, v226 quad_perm:[0,1,2,3] row_mask:8 bank_mask:0xf
    ds_read_b128 v[72:75], v165 offset:2624
    s_mov_b32 exec_hi, 0
    buffer_load_dwordx4 v159, s[60:63], s83 offen offset:2048 lds
    s_mov_b32 exec_hi, -1
    v_mov_b32_dpp v216, v219 quad_perm:[0,1,2,3] row_mask:1 bank_mask:0xf
    v_mov_b32_dpp v217, v219 quad_perm:[0,1,2,3] row_mask:1 bank_mask:0xf
    ds_read_b128 v[76:79], v165 offset:1600
    v_mov_b32_dpp v218, v219 quad_perm:[0,1,2,3] row_mask:1 bank_mask:0xf
    v_mul_f32_dpp v223, -v241, v129 row_ror:8 row_mask:0xf bank_mask:0xf
    ds_read_b128 v[80:83], v165 offset:3648
    v_fma_f32 v223, -v128, v241, v223
    v_mul_f32_dpp v252, -v218, v131 row_ror:8 row_mask:0xf bank_mask:0xf
    ds_read_b128 v[84:87], v165 offset:1088
    v_pk_mul_f32 v[248:249], v[124:125], v[216:217] op_sel_hi:[1,0]
    v_pk_mul_f32 v[250:251], v[124:125], v[216:217] op_sel:[0,1]
    ds_read2_b32 v[88:89], v48 offset0:0 offset1:1
    v_pk_fma_f32 v[248:249], v[126:127], v[216:217], v[248:249] op_sel:[0,1,0] neg_lo:[1,0,0] neg_hi:[1,0,0]
    v_pk_fma_f32 v[250:251], v[126:127], v[216:217], v[250:251] op_sel_hi:[1,0,1]
    s_add_u32 s83, s83, 4096
    s_mov_b32 exec_hi, 0
    buffer_load_dwordx4 v159, s[56:59], s83 offen offset:1024 lds
    s_mov_b32 exec_hi, -1
    ds_read2_b32 v[90:91], v48 offset0:2 offset1:3
    v_fma_f32 v252, -v130, v218, v252
    v_fmac_f32 v249, v124, v236
    ds_read_b128 v[92:95], v165 offset:2112
    v_fmac_f32 v251, v124, v238
    v_fma_f32 v249, -v126, v238, v249
    ds_read2_b32 v[96:97], v49 offset0:0 offset1:1
    v_fmac_f32 v251, v126, v236
    v_mov_b32_dpp v219, v223 quad_perm:[0,0,2,2] row_mask:0xf bank_mask:0xf
    ds_read2_b32 v[98:99], v49 offset0:2 offset1:3
    s_mov_b32 exec_lo, 0xaaaaaaaa
    s_mov_b32 exec_hi, 0xaaaaaaaa
    v_add_f32 v252, v252, v219
    s_mov_b64 exec, -1
    v_lshrrev_b32 v29, 4, v152
    ds_read_b128 v[100:103], v165 offset:576
    s_mov_b32 exec_hi, 0
    buffer_load_dwordx4 v159, s[60:63], s83 offen offset:3072 lds
    s_mov_b32 exec_hi, -1
    v_lshrrev_b32 v159, 5, v152
    v_mul_u32_u24 v159, 5056, v159
    v_add_u32 v159, v158, v159
    v_and_b32 v253, 0xf0, v153
    v_lshl_add_u32 v253, v29, 11, v253
    ds_read2_b32 v[104:105], v48 offset0:128 offset1:129
    v_add_u32 v253, s21, v253
    v_lshlrev_b32 v29, 3, v29
    ds_read2_b32 v[106:107], v48 offset0:130 offset1:131
    v_sub_u32 v29, s79, v29
    v_med3_i32 v29, v29, 0, 8
    ds_read_b128 v[108:111], v165 offset:64
    v_mul_lo_u32 v254, v29, s82
    v_mul_f32_dpp v2, -v208, v129 row_ror:8 row_mask:0xf bank_mask:0xf
    ds_read2_b32 v[112:113], v49 offset0:128 offset1:129
    v_pk_mul_f32 v[0:1], v[176:177], v[126:127] op_sel_hi:[1,0]
    s_add_u32 m0, s84, 0
    s_add_u32 s83, s17, 0
    buffer_load_dwordx4 v158, s[56:59], s83 offen offset:0 lds
    v_pk_mul_f32 v[176:177], v[176:177], v[124:125] op_sel_hi:[1,0]
    ds_read2_b32 v[114:115], v49 offset0:130 offset1:131
    v_pk_fma_f32 v[176:177], v[192:193], v[126:127], v[176:177] op_sel_hi:[1,0,1] neg_lo:[1,0,0] neg_hi:[1,0,0]
    v_pk_fma_f32 v[192:193], v[192:193], v[124:125], v[0:1] op_sel_hi:[1,0,1]
    ds_read2_b32 v[116:117], v50 offset0:0 offset1:1
    v_fma_f32 v208, -v128, v208, v2
    v_mul_f32_dpp v2, -v209, v129 row_ror:8 row_mask:0xf bank_mask:0xf
    ds_read2_b32 v[118:119], v50 offset0:2 offset1:3
    v_pk_mul_f32 v[0:1], v[178:179], v[126:127] op_sel_hi:[1,0]
    v_pk_mul_f32 v[178:179], v[178:179], v[124:125] op_sel_hi:[1,0]
    ds_read2_b32 v[120:121], v50 offset0:128 offset1:129
    v_pk_fma_f32 v[178:179], v[194:195], v[126:127], v[178:179] op_sel_hi:[1,0,1] neg_lo:[1,0,0] neg_hi:[1,0,0]
    v_pk_fma_f32 v[194:195], v[194:195], v[124:125], v[0:1] op_sel_hi:[1,0,1]
    buffer_load_dwordx4 v158, s[60:63], s83 offen offset:2048 lds
    ds_read2_b32 v[122:123], v50 offset0:130 offset1:131
    v_fma_f32 v209, -v128, v209, v2
    v_mul_f32_dpp v2, -v210, v129 row_ror:8 row_mask:0xf bank_mask:0xf
    v_pk_mul_f32 v[0:1], v[180:181], v[126:127] op_sel_hi:[1,0]
    v_pk_mul_f32 v[180:181], v[180:181], v[124:125] op_sel_hi:[1,0]
    v_pk_fma_f32 v[180:181], v[196:197], v[126:127], v[180:181] op_sel_hi:[1,0,1] neg_lo:[1,0,0] neg_hi:[1,0,0]
    v_pk_fma_f32 v[196:197], v[196:197], v[124:125], v[0:1] op_sel_hi:[1,0,1]
    v_fma_f32 v210, -v128, v210, v2
    v_mul_f32_dpp v2, -v211, v129 row_ror:8 row_mask:0xf bank_mask:0xf
    v_pk_mul_f32 v[0:1], v[182:183], v[126:127] op_sel_hi:[1,0]
    v_pk_mul_f32 v[182:183], v[182:183], v[124:125] op_sel_hi:[1,0]
    v_pk_fma_f32 v[182:183], v[198:199], v[126:127], v[182:183] op_sel_hi:[1,0,1] neg_lo:[1,0,0] neg_hi:[1,0,0]
    v_pk_fma_f32 v[198:199], v[198:199], v[124:125], v[0:1] op_sel_hi:[1,0,1]
    s_add_u32 s83, s83, 9216
    buffer_load_dwordx4 v158, s[56:59], s83 offen offset:1024 lds
    v_fma_f32 v211, -v128, v211, v2
    v_mul_f32_dpp v2, -v212, v129 row_ror:8 row_mask:0xf bank_mask:0xf
    v_pk_mul_f32 v[0:1], v[184:185], v[126:127] op_sel_hi:[1,0]
    v_pk_mul_f32 v[184:185], v[184:185], v[124:125] op_sel_hi:[1,0]
    v_pk_fma_f32 v[184:185], v[200:201], v[126:127], v[184:185] op_sel_hi:[1,0,1] neg_lo:[1,0,0] neg_hi:[1,0,0]
    v_pk_fma_f32 v[200:201], v[200:201], v[124:125], v[0:1] op_sel_hi:[1,0,1]
    v_fma_f32 v212, -v128, v212, v2
    v_mul_f32_dpp v2, -v213, v129 row_ror:8 row_mask:0xf bank_mask:0xf
    v_pk_mul_f32 v[0:1], v[186:187], v[126:127] op_sel_hi:[1,0]
    v_pk_mul_f32 v[186:187], v[186:187], v[124:125] op_sel_hi:[1,0]
    v_pk_fma_f32 v[186:187], v[202:203], v[126:127], v[186:187] op_sel_hi:[1,0,1] neg_lo:[1,0,0] neg_hi:[1,0,0]
    v_pk_fma_f32 v[202:203], v[202:203], v[124:125], v[0:1] op_sel_hi:[1,0,1]
    v_fma_f32 v213, -v128, v213, v2
    buffer_load_dwordx4 v158, s[60:63], s83 offen offset:3072 lds
    v_mul_f32_dpp v2, -v214, v129 row_ror:8 row_mask:0xf bank_mask:0xf
    v_pk_mul_f32 v[0:1], v[188:189], v[126:127] op_sel_hi:[1,0]
    v_pk_mul_f32 v[188:189], v[188:189], v[124:125] op_sel_hi:[1,0]
    v_pk_fma_f32 v[188:189], v[204:205], v[126:127], v[188:189] op_sel_hi:[1,0,1] neg_lo:[1,0,0] neg_hi:[1,0,0]
    v_pk_fma_f32 v[204:205], v[204:205], v[124:125], v[0:1] op_sel_hi:[1,0,1]
    v_fma_f32 v214, -v128, v214, v2
    v_mul_f32_dpp v2, -v215, v129 row_ror:8 row_mask:0xf bank_mask:0xf
    v_pk_mul_f32 v[0:1], v[190:191], v[126:127] op_sel_hi:[1,0]
    v_pk_mul_f32 v[190:191], v[190:191], v[124:125] op_sel_hi:[1,0]
    v_pk_fma_f32 v[190:191], v[206:207], v[126:127], v[190:191] op_sel_hi:[1,0,1] neg_lo:[1,0,0] neg_hi:[1,0,0]
    v_pk_fma_f32 v[206:207], v[206:207], v[124:125], v[0:1] op_sel_hi:[1,0,1]
    v_fma_f32 v215, -v128, v215, v2
    v_add_u32 v129, 1024, v166
    v_add_u32 v130, 2048, v166
    v_add_u32 v131, 3072, v166
    s_cmp_lg_u32 s13, 0
    s_cbranch_scc1 Lv_1
    s_waitcnt lgkmcnt(15)
    s_waitcnt lgkmcnt(9)
    v_mfma_f32_16x16x32_bf16 v[44:47], v[68:71], v[100:103], 0
    buffer_load_dwordx4 v[244:247], v253, s[92:95], 0 offen offset:2048 sc1
    v_lshrrev_b32 v29, 4, v152
    v_mul_u32_u24 v29, 640, v29
    v_mfma_f32_16x16x32_bf16 v[32:35], v[60:63], v[72:75], 0
    v_add_u32 v30, v154, v29
    v_add_u32 v31, v155, v29
    s_waitcnt lgkmcnt(2)
    v_mfma_f32_16x16x32_bf16 v[32:35], v[116:119], v[108:111], v[32:35]
    ds_read_b64 v[4:5], v154 offset:9600
    ds_read_b64 v[6:7], v155 offset:9600
    ds_read_b64 v[8:9], v30 offset:5120
    ds_read_b64 v[10:11], v31 offset:5120
    buffer_load_dwordx4 v[240:243], v253, s[92:95], 0 offen offset:1792 sc1
    v_add_u32 v30, v30, v29
    v_add_u32 v31, v31, v29
    v_mfma_f32_16x16x32_bf16 v[32:35], v[68:71], v[64:67], v[32:35]
    v_and_b32 v29, 1, v152
    v_mul_u32_u24 v29, 640, v29
    v_mfma_f32_16x16x32_bf16 v[36:39], v[60:63], v[64:67], 0
    ds_read_b128 v[64:67], v165 offset:3072
    buffer_load_dwordx4 v[236:239], v253, s[92:95], 0 offen offset:1536 sc1
    s_waitcnt vmcnt(16)
    v_add_u32 v31, v31, v29
    v_mfma_f32_16x16x32_bf16 v[36:39], v[88:91], v[72:75], v[36:39]
    ds_read_b128 v[72:75], v165 offset:2560
    ds_read2_b32 v[12:13], v30 offset1:160
    ds_read2_b32 v[14:15], v30 offset0:1 offset1:161
    ds_read_b64 v[16:17], v31 offset:0
    ds_read_b128 a[200:203], v156 offset:4096
    s_waitcnt lgkmcnt(10)
    v_mfma_f32_16x16x32_bf16 v[36:39], v[120:123], v[108:111], v[36:39]
    ds_read2_b32 v[120:121], v50 offset0:144 offset1:145
    ds_read2_b32 v[122:123], v50 offset0:146 offset1:147
    ds_read_b64 v[18:19], v154 offset:7680
    ds_read_b64 v[20:21], v155 offset:7680
    buffer_load_dwordx4 v[232:235], v253, s[92:95], 0 offen offset:1280 sc1
    ds_read_b128 a[204:207], v157 offset:4096
    v_mfma_f32_16x16x32_bf16 v[44:47], v[60:63], v[108:111], v[44:47]
    ds_read2_b32 v[60:61], v164 offset0:144 offset1:145
    ds_read2_b32 v[62:63], v164 offset0:146 offset1:147
    s_add_u32 s6, s100, 71680
    ds_read_b128 a[208:211], v156 offset:4608
    v_bfe_u32 v29, v152, 4, 1
    v_lshlrev_b32 v29, 6, v29
    v_mfma_f32_16x16x32_bf16 v[40:43], v[68:71], v[108:111], 0
    ds_read_b128 v[108:111], v165 offset:0
    buffer_load_dwordx4 v[228:231], v253, s[92:95], 0 offen offset:1024 sc1
    ds_read_b128 a[212:215], v157 offset:4608
    v_xor_b32 v22, v29, v153
    v_add_u32 v22, s6, v22
    v_mfma_f32_16x16x32_bf16 v[36:39], v[68:71], v[80:83], v[36:39]
    ds_read2_b32 v[68:69], v164 offset0:16 offset1:17
    ds_read2_b32 v[70:71], v164 offset0:18 offset1:19
    ds_read_b128 v[80:83], v165 offset:3584
    v_and_b32 v24, 3, v152
    v_lshl_add_u32 v24, v24, 8, s6
    v_mfma_f32_16x16x32_bf16 v[32:35], v[88:91], v[92:95], v[32:35]
    ds_read2_b32 v[88:89], v48 offset0:16 offset1:17
    ds_read2_b32 v[90:91], v48 offset0:18 offset1:19
    buffer_load_dwordx4 v[224:227], v253, s[92:95], 0 offen offset:768 sc1
    v_lshl_add_u32 v24, v29, 1, v24
    v_bfe_u32 v29, v152, 2, 2
    v_mfma_f32_16x16x32_bf16 v[36:39], v[104:107], v[92:95], v[36:39]
    ds_read_b128 v[92:95], v165 offset:2048
    v_lshl_add_u32 v24, v29, 4, v24
    v_lshrrev_b32 v23, 5, v152
    v_mfma_f32_16x16x32_bf16 v[36:39], v[96:99], v[76:79], v[36:39]
    buffer_load_dwordx4 v[220:223], v253, s[92:95], 0 offen offset:512 sc1
    v_lshl_add_u32 v24, v23, 3, v24
    v_and_b32 v29, 1, v152
    v_mfma_f32_16x16x32_bf16 v[32:35], v[104:107], v[76:79], v[32:35]
    ds_read2_b32 v[104:105], v48 offset0:144 offset1:145
    ds_read2_b32 v[106:107], v48 offset0:146 offset1:147
    ds_read_b128 v[76:79], v165 offset:1536
    v_lshl_add_u32 v24, v29, 6, v24
    v_xor_b32 v25, 64, v24
    v_mfma_f32_16x16x32_bf16 v[36:39], v[112:115], v[84:87], v[36:39]
    s_lshl_b32 s3, s77, 10
    s_add_u32 s3, s3, 94016
    buffer_load_dwordx4 v[216:219], v253, s[92:95], 0 offen offset:256 sc1
    v_lshl_add_u32 v26, v29, 2, s3
    v_lshlrev_b32 v28, 5, v29
    v_mfma_f32_16x16x32_bf16 v[32:35], v[96:99], v[84:87], v[32:35]
    ds_read2_b32 v[96:97], v49 offset0:16 offset1:17
    ds_read2_b32 v[98:99], v49 offset0:18 offset1:19
    ds_read_b128 v[84:87], v165 offset:1024
    v_bfe_u32 v29, v152, 1, 3
    v_lshl_add_u32 v26, v29, 5, v26
    v_mfma_f32_16x16x32_bf16 v[36:39], v[116:119], v[100:103], v[36:39]
    ds_read2_b32 v[116:117], v50 offset0:16 offset1:17
    ds_read2_b32 v[118:119], v50 offset0:18 offset1:19
    s_waitcnt lgkmcnt(14)
    s_add_u32 m0, s84, 4096
    s_add_u32 s83, s17, 5120
    buffer_load_dwordx4 v158, s[56:59], s83 offen offset:0 lds
    v_and_b32 v29, 1, v29
    v_lshl_add_u32 v28, v29, 4, v28
    v_mfma_f32_16x16x32_bf16 v[32:35], v[112:115], v[100:103], v[32:35]
    ds_read2_b32 v[112:113], v49 offset0:144 offset1:145
    ds_read2_b32 v[114:115], v49 offset0:146 offset1:147
    ds_read_b128 v[100:103], v165 offset:512
    v_and_b32 v29, 0xc0, v153
    v_add_u32 v28, v29, v28
    v_mfma_f32_16x16x32_bf16 v[32:35], v[60:63], v[72:75], v[32:35]
    v_lshrrev_b32 v29, 4, v152
    v_lshl_add_u32 v26, v29, 3, v26
    s_waitcnt lgkmcnt(15)
    v_mfma_f32_16x16x32_bf16 v[40:43], v[68:71], v[108:111], v[40:43]
    v_lshl_add_u32 v27, v29, 7, s3
    v_lshl_add_u32 v27, v152, 3, v27
    s_waitcnt lgkmcnt(14)
    v_mfma_f32_16x16x32_bf16 v[36:39], v[68:71], v[80:83], v[36:39]
    ds_read_b128 v[80:83], v167 offset:3776
    buffer_load_dwordx4 v158, s[60:63], s83 offen offset:2048 lds
    v_mul_u32_u24 v29, 40960, v29
    v_add_u32 v28, v29, v28
    v_mfma_f32_16x16x32_bf16 v[32:35], v[68:71], v[64:67], v[32:35]
    v_xor_b32 v7, v163, v7
    v_xor_b32 v11, v163, v11
    v_mfma_f32_16x16x32_bf16 v[36:39], v[60:63], v[64:67], v[36:39]
    ds_read_b128 v[64:67], v167 offset:3264
    v_xor_b32 v16, v163, v16
    v_xor_b32 v21, v163, v21
    v_mfma_f32_16x16x32_bf16 v[44:47], v[60:63], v[108:111], v[44:47]
    ds_read2_b32 v[60:61], v166 offset0:128 offset1:129
    ds_read2_b32 v[62:63], v166 offset0:130 offset1:131
    s_lshl_b32 s3, s77, 10
    s_add_u32 s3, s3, 0
    v_add_u32 v170, s3, v153
    s_waitcnt lgkmcnt(15)
    v_mfma_f32_16x16x32_bf16 v[36:39], v[88:91], v[72:75], v[36:39]
    ds_read_b128 v[72:75], v167 offset:2752
    s_add_u32 s83, s83, 9216
    buffer_load_dwordx4 v158, s[56:59], s83 offen offset:1024 lds
    s_waitcnt lgkmcnt(11)
    v_mfma_f32_16x16x32_bf16 v[36:39], v[96:99], v[76:79], v[36:39]
    s_waitcnt lgkmcnt(8)
    v_mfma_f32_16x16x32_bf16 v[32:35], v[116:119], v[108:111], v[32:35]
    s_waitcnt lgkmcnt(5)
    v_mfma_f32_16x16x32_bf16 v[44:47], v[68:71], v[100:103], v[44:47]
    ds_read2_b32 v[68:69], v166 offset0:0 offset1:1
    ds_read2_b32 v[70:71], v166 offset0:2 offset1:3
    v_mfma_f32_16x16x32_bf16 v[32:35], v[104:107], v[76:79], v[32:35]
    ds_read_b128 v[76:79], v167 offset:1728
    buffer_load_dwordx4 v158, s[60:63], s83 offen offset:3072 lds
    v_mfma_f32_16x16x32_bf16 v[32:35], v[96:99], v[84:87], v[32:35]
    ds_read2_b32 v[96:97], v130 offset0:0 offset1:1
    ds_read2_b32 v[98:99], v130 offset0:2 offset1:3
    v_mfma_f32_16x16x32_bf16 v[36:39], v[112:115], v[84:87], v[36:39]
    ds_read_b128 v[84:87], v167 offset:1216
    v_mfma_f32_16x16x32_bf16 v[32:35], v[88:91], v[92:95], v[32:35]
    ds_read2_b32 v[88:89], v129 offset0:0 offset1:1
    ds_read2_b32 v[90:91], v129 offset0:2 offset1:3
    v_mfma_f32_16x16x32_bf16 v[36:39], v[120:123], v[108:111], v[36:39]
    ds_read_b128 v[108:111], v167 offset:192
    ds_read2_b32 v[120:121], v131 offset0:128 offset1:129
    ds_read2_b32 v[122:123], v131 offset0:130 offset1:131
    v_mfma_f32_16x16x32_bf16 v[36:39], v[104:107], v[92:95], v[36:39]
    ds_read_b128 v[92:95], v167 offset:2240
    ds_read2_b32 v[104:105], v129 offset0:128 offset1:129
    ds_read2_b32 v[106:107], v129 offset0:130 offset1:131
    v_mfma_f32_16x16x32_bf16 v[32:35], v[112:115], v[100:103], v[32:35]
    ds_read2_b32 v[112:113], v130 offset0:128 offset1:129
    ds_read2_b32 v[114:115], v130 offset0:130 offset1:131
    v_mfma_f32_16x16x32_bf16 v[36:39], v[116:119], v[100:103], v[36:39]
    ds_read_b128 v[100:103], v167 offset:704
    ds_read2_b32 v[116:117], v131 offset0:0 offset1:1
    ds_read2_b32 v[118:119], v131 offset0:2 offset1:3
    s_branch Lw_2
Lv_1:
    s_waitcnt lgkmcnt(15)
    v_mfma_f32_16x16x32_bf16 v[32:35], v[60:63], v[76:79], 0
    buffer_load_dwordx4 v[244:247], v253, s[92:95], 0 offen offset:2048 sc1
    v_lshrrev_b32 v29, 4, v152
    v_mul_u32_u24 v29, 640, v29
    v_mfma_f32_16x16x32_bf16 v[44:47], v[60:63], v[84:87], 0
    v_add_u32 v30, v154, v29
    v_add_u32 v31, v155, v29
    v_mfma_f32_16x16x32_bf16 v[36:39], v[68:71], v[72:75], 0
    ds_read_b128 v[72:75], v165 offset:2560
    ds_read_b128 v[64:67], v167 offset:3264
    ds_read_b128 v[80:83], v167 offset:3776
    ds_read2_b32 v[116:117], v131 offset0:0 offset1:1
    ds_read2_b32 v[118:119], v131 offset0:2 offset1:3
    ds_read2_b32 v[120:121], v131 offset0:128 offset1:129
    ds_read2_b32 v[122:123], v131 offset0:130 offset1:131
    buffer_load_dwordx4 v[240:243], v253, s[92:95], 0 offen offset:1792 sc1
    v_mfma_f32_16x16x32_bf16 v[44:47], v[68:71], v[76:79], v[44:47]
    ds_read_b64 v[4:5], v154 offset:9600
    ds_read_b64 v[6:7], v155 offset:9600
    ds_read_b64 v[8:9], v30 offset:5120
    ds_read_b64 v[10:11], v31 offset:5120
    v_add_u32 v30, v30, v29
    v_add_u32 v31, v31, v29
    s_waitcnt lgkmcnt(15)
    v_mfma_f32_16x16x32_bf16 v[40:43], v[60:63], v[100:103], 0
    buffer_load_dwordx4 v[236:239], v253, s[92:95], 0 offen offset:1536 sc1
    s_waitcnt vmcnt(16)
    v_and_b32 v29, 1, v152
    v_mul_u32_u24 v29, 640, v29
    v_mfma_f32_16x16x32_bf16 v[36:39], v[60:63], v[92:95], v[36:39]
    ds_read2_b32 v[60:61], v164 offset0:144 offset1:145
    ds_read2_b32 v[62:63], v164 offset0:146 offset1:147
    ds_read_b128 a[200:203], v156 offset:4096
    v_add_u32 v31, v31, v29
    v_mfma_f32_16x16x32_bf16 v[36:39], v[104:107], v[84:87], v[36:39]
    ds_read2_b32 v[12:13], v30 offset1:160
    ds_read2_b32 v[14:15], v30 offset0:1 offset1:161
    ds_read_b64 v[16:17], v31 offset:0
    ds_read_b64 v[18:19], v154 offset:7680
    buffer_load_dwordx4 v[232:235], v253, s[92:95], 0 offen offset:1280 sc1
    ds_read_b128 a[204:207], v157 offset:4096
    v_mfma_f32_16x16x32_bf16 v[40:43], v[68:71], v[84:87], v[40:43]
    ds_read_b64 v[20:21], v155 offset:7680
    s_add_u32 s6, s100, 71680
    ds_read_b128 a[208:211], v156 offset:4608
    v_bfe_u32 v29, v152, 4, 1
    v_lshlrev_b32 v29, 6, v29
    v_mfma_f32_16x16x32_bf16 v[36:39], v[88:91], v[76:79], v[36:39]
    ds_read_b128 v[76:79], v165 offset:1536
    buffer_load_dwordx4 v[228:231], v253, s[92:95], 0 offen offset:1024 sc1
    ds_read_b128 a[212:215], v157 offset:4608
    v_xor_b32 v22, v29, v153
    v_add_u32 v22, s6, v22
    v_mfma_f32_16x16x32_bf16 v[32:35], v[68:71], v[92:95], v[32:35]
    ds_read2_b32 v[68:69], v164 offset0:16 offset1:17
    ds_read2_b32 v[70:71], v164 offset0:18 offset1:19
    ds_read_b128 v[92:95], v165 offset:2048
    v_and_b32 v24, 3, v152
    v_lshl_add_u32 v24, v24, 8, s6
    v_mfma_f32_16x16x32_bf16 v[32:35], v[104:107], v[100:103], v[32:35]
    buffer_load_dwordx4 v[224:227], v253, s[92:95], 0 offen offset:768 sc1
    v_lshl_add_u32 v24, v29, 1, v24
    v_bfe_u32 v29, v152, 2, 2
    v_mfma_f32_16x16x32_bf16 v[40:43], v[88:91], v[108:111], v[40:43]
    v_lshl_add_u32 v24, v29, 4, v24
    v_lshrrev_b32 v23, 5, v152
    v_mfma_f32_16x16x32_bf16 v[32:35], v[88:91], v[84:87], v[32:35]
    ds_read_b128 v[84:87], v165 offset:1024
    buffer_load_dwordx4 v[220:223], v253, s[92:95], 0 offen offset:512 sc1
    v_lshl_add_u32 v24, v23, 3, v24
    v_and_b32 v29, 1, v152
    v_mfma_f32_16x16x32_bf16 v[36:39], v[96:99], v[100:103], v[36:39]
    v_lshl_add_u32 v24, v29, 6, v24
    v_xor_b32 v25, 64, v24
    v_mfma_f32_16x16x32_bf16 v[44:47], v[88:91], v[100:103], v[44:47]
    ds_read2_b32 v[88:89], v48 offset0:16 offset1:17
    ds_read2_b32 v[90:91], v48 offset0:18 offset1:19
    ds_read_b128 v[100:103], v165 offset:512
    s_lshl_b32 s3, s77, 10
    buffer_load_dwordx4 v[216:219], v253, s[92:95], 0 offen offset:256 sc1
    v_mfma_f32_16x16x32_bf16 v[32:35], v[96:99], v[108:111], v[32:35]
    ds_read2_b32 v[96:97], v49 offset0:16 offset1:17
    ds_read2_b32 v[98:99], v49 offset0:18 offset1:19
    s_add_u32 s3, s3, 94016
    v_lshl_add_u32 v26, v29, 2, s3
    v_lshlrev_b32 v28, 5, v29
    v_mfma_f32_16x16x32_bf16 v[36:39], v[112:115], v[108:111], v[36:39]
    ds_read2_b32 v[112:113], v49 offset0:144 offset1:145
    ds_read2_b32 v[114:115], v49 offset0:146 offset1:147
    s_waitcnt lgkmcnt(11)
    s_add_u32 m0, s84, 4096
    s_add_u32 s83, s17, 5120
    buffer_load_dwordx4 v158, s[56:59], s83 offen offset:0 lds
    v_bfe_u32 v29, v152, 1, 3
    v_lshl_add_u32 v26, v29, 5, v26
    v_mfma_f32_16x16x32_bf16 v[44:47], v[104:107], v[108:111], v[44:47]
    ds_read2_b32 v[104:105], v48 offset0:144 offset1:145
    ds_read2_b32 v[106:107], v48 offset0:146 offset1:147
    ds_read_b128 v[108:111], v165 offset:0
    v_and_b32 v29, 1, v29
    v_lshl_add_u32 v28, v29, 4, v28
    v_mfma_f32_16x16x32_bf16 v[32:35], v[60:63], v[76:79], v[32:35]
    v_and_b32 v29, 0xc0, v153
    v_add_u32 v28, v29, v28
    s_waitcnt lgkmcnt(12)
    v_mfma_f32_16x16x32_bf16 v[36:39], v[68:71], v[72:75], v[36:39]
    ds_read_b128 v[72:75], v167 offset:2752
    v_lshrrev_b32 v29, 4, v152
    v_lshl_add_u32 v26, v29, 3, v26
    s_waitcnt lgkmcnt(12)
    v_mfma_f32_16x16x32_bf16 v[32:35], v[68:71], v[92:95], v[32:35]
    buffer_load_dwordx4 v158, s[60:63], s83 offen offset:2048 lds
    v_lshl_add_u32 v27, v29, 7, s3
    v_lshl_add_u32 v27, v152, 3, v27
    v_mfma_f32_16x16x32_bf16 v[36:39], v[60:63], v[92:95], v[36:39]
    ds_read_b128 v[92:95], v167 offset:2240
    v_mul_u32_u24 v29, 40960, v29
    v_add_u32 v28, v29, v28
    s_waitcnt lgkmcnt(12)
    v_mfma_f32_16x16x32_bf16 v[40:43], v[68:71], v[84:87], v[40:43]
    v_xor_b32 v7, v163, v7
    v_xor_b32 v11, v163, v11
    v_mfma_f32_16x16x32_bf16 v[44:47], v[68:71], v[76:79], v[44:47]
    ds_read2_b32 v[68:69], v166 offset0:0 offset1:1
    ds_read2_b32 v[70:71], v166 offset0:2 offset1:3
    v_xor_b32 v16, v163, v16
    v_xor_b32 v21, v163, v21
    s_waitcnt lgkmcnt(12)
    v_mfma_f32_16x16x32_bf16 v[36:39], v[88:91], v[76:79], v[36:39]
    ds_read_b128 v[76:79], v167 offset:1728
    s_lshl_b32 s3, s77, 10
    s_add_u32 s3, s3, 0
    s_add_u32 s83, s83, 9216
    buffer_load_dwordx4 v158, s[56:59], s83 offen offset:1024 lds
    v_add_u32 v170, s3, v153
    v_mfma_f32_16x16x32_bf16 v[44:47], v[60:63], v[84:87], v[44:47]
    s_waitcnt lgkmcnt(12)
    v_mfma_f32_16x16x32_bf16 v[40:43], v[60:63], v[100:103], v[40:43]
    ds_read2_b32 v[60:61], v166 offset0:128 offset1:129
    ds_read2_b32 v[62:63], v166 offset0:130 offset1:131
    v_mfma_f32_16x16x32_bf16 v[44:47], v[88:91], v[100:103], v[44:47]
    s_waitcnt lgkmcnt(8)
    s_waitcnt lgkmcnt(7)
    v_mfma_f32_16x16x32_bf16 v[44:47], v[104:107], v[108:111], v[44:47]
    buffer_load_dwordx4 v158, s[60:63], s83 offen offset:3072 lds
    v_mfma_f32_16x16x32_bf16 v[40:43], v[88:91], v[108:111], v[40:43]
    v_mfma_f32_16x16x32_bf16 v[32:35], v[88:91], v[84:87], v[32:35]
    ds_read2_b32 v[88:89], v129 offset0:0 offset1:1
    ds_read2_b32 v[90:91], v129 offset0:2 offset1:3
    v_mfma_f32_16x16x32_bf16 v[36:39], v[104:107], v[84:87], v[36:39]
    ds_read_b128 v[84:87], v167 offset:1216
    v_mfma_f32_16x16x32_bf16 v[32:35], v[96:99], v[108:111], v[32:35]
    v_mfma_f32_16x16x32_bf16 v[32:35], v[104:107], v[100:103], v[32:35]
    ds_read2_b32 v[104:105], v129 offset0:128 offset1:129
    ds_read2_b32 v[106:107], v129 offset0:130 offset1:131
    v_mfma_f32_16x16x32_bf16 v[36:39], v[112:115], v[108:111], v[36:39]
    ds_read_b128 v[108:111], v167 offset:192
    ds_read2_b32 v[112:113], v130 offset0:128 offset1:129
    ds_read2_b32 v[114:115], v130 offset0:130 offset1:131
    v_mfma_f32_16x16x32_bf16 v[36:39], v[96:99], v[100:103], v[36:39]
    ds_read2_b32 v[96:97], v130 offset0:0 offset1:1
    ds_read2_b32 v[98:99], v130 offset0:2 offset1:3
    ds_read_b128 v[100:103], v167 offset:704
Lw_2:
L_cchk0:
    s_waitcnt vmcnt(10)
    v_fmac_f32_dpp v242, v246, v7 row_ror:8 row_mask:0xf bank_mask:0xf
    v_fmac_f32 v242, v6, v246
    v_pk_fma_f32 v[240:241], v[244:245], v[4:5], v[240:241] op_sel_hi:[1,0,1]
    v_pk_fma_f32 v[240:241], v[244:245], v[4:5], v[240:241] op_sel:[1,1,0] op_sel_hi:[0,1,1] neg_lo:[1,0,0]
    ds_write_b128 v170, v[32:35] offset:0
    s_waitcnt vmcnt(9)
    v_add3_u32 v169, v247, v243, v239
    v_fmac_f32_dpp v238, v242, v7 row_ror:8 row_mask:0xf bank_mask:0xf
    v_fmac_f32 v238, v6, v242
    v_pk_fma_f32 v[236:237], v[240:241], v[4:5], v[236:237] op_sel_hi:[1,0,1]
    v_pk_fma_f32 v[236:237], v[240:241], v[4:5], v[236:237] op_sel:[1,1,0] op_sel_hi:[0,1,1] neg_lo:[1,0,0]
    s_waitcnt vmcnt(8)
    v_fmac_f32_dpp v234, v238, v7 row_ror:8 row_mask:0xf bank_mask:0xf
    v_fmac_f32 v234, v6, v238
    v_pk_fma_f32 v[232:233], v[236:237], v[4:5], v[232:233] op_sel_hi:[1,0,1]
    v_pk_fma_f32 v[232:233], v[236:237], v[4:5], v[232:233] op_sel:[1,1,0] op_sel_hi:[0,1,1] neg_lo:[1,0,0]
    ds_write_b128 v170, v[36:39] offset:4096
    s_waitcnt vmcnt(7)
    v_add3_u32 v169, v169, v235, v231
    v_fmac_f32_dpp v230, v234, v7 row_ror:8 row_mask:0xf bank_mask:0xf
    v_fmac_f32 v230, v6, v234
    v_pk_fma_f32 v[228:229], v[232:233], v[4:5], v[228:229] op_sel_hi:[1,0,1]
    v_pk_fma_f32 v[228:229], v[232:233], v[4:5], v[228:229] op_sel:[1,1,0] op_sel_hi:[0,1,1] neg_lo:[1,0,0]
    s_waitcnt vmcnt(6)
    v_fmac_f32_dpp v226, v230, v7 row_ror:8 row_mask:0xf bank_mask:0xf
    v_fmac_f32 v226, v6, v230
    v_pk_fma_f32 v[224:225], v[228:229], v[4:5], v[224:225] op_sel_hi:[1,0,1]
    v_pk_fma_f32 v[224:225], v[228:229], v[4:5], v[224:225] op_sel:[1,1,0] op_sel_hi:[0,1,1] neg_lo:[1,0,0]
    ds_write_b128 v170, v[40:43] offset:8192
    s_waitcnt vmcnt(5)
    v_add3_u32 v169, v169, v227, v223
    v_fmac_f32_dpp v222, v226, v7 row_ror:8 row_mask:0xf bank_mask:0xf
    v_fmac_f32 v222, v6, v226
    v_pk_fma_f32 v[220:221], v[224:225], v[4:5], v[220:221] op_sel_hi:[1,0,1]
    v_pk_fma_f32 v[220:221], v[224:225], v[4:5], v[220:221] op_sel:[1,1,0] op_sel_hi:[0,1,1] neg_lo:[1,0,0]
    s_waitcnt vmcnt(4)
    v_add_u32 v169, v169, v219
    v_cmp_ne_u32 vcc, v169, v254
    v_fmac_f32_dpp v218, v222, v7 row_ror:8 row_mask:0xf bank_mask:0xf
    v_fmac_f32 v218, v6, v222
    v_pk_fma_f32 v[216:217], v[220:221], v[4:5], v[216:217] op_sel_hi:[1,0,1]
    v_pk_fma_f32 v[216:217], v[220:221], v[4:5], v[216:217] op_sel:[1,1,0] op_sel_hi:[0,1,1] neg_lo:[1,0,0]
    ds_write_b128 v170, v[44:47] offset:12288
    s_cbranch_vccnz L_cre0
    v_mul_f32_dpp v222, v218, v11 row_ror:8 row_mask:0xf bank_mask:0xf
    v_pk_mul_f32 v[220:221], v[216:217], v[8:9] op_sel_hi:[1,0]
    v_fmac_f32 v222, v10, v218
    v_pk_fma_f32 v[220:221], v[216:217], v[8:9], v[220:221] op_sel:[1,1,0] op_sel_hi:[0,1,1] neg_lo:[1,0,0]

    v_mov_b32 v226, v222
    v_mov_b64 v[224:225], v[220:221]
    s_nop 0
    v_permlane32_swap_b32 v222, v226
    v_permlane32_swap_b32 v220, v224
    v_permlane32_swap_b32 v221, v225
    v_add_f32 v222, v222, v226
    v_pk_add_f32 v[220:221], v[220:221], v[224:225]

    v_mov_b32 v226, v222
    v_mov_b64 v[224:225], v[220:221]
    s_nop 0
    v_permlane16_swap_b32 v222, v226
    v_permlane16_swap_b32 v220, v224
    v_permlane16_swap_b32 v221, v225
    v_add_f32 v222, v222, v226
    v_pk_add_f32 v[220:221], v[220:221], v[224:225]

    v_fma_f32 v252, -v16, v222, v252
    v_pk_fma_f32 v[248:249], v[12:13], v[220:221], v[248:249] op_sel_hi:[1,0,1]
    v_pk_fma_f32 v[250:251], v[12:13], v[220:221], v[250:251] op_sel:[0,1,0]
    v_fmac_f32_dpp v252, -v222, v17 row_ror:8 row_mask:0xf bank_mask:0xf
    v_pk_fma_f32 v[248:249], v[14:15], v[220:221], v[248:249] op_sel:[0,1,0] neg_lo:[1,0,0] neg_hi:[1,0,0]
    v_pk_fma_f32 v[250:251], v[14:15], v[220:221], v[250:251] op_sel_hi:[1,0,1]

    v_fmac_f32_dpp v208, -v252, v21 row_ror:8 row_mask:0xf bank_mask:0xf
    v_fmac_f32 v208, v20, v252
    v_pk_fma_f32 v[176:177], v[248:249], v[18:19], v[176:177] op_sel_hi:[1,0,1]
    v_pk_fma_f32 v[192:193], v[250:251], v[18:19], v[192:193] op_sel_hi:[1,0,1]
    v_fmac_f32_dpp v209, -v208, v21 row_ror:8 row_mask:0xf bank_mask:0xf
    v_fmac_f32 v209, v20, v208
    v_pk_fma_f32 v[176:177], v[250:251], v[18:19], v[176:177] op_sel:[0,1,0] neg_lo:[1,0,0] neg_hi:[1,0,0]
    v_pk_fma_f32 v[192:193], v[248:249], v[18:19], v[192:193] op_sel:[0,1,0]
    v_fmac_f32_dpp v210, -v209, v21 row_ror:8 row_mask:0xf bank_mask:0xf
    v_fmac_f32 v210, v20, v209
    v_pk_fma_f32 v[178:179], v[176:177], v[18:19], v[178:179] op_sel_hi:[1,0,1]
    v_pk_fma_f32 v[194:195], v[192:193], v[18:19], v[194:195] op_sel_hi:[1,0,1]
    v_fmac_f32_dpp v211, -v210, v21 row_ror:8 row_mask:0xf bank_mask:0xf
    v_fmac_f32 v211, v20, v210
    v_pk_fma_f32 v[178:179], v[192:193], v[18:19], v[178:179] op_sel:[0,1,0] neg_lo:[1,0,0] neg_hi:[1,0,0]
    v_pk_fma_f32 v[194:195], v[176:177], v[18:19], v[194:195] op_sel:[0,1,0]
    v_cvt_pk_bf16_f32 v232, v176, v177
    v_cvt_pk_bf16_f32 v233, v178, v179
    v_cvt_pk_bf16_f32 v234, -v192, -v193
    v_cvt_pk_bf16_f32 v235, -v194, -v195

    ds_write_b128 v22, v[232:235] offset:0
    ds_read_b64_tr_b16 v[216:217], v24 offset:0
    ds_read_b64_tr_b16 v[218:219], v25 offset:0
    v_fmac_f32_dpp v212, -v211, v21 row_ror:8 row_mask:0xf bank_mask:0xf
    v_fmac_f32 v212, v20, v211
    v_pk_fma_f32 v[180:181], v[178:179], v[18:19], v[180:181] op_sel_hi:[1,0,1]
    v_pk_fma_f32 v[196:197], v[194:195], v[18:19], v[196:197] op_sel_hi:[1,0,1]
    v_fmac_f32_dpp v213, -v212, v21 row_ror:8 row_mask:0xf bank_mask:0xf
    v_fmac_f32 v213, v20, v212
    v_pk_fma_f32 v[180:181], v[194:195], v[18:19], v[180:181] op_sel:[0,1,0] neg_lo:[1,0,0] neg_hi:[1,0,0]
    v_pk_fma_f32 v[196:197], v[178:179], v[18:19], v[196:197] op_sel:[0,1,0]
    v_fmac_f32_dpp v214, -v213, v21 row_ror:8 row_mask:0xf bank_mask:0xf
    v_fmac_f32 v214, v20, v213
    v_pk_fma_f32 v[182:183], v[180:181], v[18:19], v[182:183] op_sel_hi:[1,0,1]
    v_pk_fma_f32 v[198:199], v[196:197], v[18:19], v[198:199] op_sel_hi:[1,0,1]
    v_fmac_f32_dpp v215, -v214, v21 row_ror:8 row_mask:0xf bank_mask:0xf
    v_fmac_f32 v215, v20, v214
    v_pk_fma_f32 v[182:183], v[196:197], v[18:19], v[182:183] op_sel:[0,1,0] neg_lo:[1,0,0] neg_hi:[1,0,0]
    v_pk_fma_f32 v[198:199], v[180:181], v[18:19], v[198:199] op_sel:[0,1,0]
    v_cvt_pk_bf16_f32 v236, v180, v181
    v_cvt_pk_bf16_f32 v237, v182, v183
    v_cvt_pk_bf16_f32 v238, -v196, -v197
    v_cvt_pk_bf16_f32 v239, -v198, -v199

    ds_write_b128 v22, v[236:239] offset:1024
    ds_read_b64_tr_b16 v[220:221], v24 offset:1024
    ds_read_b64_tr_b16 v[222:223], v25 offset:1024
    v_pk_fma_f32 v[184:185], v[182:183], v[18:19], v[184:185] op_sel_hi:[1,0,1]
    v_pk_fma_f32 v[200:201], v[198:199], v[18:19], v[200:201] op_sel_hi:[1,0,1]
    v_pk_fma_f32 v[184:185], v[198:199], v[18:19], v[184:185] op_sel:[0,1,0] neg_lo:[1,0,0] neg_hi:[1,0,0]
    v_pk_fma_f32 v[200:201], v[182:183], v[18:19], v[200:201] op_sel:[0,1,0]
    v_cvt_pk_bf16_f32 v240, v208, v209
    v_cvt_pk_bf16_f32 v241, v210, v211
    v_cvt_pk_bf16_f32 v242, v212, v213
    v_cvt_pk_bf16_f32 v243, v214, v215
    ds_write2st64_b32 v26, v240, v241 offset0:0 offset1:1
    ds_write2st64_b32 v26, v242, v243 offset0:2 offset1:3
    ds_read_b64_tr_b16 v[244:245], v27 offset:0
    ds_read_b64_tr_b16 v[246:247], v27 offset:128
    v_pk_fma_f32 v[186:187], v[184:185], v[18:19], v[186:187] op_sel_hi:[1,0,1]
    v_pk_fma_f32 v[202:203], v[200:201], v[18:19], v[202:203] op_sel_hi:[1,0,1]
    v_pk_fma_f32 v[186:187], v[200:201], v[18:19], v[186:187] op_sel:[0,1,0] neg_lo:[1,0,0] neg_hi:[1,0,0]
    v_pk_fma_f32 v[202:203], v[184:185], v[18:19], v[202:203] op_sel:[0,1,0]
    v_cvt_pk_bf16_f32 v232, v184, v185
    v_cvt_pk_bf16_f32 v233, v186, v187
    v_cvt_pk_bf16_f32 v234, -v200, -v201
    v_cvt_pk_bf16_f32 v235, -v202, -v203

    ds_write_b128 v22, v[232:235] offset:0
    ds_read_b64_tr_b16 v[224:225], v24 offset:0
    ds_read_b64_tr_b16 v[226:227], v25 offset:0
    s_waitcnt lgkmcnt(10)
    v_and_b32 v216, -2, v216
    v_and_b32 v218, -2, v218
    s_cmp_eq_u32 s88, 0
    s_cbranch_scc1 Lss_3
    buffer_store_dwordx4 v[216:219], v153, s[64:67], s36 offen
Lsd_4:
    v_pk_fma_f32 v[188:189], v[186:187], v[18:19], v[188:189] op_sel_hi:[1,0,1]
    v_pk_fma_f32 v[204:205], v[202:203], v[18:19], v[204:205] op_sel_hi:[1,0,1]
    v_pk_fma_f32 v[188:189], v[202:203], v[18:19], v[188:189] op_sel:[0,1,0] neg_lo:[1,0,0] neg_hi:[1,0,0]
    v_pk_fma_f32 v[204:205], v[186:187], v[18:19], v[204:205] op_sel:[0,1,0]
    v_pk_fma_f32 v[190:191], v[188:189], v[18:19], v[190:191] op_sel_hi:[1,0,1]
    v_pk_fma_f32 v[206:207], v[204:205], v[18:19], v[206:207] op_sel_hi:[1,0,1]
    v_pk_fma_f32 v[190:191], v[204:205], v[18:19], v[190:191] op_sel:[0,1,0] neg_lo:[1,0,0] neg_hi:[1,0,0]
    v_pk_fma_f32 v[206:207], v[188:189], v[18:19], v[206:207] op_sel:[0,1,0]
    v_cvt_pk_bf16_f32 v236, v188, v189
    v_cvt_pk_bf16_f32 v237, v190, v191
    v_cvt_pk_bf16_f32 v238, -v204, -v205
    v_cvt_pk_bf16_f32 v239, -v206, -v207

    ds_write_b128 v22, v[236:239] offset:1024
    ds_read_b64_tr_b16 v[228:229], v24 offset:1024
    ds_read_b64_tr_b16 v[230:231], v25 offset:1024
    s_waitcnt lgkmcnt(10)
    v_and_b32 v220, -2, v220
    v_and_b32 v222, -2, v222
    s_cmp_eq_u32 s88, 0
    s_cbranch_scc1 Lss_5
    buffer_store_dwordx4 v[220:223], v153, s[64:67], s18 offen
Lsd_6:
    s_waitcnt lgkmcnt(6)
    v_and_or_b32 v244, v244, -2, v23
    v_and_or_b32 v246, v246, -2, v23
    s_cmp_eq_u32 s88, 0
    s_cbranch_scc1 Lss_7
    buffer_store_dwordx2 v[244:245], v28, s[64:67], s37 offen offset:0
    buffer_store_dwordx2 v[246:247], v28, s[64:67], s37 offen offset:512
Lsd_8:
    s_waitcnt lgkmcnt(3)
    v_or_b32 v224, 1, v224
    v_or_b32 v226, 1, v226
    s_cmp_eq_u32 s88, 0
    s_cbranch_scc1 Lss_9
    buffer_store_dwordx4 v[224:227], v153, s[64:67], s19 offen
Lsd_10:
    s_waitcnt lgkmcnt(0)
    v_or_b32 v228, 1, v228
    v_or_b32 v230, 1, v230
    s_cmp_eq_u32 s88, 0
    s_cbranch_scc1 Lss_11
    buffer_store_dwordx4 v[228:231], v153, s[64:67], s20 offen
Lsd_12:
    v_mfma_f32_16x16x32_bf16 v[28:31], v[60:63], v[64:67], 0
    v_and_b32 v172, 15, v152
    v_lshrrev_b32 v164, 4, v152
    v_mfma_f32_16x16x32_bf16 v[20:23], v[68:71], v[72:75], 0
    s_lshl_b32 s8, s79, 13
    s_and_b32 s7, s91, 31
    s_lshl_b32 s7, s7, 2
    s_add_u32 s8, s8, 11272192
    s_add_u32 s7, s7, s8
    ds_read_b128 a[216:219], v156 offset:8192
    v_lshlrev_b32 v164, 3, v164
    v_lshl_add_u32 v164, v172, 5, v164
    v_mfma_f32_16x16x32_bf16 v[16:19], v[60:63], v[76:79], 0
    ds_read_b128 a[220:223], v157 offset:8192
    v_xor_b32 v172, 8, v164
    v_mov_b32 v169, s7
    v_mfma_f32_16x16x32_bf16 v[12:15], v[68:71], v[76:79], 0
    s_lshl_b32 s6, s77, 12
    s_add_u32 s6, s6, 0
    ds_read_b128 a[224:227], v156 offset:8704
    v_add_u32 v170, s6, v153
    v_mov_b32 v173, s82
    v_mfma_f32_16x16x32_bf16 v[28:31], v[68:71], v[80:83], v[28:31]
    ds_read_b128 v[80:83], v167 offset:3712
    s_add_u32 s3, s40, 26112
    ds_read_b128 a[228:231], v157 offset:8704
    v_add_u32 v171, s3, v172
    v_mfma_f32_16x16x32_bf16 v[8:11], v[68:71], v[84:87], 0
    v_mfma_f32_16x16x32_bf16 v[16:19], v[88:91], v[84:87], v[16:19]
    v_mfma_f32_16x16x32_bf16 v[20:23], v[60:63], v[92:95], v[20:23]
    v_mfma_f32_16x16x32_bf16 v[28:31], v[88:91], v[72:75], v[28:31]
    s_waitcnt lgkmcnt(0)
    s_add_u32 m0, s84, 8192
    s_add_u32 s83, s17, 40960
    buffer_load_dwordx4 v158, s[56:59], s83 offen offset:0 lds
    v_mfma_f32_16x16x32_bf16 v[24:27], v[68:71], v[64:67], 0
    ds_read_b128 v[64:67], v167 offset:3200
    v_mfma_f32_16x16x32_bf16 v[16:19], v[68:71], v[92:95], v[16:19]
    v_mfma_f32_16x16x32_bf16 v[28:31], v[96:99], v[76:79], v[28:31]
    v_mfma_f32_16x16x32_bf16 v[12:15], v[60:63], v[84:87], v[12:15]
    buffer_load_dwordx4 v158, s[60:63], s83 offen offset:2048 lds
    v_mfma_f32_16x16x32_bf16 v[24:27], v[88:91], v[92:95], v[24:27]
    ds_read_b128 a[248:251], v156 offset:12288
    v_mfma_f32_16x16x32_bf16 v[8:11], v[60:63], v[100:103], v[8:11]
    ds_read_b128 a[252:255], v157 offset:12288
    s_barrier
    v_mfma_f32_16x16x32_bf16 v[20:23], v[88:91], v[76:79], v[20:23]
    ds_read_b128 v[32:35], v170 offset:0
    v_mfma_f32_16x16x32_bf16 v[12:15], v[88:91], v[100:103], v[12:15]
    ds_read_b128 v[36:39], v170 offset:1024
    s_add_u32 s83, s83, 9216
    buffer_load_dwordx4 v158, s[56:59], s83 offen offset:1024 lds
    v_mfma_f32_16x16x32_bf16 v[24:27], v[60:63], v[72:75], v[24:27]
    ds_read_b128 v[72:75], v167 offset:2688
    ds_read_b128 v[40:43], v170 offset:2048
    v_mfma_f32_16x16x32_bf16 v[24:27], v[104:107], v[76:79], v[24:27]
    ds_read_b128 v[76:79], v167 offset:1664
    ds_read_b128 v[44:47], v170 offset:3072
    v_mfma_f32_16x16x32_bf16 v[4:7], v[60:63], v[108:111], 0
    ds_read2_b32 v[60:61], v166 offset0:144 offset1:145
    ds_read2_b32 v[62:63], v166 offset0:146 offset1:147
    ds_read_b64 v[48:49], v171
    v_mfma_f32_16x16x32_bf16 v[4:7], v[68:71], v[100:103], v[4:7]
    s_add_u32 s3, s40, s15
    s_add_u32 s3, s3, 3145728
    buffer_load_dwordx4 v158, s[60:63], s83 offen offset:3072 lds
    v_add_u32 v171, s3, v164
    v_and_b32 v57, 8, v164
    v_mfma_f32_16x16x32_bf16 v[0:3], v[68:71], v[108:111], 0
    ds_read2_b32 v[68:69], v166 offset0:16 offset1:17
    ds_read2_b32 v[70:71], v166 offset0:18 offset1:19
    v_and_b32 v164, 0x1f0, v164
    v_lshl_add_u32 v164, v57, 6, v164
    v_mfma_f32_16x16x32_bf16 v[28:31], v[112:115], v[84:87], v[28:31]
    v_mfma_f32_16x16x32_bf16 v[28:31], v[116:119], v[100:103], v[28:31]
    v_mfma_f32_16x16x32_bf16 v[24:27], v[96:99], v[84:87], v[24:27]
    s_waitcnt lgkmcnt(11)
    s_add_u32 m0, s84, 12288
    s_add_u32 s83, s17, 46080
    buffer_load_dwordx4 v158, s[56:59], s83 offen offset:0 lds
    v_mfma_f32_16x16x32_bf16 v[20:23], v[104:107], v[84:87], v[20:23]
    ds_read_b128 v[84:87], v167 offset:1152
    s_waitcnt lgkmcnt(6)
    v_add_f32 v32, v32, v36
    v_add_f32 v33, v33, v37
    v_mfma_f32_16x16x32_bf16 v[8:11], v[88:91], v[108:111], v[8:11]
    ds_read2_b32 v[88:89], v129 offset0:16 offset1:17
    ds_read2_b32 v[90:91], v129 offset0:18 offset1:19
    v_add_f32 v34, v34, v38
    v_add_f32 v35, v35, v39
    v_mfma_f32_16x16x32_bf16 v[28:31], v[104:107], v[92:95], v[28:31]
    ds_read_b128 v[92:95], v167 offset:2176
    v_add_f32 v40, v40, v44
    v_add_f32 v41, v41, v45
    v_mfma_f32_16x16x32_bf16 v[20:23], v[112:115], v[108:111], v[20:23]
    buffer_load_dwordx4 v158, s[60:63], s83 offen offset:2048 lds
    v_add_f32 v42, v42, v46
    v_add_f32 v43, v43, v47
    v_mfma_f32_16x16x32_bf16 v[16:19], v[96:99], v[108:111], v[16:19]
    ds_read_b128 a[232:235], v156 offset:0
    v_add_f32 v32, v32, v40
    v_add_f32 v33, v33, v41
    v_mfma_f32_16x16x32_bf16 v[24:27], v[116:119], v[108:111], v[24:27]
    ds_read2_b32 v[116:117], v131 offset0:16 offset1:17
    ds_read2_b32 v[118:119], v131 offset0:18 offset1:19
    s_waitcnt vmcnt(6)
    s_cmp_eq_u32 s88, 0
    s_cbranch_scc1 Lss_13
    global_store_dword v169, v173, s[50:51]
Lsd_14:
    ds_read_b128 a[236:239], v157 offset:0
    v_add_f32 v34, v34, v42
    v_add_f32 v35, v35, v43
    v_mfma_f32_16x16x32_bf16 v[20:23], v[96:99], v[100:103], v[20:23]
    ds_read2_b32 v[96:97], v130 offset0:16 offset1:17
    ds_read2_b32 v[98:99], v130 offset0:18 offset1:19
    s_waitcnt lgkmcnt(12)
    ds_read_b128 a[240:243], v156 offset:512
    v_and_b32 v36, s86, v49
    v_lshlrev_b32 v37, 16, v49
    v_mfma_f32_16x16x32_bf16 v[16:19], v[104:107], v[100:103], v[16:19]
    s_add_u32 s83, s83, 9216
    buffer_load_dwordx4 v158, s[56:59], s83 offen offset:1024 lds
    ds_read_b128 a[244:247], v157 offset:512
    v_and_b32 v38, s86, v48
    v_lshlrev_b32 v39, 16, v48
    v_mfma_f32_16x16x32_bf16 v[12:15], v[104:107], v[108:111], v[12:15]
    ds_read2_b32 v[104:105], v129 offset0:144 offset1:145
    ds_read2_b32 v[106:107], v129 offset0:146 offset1:147
    v_mul_f32 v36, s35, v36
    v_mul_f32 v37, s35, v37
    v_mfma_f32_16x16x32_bf16 v[24:27], v[112:115], v[100:103], v[24:27]
    ds_read2_b32 v[112:113], v130 offset0:144 offset1:145
    ds_read2_b32 v[114:115], v130 offset0:146 offset1:147
    ds_read_b128 v[100:103], v167 offset:640
    v_mul_f32 v38, s35, v38
    v_mul_f32 v39, s35, v39
    v_mfma_f32_16x16x32_bf16 v[28:31], v[120:123], v[108:111], v[28:31]
    ds_read2_b32 v[120:121], v131 offset0:144 offset1:145
    ds_read2_b32 v[122:123], v131 offset0:146 offset1:147
    ds_read_b128 v[108:111], v167 offset:128
    v_cvt_pk_bf16_f32 v36, 0, v36
    v_cvt_pk_bf16_f32 v37, 0, v37
    v_mfma_f32_16x16x32_bf16 v[28:31], v[60:63], v[64:67], v[28:31]
    buffer_load_dwordx4 v158, s[60:63], s83 offen offset:3072 lds
    v_cvt_pk_bf16_f32 v38, 0, v38
    v_cvt_pk_bf16_f32 v39, 0, v39
    s_waitcnt lgkmcnt(15)
    v_mfma_f32_16x16x32_bf16 v[20:23], v[68:71], v[72:75], v[20:23]
    v_cvt_pk_bf16_f32 v32, 0, v32
    v_cvt_pk_bf16_f32 v33, 0, v33
    v_mfma_f32_16x16x32_bf16 v[16:19], v[60:63], v[76:79], v[16:19]
    v_cvt_pk_bf16_f32 v34, 0, v34
    v_cvt_pk_bf16_f32 v35, 0, v35
    v_mfma_f32_16x16x32_bf16 v[12:15], v[68:71], v[76:79], v[12:15]
    v_add_f32 v32, v32, v36
    v_add_f32 v33, v33, v37
    v_mfma_f32_16x16x32_bf16 v[28:31], v[68:71], v[80:83], v[28:31]
    ds_read_b128 v[80:83], v167 offset:3648
    s_waitcnt lgkmcnt(9)
    s_add_u32 m0, s84, 0
    s_add_u32 s83, s44, 0
    buffer_load_dwordx4 v159, s[56:59], s83 offen offset:0 lds
    v_add_f32 v34, v34, v38
    v_add_f32 v35, v35, v39
    v_mfma_f32_16x16x32_bf16 v[8:11], v[68:71], v[84:87], v[8:11]
    v_cvt_pk_bf16_f32 v58, v32, v33
    v_cvt_pk_bf16_f32 v59, v34, v35
    v_mfma_f32_16x16x32_bf16 v[16:19], v[88:91], v[84:87], v[16:19]
    global_store_dwordx2 v171, v[58:59], s[50:51] sc1
    v_and_b32 v173, 31, v152
    v_lshl_add_u32 v173, v173, 2, s8
    v_mfma_f32_16x16x32_bf16 v[20:23], v[60:63], v[92:95], v[20:23]
    s_mul_i32 s3, s81, 4608
    s_lshl_b32 s4, s80, 10
    s_add_u32 s3, s3, 16896
    v_mfma_f32_16x16x32_bf16 v[28:31], v[88:91], v[72:75], v[28:31]
    buffer_load_dwordx4 v159, s[60:63], s83 offen offset:2048 lds
    s_add_u32 s9, s3, s4
    v_mfma_f32_16x16x32_bf16 v[24:27], v[68:71], v[64:67], v[24:27]
    ds_read_b128 v[64:67], v167 offset:3136
    ds_read_b128 v[176:179], v156 offset:4096
    s_sub_u32 s3, s3, s4
    v_add_u32 v57, s9, v172
    v_add_u32 v171, s3, v172
    v_mfma_f32_16x16x32_bf16 v[16:19], v[68:71], v[92:95], v[16:19]
    ds_read_b128 v[180:183], v157 offset:4096
    ds_read_b64 v[44:45], v57 offset:0
    ds_read_b64 v[46:47], v57 offset:512
    v_mfma_f32_16x16x32_bf16 v[28:31], v[96:99], v[76:79], v[28:31]
    ds_read_b128 v[184:187], v156 offset:4608
    ds_read_b64 v[48:49], v171 offset:3072
    ds_read_b64 v[50:51], v171 offset:3584
    v_add_u32 v170, 65536, v170
    v_xor_b32 v171, 0x1000, v170
    v_mfma_f32_16x16x32_bf16 v[12:15], v[60:63], v[84:87], v[12:15]
    s_add_u32 s83, s83, 9216
    buffer_load_dwordx4 v159, s[56:59], s83 offen offset:1024 lds
    ds_read_b128 v[188:191], v157 offset:4608
    v_mfma_f32_16x16x32_bf16 v[24:27], v[88:91], v[92:95], v[24:27]
    s_mul_i32 s3, s79, 163840
    s_mul_i32 s4, s77, 10240
    s_add_u32 s3, s3, s4
    v_add_u32 v175, s3, v153
    s_waitcnt lgkmcnt(13)
    v_mfma_f32_16x16x32_bf16 v[8:11], v[60:63], v[100:103], v[8:11]
    s_waitcnt lgkmcnt(4)
    v_and_b32 v52, s86, v45
    v_lshlrev_b32 v53, 16, v45
    v_mfma_f32_16x16x32_bf16 v[20:23], v[88:91], v[76:79], v[20:23]
    v_and_b32 v54, s86, v44
    v_lshlrev_b32 v55, 16, v44
    v_mfma_f32_16x16x32_bf16 v[12:15], v[88:91], v[100:103], v[12:15]
    buffer_load_dwordx4 v159, s[60:63], s83 offen offset:3072 lds
    v_and_b32 v56, s86, v47
    v_lshlrev_b32 v57, 16, v47
    v_mfma_f32_16x16x32_bf16 v[24:27], v[60:63], v[72:75], v[24:27]
    ds_read_b128 v[72:75], v167 offset:2624
    v_and_b32 v58, s86, v46
    v_lshlrev_b32 v59, 16, v46
    v_mfma_f32_16x16x32_bf16 v[24:27], v[104:107], v[76:79], v[24:27]
    ds_read_b128 v[76:79], v167 offset:1600
    v_mul_f32 v52, s34, v52
    v_mul_f32 v53, s34, v53
    v_mfma_f32_16x16x32_bf16 v[4:7], v[60:63], v[108:111], v[4:7]
    ds_read2_b32 v[60:61], v166 offset0:160 offset1:161
    ds_read2_b32 v[62:63], v166 offset0:162 offset1:163
    v_mul_f32 v54, s34, v54
    v_mul_f32 v55, s34, v55
    v_mfma_f32_16x16x32_bf16 v[4:7], v[68:71], v[100:103], v[4:7]
    s_waitcnt lgkmcnt(4)
    s_add_u32 m0, s84, 4096
    s_add_u32 s83, s44, 40960
    buffer_load_dwordx4 v159, s[56:59], s83 offen offset:0 lds
    v_mul_f32 v56, s34, v56
    v_mul_f32 v57, s34, v57
    v_mfma_f32_16x16x32_bf16 v[0:3], v[68:71], v[108:111], v[0:3]
    ds_read2_b32 v[68:69], v166 offset0:32 offset1:33
    ds_read2_b32 v[70:71], v166 offset0:34 offset1:35
    v_mul_f32 v58, s34, v58
    v_mul_f32 v59, s34, v59
    v_mfma_f32_16x16x32_bf16 v[28:31], v[112:115], v[84:87], v[28:31]
    v_cvt_pk_bf16_f32 v52, 0, v52
    v_cvt_pk_bf16_f32 v53, 0, v53
    v_mfma_f32_16x16x32_bf16 v[28:31], v[116:119], v[100:103], v[28:31]
    v_cvt_pk_bf16_f32 v54, 0, v54
    v_cvt_pk_bf16_f32 v55, 0, v55
    v_mfma_f32_16x16x32_bf16 v[24:27], v[96:99], v[84:87], v[24:27]
    buffer_load_dwordx4 v159, s[60:63], s83 offen offset:2048 lds
    s_waitcnt vmcnt(12)
    v_cvt_pk_bf16_f32 v56, 0, v56
    v_cvt_pk_bf16_f32 v57, 0, v57
    v_mfma_f32_16x16x32_bf16 v[20:23], v[104:107], v[84:87], v[20:23]
    ds_read_b128 v[84:87], v167 offset:1088
    ds_read_b128 v[192:195], v156 offset:8192
    v_cvt_pk_bf16_f32 v58, 0, v58
    v_cvt_pk_bf16_f32 v59, 0, v59
    v_mfma_f32_16x16x32_bf16 v[8:11], v[88:91], v[108:111], v[8:11]
    ds_read2_b32 v[88:89], v129 offset0:32 offset1:33
    ds_read2_b32 v[90:91], v129 offset0:34 offset1:35
    ds_read_b128 v[196:199], v157 offset:8192
    v_mfma_f32_16x16x32_bf16 v[28:31], v[104:107], v[92:95], v[28:31]
    ds_read_b128 v[92:95], v167 offset:2112
    ds_read_b128 v[200:203], v156 offset:8704
    v_and_b32 v32, s86, v49
    v_lshlrev_b32 v33, 16, v49
    v_mfma_f32_16x16x32_bf16 v[20:23], v[112:115], v[108:111], v[20:23]
    s_add_u32 s83, s83, 9216
    buffer_load_dwordx4 v159, s[56:59], s83 offen offset:1024 lds
    ds_read_b128 v[204:207], v157 offset:8704
    v_and_b32 v34, s86, v48
    v_lshlrev_b32 v35, 16, v48
    v_mfma_f32_16x16x32_bf16 v[16:19], v[96:99], v[108:111], v[16:19]
    global_load_dword v169, v173, s[50:51] sc1
    v_and_b32 v36, s86, v51
    v_lshlrev_b32 v37, 16, v51
    v_mfma_f32_16x16x32_bf16 v[24:27], v[116:119], v[108:111], v[24:27]
    ds_read2_b32 v[116:117], v131 offset0:32 offset1:33
    ds_read2_b32 v[118:119], v131 offset0:34 offset1:35
    v_and_b32 v38, s86, v50
    v_lshlrev_b32 v39, 16, v50
    v_mfma_f32_16x16x32_bf16 v[20:23], v[96:99], v[100:103], v[20:23]
    ds_read2_b32 v[96:97], v130 offset0:32 offset1:33
    ds_read2_b32 v[98:99], v130 offset0:34 offset1:35
    v_mul_f32 v32, s34, v32
    v_mul_f32 v33, s34, v33
    v_mfma_f32_16x16x32_bf16 v[16:19], v[104:107], v[100:103], v[16:19]
    buffer_load_dwordx4 v159, s[60:63], s83 offen offset:3072 lds
    v_mul_f32 v34, s34, v34
    v_mul_f32 v35, s34, v35
    v_mfma_f32_16x16x32_bf16 v[12:15], v[104:107], v[108:111], v[12:15]
    ds_read2_b32 v[104:105], v129 offset0:160 offset1:161
    ds_read2_b32 v[106:107], v129 offset0:162 offset1:163
    v_mul_f32 v36, s34, v36
    v_mul_f32 v37, s34, v37
    v_mfma_f32_16x16x32_bf16 v[24:27], v[112:115], v[100:103], v[24:27]
    ds_read2_b32 v[112:113], v130 offset0:160 offset1:161
    ds_read2_b32 v[114:115], v130 offset0:162 offset1:163
    ds_read_b128 v[100:103], v167 offset:576
    v_mul_f32 v38, s34, v38
    v_mul_f32 v39, s34, v39
    v_mfma_f32_16x16x32_bf16 v[28:31], v[120:123], v[108:111], v[28:31]
    ds_read2_b32 v[120:121], v131 offset0:160 offset1:161
    ds_read2_b32 v[122:123], v131 offset0:162 offset1:163
    ds_read_b128 v[108:111], v167 offset:64
    v_cvt_pk_bf16_f32 v32, 0, v32
    v_cvt_pk_bf16_f32 v33, 0, v33
    s_waitcnt lgkmcnt(15)
    v_mfma_f32_16x16x32_bf16 v[28:31], v[60:63], v[64:67], v[28:31]
    s_waitcnt lgkmcnt(12)
    s_add_u32 m0, s84, 8192
    s_add_u32 s83, s16, 40960
    buffer_load_dwordx4 v158, s[56:59], s83 offen offset:0 lds
    v_cvt_pk_bf16_f32 v34, 0, v34
    v_cvt_pk_bf16_f32 v35, 0, v35
    v_mfma_f32_16x16x32_bf16 v[20:23], v[68:71], v[72:75], v[20:23]
    v_cvt_pk_bf16_f32 v36, 0, v36
    v_cvt_pk_bf16_f32 v37, 0, v37
    v_mfma_f32_16x16x32_bf16 v[16:19], v[60:63], v[76:79], v[16:19]
    v_cvt_pk_bf16_f32 v38, 0, v38
    v_cvt_pk_bf16_f32 v39, 0, v39
    v_mfma_f32_16x16x32_bf16 v[12:15], v[68:71], v[76:79], v[12:15]
    s_mov_b32 s9, 40960
    v_mfma_f32_16x16x32_bf16 v[28:31], v[68:71], v[80:83], v[28:31]
    ds_read_b128 v[80:83], v167 offset:3584
    buffer_load_dwordx4 v158, s[60:63], s83 offen offset:2048 lds
    s_waitcnt vmcnt(12)
    v_mfma_f32_16x16x32_bf16 v[8:11], v[68:71], v[84:87], v[8:11]
    ds_read_b128 v[208:211], v156 offset:12288
    v_mfma_f32_16x16x32_bf16 v[16:19], v[88:91], v[84:87], v[16:19]
    ds_read_b128 v[212:215], v157 offset:12288
    v_mfma_f32_16x16x32_bf16 v[20:23], v[60:63], v[92:95], v[20:23]
    ds_read_b128 v[216:219], v156 offset:12800
    s_mul_i32 s5, s77, 40960
    v_mfma_f32_16x16x32_bf16 v[28:31], v[88:91], v[72:75], v[28:31]
    s_add_u32 s83, s83, 9216
    buffer_load_dwordx4 v158, s[56:59], s83 offen offset:1024 lds
    ds_read_b128 v[220:223], v157 offset:12800
    v_mfma_f32_16x16x32_bf16 v[24:27], v[68:71], v[64:67], v[24:27]
    ds_read_b128 v[64:67], v167 offset:3072
    s_lshl_b32 s22, s16, 5
    v_mfma_f32_16x16x32_bf16 v[16:19], v[68:71], v[92:95], v[16:19]
    s_add_u32 s22, s22, s5
    s_waitcnt lgkmcnt(14)
    v_mfma_f32_16x16x32_bf16 v[28:31], v[96:99], v[76:79], v[28:31]
    s_lshl_b32 s23, s17, 5
    s_add_u32 s23, s23, s5
    v_mfma_f32_16x16x32_bf16 v[12:15], v[60:63], v[84:87], v[12:15]
    buffer_load_dwordx4 v158, s[60:63], s83 offen offset:3072 lds
    s_lshl_b32 s24, s44, 5
    v_mfma_f32_16x16x32_bf16 v[24:27], v[88:91], v[92:95], v[24:27]
    s_add_u32 s24, s24, s5
    s_waitcnt lgkmcnt(9)
    v_mfma_f32_16x16x32_bf16 v[8:11], v[60:63], v[100:103], v[8:11]
    s_cmp_eq_u32 s77, 3
    s_cselect_b32 s5, -122880, s9
    v_mfma_f32_16x16x32_bf16 v[20:23], v[88:91], v[76:79], v[20:23]
    s_add_u32 s25, s22, s5
    s_add_u32 s26, s23, s5
    v_mfma_f32_16x16x32_bf16 v[12:15], v[88:91], v[100:103], v[12:15]
    s_waitcnt lgkmcnt(1)
    s_add_u32 m0, s84, 12288
    s_add_u32 s83, s16, 46080
    buffer_load_dwordx4 v158, s[56:59], s83 offen offset:0 lds
    v_mfma_f32_16x16x32_bf16 v[24:27], v[60:63], v[72:75], v[24:27]
    ds_read_b128 v[72:75], v167 offset:2560
    v_mfma_f32_16x16x32_bf16 v[24:27], v[104:107], v[76:79], v[24:27]
    ds_read_b128 v[76:79], v167 offset:1536
    v_mfma_f32_16x16x32_bf16 v[4:7], v[60:63], v[108:111], v[4:7]
    ds_read2_b32 v[60:61], v166 offset0:176 offset1:177
    ds_read2_b32 v[62:63], v166 offset0:178 offset1:179
    v_mfma_f32_16x16x32_bf16 v[4:7], v[68:71], v[100:103], v[4:7]
    buffer_load_dwordx4 v158, s[60:63], s83 offen offset:2048 lds
    s_add_u32 s27, s24, s5
    v_mfma_f32_16x16x32_bf16 v[0:3], v[68:71], v[108:111], v[0:3]
    ds_read2_b32 v[68:69], v166 offset0:48 offset1:49
    ds_read2_b32 v[70:71], v166 offset0:50 offset1:51
    v_mfma_f32_16x16x32_bf16 v[28:31], v[112:115], v[84:87], v[28:31]
    v_mfma_f32_16x16x32_bf16 v[28:31], v[116:119], v[100:103], v[28:31]
    s_cmp_eq_u32 s77, 2
    s_cselect_b32 s5, -122880, s9
    v_mfma_f32_16x16x32_bf16 v[24:27], v[96:99], v[84:87], v[24:27]
    s_add_u32 s83, s83, 9216
    buffer_load_dwordx4 v158, s[56:59], s83 offen offset:1024 lds
    v_mfma_f32_16x16x32_bf16 v[20:23], v[104:107], v[84:87], v[20:23]
    ds_read_b128 v[84:87], v167 offset:1024
    s_add_u32 s28, s25, s5
    v_mfma_f32_16x16x32_bf16 v[8:11], v[88:91], v[108:111], v[8:11]
    ds_read2_b32 v[88:89], v129 offset0:48 offset1:49
    ds_read2_b32 v[90:91], v129 offset0:50 offset1:51
    v_mfma_f32_16x16x32_bf16 v[28:31], v[104:107], v[92:95], v[28:31]
    ds_read_b128 v[92:95], v167 offset:2048
    s_add_u32 s29, s26, s5
    v_mfma_f32_16x16x32_bf16 v[20:23], v[112:115], v[108:111], v[20:23]
    buffer_load_dwordx4 v158, s[60:63], s83 offen offset:3072 lds
    s_add_u32 s30, s27, s5
    v_mfma_f32_16x16x32_bf16 v[16:19], v[96:99], v[108:111], v[16:19]
    s_cmp_eq_u32 s77, 1
    s_cselect_b32 s5, -122880, s9
    v_mfma_f32_16x16x32_bf16 v[24:27], v[116:119], v[108:111], v[24:27]
    ds_read2_b32 v[116:117], v131 offset0:48 offset1:49
    ds_read2_b32 v[118:119], v131 offset0:50 offset1:51
    v_mfma_f32_16x16x32_bf16 v[20:23], v[96:99], v[100:103], v[20:23]
    ds_read2_b32 v[96:97], v130 offset0:48 offset1:49
    ds_read2_b32 v[98:99], v130 offset0:50 offset1:51
    v_mfma_f32_16x16x32_bf16 v[16:19], v[104:107], v[100:103], v[16:19]
    s_add_u32 s31, s28, s5
    s_add_u32 s32, s29, s5
    v_mfma_f32_16x16x32_bf16 v[12:15], v[104:107], v[108:111], v[12:15]
    ds_read2_b32 v[104:105], v129 offset0:176 offset1:177
    ds_read2_b32 v[106:107], v129 offset0:178 offset1:179
    v_mfma_f32_16x16x32_bf16 v[24:27], v[112:115], v[100:103], v[24:27]
    ds_read2_b32 v[112:113], v130 offset0:176 offset1:177
    ds_read2_b32 v[114:115], v130 offset0:178 offset1:179
    ds_read_b128 v[100:103], v167 offset:512
    v_mfma_f32_16x16x32_bf16 v[28:31], v[120:123], v[108:111], v[28:31]
    ds_read2_b32 v[120:121], v131 offset0:176 offset1:177
    ds_read2_b32 v[122:123], v131 offset0:178 offset1:179
    ds_read_b128 v[108:111], v167 offset:0
    s_add_u32 s33, s30, s5
    s_getpc_b64 s[4:5]
L_pc2:
    s_lshr_b32 s3, s2, 3
    s_lshl_b32 s3, s3, 2
    s_add_u32 s3, s3, s77
    s_lshl_b32 s3, s3, 8
    v_and_b32 v168, 1, v152
    v_lshl_add_u32 v168, v168, 7, s3
    v_min_u32 v168, L_last-L_pc2, v168
    global_load_dword v168, v168, s[4:5]
    s_cmp_lg_u32 s80, 0
    s_cbranch_scc1 Lv_15
    s_waitcnt lgkmcnt(15)
    v_mfma_f32_16x16x32_bf16 v[16:19], v[60:63], v[76:79], v[16:19]
    s_waitcnt vmcnt(14)
    v_mfma_f32_16x16x32_bf16 v[20:23], v[68:71], v[72:75], v[20:23]
    ds_read_b128 v[224:227], v156 offset:0
    v_mfma_f32_16x16x32_bf16 v[12:15], v[68:71], v[76:79], v[12:15]
    ds_read_b128 v[232:235], v156 offset:512
    v_mfma_f32_16x16x32_bf16 v[12:15], v[60:63], v[84:87], v[12:15]
    ds_read_b128 v[228:231], v157 offset:0
    s_waitcnt lgkmcnt(15)
    v_mfma_f32_16x16x32_bf16 v[20:23], v[88:91], v[76:79], v[20:23]
    ds_read_b128 v[236:239], v157 offset:512
    v_mfma_f32_16x16x32_bf16 v[20:23], v[60:63], v[92:95], v[20:23]
    v_mfma_f32_16x16x32_bf16 v[8:11], v[68:71], v[84:87], v[8:11]
    v_mfma_f32_16x16x32_bf16 v[16:19], v[88:91], v[84:87], v[16:19]
    s_waitcnt lgkmcnt(0)
    s_add_u32 m0, s84, 0
    s_add_u32 s83, s16, 0
    buffer_load_dwordx4 v158, s[56:59], s83 offen offset:0 lds
    v_mfma_f32_16x16x32_bf16 v[16:19], v[68:71], v[92:95], v[16:19]
    v_mfma_f32_16x16x32_bf16 v[20:23], v[104:107], v[84:87], v[20:23]
    v_mfma_f32_16x16x32_bf16 v[20:23], v[96:99], v[100:103], v[20:23]
    v_mfma_f32_16x16x32_bf16 v[16:19], v[104:107], v[100:103], v[16:19]
    buffer_load_dwordx4 v158, s[60:63], s83 offen offset:2048 lds
    s_waitcnt vmcnt(11)
    v_mfma_f32_16x16x32_bf16 v[8:11], v[60:63], v[100:103], v[8:11]
    ds_read_b128 v[240:243], v156 offset:4096
L_fh0:
    v_cmp_ne_u32 vcc, s82, v169
    s_cbranch_vccnz L_fh_re0
    v_mfma_f32_16x16x32_bf16 v[16:19], v[96:99], v[108:111], v[16:19]
    ds_read_b128 v[248:251], v156 offset:4608
    v_mfma_f32_16x16x32_bf16 v[12:15], v[88:91], v[100:103], v[12:15]
    ds_read_b128 v[244:247], v157 offset:4096
    buffer_load_dwordx4 v[40:43], v175, s[64:67], s23 offen offset:0 sc1
    v_mfma_f32_16x16x32_bf16 v[8:11], v[88:91], v[108:111], v[8:11]
    s_add_u32 s83, s83, 9216
    buffer_load_dwordx4 v158, s[56:59], s83 offen offset:1024 lds
    ds_read_b128 v[252:255], v157 offset:4608
    v_mfma_f32_16x16x32_bf16 v[12:15], v[104:107], v[108:111], v[12:15]
    ds_write_b128 v170, v[16:19] offset:2048
    buffer_load_dwordx4 v[44:47], v175, s[64:67], s23 offen offset:1024 sc1
    v_mfma_f32_16x16x32_bf16 v[20:23], v[112:115], v[108:111], v[20:23]
    v_mfma_f32_16x16x32_bf16 v[28:31], v[120:123], v[108:111], v[28:31]
    ds_write_b128 v170, v[8:11] offset:0
    buffer_load_dwordx4 v[48:51], v175, s[64:67], s23 offen offset:2048 sc1
    v_mfma_f32_16x16x32_bf16 v[28:31], v[68:71], v[80:83], v[28:31]
    s_nop 0
    ds_write_b128 v170, v[12:15] offset:1024
    buffer_load_dwordx4 v158, s[60:63], s83 offen offset:3072 lds
    v_mfma_f32_16x16x32_bf16 v[24:27], v[116:119], v[108:111], v[24:27]
    ds_write_b128 v170, v[20:23] offset:3072
    buffer_load_dwordx4 v[120:123], v175, s[64:67], s22 offen offset:0 sc1
    v_mfma_f32_16x16x32_bf16 v[28:31], v[116:119], v[100:103], v[28:31]
    v_mfma_f32_16x16x32_bf16 v[24:27], v[68:71], v[64:67], v[24:27]
    v_mfma_f32_16x16x32_bf16 v[28:31], v[60:63], v[64:67], v[28:31]
    s_waitcnt lgkmcnt(4)
    s_add_u32 m0, s84, 4096
    s_add_u32 s83, s16, 5120
    buffer_load_dwordx4 v158, s[56:59], s83 offen offset:0 lds
    buffer_load_dwordx4 v[80:83], v175, s[64:67], s25 offen offset:0 sc1
    v_mfma_f32_16x16x32_bf16 v[0:3], v[68:71], v[108:111], v[0:3]
    v_mfma_f32_16x16x32_bf16 v[4:7], v[68:71], v[100:103], v[4:7]
    v_mfma_f32_16x16x32_bf16 v[4:7], v[60:63], v[108:111], v[4:7]
    buffer_load_dwordx4 v[116:119], v175, s[64:67], s28 offen offset:0 sc1
    v_mfma_f32_16x16x32_bf16 v[24:27], v[112:115], v[100:103], v[24:27]
    buffer_load_dwordx4 v158, s[60:63], s83 offen offset:2048 lds
    v_mfma_f32_16x16x32_bf16 v[24:27], v[60:63], v[72:75], v[24:27]
    v_mfma_f32_16x16x32_bf16 v[28:31], v[112:115], v[84:87], v[28:31]
    buffer_load_dwordx4 v[64:67], v175, s[64:67], s31 offen offset:0 sc1
    s_waitcnt lgkmcnt(0)
    s_barrier
    v_mfma_f32_16x16x32_bf16 v[28:31], v[88:91], v[72:75], v[28:31]
    ds_read_b128 v[8:11], v171 offset:0
    v_mfma_f32_16x16x32_bf16 v[24:27], v[96:99], v[84:87], v[24:27]
    ds_read_b128 v[12:15], v171 offset:1024
    s_add_u32 s83, s83, 9216
    buffer_load_dwordx4 v158, s[56:59], s83 offen offset:1024 lds
    v_mfma_f32_16x16x32_bf16 v[24:27], v[88:91], v[92:95], v[24:27]
    ds_read_b128 v[16:19], v171 offset:2048
    v_mfma_f32_16x16x32_bf16 v[24:27], v[104:107], v[76:79], v[24:27]
    ds_read_b128 v[20:23], v171 offset:3072
    v_mfma_f32_16x16x32_bf16 v[28:31], v[96:99], v[76:79], v[28:31]
    v_mfma_f32_16x16x32_bf16 v[28:31], v[104:107], v[92:95], v[28:31]
    buffer_load_dwordx4 v158, s[60:63], s83 offen offset:3072 lds
    s_branch Lw_16
Lv_15:
    s_waitcnt lgkmcnt(15)
    v_mfma_f32_16x16x32_bf16 v[24:27], v[68:71], v[64:67], v[24:27]
    s_waitcnt vmcnt(14)
    v_mfma_f32_16x16x32_bf16 v[28:31], v[60:63], v[64:67], v[28:31]
    ds_read_b128 v[224:227], v156 offset:0
    v_mfma_f32_16x16x32_bf16 v[24:27], v[60:63], v[72:75], v[24:27]
    ds_read_b128 v[232:235], v156 offset:512
    v_mfma_f32_16x16x32_bf16 v[28:31], v[68:71], v[80:83], v[28:31]
    ds_read_b128 v[228:231], v157 offset:0
    s_waitcnt lgkmcnt(15)
    v_mfma_f32_16x16x32_bf16 v[28:31], v[88:91], v[72:75], v[28:31]
    ds_read_b128 v[236:239], v157 offset:512
    v_mfma_f32_16x16x32_bf16 v[24:27], v[88:91], v[92:95], v[24:27]
    s_waitcnt lgkmcnt(12)
    v_mfma_f32_16x16x32_bf16 v[28:31], v[96:99], v[76:79], v[28:31]
    v_mfma_f32_16x16x32_bf16 v[24:27], v[96:99], v[84:87], v[24:27]
    s_waitcnt lgkmcnt(0)
    s_add_u32 m0, s84, 0
    s_add_u32 s83, s16, 0
    buffer_load_dwordx4 v158, s[56:59], s83 offen offset:0 lds
    v_mfma_f32_16x16x32_bf16 v[24:27], v[104:107], v[76:79], v[24:27]
    v_mfma_f32_16x16x32_bf16 v[28:31], v[104:107], v[92:95], v[28:31]
    v_mfma_f32_16x16x32_bf16 v[4:7], v[68:71], v[100:103], v[4:7]
    v_mfma_f32_16x16x32_bf16 v[28:31], v[116:119], v[100:103], v[28:31]
    buffer_load_dwordx4 v158, s[60:63], s83 offen offset:2048 lds
    s_waitcnt vmcnt(11)
    v_mfma_f32_16x16x32_bf16 v[4:7], v[60:63], v[108:111], v[4:7]
    ds_read_b128 v[240:243], v156 offset:4096
L_fh1:
    v_cmp_ne_u32 vcc, s82, v169
    s_cbranch_vccnz L_fh_re1
    v_mfma_f32_16x16x32_bf16 v[0:3], v[68:71], v[108:111], v[0:3]
    ds_read_b128 v[248:251], v156 offset:4608
    v_mfma_f32_16x16x32_bf16 v[24:27], v[112:115], v[100:103], v[24:27]
    ds_read_b128 v[244:247], v157 offset:4096
    buffer_load_dwordx4 v[40:43], v175, s[64:67], s23 offen offset:0 sc1
    v_mfma_f32_16x16x32_bf16 v[24:27], v[116:119], v[108:111], v[24:27]
    ds_write_b128 v170, v[4:7] offset:1024
    s_add_u32 s83, s83, 9216
    buffer_load_dwordx4 v158, s[56:59], s83 offen offset:1024 lds
    ds_read_b128 v[252:255], v157 offset:4608
    v_mfma_f32_16x16x32_bf16 v[28:31], v[120:123], v[108:111], v[28:31]
    ds_write_b128 v170, v[0:3] offset:0
    buffer_load_dwordx4 v[44:47], v175, s[64:67], s23 offen offset:1024 sc1
    v_mfma_f32_16x16x32_bf16 v[28:31], v[112:115], v[84:87], v[28:31]
    v_mfma_f32_16x16x32_bf16 v[12:15], v[60:63], v[84:87], v[12:15]
    ds_write_b128 v170, v[24:27] offset:2048
    buffer_load_dwordx4 v[48:51], v175, s[64:67], s23 offen offset:2048 sc1
    v_mfma_f32_16x16x32_bf16 v[12:15], v[88:91], v[100:103], v[12:15]
    buffer_load_dwordx4 v158, s[60:63], s83 offen offset:3072 lds
    v_mfma_f32_16x16x32_bf16 v[12:15], v[104:107], v[108:111], v[12:15]
    s_nop 1
    ds_write_b128 v170, v[28:31] offset:3072
    buffer_load_dwordx4 v[120:123], v175, s[64:67], s22 offen offset:0 sc1
    v_mfma_f32_16x16x32_bf16 v[8:11], v[88:91], v[108:111], v[8:11]
    v_mfma_f32_16x16x32_bf16 v[8:11], v[68:71], v[84:87], v[8:11]
    v_mfma_f32_16x16x32_bf16 v[12:15], v[68:71], v[76:79], v[12:15]
    s_waitcnt lgkmcnt(3)
    s_add_u32 m0, s84, 4096
    s_add_u32 s83, s16, 5120
    buffer_load_dwordx4 v158, s[56:59], s83 offen offset:0 lds
    buffer_load_dwordx4 v[80:83], v175, s[64:67], s25 offen offset:0 sc1
    v_mfma_f32_16x16x32_bf16 v[8:11], v[60:63], v[100:103], v[8:11]
    v_mfma_f32_16x16x32_bf16 v[16:19], v[96:99], v[108:111], v[16:19]
    v_mfma_f32_16x16x32_bf16 v[16:19], v[68:71], v[92:95], v[16:19]
    buffer_load_dwordx4 v[116:119], v175, s[64:67], s28 offen offset:0 sc1
    v_mfma_f32_16x16x32_bf16 v[20:23], v[104:107], v[84:87], v[20:23]
    buffer_load_dwordx4 v158, s[60:63], s83 offen offset:2048 lds
    v_mfma_f32_16x16x32_bf16 v[20:23], v[88:91], v[76:79], v[20:23]
    v_mfma_f32_16x16x32_bf16 v[20:23], v[60:63], v[92:95], v[20:23]
    buffer_load_dwordx4 v[64:67], v175, s[64:67], s31 offen offset:0 sc1
    s_waitcnt lgkmcnt(0)
    s_barrier
    v_mfma_f32_16x16x32_bf16 v[16:19], v[104:107], v[100:103], v[16:19]
    ds_read_b128 v[0:3], v171 offset:0
    v_mfma_f32_16x16x32_bf16 v[16:19], v[60:63], v[76:79], v[16:19]
    ds_read_b128 v[4:7], v171 offset:1024
    s_add_u32 s83, s83, 9216
    buffer_load_dwordx4 v158, s[56:59], s83 offen offset:1024 lds
    v_mfma_f32_16x16x32_bf16 v[20:23], v[68:71], v[72:75], v[20:23]
    ds_read_b128 v[24:27], v171 offset:2048
    v_mfma_f32_16x16x32_bf16 v[16:19], v[88:91], v[84:87], v[16:19]
    ds_read_b128 v[28:31], v171 offset:3072
    v_mfma_f32_16x16x32_bf16 v[20:23], v[112:115], v[108:111], v[20:23]
    v_mfma_f32_16x16x32_bf16 v[20:23], v[96:99], v[100:103], v[20:23]
    buffer_load_dwordx4 v158, s[60:63], s83 offen offset:3072 lds
Lw_16:
    s_waitcnt vmcnt(12)
    v_mfma_f32_16x16x32_bf16 v[132:135], a[232:235], v[40:43], v[132:135]
    s_waitcnt lgkmcnt(2)
    v_add_f32 v0, v0, v8
    v_add_f32 v1, v1, v9
    v_mfma_f32_16x16x32_bf16 v[136:139], v[176:179], v[40:43], v[136:139]
    v_add_f32 v2, v2, v10
    v_add_f32 v3, v3, v11
    v_mfma_f32_16x16x32_bf16 v[140:143], v[192:195], v[40:43], v[140:143]
    buffer_load_dwordx4 v[60:63], v175, s[64:67], s22 offen offset:1024 sc1
    v_add_f32 v4, v4, v12
    v_add_f32 v5, v5, v13
    v_mfma_f32_16x16x32_bf16 v[144:147], v[208:211], v[40:43], v[144:147]
    v_add_f32 v6, v6, v14
    v_add_f32 v7, v7, v15
    v_mfma_f32_16x16x32_bf16 v[148:151], a[216:219], v[40:43], v[148:151]
    v_cvt_pk_bf16_f32 v0, 0, v0
    v_cvt_pk_bf16_f32 v1, 0, v1
    s_waitcnt vmcnt(11)
    v_mfma_f32_16x16x32_bf16 v[132:135], a[236:239], v[44:47], v[132:135]
    v_cvt_pk_bf16_f32 v2, 0, v2
    v_cvt_pk_bf16_f32 v3, 0, v3
    v_mfma_f32_16x16x32_bf16 v[136:139], v[180:183], v[44:47], v[136:139]
    buffer_load_dwordx4 v[68:71], v175, s[64:67], s25 offen offset:1024 sc1
    v_cvt_pk_bf16_f32 v4, 0, v4
    v_cvt_pk_bf16_f32 v5, 0, v5
    v_mfma_f32_16x16x32_bf16 v[140:143], v[196:199], v[44:47], v[140:143]
    v_cvt_pk_bf16_f32 v6, 0, v6
    v_cvt_pk_bf16_f32 v7, 0, v7
    v_mfma_f32_16x16x32_bf16 v[144:147], v[212:215], v[44:47], v[144:147]
    ds_read_b128 v[124:127], v156 offset:8192
    v_add_f32 v0, v0, v52
    v_add_f32 v1, v1, v53
    v_mfma_f32_16x16x32_bf16 v[148:151], a[220:223], v[44:47], v[148:151]
    v_add_f32 v2, v2, v54
    v_add_f32 v3, v3, v55
    s_waitcnt vmcnt(11)
    v_mfma_f32_16x16x32_bf16 v[132:135], a[240:243], v[48:51], v[132:135]
    buffer_load_dwordx4 v[72:75], v175, s[64:67], s28 offen offset:1024 sc1
    v_add_f32 v4, v4, v56
    v_add_f32 v5, v5, v57
    v_mfma_f32_16x16x32_bf16 v[136:139], v[184:187], v[48:51], v[136:139]
    v_add_f32 v6, v6, v58
    v_add_f32 v7, v7, v59
    v_mfma_f32_16x16x32_bf16 v[140:143], v[200:203], v[48:51], v[140:143]
    ds_read_b128 v[128:131], v156 offset:12288
    v_cvt_pk_bf16_f32 v170, v0, v1
    v_cvt_pk_bf16_f32 v171, v2, v3
    v_mfma_f32_16x16x32_bf16 v[144:147], v[216:219], v[48:51], v[144:147]
    v_cvt_pk_bf16_f32 v172, v4, v5
    v_cvt_pk_bf16_f32 v173, v6, v7
    v_mfma_f32_16x16x32_bf16 v[148:151], a[224:227], v[48:51], v[148:151]
    buffer_load_dwordx4 v[76:79], v175, s[64:67], s31 offen offset:1024 sc1
    v_permlane16_swap_b32 v170, v172
    s_waitcnt vmcnt(9)
    v_mfma_f32_16x16x32_bf16 v[148:151], a[200:203], v[120:123], v[148:151]
    v_permlane16_swap_b32 v171, v173
    v_mfma_f32_16x16x32_bf16 v[40:43], a[200:203], v[80:83], 0
    ds_read_b128 v[112:115], v156 offset:0
    s_waitcnt lgkmcnt(3)
    v_add_f32 v16, v16, v24
    v_add_f32 v17, v17, v25
    s_waitcnt vmcnt(6)
    v_mfma_f32_16x16x32_bf16 v[44:47], a[200:203], v[116:119], 0
    v_add_f32 v18, v18, v26
    v_add_f32 v19, v19, v27
    v_mfma_f32_16x16x32_bf16 v[48:51], a[200:203], v[64:67], 0
    buffer_load_dwordx4 v[84:87], v175, s[64:67], s22 offen offset:2048 sc1
    v_add_f32 v20, v20, v28
    v_add_f32 v21, v21, v29
    s_waitcnt lgkmcnt(2)
    v_mfma_f32_16x16x32_bf16 v[140:143], v[124:127], v[120:123], v[140:143]
    v_add_f32 v22, v22, v30
    v_add_f32 v23, v23, v31
    v_mfma_f32_16x16x32_bf16 v[52:55], v[124:127], v[80:83], 0
    v_cvt_pk_bf16_f32 v16, 0, v16
    v_cvt_pk_bf16_f32 v17, 0, v17
    v_mfma_f32_16x16x32_bf16 v[56:59], v[124:127], v[116:119], 0
    v_cvt_pk_bf16_f32 v18, 0, v18
    v_cvt_pk_bf16_f32 v19, 0, v19
    v_mfma_f32_16x16x32_bf16 v[0:3], v[124:127], v[64:67], 0
    s_waitcnt vmcnt(5)
    ds_read_b128 v[124:127], v156 offset:4096
    buffer_load_dwordx4 v[88:91], v175, s[64:67], s25 offen offset:2048 sc1
    v_cvt_pk_bf16_f32 v20, 0, v20
    v_cvt_pk_bf16_f32 v21, 0, v21
    s_waitcnt lgkmcnt(2)
    v_mfma_f32_16x16x32_bf16 v[144:147], v[128:131], v[120:123], v[144:147]
    v_cvt_pk_bf16_f32 v22, 0, v22
    v_cvt_pk_bf16_f32 v23, 0, v23
    v_mfma_f32_16x16x32_bf16 v[4:7], v[128:131], v[80:83], 0
    v_add_f32 v16, v16, v32
    v_add_f32 v17, v17, v33
    v_mfma_f32_16x16x32_bf16 v[8:11], v[128:131], v[116:119], 0
    v_add_f32 v18, v18, v34
    v_add_f32 v19, v19, v35
    v_mfma_f32_16x16x32_bf16 v[12:15], v[128:131], v[64:67], 0
    ds_read_b128 v[128:131], v157 offset:8192
    buffer_load_dwordx4 v[92:95], v175, s[64:67], s28 offen offset:2048 sc1
    v_add_f32 v20, v20, v36
    v_add_f32 v21, v21, v37
    s_waitcnt lgkmcnt(2)
    v_mfma_f32_16x16x32_bf16 v[132:135], v[112:115], v[120:123], v[132:135]
    v_add_f32 v22, v22, v38
    v_add_f32 v23, v23, v39
    v_mfma_f32_16x16x32_bf16 v[28:31], v[112:115], v[80:83], 0
    v_cvt_pk_bf16_f32 v166, v16, v17
    v_cvt_pk_bf16_f32 v167, v18, v19
    v_mfma_f32_16x16x32_bf16 v[32:35], v[112:115], v[116:119], 0
    v_cvt_pk_bf16_f32 v168, v20, v21
    v_cvt_pk_bf16_f32 v169, v22, v23
    v_mfma_f32_16x16x32_bf16 v[36:39], v[112:115], v[64:67], 0
    ds_read_b128 v[112:115], v157 offset:12288
    buffer_load_dwordx4 v[96:99], v175, s[64:67], s31 offen offset:2048 sc1
    v_permlane16_swap_b32 v166, v168
    s_waitcnt lgkmcnt(2)
    v_mfma_f32_16x16x32_bf16 v[136:139], v[124:127], v[120:123], v[136:139]
    v_permlane16_swap_b32 v167, v169
    v_mfma_f32_16x16x32_bf16 v[16:19], v[124:127], v[80:83], 0
    v_mfma_f32_16x16x32_bf16 v[20:23], v[124:127], v[116:119], 0
    v_mfma_f32_16x16x32_bf16 v[24:27], v[124:127], v[64:67], 0
    ds_read_b128 v[124:127], v157 offset:0
    buffer_load_dwordx4 v[100:103], v175, s[64:67], s22 offen offset:3072 sc1
    s_waitcnt vmcnt(7)
    v_mfma_f32_16x16x32_bf16 v[148:151], a[204:207], v[60:63], v[148:151]
    v_mfma_f32_16x16x32_bf16 v[40:43], a[204:207], v[68:71], v[40:43]
    buffer_store_dwordx4 v[170:173], v164, s[68:71], s38 offen sc1
    buffer_store_dwordx4 v[166:169], v164, s[68:71], s39 offen sc1
    s_waitcnt vmcnt(7)
    v_mfma_f32_16x16x32_bf16 v[44:47], a[204:207], v[72:75], v[44:47]
    v_mfma_f32_16x16x32_bf16 v[48:51], a[204:207], v[76:79], v[48:51]
    buffer_load_dwordx4 v[104:107], v175, s[64:67], s25 offen offset:3072 sc1
    s_waitcnt lgkmcnt(2)
    v_mfma_f32_16x16x32_bf16 v[140:143], v[128:131], v[60:63], v[140:143]
    s_movk_i32 s9, 0x70
    v_lshrrev_b32 v164, 3, v152
    v_mfma_f32_16x16x32_bf16 v[52:55], v[128:131], v[68:71], v[52:55]
    v_lshlrev_b32 v164, 12, v164
    v_and_or_b32 v164, v153, s9, v164
    v_mfma_f32_16x16x32_bf16 v[56:59], v[128:131], v[72:75], v[56:59]
    s_mul_i32 s6, s78, 327680
    s_lshl_b32 s5, s79, 7
    v_mfma_f32_16x16x32_bf16 v[0:3], v[128:131], v[76:79], v[0:3]
    ds_read_b128 v[128:131], v157 offset:4096
    buffer_load_dwordx4 v[108:111], v175, s[64:67], s28 offen offset:3072 sc1
    s_waitcnt lgkmcnt(2)
    v_mfma_f32_16x16x32_bf16 v[144:147], v[112:115], v[60:63], v[144:147]
    s_add_u32 s6, s6, s5
    s_lshl_b32 s5, s77, 14
    v_mfma_f32_16x16x32_bf16 v[4:7], v[112:115], v[68:71], v[4:7]
    s_add_u32 s7, s6, s5
    s_add_u32 s7, s7, 262144
    v_mfma_f32_16x16x32_bf16 v[8:11], v[112:115], v[72:75], v[8:11]
    s_lshl_b32 s5, s77, 16
    s_add_u32 s6, s6, s5
    v_mfma_f32_16x16x32_bf16 v[12:15], v[112:115], v[76:79], v[12:15]
    ds_read_b128 v[112:115], v156 offset:8704
    buffer_load_dwordx4 v[120:123], v175, s[64:67], s31 offen offset:3072 sc1
    s_waitcnt lgkmcnt(2)
    v_mfma_f32_16x16x32_bf16 v[132:135], v[124:127], v[60:63], v[132:135]
    s_mov_b32 s5, 3145728
    s_add_u32 s6, s6, s5
    v_mfma_f32_16x16x32_bf16 v[28:31], v[124:127], v[68:71], v[28:31]
    s_add_u32 s7, s7, s5
    s_lshl_b32 s5, s77, 9
    v_mfma_f32_16x16x32_bf16 v[32:35], v[124:127], v[72:75], v[32:35]
    s_mul_i32 s4, s77, 15360
    v_add_u32 v154, s4, v153
    v_mfma_f32_16x16x32_bf16 v[36:39], v[124:127], v[76:79], v[36:39]
    ds_read_b128 v[124:127], v156 offset:12800
    buffer_load_dwordx4 v[80:83], v175, s[64:67], s26 offen offset:0 sc1
    s_waitcnt lgkmcnt(2)
    v_mfma_f32_16x16x32_bf16 v[136:139], v[128:131], v[60:63], v[136:139]
    v_and_b32 v155, 0xf0, v153
    v_lshrrev_b32 v163, 4, v152
    v_mfma_f32_16x16x32_bf16 v[16:19], v[128:131], v[68:71], v[16:19]
    v_lshl_add_u32 v163, v163, 9, v155
    v_lshrrev_b32 v172, 5, v152
    v_mfma_f32_16x16x32_bf16 v[20:23], v[128:131], v[72:75], v[20:23]
    v_lshl_add_u32 v155, v172, 3, v155
    v_mfma_f32_16x16x32_bf16 v[24:27], v[128:131], v[76:79], v[24:27]
    ds_read_b128 v[128:131], v156 offset:512
    buffer_load_dwordx4 v[116:119], v175, s[64:67], s26 offen offset:1024 sc1
    s_waitcnt vmcnt(10)
    v_mfma_f32_16x16x32_bf16 v[148:151], a[208:211], v[84:87], v[148:151]
    s_lshl_b32 s4, s78, 8
    v_add_u32 v155, s4, v155
    v_mfma_f32_16x16x32_bf16 v[40:43], a[208:211], v[88:91], v[40:43]
    s_lshl_b32 s4, s79, 13
    s_waitcnt vmcnt(8)
    v_mfma_f32_16x16x32_bf16 v[44:47], a[208:211], v[92:95], v[44:47]
    s_add_u32 s4, s4, s100
    s_add_u32 s4, s4, 10485760
    v_mfma_f32_16x16x32_bf16 v[48:51], a[208:211], v[96:99], v[48:51]
    buffer_load_dwordx4 v[64:67], v175, s[64:67], s26 offen offset:2048 sc1
    s_waitcnt lgkmcnt(2)
    v_mfma_f32_16x16x32_bf16 v[140:143], v[112:115], v[84:87], v[140:143]
    s_add_u32 s98, s50, s4
    s_addc_u32 s99, s51, 0
    v_mfma_f32_16x16x32_bf16 v[52:55], v[112:115], v[88:91], v[52:55]
    s_add_u32 s4, s100, 61440
    v_lshl_add_u32 v170, v152, 3, s4
    v_mfma_f32_16x16x32_bf16 v[56:59], v[112:115], v[92:95], v[56:59]
    s_add_u32 s4, s5, 69632
    v_lshl_add_u32 v171, v152, 3, s4
    v_mfma_f32_16x16x32_bf16 v[0:3], v[112:115], v[96:99], v[0:3]
    ds_read_b128 v[112:115], v156 offset:4608
    buffer_load_dwordx4 v[60:63], v175, s[64:67], s26 offen offset:3072 sc1
    s_waitcnt lgkmcnt(2)
    v_mfma_f32_16x16x32_bf16 v[144:147], v[124:127], v[84:87], v[144:147]
    v_mfma_f32_16x16x32_bf16 v[4:7], v[124:127], v[88:91], v[4:7]
    v_mfma_f32_16x16x32_bf16 v[8:11], v[124:127], v[92:95], v[8:11]
    v_mfma_f32_16x16x32_bf16 v[12:15], v[124:127], v[96:99], v[12:15]
    ds_read_b128 v[124:127], v157 offset:8704
    buffer_load_dwordx4 v[68:71], v175, s[64:67], s27 offen offset:0 sc1
    s_waitcnt lgkmcnt(2)
    v_mfma_f32_16x16x32_bf16 v[132:135], v[128:131], v[84:87], v[132:135]
    v_mfma_f32_16x16x32_bf16 v[28:31], v[128:131], v[88:91], v[28:31]
    v_mfma_f32_16x16x32_bf16 v[32:35], v[128:131], v[92:95], v[32:35]
    v_mfma_f32_16x16x32_bf16 v[36:39], v[128:131], v[96:99], v[36:39]
    ds_read_b128 v[128:131], v157 offset:12800
    buffer_load_dwordx4 v[72:75], v175, s[64:67], s27 offen offset:1024 sc1
    s_waitcnt lgkmcnt(2)
    v_mfma_f32_16x16x32_bf16 v[136:139], v[112:115], v[84:87], v[136:139]
    v_mfma_f32_16x16x32_bf16 v[16:19], v[112:115], v[88:91], v[16:19]
    v_mfma_f32_16x16x32_bf16 v[20:23], v[112:115], v[92:95], v[20:23]
    v_mfma_f32_16x16x32_bf16 v[24:27], v[112:115], v[96:99], v[24:27]
    ds_read_b128 v[112:115], v157 offset:512
    buffer_load_dwordx4 v[76:79], v175, s[64:67], s29 offen offset:0 sc1
    s_waitcnt vmcnt(9)
    v_mfma_f32_16x16x32_bf16 v[148:151], a[212:215], v[100:103], v[148:151]
    v_mfma_f32_16x16x32_bf16 v[40:43], a[212:215], v[104:107], v[40:43]
    s_waitcnt vmcnt(7)
    v_mfma_f32_16x16x32_bf16 v[44:47], a[212:215], v[108:111], v[44:47]
    v_mfma_f32_16x16x32_bf16 v[48:51], a[212:215], v[120:123], v[48:51]
    buffer_load_dwordx4 v[84:87], v175, s[64:67], s29 offen offset:1024 sc1
    s_waitcnt lgkmcnt(2)
    v_mfma_f32_16x16x32_bf16 v[140:143], v[124:127], v[100:103], v[140:143]
    v_mfma_f32_16x16x32_bf16 v[52:55], v[124:127], v[104:107], v[52:55]
    v_mfma_f32_16x16x32_bf16 v[56:59], v[124:127], v[108:111], v[56:59]
    v_mfma_f32_16x16x32_bf16 v[0:3], v[124:127], v[120:123], v[0:3]
    ds_read_b128 v[124:127], v157 offset:4608
    buffer_load_dwordx4 v[88:91], v175, s[64:67], s29 offen offset:2048 sc1
    s_waitcnt lgkmcnt(2)
    v_mfma_f32_16x16x32_bf16 v[144:147], v[128:131], v[100:103], v[144:147]
    v_mfma_f32_16x16x32_bf16 v[4:7], v[128:131], v[104:107], v[4:7]
    v_mfma_f32_16x16x32_bf16 v[8:11], v[128:131], v[108:111], v[8:11]
    v_mfma_f32_16x16x32_bf16 v[12:15], v[128:131], v[120:123], v[12:15]
    buffer_load_dwordx4 v[92:95], v175, s[64:67], s29 offen offset:3072 sc1
    s_waitcnt lgkmcnt(1)
    v_mfma_f32_16x16x32_bf16 v[132:135], v[112:115], v[100:103], v[132:135]
    v_mfma_f32_16x16x32_bf16 v[28:31], v[112:115], v[104:107], v[28:31]
    v_mfma_f32_16x16x32_bf16 v[32:35], v[112:115], v[108:111], v[32:35]
    v_mfma_f32_16x16x32_bf16 v[36:39], v[112:115], v[120:123], v[36:39]
    buffer_load_dwordx4 v[96:99], v175, s[64:67], s30 offen offset:0 sc1
    s_waitcnt lgkmcnt(0)
    v_mfma_f32_16x16x32_bf16 v[136:139], v[124:127], v[100:103], v[136:139]
    v_mfma_f32_16x16x32_bf16 v[16:19], v[124:127], v[104:107], v[16:19]
    v_mfma_f32_16x16x32_bf16 v[20:23], v[124:127], v[108:111], v[20:23]
    v_mfma_f32_16x16x32_bf16 v[24:27], v[124:127], v[120:123], v[24:27]
    buffer_load_dwordx4 v[100:103], v175, s[64:67], s30 offen offset:1024 sc1
    s_waitcnt vmcnt(10)
    v_mfma_f32_16x16x32_bf16 v[28:31], a[232:235], v[80:83], v[28:31]
    v_mfma_f32_16x16x32_bf16 v[28:31], a[236:239], v[116:119], v[28:31]
    s_waitcnt vmcnt(8)
    v_mfma_f32_16x16x32_bf16 v[28:31], a[240:243], v[64:67], v[28:31]
    v_mfma_f32_16x16x32_bf16 v[28:31], a[244:247], v[60:63], v[28:31]
    buffer_load_dwordx4 v[104:107], v175, s[64:67], s32 offen offset:0 sc1
    s_waitcnt vmcnt(7)
    v_mfma_f32_16x16x32_bf16 v[28:31], v[224:227], v[68:71], v[28:31]
    s_add_u32 s3, s77, 1
    s_and_b32 s3, s3, 3
    v_mfma_f32_16x16x32_bf16 v[28:31], v[228:231], v[72:75], v[28:31]
    s_mul_i32 s3, s3, 15360
    v_add_u32 v165, s3, v153
    v_mfma_f32_16x16x32_bf16 v[16:19], v[176:179], v[80:83], v[16:19]
    v_mfma_f32_16x16x32_bf16 v[16:19], v[180:183], v[116:119], v[16:19]
    buffer_load_dwordx4 v[108:111], v175, s[64:67], s32 offen offset:1024 sc1
    s_mul_i32 s8, s79, 163840
    s_mul_i32 s12, s77, 20480
    v_mov_b64 v[112:113], 0
    v_mov_b64 v[114:115], 0
    v_mfma_f32_16x16x32_bf16 v[16:19], v[184:187], v[64:67], v[16:19]
    s_mul_i32 s9, s78, 2560
    s_add_u32 s9, s9, s8
    s_lshl_b32 s85, s85, 4
    v_mov_b64 v[124:125], 0
    v_mov_b64 v[126:127], 0
    v_mfma_f32_16x16x32_bf16 v[16:19], v[188:191], v[60:63], v[16:19]
    ds_write_b128 v165, v[28:31] offset:0
    s_lshl_b32 s90, s90, 4
    s_lshl_b32 s72, s72, 4
    v_mov_b64 v[128:129], 0
    v_mov_b64 v[130:131], 0
    v_mfma_f32_16x16x32_bf16 v[16:19], v[232:235], v[68:71], v[16:19]
    s_add_u32 s72, s72, s8
    s_lshl_b32 s73, s73, 4
    s_add_u32 s73, s73, s8
    v_mfma_f32_16x16x32_bf16 v[16:19], v[236:239], v[72:75], v[16:19]
    buffer_load_dwordx4 v[120:123], v175, s[64:67], s32 offen offset:2048 sc1
    s_lshl_b32 s74, s74, 4
    s_add_u32 s74, s74, s8
    v_mfma_f32_16x16x32_bf16 v[52:55], v[192:195], v[80:83], v[52:55]
    s_lshl_b32 s75, s75, 4
    s_add_u32 s75, s75, s8
    s_lshl_b32 s76, s76, 4
    v_mfma_f32_16x16x32_bf16 v[52:55], v[196:199], v[116:119], v[52:55]
    s_add_u32 s76, s76, s8
    s_lshl_b32 s8, s81, 13
    v_add_u32 v158, s8, v153
    v_xor_b32 v159, 0x2000, v158
    v_mfma_f32_16x16x32_bf16 v[52:55], v[200:203], v[64:67], v[52:55]
    v_add_u32 v173, s12, v153
    v_mfma_f32_16x16x32_bf16 v[52:55], v[204:207], v[60:63], v[52:55]
    ds_write_b128 v165, v[16:19] offset:1024
    s_add_u32 s12, s12, s9
    v_mfma_f32_16x16x32_bf16 v[52:55], v[240:243], v[68:71], v[52:55]
    v_mfma_f32_16x16x32_bf16 v[52:55], v[244:247], v[72:75], v[52:55]
    v_mfma_f32_16x16x32_bf16 v[4:7], v[208:211], v[80:83], v[4:7]
    v_mfma_f32_16x16x32_bf16 v[4:7], v[212:215], v[116:119], v[4:7]
    v_mfma_f32_16x16x32_bf16 v[4:7], v[216:219], v[64:67], v[4:7]
    v_mfma_f32_16x16x32_bf16 v[4:7], v[220:223], v[60:63], v[4:7]
    s_nop 3
    ds_write_b128 v165, v[52:55] offset:2048
    v_mfma_f32_16x16x32_bf16 v[4:7], v[248:251], v[68:71], v[4:7]
    v_mfma_f32_16x16x32_bf16 v[4:7], v[252:255], v[72:75], v[4:7]
    v_mfma_f32_16x16x32_bf16 v[40:43], a[216:219], v[80:83], v[40:43]
    buffer_load_dwordx4 v[80:83], v175, s[64:67], s32 offen offset:3072 sc1
    v_mfma_f32_16x16x32_bf16 v[40:43], a[220:223], v[116:119], v[40:43]
    v_mfma_f32_16x16x32_bf16 v[40:43], a[224:227], v[64:67], v[40:43]
    v_mfma_f32_16x16x32_bf16 v[40:43], a[228:231], v[60:63], v[40:43]
    s_nop 2
    ds_write_b128 v165, v[4:7] offset:3072
    v_mfma_f32_16x16x32_bf16 v[40:43], a[248:251], v[68:71], v[40:43]
    buffer_load_dwordx4 v[116:119], v175, s[64:67], s33 offen offset:0 sc1
    v_mfma_f32_16x16x32_bf16 v[40:43], a[252:255], v[72:75], v[40:43]
    s_waitcnt vmcnt(9)
    v_mfma_f32_16x16x32_bf16 v[32:35], a[232:235], v[76:79], v[32:35]
    v_mfma_f32_16x16x32_bf16 v[32:35], a[236:239], v[84:87], v[32:35]
    s_waitcnt vmcnt(7)
    v_mfma_f32_16x16x32_bf16 v[32:35], a[240:243], v[88:91], v[32:35]
    buffer_load_dwordx4 v[64:67], v175, s[64:67], s33 offen offset:1024 sc1
    v_mfma_f32_16x16x32_bf16 v[32:35], a[244:247], v[92:95], v[32:35]
    s_nop 0
    ds_write_b128 v165, v[40:43] offset:4096
    s_waitcnt vmcnt(6)
    v_mfma_f32_16x16x32_bf16 v[32:35], v[224:227], v[96:99], v[32:35]
    s_add_u32 s3, s77, 2
    s_and_b32 s3, s3, 3
    v_mfma_f32_16x16x32_bf16 v[32:35], v[228:231], v[100:103], v[32:35]
    s_mul_i32 s3, s3, 15360
    v_add_u32 v165, s3, v153
    v_mfma_f32_16x16x32_bf16 v[20:23], v[176:179], v[76:79], v[20:23]
    buffer_load_dwordx4 v[60:63], v175, s[64:67], s23 offen offset:3072 sc1
    v_mfma_f32_16x16x32_bf16 v[20:23], v[180:183], v[84:87], v[20:23]
    v_mfma_f32_16x16x32_bf16 v[20:23], v[184:187], v[88:91], v[20:23]
    v_mfma_f32_16x16x32_bf16 v[20:23], v[188:191], v[92:95], v[20:23]
    s_nop 0
    ds_write_b128 v165, v[32:35] offset:5120
    v_mfma_f32_16x16x32_bf16 v[20:23], v[232:235], v[96:99], v[20:23]
    buffer_load_dwordx4 v[68:71], v175, s[64:67], s24 offen offset:0 sc1
    v_mfma_f32_16x16x32_bf16 v[20:23], v[236:239], v[100:103], v[20:23]
    v_mfma_f32_16x16x32_bf16 v[56:59], v[192:195], v[76:79], v[56:59]
    v_mfma_f32_16x16x32_bf16 v[56:59], v[196:199], v[84:87], v[56:59]
    v_mfma_f32_16x16x32_bf16 v[56:59], v[200:203], v[88:91], v[56:59]
    buffer_load_dwordx4 v[72:75], v175, s[64:67], s24 offen offset:1024 sc1
    v_mfma_f32_16x16x32_bf16 v[56:59], v[204:207], v[92:95], v[56:59]
    s_nop 2
    ds_write_b128 v165, v[20:23] offset:6144
    s_lshl_b32 s8, s77, 2
    s_add_u32 s8, s8, 61440
    v_bfe_u32 v172, v152, 2, 2
    v_lshl_add_u32 v166, v172, 5, s8
    v_mfma_f32_16x16x32_bf16 v[56:59], v[240:243], v[96:99], v[56:59]
    v_bfe_u32 v172, v152, 0, 1
    v_lshl_add_u32 v166, v172, 4, v166
    v_mfma_f32_16x16x32_bf16 v[56:59], v[244:247], v[100:103], v[56:59]
    v_bfe_u32 v172, v152, 1, 1
    v_lshl_add_u32 v166, v172, 1, v166
    v_mfma_f32_16x16x32_bf16 v[8:11], v[208:211], v[76:79], v[8:11]
    v_lshrrev_b32 v172, 4, v152
    v_lshl_add_u32 v167, v172, 9, v166
    v_mfma_f32_16x16x32_bf16 v[8:11], v[212:215], v[84:87], v[8:11]
    v_lshl_add_u32 v166, v172, 10, v166
    v_mfma_f32_16x16x32_bf16 v[8:11], v[216:219], v[88:91], v[8:11]
    v_mfma_f32_16x16x32_bf16 v[8:11], v[220:223], v[92:95], v[8:11]
    ds_write_b128 v165, v[56:59] offset:7168
    v_mfma_f32_16x16x32_bf16 v[8:11], v[248:251], v[96:99], v[8:11]
    v_mfma_f32_16x16x32_bf16 v[8:11], v[252:255], v[100:103], v[8:11]
    v_mfma_f32_16x16x32_bf16 v[44:47], a[216:219], v[76:79], v[44:47]
    v_mfma_f32_16x16x32_bf16 v[44:47], a[220:223], v[84:87], v[44:47]
    v_mfma_f32_16x16x32_bf16 v[44:47], a[224:227], v[88:91], v[44:47]
    v_mfma_f32_16x16x32_bf16 v[44:47], a[228:231], v[92:95], v[44:47]
    s_nop 3
    ds_write_b128 v165, v[8:11] offset:8192
    v_mfma_f32_16x16x32_bf16 v[44:47], a[248:251], v[96:99], v[44:47]
    v_mfma_f32_16x16x32_bf16 v[44:47], a[252:255], v[100:103], v[44:47]
    s_waitcnt vmcnt(7)
    v_mfma_f32_16x16x32_bf16 v[36:39], a[232:235], v[104:107], v[36:39]
    v_mfma_f32_16x16x32_bf16 v[36:39], a[236:239], v[108:111], v[36:39]
    s_waitcnt vmcnt(5)
    v_mfma_f32_16x16x32_bf16 v[36:39], a[240:243], v[120:123], v[36:39]
    v_mfma_f32_16x16x32_bf16 v[36:39], a[244:247], v[80:83], v[36:39]
    s_nop 1
    ds_write_b128 v165, v[44:47] offset:9216
    s_waitcnt vmcnt(3)
    v_mfma_f32_16x16x32_bf16 v[36:39], v[224:227], v[116:119], v[36:39]
    s_add_u32 s3, s77, 3
    s_and_b32 s3, s3, 3
    v_mfma_f32_16x16x32_bf16 v[36:39], v[228:231], v[64:67], v[36:39]
    s_mul_i32 s3, s3, 15360
    v_add_u32 v165, s3, v153
    v_mfma_f32_16x16x32_bf16 v[24:27], v[176:179], v[104:107], v[24:27]
    v_mfma_f32_16x16x32_bf16 v[24:27], v[180:183], v[108:111], v[24:27]
    v_mfma_f32_16x16x32_bf16 v[24:27], v[184:187], v[120:123], v[24:27]
    v_mfma_f32_16x16x32_bf16 v[24:27], v[188:191], v[80:83], v[24:27]
    s_nop 1
    ds_write_b128 v165, v[36:39] offset:10240
    v_mfma_f32_16x16x32_bf16 v[24:27], v[232:235], v[116:119], v[24:27]
    v_mfma_f32_16x16x32_bf16 v[24:27], v[236:239], v[64:67], v[24:27]
    s_waitcnt lgkmcnt(1)
    s_barrier
    v_mfma_f32_16x16x32_bf16 v[0:3], v[192:195], v[104:107], v[0:3]
    ds_read_b128 v[28:31], v154 offset:0
    v_mfma_f32_16x16x32_bf16 v[0:3], v[196:199], v[108:111], v[0:3]
    ds_read_b128 v[16:19], v154 offset:1024
    s_add_u32 m0, s100, 61440
    s_nop 0
    buffer_load_dwordx4 v164, s[68:71], s6 offen sc1 lds
    v_mfma_f32_16x16x32_bf16 v[0:3], v[200:203], v[120:123], v[0:3]
    ds_read_b128 v[52:55], v154 offset:2048
    v_mfma_f32_16x16x32_bf16 v[0:3], v[204:207], v[80:83], v[0:3]
    ds_read_b128 v[4:7], v154 offset:3072
    ds_write_b128 v165, v[24:27] offset:11264
    v_mfma_f32_16x16x32_bf16 v[0:3], v[240:243], v[116:119], v[0:3]
    ds_read_b128 v[40:43], v154 offset:4096
    s_add_u32 m0, s100, 62464
    s_add_u32 s83, s6, 32768
    buffer_load_dwordx4 v164, s[68:71], s83 offen sc1 lds
    v_mfma_f32_16x16x32_bf16 v[0:3], v[244:247], v[64:67], v[0:3]
    ds_read_b128 v[32:35], v154 offset:5120
    v_mfma_f32_16x16x32_bf16 v[12:15], v[208:211], v[104:107], v[12:15]
    ds_read_b128 v[20:23], v154 offset:6144
    s_waitcnt lgkmcnt(7)
    v_add_f32 v132, v132, v28
    v_add_f32 v133, v133, v29
    v_mfma_f32_16x16x32_bf16 v[12:15], v[212:215], v[108:111], v[12:15]
    ds_read_b128 v[56:59], v154 offset:7168
    s_add_u32 m0, s5, 69632
    s_mov_b32 exec_hi, 0
    buffer_load_dwordx4 v164, s[68:71], s7 offen sc1 lds
    s_mov_b32 exec_hi, -1
    v_add_f32 v134, v134, v30
    v_add_f32 v135, v135, v31
    v_mfma_f32_16x16x32_bf16 v[12:15], v[216:219], v[120:123], v[12:15]
    ds_read_b128 v[8:11], v154 offset:8192
    s_waitcnt lgkmcnt(8)
    v_add_f32 v136, v136, v16
    v_add_f32 v137, v137, v17
    v_mfma_f32_16x16x32_bf16 v[12:15], v[220:223], v[80:83], v[12:15]
    ds_read_b128 v[44:47], v154 offset:9216
    ds_write_b128 v165, v[0:3] offset:12288
    v_add_f32 v138, v138, v18
    v_add_f32 v139, v139, v19
    v_mfma_f32_16x16x32_bf16 v[12:15], v[248:251], v[116:119], v[12:15]
    s_waitcnt lgkmcnt(9)
    v_add_f32 v140, v140, v52
    v_add_f32 v141, v141, v53
    v_mfma_f32_16x16x32_bf16 v[12:15], v[252:255], v[64:67], v[12:15]
    v_add_f32 v142, v142, v54
    v_add_f32 v143, v143, v55
    v_mfma_f32_16x16x32_bf16 v[48:51], a[216:219], v[104:107], v[48:51]
    s_waitcnt lgkmcnt(8)
    v_add_f32 v144, v144, v4
    v_add_f32 v145, v145, v5
    v_mfma_f32_16x16x32_bf16 v[48:51], a[220:223], v[108:111], v[48:51]
    v_add_f32 v146, v146, v6
    v_add_f32 v147, v147, v7
    v_mfma_f32_16x16x32_bf16 v[48:51], a[224:227], v[120:123], v[48:51]
    s_waitcnt lgkmcnt(6)
    v_add_f32 v148, v148, v40
    v_add_f32 v149, v149, v41
    v_mfma_f32_16x16x32_bf16 v[48:51], a[228:231], v[80:83], v[48:51]
    ds_write_b128 v165, v[12:15] offset:13312
    v_add_f32 v150, v150, v42
    v_add_f32 v151, v151, v43
    v_mfma_f32_16x16x32_bf16 v[48:51], a[248:251], v[116:119], v[48:51]
    v_mfma_f32_16x16x32_bf16 v[48:51], a[252:255], v[64:67], v[48:51]
    s_waitcnt lgkmcnt(6)
    s_waitcnt vmcnt(5)
    v_mfma_f32_16x16x32_bf16 v[32:35], a[244:247], v[60:63], v[32:35]
    s_waitcnt vmcnt(4)
    v_mfma_f32_16x16x32_bf16 v[32:35], v[224:227], v[68:71], v[32:35]
    s_waitcnt vmcnt(3)
    v_mfma_f32_16x16x32_bf16 v[32:35], v[228:231], v[72:75], v[32:35]
    v_mov_b64 v[116:117], 0
    v_mov_b64 v[118:119], 0
    s_waitcnt lgkmcnt(5)
    v_mfma_f32_16x16x32_bf16 v[20:23], v[188:191], v[60:63], v[20:23]
    ds_write_b128 v165, v[48:51] offset:14336
    v_mov_b64 v[120:121], 0
    v_mov_b64 v[122:123], 0
    v_mfma_f32_16x16x32_bf16 v[20:23], v[232:235], v[68:71], v[20:23]
    v_mfma_f32_16x16x32_bf16 v[20:23], v[236:239], v[72:75], v[20:23]
    s_waitcnt lgkmcnt(5)
    v_mfma_f32_16x16x32_bf16 v[56:59], v[204:207], v[60:63], v[56:59]
    v_mfma_f32_16x16x32_bf16 v[56:59], v[240:243], v[68:71], v[56:59]
    v_mfma_f32_16x16x32_bf16 v[56:59], v[244:247], v[72:75], v[56:59]
    s_waitcnt lgkmcnt(0)
    s_barrier
    v_mfma_f32_16x16x32_bf16 v[8:11], v[220:223], v[60:63], v[8:11]
    ds_read_b128 v[28:31], v154 offset:10240
    v_mfma_f32_16x16x32_bf16 v[8:11], v[248:251], v[68:71], v[8:11]
    ds_read_b128 v[16:19], v154 offset:11264
    v_mfma_f32_16x16x32_bf16 v[8:11], v[252:255], v[72:75], v[8:11]
    ds_read_b128 v[52:55], v154 offset:12288
    v_mfma_f32_16x16x32_bf16 v[44:47], a[228:231], v[60:63], v[44:47]
    ds_read_b128 v[4:7], v154 offset:13312
    v_mfma_f32_16x16x32_bf16 v[44:47], a[248:251], v[68:71], v[44:47]
    ds_read_b128 v[40:43], v154 offset:14336
    v_mfma_f32_16x16x32_bf16 v[44:47], a[252:255], v[72:75], v[44:47]
    v_pk_add_f32 v[132:133], v[132:133], v[32:33]
    v_pk_add_f32 v[134:135], v[134:135], v[34:35]
    v_pk_add_f32 v[136:137], v[136:137], v[20:21]
    v_pk_add_f32 v[138:139], v[138:139], v[22:23]
    v_pk_add_f32 v[140:141], v[140:141], v[56:57]
    v_pk_add_f32 v[142:143], v[142:143], v[58:59]
    v_pk_add_f32 v[144:145], v[144:145], v[8:9]
    v_pk_add_f32 v[146:147], v[146:147], v[10:11]
    v_pk_add_f32 v[148:149], v[148:149], v[44:45]
    v_pk_add_f32 v[150:151], v[150:151], v[46:47]
    s_waitcnt lgkmcnt(4)
    v_pk_add_f32 v[132:133], v[132:133], v[28:29]
    v_pk_add_f32 v[134:135], v[134:135], v[30:31]
    s_waitcnt lgkmcnt(3)
    v_pk_add_f32 v[136:137], v[136:137], v[16:17]
    v_pk_add_f32 v[138:139], v[138:139], v[18:19]
    s_waitcnt lgkmcnt(2)
    v_pk_add_f32 v[140:141], v[140:141], v[52:53]
    v_pk_add_f32 v[142:143], v[142:143], v[54:55]
    s_waitcnt lgkmcnt(1)
    v_pk_add_f32 v[144:145], v[144:145], v[4:5]
    v_pk_add_f32 v[146:147], v[146:147], v[6:7]
    s_waitcnt lgkmcnt(0)
    v_pk_add_f32 v[148:149], v[148:149], v[40:41]
    v_pk_add_f32 v[150:151], v[150:151], v[42:43]
    v_pk_add_f32 v[4:5], v[132:133], v[134:135]
    v_pk_mul_f32 v[6:7], v[132:133], v[132:133]
    v_pk_fma_f32 v[6:7], v[134:135], v[134:135], v[6:7]
    v_pk_fma_f32 v[6:7], v[136:137], v[136:137], v[6:7]
    v_pk_add_f32 v[4:5], v[4:5], v[136:137]
    v_pk_fma_f32 v[6:7], v[138:139], v[138:139], v[6:7]
    v_pk_add_f32 v[4:5], v[4:5], v[138:139]
    v_pk_fma_f32 v[6:7], v[140:141], v[140:141], v[6:7]
    v_pk_add_f32 v[4:5], v[4:5], v[140:141]
    v_pk_fma_f32 v[6:7], v[142:143], v[142:143], v[6:7]
    v_pk_add_f32 v[4:5], v[4:5], v[142:143]
    v_pk_fma_f32 v[6:7], v[144:145], v[144:145], v[6:7]
    v_pk_add_f32 v[4:5], v[4:5], v[144:145]
    v_pk_fma_f32 v[6:7], v[146:147], v[146:147], v[6:7]
    v_pk_add_f32 v[4:5], v[4:5], v[146:147]
    v_pk_fma_f32 v[6:7], v[148:149], v[148:149], v[6:7]
    v_pk_add_f32 v[4:5], v[4:5], v[148:149]
    v_pk_fma_f32 v[6:7], v[150:151], v[150:151], v[6:7]
    v_pk_add_f32 v[4:5], v[4:5], v[150:151]
    v_add_f32 v6, v6, v7
    v_add_f32 v4, v4, v5
    v_mov_b32 v1, s82
    s_nop 0
    v_permlane32_swap_b32 v4, v6
    v_add_f32 v4, v4, v6
    v_mov_b32 v6, v4
    s_nop 1
    v_permlane16_swap_b32 v4, v6
    v_add_f32 v0, v4, v6

    s_cmp_eq_u32 s88, 0
    s_cbranch_scc1 Lss_17
    global_store_dwordx2 v155, v[0:1], s[98:99]
Lsd_18:
    s_waitcnt vmcnt(1)
    ds_read2st64_b32 v[8:9], v170 offset1:2
    ds_read2st64_b32 v[10:11], v170 offset0:4 offset1:6
    ds_read_b32 v12, v171
    v_and_b32 v84, 0xf0, v153
    v_lshrrev_b32 v85, 5, v152
    v_lshl_add_u32 v84, v85, 8, v84
    v_bfe_u32 v85, v152, 2, 3
    v_mul_u32_u24 v85, 2560, v85
    v_and_b32 v86, 3, v152
    v_min_u32 v86, 2, v86
    v_lshl_add_u32 v85, v86, 10, v85
    s_mul_i32 s3, s78, 2560
    s_sub_u32 s3, s12, s3
    v_add_u32 v85, s3, v85
    s_waitcnt lgkmcnt(0)
    v_max3_u32 v169, v8, v9, v10
    v_max3_u32 v169, v169, v11, v12
    v_cmp_eq_u32 s[96:97], -1, v169
    s_cmp_lg_u64 s[96:97], 0
    s_cbranch_scc1 L_gcr
L_gc:
    global_load_dwordx4 v[0:3], v163, s[98:99] sc1
    global_load_dwordx4 v[4:7], v163, s[98:99] offset:256 sc1
    s_barrier
    ds_read_u16_d16_hi v112, v166 offset:0
    ds_read_u16_d16_hi v113, v166 offset:128
    ds_read_u16_d16_hi v114, v166 offset:256
    ds_read_u16_d16_hi v115, v166 offset:384
    ds_read_u16_d16_hi v116, v166 offset:512
    ds_read_u16_d16_hi v117, v166 offset:640
    ds_read_u16_d16_hi v118, v166 offset:768
    ds_read_u16_d16_hi v119, v166 offset:896
    ds_read_u16_d16_hi v120, v166 offset:4096
    ds_read_u16_d16_hi v121, v166 offset:4224
    ds_read_u16_d16_hi v122, v166 offset:4352
    ds_read_u16_d16_hi v123, v166 offset:4480
    ds_read_u16_d16_hi v124, v166 offset:4608
    ds_read_u16_d16_hi v125, v166 offset:4736
    ds_read_u16_d16_hi v126, v166 offset:4864
    ds_read_u16_d16_hi v127, v166 offset:4992
    ds_read_u16_d16_hi v128, v167 offset:8192
    ds_read_u16_d16_hi v129, v167 offset:8320
    ds_read_u16_d16_hi v130, v167 offset:8448
    ds_read_u16_d16_hi v131, v167 offset:8576
    s_waitcnt lgkmcnt(0)
    s_waitcnt vmcnt(0)
    L_s1:
    v_min3_u32 v168, v1, v3, v5
    v_max3_u32 v1, v1, v3, v5
    v_min3_u32 v168, v168, v7, s82
    v_max3_u32 v1, v1, v7, s82
    v_cmp_ne_u32 vcc, v168, v1

    s_cbranch_vccnz L_s1r
    v_add_f32 v0, v0, v4
    v_add_f32 v2, v2, v6
    s_nop 1
    v_permlane32_swap_b32 v0, v2
    v_add_f32 v0, v0, v2
    v_mov_b32 v2, v0
    s_nop 1
    v_permlane16_swap_b32 v0, v2
    v_add_f32 v0, v0, v2
    v_mov_b32 v2, v0
    s_nop 1
    v_permlane32_swap_b32 v0, v2
    v_mul_f32 v0, 0x3acccccd, v0
    v_mov_b32 v166, 0x3727c5ac
    v_fmac_f32 v166, 0x3acccccd, v2
    v_fma_f32 v166, -v0, v0, v166
    v_max_f32 v166, 0x3727c5ac, v166
    v_rsq_f32 v166, v166
    s_nop 0
    v_mul_f32_e64 v167, -v0, v166
    v_pk_fma_f32 v[32:33], v[148:149], v[166:167], v[166:167] op_sel:[0,0,1] op_sel_hi:[1,0,1]
    v_pk_fma_f32 v[34:35], v[150:151], v[166:167], v[166:167] op_sel:[0,0,1] op_sel_hi:[1,0,1]
    v_pk_fma_f32 v[16:17], v[132:133], v[166:167], v[166:167] op_sel:[0,0,1] op_sel_hi:[1,0,1]
    v_pk_fma_f32 v[18:19], v[134:135], v[166:167], v[166:167] op_sel:[0,0,1] op_sel_hi:[1,0,1]
    v_pk_fma_f32 v[20:21], v[136:137], v[166:167], v[166:167] op_sel:[0,0,1] op_sel_hi:[1,0,1]
    v_pk_fma_f32 v[22:23], v[138:139], v[166:167], v[166:167] op_sel:[0,0,1] op_sel_hi:[1,0,1]
    v_pk_fma_f32 v[24:25], v[140:141], v[166:167], v[166:167] op_sel:[0,0,1] op_sel_hi:[1,0,1]
    v_pk_fma_f32 v[26:27], v[142:143], v[166:167], v[166:167] op_sel:[0,0,1] op_sel_hi:[1,0,1]
    v_pk_fma_f32 v[28:29], v[144:145], v[166:167], v[166:167] op_sel:[0,0,1] op_sel_hi:[1,0,1]
    v_pk_fma_f32 v[30:31], v[146:147], v[166:167], v[166:167] op_sel:[0,0,1] op_sel_hi:[1,0,1]
    v_pk_fma_f32 v[148:149], v[32:33], v[128:129], v[148:149]
    v_pk_fma_f32 v[150:151], v[34:35], v[130:131], v[150:151]
    v_pk_fma_f32 v[132:133], v[16:17], v[112:113], v[132:133]
    v_pk_fma_f32 v[134:135], v[18:19], v[114:115], v[134:135]
    v_pk_fma_f32 v[136:137], v[20:21], v[116:117], v[136:137]
    v_pk_fma_f32 v[138:139], v[22:23], v[118:119], v[138:139]
    v_pk_fma_f32 v[140:141], v[24:25], v[120:121], v[140:141]
    v_pk_fma_f32 v[142:143], v[26:27], v[122:123], v[142:143]
    v_pk_fma_f32 v[144:145], v[28:29], v[124:125], v[144:145]
    v_pk_fma_f32 v[146:147], v[30:31], v[126:127], v[146:147]
    v_cvt_pk_bf16_f32 v44, v148, v149
    v_cvt_pk_bf16_f32 v45, v150, v151
    v_or_b32 v44, 1, v44
    v_cvt_pk_bf16_f32 v36, v132, v133
    v_cvt_pk_bf16_f32 v37, v134, v135
    v_or_b32 v36, 1, v36
    v_permlane16_swap_b32 v44, v46
    v_permlane16_swap_b32 v45, v47
    v_cvt_pk_bf16_f32 v38, v136, v137
    v_cvt_pk_bf16_f32 v39, v138, v139
    v_or_b32 v38, 1, v38
    v_cvt_pk_bf16_f32 v40, v140, v141
    v_cvt_pk_bf16_f32 v41, v142, v143
    v_or_b32 v40, 1, v40
    v_cvt_pk_bf16_f32 v42, v144, v145
    v_cvt_pk_bf16_f32 v43, v146, v147
    v_or_b32 v42, 1, v42
    s_cmp_eq_u32 s88, 0
    s_cbranch_scc1 Lss_19
    buffer_store_dwordx4 v[36:39], v153, s[64:67], s12 offen
    buffer_store_dwordx4 v[40:43], v153, s[64:67], s12 offen offset:1024
    s_mov_b32 exec_lo, 0xffff
    s_mov_b32 exec_hi, 0xffff
    buffer_store_dwordx4 v[44:47], v84, s[64:67], s12 offen offset:2048
Lsd_20:
    s_mov_b64 exec, -1
    v_pk_add_f32 v[4:5], v[132:133], v[134:135]
    v_pk_mul_f32 v[6:7], v[132:133], v[132:133]
    v_pk_fma_f32 v[6:7], v[134:135], v[134:135], v[6:7]
    v_pk_fma_f32 v[6:7], v[136:137], v[136:137], v[6:7]
    v_pk_add_f32 v[4:5], v[4:5], v[136:137]
    v_pk_fma_f32 v[6:7], v[138:139], v[138:139], v[6:7]
    v_pk_add_f32 v[4:5], v[4:5], v[138:139]
    v_pk_fma_f32 v[6:7], v[140:141], v[140:141], v[6:7]
    v_pk_add_f32 v[4:5], v[4:5], v[140:141]
    v_pk_fma_f32 v[6:7], v[142:143], v[142:143], v[6:7]
    v_pk_add_f32 v[4:5], v[4:5], v[142:143]
    v_pk_fma_f32 v[6:7], v[144:145], v[144:145], v[6:7]
    v_pk_add_f32 v[4:5], v[4:5], v[144:145]
    v_pk_fma_f32 v[6:7], v[146:147], v[146:147], v[6:7]
    v_pk_add_f32 v[4:5], v[4:5], v[146:147]
    v_pk_fma_f32 v[6:7], v[148:149], v[148:149], v[6:7]
    v_pk_add_f32 v[4:5], v[4:5], v[148:149]
    v_pk_fma_f32 v[6:7], v[150:151], v[150:151], v[6:7]
    v_pk_add_f32 v[4:5], v[4:5], v[150:151]
    v_add_f32 v6, v6, v7
    v_add_f32 v4, v4, v5
    v_mov_b32 v1, s82
    s_nop 0
    v_permlane32_swap_b32 v4, v6
    v_add_f32 v4, v4, v6
    v_mov_b32 v6, v4
    s_nop 1
    v_permlane16_swap_b32 v4, v6
    v_add_f32 v0, v4, v6

    s_add_u32 s98, s98, 0x40000
    s_addc_u32 s99, s99, 0
    s_cmp_eq_u32 s88, 0
    s_cbranch_scc1 Lss_21
    global_store_dwordx2 v155, v[0:1], s[98:99]
Lsd_22:
    v_bfe_u32 v122, v152, 2, 2
    s_lshl_b32 s3, s77, 4
    s_add_u32 s3, s3, 92160
    v_lshl_add_u32 v120, v122, 6, s3
    s_lshl_b32 s3, s77, 3
    s_add_u32 s3, s3, 92672
    v_lshl_add_u32 v121, v122, 6, s3
    v_bfe_u32 v122, v152, 0, 2
    v_lshl_add_u32 v120, v122, 2, v120
    v_bfe_u32 v122, v152, 0, 1
    v_lshl_add_u32 v121, v122, 5, v121
    v_bfe_u32 v122, v152, 1, 1
    v_lshl_add_u32 v121, v122, 2, v121
    v_and_b32 v122, 15, v152
    s_lshl_b32 s3, s77, 7
    s_add_u32 s3, s3, 81920
    v_lshl_add_u32 v165, v122, 3, s3
    v_bfe_u32 v171, v152, 1, 2
    s_lshl_b32 s3, s77, 5
    s_add_u32 s3, s3, 82432
    v_lshl_add_u32 v171, v171, 3, s3
    v_not_b32 v122, v152
    v_lshlrev_b32 v122, 28, v122
    v_and_b32 v170, 0x80000000, v122
    v_lshrrev_b32 v122, 4, v152
    s_mov_b32 s3, 92160
    v_lshl_add_u32 v164, v122, 6, s3
    v_and_b32 v48, 1, v152
    v_lshl_add_u32 v50, v48, 5, v164
    v_lshlrev_b32 v48, 2, v48
    v_lshl_add_u32 v48, v122, 8, v48
    v_and_b32 v122, 1, v122
    v_xor_b32 v122, s77, v122
    v_lshl_add_u32 v48, v122, 6, v48
    v_bfe_u32 v122, v152, 1, 2
    v_lshl_add_u32 v48, v122, 4, v48
    v_bfe_u32 v122, v152, 3, 1
    v_lshlrev_b32 v122, 12, v122
    s_mov_b32 s3, 0
    v_add3_u32 v48, v122, v48, s3
    v_xor_b32 v49, 8, v48
L_xp:
    s_sub_u32 s101, s101, 1
    s_cbranch_scc1 L_end
    buffer_load_dword v168, v85, s[64:67], 0 offen sc1
    s_add_u32 m0, s100, 0
    s_nop 0
    buffer_load_dwordx4 v173, s[64:67], s72 offen offset:0 sc1 lds
    s_add_u32 m0, s100, 8192
    s_add_u32 s83, s72, 10240
    buffer_load_dwordx4 v173, s[64:67], s83 offen offset:0 sc1 lds
    s_add_u32 m0, s100, 0
    s_nop 0
    buffer_load_dwordx4 v173, s[64:67], s72 offen offset:1024 sc1 lds
    s_add_u32 m0, s100, 8192
    s_add_u32 s83, s72, 10240
    buffer_load_dwordx4 v173, s[64:67], s83 offen offset:1024 sc1 lds
    s_waitcnt vmcnt(4)
    v_and_b32 v168, 1, v168
    v_cmp_ne_u32 vcc, 1, v168
    s_cbranch_vccnz L_xp
    s_waitcnt vmcnt(2)
    s_barrier
    ds_read_b128 v[56:59], v158 offset:0
    ds_read_b128 v[60:63], v158 offset:2048
    ds_read_b128 v[64:67], v158 offset:4096
    ds_read_b128 v[68:71], v158 offset:6144
    s_add_u32 m0, s100, 16384
    s_nop 0
    buffer_load_dwordx4 v173, s[64:67], s73 offen offset:0 sc1 lds
    s_add_u32 m0, s100, 16384
    s_nop 0
    buffer_load_dwordx4 v173, s[64:67], s73 offen offset:1024 sc1 lds
    s_waitcnt vmcnt(2)
    s_barrier
    ds_read_b128 v[72:75], v158 offset:1024
    ds_read_b128 v[76:79], v158 offset:3072
    ds_read_b128 v[80:83], v158 offset:5120
    ds_read_b128 v[84:87], v158 offset:7168
    ds_read_b128 v[88:91], v159 offset:0
    ds_read_b128 v[92:95], v159 offset:2048
    ds_read_b128 v[96:99], v159 offset:4096
    ds_read_b128 v[100:103], v159 offset:6144
    s_waitcnt lgkmcnt(8)
    v_bitop3_b32 v169, v56, v60, v64 bitop3:128
    v_bitop3_b32 v169, v169, v68, 1 bitop3:128
    v_cmp_ne_u32 s[96:97], 1, v169
    s_cmp_lg_u64 s[96:97], 0
    s_cbranch_scc1 L_xc0r
L_xc0:
    v_mfma_f32_16x16x32_bf16 v[0:3], v[56:59], a[0:3], 0
    s_add_u32 m0, s100, 24576
    s_add_u32 s83, s73, 10240
    buffer_load_dwordx4 v173, s[64:67], s83 offen offset:0 sc1 lds
    v_mfma_f32_16x16x32_bf16 v[16:19], v[56:59], a[8:11], 0
    v_mfma_f32_16x16x32_bf16 v[32:35], v[56:59], a[16:19], 0
    ds_read_b128 v[56:59], v159 offset:1024
    v_mfma_f32_16x16x32_bf16 v[4:7], v[60:63], a[0:3], 0
    s_add_u32 m0, s100, 24576
    s_add_u32 s83, s73, 10240
    buffer_load_dwordx4 v173, s[64:67], s83 offen offset:1024 sc1 lds
    v_mfma_f32_16x16x32_bf16 v[20:23], v[60:63], a[8:11], 0
    v_mfma_f32_16x16x32_bf16 v[36:39], v[60:63], a[16:19], 0
    ds_read_b128 v[60:63], v159 offset:3072
    v_mfma_f32_16x16x32_bf16 v[8:11], v[64:67], a[0:3], 0
    s_add_u32 m0, s100, 32768
    s_nop 0
    buffer_load_dwordx4 v173, s[64:67], s74 offen offset:0 sc1 lds
    v_mfma_f32_16x16x32_bf16 v[24:27], v[64:67], a[8:11], 0
    s_waitcnt lgkmcnt(6)
    v_bitop3_b32 v169, v72, v76, v80 bitop3:128
    v_bitop3_b32 v169, v169, v84, 1 bitop3:128
    v_mfma_f32_16x16x32_bf16 v[40:43], v[64:67], a[16:19], 0
    ds_read_b128 v[64:67], v159 offset:5120
    v_cmp_ne_u32 s[96:97], 1, v169
    v_mfma_f32_16x16x32_bf16 v[12:15], v[68:71], a[0:3], 0
    s_add_u32 m0, s100, 32768
    s_nop 0
    buffer_load_dwordx4 v173, s[64:67], s74 offen offset:1024 sc1 lds
    v_mfma_f32_16x16x32_bf16 v[28:31], v[68:71], a[8:11], 0
    v_mfma_f32_16x16x32_bf16 v[44:47], v[68:71], a[16:19], 0
    ds_read_b128 v[68:71], v159 offset:7168
    s_cmp_lg_u64 s[96:97], 0
    s_cbranch_scc1 L_xc1r
L_xc1:
    v_mfma_f32_16x16x32_bf16 v[0:3], v[72:75], a[4:7], v[0:3]
    s_add_u32 m0, s100, 40960
    s_add_u32 s83, s74, 10240
    buffer_load_dwordx4 v173, s[64:67], s83 offen offset:0 sc1 lds
    v_mfma_f32_16x16x32_bf16 v[16:19], v[72:75], a[12:15], v[16:19]
    v_mfma_f32_16x16x32_bf16 v[32:35], v[72:75], a[20:23], v[32:35]
    v_mfma_f32_16x16x32_bf16 v[4:7], v[76:79], a[4:7], v[4:7]
    s_add_u32 m0, s100, 40960
    s_add_u32 s83, s74, 10240
    buffer_load_dwordx4 v173, s[64:67], s83 offen offset:1024 sc1 lds
    v_mfma_f32_16x16x32_bf16 v[20:23], v[76:79], a[12:15], v[20:23]
    v_mfma_f32_16x16x32_bf16 v[36:39], v[76:79], a[20:23], v[36:39]
    v_mfma_f32_16x16x32_bf16 v[8:11], v[80:83], a[4:7], v[8:11]
    global_load_dwordx4 v[104:107], v163, s[98:99] sc1
    v_mfma_f32_16x16x32_bf16 v[24:27], v[80:83], a[12:15], v[24:27]
    s_waitcnt lgkmcnt(4)
    v_bitop3_b32 v169, v88, v92, v96 bitop3:128
    v_bitop3_b32 v169, v169, v100, 1 bitop3:128
    v_mfma_f32_16x16x32_bf16 v[40:43], v[80:83], a[20:23], v[40:43]
    global_load_dwordx4 v[108:111], v163, s[98:99] offset:256 sc1
    v_cmp_ne_u32 s[96:97], 1, v169
    v_mfma_f32_16x16x32_bf16 v[12:15], v[84:87], a[4:7], v[12:15]
    v_mfma_f32_16x16x32_bf16 v[28:31], v[84:87], a[12:15], v[28:31]
    v_mfma_f32_16x16x32_bf16 v[44:47], v[84:87], a[20:23], v[44:47]
    s_cmp_lg_u64 s[96:97], 0
    s_cbranch_scc1 L_xc2r
L_xc2:
    v_mfma_f32_16x16x32_bf16 v[0:3], v[88:91], a[24:27], v[0:3]
    v_mfma_f32_16x16x32_bf16 v[16:19], v[88:91], a[32:35], v[16:19]
    v_mfma_f32_16x16x32_bf16 v[4:7], v[92:95], a[24:27], v[4:7]
    v_mfma_f32_16x16x32_bf16 v[20:23], v[92:95], a[32:35], v[20:23]
    s_waitcnt lgkmcnt(0)
    v_bitop3_b32 v169, v56, v60, v64 bitop3:128
    v_bitop3_b32 v169, v169, v68, 1 bitop3:128
    v_mfma_f32_16x16x32_bf16 v[8:11], v[96:99], a[24:27], v[8:11]
    v_cmp_ne_u32 s[96:97], 1, v169
    v_mfma_f32_16x16x32_bf16 v[24:27], v[96:99], a[32:35], v[24:27]
    v_mfma_f32_16x16x32_bf16 v[12:15], v[100:103], a[24:27], v[12:15]
    s_add_u32 m0, s100, 49152
    s_nop 0
    buffer_load_dwordx4 v173, s[64:67], s75 offen offset:0 sc1 lds
    s_waitcnt vmcnt(3)
    s_barrier
    ds_read_b128 v[72:75], v158 offset:16384
    ds_read_b128 v[76:79], v158 offset:18432
    v_mfma_f32_16x16x32_bf16 v[28:31], v[100:103], a[32:35], v[28:31]
    ds_read_b128 v[80:83], v158 offset:20480
    ds_read_b128 v[84:87], v158 offset:22528
    s_cmp_lg_u64 s[96:97], 0
    s_cbranch_scc1 L_xc3r
L_xc3:
    v_mfma_f32_16x16x32_bf16 v[0:3], v[56:59], a[28:31], v[0:3]
    ds_read_b128 v[88:91], v158 offset:17408
    ds_read_b128 v[92:95], v158 offset:19456
    v_mfma_f32_16x16x32_bf16 v[16:19], v[56:59], a[36:39], v[16:19]
    s_add_u32 m0, s100, 49152
    s_nop 0
    buffer_load_dwordx4 v173, s[64:67], s75 offen offset:1024 sc1 lds
    ds_read_b128 v[96:99], v158 offset:21504
    ds_read_b128 v[100:103], v158 offset:23552
    v_mfma_f32_16x16x32_bf16 v[4:7], v[60:63], a[28:31], v[4:7]
    ds_read_b128 v[56:59], v158 offset:32768
    v_mfma_f32_16x16x32_bf16 v[20:23], v[60:63], a[36:39], v[20:23]
    ds_read_b128 v[60:63], v158 offset:34816
    s_waitcnt lgkmcnt(6)
    v_bitop3_b32 v169, v72, v76, v80 bitop3:128
    v_bitop3_b32 v169, v169, v84, 1 bitop3:128
    v_mfma_f32_16x16x32_bf16 v[8:11], v[64:67], a[28:31], v[8:11]
    s_add_u32 m0, s100, 57344
    s_add_u32 s83, s75, 10240
    buffer_load_dwordx4 v173, s[64:67], s83 offen offset:0 sc1 lds
    v_cmp_ne_u32 s[96:97], 1, v169
    v_mfma_f32_16x16x32_bf16 v[24:27], v[64:67], a[36:39], v[24:27]
    ds_read_b128 v[64:67], v158 offset:36864
    v_mfma_f32_16x16x32_bf16 v[12:15], v[68:71], a[28:31], v[12:15]
    v_mfma_f32_16x16x32_bf16 v[28:31], v[68:71], a[36:39], v[28:31]
    s_add_u32 m0, s100, 57344
    s_add_u32 s83, s75, 10240
    buffer_load_dwordx4 v173, s[64:67], s83 offen offset:1024 sc1 lds
    ds_read_b128 v[68:71], v158 offset:38912
    s_cmp_lg_u64 s[96:97], 0
    s_cbranch_scc1 L_xc4r
L_xc4:
    v_mfma_f32_16x16x32_bf16 v[0:3], v[72:75], a[40:43], v[0:3]
    v_mfma_f32_16x16x32_bf16 v[16:19], v[72:75], a[48:51], v[16:19]
    v_mfma_f32_16x16x32_bf16 v[32:35], v[72:75], a[56:59], v[32:35]
    s_add_u32 m0, s100, 65536
    s_nop 0
    buffer_load_dwordx4 v173, s[64:67], s76 offen offset:0 sc1 lds
    ds_read_b128 v[72:75], v158 offset:33792
    v_mfma_f32_16x16x32_bf16 v[4:7], v[76:79], a[40:43], v[4:7]
    v_mfma_f32_16x16x32_bf16 v[20:23], v[76:79], a[48:51], v[20:23]
    v_mfma_f32_16x16x32_bf16 v[36:39], v[76:79], a[56:59], v[36:39]
    s_add_u32 m0, s100, 65536
    s_nop 0
    buffer_load_dwordx4 v173, s[64:67], s76 offen offset:1024 sc1 lds
    ds_read_b128 v[76:79], v158 offset:35840
    v_mfma_f32_16x16x32_bf16 v[8:11], v[80:83], a[40:43], v[8:11]
    v_mfma_f32_16x16x32_bf16 v[24:27], v[80:83], a[48:51], v[24:27]
    s_waitcnt lgkmcnt(6)
    v_bitop3_b32 v169, v88, v92, v96 bitop3:128
    v_bitop3_b32 v169, v169, v100, 1 bitop3:128
    v_mfma_f32_16x16x32_bf16 v[40:43], v[80:83], a[56:59], v[40:43]
    s_add_u32 m0, s100, 73728
    s_add_u32 s83, s76, 10240
    buffer_load_dwordx4 v173, s[64:67], s83 offen offset:0 sc1 lds
    ds_read_b128 v[80:83], v158 offset:37888
    v_cmp_ne_u32 s[96:97], 1, v169
    v_mfma_f32_16x16x32_bf16 v[12:15], v[84:87], a[40:43], v[12:15]
    v_mfma_f32_16x16x32_bf16 v[28:31], v[84:87], a[48:51], v[28:31]
    v_mfma_f32_16x16x32_bf16 v[44:47], v[84:87], a[56:59], v[44:47]
    s_add_u32 m0, s100, 73728
    s_add_u32 s83, s76, 10240
    buffer_load_dwordx4 v173, s[64:67], s83 offen offset:1024 sc1 lds
    ds_read_b128 v[84:87], v158 offset:39936
    s_cmp_lg_u64 s[96:97], 0
    s_cbranch_scc1 L_xc5r
L_xc5:
    v_mfma_f32_16x16x32_bf16 v[0:3], v[88:91], a[44:47], v[0:3]
    v_mfma_f32_16x16x32_bf16 v[16:19], v[88:91], a[52:55], v[16:19]
    v_mfma_f32_16x16x32_bf16 v[32:35], v[88:91], a[60:63], v[32:35]
    v_mfma_f32_16x16x32_bf16 v[4:7], v[92:95], a[44:47], v[4:7]
    v_mfma_f32_16x16x32_bf16 v[20:23], v[92:95], a[52:55], v[20:23]
    s_waitcnt vmcnt(8)
    L_s2:
    v_min3_u32 v168, v105, v107, v109
    v_max3_u32 v105, v105, v107, v109
    v_min3_u32 v168, v168, v111, s82
    v_max3_u32 v105, v105, v111, s82
    v_cmp_ne_u32 vcc, v168, v105

    s_cbranch_vccnz L_s2r
    v_mfma_f32_16x16x32_bf16 v[36:39], v[92:95], a[60:63], v[36:39]
    v_add_f32 v104, v104, v108
    v_add_f32 v106, v106, v110
    v_mfma_f32_16x16x32_bf16 v[8:11], v[96:99], a[44:47], v[8:11]
    s_nop 0
    v_permlane32_swap_b32 v104, v106
    v_add_f32 v104, v104, v106
    v_mfma_f32_16x16x32_bf16 v[24:27], v[96:99], a[52:55], v[24:27]
    s_waitcnt lgkmcnt(4)
    v_bitop3_b32 v169, v56, v60, v64 bitop3:128
    v_bitop3_b32 v169, v169, v68, 1 bitop3:128
    v_mfma_f32_16x16x32_bf16 v[40:43], v[96:99], a[60:63], v[40:43]
    v_cmp_ne_u32 s[96:97], 1, v169
    v_mov_b32 v106, v104
    v_mfma_f32_16x16x32_bf16 v[12:15], v[100:103], a[44:47], v[12:15]
    s_nop 0
    v_permlane16_swap_b32 v104, v106
    v_add_f32 v104, v104, v106
    v_mfma_f32_16x16x32_bf16 v[28:31], v[100:103], a[52:55], v[28:31]
    v_mov_b32 v106, v104
    s_nop 1
    v_permlane32_swap_b32 v104, v106
    v_mfma_f32_16x16x32_bf16 v[44:47], v[100:103], a[60:63], v[44:47]
    v_mul_f32 v104, 0x3acccccd, v104
    v_mov_b32 v166, 0x3727c5ac
    s_cmp_lg_u64 s[96:97], 0
    s_cbranch_scc1 L_xc6r
L_xc6:
    v_mfma_f32_16x16x32_bf16 v[0:3], v[56:59], a[80:83], v[0:3]
    v_fmac_f32 v166, 0x3acccccd, v106
    v_fma_f32 v166, -v104, v104, v166
    v_mfma_f32_16x16x32_bf16 v[16:19], v[56:59], a[88:91], v[16:19]
    v_max_f32 v166, 0x3727c5ac, v166
    v_rsq_f32 v166, v166
    v_mfma_f32_16x16x32_bf16 v[32:35], v[56:59], a[96:99], v[32:35]
    v_mul_f32_e64 v167, -v104, v166
    v_xor_b32 v104, 0x80000000, v104
    v_mfma_f32_16x16x32_bf16 v[4:7], v[60:63], a[80:83], v[4:7]
    s_mov_b64 exec, 0xffff
    ds_write2st64_b32 v120, v104, v166 offset1:1
    ds_write2st64_b32 v121, v104, v166 offset1:1
    s_mov_b64 exec, -1
    v_mfma_f32_16x16x32_bf16 v[20:23], v[60:63], a[88:91], v[20:23]
    s_add_u32 s98, s98, 0x40000
    s_addc_u32 s99, s99, 0
    v_mfma_f32_16x16x32_bf16 v[36:39], v[60:63], a[96:99], v[36:39]
    v_mfma_f32_16x16x32_bf16 v[8:11], v[64:67], a[80:83], v[8:11]
    v_mfma_f32_16x16x32_bf16 v[24:27], v[64:67], a[88:91], v[24:27]
    s_waitcnt lgkmcnt(2)
    v_bitop3_b32 v169, v72, v76, v80 bitop3:128
    v_bitop3_b32 v169, v169, v84, 1 bitop3:128
    v_mfma_f32_16x16x32_bf16 v[40:43], v[64:67], a[96:99], v[40:43]
    v_cmp_ne_u32 s[96:97], 1, v169
    v_mfma_f32_16x16x32_bf16 v[12:15], v[68:71], a[80:83], v[12:15]
    v_mfma_f32_16x16x32_bf16 v[28:31], v[68:71], a[88:91], v[28:31]
    v_mfma_f32_16x16x32_bf16 v[44:47], v[68:71], a[96:99], v[44:47]
    s_cmp_lg_u64 s[96:97], 0
    s_cbranch_scc1 L_xc7r
L_xc7:
    s_waitcnt lgkmcnt(0)
    v_mfma_f32_16x16x32_bf16 v[0:3], v[72:75], a[84:87], v[0:3]
    s_waitcnt vmcnt(0)
    s_barrier
    ds_read_b128 v[88:91], v158 offset:49152
    ds_read_b128 v[92:95], v158 offset:51200
    v_mfma_f32_16x16x32_bf16 v[16:19], v[72:75], a[92:95], v[16:19]
    ds_read_b128 v[96:99], v158 offset:53248
    ds_read_b128 v[100:103], v158 offset:55296
    v_mfma_f32_16x16x32_bf16 v[32:35], v[72:75], a[100:103], v[32:35]
    ds_read_b128 v[56:59], v158 offset:50176
    ds_read_b128 v[60:63], v158 offset:52224
    v_mfma_f32_16x16x32_bf16 v[4:7], v[76:79], a[84:87], v[4:7]
    ds_read_b128 v[64:67], v158 offset:54272
    ds_read_b128 v[68:71], v158 offset:56320
    v_mfma_f32_16x16x32_bf16 v[20:23], v[76:79], a[92:95], v[20:23]
    v_add_u32 v158, 0x10000, v158
    ds_read_b128 v[72:75], v158 offset:0
    v_mfma_f32_16x16x32_bf16 v[36:39], v[76:79], a[100:103], v[36:39]
    ds_read_b128 v[76:79], v158 offset:1024
    v_mfma_f32_16x16x32_bf16 v[8:11], v[80:83], a[84:87], v[8:11]
    v_mfma_f32_16x16x32_bf16 v[24:27], v[80:83], a[92:95], v[24:27]
    s_waitcnt lgkmcnt(6)
    v_bitop3_b32 v169, v88, v92, v96 bitop3:128
    v_bitop3_b32 v169, v169, v100, 1 bitop3:128
    v_mfma_f32_16x16x32_bf16 v[40:43], v[80:83], a[100:103], v[40:43]
    ds_read_b128 v[80:83], v158 offset:2048
    v_cmp_ne_u32 s[96:97], 1, v169
    v_mfma_f32_16x16x32_bf16 v[12:15], v[84:87], a[84:87], v[12:15]
    v_mfma_f32_16x16x32_bf16 v[28:31], v[84:87], a[92:95], v[28:31]
    s_lshl_b32 s3, s78, 2
    s_add_u32 s3, s3, s77
    s_lshl_b32 s3, s3, 13
    v_mfma_f32_16x16x32_bf16 v[44:47], v[84:87], a[100:103], v[44:47]
    ds_read_b128 v[84:87], v158 offset:3072
    s_add_u32 s3, s3, 9699328
    s_cmp_lg_u64 s[96:97], 0
    s_cbranch_scc1 L_xc8r
L_xc8:
    v_mfma_f32_16x16x32_bf16 v[0:3], v[88:91], a[120:123], v[0:3]
    s_add_u32 s92, s50, s3
    s_addc_u32 s93, s51, 0
    s_movk_i32 s94, 8192
    v_mfma_f32_16x16x32_bf16 v[16:19], v[88:91], a[128:131], v[16:19]
    s_sub_u32 s21, 31, s79
    s_lshl_b32 s21, s21, 8
    s_lshl_b32 s3, s77, 12
    v_and_b32 v52, 16, v152
    v_lshlrev_b32 v52, 2, v52
    v_mfma_f32_16x16x32_bf16 v[32:35], v[88:91], a[136:139], v[32:35]
    ds_read_b128 v[88:91], v158 offset:4096
    v_xor_b32 v52, v52, v153
    v_add_u32 v52, s3, v52
    v_mfma_f32_16x16x32_bf16 v[4:7], v[92:95], a[120:123], v[4:7]
    ds_read_b64 v[128:129], v165 offset:7680
    ds_read_b64 v[130:131], v171 offset:7680
    ds_read_b128 v[104:107], v164 offset:0
    v_mfma_f32_16x16x32_bf16 v[20:23], v[92:95], a[128:131], v[20:23]
    ds_read_b128 v[108:111], v164 offset:256
    ds_read_b128 v[112:115], v164 offset:16
    ds_read_b128 v[116:119], v164 offset:272
    v_mfma_f32_16x16x32_bf16 v[36:39], v[92:95], a[136:139], v[36:39]
    ds_read_b128 v[92:95], v158 offset:5120
    v_mfma_f32_16x16x32_bf16 v[8:11], v[96:99], a[120:123], v[8:11]
    v_mfma_f32_16x16x32_bf16 v[24:27], v[96:99], a[128:131], v[24:27]
    s_waitcnt lgkmcnt(12)
    v_bitop3_b32 v169, v56, v60, v64 bitop3:128
    v_bitop3_b32 v169, v169, v68, 1 bitop3:128
    v_mfma_f32_16x16x32_bf16 v[40:43], v[96:99], a[136:139], v[40:43]
    ds_read_b128 v[96:99], v158 offset:6144
    v_cmp_ne_u32 s[96:97], 1, v169
    v_mfma_f32_16x16x32_bf16 v[12:15], v[100:103], a[120:123], v[12:15]
    v_mfma_f32_16x16x32_bf16 v[28:31], v[100:103], a[128:131], v[28:31]
    v_mfma_f32_16x16x32_bf16 v[44:47], v[100:103], a[136:139], v[44:47]
    ds_read_b128 v[100:103], v158 offset:7168
    s_waitcnt lgkmcnt(7)
    v_xor_b32 v131, v170, v131
    s_cmp_lg_u64 s[96:97], 0
    s_cbranch_scc1 L_xc9r
L_xc9:
    v_mfma_f32_16x16x32_bf16 v[0:3], v[56:59], a[124:127], v[0:3]
    v_mfma_f32_16x16x32_bf16 v[16:19], v[56:59], a[132:135], v[16:19]
    v_mfma_f32_16x16x32_bf16 v[32:35], v[56:59], a[140:143], v[32:35]
    v_add_u32 v159, 0x4000, v159
    ds_read_b128 v[56:59], v159 offset:0
    v_mfma_f32_16x16x32_bf16 v[4:7], v[60:63], a[124:127], v[4:7]
    v_mfma_f32_16x16x32_bf16 v[20:23], v[60:63], a[132:135], v[20:23]
    v_mfma_f32_16x16x32_bf16 v[36:39], v[60:63], a[140:143], v[36:39]
    ds_read_b128 v[60:63], v159 offset:1024
    v_mfma_f32_16x16x32_bf16 v[8:11], v[64:67], a[124:127], v[8:11]
    v_mfma_f32_16x16x32_bf16 v[24:27], v[64:67], a[132:135], v[24:27]
    v_bitop3_b32 v169, v72, v76, v80 bitop3:128
    v_bitop3_b32 v169, v169, v84, 1 bitop3:128
    v_mfma_f32_16x16x32_bf16 v[40:43], v[64:67], a[140:143], v[40:43]
    ds_read_b128 v[64:67], v159 offset:16384
    v_cmp_ne_u32 s[96:97], 1, v169
    v_mfma_f32_16x16x32_bf16 v[12:15], v[68:71], a[124:127], v[12:15]
    v_mfma_f32_16x16x32_bf16 v[28:31], v[68:71], a[132:135], v[28:31]
    v_mfma_f32_16x16x32_bf16 v[44:47], v[68:71], a[140:143], v[44:47]
    ds_read_b128 v[68:71], v159 offset:17408
    s_cmp_lg_u64 s[96:97], 0
    s_cbranch_scc1 L_xc10r
L_xc10:
    v_mfma_f32_16x16x32_bf16 v[0:3], v[72:75], a[160:163], v[0:3]
    v_mfma_f32_16x16x32_bf16 v[16:19], v[72:75], a[168:171], v[16:19]
    v_mfma_f32_16x16x32_bf16 v[32:35], v[72:75], a[176:179], v[32:35]
    ds_read_b128 v[72:75], v159 offset:32768
    v_mfma_f32_16x16x32_bf16 v[0:3], v[76:79], a[164:167], v[0:3]
    v_mfma_f32_16x16x32_bf16 v[16:19], v[76:79], a[172:175], v[16:19]
    v_mfma_f32_16x16x32_bf16 v[32:35], v[76:79], a[180:183], v[32:35]
    ds_read_b128 v[76:79], v159 offset:33792
    v_mfma_f32_16x16x32_bf16 v[4:7], v[80:83], a[160:163], v[4:7]
    v_mfma_f32_16x16x32_bf16 v[20:23], v[80:83], a[168:171], v[20:23]
    s_nop 4
    ds_write_b128 v52, v[32:35] offset:0
    s_waitcnt lgkmcnt(7)
    v_bitop3_b32 v169, v88, v92, v96 bitop3:128
    v_bitop3_b32 v169, v169, v100, 1 bitop3:128
    v_mfma_f32_16x16x32_bf16 v[36:39], v[80:83], a[176:179], v[36:39]
    ds_read_b128 v[80:83], v159 offset:49152
    v_cmp_ne_u32 s[96:97], 1, v169
    v_mfma_f32_16x16x32_bf16 v[4:7], v[84:87], a[164:167], v[4:7]
    v_mfma_f32_16x16x32_bf16 v[20:23], v[84:87], a[172:175], v[20:23]
    v_mfma_f32_16x16x32_bf16 v[36:39], v[84:87], a[180:183], v[36:39]
    ds_read_b128 v[84:87], v159 offset:50176
    s_cmp_lg_u64 s[96:97], 0
    s_cbranch_scc1 L_xc11r
L_xc11:
    v_mfma_f32_16x16x32_bf16 v[8:11], v[88:91], a[160:163], v[8:11]
    v_mfma_f32_16x16x32_bf16 v[24:27], v[88:91], a[168:171], v[24:27]
    s_nop 2
    ds_write_b128 v52, v[36:39] offset:1024
    v_mfma_f32_16x16x32_bf16 v[40:43], v[88:91], a[176:179], v[40:43]
    v_mfma_f32_16x16x32_bf16 v[8:11], v[92:95], a[164:167], v[8:11]
    v_mfma_f32_16x16x32_bf16 v[24:27], v[92:95], a[172:175], v[24:27]
    v_mfma_f32_16x16x32_bf16 v[40:43], v[92:95], a[180:183], v[40:43]
    v_mfma_f32_16x16x32_bf16 v[12:15], v[96:99], a[160:163], v[12:15]
    v_mfma_f32_16x16x32_bf16 v[28:31], v[96:99], a[168:171], v[28:31]
    s_nop 5
    ds_write_b128 v52, v[40:43] offset:2048
    s_waitcnt lgkmcnt(7)
    v_bitop3_b32 v169, v56, v60, v64 bitop3:128
    v_bitop3_b32 v169, v169, v68, 1 bitop3:128
    v_cmp_ne_u32 s[96:97], 1, v169
    v_mfma_f32_16x16x32_bf16 v[44:47], v[96:99], a[176:179], v[44:47]
    v_mfma_f32_16x16x32_bf16 v[12:15], v[100:103], a[164:167], v[12:15]
    v_mfma_f32_16x16x32_bf16 v[28:31], v[100:103], a[172:175], v[28:31]
    v_mfma_f32_16x16x32_bf16 v[44:47], v[100:103], a[180:183], v[44:47]
    s_cmp_lg_u64 s[96:97], 0
    s_cbranch_scc1 L_xc12r
L_xc12:
    v_mfma_f32_16x16x32_bf16 v[0:3], v[56:59], a[64:67], v[0:3]
    v_mfma_f32_16x16x32_bf16 v[16:19], v[56:59], a[72:75], v[16:19]
    s_nop 3
    ds_write_b128 v52, v[44:47] offset:3072
    ds_read_b128 v[56:59], v159 offset:2048
    v_mfma_f32_16x16x32_bf16 v[0:3], v[60:63], a[68:71], v[0:3]
    v_mfma_f32_16x16x32_bf16 v[16:19], v[60:63], a[76:79], v[16:19]
    ds_read_b128 v[60:63], v159 offset:3072
    s_waitcnt lgkmcnt(5)
    v_bitop3_b32 v169, v72, v76, v80 bitop3:128
    v_bitop3_b32 v169, v169, v84, 1 bitop3:128
    v_cmp_ne_u32 s[96:97], 1, v169
    v_mfma_f32_16x16x32_bf16 v[0:3], v[64:67], a[104:107], v[0:3]
    v_mfma_f32_16x16x32_bf16 v[16:19], v[64:67], a[112:115], v[16:19]
    ds_read_b128 v[64:67], v159 offset:18432
    v_mfma_f32_16x16x32_bf16 v[0:3], v[68:71], a[108:111], v[0:3]
    v_mfma_f32_16x16x32_bf16 v[16:19], v[68:71], a[116:119], v[16:19]
    ds_read_b128 v[68:71], v159 offset:19456
    s_cmp_lg_u64 s[96:97], 0
    s_cbranch_scc1 L_xc13r
L_xc13:
    v_mfma_f32_16x16x32_bf16 v[0:3], v[72:75], a[144:147], v[0:3]
    v_mfma_f32_16x16x32_bf16 v[16:19], v[72:75], a[152:155], v[16:19]
    ds_read_b128 v[72:75], v159 offset:34816
    v_mfma_f32_16x16x32_bf16 v[0:3], v[76:79], a[148:151], v[0:3]
    s_waitcnt lgkmcnt(5)
    s_barrier
    v_mfma_f32_16x16x32_bf16 v[16:19], v[76:79], a[156:159], v[16:19]
    ds_read_b128 v[76:79], v159 offset:35840
    s_waitcnt lgkmcnt(2)
    ds_read2st64_b32 v[32:33], v48 offset0:0 offset1:32
    v_bitop3_b32 v169, v56, v60, v64 bitop3:128
    v_bitop3_b32 v169, v169, v68, 1 bitop3:128
    v_cmp_ne_u32 s[96:97], 1, v169
    v_mfma_f32_16x16x32_bf16 v[0:3], v[80:83], a[184:187], v[0:3]
    v_mfma_f32_16x16x32_bf16 v[16:19], v[80:83], a[192:195], v[16:19]
    ds_read_b128 v[80:83], v159 offset:51200
    ds_read2st64_b32 v[34:35], v49 offset0:0 offset1:32
    v_mfma_f32_16x16x32_bf16 v[0:3], v[84:87], a[188:191], v[0:3]
    v_mfma_f32_16x16x32_bf16 v[16:19], v[84:87], a[196:199], v[16:19]
    ds_read_b128 v[84:87], v159 offset:52224
    ds_read2st64_b32 v[36:37], v48 offset0:4 offset1:36
    s_cmp_lg_u64 s[96:97], 0
    s_cbranch_scc1 L_xc14r
L_xc14:
    v_mfma_f32_16x16x32_bf16 v[4:7], v[56:59], a[64:67], v[4:7]
    v_mfma_f32_16x16x32_bf16 v[20:23], v[56:59], a[72:75], v[20:23]
    ds_read_b128 v[56:59], v159 offset:4096
    ds_read2st64_b32 v[38:39], v49 offset0:4 offset1:36
    v_mfma_f32_16x16x32_bf16 v[4:7], v[60:63], a[68:71], v[4:7]
    v_fmac_f32 v0, v104, v160
    v_fmac_f32 v1, v105, v160
    v_mfma_f32_16x16x32_bf16 v[20:23], v[60:63], a[76:79], v[20:23]
    ds_read_b128 v[60:63], v159 offset:5120
    s_waitcnt lgkmcnt(4)
    ds_read2st64_b32 v[40:41], v48 offset0:8 offset1:40
    v_bitop3_b32 v169, v72, v76, v80 bitop3:128
    v_bitop3_b32 v169, v169, v84, 1 bitop3:128
    v_cmp_ne_u32 s[96:97], 1, v169
    v_mfma_f32_16x16x32_bf16 v[4:7], v[64:67], a[104:107], v[4:7]
    v_fmac_f32 v16, v104, v161
    v_fmac_f32 v17, v105, v161
    v_mfma_f32_16x16x32_bf16 v[20:23], v[64:67], a[112:115], v[20:23]
    ds_read_b128 v[64:67], v159 offset:20480
    ds_read2st64_b32 v[42:43], v49 offset0:8 offset1:40
    v_mul_f32 v0, v108, v0
    v_mul_f32 v1, v109, v1
    v_mfma_f32_16x16x32_bf16 v[4:7], v[68:71], a[108:111], v[4:7]
    v_mul_f32 v16, v108, v16
    v_mul_f32 v17, v109, v17
    v_mfma_f32_16x16x32_bf16 v[20:23], v[68:71], a[116:119], v[20:23]
    ds_read_b128 v[68:71], v159 offset:21504
    ds_read2st64_b32 v[44:45], v48 offset0:12 offset1:44
    v_fmac_f32 v2, v106, v160
    v_fmac_f32 v3, v107, v160
    s_cmp_lg_u64 s[96:97], 0
    s_cbranch_scc1 L_xc15r
L_xc15:
    v_mfma_f32_16x16x32_bf16 v[4:7], v[72:75], a[144:147], v[4:7]
    v_fmac_f32 v18, v106, v161
    v_fmac_f32 v19, v107, v161
    v_mfma_f32_16x16x32_bf16 v[20:23], v[72:75], a[152:155], v[20:23]
    ds_read_b128 v[72:75], v159 offset:36864
    ds_read2st64_b32 v[46:47], v49 offset0:12 offset1:44
    v_mul_f32 v2, v110, v2
    v_mul_f32 v3, v111, v3
    v_mfma_f32_16x16x32_bf16 v[4:7], v[76:79], a[148:151], v[4:7]
    ds_read_b128 v[88:91], v50 offset:768
    v_mul_f32 v18, v110, v18
    v_mul_f32 v19, v111, v19
    v_mfma_f32_16x16x32_bf16 v[20:23], v[76:79], a[156:159], v[20:23]
    ds_read_b128 v[76:79], v159 offset:37888
    ds_read_b128 v[92:95], v50 offset:784
    ds_read_b128 v[104:107], v164 offset:32
    v_mfma_f32_16x16x32_bf16 v[4:7], v[80:83], a[184:187], v[4:7]
    ds_read_b128 v[52:55], v50 offset:528
    ds_read_b128 v[108:111], v164 offset:288
    v_fma_f32 v124, v0, v128, v2
    v_fma_f32 v125, v1, v128, v3
    v_mfma_f32_16x16x32_bf16 v[20:23], v[80:83], a[192:195], v[20:23]
    ds_read_b128 v[80:83], v159 offset:53248
    ds_read_b128 v[48:51], v50 offset:512
    v_fma_f32 v126, v16, v128, v18
    v_fma_f32 v127, v17, v128, v19
    v_mfma_f32_16x16x32_bf16 v[4:7], v[84:87], a[188:191], v[4:7]
    ds_read_b64 v[96:97], v165 offset:8320
    v_fma_f32 v124, -v16, v129, v124
    v_fma_f32 v125, -v17, v129, v125
    v_mfma_f32_16x16x32_bf16 v[20:23], v[84:87], a[196:199], v[20:23]
    ds_read_b128 v[84:87], v159 offset:54272
    ds_read_b64 v[98:99], v165 offset:8960
    v_fmac_f32 v126, v0, v129
    v_fmac_f32 v127, v1, v129
    s_waitcnt lgkmcnt(15)
    v_mfma_f32_16x16x32_bf16 v[8:11], v[56:59], a[64:67], v[8:11]
    ds_read_b64 v[100:101], v171 offset:8320
    v_mfma_f32_16x16x32_bf16 v[24:27], v[56:59], a[72:75], v[24:27]
    ds_read_b128 v[56:59], v159 offset:6144
    ds_read_b64 v[102:103], v171 offset:8960
    v_mfma_f32_16x16x32_bf16 v[8:11], v[60:63], a[68:71], v[8:11]
    v_fmac_f32 v4, v112, v160
    v_fmac_f32 v5, v113, v160
    v_mfma_f32_16x16x32_bf16 v[24:27], v[60:63], a[76:79], v[24:27]
    ds_read_b128 v[60:63], v159 offset:7168
    v_fmac_f32 v20, v112, v161
    v_fmac_f32 v21, v113, v161
    v_mfma_f32_16x16x32_bf16 v[8:11], v[64:67], a[104:107], v[8:11]
    v_mul_f32 v4, v116, v4
    v_mul_f32 v5, v117, v5
    v_mfma_f32_16x16x32_bf16 v[24:27], v[64:67], a[112:115], v[24:27]
    ds_read_b128 v[64:67], v159 offset:22528
    s_waitcnt lgkmcnt(15)
    v_mul_f32 v20, v116, v20
    v_mul_f32 v21, v117, v21
    v_add_f32 v32, v32, v33
    v_mfma_f32_16x16x32_bf16 v[8:11], v[68:71], a[108:111], v[8:11]
    v_fmac_f32 v6, v114, v160
    v_fmac_f32 v7, v115, v160
    v_add_f32 v34, v34, v35
    v_mfma_f32_16x16x32_bf16 v[24:27], v[68:71], a[116:119], v[24:27]
    ds_read_b128 v[68:71], v159 offset:23552
    v_fmac_f32 v22, v114, v161
    v_fmac_f32 v23, v115, v161
    v_add_f32 v36, v36, v37
    v_mfma_f32_16x16x32_bf16 v[8:11], v[72:75], a[144:147], v[8:11]
    v_mul_f32 v6, v118, v6
    v_mul_f32 v7, v119, v7
    v_add_f32 v38, v38, v39
    v_mfma_f32_16x16x32_bf16 v[24:27], v[72:75], a[152:155], v[24:27]
    ds_read_b128 v[72:75], v159 offset:38912
    v_mul_f32 v22, v118, v22
    v_mul_f32 v23, v119, v23
    v_add_f32 v40, v40, v41
    s_waitcnt lgkmcnt(15)
    v_mfma_f32_16x16x32_bf16 v[8:11], v[76:79], a[148:151], v[8:11]
    ds_read_b128 v[112:115], v164 offset:48
    ds_read_b128 v[116:119], v164 offset:304
    v_fma_f32 v120, v124, v128, v4
    v_fma_f32 v121, v125, v128, v5
    v_add_f32 v42, v42, v43
    v_mfma_f32_16x16x32_bf16 v[24:27], v[76:79], a[156:159], v[24:27]
    ds_read_b128 v[76:79], v159 offset:39936
    v_fma_f32 v122, v126, v128, v20
    v_fma_f32 v123, v127, v128, v21
    v_add_f32 v44, v44, v45
    s_waitcnt lgkmcnt(14)
    v_mfma_f32_16x16x32_bf16 v[8:11], v[80:83], a[184:187], v[8:11]
    v_fma_f32 v120, -v126, v129, v120
    v_fma_f32 v121, -v127, v129, v121
    v_add_f32 v46, v46, v47
    v_mfma_f32_16x16x32_bf16 v[24:27], v[80:83], a[192:195], v[24:27]
    ds_read_b128 v[80:83], v159 offset:55296
    s_waitcnt lgkmcnt(14)
    v_fmac_f32 v122, v124, v129
    v_fmac_f32 v123, v125, v129
    v_fma_f32 v48, v48, v162, v32
    s_waitcnt lgkmcnt(12)
    v_mfma_f32_16x16x32_bf16 v[8:11], v[84:87], a[188:191], v[8:11]
    v_fma_f32 v124, v120, v128, v6
    v_fma_f32 v125, v121, v128, v7
    v_fma_f32 v49, v49, v162, v34
    v_mfma_f32_16x16x32_bf16 v[24:27], v[84:87], a[196:199], v[24:27]
    ds_read_b128 v[84:87], v159 offset:56320
    v_fma_f32 v126, v122, v128, v22
    v_fma_f32 v127, v123, v128, v23
    v_fma_f32 v50, v50, v162, v36
    s_waitcnt lgkmcnt(10)
    v_mfma_f32_16x16x32_bf16 v[12:15], v[56:59], a[64:67], v[12:15]
    v_fma_f32 v124, -v122, v129, v124
    v_fma_f32 v125, -v123, v129, v125
    v_fma_f32 v51, v51, v162, v38
    v_mfma_f32_16x16x32_bf16 v[28:31], v[56:59], a[72:75], v[28:31]
    v_fmac_f32 v126, v120, v129
    v_fmac_f32 v127, v121, v129
    v_fma_f32 v52, v52, v162, v40
    s_waitcnt lgkmcnt(8)
    v_mfma_f32_16x16x32_bf16 v[12:15], v[60:63], a[68:71], v[12:15]
    v_fma_f32 v53, v53, v162, v42
    v_fma_f32 v54, v54, v162, v44
    v_fma_f32 v55, v55, v162, v46
    v_mfma_f32_16x16x32_bf16 v[28:31], v[60:63], a[76:79], v[28:31]
    v_mul_f32 v48, v88, v48
    v_mul_f32 v49, v89, v49
    v_mul_f32 v50, v90, v50
    s_waitcnt lgkmcnt(7)
    v_mfma_f32_16x16x32_bf16 v[12:15], v[64:67], a[104:107], v[12:15]
    v_mul_f32 v51, v91, v51
    v_mul_f32 v52, v92, v52
    v_mul_f32 v53, v93, v53
    v_mfma_f32_16x16x32_bf16 v[28:31], v[64:67], a[112:115], v[28:31]
    v_mul_f32 v54, v94, v54
    v_mul_f32 v55, v95, v55
    v_fmac_f32 v8, v104, v160
    s_waitcnt lgkmcnt(6)
    v_mfma_f32_16x16x32_bf16 v[12:15], v[68:71], a[108:111], v[12:15]
    v_xor_b32 v101, v170, v101
    v_xor_b32 v103, v170, v103
    v_fma_f32 v173, v130, v48, v49
    v_mfma_f32_16x16x32_bf16 v[28:31], v[68:71], a[116:119], v[28:31]
    s_nop 0
    v_fmac_f32_dpp v173, v48, v131 row_ror:8 row_mask:0xf bank_mask:0xf
    v_fma_f32 v172, v130, v173, v50
    s_nop 1
    v_fmac_f32_dpp v172, v173, v131 row_ror:8 row_mask:0xf bank_mask:0xf
    s_waitcnt lgkmcnt(5)
    v_mfma_f32_16x16x32_bf16 v[12:15], v[72:75], a[144:147], v[12:15]
    v_fma_f32 v173, v130, v172, v51
    s_nop 1
    v_fmac_f32_dpp v173, v172, v131 row_ror:8 row_mask:0xf bank_mask:0xf
    v_fma_f32 v172, v130, v173, v52
    v_mfma_f32_16x16x32_bf16 v[28:31], v[72:75], a[152:155], v[28:31]
    s_nop 0
    v_fmac_f32_dpp v172, v173, v131 row_ror:8 row_mask:0xf bank_mask:0xf
    v_fma_f32 v173, v130, v172, v53
    s_nop 1
    v_fmac_f32_dpp v173, v172, v131 row_ror:8 row_mask:0xf bank_mask:0xf
    s_waitcnt lgkmcnt(2)
    v_mfma_f32_16x16x32_bf16 v[12:15], v[76:79], a[148:151], v[12:15]
    v_fma_f32 v172, v130, v173, v54
    s_nop 1
    v_fmac_f32_dpp v172, v173, v131 row_ror:8 row_mask:0xf bank_mask:0xf
    v_fma_f32 v173, v130, v172, v55
    v_mfma_f32_16x16x32_bf16 v[28:31], v[76:79], a[156:159], v[28:31]
    s_nop 0
    v_fmac_f32_dpp v173, v172, v131 row_ror:8 row_mask:0xf bank_mask:0xf
    v_fmac_f32 v9, v105, v160
    v_fmac_f32 v24, v104, v161
    s_waitcnt lgkmcnt(1)
    v_mfma_f32_16x16x32_bf16 v[12:15], v[80:83], a[184:187], v[12:15]
    v_fmac_f32 v25, v105, v161
    v_mul_f32 v8, v108, v8
    v_mul_f32 v9, v109, v9
    v_mfma_f32_16x16x32_bf16 v[28:31], v[80:83], a[192:195], v[28:31]
    v_mul_f32 v24, v108, v24
    v_mul_f32 v25, v109, v25
    v_fmac_f32 v10, v106, v160
    s_waitcnt lgkmcnt(0)
    v_mfma_f32_16x16x32_bf16 v[12:15], v[84:87], a[188:191], v[12:15]
    v_fmac_f32 v11, v107, v160
    v_fmac_f32 v26, v106, v161
    v_fmac_f32 v27, v107, v161
    v_mfma_f32_16x16x32_bf16 v[28:31], v[84:87], a[196:199], v[28:31]
    v_mul_f32 v10, v110, v10
    v_mul_f32 v11, v111, v11
    v_mul_f32 v26, v110, v26
    v_mul_f32 v27, v111, v27
    v_pk_fma_f32 v[120:121], v[124:125], v[128:129], v[8:9] op_sel_hi:[1,0,1]
    v_pk_fma_f32 v[122:123], v[126:127], v[128:129], v[24:25] op_sel_hi:[1,0,1]
    v_pk_fma_f32 v[120:121], v[126:127], v[128:129], v[120:121] op_sel:[0,1,0] neg_lo:[1,0,0] neg_hi:[1,0,0]
    v_pk_fma_f32 v[122:123], v[124:125], v[128:129], v[122:123] op_sel:[0,1,0]
    v_pk_fma_f32 v[124:125], v[120:121], v[128:129], v[10:11] op_sel_hi:[1,0,1]
    v_pk_fma_f32 v[126:127], v[122:123], v[128:129], v[26:27] op_sel_hi:[1,0,1]
    v_pk_fma_f32 v[124:125], v[122:123], v[128:129], v[124:125] op_sel:[0,1,0] neg_lo:[1,0,0] neg_hi:[1,0,0]
    v_pk_fma_f32 v[126:127], v[120:121], v[128:129], v[126:127] op_sel:[0,1,0]
    v_pk_fma_f32 v[12:13], v[112:113], v[160:161], v[12:13] op_sel_hi:[1,0,1]
    v_pk_fma_f32 v[28:29], v[112:113], v[160:161], v[28:29] op_sel:[0,1,0]
    v_pk_fma_f32 v[14:15], v[114:115], v[160:161], v[14:15] op_sel_hi:[1,0,1]
    v_pk_fma_f32 v[30:31], v[114:115], v[160:161], v[30:31] op_sel:[0,1,0]
    v_pk_mul_f32 v[12:13], v[116:117], v[12:13]
    v_pk_mul_f32 v[28:29], v[116:117], v[28:29]
    v_pk_mul_f32 v[14:15], v[118:119], v[14:15]
    v_pk_mul_f32 v[30:31], v[118:119], v[30:31]
    v_pk_fma_f32 v[120:121], v[124:125], v[128:129], v[12:13] op_sel_hi:[1,0,1]
    v_pk_fma_f32 v[122:123], v[126:127], v[128:129], v[28:29] op_sel_hi:[1,0,1]
    v_pk_fma_f32 v[120:121], v[126:127], v[128:129], v[120:121] op_sel:[0,1,0] neg_lo:[1,0,0] neg_hi:[1,0,0]
    v_pk_fma_f32 v[122:123], v[124:125], v[128:129], v[122:123] op_sel:[0,1,0]
    v_pk_fma_f32 v[124:125], v[120:121], v[128:129], v[14:15] op_sel_hi:[1,0,1]
    v_pk_fma_f32 v[126:127], v[122:123], v[128:129], v[30:31] op_sel_hi:[1,0,1]
    v_pk_fma_f32 v[124:125], v[122:123], v[128:129], v[124:125] op_sel:[0,1,0] neg_lo:[1,0,0] neg_hi:[1,0,0]
    v_pk_fma_f32 v[126:127], v[120:121], v[128:129], v[126:127] op_sel:[0,1,0]
    v_mul_f32 v59, v100, v173
    v_fma_f32 v56, v96, v124, v125
    v_fma_f32 v57, v96, v126, v127
    v_fmac_f32_dpp v59, v173, v101 row_ror:8 row_mask:0xf bank_mask:0xf
    v_mov_b32_dpp v58, v173 quad_perm:[1,1,3,3] row_mask:0xf bank_mask:0xf
    v_fma_f32 v56, -v97, v126, v56
    v_fmac_f32 v57, v97, v124
    v_add_f32_dpp v58, v59, v58 quad_perm:[0,0,2,2] row_mask:0xf bank_mask:0xf
    v_mov_b64 v[64:65], v[56:57]
    v_mov_b32 v66, v58
    v_mov_b32 v71, s82
    v_permlane32_swap_b32 v56, v64
    v_permlane32_swap_b32 v57, v65
    v_permlane32_swap_b32 v58, v66
    v_mov_b64 v[60:61], v[56:57]
    v_mov_b32 v62, v58
    v_mov_b64 v[68:69], v[64:65]
    v_mov_b32 v70, v66

    v_permlane16_swap_b32 v58, v62
    v_permlane16_swap_b32 v56, v60
    v_permlane16_swap_b32 v57, v61
    v_permlane16_swap_b32 v66, v70
    v_fmac_f32_dpp v62, v58, v103 row_ror:8 row_mask:0xf bank_mask:0xf
    v_pk_fma_f32 v[60:61], v[56:57], v[98:99], v[60:61] op_sel_hi:[1,0,1]
    v_permlane16_swap_b32 v64, v68
    v_fmac_f32 v62, v102, v58
    v_pk_fma_f32 v[60:61], v[56:57], v[98:99], v[60:61] op_sel:[1,1,0] op_sel_hi:[0,1,1] neg_lo:[1,0,0]
    v_permlane16_swap_b32 v65, v69
    v_fmac_f32_dpp v66, v62, v103 row_ror:8 row_mask:0xf bank_mask:0xf
    v_fmac_f32 v66, v102, v62
    v_pk_fma_f32 v[64:65], v[60:61], v[98:99], v[64:65] op_sel_hi:[1,0,1]
    v_pk_fma_f32 v[64:65], v[60:61], v[98:99], v[64:65] op_sel:[1,1,0] op_sel_hi:[0,1,1] neg_lo:[1,0,0]
    v_fmac_f32_dpp v70, v66, v103 row_ror:8 row_mask:0xf bank_mask:0xf
    v_fmac_f32 v70, v102, v66
    v_pk_fma_f32 v[68:69], v[64:65], v[98:99], v[68:69] op_sel_hi:[1,0,1]
    v_pk_fma_f32 v[68:69], v[64:65], v[98:99], v[68:69] op_sel:[1,1,0] op_sel_hi:[0,1,1] neg_lo:[1,0,0]
    s_mov_b64 exec, 0xffff
    buffer_store_dwordx4 v[68:71], v153, s[92:95], s21 offen sc1
    s_mov_b64 exec, -1
    v_and_b32 v110, 1, v152
    v_mul_u32_u24 v110, 640, v110
    v_add_u32 v110, v171, v110
    ds_read2_b32 v[72:73], v165 offset1:160
    ds_read2_b32 v[74:75], v165 offset0:1 offset1:161
    ds_read_b64 v[76:77], v171 offset:0
    ds_read_b64 v[78:79], v110 offset:0
    v_lshrrev_b32 v109, 4, v152
    s_mov_b32 s4, 93696
    v_lshl_add_u32 v108, v109, 5, s4
    v_lshl_add_u32 v109, v109, 4, s4
    ds_read_b128 v[88:91], v108 offset:0
    ds_read_b128 v[92:95], v108 offset:16
    ds_read_b128 v[96:99], v108 offset:128
    ds_read_b128 v[100:103], v108 offset:144
    ds_read_b128 v[104:107], v109 offset:256
    s_lshl_b32 s8, s79, 13
    s_add_u32 s8, s8, 11272192
    s_and_b32 s4, s91, 31
    s_lshl_b32 s4, s4, 2
    s_add_u32 s4, s4, s8
    v_mov_b32 v110, s4
    s_not_b32 s13, s82
    v_mov_b32 v111, s13
    v_and_b32 v87, 31, v152
    v_lshl_add_u32 v87, v87, 2, s8
    s_cmp_eq_u32 s88, 0
    s_cbranch_scc1 Lss_23
    global_store_dword v110, v111, s[50:51]
Lsd_24:
    s_movk_i32 s9, 0x70
    v_lshrrev_b32 v164, 3, v152
    v_lshlrev_b32 v164, 12, v164
    v_and_or_b32 v164, v153, s9, v164
    s_mul_i32 s6, s78, 327680
    s_lshl_b32 s5, s79, 7
    s_add_u32 s6, s6, s5
    s_lshl_b32 s5, s77, 14
    s_add_u32 s7, s6, s5
    s_add_u32 s7, s7, 262144
    s_lshl_b32 s5, s77, 16
    s_add_u32 s6, s6, s5
    s_mov_b32 s5, 3145728
    s_add_u32 s6, s6, s5
    s_add_u32 s7, s7, s5
    s_lshl_b32 s5, s77, 9
    s_barrier
    s_add_u32 m0, s100, 61440
    s_nop 0
    buffer_load_dwordx4 v164, s[68:71], s6 offen sc1 lds
    s_add_u32 m0, s100, 62464
    s_add_u32 s83, s6, 32768
    buffer_load_dwordx4 v164, s[68:71], s83 offen sc1 lds
    s_add_u32 m0, s5, 69632
    s_mov_b32 exec_hi, 0
    buffer_load_dwordx4 v164, s[68:71], s7 offen sc1 lds
    s_mov_b32 exec_hi, -1
    v_mov_b32 v59, 0
    s_waitcnt lgkmcnt(5)
    v_xor_b32 v76, v170, v76
    v_xor_b32 v78, v170, v78
    v_mov_b32_dpp v56, v60 quad_perm:[0,1,2,3] row_mask:4 bank_mask:0xf
    v_mov_b32_dpp v57, v61 quad_perm:[0,1,2,3] row_mask:4 bank_mask:0xf
    v_mov_b32_dpp v58, v62 quad_perm:[0,1,2,3] row_mask:4 bank_mask:0xf
    v_mov_b32_dpp v56, v64 quad_perm:[0,1,2,3] row_mask:8 bank_mask:0xf
    v_mov_b32_dpp v57, v65 quad_perm:[0,1,2,3] row_mask:8 bank_mask:0xf
    v_mov_b32_dpp v58, v66 quad_perm:[0,1,2,3] row_mask:8 bank_mask:0xf
    v_mov_b32_dpp v56, v59 quad_perm:[0,1,2,3] row_mask:1 bank_mask:0xf
    v_mov_b32_dpp v57, v59 quad_perm:[0,1,2,3] row_mask:1 bank_mask:0xf
    v_mov_b32_dpp v58, v59 quad_perm:[0,1,2,3] row_mask:1 bank_mask:0xf
    v_mul_f32_dpp v63, -v173, v77 row_ror:8 row_mask:0xf bank_mask:0xf
    v_fma_f32 v63, -v76, v173, v63
    v_mul_f32_dpp v84, -v58, v79 row_ror:8 row_mask:0xf bank_mask:0xf
    v_pk_mul_f32 v[80:81], v[72:73], v[56:57] op_sel_hi:[1,0]
    v_pk_mul_f32 v[82:83], v[72:73], v[56:57] op_sel:[0,1]
    v_pk_fma_f32 v[80:81], v[74:75], v[56:57], v[80:81] op_sel:[0,1,0] neg_lo:[1,0,0] neg_hi:[1,0,0]
    v_pk_fma_f32 v[82:83], v[74:75], v[56:57], v[82:83] op_sel_hi:[1,0,1]
    v_fma_f32 v84, -v78, v58, v84
    v_fmac_f32 v81, v72, v124
    v_fmac_f32 v83, v72, v126
    v_fma_f32 v81, -v74, v126, v81
    v_fmac_f32 v83, v74, v124
    v_mov_b32_dpp v59, v63 quad_perm:[0,0,2,2] row_mask:0xf bank_mask:0xf
    s_mov_b32 exec_lo, 0xaaaaaaaa
    s_mov_b32 exec_hi, 0xaaaaaaaa
    v_add_f32 v84, v84, v59
    s_mov_b64 exec, -1
    s_waitcnt lgkmcnt(0)
    v_pk_fma_f32 v[112:113], v[132:133], v[166:167], v[166:167] op_sel:[0,0,1] op_sel_hi:[1,0,1]
    v_pk_fma_f32 v[114:115], v[134:135], v[166:167], v[166:167] op_sel:[0,0,1] op_sel_hi:[1,0,1]
    v_pk_fma_f32 v[132:133], v[112:113], v[88:89], v[132:133]
    v_pk_fma_f32 v[134:135], v[114:115], v[90:91], v[134:135]
    v_pk_fma_f32 v[112:113], v[136:137], v[166:167], v[166:167] op_sel:[0,0,1] op_sel_hi:[1,0,1]
    v_pk_fma_f32 v[114:115], v[138:139], v[166:167], v[166:167] op_sel:[0,0,1] op_sel_hi:[1,0,1]
    v_pk_fma_f32 v[136:137], v[112:113], v[92:93], v[136:137]
    v_pk_fma_f32 v[138:139], v[114:115], v[94:95], v[138:139]
    v_pk_fma_f32 v[112:113], v[140:141], v[166:167], v[166:167] op_sel:[0,0,1] op_sel_hi:[1,0,1]
    v_pk_fma_f32 v[114:115], v[142:143], v[166:167], v[166:167] op_sel:[0,0,1] op_sel_hi:[1,0,1]
    v_pk_fma_f32 v[140:141], v[112:113], v[96:97], v[140:141]
    v_pk_fma_f32 v[142:143], v[114:115], v[98:99], v[142:143]
    v_pk_fma_f32 v[112:113], v[144:145], v[166:167], v[166:167] op_sel:[0,0,1] op_sel_hi:[1,0,1]
    v_pk_fma_f32 v[114:115], v[146:147], v[166:167], v[166:167] op_sel:[0,0,1] op_sel_hi:[1,0,1]
    v_pk_fma_f32 v[144:145], v[112:113], v[100:101], v[144:145]
    v_pk_fma_f32 v[146:147], v[114:115], v[102:103], v[146:147]
    v_pk_fma_f32 v[112:113], v[148:149], v[166:167], v[166:167] op_sel:[0,0,1] op_sel_hi:[1,0,1]
    v_pk_fma_f32 v[114:115], v[150:151], v[166:167], v[166:167] op_sel:[0,0,1] op_sel_hi:[1,0,1]
    v_pk_fma_f32 v[148:149], v[112:113], v[104:105], v[148:149]
    v_pk_fma_f32 v[150:151], v[114:115], v[106:107], v[150:151]
    v_lshrrev_b32 v120, 4, v152
    v_and_b32 v85, 0xf0, v153
    v_lshl_add_u32 v85, v120, 11, v85
    v_add_u32 v85, s21, v85
    v_lshlrev_b32 v120, 3, v120
    v_sub_u32 v120, s79, v120
    v_med3_i32 v120, v120, 0, 8
    v_mul_lo_u32 v86, v120, s82
    v_lshrrev_b32 v120, 4, v152
    v_mul_u32_u24 v120, 640, v120
    v_add_u32 v121, v165, v120
    v_add_u32 v122, v171, v120
    ds_read_b64 v[32:33], v165 offset:9600
    ds_read_b64 v[34:35], v171 offset:9600
    ds_read_b64 v[36:37], v121 offset:5120
    ds_read_b64 v[38:39], v122 offset:5120
    v_add_u32 v121, v121, v120
    v_add_u32 v122, v122, v120
    v_and_b32 v120, 1, v152
    v_mul_u32_u24 v120, 640, v120
    v_add_u32 v122, v122, v120
    ds_read2_b32 v[40:41], v121 offset1:160
    ds_read2_b32 v[42:43], v121 offset0:1 offset1:161
    ds_read_b64 v[44:45], v122 offset:0
    v_mul_f32_dpp v126, -v48, v77 row_ror:8 row_mask:0xf bank_mask:0xf
    v_pk_mul_f32 v[124:125], v[0:1], v[74:75] op_sel_hi:[1,0]
    v_pk_mul_f32 v[0:1], v[0:1], v[72:73] op_sel_hi:[1,0]
    v_pk_fma_f32 v[0:1], v[16:17], v[74:75], v[0:1] op_sel_hi:[1,0,1] neg_lo:[1,0,0] neg_hi:[1,0,0]
    v_pk_fma_f32 v[16:17], v[16:17], v[72:73], v[124:125] op_sel_hi:[1,0,1]
    v_fma_f32 v48, -v76, v48, v126
    v_mul_f32_dpp v126, -v49, v77 row_ror:8 row_mask:0xf bank_mask:0xf
    v_pk_mul_f32 v[124:125], v[2:3], v[74:75] op_sel_hi:[1,0]
    v_pk_mul_f32 v[2:3], v[2:3], v[72:73] op_sel_hi:[1,0]
    v_pk_fma_f32 v[2:3], v[18:19], v[74:75], v[2:3] op_sel_hi:[1,0,1] neg_lo:[1,0,0] neg_hi:[1,0,0]
    v_pk_fma_f32 v[18:19], v[18:19], v[72:73], v[124:125] op_sel_hi:[1,0,1]
    v_fma_f32 v49, -v76, v49, v126
    v_mul_f32_dpp v126, -v50, v77 row_ror:8 row_mask:0xf bank_mask:0xf
    v_pk_mul_f32 v[124:125], v[4:5], v[74:75] op_sel_hi:[1,0]
    v_pk_mul_f32 v[4:5], v[4:5], v[72:73] op_sel_hi:[1,0]
    v_pk_fma_f32 v[4:5], v[20:21], v[74:75], v[4:5] op_sel_hi:[1,0,1] neg_lo:[1,0,0] neg_hi:[1,0,0]
    buffer_load_dwordx4 v[116:119], v85, s[92:95], 0 offen offset:2048 sc1
    v_pk_fma_f32 v[20:21], v[20:21], v[72:73], v[124:125] op_sel_hi:[1,0,1]
    v_fma_f32 v50, -v76, v50, v126
    v_mul_f32_dpp v126, -v51, v77 row_ror:8 row_mask:0xf bank_mask:0xf
    v_pk_mul_f32 v[124:125], v[6:7], v[74:75] op_sel_hi:[1,0]
    v_pk_mul_f32 v[6:7], v[6:7], v[72:73] op_sel_hi:[1,0]
    v_pk_fma_f32 v[6:7], v[22:23], v[74:75], v[6:7] op_sel_hi:[1,0,1] neg_lo:[1,0,0] neg_hi:[1,0,0]
    v_pk_fma_f32 v[22:23], v[22:23], v[72:73], v[124:125] op_sel_hi:[1,0,1]
    v_fma_f32 v51, -v76, v51, v126
    v_mul_f32_dpp v126, -v52, v77 row_ror:8 row_mask:0xf bank_mask:0xf
    buffer_load_dwordx4 v[112:115], v85, s[92:95], 0 offen offset:1792 sc1
    v_pk_mul_f32 v[124:125], v[8:9], v[74:75] op_sel_hi:[1,0]
    v_pk_mul_f32 v[8:9], v[8:9], v[72:73] op_sel_hi:[1,0]
    v_pk_fma_f32 v[8:9], v[24:25], v[74:75], v[8:9] op_sel_hi:[1,0,1] neg_lo:[1,0,0] neg_hi:[1,0,0]
    v_pk_fma_f32 v[24:25], v[24:25], v[72:73], v[124:125] op_sel_hi:[1,0,1]
    v_fma_f32 v52, -v76, v52, v126
    v_mul_f32_dpp v126, -v53, v77 row_ror:8 row_mask:0xf bank_mask:0xf
    v_pk_mul_f32 v[124:125], v[10:11], v[74:75] op_sel_hi:[1,0]
    v_pk_mul_f32 v[10:11], v[10:11], v[72:73] op_sel_hi:[1,0]
    v_pk_fma_f32 v[10:11], v[26:27], v[74:75], v[10:11] op_sel_hi:[1,0,1] neg_lo:[1,0,0] neg_hi:[1,0,0]
    buffer_load_dwordx4 v[108:111], v85, s[92:95], 0 offen offset:1536 sc1
    v_pk_fma_f32 v[26:27], v[26:27], v[72:73], v[124:125] op_sel_hi:[1,0,1]
    v_fma_f32 v53, -v76, v53, v126
    v_mul_f32_dpp v126, -v54, v77 row_ror:8 row_mask:0xf bank_mask:0xf
    v_pk_mul_f32 v[124:125], v[12:13], v[74:75] op_sel_hi:[1,0]
    v_pk_mul_f32 v[12:13], v[12:13], v[72:73] op_sel_hi:[1,0]
    v_pk_fma_f32 v[12:13], v[28:29], v[74:75], v[12:13] op_sel_hi:[1,0,1] neg_lo:[1,0,0] neg_hi:[1,0,0]
    v_pk_fma_f32 v[28:29], v[28:29], v[72:73], v[124:125] op_sel_hi:[1,0,1]
    v_fma_f32 v54, -v76, v54, v126
    v_mul_f32_dpp v126, -v55, v77 row_ror:8 row_mask:0xf bank_mask:0xf
    buffer_load_dwordx4 v[104:107], v85, s[92:95], 0 offen offset:1280 sc1
    v_pk_mul_f32 v[124:125], v[14:15], v[74:75] op_sel_hi:[1,0]
    v_pk_mul_f32 v[14:15], v[14:15], v[72:73] op_sel_hi:[1,0]
    v_pk_fma_f32 v[14:15], v[30:31], v[74:75], v[14:15] op_sel_hi:[1,0,1] neg_lo:[1,0,0] neg_hi:[1,0,0]
    v_pk_fma_f32 v[30:31], v[30:31], v[72:73], v[124:125] op_sel_hi:[1,0,1]
    v_fma_f32 v55, -v76, v55, v126
    s_waitcnt lgkmcnt(0)
    v_xor_b32 v35, v170, v35
    v_xor_b32 v39, v170, v39
    v_xor_b32 v44, v170, v44
    buffer_load_dwordx4 v[100:103], v85, s[92:95], 0 offen offset:1024 sc1
    s_add_u32 s6, s100, 71680
    v_bfe_u32 v63, v152, 4, 1
    v_lshlrev_b32 v63, 6, v63
    v_xor_b32 v56, v63, v153
    v_add_u32 v56, s6, v56
    v_and_b32 v58, 3, v152
    v_lshl_add_u32 v58, v58, 8, s6
    v_lshl_add_u32 v58, v63, 1, v58
    v_bfe_u32 v63, v152, 2, 2
    buffer_load_dwordx4 v[96:99], v85, s[92:95], 0 offen offset:768 sc1
    v_lshl_add_u32 v58, v63, 4, v58
    v_lshrrev_b32 v57, 5, v152
    v_lshl_add_u32 v58, v57, 3, v58
    v_and_b32 v63, 1, v152
    v_lshl_add_u32 v58, v63, 6, v58
    v_xor_b32 v59, 64, v58
    s_lshl_b32 s3, s77, 10
    s_add_u32 s3, s3, 94016
    v_lshl_add_u32 v60, v63, 2, s3
    buffer_load_dwordx4 v[92:95], v85, s[92:95], 0 offen offset:512 sc1
    v_lshlrev_b32 v62, 5, v63
    v_bfe_u32 v63, v152, 1, 3
    v_lshl_add_u32 v60, v63, 5, v60
    v_and_b32 v63, 1, v63
    v_lshl_add_u32 v62, v63, 4, v62
    v_and_b32 v63, 0xc0, v153
    v_add_u32 v62, v63, v62
    v_lshrrev_b32 v63, 4, v152
    v_lshl_add_u32 v60, v63, 3, v60
    buffer_load_dwordx4 v[88:91], v85, s[92:95], 0 offen offset:256 sc1
    v_lshl_add_u32 v61, v63, 7, s3
    v_lshl_add_u32 v61, v152, 3, v61
    v_mul_u32_u24 v63, 40960, v63
    v_add_u32 v62, v63, v62
    v_and_b32 v120, 15, v152
    v_min_u32 v120, 9, v120
    v_lshrrev_b32 v121, 4, v152
    v_mul_u32_u24 v121, 40960, v121
    v_lshl_add_u32 v120, v120, 10, v121
    global_load_dword v64, v87, s[50:51] sc1
    v_sub_u32 v121, v175, v153
    v_add_u32 v158, v120, v121
L_cchk1:
    s_waitcnt vmcnt(7)
    v_fmac_f32_dpp v114, v118, v35 row_ror:8 row_mask:0xf bank_mask:0xf
    v_fmac_f32 v114, v34, v118
    v_pk_fma_f32 v[112:113], v[116:117], v[32:33], v[112:113] op_sel_hi:[1,0,1]
    v_pk_fma_f32 v[112:113], v[116:117], v[32:33], v[112:113] op_sel:[1,1,0] op_sel_hi:[0,1,1] neg_lo:[1,0,0]
    s_waitcnt vmcnt(6)
    v_add3_u32 v169, v119, v115, v111
    v_fmac_f32_dpp v110, v114, v35 row_ror:8 row_mask:0xf bank_mask:0xf
    v_fmac_f32 v110, v34, v114
    v_pk_fma_f32 v[108:109], v[112:113], v[32:33], v[108:109] op_sel_hi:[1,0,1]
    v_pk_fma_f32 v[108:109], v[112:113], v[32:33], v[108:109] op_sel:[1,1,0] op_sel_hi:[0,1,1] neg_lo:[1,0,0]
    s_waitcnt vmcnt(5)
    v_fmac_f32_dpp v106, v110, v35 row_ror:8 row_mask:0xf bank_mask:0xf
    v_fmac_f32 v106, v34, v110
    v_pk_fma_f32 v[104:105], v[108:109], v[32:33], v[104:105] op_sel_hi:[1,0,1]
    v_pk_fma_f32 v[104:105], v[108:109], v[32:33], v[104:105] op_sel:[1,1,0] op_sel_hi:[0,1,1] neg_lo:[1,0,0]
    s_waitcnt vmcnt(4)
    v_add3_u32 v169, v169, v107, v103
    v_fmac_f32_dpp v102, v106, v35 row_ror:8 row_mask:0xf bank_mask:0xf
    v_fmac_f32 v102, v34, v106
    v_pk_fma_f32 v[100:101], v[104:105], v[32:33], v[100:101] op_sel_hi:[1,0,1]
    v_pk_fma_f32 v[100:101], v[104:105], v[32:33], v[100:101] op_sel:[1,1,0] op_sel_hi:[0,1,1] neg_lo:[1,0,0]
    s_waitcnt vmcnt(3)
    v_fmac_f32_dpp v98, v102, v35 row_ror:8 row_mask:0xf bank_mask:0xf
    v_fmac_f32 v98, v34, v102
    v_pk_fma_f32 v[96:97], v[100:101], v[32:33], v[96:97] op_sel_hi:[1,0,1]
    v_pk_fma_f32 v[96:97], v[100:101], v[32:33], v[96:97] op_sel:[1,1,0] op_sel_hi:[0,1,1] neg_lo:[1,0,0]
    s_waitcnt vmcnt(2)
    v_add3_u32 v169, v169, v99, v95
    v_fmac_f32_dpp v94, v98, v35 row_ror:8 row_mask:0xf bank_mask:0xf
    v_fmac_f32 v94, v34, v98
    v_pk_fma_f32 v[92:93], v[96:97], v[32:33], v[92:93] op_sel_hi:[1,0,1]
    v_pk_fma_f32 v[92:93], v[96:97], v[32:33], v[92:93] op_sel:[1,1,0] op_sel_hi:[0,1,1] neg_lo:[1,0,0]
    s_waitcnt vmcnt(1)
    v_add_u32 v169, v169, v91
    v_cmp_ne_u32 vcc, v169, v86
    v_fmac_f32_dpp v90, v94, v35 row_ror:8 row_mask:0xf bank_mask:0xf
    v_fmac_f32 v90, v34, v94
    v_pk_fma_f32 v[88:89], v[92:93], v[32:33], v[88:89] op_sel_hi:[1,0,1]
    v_pk_fma_f32 v[88:89], v[92:93], v[32:33], v[88:89] op_sel:[1,1,0] op_sel_hi:[0,1,1] neg_lo:[1,0,0]
    s_cbranch_vccnz L_cre1
    v_mul_f32_dpp v94, v90, v39 row_ror:8 row_mask:0xf bank_mask:0xf
    v_pk_mul_f32 v[92:93], v[88:89], v[36:37] op_sel_hi:[1,0]
    v_fmac_f32 v94, v38, v90
    v_pk_fma_f32 v[92:93], v[88:89], v[36:37], v[92:93] op_sel:[1,1,0] op_sel_hi:[0,1,1] neg_lo:[1,0,0]

    v_mov_b32 v98, v94
    v_mov_b64 v[96:97], v[92:93]
    s_nop 0
    v_permlane32_swap_b32 v94, v98
    v_permlane32_swap_b32 v92, v96
    v_permlane32_swap_b32 v93, v97
    v_add_f32 v94, v94, v98
    v_pk_add_f32 v[92:93], v[92:93], v[96:97]

    v_mov_b32 v98, v94
    v_mov_b64 v[96:97], v[92:93]
    s_nop 0
    v_permlane16_swap_b32 v94, v98
    v_permlane16_swap_b32 v92, v96
    v_permlane16_swap_b32 v93, v97
    v_add_f32 v94, v94, v98
    v_pk_add_f32 v[92:93], v[92:93], v[96:97]

    v_fma_f32 v84, -v44, v94, v84
    v_pk_fma_f32 v[80:81], v[40:41], v[92:93], v[80:81] op_sel_hi:[1,0,1]
    v_pk_fma_f32 v[82:83], v[40:41], v[92:93], v[82:83] op_sel:[0,1,0]
    v_fmac_f32_dpp v84, -v94, v45 row_ror:8 row_mask:0xf bank_mask:0xf
    v_pk_fma_f32 v[80:81], v[42:43], v[92:93], v[80:81] op_sel:[0,1,0] neg_lo:[1,0,0] neg_hi:[1,0,0]
    v_pk_fma_f32 v[82:83], v[42:43], v[92:93], v[82:83] op_sel_hi:[1,0,1]

    v_fmac_f32_dpp v48, -v84, v131 row_ror:8 row_mask:0xf bank_mask:0xf
    v_fmac_f32 v48, v130, v84
    v_pk_fma_f32 v[0:1], v[80:81], v[128:129], v[0:1] op_sel_hi:[1,0,1]
    v_pk_fma_f32 v[16:17], v[82:83], v[128:129], v[16:17] op_sel_hi:[1,0,1]
    v_fmac_f32_dpp v49, -v48, v131 row_ror:8 row_mask:0xf bank_mask:0xf
    v_fmac_f32 v49, v130, v48
    v_pk_fma_f32 v[0:1], v[82:83], v[128:129], v[0:1] op_sel:[0,1,0] neg_lo:[1,0,0] neg_hi:[1,0,0]
    v_pk_fma_f32 v[16:17], v[80:81], v[128:129], v[16:17] op_sel:[0,1,0]
    v_fmac_f32_dpp v50, -v49, v131 row_ror:8 row_mask:0xf bank_mask:0xf
    v_fmac_f32 v50, v130, v49
    v_pk_fma_f32 v[2:3], v[0:1], v[128:129], v[2:3] op_sel_hi:[1,0,1]
    v_pk_fma_f32 v[18:19], v[16:17], v[128:129], v[18:19] op_sel_hi:[1,0,1]
    v_fmac_f32_dpp v51, -v50, v131 row_ror:8 row_mask:0xf bank_mask:0xf
    v_fmac_f32 v51, v130, v50
    v_pk_fma_f32 v[2:3], v[16:17], v[128:129], v[2:3] op_sel:[0,1,0] neg_lo:[1,0,0] neg_hi:[1,0,0]
    v_pk_fma_f32 v[18:19], v[0:1], v[128:129], v[18:19] op_sel:[0,1,0]
    v_cvt_pk_bf16_f32 v104, v0, v1
    v_cvt_pk_bf16_f32 v105, v2, v3
    v_cvt_pk_bf16_f32 v106, -v16, -v17
    v_cvt_pk_bf16_f32 v107, -v18, -v19

    ds_write_b128 v56, v[104:107] offset:0
    ds_read_b64_tr_b16 v[88:89], v58 offset:0
    ds_read_b64_tr_b16 v[90:91], v59 offset:0
    v_fmac_f32_dpp v52, -v51, v131 row_ror:8 row_mask:0xf bank_mask:0xf
    v_fmac_f32 v52, v130, v51
    v_pk_fma_f32 v[4:5], v[2:3], v[128:129], v[4:5] op_sel_hi:[1,0,1]
    v_pk_fma_f32 v[20:21], v[18:19], v[128:129], v[20:21] op_sel_hi:[1,0,1]
    v_fmac_f32_dpp v53, -v52, v131 row_ror:8 row_mask:0xf bank_mask:0xf
    v_fmac_f32 v53, v130, v52
    v_pk_fma_f32 v[4:5], v[18:19], v[128:129], v[4:5] op_sel:[0,1,0] neg_lo:[1,0,0] neg_hi:[1,0,0]
    v_pk_fma_f32 v[20:21], v[2:3], v[128:129], v[20:21] op_sel:[0,1,0]
    v_fmac_f32_dpp v54, -v53, v131 row_ror:8 row_mask:0xf bank_mask:0xf
    v_fmac_f32 v54, v130, v53
    v_pk_fma_f32 v[6:7], v[4:5], v[128:129], v[6:7] op_sel_hi:[1,0,1]
    v_pk_fma_f32 v[22:23], v[20:21], v[128:129], v[22:23] op_sel_hi:[1,0,1]
    v_fmac_f32_dpp v55, -v54, v131 row_ror:8 row_mask:0xf bank_mask:0xf
    v_fmac_f32 v55, v130, v54
    v_pk_fma_f32 v[6:7], v[20:21], v[128:129], v[6:7] op_sel:[0,1,0] neg_lo:[1,0,0] neg_hi:[1,0,0]
    v_pk_fma_f32 v[22:23], v[4:5], v[128:129], v[22:23] op_sel:[0,1,0]
    v_cvt_pk_bf16_f32 v108, v4, v5
    v_cvt_pk_bf16_f32 v109, v6, v7
    v_cvt_pk_bf16_f32 v110, -v20, -v21
    v_cvt_pk_bf16_f32 v111, -v22, -v23

    ds_write_b128 v56, v[108:111] offset:1024
    ds_read_b64_tr_b16 v[92:93], v58 offset:1024
    ds_read_b64_tr_b16 v[94:95], v59 offset:1024
    v_pk_fma_f32 v[8:9], v[6:7], v[128:129], v[8:9] op_sel_hi:[1,0,1]
    v_pk_fma_f32 v[24:25], v[22:23], v[128:129], v[24:25] op_sel_hi:[1,0,1]
    v_pk_fma_f32 v[8:9], v[22:23], v[128:129], v[8:9] op_sel:[0,1,0] neg_lo:[1,0,0] neg_hi:[1,0,0]
    v_pk_fma_f32 v[24:25], v[6:7], v[128:129], v[24:25] op_sel:[0,1,0]
    v_cvt_pk_bf16_f32 v112, v48, v49
    v_cvt_pk_bf16_f32 v113, v50, v51
    v_cvt_pk_bf16_f32 v114, v52, v53
    v_cvt_pk_bf16_f32 v115, v54, v55
    ds_write2st64_b32 v60, v112, v113 offset0:0 offset1:1
    ds_write2st64_b32 v60, v114, v115 offset0:2 offset1:3
    ds_read_b64_tr_b16 v[116:117], v61 offset:0
    ds_read_b64_tr_b16 v[118:119], v61 offset:128
    v_pk_fma_f32 v[10:11], v[8:9], v[128:129], v[10:11] op_sel_hi:[1,0,1]
    v_pk_fma_f32 v[26:27], v[24:25], v[128:129], v[26:27] op_sel_hi:[1,0,1]
    v_pk_fma_f32 v[10:11], v[24:25], v[128:129], v[10:11] op_sel:[0,1,0] neg_lo:[1,0,0] neg_hi:[1,0,0]
    v_pk_fma_f32 v[26:27], v[8:9], v[128:129], v[26:27] op_sel:[0,1,0]
    v_cvt_pk_bf16_f32 v104, v8, v9
    v_cvt_pk_bf16_f32 v105, v10, v11
    v_cvt_pk_bf16_f32 v106, -v24, -v25
    v_cvt_pk_bf16_f32 v107, -v26, -v27

    ds_write_b128 v56, v[104:107] offset:0
    ds_read_b64_tr_b16 v[96:97], v58 offset:0
    ds_read_b64_tr_b16 v[98:99], v59 offset:0
    s_waitcnt vmcnt(0)
L_xr:
    v_cmp_ne_u32 vcc, s13, v64
    s_cbranch_vccnz L_xr_re
    s_waitcnt lgkmcnt(10)
    v_and_b32 v88, -2, v88
    v_and_b32 v90, -2, v90
    s_cmp_eq_u32 s88, 0
    s_cbranch_scc1 Lss_25
    buffer_store_dwordx4 v[88:91], v153, s[64:67], s36 offen
Lsd_26:
    v_pk_fma_f32 v[12:13], v[10:11], v[128:129], v[12:13] op_sel_hi:[1,0,1]
    v_pk_fma_f32 v[28:29], v[26:27], v[128:129], v[28:29] op_sel_hi:[1,0,1]
    v_pk_fma_f32 v[12:13], v[26:27], v[128:129], v[12:13] op_sel:[0,1,0] neg_lo:[1,0,0] neg_hi:[1,0,0]
    v_pk_fma_f32 v[28:29], v[10:11], v[128:129], v[28:29] op_sel:[0,1,0]
    v_pk_fma_f32 v[14:15], v[12:13], v[128:129], v[14:15] op_sel_hi:[1,0,1]
    v_pk_fma_f32 v[30:31], v[28:29], v[128:129], v[30:31] op_sel_hi:[1,0,1]
    v_pk_fma_f32 v[14:15], v[28:29], v[128:129], v[14:15] op_sel:[0,1,0] neg_lo:[1,0,0] neg_hi:[1,0,0]
    v_pk_fma_f32 v[30:31], v[12:13], v[128:129], v[30:31] op_sel:[0,1,0]
    v_cvt_pk_bf16_f32 v108, v12, v13
    v_cvt_pk_bf16_f32 v109, v14, v15
    v_cvt_pk_bf16_f32 v110, -v28, -v29
    v_cvt_pk_bf16_f32 v111, -v30, -v31

    ds_write_b128 v56, v[108:111] offset:1024
    ds_read_b64_tr_b16 v[100:101], v58 offset:1024
    ds_read_b64_tr_b16 v[102:103], v59 offset:1024
    s_waitcnt lgkmcnt(10)
    v_and_b32 v92, -2, v92
    v_and_b32 v94, -2, v94
    s_cmp_eq_u32 s88, 0
    s_cbranch_scc1 Lss_27
    buffer_store_dwordx4 v[92:95], v153, s[64:67], s18 offen
Lsd_28:
    s_waitcnt lgkmcnt(6)
    v_and_b32 v116, -2, v116
    v_and_b32 v118, -2, v118
    s_cmp_eq_u32 s88, 0
    s_cbranch_scc1 Lss_29
    buffer_store_dwordx2 v[116:117], v62, s[64:67], s37 offen offset:0
    buffer_store_dwordx2 v[118:119], v62, s[64:67], s37 offen offset:512
Lsd_30:
    s_waitcnt lgkmcnt(3)
    v_and_b32 v96, -2, v96
    v_and_b32 v98, -2, v98
    s_cmp_eq_u32 s88, 0
    s_cbranch_scc1 Lss_31
    buffer_store_dwordx4 v[96:99], v153, s[64:67], s19 offen
Lsd_32:
    s_waitcnt lgkmcnt(0)
    v_and_b32 v100, -2, v100
    v_and_b32 v102, -2, v102
    s_cmp_eq_u32 s88, 0
    s_cbranch_scc1 Lss_33
    buffer_store_dwordx4 v[100:103], v153, s[64:67], s20 offen
Lsd_34:
    s_lshl_b32 s8, s77, 2
    s_add_u32 s8, s8, 61440
    v_bfe_u32 v121, v152, 4, 2
    v_lshl_add_u32 v120, v121, 5, s8
    v_bfe_u32 v121, v152, 2, 1
    v_lshl_add_u32 v120, v121, 4, v120
    v_bfe_u32 v121, v152, 3, 1
    v_lshl_add_u32 v120, v121, 1, v120
    v_and_b32 v121, 3, v152
    v_lshl_add_u32 v120, v121, 9, v120
    s_barrier
    v_accvgpr_write_b32 a0, 0
    v_accvgpr_write_b32 a1, 0
    v_accvgpr_write_b32 a2, 0
    ds_read_u16_d16_hi a0, v120 offset:0
    v_accvgpr_write_b32 a3, 0
    ds_read_u16_d16_hi a1, v120 offset:128
    v_accvgpr_write_b32 a4, 0
    ds_read_u16_d16_hi a2, v120 offset:256
    v_accvgpr_write_b32 a5, 0
    ds_read_u16_d16_hi a3, v120 offset:384
    v_accvgpr_write_b32 a6, 0
    ds_read_u16_d16_hi a4, v120 offset:2048
    v_accvgpr_write_b32 a7, 0
    ds_read_u16_d16_hi a5, v120 offset:2176
    v_accvgpr_write_b32 a8, 0
    ds_read_u16_d16_hi a6, v120 offset:2304
    v_accvgpr_write_b32 a9, 0
    ds_read_u16_d16_hi a7, v120 offset:2432
    v_accvgpr_write_b32 a10, 0
    ds_read_u16_d16_hi a8, v120 offset:4096
    v_accvgpr_write_b32 a11, 0
    ds_read_u16_d16_hi a9, v120 offset:4224
    v_accvgpr_write_b32 a12, 0
    ds_read_u16_d16_hi a10, v120 offset:4352
    v_accvgpr_write_b32 a13, 0
    ds_read_u16_d16_hi a11, v120 offset:4480
    v_accvgpr_write_b32 a14, 0
    ds_read_u16_d16_hi a12, v120 offset:6144
    v_accvgpr_write_b32 a15, 0
    ds_read_u16_d16_hi a13, v120 offset:6272
    v_accvgpr_write_b32 a16, 0
    ds_read_u16_d16_hi a14, v120 offset:6400
    v_accvgpr_write_b32 a17, 0
    ds_read_u16_d16_hi a15, v120 offset:6528
    v_accvgpr_write_b32 a18, 0
    ds_read_u16_d16_hi a16, v120 offset:8192
    v_accvgpr_write_b32 a19, 0
    ds_read_u16_d16_hi a17, v120 offset:8320
    ds_read_u16_d16_hi a18, v120 offset:8448
    ds_read_u16_d16_hi a19, v120 offset:8576
L_hp:
    s_sub_u32 s101, s101, 1
    s_cbranch_scc1 L_end
    buffer_load_dwordx4 v[40:43], v175, s[64:67], s23 offen offset:0 sc1
    buffer_load_dwordx4 v[44:47], v175, s[64:67], s23 offen offset:1024 sc1
    buffer_load_dwordx4 v[48:51], v175, s[64:67], s23 offen offset:2048 sc1
    buffer_load_dwordx4 v[120:123], v175, s[64:67], s22 offen offset:0 sc1
    buffer_load_dwordx4 v[80:83], v175, s[64:67], s25 offen offset:0 sc1
    buffer_load_dwordx4 v[116:119], v175, s[64:67], s28 offen offset:0 sc1
    buffer_load_dwordx4 v[64:67], v175, s[64:67], s31 offen offset:0 sc1
    s_waitcnt vmcnt(4)
    v_bitop3_b32 v169, v40, v42, v44 bitop3:254
    v_bitop3_b32 v169, v169, v46, v48 bitop3:254
    v_bitop3_b32 v169, v169, v50, 1 bitop3:168
    v_cmp_ne_u32 s[96:97], 0, v169
    s_cmp_lg_u64 s[96:97], 0
    s_cbranch_scc1 Lh1c0r
Lh1c0:
    v_mfma_f32_16x16x32_bf16 v[132:135], a[232:235], v[40:43], v[132:135]
    buffer_load_dwordx4 v[60:63], v175, s[64:67], s22 offen offset:1024 sc1
    v_mfma_f32_16x16x32_bf16 v[136:139], v[176:179], v[40:43], v[136:139]
    v_mfma_f32_16x16x32_bf16 v[140:143], v[192:195], v[40:43], v[140:143]
    v_mfma_f32_16x16x32_bf16 v[144:147], v[208:211], v[40:43], v[144:147]
    v_mfma_f32_16x16x32_bf16 v[148:151], a[216:219], v[40:43], v[148:151]
    buffer_load_dwordx4 v[68:71], v175, s[64:67], s25 offen offset:1024 sc1
    v_mfma_f32_16x16x32_bf16 v[132:135], a[236:239], v[44:47], v[132:135]
    v_mfma_f32_16x16x32_bf16 v[136:139], v[180:183], v[44:47], v[136:139]
    v_mfma_f32_16x16x32_bf16 v[140:143], v[196:199], v[44:47], v[140:143]
    v_mfma_f32_16x16x32_bf16 v[144:147], v[212:215], v[44:47], v[144:147]
    ds_read_b128 v[124:127], v156 offset:8192
    buffer_load_dwordx4 v[72:75], v175, s[64:67], s28 offen offset:1024 sc1
    s_waitcnt vmcnt(3)
    v_bitop3_b32 v169, v120, v122, v80 bitop3:254
    v_bitop3_b32 v169, v169, v82, v116 bitop3:254
    v_mfma_f32_16x16x32_bf16 v[148:151], a[220:223], v[44:47], v[148:151]
    v_bitop3_b32 v169, v169, v118, v64 bitop3:254
    v_bitop3_b32 v169, v169, v66, 1 bitop3:168
    v_mfma_f32_16x16x32_bf16 v[132:135], a[240:243], v[48:51], v[132:135]
    v_cmp_ne_u32 s[96:97], 0, v169
    v_mfma_f32_16x16x32_bf16 v[136:139], v[184:187], v[48:51], v[136:139]
    v_mfma_f32_16x16x32_bf16 v[140:143], v[200:203], v[48:51], v[140:143]
    ds_read_b128 v[128:131], v156 offset:12288
    buffer_load_dwordx4 v[76:79], v175, s[64:67], s31 offen offset:1024 sc1
    v_mfma_f32_16x16x32_bf16 v[144:147], v[216:219], v[48:51], v[144:147]
    v_mfma_f32_16x16x32_bf16 v[148:151], a[224:227], v[48:51], v[148:151]
    s_cmp_lg_u64 s[96:97], 0
    s_cbranch_scc1 Lh1c1r
Lh1c1:
    v_mfma_f32_16x16x32_bf16 v[148:151], a[200:203], v[120:123], v[148:151]
    v_mfma_f32_16x16x32_bf16 v[40:43], a[200:203], v[80:83], 0
    ds_read_b128 v[112:115], v156 offset:0
    buffer_load_dwordx4 v[84:87], v175, s[64:67], s22 offen offset:2048 sc1
    v_mfma_f32_16x16x32_bf16 v[44:47], a[200:203], v[116:119], 0
    v_mfma_f32_16x16x32_bf16 v[48:51], a[200:203], v[64:67], 0
    s_waitcnt lgkmcnt(2)
    v_mfma_f32_16x16x32_bf16 v[140:143], v[124:127], v[120:123], v[140:143]
    v_mfma_f32_16x16x32_bf16 v[52:55], v[124:127], v[80:83], 0
    buffer_load_dwordx4 v[88:91], v175, s[64:67], s25 offen offset:2048 sc1
    v_mfma_f32_16x16x32_bf16 v[56:59], v[124:127], v[116:119], 0
    v_mfma_f32_16x16x32_bf16 v[0:3], v[124:127], v[64:67], 0
    ds_read_b128 v[124:127], v156 offset:4096
    s_waitcnt lgkmcnt(2)
    v_mfma_f32_16x16x32_bf16 v[144:147], v[128:131], v[120:123], v[144:147]
    v_mfma_f32_16x16x32_bf16 v[4:7], v[128:131], v[80:83], 0
    buffer_load_dwordx4 v[92:95], v175, s[64:67], s28 offen offset:2048 sc1
    v_mfma_f32_16x16x32_bf16 v[8:11], v[128:131], v[116:119], 0
    v_mfma_f32_16x16x32_bf16 v[12:15], v[128:131], v[64:67], 0
    ds_read_b128 v[128:131], v157 offset:8192
    s_waitcnt lgkmcnt(2)
    v_mfma_f32_16x16x32_bf16 v[132:135], v[112:115], v[120:123], v[132:135]
    v_mfma_f32_16x16x32_bf16 v[28:31], v[112:115], v[80:83], 0
    buffer_load_dwordx4 v[96:99], v175, s[64:67], s31 offen offset:2048 sc1
    s_waitcnt vmcnt(4)
    v_bitop3_b32 v169, v60, v62, v68 bitop3:254
    v_bitop3_b32 v169, v169, v70, v72 bitop3:254
    v_mfma_f32_16x16x32_bf16 v[32:35], v[112:115], v[116:119], 0
    v_bitop3_b32 v169, v169, v74, v76 bitop3:254
    v_bitop3_b32 v169, v169, v78, 1 bitop3:168
    v_mfma_f32_16x16x32_bf16 v[36:39], v[112:115], v[64:67], 0
    ds_read_b128 v[112:115], v157 offset:12288
    v_cmp_ne_u32 s[96:97], 0, v169
    s_waitcnt lgkmcnt(2)
    v_mfma_f32_16x16x32_bf16 v[136:139], v[124:127], v[120:123], v[136:139]
    v_mfma_f32_16x16x32_bf16 v[16:19], v[124:127], v[80:83], 0
    buffer_load_dwordx4 v[100:103], v175, s[64:67], s22 offen offset:3072 sc1
    v_mfma_f32_16x16x32_bf16 v[20:23], v[124:127], v[116:119], 0
    v_mfma_f32_16x16x32_bf16 v[24:27], v[124:127], v[64:67], 0
    ds_read_b128 v[124:127], v157 offset:0
    s_cmp_lg_u64 s[96:97], 0
    s_cbranch_scc1 Lh1c2r
Lh1c2:
    v_mfma_f32_16x16x32_bf16 v[148:151], a[204:207], v[60:63], v[148:151]
    v_mfma_f32_16x16x32_bf16 v[40:43], a[204:207], v[68:71], v[40:43]
    buffer_load_dwordx4 v[104:107], v175, s[64:67], s25 offen offset:3072 sc1
    v_mfma_f32_16x16x32_bf16 v[44:47], a[204:207], v[72:75], v[44:47]
    v_mfma_f32_16x16x32_bf16 v[48:51], a[204:207], v[76:79], v[48:51]
    s_waitcnt lgkmcnt(2)
    v_mfma_f32_16x16x32_bf16 v[140:143], v[128:131], v[60:63], v[140:143]
    v_mfma_f32_16x16x32_bf16 v[52:55], v[128:131], v[68:71], v[52:55]
    buffer_load_dwordx4 v[108:111], v175, s[64:67], s28 offen offset:3072 sc1
    v_mfma_f32_16x16x32_bf16 v[56:59], v[128:131], v[72:75], v[56:59]
    v_mfma_f32_16x16x32_bf16 v[0:3], v[128:131], v[76:79], v[0:3]
    ds_read_b128 v[128:131], v157 offset:4096
    s_waitcnt lgkmcnt(2)
    v_mfma_f32_16x16x32_bf16 v[144:147], v[112:115], v[60:63], v[144:147]
    v_mfma_f32_16x16x32_bf16 v[4:7], v[112:115], v[68:71], v[4:7]
    buffer_load_dwordx4 v[120:123], v175, s[64:67], s31 offen offset:3072 sc1
    v_mfma_f32_16x16x32_bf16 v[8:11], v[112:115], v[72:75], v[8:11]
    v_mfma_f32_16x16x32_bf16 v[12:15], v[112:115], v[76:79], v[12:15]
    ds_read_b128 v[112:115], v156 offset:8704
    s_waitcnt lgkmcnt(2)
    v_mfma_f32_16x16x32_bf16 v[132:135], v[124:127], v[60:63], v[132:135]
    v_mfma_f32_16x16x32_bf16 v[28:31], v[124:127], v[68:71], v[28:31]
    buffer_load_dwordx4 v[80:83], v175, s[64:67], s26 offen offset:0 sc1
    s_waitcnt vmcnt(5)
    v_bitop3_b32 v169, v84, v86, v88 bitop3:254
    v_bitop3_b32 v169, v169, v90, v92 bitop3:254
    v_mfma_f32_16x16x32_bf16 v[32:35], v[124:127], v[72:75], v[32:35]
    v_bitop3_b32 v169, v169, v94, v96 bitop3:254
    v_bitop3_b32 v169, v169, v98, 1 bitop3:168
    v_mfma_f32_16x16x32_bf16 v[36:39], v[124:127], v[76:79], v[36:39]
    ds_read_b128 v[124:127], v156 offset:12800
    v_cmp_ne_u32 s[96:97], 0, v169
    s_waitcnt lgkmcnt(2)
    v_mfma_f32_16x16x32_bf16 v[136:139], v[128:131], v[60:63], v[136:139]
    v_mfma_f32_16x16x32_bf16 v[16:19], v[128:131], v[68:71], v[16:19]
    buffer_load_dwordx4 v[116:119], v175, s[64:67], s26 offen offset:1024 sc1
    v_mfma_f32_16x16x32_bf16 v[20:23], v[128:131], v[72:75], v[20:23]
    v_mfma_f32_16x16x32_bf16 v[24:27], v[128:131], v[76:79], v[24:27]
    ds_read_b128 v[128:131], v156 offset:512
    s_cmp_lg_u64 s[96:97], 0
    s_cbranch_scc1 Lh1c3r
Lh1c3:
    v_mfma_f32_16x16x32_bf16 v[148:151], a[208:211], v[84:87], v[148:151]
    v_mfma_f32_16x16x32_bf16 v[40:43], a[208:211], v[88:91], v[40:43]
    buffer_load_dwordx4 v[64:67], v175, s[64:67], s26 offen offset:2048 sc1
    v_mfma_f32_16x16x32_bf16 v[44:47], a[208:211], v[92:95], v[44:47]
    v_mfma_f32_16x16x32_bf16 v[48:51], a[208:211], v[96:99], v[48:51]
    s_waitcnt lgkmcnt(2)
    v_mfma_f32_16x16x32_bf16 v[140:143], v[112:115], v[84:87], v[140:143]
    v_mfma_f32_16x16x32_bf16 v[52:55], v[112:115], v[88:91], v[52:55]
    buffer_load_dwordx4 v[60:63], v175, s[64:67], s26 offen offset:3072 sc1
    v_mfma_f32_16x16x32_bf16 v[56:59], v[112:115], v[92:95], v[56:59]
    v_mfma_f32_16x16x32_bf16 v[0:3], v[112:115], v[96:99], v[0:3]
    ds_read_b128 v[112:115], v156 offset:4608
    s_waitcnt lgkmcnt(2)
    v_mfma_f32_16x16x32_bf16 v[144:147], v[124:127], v[84:87], v[144:147]
    v_mfma_f32_16x16x32_bf16 v[4:7], v[124:127], v[88:91], v[4:7]
    buffer_load_dwordx4 v[68:71], v175, s[64:67], s27 offen offset:0 sc1
    v_mfma_f32_16x16x32_bf16 v[8:11], v[124:127], v[92:95], v[8:11]
    v_mfma_f32_16x16x32_bf16 v[12:15], v[124:127], v[96:99], v[12:15]
    ds_read_b128 v[124:127], v157 offset:8704
    s_waitcnt lgkmcnt(2)
    v_mfma_f32_16x16x32_bf16 v[132:135], v[128:131], v[84:87], v[132:135]
    v_mfma_f32_16x16x32_bf16 v[28:31], v[128:131], v[88:91], v[28:31]
    buffer_load_dwordx4 v[72:75], v175, s[64:67], s27 offen offset:1024 sc1
    s_waitcnt vmcnt(6)
    v_bitop3_b32 v169, v100, v102, v104 bitop3:254
    v_bitop3_b32 v169, v169, v106, v108 bitop3:254
    v_mfma_f32_16x16x32_bf16 v[32:35], v[128:131], v[92:95], v[32:35]
    v_bitop3_b32 v169, v169, v110, v120 bitop3:254
    v_bitop3_b32 v169, v169, v122, 1 bitop3:168
    v_mfma_f32_16x16x32_bf16 v[36:39], v[128:131], v[96:99], v[36:39]
    ds_read_b128 v[128:131], v157 offset:12800
    v_cmp_ne_u32 s[96:97], 0, v169
    s_waitcnt lgkmcnt(2)
    v_mfma_f32_16x16x32_bf16 v[136:139], v[112:115], v[84:87], v[136:139]
    v_mfma_f32_16x16x32_bf16 v[16:19], v[112:115], v[88:91], v[16:19]
    buffer_load_dwordx4 v[76:79], v175, s[64:67], s29 offen offset:0 sc1
    v_mfma_f32_16x16x32_bf16 v[20:23], v[112:115], v[92:95], v[20:23]
    v_mfma_f32_16x16x32_bf16 v[24:27], v[112:115], v[96:99], v[24:27]
    ds_read_b128 v[112:115], v157 offset:512
    s_cmp_lg_u64 s[96:97], 0
    s_cbranch_scc1 Lh1c4r
Lh1c4:
    v_mfma_f32_16x16x32_bf16 v[148:151], a[212:215], v[100:103], v[148:151]
    v_mfma_f32_16x16x32_bf16 v[40:43], a[212:215], v[104:107], v[40:43]
    buffer_load_dwordx4 v[84:87], v175, s[64:67], s29 offen offset:1024 sc1
    v_mfma_f32_16x16x32_bf16 v[44:47], a[212:215], v[108:111], v[44:47]
    v_mfma_f32_16x16x32_bf16 v[48:51], a[212:215], v[120:123], v[48:51]
    s_waitcnt lgkmcnt(2)
    v_mfma_f32_16x16x32_bf16 v[140:143], v[124:127], v[100:103], v[140:143]
    v_mfma_f32_16x16x32_bf16 v[52:55], v[124:127], v[104:107], v[52:55]
    buffer_load_dwordx4 v[88:91], v175, s[64:67], s29 offen offset:2048 sc1
    v_mfma_f32_16x16x32_bf16 v[56:59], v[124:127], v[108:111], v[56:59]
    v_mfma_f32_16x16x32_bf16 v[0:3], v[124:127], v[120:123], v[0:3]
    ds_read_b128 v[124:127], v157 offset:4608
    s_waitcnt lgkmcnt(2)
    v_mfma_f32_16x16x32_bf16 v[144:147], v[128:131], v[100:103], v[144:147]
    v_mfma_f32_16x16x32_bf16 v[4:7], v[128:131], v[104:107], v[4:7]
    buffer_load_dwordx4 v[92:95], v175, s[64:67], s29 offen offset:3072 sc1
    v_mfma_f32_16x16x32_bf16 v[8:11], v[128:131], v[108:111], v[8:11]
    v_mfma_f32_16x16x32_bf16 v[12:15], v[128:131], v[120:123], v[12:15]
    s_waitcnt lgkmcnt(1)
    v_mfma_f32_16x16x32_bf16 v[132:135], v[112:115], v[100:103], v[132:135]
    v_mfma_f32_16x16x32_bf16 v[28:31], v[112:115], v[104:107], v[28:31]
    buffer_load_dwordx4 v[96:99], v175, s[64:67], s30 offen offset:0 sc1
    s_waitcnt vmcnt(5)
    v_bitop3_b32 v169, v80, v82, v116 bitop3:254
    v_bitop3_b32 v169, v169, v118, v64 bitop3:254
    v_mfma_f32_16x16x32_bf16 v[32:35], v[112:115], v[108:111], v[32:35]
    v_bitop3_b32 v169, v169, v66, v60 bitop3:254
    v_bitop3_b32 v169, v169, v62, v68 bitop3:254
    v_mfma_f32_16x16x32_bf16 v[36:39], v[112:115], v[120:123], v[36:39]
    v_bitop3_b32 v169, v169, v70, v72 bitop3:254
    v_bitop3_b32 v169, v169, v74, 1 bitop3:168
    s_waitcnt lgkmcnt(0)
    v_mfma_f32_16x16x32_bf16 v[136:139], v[124:127], v[100:103], v[136:139]
    v_cmp_ne_u32 s[96:97], 0, v169
    v_mfma_f32_16x16x32_bf16 v[16:19], v[124:127], v[104:107], v[16:19]
    buffer_load_dwordx4 v[100:103], v175, s[64:67], s30 offen offset:1024 sc1
    v_mfma_f32_16x16x32_bf16 v[20:23], v[124:127], v[108:111], v[20:23]
    v_mfma_f32_16x16x32_bf16 v[24:27], v[124:127], v[120:123], v[24:27]
    s_cmp_lg_u64 s[96:97], 0
    s_cbranch_scc1 Lh1c5r
Lh1c5:
    v_mfma_f32_16x16x32_bf16 v[28:31], a[232:235], v[80:83], v[28:31]
    v_mfma_f32_16x16x32_bf16 v[28:31], a[236:239], v[116:119], v[28:31]
    buffer_load_dwordx4 v[104:107], v175, s[64:67], s32 offen offset:0 sc1
    v_mfma_f32_16x16x32_bf16 v[28:31], a[240:243], v[64:67], v[28:31]
    v_mfma_f32_16x16x32_bf16 v[28:31], a[244:247], v[60:63], v[28:31]
    v_mfma_f32_16x16x32_bf16 v[28:31], v[224:227], v[68:71], v[28:31]
    s_add_u32 s3, s77, 1
    s_and_b32 s3, s3, 3
    s_mul_i32 s8, s77, 15360
    v_mfma_f32_16x16x32_bf16 v[28:31], v[228:231], v[72:75], v[28:31]
    s_mul_i32 s3, s3, 15360
    buffer_load_dwordx4 v[108:111], v175, s[64:67], s32 offen offset:1024 sc1
    s_movk_i32 s9, 320
    v_add_u32 v165, s3, v153
    v_and_b32 v124, 15, v152
    v_mfma_f32_16x16x32_bf16 v[16:19], v[176:179], v[80:83], v[16:19]
    v_lshrrev_b32 v112, 4, v152
    v_bfe_u32 v113, v152, 1, 2
    v_mfma_f32_16x16x32_bf16 v[16:19], v[180:183], v[116:119], v[16:19]
    v_mov_b32 v114, s8
    v_mad_u32_u24 v124, v124, s9, v114
    v_mfma_f32_16x16x32_bf16 v[16:19], v[184:187], v[64:67], v[16:19]
    v_xor_b32 v126, v112, v113
    v_lshl_add_u32 v126, v126, 4, v124
    v_mfma_f32_16x16x32_bf16 v[16:19], v[188:191], v[60:63], v[16:19]
    ds_write_b128 v165, v[28:31] offset:0
    buffer_load_dwordx4 v[120:123], v175, s[64:67], s32 offen offset:2048 sc1
    v_lshrrev_b32 v115, 1, v112
    v_lshl_add_u32 v124, v115, 6, v124
    v_mfma_f32_16x16x32_bf16 v[16:19], v[232:235], v[68:71], v[16:19]
    v_and_b32 v115, 1, v112
    v_lshlrev_b32 v115, 1, v115
    v_mfma_f32_16x16x32_bf16 v[16:19], v[236:239], v[72:75], v[16:19]
    v_xor_b32 v115, v115, v113
    v_lshl_add_u32 v124, v115, 4, v124
    v_mfma_f32_16x16x32_bf16 v[52:55], v[192:195], v[80:83], v[52:55]
    v_xor_b32 v125, 16, v124
    v_lshrrev_b32 v115, 2, v152
    v_mfma_f32_16x16x32_bf16 v[52:55], v[196:199], v[116:119], v[52:55]
    v_mad_u32_u24 v127, v115, s9, v114
    v_bfe_u32 v113, v152, 3, 2
    v_mfma_f32_16x16x32_bf16 v[52:55], v[200:203], v[64:67], v[52:55]
    v_and_b32 v114, 3, v152
    v_xor_b32 v113, v113, v114
    v_mfma_f32_16x16x32_bf16 v[52:55], v[204:207], v[60:63], v[52:55]
    ds_write_b128 v165, v[16:19] offset:1024
    v_lshl_add_u32 v127, v113, 4, v127
    v_mfma_f32_16x16x32_bf16 v[52:55], v[240:243], v[68:71], v[52:55]
    s_lshl_b32 s8, s77, 4
    s_add_u32 s8, s8, 93184
    v_lshl_add_u32 v128, v112, 6, s8
    v_and_b32 v115, 3, v115
    v_mfma_f32_16x16x32_bf16 v[52:55], v[244:247], v[72:75], v[52:55]
    v_lshl_add_u32 v128, v115, 2, v128
    v_lshl_add_u32 v112, v112, 2, v114
    v_mfma_f32_16x16x32_bf16 v[4:7], v[208:211], v[80:83], v[4:7]
    v_lshlrev_b32 v163, 4, v112
    v_lshl_add_u32 v163, v115, 9, v163
    v_mfma_f32_16x16x32_bf16 v[4:7], v[212:215], v[116:119], v[4:7]
    ds_read_b32 v128, v128
    s_lshl_b32 s8, s77, 2
    s_add_u32 s8, s8, 0
    v_bfe_u32 v113, v152, 4, 2
    v_lshl_add_u32 v131, v113, 5, s8
    v_mfma_f32_16x16x32_bf16 v[4:7], v[216:219], v[64:67], v[4:7]
    v_bfe_u32 v113, v152, 2, 1
    v_lshl_add_u32 v131, v113, 4, v131
    v_mfma_f32_16x16x32_bf16 v[4:7], v[220:223], v[60:63], v[4:7]
    ds_write_b128 v165, v[52:55] offset:2048
    v_bfe_u32 v113, v152, 3, 1
    v_lshl_add_u32 v131, v113, 1, v131
    v_mfma_f32_16x16x32_bf16 v[4:7], v[248:251], v[68:71], v[4:7]
    s_mul_i32 s8, s79, 163840
    s_mul_i32 s9, s78, 320
    s_add_u32 s8, s8, s9
    v_mul_u32_u24 v131, 1280, v131
    v_lshl_add_u32 v131, v114, 4, v131
    v_mfma_f32_16x16x32_bf16 v[4:7], v[252:255], v[72:75], v[4:7]
    s_waitcnt vmcnt(3)
    v_bitop3_b32 v169, v76, v78, v84 bitop3:254
    v_bitop3_b32 v169, v169, v86, v88 bitop3:254
    v_mfma_f32_16x16x32_bf16 v[40:43], a[216:219], v[80:83], v[40:43]
    buffer_load_dwordx4 v[80:83], v175, s[64:67], s32 offen offset:3072 sc1
    v_bitop3_b32 v169, v169, v90, v92 bitop3:254
    v_bitop3_b32 v169, v169, v94, v96 bitop3:254
    v_mfma_f32_16x16x32_bf16 v[40:43], a[220:223], v[116:119], v[40:43]
    v_bitop3_b32 v169, v169, v98, v100 bitop3:254
    v_bitop3_b32 v169, v169, v102, 1 bitop3:168
    v_mfma_f32_16x16x32_bf16 v[40:43], a[224:227], v[64:67], v[40:43]
    v_cmp_ne_u32 s[96:97], 0, v169
    v_add_u32 v131, s8, v131
    v_mfma_f32_16x16x32_bf16 v[40:43], a[228:231], v[60:63], v[40:43]
    ds_write_b128 v165, v[4:7] offset:3072
    v_mfma_f32_16x16x32_bf16 v[40:43], a[248:251], v[68:71], v[40:43]
    buffer_load_dwordx4 v[116:119], v175, s[64:67], s33 offen offset:0 sc1
    v_mfma_f32_16x16x32_bf16 v[40:43], a[252:255], v[72:75], v[40:43]
    s_cmp_lg_u64 s[96:97], 0
    s_cbranch_scc1 Lh1c6r
Lh1c6:
    v_mfma_f32_16x16x32_bf16 v[32:35], a[232:235], v[76:79], v[32:35]
    v_mfma_f32_16x16x32_bf16 v[32:35], a[236:239], v[84:87], v[32:35]
    v_mfma_f32_16x16x32_bf16 v[32:35], a[240:243], v[88:91], v[32:35]
    buffer_load_dwordx4 v[64:67], v175, s[64:67], s33 offen offset:1024 sc1
    v_mfma_f32_16x16x32_bf16 v[32:35], a[244:247], v[92:95], v[32:35]
    s_nop 0
    ds_write_b128 v165, v[40:43] offset:4096
    v_mfma_f32_16x16x32_bf16 v[32:35], v[224:227], v[96:99], v[32:35]
    s_add_u32 s3, s77, 2
    s_and_b32 s3, s3, 3
    v_mfma_f32_16x16x32_bf16 v[32:35], v[228:231], v[100:103], v[32:35]
    s_mul_i32 s3, s3, 15360
    v_add_u32 v165, s3, v153
    v_mfma_f32_16x16x32_bf16 v[20:23], v[176:179], v[76:79], v[20:23]
    buffer_load_dwordx4 v[60:63], v175, s[64:67], s23 offen offset:3072 sc1
    v_mfma_f32_16x16x32_bf16 v[20:23], v[180:183], v[84:87], v[20:23]
    v_mfma_f32_16x16x32_bf16 v[20:23], v[184:187], v[88:91], v[20:23]
    v_mfma_f32_16x16x32_bf16 v[20:23], v[188:191], v[92:95], v[20:23]
    s_nop 0
    ds_write_b128 v165, v[32:35] offset:5120
    v_mfma_f32_16x16x32_bf16 v[20:23], v[232:235], v[96:99], v[20:23]
    buffer_load_dwordx4 v[68:71], v175, s[64:67], s24 offen offset:0 sc1
    v_mfma_f32_16x16x32_bf16 v[20:23], v[236:239], v[100:103], v[20:23]
    v_mfma_f32_16x16x32_bf16 v[56:59], v[192:195], v[76:79], v[56:59]
    v_mfma_f32_16x16x32_bf16 v[56:59], v[196:199], v[84:87], v[56:59]
    v_mfma_f32_16x16x32_bf16 v[56:59], v[200:203], v[88:91], v[56:59]
    buffer_load_dwordx4 v[72:75], v175, s[64:67], s24 offen offset:1024 sc1
    v_mfma_f32_16x16x32_bf16 v[56:59], v[204:207], v[92:95], v[56:59]
    s_nop 2
    ds_write_b128 v165, v[20:23] offset:6144
    v_mfma_f32_16x16x32_bf16 v[56:59], v[240:243], v[96:99], v[56:59]
    v_mfma_f32_16x16x32_bf16 v[56:59], v[244:247], v[100:103], v[56:59]
    v_mfma_f32_16x16x32_bf16 v[8:11], v[208:211], v[76:79], v[8:11]
    v_mfma_f32_16x16x32_bf16 v[8:11], v[212:215], v[84:87], v[8:11]
    v_mfma_f32_16x16x32_bf16 v[8:11], v[216:219], v[88:91], v[8:11]
    v_mfma_f32_16x16x32_bf16 v[8:11], v[220:223], v[92:95], v[8:11]
    s_nop 3
    ds_write_b128 v165, v[56:59] offset:7168
    v_mfma_f32_16x16x32_bf16 v[8:11], v[248:251], v[96:99], v[8:11]
    v_mfma_f32_16x16x32_bf16 v[8:11], v[252:255], v[100:103], v[8:11]
    s_waitcnt vmcnt(3)
    v_bitop3_b32 v169, v104, v106, v108 bitop3:254
    v_bitop3_b32 v169, v169, v110, v120 bitop3:254
    v_mfma_f32_16x16x32_bf16 v[44:47], a[216:219], v[76:79], v[44:47]
    v_bitop3_b32 v169, v169, v122, v80 bitop3:254
    v_bitop3_b32 v169, v169, v82, v116 bitop3:254
    v_mfma_f32_16x16x32_bf16 v[44:47], a[220:223], v[84:87], v[44:47]
    v_bitop3_b32 v169, v169, v118, v64 bitop3:254
    v_bitop3_b32 v169, v169, v66, 1 bitop3:168
    v_mfma_f32_16x16x32_bf16 v[44:47], a[224:227], v[88:91], v[44:47]
    v_cmp_ne_u32 s[96:97], 0, v169
    v_mfma_f32_16x16x32_bf16 v[44:47], a[228:231], v[92:95], v[44:47]
    ds_write_b128 v165, v[8:11] offset:8192
    v_mfma_f32_16x16x32_bf16 v[44:47], a[248:251], v[96:99], v[44:47]
    v_mfma_f32_16x16x32_bf16 v[44:47], a[252:255], v[100:103], v[44:47]
    s_cmp_lg_u64 s[96:97], 0
    s_cbranch_scc1 Lh1c7r
Lh1c7:
    v_mfma_f32_16x16x32_bf16 v[36:39], a[232:235], v[104:107], v[36:39]
    v_mfma_f32_16x16x32_bf16 v[36:39], a[236:239], v[108:111], v[36:39]
    v_mfma_f32_16x16x32_bf16 v[36:39], a[240:243], v[120:123], v[36:39]
    v_mfma_f32_16x16x32_bf16 v[36:39], a[244:247], v[80:83], v[36:39]
    s_nop 1
    ds_write_b128 v165, v[44:47] offset:9216
    v_mfma_f32_16x16x32_bf16 v[36:39], v[224:227], v[116:119], v[36:39]
    s_add_u32 s3, s77, 3
    s_and_b32 s3, s3, 3
    v_mfma_f32_16x16x32_bf16 v[36:39], v[228:231], v[64:67], v[36:39]
    s_mul_i32 s3, s3, 15360
    v_add_u32 v165, s3, v153
    v_mfma_f32_16x16x32_bf16 v[24:27], v[176:179], v[104:107], v[24:27]
    v_mfma_f32_16x16x32_bf16 v[24:27], v[180:183], v[108:111], v[24:27]
    v_mfma_f32_16x16x32_bf16 v[24:27], v[184:187], v[120:123], v[24:27]
    v_mfma_f32_16x16x32_bf16 v[24:27], v[188:191], v[80:83], v[24:27]
    s_nop 1
    ds_write_b128 v165, v[36:39] offset:10240
    v_mfma_f32_16x16x32_bf16 v[24:27], v[232:235], v[116:119], v[24:27]
    v_mfma_f32_16x16x32_bf16 v[24:27], v[236:239], v[64:67], v[24:27]
    s_waitcnt lgkmcnt(1)
    s_barrier
    v_mfma_f32_16x16x32_bf16 v[0:3], v[192:195], v[104:107], v[0:3]
    ds_read_b128 v[28:31], v154 offset:0
    v_mfma_f32_16x16x32_bf16 v[0:3], v[196:199], v[108:111], v[0:3]
    ds_read_b128 v[16:19], v154 offset:1024
    v_mfma_f32_16x16x32_bf16 v[0:3], v[200:203], v[120:123], v[0:3]
    ds_read_b128 v[52:55], v154 offset:2048
    v_mfma_f32_16x16x32_bf16 v[0:3], v[204:207], v[80:83], v[0:3]
    ds_read_b128 v[4:7], v154 offset:3072
    ds_write_b128 v165, v[24:27] offset:11264
    v_mfma_f32_16x16x32_bf16 v[0:3], v[240:243], v[116:119], v[0:3]
    ds_read_b128 v[40:43], v154 offset:4096
    v_mfma_f32_16x16x32_bf16 v[0:3], v[244:247], v[64:67], v[0:3]
    ds_read_b128 v[32:35], v154 offset:5120
    v_mfma_f32_16x16x32_bf16 v[12:15], v[208:211], v[104:107], v[12:15]
    ds_read_b128 v[20:23], v154 offset:6144
    s_waitcnt lgkmcnt(7)
    v_add_f32 v132, v132, v28
    v_add_f32 v133, v133, v29
    v_mfma_f32_16x16x32_bf16 v[12:15], v[212:215], v[108:111], v[12:15]
    ds_read_b128 v[56:59], v154 offset:7168
    v_add_f32 v134, v134, v30
    v_add_f32 v135, v135, v31
    v_mfma_f32_16x16x32_bf16 v[12:15], v[216:219], v[120:123], v[12:15]
    ds_read_b128 v[8:11], v154 offset:8192
    s_waitcnt lgkmcnt(8)
    v_add_f32 v136, v136, v16
    v_add_f32 v137, v137, v17
    v_mfma_f32_16x16x32_bf16 v[12:15], v[220:223], v[80:83], v[12:15]
    ds_read_b128 v[44:47], v154 offset:9216
    ds_write_b128 v165, v[0:3] offset:12288
    v_add_f32 v138, v138, v18
    v_add_f32 v139, v139, v19
    v_mfma_f32_16x16x32_bf16 v[12:15], v[248:251], v[116:119], v[12:15]
    s_waitcnt lgkmcnt(9)
    v_add_f32 v140, v140, v52
    v_add_f32 v141, v141, v53
    v_mfma_f32_16x16x32_bf16 v[12:15], v[252:255], v[64:67], v[12:15]
    s_waitcnt vmcnt(0)
    v_add_f32 v142, v142, v54
    v_add_f32 v143, v143, v55
    v_bitop3_b32 v169, v60, v62, v68 bitop3:254
    v_mfma_f32_16x16x32_bf16 v[48:51], a[216:219], v[104:107], v[48:51]
    s_waitcnt lgkmcnt(8)
    v_add_f32 v144, v144, v4
    v_add_f32 v145, v145, v5
    v_bitop3_b32 v169, v169, v70, v72 bitop3:254
    v_mfma_f32_16x16x32_bf16 v[48:51], a[220:223], v[108:111], v[48:51]
    v_add_f32 v146, v146, v6
    v_add_f32 v147, v147, v7
    v_bitop3_b32 v169, v169, v74, 1 bitop3:168
    v_mfma_f32_16x16x32_bf16 v[48:51], a[224:227], v[120:123], v[48:51]
    s_waitcnt lgkmcnt(6)
    v_add_f32 v148, v148, v40
    v_add_f32 v149, v149, v41
    v_cmp_ne_u32 s[96:97], 0, v169
    v_mfma_f32_16x16x32_bf16 v[48:51], a[228:231], v[80:83], v[48:51]
    ds_write_b128 v165, v[12:15] offset:13312
    v_add_f32 v150, v150, v42
    v_add_f32 v151, v151, v43
    v_mfma_f32_16x16x32_bf16 v[48:51], a[248:251], v[116:119], v[48:51]
    v_mfma_f32_16x16x32_bf16 v[48:51], a[252:255], v[64:67], v[48:51]
    s_cmp_lg_u64 s[96:97], 0
    s_cbranch_scc1 Lh1c8r
Lh1c8:
    s_waitcnt lgkmcnt(6)
    v_mfma_f32_16x16x32_bf16 v[32:35], a[244:247], v[60:63], v[32:35]
    v_mfma_f32_16x16x32_bf16 v[32:35], v[224:227], v[68:71], v[32:35]
    v_mfma_f32_16x16x32_bf16 v[32:35], v[228:231], v[72:75], v[32:35]
    s_waitcnt lgkmcnt(5)
    v_mfma_f32_16x16x32_bf16 v[20:23], v[188:191], v[60:63], v[20:23]
    ds_write_b128 v165, v[48:51] offset:14336
    v_mfma_f32_16x16x32_bf16 v[20:23], v[232:235], v[68:71], v[20:23]
    v_mfma_f32_16x16x32_bf16 v[20:23], v[236:239], v[72:75], v[20:23]
    s_waitcnt lgkmcnt(5)
    v_mfma_f32_16x16x32_bf16 v[56:59], v[204:207], v[60:63], v[56:59]
    v_mfma_f32_16x16x32_bf16 v[56:59], v[240:243], v[68:71], v[56:59]
    v_mfma_f32_16x16x32_bf16 v[56:59], v[244:247], v[72:75], v[56:59]
    s_waitcnt lgkmcnt(0)
    s_barrier
    v_mfma_f32_16x16x32_bf16 v[8:11], v[220:223], v[60:63], v[8:11]
    ds_read_b128 v[28:31], v154 offset:10240
    v_mfma_f32_16x16x32_bf16 v[8:11], v[248:251], v[68:71], v[8:11]
    ds_read_b128 v[16:19], v154 offset:11264
    v_mfma_f32_16x16x32_bf16 v[8:11], v[252:255], v[72:75], v[8:11]
    ds_read_b128 v[52:55], v154 offset:12288
    v_mfma_f32_16x16x32_bf16 v[44:47], a[228:231], v[60:63], v[44:47]
    ds_read_b128 v[4:7], v154 offset:13312
    v_mfma_f32_16x16x32_bf16 v[44:47], a[248:251], v[68:71], v[44:47]
    ds_read_b128 v[40:43], v154 offset:14336
    v_mfma_f32_16x16x32_bf16 v[44:47], a[252:255], v[72:75], v[44:47]
    v_pk_add_f32 v[132:133], v[132:133], v[32:33]
    v_pk_add_f32 v[134:135], v[134:135], v[34:35]
    v_pk_add_f32 v[136:137], v[136:137], v[20:21]
    v_pk_add_f32 v[138:139], v[138:139], v[22:23]
    v_pk_add_f32 v[140:141], v[140:141], v[56:57]
    v_pk_add_f32 v[142:143], v[142:143], v[58:59]
    v_pk_add_f32 v[144:145], v[144:145], v[8:9]
    v_pk_add_f32 v[146:147], v[146:147], v[10:11]
    v_pk_add_f32 v[148:149], v[148:149], v[44:45]
    v_pk_add_f32 v[150:151], v[150:151], v[46:47]
    s_waitcnt lgkmcnt(4)
    v_pk_add_f32 v[132:133], v[132:133], v[28:29]
    v_pk_add_f32 v[134:135], v[134:135], v[30:31]
    s_waitcnt lgkmcnt(3)
    v_pk_add_f32 v[136:137], v[136:137], v[16:17]
    v_pk_add_f32 v[138:139], v[138:139], v[18:19]
    s_waitcnt lgkmcnt(2)
    v_pk_add_f32 v[140:141], v[140:141], v[52:53]
    v_pk_add_f32 v[142:143], v[142:143], v[54:55]
    s_waitcnt lgkmcnt(1)
    v_pk_add_f32 v[144:145], v[144:145], v[4:5]
    v_pk_add_f32 v[146:147], v[146:147], v[6:7]
    s_waitcnt lgkmcnt(0)
    v_pk_add_f32 v[148:149], v[148:149], v[40:41]
    v_pk_add_f32 v[150:151], v[150:151], v[42:43]
    v_pk_add_f32 v[4:5], v[132:133], v[134:135]
    v_pk_mul_f32 v[6:7], v[132:133], v[132:133]
    v_pk_fma_f32 v[6:7], v[134:135], v[134:135], v[6:7]
    v_pk_fma_f32 v[6:7], v[136:137], v[136:137], v[6:7]
    v_pk_add_f32 v[4:5], v[4:5], v[136:137]
    v_pk_fma_f32 v[6:7], v[138:139], v[138:139], v[6:7]
    v_pk_add_f32 v[4:5], v[4:5], v[138:139]
    v_pk_fma_f32 v[6:7], v[140:141], v[140:141], v[6:7]
    v_pk_add_f32 v[4:5], v[4:5], v[140:141]
    v_pk_fma_f32 v[6:7], v[142:143], v[142:143], v[6:7]
    v_pk_add_f32 v[4:5], v[4:5], v[142:143]
    v_pk_fma_f32 v[6:7], v[144:145], v[144:145], v[6:7]
    v_pk_add_f32 v[4:5], v[4:5], v[144:145]
    v_pk_fma_f32 v[6:7], v[146:147], v[146:147], v[6:7]
    v_pk_add_f32 v[4:5], v[4:5], v[146:147]
    v_pk_fma_f32 v[6:7], v[148:149], v[148:149], v[6:7]
    v_pk_add_f32 v[4:5], v[4:5], v[148:149]
    v_pk_fma_f32 v[6:7], v[150:151], v[150:151], v[6:7]
    v_pk_add_f32 v[4:5], v[4:5], v[150:151]
    v_add_f32 v6, v6, v7
    v_add_f32 v4, v4, v5
    v_mov_b32 v1, s82
    s_nop 0
    v_permlane32_swap_b32 v4, v6
    v_add_f32 v4, v4, v6
    v_mov_b32 v6, v4
    s_nop 1
    v_permlane16_swap_b32 v4, v6
    v_add_f32 v0, v4, v6

    s_cmp_eq_u32 s88, 0
    s_cbranch_scc1 Lss_35
    global_store_dwordx2 v155, v[0:1], s[98:99]
Lsd_36:
    ds_write_b128 v124, v[132:135] offset:0
    v_accvgpr_read_b32 v84, a0
    v_accvgpr_read_b32 v85, a1
    ds_write_b128 v125, v[136:139] offset:0
    v_accvgpr_read_b32 v88, a4
    v_accvgpr_read_b32 v89, a5
    ds_write_b128 v124, v[140:143] offset:128
    v_accvgpr_read_b32 v92, a8
    v_accvgpr_read_b32 v93, a9
    ds_write_b128 v125, v[144:147] offset:128
    v_accvgpr_read_b32 v96, a12
    v_accvgpr_read_b32 v97, a13
    ds_write_b128 v126, v[148:151] offset:256
    v_accvgpr_read_b32 v100, a16
    v_accvgpr_read_b32 v101, a17
    ds_read_b128 v[20:23], v127 offset:0
    ds_read_b128 v[24:27], v127 offset:64
    ds_read_b128 v[28:31], v127 offset:128
    ds_read_b128 v[32:35], v127 offset:192
    ds_read_b128 v[36:39], v127 offset:256
    v_accvgpr_read_b32 v86, a2
    v_accvgpr_read_b32 v87, a3
    v_accvgpr_read_b32 v90, a6
    v_accvgpr_read_b32 v91, a7
    v_accvgpr_read_b32 v94, a10
    v_accvgpr_read_b32 v95, a11
    v_accvgpr_read_b32 v98, a14
    v_accvgpr_read_b32 v99, a15
    v_accvgpr_read_b32 v102, a18
    v_accvgpr_read_b32 v103, a19
    global_load_dwordx4 v[0:3], v163, s[98:99] sc1
    global_load_dwordx4 v[4:7], v163, s[98:99] offset:256 sc1
    s_waitcnt lgkmcnt(4)
    v_pk_add_f32 v[60:61], v[20:21], v[128:129] op_sel_hi:[1,0]
    v_pk_add_f32 v[62:63], v[22:23], v[128:129] op_sel_hi:[1,0]
    s_waitcnt lgkmcnt(3)
    v_pk_add_f32 v[64:65], v[24:25], v[128:129] op_sel_hi:[1,0]
    v_pk_add_f32 v[66:67], v[26:27], v[128:129] op_sel_hi:[1,0]
    s_waitcnt lgkmcnt(2)
    v_pk_add_f32 v[68:69], v[28:29], v[128:129] op_sel_hi:[1,0]
    v_pk_add_f32 v[70:71], v[30:31], v[128:129] op_sel_hi:[1,0]
    s_waitcnt lgkmcnt(1)
    v_pk_add_f32 v[72:73], v[32:33], v[128:129] op_sel_hi:[1,0]
    v_pk_add_f32 v[74:75], v[34:35], v[128:129] op_sel_hi:[1,0]
    s_waitcnt lgkmcnt(0)
    v_pk_add_f32 v[76:77], v[36:37], v[128:129] op_sel_hi:[1,0]
    v_pk_add_f32 v[78:79], v[38:39], v[128:129] op_sel_hi:[1,0]
    s_waitcnt vmcnt(0)
    L_s3:
    v_min3_u32 v168, v1, v3, v5
    v_max3_u32 v1, v1, v3, v5
    v_min3_u32 v168, v168, v7, s82
    v_max3_u32 v1, v1, v7, s82
    v_cmp_ne_u32 vcc, v168, v1

    s_cbranch_vccnz L_s3r
    v_add_f32 v0, v0, v4
    v_add_f32 v2, v2, v6
    s_nop 0
    v_add_f32_dpp v0, v0, v0 row_ror:4 row_mask:0xf bank_mask:0xf
    v_add_f32_dpp v2, v2, v2 row_ror:4 row_mask:0xf bank_mask:0xf
    s_nop 0
    v_add_f32_dpp v0, v0, v0 row_ror:8 row_mask:0xf bank_mask:0xf
    v_add_f32_dpp v2, v2, v2 row_ror:8 row_mask:0xf bank_mask:0xf
    s_nop 0
    v_mov_b32_dpp v4, v0 quad_perm:[0,0,0,0] row_mask:0xf bank_mask:1
    v_mov_b32_dpp v6, v2 quad_perm:[0,0,0,0] row_mask:0xf bank_mask:1
    s_nop 0
    v_mov_b32_dpp v4, v0 quad_perm:[1,1,1,1] row_mask:0xf bank_mask:2
    v_mov_b32_dpp v6, v2 quad_perm:[1,1,1,1] row_mask:0xf bank_mask:2
    s_nop 0
    v_mov_b32_dpp v4, v0 quad_perm:[2,2,2,2] row_mask:0xf bank_mask:4
    v_mov_b32_dpp v6, v2 quad_perm:[2,2,2,2] row_mask:0xf bank_mask:4
    s_nop 0
    v_mov_b32_dpp v4, v0 quad_perm:[3,3,3,3] row_mask:0xf bank_mask:8
    v_mov_b32_dpp v6, v2 quad_perm:[3,3,3,3] row_mask:0xf bank_mask:8
    v_mul_f32 v4, 0x3acccccd, v4
    v_mov_b32 v166, 0x3727c5ac
    v_fmac_f32 v166, 0x3acccccd, v6
    v_fma_f32 v166, -v4, v4, v166
    v_max_f32 v166, 0x3727c5ac, v166
    v_rsq_f32 v166, v166
    s_nop 0
    v_mul_f32_e64 v167, -v4, v166
    v_pk_fma_f32 v[20:21], v[20:21], v[166:167], v[166:167] op_sel:[0,0,1] op_sel_hi:[1,0,1]
    v_pk_fma_f32 v[22:23], v[22:23], v[166:167], v[166:167] op_sel:[0,0,1] op_sel_hi:[1,0,1]
    v_pk_fma_f32 v[60:61], v[20:21], v[84:85], v[60:61]
    v_pk_fma_f32 v[62:63], v[22:23], v[86:87], v[62:63]
    global_store_dwordx4 v131, v[60:63], s[46:47] offset:0
    v_pk_fma_f32 v[24:25], v[24:25], v[166:167], v[166:167] op_sel:[0,0,1] op_sel_hi:[1,0,1]
    v_pk_fma_f32 v[26:27], v[26:27], v[166:167], v[166:167] op_sel:[0,0,1] op_sel_hi:[1,0,1]
    v_pk_fma_f32 v[64:65], v[24:25], v[88:89], v[64:65]
    v_pk_fma_f32 v[66:67], v[26:27], v[90:91], v[66:67]
    global_store_dwordx4 v131, v[64:67], s[46:47] offset:64
    v_pk_fma_f32 v[28:29], v[28:29], v[166:167], v[166:167] op_sel:[0,0,1] op_sel_hi:[1,0,1]
    v_pk_fma_f32 v[30:31], v[30:31], v[166:167], v[166:167] op_sel:[0,0,1] op_sel_hi:[1,0,1]
    v_pk_fma_f32 v[68:69], v[28:29], v[92:93], v[68:69]
    v_pk_fma_f32 v[70:71], v[30:31], v[94:95], v[70:71]
    global_store_dwordx4 v131, v[68:71], s[46:47] offset:128
    v_pk_fma_f32 v[32:33], v[32:33], v[166:167], v[166:167] op_sel:[0,0,1] op_sel_hi:[1,0,1]
    v_pk_fma_f32 v[34:35], v[34:35], v[166:167], v[166:167] op_sel:[0,0,1] op_sel_hi:[1,0,1]
    v_pk_fma_f32 v[72:73], v[32:33], v[96:97], v[72:73]
    v_pk_fma_f32 v[74:75], v[34:35], v[98:99], v[74:75]
    global_store_dwordx4 v131, v[72:75], s[46:47] offset:192
    v_pk_fma_f32 v[36:37], v[36:37], v[166:167], v[166:167] op_sel:[0,0,1] op_sel_hi:[1,0,1]
    v_pk_fma_f32 v[38:39], v[38:39], v[166:167], v[166:167] op_sel:[0,0,1] op_sel_hi:[1,0,1]
    v_pk_fma_f32 v[76:77], v[36:37], v[100:101], v[76:77]
    v_pk_fma_f32 v[78:79], v[38:39], v[102:103], v[78:79]
    global_store_dwordx4 v131, v[76:79], s[46:47] offset:256
L_end:
    s_endpgm
L_nonce_re:
    s_sub_u32 s101, s101, 1
    s_cbranch_scc1 L_end
    global_load_dword v224, v224, s[48:49] sc1
    s_waitcnt vmcnt(0)
    s_branch L_nonce
L_kf_re:
    s_sub_u32 s101, s101, 1
    s_cbranch_scc1 L_end
    global_load_dword v224, v169, s[50:51] sc1
    global_load_dwordx2 v[170:171], v168, s[50:51] sc1
    s_waitcnt vmcnt(0)
    s_branch L_kf
L_cre0:
    s_sub_u32 s101, s101, 1
    s_cbranch_scc1 L_end
    buffer_load_dwordx4 v[244:247], v253, s[92:95], 0 offen offset:2048 sc1
    buffer_load_dwordx4 v[240:243], v253, s[92:95], 0 offen offset:1792 sc1
    buffer_load_dwordx4 v[236:239], v253, s[92:95], 0 offen offset:1536 sc1
    buffer_load_dwordx4 v[232:235], v253, s[92:95], 0 offen offset:1280 sc1
    buffer_load_dwordx4 v[228:231], v253, s[92:95], 0 offen offset:1024 sc1
    buffer_load_dwordx4 v[224:227], v253, s[92:95], 0 offen offset:768 sc1
    buffer_load_dwordx4 v[220:223], v253, s[92:95], 0 offen offset:512 sc1
    buffer_load_dwordx4 v[216:219], v253, s[92:95], 0 offen offset:256 sc1
    s_waitcnt vmcnt(0)
    s_branch L_cchk0
Lss_3:
    buffer_store_dwordx4 v[216:219], v153, s[64:67], s36 offen sc1
    s_branch Lsd_4
Lss_5:
    buffer_store_dwordx4 v[220:223], v153, s[64:67], s18 offen sc1
    s_branch Lsd_6
Lss_7:
    buffer_store_dwordx2 v[244:245], v28, s[64:67], s37 offen offset:0 sc1
    buffer_store_dwordx2 v[246:247], v28, s[64:67], s37 offen offset:512 sc1
    s_branch Lsd_8
Lss_9:
    buffer_store_dwordx4 v[224:227], v153, s[64:67], s19 offen sc1
    s_branch Lsd_10
Lss_11:
    buffer_store_dwordx4 v[228:231], v153, s[64:67], s20 offen sc1
    s_branch Lsd_12
Lss_13:
    global_store_dword v169, v173, s[50:51] sc1
    s_branch Lsd_14
L_fh_re0:
    s_sub_u32 s101, s101, 1
    s_cbranch_scc1 L_end
    global_load_dword v169, v173, s[50:51] sc1
    s_waitcnt vmcnt(0)
    s_branch L_fh0
L_fh_re1:
    s_sub_u32 s101, s101, 1
    s_cbranch_scc1 L_end
    global_load_dword v169, v173, s[50:51] sc1
    s_waitcnt vmcnt(0)
    s_branch L_fh1
Lss_17:
    global_store_dwordx2 v155, v[0:1], s[98:99] sc1
    s_branch Lsd_18
L_gcr:
    s_sub_u32 s101, s101, 1
    s_cbranch_scc1 L_end
    s_add_u32 m0, s100, 61440
    s_nop 0
    buffer_load_dwordx4 v164, s[68:71], s6 offen sc1 lds
    s_add_u32 m0, s100, 62464
    s_add_u32 s83, s6, 32768
    buffer_load_dwordx4 v164, s[68:71], s83 offen sc1 lds
    s_add_u32 m0, s5, 69632
    s_mov_b32 exec_hi, 0
    buffer_load_dwordx4 v164, s[68:71], s7 offen sc1 lds
    s_mov_b32 exec_hi, -1
    s_waitcnt vmcnt(0)
    ds_read2st64_b32 v[8:9], v170 offset1:2
    ds_read2st64_b32 v[10:11], v170 offset0:4 offset1:6
    ds_read_b32 v12, v171
    s_waitcnt lgkmcnt(0)
    v_max3_u32 v169, v8, v9, v10
    v_max3_u32 v169, v169, v11, v12
    v_cmp_eq_u32 vcc, -1, v169
    s_cbranch_vccnz L_gcr
    s_branch L_gc
L_s1r:
    s_sub_u32 s101, s101, 1
    s_cbranch_scc1 L_end
    global_load_dwordx4 v[0:3], v163, s[98:99] sc1
    global_load_dwordx4 v[4:7], v163, s[98:99] offset:256 sc1
    s_waitcnt vmcnt(0)
    s_branch L_s1
Lss_19:
    buffer_store_dwordx4 v[36:39], v153, s[64:67], s12 offen sc1
    buffer_store_dwordx4 v[40:43], v153, s[64:67], s12 offen offset:1024 sc1
    s_mov_b32 exec_lo, 0xffff
    s_mov_b32 exec_hi, 0xffff
    buffer_store_dwordx4 v[44:47], v84, s[64:67], s12 offen offset:2048 sc1
    s_branch Lsd_20
Lss_21:
    global_store_dwordx2 v155, v[0:1], s[98:99] sc1
    s_branch Lsd_22
L_xc0r:
    s_sub_u32 s101, s101, 1
    s_cbranch_scc1 L_end
    s_lshl_b32 m0, s81, 13
    s_add_u32 m0, m0, 0
    s_add_u32 s83, s72, s85
    s_add_u32 s83, s83, 0
    buffer_load_dwordx4 v153, s[64:67], s83 offen offset:0 sc1 lds
    s_lshl_b32 m0, s81, 13
    s_add_u32 m0, m0, 2048
    s_add_u32 s83, s72, s85
    s_add_u32 s83, s83, 20480
    buffer_load_dwordx4 v153, s[64:67], s83 offen offset:0 sc1 lds
    s_lshl_b32 m0, s81, 13
    s_add_u32 m0, m0, 4096
    s_add_u32 s83, s72, s85
    s_add_u32 s83, s83, 40960
    buffer_load_dwordx4 v153, s[64:67], s83 offen offset:0 sc1 lds
    s_lshl_b32 m0, s81, 13
    s_add_u32 m0, m0, 6144
    s_add_u32 s83, s72, s85
    s_add_u32 s83, s83, 61440
    buffer_load_dwordx4 v153, s[64:67], s83 offen offset:0 sc1 lds
    s_waitcnt vmcnt(0)
    v_and_b32 v169, 0x23ff, v158
    v_add_u32 v169, 0, v169
    ds_read_b128 v[56:59], v169 offset:0
    v_and_b32 v169, 0x23ff, v158
    v_add_u32 v169, 0, v169
    ds_read_b128 v[60:63], v169 offset:2048
    v_and_b32 v169, 0x23ff, v158
    v_add_u32 v169, 0, v169
    ds_read_b128 v[64:67], v169 offset:4096
    v_and_b32 v169, 0x23ff, v158
    v_add_u32 v169, 0, v169
    ds_read_b128 v[68:71], v169 offset:6144
    s_waitcnt lgkmcnt(0)
    v_bitop3_b32 v169, v56, v60, v64 bitop3:128
    v_bitop3_b32 v169, v169, v68, 1 bitop3:128
    v_cmp_ne_u32 vcc, 1, v169
    s_cbranch_vccnz L_xc0r
    s_branch L_xc0
L_xc1r:
    s_sub_u32 s101, s101, 1
    s_cbranch_scc1 L_end
    s_lshl_b32 m0, s81, 13
    s_add_u32 m0, m0, 0
    s_add_u32 s83, s72, s85
    s_add_u32 s83, s83, 0
    buffer_load_dwordx4 v153, s[64:67], s83 offen offset:1024 sc1 lds
    s_lshl_b32 m0, s81, 13
    s_add_u32 m0, m0, 2048
    s_add_u32 s83, s72, s85
    s_add_u32 s83, s83, 20480
    buffer_load_dwordx4 v153, s[64:67], s83 offen offset:1024 sc1 lds
    s_lshl_b32 m0, s81, 13
    s_add_u32 m0, m0, 4096
    s_add_u32 s83, s72, s85
    s_add_u32 s83, s83, 40960
    buffer_load_dwordx4 v153, s[64:67], s83 offen offset:1024 sc1 lds
    s_lshl_b32 m0, s81, 13
    s_add_u32 m0, m0, 6144
    s_add_u32 s83, s72, s85
    s_add_u32 s83, s83, 61440
    buffer_load_dwordx4 v153, s[64:67], s83 offen offset:1024 sc1 lds
    s_waitcnt vmcnt(0)
    v_and_b32 v169, 0x23ff, v158
    v_add_u32 v169, 0, v169
    ds_read_b128 v[72:75], v169 offset:1024
    v_and_b32 v169, 0x23ff, v158
    v_add_u32 v169, 0, v169
    ds_read_b128 v[76:79], v169 offset:3072
    v_and_b32 v169, 0x23ff, v158
    v_add_u32 v169, 0, v169
    ds_read_b128 v[80:83], v169 offset:5120
    v_and_b32 v169, 0x23ff, v158
    v_add_u32 v169, 0, v169
    ds_read_b128 v[84:87], v169 offset:7168
    s_waitcnt lgkmcnt(0)
    v_bitop3_b32 v169, v72, v76, v80 bitop3:128
    v_bitop3_b32 v169, v169, v84, 1 bitop3:128
    v_cmp_ne_u32 vcc, 1, v169
    s_cbranch_vccnz L_xc1r
    s_branch L_xc1
L_xc2r:
    s_sub_u32 s101, s101, 1
    s_cbranch_scc1 L_end
    s_lshl_b32 m0, s81, 13
    s_xor_b32 m0, m0, 0x2000
    s_add_u32 m0, m0, 0
    s_add_u32 s83, s72, s90
    s_add_u32 s83, s83, 0
    buffer_load_dwordx4 v153, s[64:67], s83 offen offset:0 sc1 lds
    s_lshl_b32 m0, s81, 13
    s_xor_b32 m0, m0, 0x2000
    s_add_u32 m0, m0, 2048
    s_add_u32 s83, s72, s90
    s_add_u32 s83, s83, 20480
    buffer_load_dwordx4 v153, s[64:67], s83 offen offset:0 sc1 lds
    s_lshl_b32 m0, s81, 13
    s_xor_b32 m0, m0, 0x2000
    s_add_u32 m0, m0, 4096
    s_add_u32 s83, s72, s90
    s_add_u32 s83, s83, 40960
    buffer_load_dwordx4 v153, s[64:67], s83 offen offset:0 sc1 lds
    s_lshl_b32 m0, s81, 13
    s_xor_b32 m0, m0, 0x2000
    s_add_u32 m0, m0, 6144
    s_add_u32 s83, s72, s90
    s_add_u32 s83, s83, 61440
    buffer_load_dwordx4 v153, s[64:67], s83 offen offset:0 sc1 lds
    s_waitcnt vmcnt(0)
    v_and_b32 v169, 0x23ff, v159
    v_add_u32 v169, 0, v169
    ds_read_b128 v[88:91], v169 offset:0
    v_and_b32 v169, 0x23ff, v159
    v_add_u32 v169, 0, v169
    ds_read_b128 v[92:95], v169 offset:2048
    v_and_b32 v169, 0x23ff, v159
    v_add_u32 v169, 0, v169
    ds_read_b128 v[96:99], v169 offset:4096
    v_and_b32 v169, 0x23ff, v159
    v_add_u32 v169, 0, v169
    ds_read_b128 v[100:103], v169 offset:6144
    s_waitcnt lgkmcnt(0)
    v_bitop3_b32 v169, v88, v92, v96 bitop3:128
    v_bitop3_b32 v169, v169, v100, 1 bitop3:128
    v_cmp_ne_u32 vcc, 1, v169
    s_cbranch_vccnz L_xc2r
    s_branch L_xc2
L_xc3r:
    s_sub_u32 s101, s101, 1
    s_cbranch_scc1 L_end
    s_lshl_b32 m0, s81, 13
    s_xor_b32 m0, m0, 0x2000
    s_add_u32 m0, m0, 0
    s_add_u32 s83, s72, s90
    s_add_u32 s83, s83, 0
    buffer_load_dwordx4 v153, s[64:67], s83 offen offset:1024 sc1 lds
    s_lshl_b32 m0, s81, 13
    s_xor_b32 m0, m0, 0x2000
    s_add_u32 m0, m0, 2048
    s_add_u32 s83, s72, s90
    s_add_u32 s83, s83, 20480
    buffer_load_dwordx4 v153, s[64:67], s83 offen offset:1024 sc1 lds
    s_lshl_b32 m0, s81, 13
    s_xor_b32 m0, m0, 0x2000
    s_add_u32 m0, m0, 4096
    s_add_u32 s83, s72, s90
    s_add_u32 s83, s83, 40960
    buffer_load_dwordx4 v153, s[64:67], s83 offen offset:1024 sc1 lds
    s_lshl_b32 m0, s81, 13
    s_xor_b32 m0, m0, 0x2000
    s_add_u32 m0, m0, 6144
    s_add_u32 s83, s72, s90
    s_add_u32 s83, s83, 61440
    buffer_load_dwordx4 v153, s[64:67], s83 offen offset:1024 sc1 lds
    s_waitcnt vmcnt(0)
    v_and_b32 v169, 0x23ff, v159
    v_add_u32 v169, 0, v169
    ds_read_b128 v[56:59], v169 offset:1024
    v_and_b32 v169, 0x23ff, v159
    v_add_u32 v169, 0, v169
    ds_read_b128 v[60:63], v169 offset:3072
    v_and_b32 v169, 0x23ff, v159
    v_add_u32 v169, 0, v169
    ds_read_b128 v[64:67], v169 offset:5120
    v_and_b32 v169, 0x23ff, v159
    v_add_u32 v169, 0, v169
    ds_read_b128 v[68:71], v169 offset:7168
    s_waitcnt lgkmcnt(0)
    v_bitop3_b32 v169, v56, v60, v64 bitop3:128
    v_bitop3_b32 v169, v169, v68, 1 bitop3:128
    v_cmp_ne_u32 vcc, 1, v169
    s_cbranch_vccnz L_xc3r
    s_branch L_xc3
L_xc4r:
    s_sub_u32 s101, s101, 1
    s_cbranch_scc1 L_end
    s_lshl_b32 m0, s81, 13
    s_add_u32 m0, m0, 16384
    s_add_u32 s83, s73, s85
    s_add_u32 s83, s83, 0
    buffer_load_dwordx4 v153, s[64:67], s83 offen offset:0 sc1 lds
    s_lshl_b32 m0, s81, 13
    s_add_u32 m0, m0, 18432
    s_add_u32 s83, s73, s85
    s_add_u32 s83, s83, 20480
    buffer_load_dwordx4 v153, s[64:67], s83 offen offset:0 sc1 lds
    s_lshl_b32 m0, s81, 13
    s_add_u32 m0, m0, 20480
    s_add_u32 s83, s73, s85
    s_add_u32 s83, s83, 40960
    buffer_load_dwordx4 v153, s[64:67], s83 offen offset:0 sc1 lds
    s_lshl_b32 m0, s81, 13
    s_add_u32 m0, m0, 22528
    s_add_u32 s83, s73, s85
    s_add_u32 s83, s83, 61440
    buffer_load_dwordx4 v153, s[64:67], s83 offen offset:0 sc1 lds
    s_waitcnt vmcnt(0)
    v_and_b32 v169, 0x23ff, v158
    v_add_u32 v169, 16384, v169
    ds_read_b128 v[72:75], v169 offset:0
    v_and_b32 v169, 0x23ff, v158
    v_add_u32 v169, 16384, v169
    ds_read_b128 v[76:79], v169 offset:2048
    v_and_b32 v169, 0x23ff, v158
    v_add_u32 v169, 16384, v169
    ds_read_b128 v[80:83], v169 offset:4096
    v_and_b32 v169, 0x23ff, v158
    v_add_u32 v169, 16384, v169
    ds_read_b128 v[84:87], v169 offset:6144
    s_waitcnt lgkmcnt(0)
    v_bitop3_b32 v169, v72, v76, v80 bitop3:128
    v_bitop3_b32 v169, v169, v84, 1 bitop3:128
    v_cmp_ne_u32 vcc, 1, v169
    s_cbranch_vccnz L_xc4r
    s_branch L_xc4
L_xc5r:
    s_sub_u32 s101, s101, 1
    s_cbranch_scc1 L_end
    s_lshl_b32 m0, s81, 13
    s_add_u32 m0, m0, 16384
    s_add_u32 s83, s73, s85
    s_add_u32 s83, s83, 0
    buffer_load_dwordx4 v153, s[64:67], s83 offen offset:1024 sc1 lds
    s_lshl_b32 m0, s81, 13
    s_add_u32 m0, m0, 18432
    s_add_u32 s83, s73, s85
    s_add_u32 s83, s83, 20480
    buffer_load_dwordx4 v153, s[64:67], s83 offen offset:1024 sc1 lds
    s_lshl_b32 m0, s81, 13
    s_add_u32 m0, m0, 20480
    s_add_u32 s83, s73, s85
    s_add_u32 s83, s83, 40960
    buffer_load_dwordx4 v153, s[64:67], s83 offen offset:1024 sc1 lds
    s_lshl_b32 m0, s81, 13
    s_add_u32 m0, m0, 22528
    s_add_u32 s83, s73, s85
    s_add_u32 s83, s83, 61440
    buffer_load_dwordx4 v153, s[64:67], s83 offen offset:1024 sc1 lds
    s_waitcnt vmcnt(0)
    v_and_b32 v169, 0x23ff, v158
    v_add_u32 v169, 16384, v169
    ds_read_b128 v[88:91], v169 offset:1024
    v_and_b32 v169, 0x23ff, v158
    v_add_u32 v169, 16384, v169
    ds_read_b128 v[92:95], v169 offset:3072
    v_and_b32 v169, 0x23ff, v158
    v_add_u32 v169, 16384, v169
    ds_read_b128 v[96:99], v169 offset:5120
    v_and_b32 v169, 0x23ff, v158
    v_add_u32 v169, 16384, v169
    ds_read_b128 v[100:103], v169 offset:7168
    s_waitcnt lgkmcnt(0)
    v_bitop3_b32 v169, v88, v92, v96 bitop3:128
    v_bitop3_b32 v169, v169, v100, 1 bitop3:128
    v_cmp_ne_u32 vcc, 1, v169
    s_cbranch_vccnz L_xc5r
    s_branch L_xc5
L_s2r:
    s_sub_u32 s101, s101, 1
    s_cbranch_scc1 L_end
    global_load_dwordx4 v[104:107], v163, s[98:99] sc1
    global_load_dwordx4 v[108:111], v163, s[98:99] offset:256 sc1
    s_waitcnt vmcnt(0)
    s_branch L_s2
L_xc6r:
    s_sub_u32 s101, s101, 1
    s_cbranch_scc1 L_end
    s_lshl_b32 m0, s81, 13
    s_add_u32 m0, m0, 32768
    s_add_u32 s83, s74, s85
    s_add_u32 s83, s83, 0
    buffer_load_dwordx4 v153, s[64:67], s83 offen offset:0 sc1 lds
    s_lshl_b32 m0, s81, 13
    s_add_u32 m0, m0, 34816
    s_add_u32 s83, s74, s85
    s_add_u32 s83, s83, 20480
    buffer_load_dwordx4 v153, s[64:67], s83 offen offset:0 sc1 lds
    s_lshl_b32 m0, s81, 13
    s_add_u32 m0, m0, 36864
    s_add_u32 s83, s74, s85
    s_add_u32 s83, s83, 40960
    buffer_load_dwordx4 v153, s[64:67], s83 offen offset:0 sc1 lds
    s_lshl_b32 m0, s81, 13
    s_add_u32 m0, m0, 38912
    s_add_u32 s83, s74, s85
    s_add_u32 s83, s83, 61440
    buffer_load_dwordx4 v153, s[64:67], s83 offen offset:0 sc1 lds
    s_waitcnt vmcnt(0)
    v_and_b32 v169, 0x23ff, v158
    v_add_u32 v169, 32768, v169
    ds_read_b128 v[56:59], v169 offset:0
    v_and_b32 v169, 0x23ff, v158
    v_add_u32 v169, 32768, v169
    ds_read_b128 v[60:63], v169 offset:2048
    v_and_b32 v169, 0x23ff, v158
    v_add_u32 v169, 32768, v169
    ds_read_b128 v[64:67], v169 offset:4096
    v_and_b32 v169, 0x23ff, v158
    v_add_u32 v169, 32768, v169
    ds_read_b128 v[68:71], v169 offset:6144
    s_waitcnt lgkmcnt(0)
    v_bitop3_b32 v169, v56, v60, v64 bitop3:128
    v_bitop3_b32 v169, v169, v68, 1 bitop3:128
    v_cmp_ne_u32 vcc, 1, v169
    s_cbranch_vccnz L_xc6r
    s_branch L_xc6
L_xc7r:
    s_sub_u32 s101, s101, 1
    s_cbranch_scc1 L_end
    s_lshl_b32 m0, s81, 13
    s_add_u32 m0, m0, 32768
    s_add_u32 s83, s74, s85
    s_add_u32 s83, s83, 0
    buffer_load_dwordx4 v153, s[64:67], s83 offen offset:1024 sc1 lds
    s_lshl_b32 m0, s81, 13
    s_add_u32 m0, m0, 34816
    s_add_u32 s83, s74, s85
    s_add_u32 s83, s83, 20480
    buffer_load_dwordx4 v153, s[64:67], s83 offen offset:1024 sc1 lds
    s_lshl_b32 m0, s81, 13
    s_add_u32 m0, m0, 36864
    s_add_u32 s83, s74, s85
    s_add_u32 s83, s83, 40960
    buffer_load_dwordx4 v153, s[64:67], s83 offen offset:1024 sc1 lds
    s_lshl_b32 m0, s81, 13
    s_add_u32 m0, m0, 38912
    s_add_u32 s83, s74, s85
    s_add_u32 s83, s83, 61440
    buffer_load_dwordx4 v153, s[64:67], s83 offen offset:1024 sc1 lds
    s_waitcnt vmcnt(0)
    v_and_b32 v169, 0x23ff, v158
    v_add_u32 v169, 32768, v169
    ds_read_b128 v[72:75], v169 offset:1024
    v_and_b32 v169, 0x23ff, v158
    v_add_u32 v169, 32768, v169
    ds_read_b128 v[76:79], v169 offset:3072
    v_and_b32 v169, 0x23ff, v158
    v_add_u32 v169, 32768, v169
    ds_read_b128 v[80:83], v169 offset:5120
    v_and_b32 v169, 0x23ff, v158
    v_add_u32 v169, 32768, v169
    ds_read_b128 v[84:87], v169 offset:7168
    s_waitcnt lgkmcnt(0)
    v_bitop3_b32 v169, v72, v76, v80 bitop3:128
    v_bitop3_b32 v169, v169, v84, 1 bitop3:128
    v_cmp_ne_u32 vcc, 1, v169
    s_cbranch_vccnz L_xc7r
    s_branch L_xc7
L_xc8r:
    s_sub_u32 s101, s101, 1
    s_cbranch_scc1 L_end
    s_lshl_b32 m0, s81, 13
    s_add_u32 m0, m0, 49152
    s_add_u32 s83, s75, s85
    s_add_u32 s83, s83, 0
    buffer_load_dwordx4 v153, s[64:67], s83 offen offset:0 sc1 lds
    s_lshl_b32 m0, s81, 13
    s_add_u32 m0, m0, 51200
    s_add_u32 s83, s75, s85
    s_add_u32 s83, s83, 20480
    buffer_load_dwordx4 v153, s[64:67], s83 offen offset:0 sc1 lds
    s_lshl_b32 m0, s81, 13
    s_add_u32 m0, m0, 53248
    s_add_u32 s83, s75, s85
    s_add_u32 s83, s83, 40960
    buffer_load_dwordx4 v153, s[64:67], s83 offen offset:0 sc1 lds
    s_lshl_b32 m0, s81, 13
    s_add_u32 m0, m0, 55296
    s_add_u32 s83, s75, s85
    s_add_u32 s83, s83, 61440
    buffer_load_dwordx4 v153, s[64:67], s83 offen offset:0 sc1 lds
    s_waitcnt vmcnt(0)
    v_and_b32 v169, 0x23ff, v158
    v_add_u32 v169, 49152, v169
    ds_read_b128 v[88:91], v169 offset:0
    v_and_b32 v169, 0x23ff, v158
    v_add_u32 v169, 49152, v169
    ds_read_b128 v[92:95], v169 offset:2048
    v_and_b32 v169, 0x23ff, v158
    v_add_u32 v169, 49152, v169
    ds_read_b128 v[96:99], v169 offset:4096
    v_and_b32 v169, 0x23ff, v158
    v_add_u32 v169, 49152, v169
    ds_read_b128 v[100:103], v169 offset:6144
    s_waitcnt lgkmcnt(0)
    v_bitop3_b32 v169, v88, v92, v96 bitop3:128
    v_bitop3_b32 v169, v169, v100, 1 bitop3:128
    v_cmp_ne_u32 vcc, 1, v169
    s_cbranch_vccnz L_xc8r
    s_branch L_xc8
L_xc9r:
    s_sub_u32 s101, s101, 1
    s_cbranch_scc1 L_end
    s_lshl_b32 m0, s81, 13
    s_add_u32 m0, m0, 49152
    s_add_u32 s83, s75, s85
    s_add_u32 s83, s83, 0
    buffer_load_dwordx4 v153, s[64:67], s83 offen offset:1024 sc1 lds
    s_lshl_b32 m0, s81, 13
    s_add_u32 m0, m0, 51200
    s_add_u32 s83, s75, s85
    s_add_u32 s83, s83, 20480
    buffer_load_dwordx4 v153, s[64:67], s83 offen offset:1024 sc1 lds
    s_lshl_b32 m0, s81, 13
    s_add_u32 m0, m0, 53248
    s_add_u32 s83, s75, s85
    s_add_u32 s83, s83, 40960
    buffer_load_dwordx4 v153, s[64:67], s83 offen offset:1024 sc1 lds
    s_lshl_b32 m0, s81, 13
    s_add_u32 m0, m0, 55296
    s_add_u32 s83, s75, s85
    s_add_u32 s83, s83, 61440
    buffer_load_dwordx4 v153, s[64:67], s83 offen offset:1024 sc1 lds
    s_waitcnt vmcnt(0)
    v_and_b32 v169, 0x23ff, v158
    v_add_u32 v169, 49152, v169
    ds_read_b128 v[56:59], v169 offset:1024
    v_and_b32 v169, 0x23ff, v158
    v_add_u32 v169, 49152, v169
    ds_read_b128 v[60:63], v169 offset:3072
    v_and_b32 v169, 0x23ff, v158
    v_add_u32 v169, 49152, v169
    ds_read_b128 v[64:67], v169 offset:5120
    v_and_b32 v169, 0x23ff, v158
    v_add_u32 v169, 49152, v169
    ds_read_b128 v[68:71], v169 offset:7168
    s_waitcnt lgkmcnt(0)
    v_bitop3_b32 v169, v56, v60, v64 bitop3:128
    v_bitop3_b32 v169, v169, v68, 1 bitop3:128
    v_cmp_ne_u32 vcc, 1, v169
    s_cbranch_vccnz L_xc9r
    s_branch L_xc9
L_xc10r:
    s_sub_u32 s101, s101, 1
    s_cbranch_scc1 L_end
    s_lshl_b32 m0, s81, 13
    s_add_u32 m0, m0, 65536
    s_add_u32 s83, s76, s85
    s_add_u32 s83, s83, 0
    buffer_load_dwordx4 v153, s[64:67], s83 offen offset:0 sc1 lds
    s_lshl_b32 m0, s81, 13
    s_add_u32 m0, m0, 65536
    s_add_u32 s83, s76, s85
    s_add_u32 s83, s83, 0
    buffer_load_dwordx4 v153, s[64:67], s83 offen offset:1024 sc1 lds
    s_lshl_b32 m0, s81, 13
    s_add_u32 m0, m0, 67584
    s_add_u32 s83, s76, s85
    s_add_u32 s83, s83, 20480
    buffer_load_dwordx4 v153, s[64:67], s83 offen offset:0 sc1 lds
    s_lshl_b32 m0, s81, 13
    s_add_u32 m0, m0, 67584
    s_add_u32 s83, s76, s85
    s_add_u32 s83, s83, 20480
    buffer_load_dwordx4 v153, s[64:67], s83 offen offset:1024 sc1 lds
    s_waitcnt vmcnt(0)
    v_and_b32 v169, 0x23ff, v158
    v_add_u32 v169, 65536, v169
    ds_read_b128 v[72:75], v169 offset:0
    v_and_b32 v169, 0x23ff, v158
    v_add_u32 v169, 65536, v169
    ds_read_b128 v[76:79], v169 offset:1024
    v_and_b32 v169, 0x23ff, v158
    v_add_u32 v169, 65536, v169
    ds_read_b128 v[80:83], v169 offset:2048
    v_and_b32 v169, 0x23ff, v158
    v_add_u32 v169, 65536, v169
    ds_read_b128 v[84:87], v169 offset:3072
    s_waitcnt lgkmcnt(0)
    v_bitop3_b32 v169, v72, v76, v80 bitop3:128
    v_bitop3_b32 v169, v169, v84, 1 bitop3:128
    v_cmp_ne_u32 vcc, 1, v169
    s_cbranch_vccnz L_xc10r
    s_branch L_xc10
L_xc11r:
    s_sub_u32 s101, s101, 1
    s_cbranch_scc1 L_end
    s_lshl_b32 m0, s81, 13
    s_add_u32 m0, m0, 69632
    s_add_u32 s83, s76, s85
    s_add_u32 s83, s83, 40960
    buffer_load_dwordx4 v153, s[64:67], s83 offen offset:0 sc1 lds
    s_lshl_b32 m0, s81, 13
    s_add_u32 m0, m0, 69632
    s_add_u32 s83, s76, s85
    s_add_u32 s83, s83, 40960
    buffer_load_dwordx4 v153, s[64:67], s83 offen offset:1024 sc1 lds
    s_lshl_b32 m0, s81, 13
    s_add_u32 m0, m0, 71680
    s_add_u32 s83, s76, s85
    s_add_u32 s83, s83, 61440
    buffer_load_dwordx4 v153, s[64:67], s83 offen offset:0 sc1 lds
    s_lshl_b32 m0, s81, 13
    s_add_u32 m0, m0, 71680
    s_add_u32 s83, s76, s85
    s_add_u32 s83, s83, 61440
    buffer_load_dwordx4 v153, s[64:67], s83 offen offset:1024 sc1 lds
    s_waitcnt vmcnt(0)
    v_and_b32 v169, 0x23ff, v158
    v_add_u32 v169, 65536, v169
    ds_read_b128 v[88:91], v169 offset:4096
    v_and_b32 v169, 0x23ff, v158
    v_add_u32 v169, 65536, v169
    ds_read_b128 v[92:95], v169 offset:5120
    v_and_b32 v169, 0x23ff, v158
    v_add_u32 v169, 65536, v169
    ds_read_b128 v[96:99], v169 offset:6144
    v_and_b32 v169, 0x23ff, v158
    v_add_u32 v169, 65536, v169
    ds_read_b128 v[100:103], v169 offset:7168
    s_waitcnt lgkmcnt(0)
    v_bitop3_b32 v169, v88, v92, v96 bitop3:128
    v_bitop3_b32 v169, v169, v100, 1 bitop3:128
    v_cmp_ne_u32 vcc, 1, v169
    s_cbranch_vccnz L_xc11r
    s_branch L_xc11
L_xc12r:
    s_sub_u32 s101, s101, 1
    s_cbranch_scc1 L_end
    s_lshl_b32 m0, s81, 13
    s_xor_b32 m0, m0, 0x2000
    s_add_u32 m0, m0, 16384
    s_add_u32 s83, s73, s90
    s_add_u32 s83, s83, 0
    buffer_load_dwordx4 v153, s[64:67], s83 offen offset:0 sc1 lds
    s_lshl_b32 m0, s81, 13
    s_xor_b32 m0, m0, 0x2000
    s_add_u32 m0, m0, 16384
    s_add_u32 s83, s73, s90
    s_add_u32 s83, s83, 0
    buffer_load_dwordx4 v153, s[64:67], s83 offen offset:1024 sc1 lds
    s_lshl_b32 m0, s81, 13
    s_xor_b32 m0, m0, 0x2000
    s_add_u32 m0, m0, 32768
    s_add_u32 s83, s74, s90
    s_add_u32 s83, s83, 0
    buffer_load_dwordx4 v153, s[64:67], s83 offen offset:0 sc1 lds
    s_lshl_b32 m0, s81, 13
    s_xor_b32 m0, m0, 0x2000
    s_add_u32 m0, m0, 32768
    s_add_u32 s83, s74, s90
    s_add_u32 s83, s83, 0
    buffer_load_dwordx4 v153, s[64:67], s83 offen offset:1024 sc1 lds
    s_waitcnt vmcnt(0)
    v_and_b32 v169, 0x23ff, v159
    v_add_u32 v169, 16384, v169
    ds_read_b128 v[56:59], v169 offset:0
    v_and_b32 v169, 0x23ff, v159
    v_add_u32 v169, 16384, v169
    ds_read_b128 v[60:63], v169 offset:1024
    v_and_b32 v169, 0x23ff, v159
    v_add_u32 v169, 32768, v169
    ds_read_b128 v[64:67], v169 offset:0
    v_and_b32 v169, 0x23ff, v159
    v_add_u32 v169, 32768, v169
    ds_read_b128 v[68:71], v169 offset:1024
    s_waitcnt lgkmcnt(0)
    v_bitop3_b32 v169, v56, v60, v64 bitop3:128
    v_bitop3_b32 v169, v169, v68, 1 bitop3:128
    v_cmp_ne_u32 vcc, 1, v169
    s_cbranch_vccnz L_xc12r
    s_branch L_xc12
L_xc13r:
    s_sub_u32 s101, s101, 1
    s_cbranch_scc1 L_end
    s_lshl_b32 m0, s81, 13
    s_xor_b32 m0, m0, 0x2000
    s_add_u32 m0, m0, 49152
    s_add_u32 s83, s75, s90
    s_add_u32 s83, s83, 0
    buffer_load_dwordx4 v153, s[64:67], s83 offen offset:0 sc1 lds
    s_lshl_b32 m0, s81, 13
    s_xor_b32 m0, m0, 0x2000
    s_add_u32 m0, m0, 49152
    s_add_u32 s83, s75, s90
    s_add_u32 s83, s83, 0
    buffer_load_dwordx4 v153, s[64:67], s83 offen offset:1024 sc1 lds
    s_lshl_b32 m0, s81, 13
    s_xor_b32 m0, m0, 0x2000
    s_add_u32 m0, m0, 65536
    s_add_u32 s83, s76, s90
    s_add_u32 s83, s83, 0
    buffer_load_dwordx4 v153, s[64:67], s83 offen offset:0 sc1 lds
    s_lshl_b32 m0, s81, 13
    s_xor_b32 m0, m0, 0x2000
    s_add_u32 m0, m0, 65536
    s_add_u32 s83, s76, s90
    s_add_u32 s83, s83, 0
    buffer_load_dwordx4 v153, s[64:67], s83 offen offset:1024 sc1 lds
    s_waitcnt vmcnt(0)
    v_and_b32 v169, 0x23ff, v159
    v_add_u32 v169, 49152, v169
    ds_read_b128 v[72:75], v169 offset:0
    v_and_b32 v169, 0x23ff, v159
    v_add_u32 v169, 49152, v169
    ds_read_b128 v[76:79], v169 offset:1024
    v_and_b32 v169, 0x23ff, v159
    v_add_u32 v169, 65536, v169
    ds_read_b128 v[80:83], v169 offset:0
    v_and_b32 v169, 0x23ff, v159
    v_add_u32 v169, 65536, v169
    ds_read_b128 v[84:87], v169 offset:1024
    s_waitcnt lgkmcnt(0)
    v_bitop3_b32 v169, v72, v76, v80 bitop3:128
    v_bitop3_b32 v169, v169, v84, 1 bitop3:128
    v_cmp_ne_u32 vcc, 1, v169
    s_cbranch_vccnz L_xc13r
    s_branch L_xc13
L_xc14r:
    s_sub_u32 s101, s101, 1
    s_cbranch_scc1 L_end
    s_lshl_b32 m0, s81, 13
    s_xor_b32 m0, m0, 0x2000
    s_add_u32 m0, m0, 18432
    s_add_u32 s83, s73, s90
    s_add_u32 s83, s83, 20480
    buffer_load_dwordx4 v153, s[64:67], s83 offen offset:0 sc1 lds
    s_lshl_b32 m0, s81, 13
    s_xor_b32 m0, m0, 0x2000
    s_add_u32 m0, m0, 18432
    s_add_u32 s83, s73, s90
    s_add_u32 s83, s83, 20480
    buffer_load_dwordx4 v153, s[64:67], s83 offen offset:1024 sc1 lds
    s_lshl_b32 m0, s81, 13
    s_xor_b32 m0, m0, 0x2000
    s_add_u32 m0, m0, 34816
    s_add_u32 s83, s74, s90
    s_add_u32 s83, s83, 20480
    buffer_load_dwordx4 v153, s[64:67], s83 offen offset:0 sc1 lds
    s_lshl_b32 m0, s81, 13
    s_xor_b32 m0, m0, 0x2000
    s_add_u32 m0, m0, 34816
    s_add_u32 s83, s74, s90
    s_add_u32 s83, s83, 20480
    buffer_load_dwordx4 v153, s[64:67], s83 offen offset:1024 sc1 lds
    s_waitcnt vmcnt(0)
    v_and_b32 v169, 0x23ff, v159
    v_add_u32 v169, 16384, v169
    ds_read_b128 v[56:59], v169 offset:2048
    v_and_b32 v169, 0x23ff, v159
    v_add_u32 v169, 16384, v169
    ds_read_b128 v[60:63], v169 offset:3072
    v_and_b32 v169, 0x23ff, v159
    v_add_u32 v169, 32768, v169
    ds_read_b128 v[64:67], v169 offset:2048
    v_and_b32 v169, 0x23ff, v159
    v_add_u32 v169, 32768, v169
    ds_read_b128 v[68:71], v169 offset:3072
    s_waitcnt lgkmcnt(0)
    v_bitop3_b32 v169, v56, v60, v64 bitop3:128
    v_bitop3_b32 v169, v169, v68, 1 bitop3:128
    v_cmp_ne_u32 vcc, 1, v169
    s_cbranch_vccnz L_xc14r
    s_branch L_xc14
L_xc15r:
    s_sub_u32 s101, s101, 1
    s_cbranch_scc1 L_end
    s_lshl_b32 m0, s81, 13
    s_xor_b32 m0, m0, 0x2000
    s_add_u32 m0, m0, 51200
    s_add_u32 s83, s75, s90
    s_add_u32 s83, s83, 20480
    buffer_load_dwordx4 v153, s[64:67], s83 offen offset:0 sc1 lds
    s_lshl_b32 m0, s81, 13
    s_xor_b32 m0, m0, 0x2000
    s_add_u32 m0, m0, 51200
    s_add_u32 s83, s75, s90
    s_add_u32 s83, s83, 20480
    buffer_load_dwordx4 v153, s[64:67], s83 offen offset:1024 sc1 lds
    s_lshl_b32 m0, s81, 13
    s_xor_b32 m0, m0, 0x2000
    s_add_u32 m0, m0, 67584
    s_add_u32 s83, s76, s90
    s_add_u32 s83, s83, 20480
    buffer_load_dwordx4 v153, s[64:67], s83 offen offset:0 sc1 lds
    s_lshl_b32 m0, s81, 13
    s_xor_b32 m0, m0, 0x2000
    s_add_u32 m0, m0, 67584
    s_add_u32 s83, s76, s90
    s_add_u32 s83, s83, 20480
    buffer_load_dwordx4 v153, s[64:67], s83 offen offset:1024 sc1 lds
    s_waitcnt vmcnt(0)
    v_and_b32 v169, 0x23ff, v159
    v_add_u32 v169, 49152, v169
    ds_read_b128 v[72:75], v169 offset:2048
    v_and_b32 v169, 0x23ff, v159
    v_add_u32 v169, 49152, v169
    ds_read_b128 v[76:79], v169 offset:3072
    v_and_b32 v169, 0x23ff, v159
    v_add_u32 v169, 65536, v169
    ds_read_b128 v[80:83], v169 offset:2048
    v_and_b32 v169, 0x23ff, v159
    v_add_u32 v169, 65536, v169
    ds_read_b128 v[84:87], v169 offset:3072
    s_waitcnt lgkmcnt(0)
    v_bitop3_b32 v169, v72, v76, v80 bitop3:128
    v_bitop3_b32 v169, v169, v84, 1 bitop3:128
    v_cmp_ne_u32 vcc, 1, v169
    s_cbranch_vccnz L_xc15r
    s_branch L_xc15
Lss_23:
    global_store_dword v110, v111, s[50:51] sc1
    s_branch Lsd_24
L_cre1:
    s_sub_u32 s101, s101, 1
    s_cbranch_scc1 L_end
    buffer_load_dwordx4 v[116:119], v85, s[92:95], 0 offen offset:2048 sc1
    buffer_load_dwordx4 v[112:115], v85, s[92:95], 0 offen offset:1792 sc1
    buffer_load_dwordx4 v[108:111], v85, s[92:95], 0 offen offset:1536 sc1
    buffer_load_dwordx4 v[104:107], v85, s[92:95], 0 offen offset:1280 sc1
    buffer_load_dwordx4 v[100:103], v85, s[92:95], 0 offen offset:1024 sc1
    buffer_load_dwordx4 v[96:99], v85, s[92:95], 0 offen offset:768 sc1
    buffer_load_dwordx4 v[92:95], v85, s[92:95], 0 offen offset:512 sc1
    buffer_load_dwordx4 v[88:91], v85, s[92:95], 0 offen offset:256 sc1
    s_waitcnt vmcnt(0)
    s_branch L_cchk1
L_xr_re:
    s_sub_u32 s101, s101, 1
    s_cbranch_scc1 L_end
    global_load_dword v64, v87, s[50:51] sc1
    s_waitcnt vmcnt(0)
    s_branch L_xr
Lss_25:
    buffer_store_dwordx4 v[88:91], v153, s[64:67], s36 offen sc1
    s_branch Lsd_26
Lss_27:
    buffer_store_dwordx4 v[92:95], v153, s[64:67], s18 offen sc1
    s_branch Lsd_28
Lss_29:
    buffer_store_dwordx2 v[116:117], v62, s[64:67], s37 offen offset:0 sc1
    buffer_store_dwordx2 v[118:119], v62, s[64:67], s37 offen offset:512 sc1
    s_branch Lsd_30
Lss_31:
    buffer_store_dwordx4 v[96:99], v153, s[64:67], s19 offen sc1
    s_branch Lsd_32
Lss_33:
    buffer_store_dwordx4 v[100:103], v153, s[64:67], s20 offen sc1
    s_branch Lsd_34
Lh1c0r:
    s_sub_u32 s101, s101, 1
    s_cbranch_scc1 L_end
    buffer_load_dwordx4 v[40:43], v175, s[64:67], s23 offen offset:0 sc1
    buffer_load_dwordx4 v[44:47], v175, s[64:67], s23 offen offset:1024 sc1
    buffer_load_dwordx4 v[48:51], v175, s[64:67], s23 offen offset:2048 sc1
    buffer_load_dwordx4 v[120:123], v175, s[64:67], s22 offen offset:0 sc1
    buffer_load_dwordx4 v[80:83], v175, s[64:67], s25 offen offset:0 sc1
    buffer_load_dwordx4 v[116:119], v175, s[64:67], s28 offen offset:0 sc1
    buffer_load_dwordx4 v[64:67], v175, s[64:67], s31 offen offset:0 sc1
    s_waitcnt vmcnt(0)
    v_bitop3_b32 v169, v40, v42, v44 bitop3:254
    v_bitop3_b32 v169, v169, v46, v48 bitop3:254
    v_bitop3_b32 v169, v169, v50, 1 bitop3:168
    v_cmp_ne_u32 vcc, 0, v169
    s_cbranch_vccnz Lh1c0r
    s_branch Lh1c0
Lh1c1r:
    s_sub_u32 s101, s101, 1
    s_cbranch_scc1 L_end
    buffer_load_dwordx4 v[120:123], v175, s[64:67], s22 offen offset:0 sc1
    buffer_load_dwordx4 v[80:83], v175, s[64:67], s25 offen offset:0 sc1
    buffer_load_dwordx4 v[116:119], v175, s[64:67], s28 offen offset:0 sc1
    buffer_load_dwordx4 v[64:67], v175, s[64:67], s31 offen offset:0 sc1
    buffer_load_dwordx4 v[60:63], v175, s[64:67], s22 offen offset:1024 sc1
    buffer_load_dwordx4 v[68:71], v175, s[64:67], s25 offen offset:1024 sc1
    buffer_load_dwordx4 v[72:75], v175, s[64:67], s28 offen offset:1024 sc1
    buffer_load_dwordx4 v[76:79], v175, s[64:67], s31 offen offset:1024 sc1
    s_waitcnt vmcnt(0)
    v_bitop3_b32 v169, v120, v122, v80 bitop3:254
    v_bitop3_b32 v169, v169, v82, v116 bitop3:254
    v_bitop3_b32 v169, v169, v118, v64 bitop3:254
    v_bitop3_b32 v169, v169, v66, 1 bitop3:168
    v_cmp_ne_u32 vcc, 0, v169
    s_cbranch_vccnz Lh1c1r
    s_branch Lh1c1
Lh1c2r:
    s_sub_u32 s101, s101, 1
    s_cbranch_scc1 L_end
    buffer_load_dwordx4 v[60:63], v175, s[64:67], s22 offen offset:1024 sc1
    buffer_load_dwordx4 v[68:71], v175, s[64:67], s25 offen offset:1024 sc1
    buffer_load_dwordx4 v[72:75], v175, s[64:67], s28 offen offset:1024 sc1
    buffer_load_dwordx4 v[76:79], v175, s[64:67], s31 offen offset:1024 sc1
    buffer_load_dwordx4 v[84:87], v175, s[64:67], s22 offen offset:2048 sc1
    buffer_load_dwordx4 v[88:91], v175, s[64:67], s25 offen offset:2048 sc1
    buffer_load_dwordx4 v[92:95], v175, s[64:67], s28 offen offset:2048 sc1
    buffer_load_dwordx4 v[96:99], v175, s[64:67], s31 offen offset:2048 sc1
    buffer_load_dwordx4 v[100:103], v175, s[64:67], s22 offen offset:3072 sc1
    s_waitcnt vmcnt(0)
    v_bitop3_b32 v169, v60, v62, v68 bitop3:254
    v_bitop3_b32 v169, v169, v70, v72 bitop3:254
    v_bitop3_b32 v169, v169, v74, v76 bitop3:254
    v_bitop3_b32 v169, v169, v78, 1 bitop3:168
    v_cmp_ne_u32 vcc, 0, v169
    s_cbranch_vccnz Lh1c2r
    s_branch Lh1c2
Lh1c3r:
    s_sub_u32 s101, s101, 1
    s_cbranch_scc1 L_end
    buffer_load_dwordx4 v[84:87], v175, s[64:67], s22 offen offset:2048 sc1
    buffer_load_dwordx4 v[88:91], v175, s[64:67], s25 offen offset:2048 sc1
    buffer_load_dwordx4 v[92:95], v175, s[64:67], s28 offen offset:2048 sc1
    buffer_load_dwordx4 v[96:99], v175, s[64:67], s31 offen offset:2048 sc1
    buffer_load_dwordx4 v[100:103], v175, s[64:67], s22 offen offset:3072 sc1
    buffer_load_dwordx4 v[104:107], v175, s[64:67], s25 offen offset:3072 sc1
    buffer_load_dwordx4 v[108:111], v175, s[64:67], s28 offen offset:3072 sc1
    buffer_load_dwordx4 v[120:123], v175, s[64:67], s31 offen offset:3072 sc1
    buffer_load_dwordx4 v[80:83], v175, s[64:67], s26 offen offset:0 sc1
    buffer_load_dwordx4 v[116:119], v175, s[64:67], s26 offen offset:1024 sc1
    s_waitcnt vmcnt(0)
    v_bitop3_b32 v169, v84, v86, v88 bitop3:254
    v_bitop3_b32 v169, v169, v90, v92 bitop3:254
    v_bitop3_b32 v169, v169, v94, v96 bitop3:254
    v_bitop3_b32 v169, v169, v98, 1 bitop3:168
    v_cmp_ne_u32 vcc, 0, v169
    s_cbranch_vccnz Lh1c3r
    s_branch Lh1c3
Lh1c4r:
    s_sub_u32 s101, s101, 1
    s_cbranch_scc1 L_end
    buffer_load_dwordx4 v[100:103], v175, s[64:67], s22 offen offset:3072 sc1
    buffer_load_dwordx4 v[104:107], v175, s[64:67], s25 offen offset:3072 sc1
    buffer_load_dwordx4 v[108:111], v175, s[64:67], s28 offen offset:3072 sc1
    buffer_load_dwordx4 v[120:123], v175, s[64:67], s31 offen offset:3072 sc1
    buffer_load_dwordx4 v[80:83], v175, s[64:67], s26 offen offset:0 sc1
    buffer_load_dwordx4 v[116:119], v175, s[64:67], s26 offen offset:1024 sc1
    buffer_load_dwordx4 v[64:67], v175, s[64:67], s26 offen offset:2048 sc1
    buffer_load_dwordx4 v[60:63], v175, s[64:67], s26 offen offset:3072 sc1
    buffer_load_dwordx4 v[68:71], v175, s[64:67], s27 offen offset:0 sc1
    buffer_load_dwordx4 v[72:75], v175, s[64:67], s27 offen offset:1024 sc1
    buffer_load_dwordx4 v[76:79], v175, s[64:67], s29 offen offset:0 sc1
    s_waitcnt vmcnt(0)
    v_bitop3_b32 v169, v100, v102, v104 bitop3:254
    v_bitop3_b32 v169, v169, v106, v108 bitop3:254
    v_bitop3_b32 v169, v169, v110, v120 bitop3:254
    v_bitop3_b32 v169, v169, v122, 1 bitop3:168
    v_cmp_ne_u32 vcc, 0, v169
    s_cbranch_vccnz Lh1c4r
    s_branch Lh1c4
Lh1c5r:
    s_sub_u32 s101, s101, 1
    s_cbranch_scc1 L_end
    buffer_load_dwordx4 v[80:83], v175, s[64:67], s26 offen offset:0 sc1
    buffer_load_dwordx4 v[116:119], v175, s[64:67], s26 offen offset:1024 sc1
    buffer_load_dwordx4 v[64:67], v175, s[64:67], s26 offen offset:2048 sc1
    buffer_load_dwordx4 v[60:63], v175, s[64:67], s26 offen offset:3072 sc1
    buffer_load_dwordx4 v[68:71], v175, s[64:67], s27 offen offset:0 sc1
    buffer_load_dwordx4 v[72:75], v175, s[64:67], s27 offen offset:1024 sc1
    buffer_load_dwordx4 v[76:79], v175, s[64:67], s29 offen offset:0 sc1
    buffer_load_dwordx4 v[84:87], v175, s[64:67], s29 offen offset:1024 sc1
    buffer_load_dwordx4 v[88:91], v175, s[64:67], s29 offen offset:2048 sc1
    buffer_load_dwordx4 v[92:95], v175, s[64:67], s29 offen offset:3072 sc1
    buffer_load_dwordx4 v[96:99], v175, s[64:67], s30 offen offset:0 sc1
    buffer_load_dwordx4 v[100:103], v175, s[64:67], s30 offen offset:1024 sc1
    s_waitcnt vmcnt(0)
    v_bitop3_b32 v169, v80, v82, v116 bitop3:254
    v_bitop3_b32 v169, v169, v118, v64 bitop3:254
    v_bitop3_b32 v169, v169, v66, v60 bitop3:254
    v_bitop3_b32 v169, v169, v62, v68 bitop3:254
    v_bitop3_b32 v169, v169, v70, v72 bitop3:254
    v_bitop3_b32 v169, v169, v74, 1 bitop3:168
    v_cmp_ne_u32 vcc, 0, v169
    s_cbranch_vccnz Lh1c5r
    s_branch Lh1c5
Lh1c6r:
    s_sub_u32 s101, s101, 1
    s_cbranch_scc1 L_end
    buffer_load_dwordx4 v[76:79], v175, s[64:67], s29 offen offset:0 sc1
    buffer_load_dwordx4 v[84:87], v175, s[64:67], s29 offen offset:1024 sc1
    buffer_load_dwordx4 v[88:91], v175, s[64:67], s29 offen offset:2048 sc1
    buffer_load_dwordx4 v[92:95], v175, s[64:67], s29 offen offset:3072 sc1
    buffer_load_dwordx4 v[96:99], v175, s[64:67], s30 offen offset:0 sc1
    buffer_load_dwordx4 v[100:103], v175, s[64:67], s30 offen offset:1024 sc1
    buffer_load_dwordx4 v[104:107], v175, s[64:67], s32 offen offset:0 sc1
    buffer_load_dwordx4 v[108:111], v175, s[64:67], s32 offen offset:1024 sc1
    buffer_load_dwordx4 v[120:123], v175, s[64:67], s32 offen offset:2048 sc1
    buffer_load_dwordx4 v[80:83], v175, s[64:67], s32 offen offset:3072 sc1
    buffer_load_dwordx4 v[116:119], v175, s[64:67], s33 offen offset:0 sc1
    s_waitcnt vmcnt(0)
    v_bitop3_b32 v169, v76, v78, v84 bitop3:254
    v_bitop3_b32 v169, v169, v86, v88 bitop3:254
    v_bitop3_b32 v169, v169, v90, v92 bitop3:254
    v_bitop3_b32 v169, v169, v94, v96 bitop3:254
    v_bitop3_b32 v169, v169, v98, v100 bitop3:254
    v_bitop3_b32 v169, v169, v102, 1 bitop3:168
    v_cmp_ne_u32 vcc, 0, v169
    s_cbranch_vccnz Lh1c6r
    s_branch Lh1c6
Lh1c7r:
    s_sub_u32 s101, s101, 1
    s_cbranch_scc1 L_end
    buffer_load_dwordx4 v[104:107], v175, s[64:67], s32 offen offset:0 sc1
    buffer_load_dwordx4 v[108:111], v175, s[64:67], s32 offen offset:1024 sc1
    buffer_load_dwordx4 v[120:123], v175, s[64:67], s32 offen offset:2048 sc1
    buffer_load_dwordx4 v[80:83], v175, s[64:67], s32 offen offset:3072 sc1
    buffer_load_dwordx4 v[116:119], v175, s[64:67], s33 offen offset:0 sc1
    buffer_load_dwordx4 v[64:67], v175, s[64:67], s33 offen offset:1024 sc1
    buffer_load_dwordx4 v[60:63], v175, s[64:67], s23 offen offset:3072 sc1
    buffer_load_dwordx4 v[68:71], v175, s[64:67], s24 offen offset:0 sc1
    buffer_load_dwordx4 v[72:75], v175, s[64:67], s24 offen offset:1024 sc1
    s_waitcnt vmcnt(0)
    v_bitop3_b32 v169, v104, v106, v108 bitop3:254
    v_bitop3_b32 v169, v169, v110, v120 bitop3:254
    v_bitop3_b32 v169, v169, v122, v80 bitop3:254
    v_bitop3_b32 v169, v169, v82, v116 bitop3:254
    v_bitop3_b32 v169, v169, v118, v64 bitop3:254
    v_bitop3_b32 v169, v169, v66, 1 bitop3:168
    v_cmp_ne_u32 vcc, 0, v169
    s_cbranch_vccnz Lh1c7r
    s_branch Lh1c7
Lh1c8r:
    s_sub_u32 s101, s101, 1
    s_cbranch_scc1 L_end
    buffer_load_dwordx4 v[60:63], v175, s[64:67], s23 offen offset:3072 sc1
    buffer_load_dwordx4 v[68:71], v175, s[64:67], s24 offen offset:0 sc1
    buffer_load_dwordx4 v[72:75], v175, s[64:67], s24 offen offset:1024 sc1
    s_waitcnt vmcnt(0)
    v_bitop3_b32 v169, v60, v62, v68 bitop3:254
    v_bitop3_b32 v169, v169, v70, v72 bitop3:254
    v_bitop3_b32 v169, v169, v74, 1 bitop3:168
    v_cmp_ne_u32 vcc, 0, v169
    s_cbranch_vccnz Lh1c8r
    s_branch Lh1c8
Lss_35:
    global_store_dwordx2 v155, v[0:1], s[98:99] sc1
    s_branch Lsd_36
L_s3r:
    s_sub_u32 s101, s101, 1
    s_cbranch_scc1 L_end
    global_load_dwordx4 v[0:3], v163, s[98:99] sc1
    global_load_dwordx4 v[4:7], v163, s[98:99] offset:256 sc1
    s_waitcnt vmcnt(0)
    s_branch L_s3
L_last:
    s_endpgm
.section .rodata,"a"
.p2align 6
.amdhsa_kernel interleave_layers__ssm_conv_s5__ssm_conv_h3__prompt_kernel
  .amdhsa_next_free_vgpr 512
  .amdhsa_next_free_sgpr 102
  .amdhsa_accum_offset 256
  .amdhsa_group_segment_fixed_size 0
  .amdhsa_kernarg_size 144
  .amdhsa_user_sgpr_count 2
  .amdhsa_user_sgpr_kernarg_segment_ptr 1
  .amdhsa_system_sgpr_workgroup_id_x 1
.end_amdhsa_kernel
```

```asm
; @launch grid=(256,1,1) block=(256,1,1) lds=163840
.amdgcn_target "amdgcn-amd-amdhsa--gfx950"
.text
.globl interleave_layers__ssm_conv_s5__ssm_conv_h3__prompt_kernel
.p2align 8
.type interleave_layers__ssm_conv_s5__ssm_conv_h3__prompt_kernel,@function
interleave_layers__ssm_conv_s5__ssm_conv_h3__prompt_kernel:
    s_cmp_gt_u32 s2, 255
    s_cbranch_scc1 L_end
    s_load_dwordx16 s[32:47], s[0:1], 64
    s_load_dwordx16 s[16:31], s[0:1], 0
    s_load_dwordx4 s[48:51], s[0:1], 128
    s_memrealtime s[6:7]
    v_and_b32 v152, 63, v0
    v_lshrrev_b32 v1, 6, v0
    s_and_b32 s8, s2, 7
    s_lshr_b32 s9, s2, 3
    v_readfirstlane_b32 s77, v1
    s_getpc_b64 s[4:5]
L_pc:
    s_lshl_b32 s3, s9, 2
    s_add_u32 s3, s3, s77
    s_lshl_b32 s3, s3, 9
    v_and_b32 v2, 3, v152
    v_lshl_add_u32 v2, v2, 7, s3
    v_min_u32 v2, L_last-L_pc, v2
    global_load_dword a255, v2, s[4:5]
    s_and_b32 s78, s9, 7
    s_lshr_b32 s10, s9, 3
    s_lshl_b32 s79, s10, 3
    s_add_u32 s79, s79, s8
    v_mov_b32 v174, 0
    s_and_b32 s10, s10, 2
    s_add_u32 s10, s10, s8
    s_add_u32 s10, s10, s78
    s_mov_b32 s12, s10
    v_lshrrev_b32 v12, 3, v152
    v_and_b32 v13, 7, v152
    v_mul_u32_u24 v158, 1280, v12
    v_lshl_add_u32 v14, v13, 4, v158
    s_mul_i32 s5, s79, 81920
    s_lshl_b32 s4, s78, 7
    s_add_u32 s4, s4, s5
    s_mul_i32 s3, s77, 20480
    s_add_u32 s3, s3, s4
    v_add_u32 v70, s3, v14
    s_mul_i32 s8, s77, 4128
    s_mov_b32 s66, 2621440
    s_mov_b32 s67, 0x20000
    s_add_u32 s70, s66, 1024
    s_mov_b32 s71, s67
    v_lshrrev_b32 v145, 1, v0
    v_min_u32 v145, 79, v145
    s_mul_i32 s13, s78, 160
    v_lshl_add_u32 v147, v145, 1, s13
    s_waitcnt lgkmcnt(0)
    s_mov_b64 s[64:65], s[36:37]
    s_sub_u32 s68, s38, 1024
    s_subb_u32 s69, s39, 0
    global_load_ushort v142, v147, s[18:19]
    global_load_ushort v143, v147, s[20:21]
    global_load_ushort v146, v147, s[32:33]
    global_load_ushort v144, v147, s[30:31]
    s_add_u32 m0, s8, 56336
    s_movk_i32 s83, 0
    buffer_load_dwordx4 v70, s[64:67], s83 offen nt lds
    buffer_load_dwordx4 v70, s[68:71], s83 offen offset:1024 nt lds
    s_add_u32 m0, s8, 58400
    s_movk_i32 s83, 10240
    buffer_load_dwordx4 v70, s[64:67], s83 offen nt lds
    buffer_load_dwordx4 v70, s[68:71], s83 offen offset:1024 nt lds
    s_sub_u32 s4, s4, 10240
    v_add_u32 v14, s4, v14
    v_lshrrev_b32 v15, 1, v152
    v_mul_u32_u24 v15, 1280, v15
    v_and_b32 v72, 1, v152
    v_lshl_add_u32 v15, v72, 4, v15
    s_mul_i32 s4, s78, 96
    s_sub_u32 s3, s3, s4
    s_add_u32 s3, s3, 2048
    v_add_u32 v72, s3, v15
    v_cmp_gt_u32 vcc, 40, v152
    v_subrev_u32 v71, 6144, v72
    s_mul_i32 s9, s77, 1536
    v_cndmask_b32 v71, v14, v71, vcc
    s_sub_u32 s9, 54272, s9
    v_lshlrev_b32 v153, 4, v152
    s_movk_i32 s3, 160
    v_cmp_gt_u32 s[96:97], s3, v0
    s_lshl_b32 s3, s78, 9
    v_add_u32 v16, s3, v153
    s_mul_i32 s3, s78, 384
    s_sub_u32 s3, 3584, s3
    v_lshrrev_b32 v17, 5, v152
    v_mad_u32_u24 v16, v17, s3, v16
    s_mul_i32 s13, s12, 52
    s_lshr_b32 s13, s13, 8
    s_mul_i32 s13, s13, 5
    s_sub_u32 s72, s12, s13
    s_mov_b32 m0, s9
    s_nop 0
    buffer_load_dwordx4 v71, s[64:67], 0 offen nt lds
    s_sub_u32 m0, s9, 512
    s_mov_b32 exec_hi, 0
    buffer_load_dwordx4 v72, s[68:71], 0 offen nt lds
    s_mov_b32 m0, 94016
    s_mov_b32 exec_hi, 0xff
    global_load_lds_dwordx4 v16, s[40:41]
    s_mov_b32 exec_hi, -1
    s_or_b32 s3, s2, s77
    s_cmp_lg_u32 s3, 0
    s_cbranch_scc1 L_par
    s_or_b32 s6, s6, 7
    v_mov_b32 v2, 0
    v_mov_b32 v3, s6
    global_store_dword v2, v3, s[48:49] sc1
L_par:
    s_and_b32 s80, s77, 1
    s_lshr_b32 s81, s77, 1
    s_lshl_b32 s84, s77, 14
    s_add_u32 s84, s84, 98304
    s_lshl_b32 s72, s72, 7
    s_mul_i32 s85, s81, 640
    s_sub_u32 s90, 640, s85
    s_lshl_b32 s100, s77, 11
    v_lshrrev_b32 v11, 4, v152
    v_xor_b32 v14, v13, v11
    v_lshlrev_b32 v14, 4, v14
    s_mul_i32 s3, s78, 102400
    s_mul_i32 s4, s77, 20480
    s_add_u32 s3, s3, s4
    v_add3_u32 v158, v158, v14, s3
    v_xor_b32 v159, 64, v158
    v_add_u32 v159, 9216, v159
    s_mov_b64 s[56:57], s[22:23]
    s_mov_b32 s58, 819200
    s_mov_b32 s59, 0x20000
    s_mov_b64 s[60:61], s[24:25]
    s_mov_b32 s62, 819200
    s_mov_b32 s63, 0x20000
    s_sub_u32 s4, 81920, s4
    s_cmp_eq_u32 s80, 0
    s_cselect_b32 s92, s22, s24
    s_cselect_b32 s93, s23, s25
    s_add_u32 s92, s92, s4
    s_addc_u32 s93, s93, 0
    s_sub_u32 s94, 819200, s4
    s_mov_b32 s95, 0x20000
    v_lshrrev_b32 v15, 5, v152
    v_mul_u32_u24 v164, 20480, v15
    v_bfe_u32 v15, v152, 3, 1
    s_movk_i32 s3, 10240
    v_mad_u32_u24 v164, v15, s3, v164
    v_and_b32 v15, 1, v11
    s_movk_i32 s3, 1280
    v_mad_u32_u24 v164, v15, s3, v164
    s_mul_i32 s4, s77, 2560
    s_add_u32 s5, s5, s4
    v_add3_u32 v164, v164, v14, s5
    v_xor_b32 v165, 64, v164
    v_add_u32 v165, 39936, v165
    s_mov_b64 s[52:53], s[16:17]
    s_mov_b32 s54, 2621440
    s_mov_b32 s55, 0x20000
    s_mul_i32 s3, s2, 3200
    s_mul_i32 s4, s77, 7
    v_min_u32 v112, 6, v152
    v_add_u32 v112, s4, v112
    v_min_u32 v112, 24, v112
    v_lshl_add_u32 v112, v112, 7, s3
    s_mul_i32 s3, s78, 10240
    s_add_u32 s3, s3, s5
    v_min_u32 v113, 19, v152
    v_lshl_add_u32 v113, v113, 7, s3
    s_lshl_b32 s4, s78, 6
    s_lshl_b32 s3, s79, 1
    global_load_dword a255, v112, s[22:23]
    s_add_u32 s3, s3, s4
    s_and_b32 s5, s79, 15
    s_lshl_b32 s4, s78, 4
    s_add_u32 s4, s4, s5
    global_load_dword a255, v112, s[24:25]
    s_add_u32 s4, s4, 512
    s_lshl_b32 s14, s3, 12
    s_lshl_b32 s15, s4, 12
    s_lshl_b32 s3, s3, 1
    global_load_dword a255, v113, s[16:17]
    s_lshl_b32 s4, s4, 1
    s_andn2_b32 s4, s4, 3
    s_load_dword s34, s[44:45], s3
    s_load_dword s35, s[44:45], s4
    s_lshl_b32 s5, s77, 10
    s_sub_u32 s5, s5, 4
    s_max_i32 s5, s5, 0
    s_add_u32 s3, s5, s14
    s_load_dword s30, s[42:43], s3
    s_add_u32 s3, s3, 4096
    s_load_dword s31, s[42:43], s3
    s_add_u32 s3, s5, s15
    s_load_dword s32, s[42:43], s3
    s_lshl_b32 s12, s77, 10
    v_add_u32 v243, s12, v153
    s_add_u32 s73, s72, 128
    s_cmp_eq_u32 s73, 640
    s_cselect_b32 s73, 0, s73
    s_add_u32 s74, s73, 128
    s_cmp_eq_u32 s74, 640
    s_cselect_b32 s74, 0, s74
    s_add_u32 s75, s74, 128
    s_cmp_eq_u32 s75, 640
    s_cselect_b32 s75, 0, s75
    s_add_u32 s76, s75, 128
    s_cmp_eq_u32 s76, 640
    s_cselect_b32 s76, 0, s76
    v_and_b32 v10, 15, v152
    v_lshrrev_b32 v14, 1, v10
    v_xor_b32 v14, v14, v11
    v_lshlrev_b32 v14, 4, v14
    v_lshl_add_u32 v14, v10, 7, v14
    v_add_u32 v156, s84, v14
    v_xor_b32 v157, 64, v156
    s_lshl_b32 s3, s81, 13
    v_add_u32 v120, s3, v14
    v_xor_b32 v121, 64, v120
    v_xor_b32 v122, 0x2000, v120
    v_xor_b32 v123, 0x2000, v121
    s_getreg_b32 s89, hwreg(HW_REG_XCC_ID, 0, 3)
    s_mov_b32 s101, 0x20000
    s_mov_b32 s86, 0xffff0000
    s_mov_b32 s87, 0x3f803f80
    v_mov_b32 v116, s87
    v_mov_b32 v117, s87
    v_mov_b32 v118, s87
    v_mov_b32 v119, s87
    v_mov_b32 v224, 0
    v_add_u32 v124, s100, v14
    v_xor_b32 v125, 64, v124
    v_lshrrev_b32 v226, 3, v152
    v_and_b32 v221, 7, v152
    s_lshl_b32 s3, s77, 5
    s_add_u32 s3, s3, 56336
    v_lshl_add_u32 v64, v226, 2, s3
    s_movk_i32 s3, 2064
    v_mad_u32_u24 v64, v221, s3, v64
    v_subrev_u32 v65, 1424, v64
    v_add_u32 v66, 1024, v64
    s_sub_u32 s3, s9, 512
    v_lshl_add_u32 v75, v221, 2, s3
    v_lshl_add_u32 v75, v226, 6, v75
    s_lshl_b32 s4, s78, 2
    s_add_u32 s4, s4, s77
    s_lshl_b32 s3, s4, 16
    s_lshl_b32 s5, s79, 7
    s_add_u32 s3, s3, s5
    s_add_u32 s3, s3, 2048
    v_lshl_add_u32 v76, v226, 13, s3
    v_lshl_add_u32 v76, v221, 4, v76
    s_lshl_b32 s4, s4, 14
    s_add_u32 s4, s4, s5
    s_add_u32 s4, s4, 2097152
    v_lshrrev_b32 v229, 4, v152
    v_lshl_add_u32 v229, v229, 12, s4
    v_and_b32 v228, 15, v152
    v_lshl_add_u32 v229, v228, 3, v229
    s_lshl_b32 s3, s77, 9
    s_add_u32 s3, s3, 79872
    v_lshl_add_u32 v228, v152, 3, s3
    s_lshl_b32 s3, s77, 7
    s_add_u32 s3, s3, 94016
    v_lshl_add_u32 v73, v226, 4, s3
    s_mov_b32 s3, 94528
    v_lshl_add_u32 v74, v221, 4, s3
    v_xor_b32 v226, 3, v226
    s_lshl_b32 s3, s77, 5
    s_add_u32 s3, s3, 79872
    v_lshl_add_u32 v77, v226, 2, s3
    v_lshl_add_u32 v77, v221, 8, v77
    s_lshl_b32 s3, s78, 9
    s_add_u32 s3, s3, 11534336
    v_lshl_add_u32 v168, v152, 3, s3
    s_lshl_b32 s4, s79, 4
    s_add_u32 s3, s3, s4
    s_add_u32 s4, s4, 11534336
    v_and_b32 v169, 7, v152
    v_lshl_add_u32 v169, v169, 9, s4
    s_lshl_b32 s4, s77, 2
    s_add_u32 s3, s3, s4
    v_mov_b32 v223, s3
    s_waitcnt vmcnt(10)
    v_lshlrev_b32 v178, 16, v144
    v_lshlrev_b32 v176, 16, v142
    v_mul_f32 v178, 0x3fb8aa3b, v178
    s_mov_b32 m0, s100
    s_mov_b32 s83, s72
    buffer_load_dwordx4 v164, s[52:55], s83 offen lds
    v_lshlrev_b32 v177, 16, v143
    v_exp_f32 v178, v178
    v_mul_f32 v185, v176, v176
    v_fmac_f32 v185, v177, v177
    v_cvt_pk_bf16_f32 v178, 0, v178
    v_rcp_f32 v185, v185
    v_mul_f32 v179, v178, v176
    v_mul_f32 v180, v178, v177
    v_mul_f32 v179, 0x3fb8aa3b, v179
    v_mul_f32 v180, 0x3e22f983, v180
    v_and_b32 v188, 1, v152
    v_cmp_eq_u32 vcc, 1, v188
    v_mov_b32 v189, 0x44000000
    v_mov_b32 v181, 0x41000000
    v_mov_b32 v198, 0x42800000
    v_mov_b32 v199, 0x41800000
    v_cndmask_b32 v189, v189, v181, vcc
    v_cndmask_b32 v198, v198, v199, vcc
    v_mul_f32 v184, 1.0, v179
    v_mul_f32 v183, 1.0, v180
    v_exp_f32 v184, v184
    buffer_load_dwordx4 v165, s[52:55], s83 offen offset:1024 lds
    v_fract_f32 v183, v183
    v_cos_f32 v182, v183
    v_sin_f32 v183, v183
    v_mul_f32 v182, v184, v182
    v_mul_f32 v183, v184, v183
    v_mul_f32 v192, v189, v179
    v_mul_f32 v191, v189, v180
    v_exp_f32 v192, v192
    v_fract_f32 v191, v191
    v_cos_f32 v190, v191
    v_sin_f32 v191, v191
    v_mul_f32 v190, v192, v190
    v_mul_f32 v191, v192, v191
    v_add_f32 v185, v185, v185
    v_add_f32 v184, -1.0, v182
    v_mul_f32 v186, v184, v176
    v_mul_f32 v187, v183, v176
    v_fmac_f32 v186, v183, v177
    v_fma_f32 v187, -v184, v177, v187
    v_mul_f32 v186, v186, v185
    v_mul_f32 v187, v187, v185
    s_add_u32 m0, s100, 8192
    s_add_u32 s83, s72, 640
    buffer_load_dwordx4 v164, s[52:55], s83 offen lds
    v_cndmask_b32 v186, 1.0, v186, vcc
    v_cndmask_b32 v187, 0, v187, vcc
    v_cndmask_b32 v182, v182, v190, vcc
    v_cndmask_b32 v183, v183, v191, vcc
    v_mul_u32_u24 v188, 640, v188
    v_lshlrev_b32 v181, 3, v145
    v_add_u32 v181, 81920, v181
    v_add_u32 v189, v181, v188
    s_mov_b64 exec, s[96:97]
    ds_write_b64 v189, v[182:183] offset:7680
    s_mov_b64 exec, -1
    v_sub_u32 v189, v181, v188
    v_lshlrev_b32 v188, 3, v188
    v_sub_u32 v188, v181, v188
    s_mov_b64 exec, s[96:97]
    ds_write_b64 v188, v[186:187] offset:5120
    s_mov_b64 exec, -1
    v_mul_f32 v196, v198, v179
    v_mul_f32 v195, v198, v180
    v_exp_f32 v196, v196
    v_fract_f32 v195, v195
    v_cos_f32 v194, v195
    v_sin_f32 v195, v195
    buffer_load_dwordx4 v165, s[52:55], s83 offen offset:1024 lds
    v_mul_f32 v194, v196, v194
    v_mul_f32 v195, v196, v195
    s_mov_b64 exec, s[96:97]
    ds_write_b64 v189, v[194:195] offset:9600
    s_mov_b64 exec, -1
    v_pk_mul_f32 v[200:201], v[186:187], v[190:191] op_sel_hi:[1,0]
    v_pk_fma_f32 v[200:201], v[186:187], v[190:191], v[200:201] op_sel:[1,1,0] op_sel_hi:[0,1,1] neg_lo:[1,0,0]
    s_mov_b64 exec, s[96:97]
    ds_write_b64 v188, v[200:201] offset:5760
    s_mov_b64 exec, -1
    v_pk_mul_f32 v[186:187], v[200:201], v[190:191] op_sel_hi:[1,0]
    v_pk_fma_f32 v[186:187], v[200:201], v[190:191], v[186:187] op_sel:[1,1,0] op_sel_hi:[0,1,1] neg_lo:[1,0,0]
    s_mov_b64 exec, s[96:97]
    ds_write_b64 v188, v[186:187] offset:6400
    s_mov_b64 exec, -1
    v_pk_mul_f32 v[200:201], v[186:187], v[190:191] op_sel_hi:[1,0]
    v_pk_fma_f32 v[200:201], v[186:187], v[190:191], v[200:201] op_sel:[1,1,0] op_sel_hi:[0,1,1] neg_lo:[1,0,0]
    s_mov_b64 exec, s[96:97]
    ds_write_b64 v188, v[200:201] offset:7040
    s_mov_b64 exec, -1
    v_pk_mul_f32 v[186:187], v[200:201], v[190:191] op_sel_hi:[1,0]
    v_pk_fma_f32 v[186:187], v[200:201], v[190:191], v[186:187] op_sel:[1,1,0] op_sel_hi:[0,1,1] neg_lo:[1,0,0]
    s_and_b64 s[96:97], s[96:97], vcc
    s_mov_b64 exec, s[96:97]
    ds_write_b64 v188, v[186:187] offset:7680
    s_mov_b64 exec, -1
    v_pk_mul_f32 v[200:201], v[186:187], v[190:191] op_sel_hi:[1,0]
    v_pk_fma_f32 v[200:201], v[186:187], v[190:191], v[200:201] op_sel:[1,1,0] op_sel_hi:[0,1,1] neg_lo:[1,0,0]
    s_mov_b64 exec, s[96:97]
    ds_write_b64 v188, v[200:201] offset:8320
    s_mov_b64 exec, -1
    s_mov_b32 m0, s84
    s_add_u32 s83, s72, s85
    buffer_load_dwordx4 v158, s[56:59], s83 offen lds
    v_pk_mul_f32 v[186:187], v[200:201], v[190:191] op_sel_hi:[1,0]
    v_pk_fma_f32 v[186:187], v[200:201], v[190:191], v[186:187] op_sel:[1,1,0] op_sel_hi:[0,1,1] neg_lo:[1,0,0]
    s_mov_b64 exec, s[96:97]
    ds_write_b64 v188, v[186:187] offset:8960
    s_mov_b64 exec, -1
    v_pk_mul_f32 v[200:201], v[186:187], v[190:191] op_sel_hi:[1,0]
    v_pk_fma_f32 v[200:201], v[186:187], v[190:191], v[200:201] op_sel:[1,1,0] op_sel_hi:[0,1,1] neg_lo:[1,0,0]
    s_mov_b64 exec, s[96:97]
    ds_write_b64 v188, v[200:201] offset:9600
    s_mov_b64 exec, -1
    v_lshlrev_b32 v188, 2, v145
    v_add_u32 v188, 93696, v188
    v_lshlrev_b32 v189, 16, v146
    s_mov_b64 exec, s[96:97]
    ds_write_b32 v188, v189
    s_mov_b64 exec, -1
    v_and_b32 v230, 15, v152
    v_lshrrev_b32 v231, 1, v230
    s_lshr_b32 s3, s78, 2
    s_lshl_b32 s3, s3, 13
    s_add_u32 s3, s3, s100
    v_lshl_add_u32 v230, v230, 7, s3
    s_and_b32 s3, s78, 3
    s_mul_i32 s3, s3, 10
    s_lshr_b32 s4, s72, 4
    s_sub_u32 s3, s3, s4
    v_lshrrev_b32 v226, 4, v152
    v_add_u32 v128, s3, v226
    buffer_load_dwordx4 v159, s[56:59], s83 offen offset:1024 lds
    v_add_u32 v129, 4, v128
    s_add_u32 s3, s3, 8
    v_lshrrev_b32 v226, 5, v152
    v_add_u32 v130, s3, v226
    v_add_u32 v226, 40, v128
    v_min_u32 v128, v128, v226
    v_lshrrev_b32 v226, 3, v128
    v_lshl_add_u32 v226, v226, 14, v230
    v_and_b32 v128, 7, v128
    v_xor_b32 v128, v128, v231
    v_lshl_add_u32 v128, v128, 4, v226
    v_add_u32 v226, 40, v129
    v_min_u32 v129, v129, v226
    s_waitcnt vmcnt(9)
    s_waitcnt lgkmcnt(0)
    s_barrier
    ds_read2_b32 v[80:81], v75 offset0:136 offset1:144
    ds_read2_b32 v[82:83], v75 offset0:152 offset1:160
    ds_read_b32 v84, v75 offset:672
    ds_read2_b32 v[86:87], v75 offset0:0 offset1:8
    ds_read_b128 v[88:91], v74
    ds_read_b128 v[60:63], v73
    ds_read2_b32 v[40:41], v65 offset0:0 offset1:32
    s_add_u32 m0, s84, 2048
    s_add_u32 s83, s72, s85
    buffer_load_dwordx4 v158, s[60:63], s83 offen lds
    ds_read_b32 v42, v65 offset:256
    ds_read2_b32 v[44:45], v64 offset0:0 offset1:32
    ds_read2_b32 v[46:47], v64 offset0:64 offset1:96
    ds_read2_b32 v[48:49], v64 offset0:128 offset1:160
    ds_read2_b32 v[50:51], v64 offset0:192 offset1:224
    ds_read2_b32 v[52:53], v66 offset0:0 offset1:32
    ds_read2_b32 v[54:55], v66 offset0:64 offset1:96
    ds_read2_b32 v[56:57], v66 offset0:128 offset1:160
    ds_read2_b32 v[58:59], v66 offset0:192 offset1:224
    v_mov_b64 v[208:209], -1
    v_add_u32 v212, 3145728, v229
    v_mov_b64 v[210:211], -1
    v_add_u32 v213, 3145728, v76
    s_waitcnt lgkmcnt(11)
    v_lshlrev_b32 v22, 16, v88
    v_and_b32 v24, s86, v88
    v_lshlrev_b32 v26, 16, v89
    v_and_b32 v28, s86, v89
    v_lshlrev_b32 v23, 16, v90
    v_and_b32 v25, s86, v90
    v_lshlrev_b32 v27, 16, v91
    v_and_b32 v29, s86, v91
    v_lshlrev_b32 v0, 16, v80
    v_and_b32 v1, s86, v80
    buffer_load_dwordx4 v159, s[60:63], s83 offen offset:1024 lds
    v_lshlrev_b32 v2, 16, v81
    v_and_b32 v3, s86, v81
    v_lshlrev_b32 v4, 16, v82
    v_and_b32 v5, s86, v82
    v_lshlrev_b32 v6, 16, v83
    v_and_b32 v7, s86, v83
    v_lshlrev_b32 v8, 16, v84
    v_and_b32 v9, s86, v84
    v_pk_mul_f32 v[30:31], v[0:1], v[28:29]
    v_pk_mul_f32 v[32:33], v[2:3], v[28:29]
    v_pk_mul_f32 v[34:35], v[2:3], v[26:27]
    v_pk_mul_f32 v[36:37], v[4:5], v[26:27]
    v_cvt_pk_bf16_f32 v34, v30, v34
    v_cvt_pk_bf16_f32 v35, v31, v35
    v_cvt_pk_bf16_f32 v36, v32, v36
    v_cvt_pk_bf16_f32 v37, v33, v37
    v_dot2_f32_bf16 v30, v34, s87, 0
    v_dot2_f32_bf16 v31, v35, s87, 0
    v_dot2_f32_bf16 v32, v36, s87, 0
    v_dot2_f32_bf16 v33, v37, s87, 0
    v_pk_mul_f32 v[34:35], v[4:5], v[24:25]
    v_pk_mul_f32 v[36:37], v[6:7], v[24:25]
    v_cvt_pk_bf16_f32 v34, v30, v34
    v_cvt_pk_bf16_f32 v35, v31, v35
    s_add_u32 m0, s84, 4096
    s_add_u32 s83, s72, s85
    buffer_load_dwordx4 v158, s[92:95], s83 offen lds
    v_cvt_pk_bf16_f32 v36, v32, v36
    v_cvt_pk_bf16_f32 v37, v33, v37
    v_dot2_f32_bf16 v30, v34, s87, 0
    v_dot2_f32_bf16 v31, v35, s87, 0
    v_dot2_f32_bf16 v32, v36, s87, 0
    v_dot2_f32_bf16 v33, v37, s87, 0
    v_pk_mul_f32 v[34:35], v[6:7], v[22:23]
    v_pk_mul_f32 v[36:37], v[8:9], v[22:23]
    v_cvt_pk_bf16_f32 v34, v30, v34
    v_cvt_pk_bf16_f32 v35, v31, v35
    v_cvt_pk_bf16_f32 v36, v32, v36
    v_cvt_pk_bf16_f32 v37, v33, v37
    v_dot2_f32_bf16 v30, v34, s87, 0
    v_dot2_f32_bf16 v31, v35, s87, 0
    v_dot2_f32_bf16 v32, v36, s87, 0
    v_dot2_f32_bf16 v33, v37, s87, 0
    v_and_b32 v34, 0xffff, v86
    v_and_b32 v35, s86, v86
    v_and_b32 v36, 0xffff, v87
    v_and_b32 v37, s86, v87
    v_cvt_pk_bf16_f32 v38, v30, v31
    v_cvt_pk_bf16_f32 v39, v32, v33
    v_dot2_f32_bf16 v34, v38, v34, 0
    v_dot2_f32_bf16 v36, v39, v36, 0
    buffer_load_dwordx4 v159, s[92:95], s83 offen offset:1024 lds
    v_dot2_f32_bf16 v35, v38, v35, 0
    v_dot2_f32_bf16 v37, v39, v37, 0
    v_cvt_pk_bf16_f32 v68, v36, v34
    s_nop 1
    v_cvt_pk_bf16_f32 v69, v37, v35
    s_waitcnt lgkmcnt(0)
    ds_write2_b32 v77, v68, v69 offset1:32
    v_lshlrev_b32 v22, 16, v60
    v_and_b32 v24, s86, v60
    v_lshlrev_b32 v26, 16, v61
    v_and_b32 v28, s86, v61
    v_lshlrev_b32 v23, 16, v62
    v_and_b32 v25, s86, v62
    v_lshlrev_b32 v27, 16, v63
    v_and_b32 v29, s86, v63
    v_lshlrev_b32 v0, 16, v40
    v_and_b32 v1, s86, v40
    v_lshlrev_b32 v2, 16, v41
    v_and_b32 v3, s86, v41
    v_lshlrev_b32 v4, 16, v42
    v_and_b32 v5, s86, v42
    v_lshlrev_b32 v6, 16, v44
    v_and_b32 v7, s86, v44
    v_lshlrev_b32 v8, 16, v45
    v_and_b32 v9, s86, v45
    s_add_u32 m0, s84, 6144
    s_add_u32 s83, s72, s90
    buffer_load_dwordx4 v158, s[56:59], s83 offen lds
    v_lshlrev_b32 v10, 16, v46
    v_and_b32 v11, s86, v46
    v_lshlrev_b32 v12, 16, v47
    v_and_b32 v13, s86, v47
    v_lshlrev_b32 v14, 16, v48
    v_and_b32 v15, s86, v48
    v_lshlrev_b32 v16, 16, v49
    v_and_b32 v17, s86, v49
    v_lshlrev_b32 v18, 16, v50
    v_and_b32 v19, s86, v50
    v_lshlrev_b32 v20, 16, v51
    v_and_b32 v21, s86, v51
    v_pk_mul_f32 v[30:31], v[0:1], v[28:29]
    v_pk_mul_f32 v[32:33], v[2:3], v[28:29]
    v_pk_mul_f32 v[34:35], v[2:3], v[26:27]
    v_pk_mul_f32 v[36:37], v[4:5], v[26:27]
    v_cvt_pk_bf16_f32 v34, v30, v34
    v_cvt_pk_bf16_f32 v35, v31, v35
    v_cvt_pk_bf16_f32 v36, v32, v36
    v_cvt_pk_bf16_f32 v37, v33, v37
    v_dot2_f32_bf16 v30, v34, s87, 0
    v_dot2_f32_bf16 v31, v35, s87, 0
    v_dot2_f32_bf16 v32, v36, s87, 0
    v_dot2_f32_bf16 v33, v37, s87, 0
    buffer_load_dwordx4 v159, s[56:59], s83 offen offset:1024 lds
    v_pk_mul_f32 v[34:35], v[4:5], v[24:25]
    v_pk_mul_f32 v[36:37], v[6:7], v[24:25]
    v_cvt_pk_bf16_f32 v34, v30, v34
    v_cvt_pk_bf16_f32 v35, v31, v35
    v_cvt_pk_bf16_f32 v36, v32, v36
    v_cvt_pk_bf16_f32 v37, v33, v37
    v_dot2_f32_bf16 v30, v34, s87, 0
    v_dot2_f32_bf16 v31, v35, s87, 0
    v_dot2_f32_bf16 v32, v36, s87, 0
    v_dot2_f32_bf16 v33, v37, s87, 0
    v_pk_mul_f32 v[34:35], v[6:7], v[22:23]
    v_pk_mul_f32 v[36:37], v[8:9], v[22:23]
    v_cvt_pk_bf16_f32 v34, v30, v34
    v_cvt_pk_bf16_f32 v35, v31, v35
    v_cvt_pk_bf16_f32 v36, v32, v36
    v_cvt_pk_bf16_f32 v37, v33, v37
    v_dot2_f32_bf16 v30, v34, s87, 0
    v_dot2_f32_bf16 v31, v35, s87, 0
    v_dot2_f32_bf16 v32, v36, s87, 0
    v_dot2_f32_bf16 v33, v37, s87, 0
    v_and_b32 v34, 0xffff, v52
    v_and_b32 v35, s86, v52
    v_and_b32 v36, 0xffff, v53
    v_and_b32 v37, s86, v53
    s_add_u32 m0, s84, 8192
    s_add_u32 s83, s72, s90
    buffer_load_dwordx4 v158, s[60:63], s83 offen lds
    v_cvt_pk_bf16_f32 v38, v30, v31
    v_cvt_pk_bf16_f32 v39, v32, v33
    v_dot2_f32_bf16 v34, v38, v34, 0
    v_dot2_f32_bf16 v36, v39, v36, 0
    v_dot2_f32_bf16 v35, v38, v35, 0
    v_dot2_f32_bf16 v37, v39, v37, 0
    s_nop 0
    v_cvt_pk_bf16_f32 v107, v36, v34
    s_nop 0
    v_cvt_pk_bf16_f32 v111, v37, v35
    v_pk_mul_f32 v[30:31], v[4:5], v[28:29]
    v_pk_mul_f32 v[32:33], v[6:7], v[28:29]
    v_pk_mul_f32 v[34:35], v[6:7], v[26:27]
    v_pk_mul_f32 v[36:37], v[8:9], v[26:27]
    v_cvt_pk_bf16_f32 v34, v30, v34
    v_cvt_pk_bf16_f32 v35, v31, v35
    v_cvt_pk_bf16_f32 v36, v32, v36
    v_cvt_pk_bf16_f32 v37, v33, v37
    v_dot2_f32_bf16 v30, v34, s87, 0
    v_dot2_f32_bf16 v31, v35, s87, 0
    v_dot2_f32_bf16 v32, v36, s87, 0
    v_dot2_f32_bf16 v33, v37, s87, 0
    v_pk_mul_f32 v[34:35], v[8:9], v[24:25]
    v_pk_mul_f32 v[36:37], v[10:11], v[24:25]
    v_cvt_pk_bf16_f32 v34, v30, v34
    v_cvt_pk_bf16_f32 v35, v31, v35
    buffer_load_dwordx4 v159, s[60:63], s83 offen offset:1024 lds
    v_cvt_pk_bf16_f32 v36, v32, v36
    v_cvt_pk_bf16_f32 v37, v33, v37
    v_dot2_f32_bf16 v30, v34, s87, 0
    v_dot2_f32_bf16 v31, v35, s87, 0
    v_dot2_f32_bf16 v32, v36, s87, 0
    v_dot2_f32_bf16 v33, v37, s87, 0
    v_pk_mul_f32 v[34:35], v[10:11], v[22:23]
    v_pk_mul_f32 v[36:37], v[12:13], v[22:23]
    v_cvt_pk_bf16_f32 v34, v30, v34
    v_cvt_pk_bf16_f32 v35, v31, v35
    v_cvt_pk_bf16_f32 v36, v32, v36
    v_cvt_pk_bf16_f32 v37, v33, v37
    v_dot2_f32_bf16 v30, v34, s87, 0
    v_dot2_f32_bf16 v31, v35, s87, 0
    v_dot2_f32_bf16 v32, v36, s87, 0
    v_dot2_f32_bf16 v33, v37, s87, 0
    v_and_b32 v34, 0xffff, v54
    v_and_b32 v35, s86, v54
    v_and_b32 v36, 0xffff, v55
    v_and_b32 v37, s86, v55
    v_cvt_pk_bf16_f32 v38, v30, v31
    v_cvt_pk_bf16_f32 v39, v32, v33
    v_dot2_f32_bf16 v34, v38, v34, 0
    v_dot2_f32_bf16 v36, v39, v36, 0
    s_add_u32 m0, s100, 16384
    s_mov_b32 s83, s73
    buffer_load_dwordx4 v164, s[52:55], s83 offen lds
    v_dot2_f32_bf16 v35, v38, v35, 0
    v_dot2_f32_bf16 v37, v39, v37, 0
    v_cvt_pk_bf16_f32 v106, v36, v34
    s_nop 1
    v_cvt_pk_bf16_f32 v110, v37, v35
    v_pk_mul_f32 v[30:31], v[8:9], v[28:29]
    v_pk_mul_f32 v[32:33], v[10:11], v[28:29]
    v_pk_mul_f32 v[34:35], v[10:11], v[26:27]
    v_pk_mul_f32 v[36:37], v[12:13], v[26:27]
    v_cvt_pk_bf16_f32 v34, v30, v34
    v_cvt_pk_bf16_f32 v35, v31, v35
    v_cvt_pk_bf16_f32 v36, v32, v36
    v_cvt_pk_bf16_f32 v37, v33, v37
    v_dot2_f32_bf16 v30, v34, s87, 0
    v_dot2_f32_bf16 v31, v35, s87, 0
    v_dot2_f32_bf16 v32, v36, s87, 0
    v_dot2_f32_bf16 v33, v37, s87, 0
    v_pk_mul_f32 v[34:35], v[12:13], v[24:25]
    v_pk_mul_f32 v[36:37], v[14:15], v[24:25]
    v_cvt_pk_bf16_f32 v34, v30, v34
    v_cvt_pk_bf16_f32 v35, v31, v35
    v_cvt_pk_bf16_f32 v36, v32, v36
    v_cvt_pk_bf16_f32 v37, v33, v37
    v_dot2_f32_bf16 v30, v34, s87, 0
    v_dot2_f32_bf16 v31, v35, s87, 0
    buffer_load_dwordx4 v165, s[52:55], s83 offen offset:1024 lds
    v_dot2_f32_bf16 v32, v36, s87, 0
    v_dot2_f32_bf16 v33, v37, s87, 0
    v_pk_mul_f32 v[34:35], v[14:15], v[22:23]
    v_pk_mul_f32 v[36:37], v[16:17], v[22:23]
    v_cvt_pk_bf16_f32 v34, v30, v34
    v_cvt_pk_bf16_f32 v35, v31, v35
    v_cvt_pk_bf16_f32 v36, v32, v36
    v_cvt_pk_bf16_f32 v37, v33, v37
    v_dot2_f32_bf16 v30, v34, s87, 0
    v_dot2_f32_bf16 v31, v35, s87, 0
    v_dot2_f32_bf16 v32, v36, s87, 0
    v_dot2_f32_bf16 v33, v37, s87, 0
    v_and_b32 v34, 0xffff, v56
    v_and_b32 v35, s86, v56
    v_and_b32 v36, 0xffff, v57
    v_and_b32 v37, s86, v57
    v_cvt_pk_bf16_f32 v38, v30, v31
    v_cvt_pk_bf16_f32 v39, v32, v33
    v_dot2_f32_bf16 v34, v38, v34, 0
    v_dot2_f32_bf16 v36, v39, v36, 0
    v_dot2_f32_bf16 v35, v38, v35, 0
    v_dot2_f32_bf16 v37, v39, v37, 0
    s_nop 0
    v_cvt_pk_bf16_f32 v105, v36, v34
    s_nop 0
    v_cvt_pk_bf16_f32 v109, v37, v35
    s_add_u32 m0, s100, 24576
    s_add_u32 s83, s73, 640
    buffer_load_dwordx4 v164, s[52:55], s83 offen lds
    v_pk_mul_f32 v[30:31], v[12:13], v[28:29]
    v_pk_mul_f32 v[32:33], v[14:15], v[28:29]
    v_pk_mul_f32 v[34:35], v[14:15], v[26:27]
    v_pk_mul_f32 v[36:37], v[16:17], v[26:27]
    v_cvt_pk_bf16_f32 v34, v30, v34
    v_cvt_pk_bf16_f32 v35, v31, v35
    v_cvt_pk_bf16_f32 v36, v32, v36
    v_cvt_pk_bf16_f32 v37, v33, v37
    v_dot2_f32_bf16 v30, v34, s87, 0
    v_dot2_f32_bf16 v31, v35, s87, 0
    v_dot2_f32_bf16 v32, v36, s87, 0
    v_dot2_f32_bf16 v33, v37, s87, 0
    v_pk_mul_f32 v[34:35], v[16:17], v[24:25]
    v_pk_mul_f32 v[36:37], v[18:19], v[24:25]
    v_cvt_pk_bf16_f32 v34, v30, v34
    v_cvt_pk_bf16_f32 v35, v31, v35
    v_cvt_pk_bf16_f32 v36, v32, v36
    v_cvt_pk_bf16_f32 v37, v33, v37
    v_dot2_f32_bf16 v30, v34, s87, 0
    v_dot2_f32_bf16 v31, v35, s87, 0
    v_dot2_f32_bf16 v32, v36, s87, 0
    v_dot2_f32_bf16 v33, v37, s87, 0
    v_pk_mul_f32 v[34:35], v[18:19], v[22:23]
    v_pk_mul_f32 v[36:37], v[20:21], v[22:23]
    buffer_load_dwordx4 v165, s[52:55], s83 offen offset:1024 lds
    v_cvt_pk_bf16_f32 v34, v30, v34
    v_cvt_pk_bf16_f32 v35, v31, v35
    v_cvt_pk_bf16_f32 v36, v32, v36
    v_cvt_pk_bf16_f32 v37, v33, v37
    v_dot2_f32_bf16 v30, v34, s87, 0
    v_dot2_f32_bf16 v31, v35, s87, 0
    v_dot2_f32_bf16 v32, v36, s87, 0
    v_dot2_f32_bf16 v33, v37, s87, 0
    s_waitcnt vmcnt(12)
    ds_read_b128 a[0:3], v156 offset:0
    ds_read_b128 a[4:7], v157 offset:0
    v_and_b32 v34, 0xffff, v58
    v_and_b32 v35, s86, v58
    v_and_b32 v36, 0xffff, v59
    v_and_b32 v37, s86, v59
    s_waitcnt vmcnt(10)
    ds_read_b128 a[8:11], v156 offset:2048
    ds_read_b128 a[12:15], v157 offset:2048
    v_cvt_pk_bf16_f32 v38, v30, v31
    v_cvt_pk_bf16_f32 v39, v32, v33
    v_dot2_f32_bf16 v34, v38, v34, 0
    v_dot2_f32_bf16 v36, v39, v36, 0
    s_waitcnt vmcnt(8)
    ds_read_b128 a[16:19], v156 offset:4096
    ds_read_b128 a[20:23], v157 offset:4096
    v_dot2_f32_bf16 v35, v38, v35, 0
    v_dot2_f32_bf16 v37, v39, v37, 0
    v_cvt_pk_bf16_f32 v104, v36, v34
    s_nop 1
    v_cvt_pk_bf16_f32 v108, v37, v35
    global_store_dwordx4 v76, v[104:107], s[50:51] offset:-2048 sc1
    global_store_dwordx4 v76, v[108:111], s[50:51] offset:2048 sc1
    s_add_u32 m0, s84, 10240
    s_add_u32 s83, s73, s85
    buffer_load_dwordx4 v158, s[56:59], s83 offen lds
    s_waitcnt lgkmcnt(0)
    s_barrier
    ds_read_b128 v[60:63], v120 offset:0
    ds_read_b128 v[64:67], v120 offset:2048
    ds_read_b128 v[68:71], v120 offset:4096
    ds_read_b128 v[72:75], v120 offset:6144
    ds_read_b128 v[76:79], v121 offset:0
    ds_read_b128 v[80:83], v121 offset:2048
    ds_read_b128 v[84:87], v121 offset:4096
    ds_read_b128 v[88:91], v121 offset:6144
    s_waitcnt lgkmcnt(6)
    v_mfma_f32_16x16x32_bf16 v[176:179], v[60:63], a[0:3], 0
    v_lshrrev_b32 v226, 3, v129
    v_mfma_f32_16x16x32_bf16 v[192:195], v[60:63], a[8:11], 0
    v_lshl_add_u32 v226, v226, 14, v230
    v_mfma_f32_16x16x32_bf16 v[32:35], v[60:63], a[16:19], 0
    ds_read_b128 v[60:63], v122 offset:0
    v_and_b32 v129, 7, v129
    v_mfma_f32_16x16x32_bf16 v[48:51], v[116:119], a[0:3], 0
    ds_read_b64 v[170:171], v228
    v_xor_b32 v129, v129, v231
    v_mfma_f32_16x16x32_bf16 v[180:183], v[64:67], a[0:3], 0
    buffer_load_dwordx4 v159, s[56:59], s83 offen offset:1024 lds
    global_load_dword v224, v224, s[48:49] sc1
    v_lshl_add_u32 v129, v129, 4, v226
    v_mfma_f32_16x16x32_bf16 v[196:199], v[64:67], a[8:11], 0
    v_add_u32 v226, 40, v130
    v_min_u32 v130, v130, v226
    v_mfma_f32_16x16x32_bf16 v[36:39], v[64:67], a[16:19], 0
    ds_read_b128 v[64:67], v122 offset:2048
    v_lshrrev_b32 v226, 3, v130
    v_mfma_f32_16x16x32_bf16 v[52:55], v[116:119], a[8:11], 0
    s_add_u32 m0, s84, 12288
    s_add_u32 s83, s73, s85
    buffer_load_dwordx4 v158, s[60:63], s83 offen lds
    s_waitcnt lgkmcnt(7)
    v_mfma_f32_16x16x32_bf16 v[184:187], v[68:71], a[0:3], 0
    v_lshl_add_u32 v226, v226, 14, v230
    v_and_b32 v130, 7, v130
    v_mfma_f32_16x16x32_bf16 v[200:203], v[68:71], a[8:11], 0
    s_waitcnt lgkmcnt(1)
    global_store_dwordx2 v229, v[170:171], s[50:51] sc1
    v_mfma_f32_16x16x32_bf16 v[40:43], v[68:71], a[16:19], 0
    ds_read_b128 v[68:71], v122 offset:4096
    v_xor_b32 v130, v130, v231
    v_mfma_f32_16x16x32_bf16 v[56:59], v[116:119], a[16:19], 0
    buffer_load_dwordx4 v159, s[60:63], s83 offen offset:1024 lds
    v_lshl_add_u32 v130, v130, 4, v226
    v_mfma_f32_16x16x32_bf16 v[188:191], v[72:75], a[0:3], 0
    s_cmp_eq_u32 s77, 0
    s_cselect_b32 s30, 0, s30
    s_cselect_b32 s31, 0, s31
    s_cselect_b32 s32, 0, s32
    v_mfma_f32_16x16x32_bf16 v[204:207], v[72:75], a[8:11], 0
    v_bfe_u32 v226, v152, 4, 1
    v_lshl_add_u32 v130, v226, 3, v130
    v_mfma_f32_16x16x32_bf16 v[44:47], v[72:75], a[16:19], 0
    ds_read_b128 v[72:75], v122 offset:6144
    v_mfma_f32_16x16x32_bf16 v[176:179], v[76:79], a[4:7], v[176:179]
    s_add_u32 m0, s84, 14336
    s_add_u32 s83, s73, s85
    buffer_load_dwordx4 v158, s[92:95], s83 offen lds
    v_mfma_f32_16x16x32_bf16 v[192:195], v[76:79], a[12:15], v[192:195]
    ds_read_b128 v[92:95], v124 offset:0
    v_lshrrev_b32 v167, 4, v152
    s_mov_b32 s4, 93696
    v_mfma_f32_16x16x32_bf16 v[32:35], v[76:79], a[20:23], v[32:35]
    ds_read_b128 v[76:79], v123 offset:0
    ds_read_b128 v[96:99], v125 offset:0
    v_lshl_add_u32 v166, v167, 5, s4
    v_mfma_f32_16x16x32_bf16 v[48:51], v[116:119], a[4:7], v[48:51]
    ds_read_b128 v[100:103], v124 offset:8192
    v_lshl_add_u32 v167, v167, 4, s4
    s_lshl_b32 s3, s81, 12
    v_mfma_f32_16x16x32_bf16 v[180:183], v[80:83], a[4:7], v[180:183]
    buffer_load_dwordx4 v159, s[92:95], s83 offen offset:1024 lds
    s_add_u32 s3, s3, s14
    ds_read_b128 v[104:107], v125 offset:8192
    v_mfma_f32_16x16x32_bf16 v[196:199], v[80:83], a[12:15], v[196:199]
    s_add_u32 s3, s3, 3145728
    s_lshl_b32 s4, s80, 10
    v_mfma_f32_16x16x32_bf16 v[36:39], v[80:83], a[20:23], v[36:39]
    ds_read_b128 v[80:83], v123 offset:2048
    s_add_u32 s38, s3, s4
    v_mfma_f32_16x16x32_bf16 v[52:55], v[116:119], a[12:15], v[52:55]
    s_sub_u32 s39, s3, s4
    v_mfma_f32_16x16x32_bf16 v[184:187], v[84:87], a[4:7], v[184:187]
    s_add_u32 m0, s100, 32768
    s_mov_b32 s83, s74
    buffer_load_dwordx4 v164, s[52:55], s83 offen lds
    v_mfma_f32_16x16x32_bf16 v[200:203], v[84:87], a[12:15], v[200:203]
    s_add_u32 s39, s39, 3072
    s_lshr_b32 s13, s79, 4
    v_mfma_f32_16x16x32_bf16 v[40:43], v[84:87], a[20:23], v[40:43]
    ds_read_b128 v[84:87], v123 offset:4096
    s_sub_u32 s4, 3, s13
    v_mfma_f32_16x16x32_bf16 v[56:59], v[116:119], a[20:23], v[56:59]
    buffer_load_dwordx4 v165, s[52:55], s83 offen offset:1024 lds
    s_waitcnt lgkmcnt(4)
    v_mfma_f32_16x16x32_bf16 v[108:111], v[92:95], v[92:95], 0
    s_cmp_eq_u32 s81, 0
    s_cselect_b32 s3, s4, s13
    v_mfma_f32_16x16x32_bf16 v[232:235], v[116:119], v[92:95], 0
    s_waitcnt vmcnt(18)
    ds_read_b128 a[24:27], v156 offset:6144
    ds_read_b128 a[28:31], v157 offset:6144
    v_mfma_f32_16x16x32_bf16 v[188:191], v[88:91], a[4:7], v[188:191]
    s_waitcnt vmcnt(16)
    ds_read_b128 a[32:35], v156 offset:8192
    ds_read_b128 a[36:39], v157 offset:8192
    v_mfma_f32_16x16x32_bf16 v[204:207], v[88:91], a[12:15], v[204:207]
    s_add_u32 m0, s100, 40960
    s_add_u32 s83, s74, 640
    buffer_load_dwordx4 v164, s[52:55], s83 offen lds
    v_mfma_f32_16x16x32_bf16 v[44:47], v[88:91], a[20:23], v[44:47]
    ds_read_b128 v[88:91], v123 offset:6144
    s_lshl_b32 s3, s3, 1
    v_mfma_f32_16x16x32_bf16 v[108:111], v[96:99], v[96:99], v[108:111]
    s_add_u32 s3, s3, s80
    s_lshl_b32 s40, s3, 9
    v_mfma_f32_16x16x32_bf16 v[232:235], v[116:119], v[96:99], v[232:235]
    s_waitcnt lgkmcnt(3)
    v_mfma_f32_16x16x32_bf16 v[176:179], v[60:63], a[24:27], v[176:179]
    buffer_load_dwordx4 v165, s[52:55], s83 offen offset:1024 lds
    s_waitcnt lgkmcnt(1)
    v_mfma_f32_16x16x32_bf16 v[192:195], v[60:63], a[32:35], v[192:195]
    s_waitcnt vmcnt(14)
    s_barrier
    ds_read_b128 v[60:63], v120 offset:16384
    v_mfma_f32_16x16x32_bf16 v[48:51], v[116:119], a[24:27], v[48:51]
    v_bfe_u32 v230, v152, 1, 2
    v_and_b32 v227, 1, v152
    v_mfma_f32_16x16x32_bf16 v[108:111], v[100:103], v[100:103], v[108:111]
    v_lshlrev_b32 v230, 18, v230
    v_lshl_add_u32 v227, v227, 7, v230
    v_mfma_f32_16x16x32_bf16 v[232:235], v[116:119], v[100:103], v[232:235]
    s_mov_b32 m0, s84
    s_add_u32 s83, s73, s90
    buffer_load_dwordx4 v158, s[56:59], s83 offen lds
    v_mfma_f32_16x16x32_bf16 v[180:183], v[64:67], a[24:27], v[180:183]
    s_lshl_b32 s3, s79, 13
    s_add_u32 s3, s3, s100
    v_mfma_f32_16x16x32_bf16 v[196:199], v[64:67], a[32:35], v[196:199]
    ds_read_b128 v[64:67], v120 offset:18432
    global_store_dwordx2 v212, v[208:209], s[50:51] sc1
    v_mfma_f32_16x16x32_bf16 v[52:55], v[116:119], a[32:35], v[52:55]
    s_lshl_b32 s4, s78, 8
    s_add_u32 s3, s3, s4
    v_mfma_f32_16x16x32_bf16 v[108:111], v[104:107], v[104:107], v[108:111]
    buffer_load_dwordx4 v159, s[56:59], s83 offen offset:1024 lds
    s_add_u32 s3, s3, 10485760
    v_mfma_f32_16x16x32_bf16 v[232:235], v[116:119], v[104:107], v[232:235]
    v_add_u32 v227, s3, v227
    v_mfma_f32_16x16x32_bf16 v[184:187], v[68:71], a[24:27], v[184:187]
    s_lshl_b32 s91, s79, 3
    s_add_u32 s91, s91, s78
    v_mfma_f32_16x16x32_bf16 v[200:203], v[68:71], a[32:35], v[200:203]
    ds_read_b128 v[68:71], v120 offset:20480
    s_add_u32 m0, s84, 2048
    s_add_u32 s83, s73, s90
    buffer_load_dwordx4 v158, s[60:63], s83 offen lds
    ds_read_b128 v[92:95], v124 offset:16384
    v_mfma_f32_16x16x32_bf16 v[188:191], v[72:75], a[24:27], v[188:191]
    s_lshl_b32 s91, s91, 2
    s_add_u32 s91, s91, s77
    ds_read_b128 v[96:99], v125 offset:16384
    v_mfma_f32_16x16x32_bf16 v[204:207], v[72:75], a[32:35], v[204:207]
    ds_read_b128 v[72:75], v120 offset:22528
    ds_read_b128 v[100:103], v124 offset:24576
    v_mfma_f32_16x16x32_bf16 v[176:179], v[76:79], a[28:31], v[176:179]
    s_mul_i32 s3, s91, 5120
    s_add_u32 s3, s3, 2048
    ds_read_b128 v[104:107], v125 offset:24576
    v_mfma_f32_16x16x32_bf16 v[192:195], v[76:79], a[36:39], v[192:195]
    ds_read_b128 v[76:79], v121 offset:16384
    buffer_load_dwordx4 v159, s[60:63], s83 offen offset:1024 lds
    v_mfma_f32_16x16x32_bf16 v[48:51], v[116:119], a[28:31], v[48:51]
    v_min_u32 v242, 7, v152
    v_lshl_add_u32 v242, v242, 7, s3
    v_mfma_f32_16x16x32_bf16 v[180:183], v[80:83], a[28:31], v[180:183]
    v_and_b32 v225, 15, v152
    s_lshl_b32 s3, s77, 6
    v_mfma_f32_16x16x32_bf16 v[196:199], v[80:83], a[36:39], v[196:199]
    ds_read_b128 v[80:83], v121 offset:18432
    s_add_u32 s3, s3, 93440
    v_mfma_f32_16x16x32_bf16 v[52:55], v[116:119], a[36:39], v[52:55]
    s_add_u32 m0, s100, 49152
    s_mov_b32 s83, s75
    buffer_load_dwordx4 v164, s[52:55], s83 offen lds
    s_waitcnt lgkmcnt(10)
    v_mfma_f32_16x16x32_bf16 v[184:187], v[84:87], a[28:31], v[184:187]
    v_lshl_add_u32 v225, v225, 2, s3
    v_bfe_u32 v222, v152, 1, 2
    v_mfma_f32_16x16x32_bf16 v[200:203], v[84:87], a[36:39], v[200:203]
    ds_read_b128 v[84:87], v121 offset:20480
    global_store_dwordx4 v213, v[208:211], s[50:51] offset:-2048 sc1
    s_waitcnt lgkmcnt(6)
    v_mfma_f32_16x16x32_bf16 v[108:111], v[92:95], v[92:95], v[108:111]
    s_waitcnt vmcnt(17)
    ds_read_b128 a[40:43], v156 offset:10240
    ds_read_b128 a[44:47], v157 offset:10240
    v_mfma_f32_16x16x32_bf16 v[232:235], v[116:119], v[92:95], v[232:235]
    buffer_load_dwordx4 v165, s[52:55], s83 offen offset:1024 lds
    s_waitcnt vmcnt(14)
    ds_read_b128 a[48:51], v156 offset:12288
    ds_read_b128 a[52:55], v157 offset:12288
    v_mfma_f32_16x16x32_bf16 v[188:191], v[88:91], a[28:31], v[188:191]
    s_waitcnt vmcnt(12)
    ds_read_b128 a[56:59], v156 offset:14336
    ds_read_b128 a[60:63], v157 offset:14336
    v_mfma_f32_16x16x32_bf16 v[204:207], v[88:91], a[36:39], v[204:207]
    ds_read_b128 v[88:91], v121 offset:22528
    s_lshl_b32 s3, s77, 4
    v_mfma_f32_16x16x32_bf16 v[108:111], v[96:99], v[96:99], v[108:111]
    s_add_u32 s3, s3, 93440
    v_lshl_add_u32 v222, v222, 2, s3
    v_mfma_f32_16x16x32_bf16 v[232:235], v[116:119], v[96:99], v[232:235]
    s_add_u32 m0, s100, 57344
    s_add_u32 s83, s75, 640
    buffer_load_dwordx4 v164, s[52:55], s83 offen lds
    s_waitcnt lgkmcnt(5)
    v_mfma_f32_16x16x32_bf16 v[176:179], v[60:63], a[40:43], v[176:179]
    v_and_b32 v230, 8, v152
    s_waitcnt lgkmcnt(3)
    v_mfma_f32_16x16x32_bf16 v[192:195], v[60:63], a[48:51], v[192:195]
    v_lshl_add_u32 v222, v230, 3, v222
    s_waitcnt lgkmcnt(1)
    v_mfma_f32_16x16x32_bf16 v[32:35], v[60:63], a[56:59], v[32:35]
    ds_read_b128 v[60:63], v122 offset:16384
    buffer_load_dwordx4 v165, s[52:55], s83 offen offset:1024 lds
    v_mfma_f32_16x16x32_bf16 v[48:51], v[116:119], a[40:43], v[48:51]
    s_lshl_b32 s3, s77, 12
    v_and_b32 v220, 16, v152
    v_mfma_f32_16x16x32_bf16 v[108:111], v[100:103], v[100:103], v[108:111]
    v_lshlrev_b32 v220, 2, v220
    v_xor_b32 v220, v220, v153
    v_mfma_f32_16x16x32_bf16 v[232:235], v[116:119], v[100:103], v[232:235]
    v_add_u32 v220, s3, v220
    v_bfe_u32 v230, v152, 2, 2
    v_mfma_f32_16x16x32_bf16 v[180:183], v[64:67], a[40:43], v[180:183]
    s_add_u32 m0, s84, 4096
    s_add_u32 s83, s74, s85
    buffer_load_dwordx4 v158, s[56:59], s83 offen lds
    v_mfma_f32_16x16x32_bf16 v[196:199], v[64:67], a[48:51], v[196:199]
    s_lshl_b32 s3, s77, 4
    s_add_u32 s3, s3, 92160
    v_mfma_f32_16x16x32_bf16 v[36:39], v[64:67], a[56:59], v[36:39]
    ds_read_b128 v[64:67], v122 offset:18432
    global_store_dwordx4 v213, v[208:211], s[50:51] offset:2048 sc1
    v_mfma_f32_16x16x32_bf16 v[52:55], v[116:119], a[48:51], v[52:55]
    v_lshl_add_u32 v126, v230, 6, s3
    s_lshl_b32 s3, s77, 3
    v_mfma_f32_16x16x32_bf16 v[108:111], v[104:107], v[104:107], v[108:111]
    buffer_load_dwordx4 v159, s[56:59], s83 offen offset:1024 lds
    s_add_u32 s3, s3, 92672
    v_mfma_f32_16x16x32_bf16 v[232:235], v[116:119], v[104:107], v[232:235]
    v_lshl_add_u32 v127, v230, 6, s3
    v_mfma_f32_16x16x32_bf16 v[184:187], v[68:71], a[40:43], v[184:187]
    v_bfe_u32 v230, v152, 0, 2
    v_lshl_add_u32 v126, v230, 2, v126
    v_mfma_f32_16x16x32_bf16 v[200:203], v[68:71], a[48:51], v[200:203]
    v_bfe_u32 v230, v152, 0, 1
    v_lshl_add_u32 v127, v230, 5, v127
    v_mfma_f32_16x16x32_bf16 v[40:43], v[68:71], a[56:59], v[40:43]
    ds_read_b128 v[68:71], v122 offset:20480
    s_add_u32 m0, s84, 6144
    s_add_u32 s83, s74, s85
    buffer_load_dwordx4 v158, s[60:63], s83 offen lds
    v_mfma_f32_16x16x32_bf16 v[56:59], v[116:119], a[56:59], v[56:59]
    v_bfe_u32 v230, v152, 1, 1
    v_lshl_add_u32 v127, v230, 2, v127
    v_mfma_f32_16x16x32_bf16 v[188:191], v[72:75], a[40:43], v[188:191]
    v_and_b32 v230, 15, v152
    s_lshl_b32 s3, s77, 7
    v_mfma_f32_16x16x32_bf16 v[204:207], v[72:75], a[48:51], v[204:207]
    s_add_u32 s3, s3, 81920
    v_lshl_add_u32 v154, v230, 3, s3
    v_mfma_f32_16x16x32_bf16 v[44:47], v[72:75], a[56:59], v[44:47]
    ds_read_b128 v[72:75], v122 offset:22528
    buffer_load_dwordx4 v159, s[60:63], s83 offen offset:1024 lds
    v_mfma_f32_16x16x32_bf16 v[176:179], v[76:79], a[44:47], v[176:179]
    s_waitcnt vmcnt(15)
    v_bfe_u32 v155, v152, 1, 2
    s_lshl_b32 s3, s77, 5
    v_mfma_f32_16x16x32_bf16 v[192:195], v[76:79], a[52:55], v[192:195]
    s_add_u32 s3, s3, 82432
    ds_read_b128 v[92:95], v124 offset:32768
    v_lshl_add_u32 v155, v155, 3, s3
    v_mfma_f32_16x16x32_bf16 v[32:35], v[76:79], a[60:63], v[32:35]
    ds_read_b128 v[76:79], v123 offset:16384
    s_add_u32 m0, s84, 8192
    s_add_u32 s83, s74, s85
    buffer_load_dwordx4 v158, s[92:95], s83 offen lds
    ds_read_b128 v[96:99], v125 offset:32768
    v_mfma_f32_16x16x32_bf16 v[48:51], v[116:119], a[44:47], v[48:51]
    ds_read_b128 v[100:103], v124 offset:40960
    v_not_b32 v230, v152
    v_lshlrev_b32 v230, 28, v230
    v_mfma_f32_16x16x32_bf16 v[180:183], v[80:83], a[44:47], v[180:183]
    ds_read_b128 v[104:107], v125 offset:40960
    v_and_b32 v163, 0x80000000, v230
    v_lshrrev_b32 v230, 4, v152
    v_mfma_f32_16x16x32_bf16 v[196:199], v[80:83], a[52:55], v[196:199]
    s_mov_b32 s3, 92160
    v_lshl_add_u32 v216, v230, 6, s3
    v_mfma_f32_16x16x32_bf16 v[36:39], v[80:83], a[60:63], v[36:39]
    ds_read_b128 v[80:83], v123 offset:18432
    buffer_load_dwordx4 v159, s[92:95], s83 offen offset:1024 lds
    v_mfma_f32_16x16x32_bf16 v[52:55], v[116:119], a[52:55], v[52:55]
    v_and_b32 v218, 1, v152
    s_waitcnt lgkmcnt(10)
    v_mfma_f32_16x16x32_bf16 v[184:187], v[84:87], a[44:47], v[184:187]
    v_lshl_add_u32 v217, v218, 5, v216
    v_lshlrev_b32 v218, 2, v218
    v_mfma_f32_16x16x32_bf16 v[200:203], v[84:87], a[52:55], v[200:203]
    v_lshl_add_u32 v218, v230, 8, v218
    v_and_b32 v230, 1, v230
    v_mfma_f32_16x16x32_bf16 v[40:43], v[84:87], a[60:63], v[40:43]
    ds_read_b128 v[84:87], v123 offset:20480
    s_add_u32 m0, s100, 65536
    s_mov_b32 s83, s76
    buffer_load_dwordx4 v164, s[52:55], s83 offen lds
    v_mfma_f32_16x16x32_bf16 v[56:59], v[116:119], a[60:63], v[56:59]
    v_xor_b32 v230, s77, v230
    v_lshl_add_u32 v218, v230, 6, v218
    s_waitcnt lgkmcnt(4)
    v_mfma_f32_16x16x32_bf16 v[108:111], v[92:95], v[92:95], v[108:111]
    v_bfe_u32 v230, v152, 1, 2
    v_lshl_add_u32 v218, v230, 4, v218
    v_mfma_f32_16x16x32_bf16 v[232:235], v[116:119], v[92:95], v[232:235]
    s_waitcnt vmcnt(15)
    ds_read_b128 a[64:67], v156 offset:0
    ds_read_b128 a[68:71], v157 offset:0
    v_mfma_f32_16x16x32_bf16 v[188:191], v[88:91], a[44:47], v[188:191]
    buffer_load_dwordx4 v165, s[52:55], s83 offen offset:1024 lds
    s_waitcnt vmcnt(14)
    ds_read_b128 a[72:75], v156 offset:2048
    ds_read_b128 a[76:79], v157 offset:2048
    v_mfma_f32_16x16x32_bf16 v[204:207], v[88:91], a[52:55], v[204:207]
    v_bfe_u32 v230, v152, 3, 1
    v_lshlrev_b32 v230, 12, v230
    v_mfma_f32_16x16x32_bf16 v[44:47], v[88:91], a[60:63], v[44:47]
    ds_read_b128 v[88:91], v123 offset:22528
    s_mov_b32 s3, 0
    v_mfma_f32_16x16x32_bf16 v[108:111], v[96:99], v[96:99], v[108:111]
    v_add3_u32 v218, v230, v218, s3
    v_xor_b32 v219, 8, v218
    v_mfma_f32_16x16x32_bf16 v[232:235], v[116:119], v[96:99], v[232:235]
    s_add_u32 m0, s100, 73728
    s_add_u32 s83, s76, 640
    buffer_load_dwordx4 v164, s[52:55], s83 offen lds
    s_waitcnt lgkmcnt(3)
    v_mfma_f32_16x16x32_bf16 v[176:179], v[60:63], a[64:67], v[176:179]
    s_mul_i32 s3, s79, 163840
    s_waitcnt lgkmcnt(1)
    v_mfma_f32_16x16x32_bf16 v[192:195], v[60:63], a[72:75], v[192:195]
    s_barrier
    ds_read_b128 v[60:63], v120 offset:32768
    v_mfma_f32_16x16x32_bf16 v[48:51], v[116:119], a[64:67], v[48:51]
    buffer_load_dwordx4 v165, s[52:55], s83 offen offset:1024 lds
    s_mul_i32 s4, s78, 5120
    v_mfma_f32_16x16x32_bf16 v[108:111], v[100:103], v[100:103], v[108:111]
    s_add_u32 s3, s3, s4
    s_lshl_b32 s4, s77, 10
    v_mfma_f32_16x16x32_bf16 v[232:235], v[116:119], v[100:103], v[232:235]
    s_add_u32 s36, s3, s4
    s_add_u32 s18, s36, 40960
    v_mfma_f32_16x16x32_bf16 v[180:183], v[64:67], a[64:67], v[180:183]
    s_add_u32 s19, s36, 81920
    s_add_u32 s20, s36, 122880
    v_mfma_f32_16x16x32_bf16 v[196:199], v[64:67], a[72:75], v[196:199]
    ds_read_b128 v[64:67], v120 offset:34816
    s_add_u32 m0, s84, 10240
    s_add_u32 s83, s74, s90
    buffer_load_dwordx4 v158, s[56:59], s83 offen lds
    v_mfma_f32_16x16x32_bf16 v[52:55], v[116:119], a[72:75], v[52:55]
    s_lshl_b32 s4, s81, 8
    s_add_u32 s3, s3, s4
    v_mfma_f32_16x16x32_bf16 v[108:111], v[104:107], v[104:107], v[108:111]
    s_lshl_b32 s4, s80, 3
    s_add_u32 s3, s3, s4
    v_mfma_f32_16x16x32_bf16 v[232:235], v[116:119], v[104:107], v[232:235]
    s_add_u32 s37, s3, 4096
    v_mfma_f32_16x16x32_bf16 v[184:187], v[68:71], a[64:67], v[184:187]
    buffer_load_dwordx4 v159, s[56:59], s83 offen offset:1024 lds
    s_waitcnt vmcnt(13)
    v_and_b32 v165, 15, v152
    v_mfma_f32_16x16x32_bf16 v[200:203], v[68:71], a[72:75], v[200:203]
    ds_read_b128 v[68:71], v120 offset:36864
    ds_read_b128 v[92:95], v124 offset:49152
    v_lshrrev_b32 v230, 4, v152
    v_mfma_f32_16x16x32_bf16 v[188:191], v[72:75], a[64:67], v[188:191]
    ds_read_b128 v[96:99], v125 offset:49152
    v_add_u32 v164, 1, v165
    v_and_b32 v231, 1, v164
    v_mfma_f32_16x16x32_bf16 v[204:207], v[72:75], a[72:75], v[204:207]
    ds_read_b128 v[72:75], v120 offset:38912
    ds_read_b128 v[100:103], v124 offset:57344
    v_mfma_f32_16x16x32_bf16 v[176:179], v[76:79], a[68:71], v[176:179]
    s_add_u32 m0, s84, 12288
    s_add_u32 s83, s74, s90
    buffer_load_dwordx4 v158, s[60:63], s83 offen lds
    ds_read_b128 v[104:107], v125 offset:57344
    v_mfma_f32_16x16x32_bf16 v[192:195], v[76:79], a[76:79], v[192:195]
    ds_read_b128 v[76:79], v121 offset:32768
    v_sub_u32 v164, v164, v231
    v_mfma_f32_16x16x32_bf16 v[48:51], v[116:119], a[68:71], v[48:51]
    v_mul_u32_u24 v231, 4164, v231
    v_lshl_add_u32 v164, v164, 1, v231
    v_mfma_f32_16x16x32_bf16 v[180:183], v[80:83], a[68:71], v[180:183]
    v_lshlrev_b32 v231, 4, v230
    v_sub_u32 v164, v164, v231
    v_mfma_f32_16x16x32_bf16 v[196:199], v[80:83], a[76:79], v[196:199]
    ds_read_b128 v[80:83], v121 offset:34816
    buffer_load_dwordx4 v159, s[60:63], s83 offen offset:1024 lds
    v_mfma_f32_16x16x32_bf16 v[52:55], v[116:119], a[76:79], v[52:55]
    v_lshl_add_u32 v165, v165, 5, v231
    s_waitcnt lgkmcnt(10)
    v_mfma_f32_16x16x32_bf16 v[184:187], v[84:87], a[68:71], v[184:187]
    s_lshl_b32 s3, s77, 7
    s_add_u32 s4, s3, 30256
    v_mfma_f32_16x16x32_bf16 v[200:203], v[84:87], a[76:79], v[200:203]
    ds_read_b128 v[84:87], v121 offset:36864
    s_add_u32 m0, s84, 14336
    s_add_u32 s83, s75, s85
    buffer_load_dwordx4 v158, s[56:59], s83 offen lds
    s_waitcnt lgkmcnt(6)
    v_mfma_f32_16x16x32_bf16 v[108:111], v[92:95], v[92:95], v[108:111]
    s_waitcnt vmcnt(13)
    ds_read_b128 a[80:83], v156 offset:4096
    ds_read_b128 a[84:87], v157 offset:4096
    v_mfma_f32_16x16x32_bf16 v[232:235], v[116:119], v[92:95], v[232:235]
    s_waitcnt vmcnt(11)
    ds_read_b128 a[88:91], v156 offset:6144
    ds_read_b128 a[92:95], v157 offset:6144
    v_mfma_f32_16x16x32_bf16 v[188:191], v[88:91], a[68:71], v[188:191]
    s_waitcnt vmcnt(9)
    ds_read_b128 a[96:99], v156 offset:8192
    ds_read_b128 a[100:103], v157 offset:8192
    v_mfma_f32_16x16x32_bf16 v[204:207], v[88:91], a[76:79], v[204:207]
    ds_read_b128 v[88:91], v121 offset:38912
    buffer_load_dwordx4 v159, s[56:59], s83 offen offset:1024 lds
    v_mfma_f32_16x16x32_bf16 v[108:111], v[96:99], v[96:99], v[108:111]
    s_sub_u32 s3, 26016, s3
    v_add_u32 v164, s4, v164
    v_mfma_f32_16x16x32_bf16 v[232:235], v[116:119], v[96:99], v[232:235]
    s_waitcnt lgkmcnt(5)
    v_mfma_f32_16x16x32_bf16 v[176:179], v[60:63], a[80:83], v[176:179]
    v_add_u32 v165, s3, v165
    s_waitcnt lgkmcnt(3)
    v_mfma_f32_16x16x32_bf16 v[192:195], v[60:63], a[88:91], v[192:195]
    s_mov_b32 m0, s84
    s_add_u32 s83, s75, s85
    buffer_load_dwordx4 v158, s[60:63], s83 offen lds
    s_waitcnt lgkmcnt(1)
    v_mfma_f32_16x16x32_bf16 v[32:35], v[60:63], a[96:99], v[32:35]
    ds_read_b128 v[60:63], v122 offset:32768
    s_min_u32 s4, s77, 2
    L_nonce:
    v_readfirstlane_b32 s82, v224
    s_cmp_eq_u32 s82, 0
    s_cbranch_scc1 L_nonce_re
    s_xor_b32 s8, s82, s89
    v_mov_b32 v224, s8
    s_mov_b64 exec, 1

    global_store_dword v223, v224, s[50:51] sc1
    s_mov_b64 exec, -1
    v_mfma_f32_16x16x32_bf16 v[48:51], v[116:119], a[80:83], v[48:51]
    s_mul_i32 s3, s4, 4608
    s_add_u32 s3, s3, 16384
    v_mfma_f32_16x16x32_bf16 v[108:111], v[100:103], v[100:103], v[108:111]
    v_lshl_add_u32 v173, v152, 3, s3
    s_mul_i32 s4, s4, 8320
    v_mfma_f32_16x16x32_bf16 v[232:235], v[116:119], v[100:103], v[232:235]
    buffer_load_dwordx4 v159, s[60:63], s83 offen offset:1024 lds
    s_add_u32 s4, s4, 30208
    v_mfma_f32_16x16x32_bf16 v[180:183], v[64:67], a[80:83], v[180:183]
    v_lshrrev_b32 v172, 3, v152
    v_mul_u32_u24 v172, 4132, v172
    v_mfma_f32_16x16x32_bf16 v[196:199], v[64:67], a[88:91], v[196:199]
    v_lshl_add_u32 v172, v152, 2, v172
    v_add_u32 v172, s4, v172
    v_mfma_f32_16x16x32_bf16 v[36:39], v[64:67], a[96:99], v[36:39]
    ds_read_b128 v[64:67], v122 offset:34816
    s_and_b32 s3, s79, 1
    v_mfma_f32_16x16x32_bf16 v[52:55], v[116:119], a[88:91], v[52:55]
    s_lshl_b32 s3, s3, 4
    s_lshr_b32 s35, s35, s3
    v_mfma_f32_16x16x32_bf16 v[108:111], v[104:107], v[104:107], v[108:111]
    s_lshl_b32 s35, s35, 16
    s_lshl_b32 s3, s81, 4
    v_mfma_f32_16x16x32_bf16 v[232:235], v[116:119], v[104:107], v[232:235]
    s_lshr_b32 s34, s34, s3
    v_mfma_f32_16x16x32_bf16 v[184:187], v[68:71], a[80:83], v[184:187]
    global_load_dword a255, v112, s[26:27]
    s_lshl_b32 s34, s34, 16
    v_mfma_f32_16x16x32_bf16 v[200:203], v[68:71], a[88:91], v[200:203]
    s_mov_b64 s[68:69], s[50:51]
    s_mov_b32 s70, 5767168
    v_mfma_f32_16x16x32_bf16 v[40:43], v[68:71], a[96:99], v[40:43]
    ds_read_b128 v[68:71], v122 offset:36864
    global_load_dword a255, v112, s[28:29]
    v_mfma_f32_16x16x32_bf16 v[56:59], v[116:119], a[96:99], v[56:59]
    s_mov_b64 s[64:65], s[46:47]
    s_mov_b32 s66, 5242880
    v_add_u32 v124, 0x10000, v124
    v_mfma_f32_16x16x32_bf16 v[188:191], v[72:75], a[80:83], v[188:191]
    s_add_u32 m0, s84, 2048
    s_add_u32 s83, s75, s85
    buffer_load_dwordx4 v158, s[92:95], s83 offen lds
    v_add_u32 v125, 0x10000, v125
    v_mfma_f32_16x16x32_bf16 v[204:207], v[72:75], a[88:91], v[204:207]
    s_waitcnt vmcnt(12)
    v_mov_b64 v[228:229], 0
    v_mfma_f32_16x16x32_bf16 v[44:47], v[72:75], a[96:99], v[44:47]
    ds_read_b128 v[72:75], v122 offset:38912
    ds_read_b128 v[92:95], v124 offset:0
    v_mfma_f32_16x16x32_bf16 v[176:179], v[76:79], a[84:87], v[176:179]
    buffer_load_dwordx4 v159, s[92:95], s83 offen offset:1024 lds
    ds_read_b128 v[96:99], v125 offset:0
    v_mfma_f32_16x16x32_bf16 v[192:195], v[76:79], a[92:95], v[192:195]
    ds_read_b128 v[100:103], v124 offset:8192
    v_mfma_f32_16x16x32_bf16 v[32:35], v[76:79], a[100:103], v[32:35]
    ds_read_b128 v[76:79], v123 offset:32768
    ds_read_b128 v[104:107], v125 offset:8192
    v_mfma_f32_16x16x32_bf16 v[48:51], v[116:119], a[84:87], v[48:51]
    ds_read_b128 v[142:145], v128
    v_mfma_f32_16x16x32_bf16 v[180:183], v[80:83], a[84:87], v[180:183]
    s_add_u32 m0, s84, 4096
    s_add_u32 s83, s76, s85
    buffer_load_dwordx4 v158, s[56:59], s83 offen lds
    ds_read_b128 v[146:149], v129
    v_mfma_f32_16x16x32_bf16 v[196:199], v[80:83], a[92:95], v[196:199]
    ds_read_b64 v[150:151], v130
    v_mfma_f32_16x16x32_bf16 v[36:39], v[80:83], a[100:103], v[36:39]
    ds_read_b128 v[80:83], v123 offset:34816
    v_mfma_f32_16x16x32_bf16 v[52:55], v[116:119], a[92:95], v[52:55]
    s_waitcnt lgkmcnt(7)
    v_mfma_f32_16x16x32_bf16 v[108:111], v[92:95], v[92:95], v[108:111]
    buffer_load_dwordx4 v159, s[56:59], s83 offen offset:1024 lds
    v_mfma_f32_16x16x32_bf16 v[232:235], v[116:119], v[92:95], v[232:235]
    v_mfma_f32_16x16x32_bf16 v[184:187], v[84:87], a[84:87], v[184:187]
    v_mfma_f32_16x16x32_bf16 v[200:203], v[84:87], a[92:95], v[200:203]
    v_mfma_f32_16x16x32_bf16 v[40:43], v[84:87], a[100:103], v[40:43]
    ds_read_b128 v[84:87], v123 offset:36864
    s_add_u32 m0, s84, 6144
    s_add_u32 s83, s76, s85
    buffer_load_dwordx4 v158, s[60:63], s83 offen lds
    v_mfma_f32_16x16x32_bf16 v[56:59], v[116:119], a[100:103], v[56:59]
    s_waitcnt lgkmcnt(2)
    ds_read_b128 v[0:3], v166 offset:0
    ds_read_b128 v[4:7], v166 offset:16
    v_mfma_f32_16x16x32_bf16 v[108:111], v[96:99], v[96:99], v[108:111]
    ds_read_b128 v[8:11], v166 offset:128
    ds_read_b128 v[12:15], v166 offset:144
    ds_read_b128 v[16:19], v167 offset:256
    v_mfma_f32_16x16x32_bf16 v[232:235], v[116:119], v[96:99], v[232:235]
    s_waitcnt vmcnt(14)
    ds_read_b128 a[104:107], v156 offset:10240
    ds_read_b128 a[108:111], v157 offset:10240
    v_mfma_f32_16x16x32_bf16 v[188:191], v[88:91], a[84:87], v[188:191]
    buffer_load_dwordx4 v159, s[60:63], s83 offen offset:1024 lds
    s_waitcnt vmcnt(13)
    ds_read_b128 a[112:115], v156 offset:12288
    ds_read_b128 a[116:119], v157 offset:12288
    v_mfma_f32_16x16x32_bf16 v[204:207], v[88:91], a[92:95], v[204:207]
    v_lshlrev_b32 v132, 16, v142
    v_and_b32 v133, s86, v142
    v_mfma_f32_16x16x32_bf16 v[44:47], v[88:91], a[100:103], v[44:47]
    ds_read_b128 v[88:91], v123 offset:38912
    v_lshlrev_b32 v134, 16, v143
    v_mfma_f32_16x16x32_bf16 v[108:111], v[100:103], v[100:103], v[108:111]
    s_add_u32 m0, s84, 8192
    s_add_u32 s83, s76, s85
    buffer_load_dwordx4 v158, s[92:95], s83 offen lds
    v_mfma_f32_16x16x32_bf16 v[232:235], v[116:119], v[100:103], v[232:235]
    v_and_b32 v135, s86, v143
    s_waitcnt lgkmcnt(3)
    v_mfma_f32_16x16x32_bf16 v[176:179], v[60:63], a[104:107], v[176:179]
    v_lshlrev_b32 v136, 16, v144
    v_and_b32 v137, s86, v144
    s_waitcnt lgkmcnt(1)
    v_mfma_f32_16x16x32_bf16 v[192:195], v[60:63], a[112:115], v[192:195]
    s_waitcnt lgkmcnt(0)
    s_barrier
    ds_read_b128 v[60:63], v120 offset:49152
    v_mfma_f32_16x16x32_bf16 v[48:51], v[116:119], a[104:107], v[48:51]
    buffer_load_dwordx4 v159, s[92:95], s83 offen offset:1024 lds
    v_lshlrev_b32 v138, 16, v145
    v_and_b32 v139, s86, v145
    v_mfma_f32_16x16x32_bf16 v[108:111], v[104:107], v[104:107], v[108:111]
    v_lshlrev_b32 v140, 16, v146
    v_and_b32 v141, s86, v146
    v_mfma_f32_16x16x32_bf16 v[232:235], v[116:119], v[104:107], v[232:235]
    v_lshlrev_b32 v142, 16, v147
    v_and_b32 v143, s86, v147
    v_mfma_f32_16x16x32_bf16 v[180:183], v[64:67], a[104:107], v[180:183]
    v_lshlrev_b32 v144, 16, v148
    v_and_b32 v145, s86, v148
    v_mfma_f32_16x16x32_bf16 v[196:199], v[64:67], a[112:115], v[196:199]
    ds_read_b128 v[64:67], v120 offset:51200
    s_add_u32 m0, s84, 10240
    s_add_u32 s83, s75, s90
    buffer_load_dwordx4 v158, s[56:59], s83 offen lds
    v_mfma_f32_16x16x32_bf16 v[52:55], v[116:119], a[112:115], v[52:55]
    s_mov_b32 vcc_lo, 0xaaaaaaaa
    s_mov_b32 vcc_hi, 0xaaaaaaaa
    v_cndmask_b32 v108, v108, v109, vcc
    v_cndmask_b32 v110, v110, v111, vcc
    v_mfma_f32_16x16x32_bf16 v[184:187], v[68:71], a[104:107], v[184:187]
    s_mov_b32 vcc_lo, 0xcccccccc
    s_mov_b32 vcc_hi, 0xcccccccc
    v_cndmask_b32 v108, v108, v110, vcc
    v_mfma_f32_16x16x32_bf16 v[200:203], v[68:71], a[112:115], v[200:203]
    ds_read_b128 v[68:71], v120 offset:53248
    s_mov_b32 vcc_lo, 0x00f0000f
    s_mov_b32 vcc_hi, 0xf0000f00
    v_cndmask_b32 v108, 0, v108, vcc
    v_mfma_f32_16x16x32_bf16 v[188:191], v[72:75], a[104:107], v[188:191]
    buffer_load_dwordx4 v159, s[56:59], s83 offen offset:1024 lds
    v_mov_b32 v109, v108
    s_nop 1
    v_permlane32_swap_b32 v108, v109
    v_mfma_f32_16x16x32_bf16 v[204:207], v[72:75], a[112:115], v[204:207]
    ds_read_b128 v[72:75], v120 offset:55296
    v_add_f32 v108, v108, v109
    v_mov_b32 v109, v108
    v_mfma_f32_16x16x32_bf16 v[176:179], v[76:79], a[108:111], v[176:179]
    s_nop 0
    v_permlane16_swap_b32 v108, v109
    v_add_f32 v108, v108, v109
    v_mfma_f32_16x16x32_bf16 v[192:195], v[76:79], a[116:119], v[192:195]
    ds_read_b128 v[76:79], v121 offset:49152
    s_waitcnt vmcnt(15)
    ds_read_b128 a[120:123], v156 offset:14336
    ds_read_b128 a[124:127], v157 offset:14336
    v_mul_f32 v232, 0x3acccccd, v232
    v_mul_f32 v108, 0x3acccccd, v108
    v_mfma_f32_16x16x32_bf16 v[48:51], v[116:119], a[108:111], v[48:51]
    s_add_u32 m0, s84, 12288
    s_add_u32 s83, s75, s90
    buffer_load_dwordx4 v158, s[60:63], s83 offen lds
    v_fma_f32 v108, -v232, v232, v108
    v_max_f32 v108, 0, v108
    v_mfma_f32_16x16x32_bf16 v[180:183], v[80:83], a[108:111], v[180:183]
    v_cvt_pk_bf16_f32 v232, 0, v232
    v_cvt_pk_bf16_f32 v108, 0, v108
    v_mfma_f32_16x16x32_bf16 v[196:199], v[80:83], a[116:119], v[196:199]
    ds_read_b128 v[80:83], v121 offset:51200
    v_add_f32 v108, 0x3727c5ac, v108
    v_cvt_pk_bf16_f32 v108, 0, v108
    v_mfma_f32_16x16x32_bf16 v[52:55], v[116:119], a[116:119], v[52:55]
    buffer_load_dwordx4 v159, s[60:63], s83 offen offset:1024 lds
    s_waitcnt vmcnt(14)
    ds_read_b128 a[128:131], v156 offset:0
    ds_read_b128 a[132:135], v157 offset:0
    v_sqrt_f32 v108, v108
    v_xor_b32 v233, 0x80000000, v232
    v_mfma_f32_16x16x32_bf16 v[184:187], v[84:87], a[108:111], v[184:187]
    s_waitcnt vmcnt(10)
    ds_read_b128 a[136:139], v156 offset:2048
    ds_read_b128 a[140:143], v157 offset:2048
    v_cvt_pk_bf16_f32 v108, 0, v108
    v_rcp_f32 v108, v108
    v_mfma_f32_16x16x32_bf16 v[200:203], v[84:87], a[116:119], v[200:203]
    ds_read_b128 v[84:87], v121 offset:53248
    v_lshlrev_b32 v146, 16, v149
    v_and_b32 v147, s86, v149
    v_mfma_f32_16x16x32_bf16 v[188:191], v[88:91], a[108:111], v[188:191]
    v_lshlrev_b32 v148, 16, v150
    v_and_b32 v149, s86, v150
    v_mfma_f32_16x16x32_bf16 v[204:207], v[88:91], a[116:119], v[204:207]
    ds_read_b128 v[88:91], v121 offset:55296
    s_waitcnt lgkmcnt(7)
    s_add_u32 m0, s84, 14336
    s_add_u32 s83, s76, s90
    buffer_load_dwordx4 v158, s[56:59], s83 offen lds
    v_mfma_f32_16x16x32_bf16 v[176:179], v[60:63], a[120:123], v[176:179]
    v_lshlrev_b32 v150, 16, v151
    v_and_b32 v151, s86, v151
    s_waitcnt lgkmcnt(4)
    v_mfma_f32_16x16x32_bf16 v[192:195], v[60:63], a[128:131], v[192:195]
    v_add_f32 v132, v233, v132
    s_waitcnt lgkmcnt(2)
    v_mfma_f32_16x16x32_bf16 v[32:35], v[60:63], a[136:139], v[32:35]
    v_add_u32 v120, 0x10000, v120
    v_add_u32 v121, 0x10000, v121
    ds_read_b128 v[60:63], v120 offset:0
    v_add_f32 v133, v233, v133
    v_add_f32 v134, v233, v134
    v_mfma_f32_16x16x32_bf16 v[48:51], v[116:119], a[120:123], v[48:51]
    buffer_load_dwordx4 v159, s[56:59], s83 offen offset:1024 lds
    v_add_f32 v135, v233, v135
    v_add_f32 v136, v233, v136
    v_mfma_f32_16x16x32_bf16 v[180:183], v[64:67], a[120:123], v[180:183]
    v_add_f32 v137, v233, v137
    v_add_f32 v138, v233, v138
    v_mfma_f32_16x16x32_bf16 v[196:199], v[64:67], a[128:131], v[196:199]
    v_add_f32 v139, v233, v139
    v_add_f32 v140, v233, v140
    v_mfma_f32_16x16x32_bf16 v[36:39], v[64:67], a[136:139], v[36:39]
    ds_read_b128 v[64:67], v121 offset:0
    v_add_f32 v141, v233, v141
    v_add_f32 v142, v233, v142
    v_mfma_f32_16x16x32_bf16 v[52:55], v[116:119], a[128:131], v[52:55]
    s_mov_b32 m0, s84
    s_add_u32 s83, s76, s90
    buffer_load_dwordx4 v158, s[60:63], s83 offen lds
    v_mfma_f32_16x16x32_bf16 v[184:187], v[68:71], a[120:123], v[184:187]
    v_add_f32 v143, v233, v143
    v_add_f32 v144, v233, v144
    v_mfma_f32_16x16x32_bf16 v[200:203], v[68:71], a[128:131], v[200:203]
    v_add_f32 v145, v233, v145
    v_add_f32 v146, v233, v146
    v_mfma_f32_16x16x32_bf16 v[40:43], v[68:71], a[136:139], v[40:43]
    ds_read_b128 v[68:71], v120 offset:2048
    v_add_f32 v147, v233, v147
    v_add_f32 v148, v233, v148
    v_mfma_f32_16x16x32_bf16 v[56:59], v[116:119], a[136:139], v[56:59]
    buffer_load_dwordx4 v159, s[60:63], s83 offen offset:1024 lds
    v_add_f32 v149, v233, v149
    v_add_f32 v150, v233, v150
    v_mfma_f32_16x16x32_bf16 v[188:191], v[72:75], a[120:123], v[188:191]
    s_mov_b64 s[56:57], s[26:27]
    s_sub_u32 s60, s28, 2048
    s_subb_u32 s61, s29, 0
    v_mfma_f32_16x16x32_bf16 v[204:207], v[72:75], a[128:131], v[204:207]
    s_mov_b32 s62, 821248
    v_bfe_u32 v230, v152, 4, 1
    v_lshlrev_b32 v159, 1, v230
    v_mfma_f32_16x16x32_bf16 v[44:47], v[72:75], a[136:139], v[44:47]
    ds_read_b128 v[72:75], v121 offset:2048
    s_add_u32 s83, s12, s15
    v_add_u32 v175, s83, v153
    global_load_dwordx4 v[252:255], v175, s[42:43]
    v_and_b32 v231, 3, v152
    v_xor_b32 v159, v159, v231
    v_mfma_f32_16x16x32_bf16 v[176:179], v[76:79], a[124:127], v[176:179]
    v_lshrrev_b32 v231, 5, v152
    v_lshl_add_u32 v159, v231, 2, v159
    s_mul_i32 s3, s78, 102400
    s_mul_i32 s4, s77, 320
    s_add_u32 s3, s3, s4
    v_mfma_f32_16x16x32_bf16 v[192:195], v[76:79], a[132:135], v[192:195]
    s_waitcnt vmcnt(13)
    ds_read_b128 a[160:163], v156 offset:4096
    ds_read_b128 a[164:167], v157 offset:4096
    v_lshl_add_u32 v159, v159, 4, s3
    v_bfe_u32 v231, v152, 2, 2
    v_mfma_f32_16x16x32_bf16 v[32:35], v[76:79], a[140:143], v[32:35]
    ds_read_b128 v[76:79], v120 offset:4096
    v_lshl_add_u32 v231, v230, 3, v231
    s_movk_i32 s4, 1280
    v_mad_u32_u24 v159, v231, s4, v159
    s_movk_i32 s4, 10240
    v_mfma_f32_16x16x32_bf16 v[48:51], v[116:119], a[124:127], v[48:51]
    v_mad_u32_u24 v158, v230, s4, v159
    s_lshl_b32 s3, s79, 4
    s_and_b32 s3, s3, 128
    s_lshl_b32 s4, s80, 6
    v_mfma_f32_16x16x32_bf16 v[180:183], v[80:83], a[124:127], v[180:183]
    s_add_u32 s16, s3, s4
    s_xor_b32 s17, s16, 128
    s_lshl_b32 s4, s4, 2
    v_mfma_f32_16x16x32_bf16 v[196:199], v[80:83], a[132:135], v[196:199]
    s_xor_b32 s44, s4, 256
    s_add_u32 s83, s12, s14
    v_add_u32 v175, s83, v153
    global_load_dwordx4 v[244:247], v175, s[42:43]
    v_add_f32 v151, v233, v151
    v_fma_f32 v0, v0, v108, 1.0
    v_mfma_f32_16x16x32_bf16 v[36:39], v[80:83], a[140:143], v[36:39]
    ds_read_b128 v[80:83], v121 offset:4096
    s_add_u32 s83, s12, s14
    v_add_u32 v175, s83, v153
    v_add_u32 v175, 4096, v175
    global_load_dwordx4 v[248:251], v175, s[42:43]
    v_fma_f32 v1, v1, v108, 1.0
    v_fma_f32 v2, v2, v108, 1.0
    v_mfma_f32_16x16x32_bf16 v[52:55], v[116:119], a[132:135], v[52:55]
    global_load_dword v224, v169, s[50:51] sc1
    v_fma_f32 v3, v3, v108, 1.0
    v_fma_f32 v4, v4, v108, 1.0
    s_waitcnt lgkmcnt(8)
    v_mfma_f32_16x16x32_bf16 v[184:187], v[84:87], a[124:127], v[184:187]
    global_load_dwordx2 v[170:171], v168, s[50:51] sc1
    v_fma_f32 v5, v5, v108, 1.0
    v_fma_f32 v6, v6, v108, 1.0
    v_mfma_f32_16x16x32_bf16 v[200:203], v[84:87], a[132:135], v[200:203]
    s_waitcnt vmcnt(15)
    ds_read_b128 a[168:171], v156 offset:6144
    ds_read_b128 a[172:175], v157 offset:6144
    global_load_dword a255, v227, s[50:51] sc1
    v_mfma_f32_16x16x32_bf16 v[40:43], v[84:87], a[140:143], v[40:43]
    ds_read_b128 v[84:87], v120 offset:6144
    v_fma_f32 v7, v7, v108, 1.0
    v_fma_f32 v8, v8, v108, 1.0
    v_mfma_f32_16x16x32_bf16 v[56:59], v[116:119], a[140:143], v[56:59]
    s_waitcnt vmcnt(14)
    ds_read_b128 a[176:179], v156 offset:8192
    ds_read_b128 a[180:183], v157 offset:8192
    global_load_dword a255, v242, s[46:47] offset:-2048
    v_mfma_f32_16x16x32_bf16 v[188:191], v[88:91], a[124:127], v[188:191]
    v_fma_f32 v9, v9, v108, 1.0
    v_fma_f32 v10, v10, v108, 1.0
    v_mfma_f32_16x16x32_bf16 v[204:207], v[88:91], a[132:135], v[204:207]
    v_fma_f32 v11, v11, v108, 1.0
    v_fma_f32 v12, v12, v108, 1.0
    v_mfma_f32_16x16x32_bf16 v[44:47], v[88:91], a[140:143], v[44:47]
    ds_read_b128 v[88:91], v121 offset:6144
    s_waitcnt lgkmcnt(8)
    v_mfma_f32_16x16x32_bf16 v[176:179], v[60:63], a[160:163], v[176:179]
    ds_read_b64 v[112:113], v154 offset:7680
    global_load_dword a255, v242, s[46:47] offset:-1024
    v_fma_f32 v13, v13, v108, 1.0
    v_fma_f32 v14, v14, v108, 1.0
    s_waitcnt lgkmcnt(5)
    v_mfma_f32_16x16x32_bf16 v[192:195], v[60:63], a[168:171], v[192:195]
    ds_read_b64 v[114:115], v155 offset:7680
    v_fma_f32 v15, v15, v108, 1.0
    v_fma_f32 v16, v16, v108, 1.0
    s_waitcnt lgkmcnt(3)
    v_mfma_f32_16x16x32_bf16 v[32:35], v[60:63], a[176:179], v[32:35]
    ds_read_b128 v[60:63], v122 offset:49152
    ds_read_b64 v[100:101], v154 offset:8320
    v_fma_f32 v17, v17, v108, 1.0
    v_fma_f32 v18, v18, v108, 1.0
    v_mfma_f32_16x16x32_bf16 v[48:51], v[116:119], a[160:163], v[48:51]
    ds_read_b64 v[102:103], v154 offset:8960
    v_fma_f32 v19, v19, v108, 1.0
    v_mul_f32 v132, v0, v132
    v_mfma_f32_16x16x32_bf16 v[176:179], v[64:67], a[164:167], v[176:179]
    ds_read_b64 v[104:105], v155 offset:8320
    global_load_dword a255, v242, s[46:47] offset:0
    v_mul_f32 v133, v1, v133
    v_mul_f32 v134, v2, v134
    v_mfma_f32_16x16x32_bf16 v[192:195], v[64:67], a[172:175], v[192:195]
    ds_read_b64 v[106:107], v155 offset:8960
    v_mul_f32 v135, v3, v135
    v_mul_f32 v136, v4, v136
    v_mfma_f32_16x16x32_bf16 v[32:35], v[64:67], a[180:183], v[32:35]
    ds_read_b128 v[64:67], v122 offset:51200
    v_mul_f32 v137, v5, v137
    v_mul_f32 v138, v6, v138
    v_mfma_f32_16x16x32_bf16 v[48:51], v[116:119], a[164:167], v[48:51]
    v_mul_f32 v139, v7, v139
    v_mul_f32 v140, v8, v140
    v_mfma_f32_16x16x32_bf16 v[180:183], v[68:71], a[160:163], v[180:183]
    s_nop 0
    ds_write_b128 v220, v[32:35] offset:0
    global_load_dword a255, v242, s[46:47] offset:1024
    v_mul_f32 v141, v9, v141
    v_mul_f32 v142, v10, v142
    v_mfma_f32_16x16x32_bf16 v[196:199], v[68:71], a[168:171], v[196:199]
    s_waitcnt vmcnt(16)
    ds_read_b128 a[144:147], v156 offset:10240
    ds_read_b128 a[148:151], v157 offset:10240
    v_mfma_f32_16x16x32_bf16 v[36:39], v[68:71], a[176:179], v[36:39]
    ds_read_b128 v[68:71], v122 offset:53248
    v_mul_f32 v143, v11, v143
    v_mul_f32 v144, v12, v144
    v_mfma_f32_16x16x32_bf16 v[52:55], v[116:119], a[168:171], v[52:55]
    v_mul_f32 v145, v13, v145
    v_mul_f32 v146, v14, v146
    v_mfma_f32_16x16x32_bf16 v[180:183], v[72:75], a[164:167], v[180:183]
    s_mov_b64 exec, 0xffff
    ds_write_b32 v126, v232 offset:1024
    ds_write2st64_b32 v126, v233, v108 offset1:1
    ds_write2st64_b32 v127, v233, v108 offset1:1
    s_mov_b64 exec, -1
    v_mfma_f32_16x16x32_bf16 v[196:199], v[72:75], a[172:175], v[196:199]
    s_waitcnt lgkmcnt(13)
    global_load_dword a255, v242, s[46:47] offset:2048
    v_mul_f32 v147, v15, v147
    v_mul_f32 v148, v16, v148
    v_mfma_f32_16x16x32_bf16 v[36:39], v[72:75], a[180:183], v[36:39]
    ds_read_b128 v[72:75], v122 offset:55296
    v_mul_f32 v149, v17, v149
    v_mul_f32 v150, v18, v150
    v_mfma_f32_16x16x32_bf16 v[52:55], v[116:119], a[172:175], v[52:55]
    v_mul_f32 v151, v19, v151
    v_xor_b32 v115, v163, v115
    v_mfma_f32_16x16x32_bf16 v[184:187], v[76:79], a[160:163], v[184:187]
    s_waitcnt vmcnt(15)
    ds_read_b128 a[152:155], v156 offset:12288
    ds_read_b128 a[156:159], v157 offset:12288
    v_mfma_f32_16x16x32_bf16 v[200:203], v[76:79], a[168:171], v[200:203]
    ds_write_b128 v220, v[36:39] offset:1024
    s_waitcnt lgkmcnt(12)
    v_xor_b32 v105, v163, v105
    v_xor_b32 v107, v163, v107
    v_mfma_f32_16x16x32_bf16 v[40:43], v[76:79], a[176:179], v[40:43]
    ds_read_b128 v[76:79], v123 offset:49152
    v_mfma_f32_16x16x32_bf16 v[56:59], v[116:119], a[176:179], v[56:59]
    v_mfma_f32_16x16x32_bf16 v[184:187], v[80:83], a[164:167], v[184:187]
    v_mfma_f32_16x16x32_bf16 v[200:203], v[80:83], a[172:175], v[200:203]
    v_mfma_f32_16x16x32_bf16 v[40:43], v[80:83], a[180:183], v[40:43]
    ds_read_b128 v[80:83], v123 offset:51200
    v_mfma_f32_16x16x32_bf16 v[56:59], v[116:119], a[180:183], v[56:59]
    v_mfma_f32_16x16x32_bf16 v[188:191], v[84:87], a[160:163], v[188:191]
    s_waitcnt vmcnt(13)
    ds_read_b128 a[184:187], v156 offset:14336
    ds_read_b128 a[188:191], v157 offset:14336
    v_mfma_f32_16x16x32_bf16 v[204:207], v[84:87], a[168:171], v[204:207]
    s_nop 0
    ds_write_b128 v220, v[40:43] offset:2048
    v_mfma_f32_16x16x32_bf16 v[44:47], v[84:87], a[176:179], v[44:47]
    ds_read_b128 v[84:87], v123 offset:53248
    v_mfma_f32_16x16x32_bf16 v[188:191], v[88:91], a[164:167], v[188:191]
    v_mfma_f32_16x16x32_bf16 v[204:207], v[88:91], a[172:175], v[204:207]
    v_mfma_f32_16x16x32_bf16 v[44:47], v[88:91], a[180:183], v[44:47]
    ds_read_b128 v[88:91], v123 offset:55296
    s_waitcnt lgkmcnt(15)
    v_mfma_f32_16x16x32_bf16 v[176:179], v[60:63], a[144:147], v[176:179]
    s_waitcnt lgkmcnt(8)
    v_mfma_f32_16x16x32_bf16 v[192:195], v[60:63], a[152:155], v[192:195]
    v_add_u32 v122, 0x10000, v122
    v_add_u32 v123, 0x10000, v123
    ds_read_b128 v[60:63], v122 offset:0
    ds_write_b128 v220, v[44:47] offset:3072
    v_mfma_f32_16x16x32_bf16 v[48:51], v[116:119], a[144:147], v[48:51]
    s_waitcnt vmcnt(11)
    ds_read_b128 a[192:195], v156 offset:0
    ds_read_b128 a[196:199], v157 offset:0
    v_mfma_f32_16x16x32_bf16 v[180:183], v[64:67], a[144:147], v[180:183]
    v_and_b32 v226, 3, v152
    v_lshl_add_u32 v156, v226, 6, s84
    v_mfma_f32_16x16x32_bf16 v[196:199], v[64:67], a[152:155], v[196:199]
    ds_read_b128 v[64:67], v123 offset:0
    s_mov_b64 exec, 0xffff
    ds_write_b32 v225, v56
    s_mov_b64 exec, -1
    v_bfe_u32 v226, v152, 2, 1
    v_lshl_add_u32 v156, v226, 10, v156
    v_mfma_f32_16x16x32_bf16 v[52:55], v[116:119], a[152:155], v[52:55]
    v_bfe_u32 v226, v152, 3, 1
    v_lshl_add_u32 v156, v226, 8, v156
    v_mfma_f32_16x16x32_bf16 v[184:187], v[68:71], a[144:147], v[184:187]
    v_lshlrev_b32 v226, 1, v226
    v_bfe_u32 v221, v152, 4, 1
    v_mfma_f32_16x16x32_bf16 v[200:203], v[68:71], a[152:155], v[200:203]
    ds_read_b128 v[68:71], v122 offset:2048
    v_xor_b32 v226, v226, v221
    v_lshl_add_u32 v156, v226, 4, v156
    v_mfma_f32_16x16x32_bf16 v[188:191], v[72:75], a[144:147], v[188:191]
    v_lshrrev_b32 v226, 5, v152
    v_lshl_add_u32 v156, v226, 11, v156
    v_mfma_f32_16x16x32_bf16 v[204:207], v[72:75], a[152:155], v[204:207]
    ds_read_b128 v[72:75], v123 offset:2048
    v_xor_b32 v157, 32, v156
    s_waitcnt lgkmcnt(13)
    v_mfma_f32_16x16x32_bf16 v[176:179], v[76:79], a[148:151], v[176:179]
    s_lshl_b32 s3, s78, 2
    s_add_u32 s3, s3, s77
    s_lshl_b32 s3, s3, 13
    s_waitcnt lgkmcnt(0)
    s_barrier
    v_mfma_f32_16x16x32_bf16 v[192:195], v[76:79], a[156:159], v[192:195]
    ds_read_b128 v[76:79], v122 offset:4096
    s_add_u32 s3, s3, 9437184
    ds_read2st64_b32 v[16:17], v218 offset0:0 offset1:32
    v_mov_b32 v36, s30
    v_mfma_f32_16x16x32_bf16 v[48:51], v[116:119], a[148:151], v[48:51]
    s_add_u32 s92, s50, s3
    s_addc_u32 s93, s51, 0
    s_movk_i32 s94, 8192
    s_waitcnt vmcnt(9)
    v_mov_b32_dpp v36, v247 wave_shr:1 row_mask:0xf bank_mask:0xf
    v_alignbit_b32 v33, v245, v244, 16
    v_mfma_f32_16x16x32_bf16 v[180:183], v[80:83], a[148:151], v[180:183]
    s_sub_u32 s21, 31, s79
    s_lshl_b32 s21, s21, 8
    ds_read2st64_b32 v[18:19], v219 offset0:0 offset1:32
    v_alignbit_b32 v34, v246, v245, 16
    v_alignbit_b32 v35, v247, v246, 16
    v_mfma_f32_16x16x32_bf16 v[196:199], v[80:83], a[156:159], v[196:199]
    ds_read_b128 v[80:83], v123 offset:4096
    v_alignbit_b32 v32, v244, v36, 16
    v_mov_b32 v40, s31
    v_mfma_f32_16x16x32_bf16 v[52:55], v[116:119], a[156:159], v[52:55]
    ds_read2st64_b32 v[20:21], v218 offset0:4 offset1:36
    s_waitcnt vmcnt(8)
    v_mov_b32_dpp v40, v251 wave_shr:1 row_mask:0xf bank_mask:0xf
    v_alignbit_b32 v37, v249, v248, 16
    v_mfma_f32_16x16x32_bf16 v[184:187], v[84:87], a[148:151], v[184:187]
    s_waitcnt vmcnt(6)
    L_kf:
    v_xor_b32 v224, s82, v224
    v_xor_b32 v170, s82, v170
    v_xor_b32 v171, s82, v171
    v_max3_u32 v170, v170, v171, v224
    v_cmp_lt_u32 vcc, 7, v170
    s_cbranch_vccnz L_kf_re
    v_cmp_ne_u32 vcc, s89, v224
    s_lshl_b32 s5, s77, 10
    s_cmp_eq_u32 vcc_hi, 0
    s_cselect_b32 s88, 1, 0

    s_add_u32 m0, s5, 26112
    s_add_u32 s83, s5, s15
    buffer_load_dwordx4 v153, s[68:71], s83 offen sc1 lds
    v_alignbit_b32 v38, v250, v249, 16
    v_alignbit_b32 v39, v251, v250, 16
    v_mfma_f32_16x16x32_bf16 v[200:203], v[84:87], a[156:159], v[200:203]
    ds_read_b128 v[84:87], v122 offset:6144
    ds_read2st64_b32 v[22:23], v219 offset0:4 offset1:36
    v_alignbit_b32 v36, v248, v40, 16
    v_mov_b32 v44, s32
    v_mfma_f32_16x16x32_bf16 v[188:191], v[88:91], a[148:151], v[188:191]
    s_nop 0
    v_mov_b32_dpp v44, v255 wave_shr:1 row_mask:0xf bank_mask:0xf
    v_alignbit_b32 v41, v253, v252, 16
    v_mfma_f32_16x16x32_bf16 v[204:207], v[88:91], a[156:159], v[204:207]
    ds_read_b128 v[88:91], v123 offset:6144
    ds_read2st64_b32 v[24:25], v218 offset0:8 offset1:40
    v_alignbit_b32 v42, v254, v253, 16
    v_alignbit_b32 v43, v255, v254, 16
    v_mfma_f32_16x16x32_bf16 v[176:179], v[60:63], a[184:187], v[176:179]
    s_add_u32 m0, s5, 16896
    s_add_u32 s83, s5, s14
    buffer_load_dwordx4 v153, s[68:71], s83 offen sc1 lds
    v_alignbit_b32 v40, v252, v44, 16
    v_mfma_f32_16x16x32_bf16 v[192:195], v[60:63], a[192:195], v[192:195]
    ds_read2st64_b32 v[26:27], v219 offset0:8 offset1:40
    v_mfma_f32_16x16x32_bf16 v[48:51], v[116:119], a[184:187], v[48:51]
    v_mfma_f32_16x16x32_bf16 v[176:179], v[64:67], a[188:191], v[176:179]
    ds_read2st64_b32 v[28:29], v218 offset0:12 offset1:44
    s_add_u32 m0, s5, 21504
    s_add_u32 s83, s5, s14
    s_add_u32 s83, s83, 4096
    buffer_load_dwordx4 v153, s[68:71], s83 offen sc1 lds
    v_mfma_f32_16x16x32_bf16 v[192:195], v[64:67], a[196:199], v[192:195]
    ds_write_b64 v173, v[228:229]
    v_mfma_f32_16x16x32_bf16 v[48:51], v[116:119], a[188:191], v[48:51]
    ds_read2st64_b32 v[30:31], v219 offset0:12 offset1:44
    v_mfma_f32_16x16x32_bf16 v[180:183], v[68:71], a[184:187], v[180:183]
    ds_read2_b32 v[230:231], v222 offset1:32
    v_and_b32 v120, 1, v152
    v_mul_u32_u24 v120, 640, v120
    v_add_u32 v120, v155, v120
    v_mfma_f32_16x16x32_bf16 v[196:199], v[68:71], a[192:195], v[196:199]
    ds_read_b128 v[92:95], v217 offset:768
    s_add_u32 m0, s84, 4096
    s_add_u32 s83, s16, 81920
    buffer_load_dwordx4 v159, s[56:59], s83 offen offset:0 lds
    v_mfma_f32_16x16x32_bf16 v[52:55], v[116:119], a[192:195], v[52:55]
    ds_read_b128 v[96:99], v217 offset:784
    s_mov_b64 exec, 0x7fff
    ds_write_b32 v172, v228
    s_mov_b64 exec, -1
    v_mfma_f32_16x16x32_bf16 v[180:183], v[72:75], a[188:191], v[180:183]
    ds_read_b128 v[212:215], v217 offset:528
    ds_read2_b32 v[124:125], v154 offset1:160
    ds_read2_b32 v[126:127], v154 offset0:1 offset1:161
    ds_read_b64 v[128:129], v155 offset:0
    v_mfma_f32_16x16x32_bf16 v[196:199], v[72:75], a[196:199], v[196:199]
    ds_read_b128 v[208:211], v217 offset:512
    ds_read_b64 v[130:131], v120 offset:0
    s_waitcnt lgkmcnt(10)
    v_add_f32 v16, v16, v17
    v_add_f32 v18, v18, v19
    v_mfma_f32_16x16x32_bf16 v[52:55], v[116:119], a[196:199], v[52:55]
    ds_read_b128 v[0:3], v216 offset:0
    buffer_load_dwordx4 v159, s[60:63], s83 offen offset:2048 lds
    v_add_f32 v20, v20, v21
    v_add_f32 v22, v22, v23
    v_mfma_f32_16x16x32_bf16 v[184:187], v[76:79], a[184:187], v[184:187]
    ds_read_b128 v[4:7], v216 offset:256
    ds_write_b128 v243, v[244:247] offset:38560
    v_add_f32 v24, v24, v25
    v_add_f32 v26, v26, v27
    v_mfma_f32_16x16x32_bf16 v[200:203], v[76:79], a[192:195], v[200:203]
    ds_read_b128 v[8:11], v216 offset:16
    v_add_f32 v28, v28, v29
    v_add_f32 v30, v30, v31
    v_mfma_f32_16x16x32_bf16 v[184:187], v[80:83], a[188:191], v[184:187]
    ds_read_b128 v[12:15], v216 offset:272
    s_waitcnt lgkmcnt(6)
    v_add_f32 v162, v230, v231
    v_fma_f32 v208, v208, v162, v16
    v_mfma_f32_16x16x32_bf16 v[200:203], v[80:83], a[196:199], v[200:203]
    s_add_u32 s83, s83, 4096
    buffer_load_dwordx4 v159, s[56:59], s83 offen offset:1024 lds
    v_fma_f32 v209, v209, v162, v18
    v_fma_f32 v210, v210, v162, v20
    v_mfma_f32_16x16x32_bf16 v[188:191], v[84:87], a[184:187], v[188:191]
    ds_write_b128 v243, v[32:35] offset:42720
    v_fma_f32 v211, v211, v162, v22
    v_fma_f32 v212, v212, v162, v24
    v_mfma_f32_16x16x32_bf16 v[204:207], v[84:87], a[192:195], v[204:207]
    v_fma_f32 v213, v213, v162, v26
    v_fma_f32 v214, v214, v162, v28
    v_mfma_f32_16x16x32_bf16 v[188:191], v[88:91], a[188:191], v[188:191]
    v_fma_f32 v215, v215, v162, v30
    v_mul_f32 v208, v92, v208
    v_mfma_f32_16x16x32_bf16 v[204:207], v[88:91], a[196:199], v[204:207]
    buffer_load_dwordx4 v159, s[60:63], s83 offen offset:3072 lds
    v_mul_f32 v209, v93, v209
    v_mul_f32 v210, v94, v210
    v_mul_f32 v211, v95, v211
    v_mul_f32 v212, v96, v212
    v_mul_f32 v213, v97, v213
    v_mul_f32 v214, v98, v214
    v_mul_f32 v215, v99, v215
    v_mov_b32 v160, v48
    v_mov_b32 v161, v52
    s_waitcnt lgkmcnt(4)
    v_pk_fma_f32 v[176:177], v[0:1], v[160:161], v[176:177] op_sel_hi:[1,0,1]
    v_pk_fma_f32 v[192:193], v[0:1], v[160:161], v[192:193] op_sel:[0,1,0]
    v_fma_f32 v241, v114, v208, v209
    v_pk_fma_f32 v[178:179], v[2:3], v[160:161], v[178:179] op_sel_hi:[1,0,1]
    v_pk_fma_f32 v[194:195], v[2:3], v[160:161], v[194:195] op_sel:[0,1,0]
    v_pk_mul_f32 v[176:177], v[4:5], v[176:177]
    v_fmac_f32_dpp v241, v208, v115 row_ror:8 row_mask:0xf bank_mask:0xf
    v_pk_mul_f32 v[192:193], v[4:5], v[192:193]
    v_pk_mul_f32 v[178:179], v[6:7], v[178:179]
    v_pk_mul_f32 v[194:195], v[6:7], v[194:195]
    v_fma_f32 v240, v114, v241, v210
    ds_read_b128 v[0:3], v216 offset:32
    ds_read_b128 v[4:7], v216 offset:288
    v_pk_fma_f32 v[236:237], v[176:177], v[112:113], v[178:179] op_sel_hi:[1,0,1]
    v_fmac_f32_dpp v240, v241, v115 row_ror:8 row_mask:0xf bank_mask:0xf
    v_pk_fma_f32 v[238:239], v[192:193], v[112:113], v[194:195] op_sel_hi:[1,0,1]
    v_pk_fma_f32 v[236:237], v[192:193], v[112:113], v[236:237] op_sel:[0,1,0] neg_lo:[1,0,0] neg_hi:[1,0,0]
    v_pk_fma_f32 v[238:239], v[176:177], v[112:113], v[238:239] op_sel:[0,1,0]
    s_waitcnt lgkmcnt(3)
    v_pk_fma_f32 v[180:181], v[8:9], v[160:161], v[180:181] op_sel_hi:[1,0,1]
    v_pk_fma_f32 v[196:197], v[8:9], v[160:161], v[196:197] op_sel:[0,1,0]
    v_fma_f32 v241, v114, v240, v211
    v_pk_fma_f32 v[182:183], v[10:11], v[160:161], v[182:183] op_sel_hi:[1,0,1]
    v_pk_fma_f32 v[198:199], v[10:11], v[160:161], v[198:199] op_sel:[0,1,0]
    v_pk_mul_f32 v[180:181], v[12:13], v[180:181]
    v_fmac_f32_dpp v241, v240, v115 row_ror:8 row_mask:0xf bank_mask:0xf
    v_pk_mul_f32 v[196:197], v[12:13], v[196:197]
    v_pk_mul_f32 v[182:183], v[14:15], v[182:183]
    v_pk_mul_f32 v[198:199], v[14:15], v[198:199]
    v_fma_f32 v240, v114, v241, v212
    ds_read_b128 v[8:11], v216 offset:48
    ds_read_b128 v[12:15], v216 offset:304
    v_pk_fma_f32 v[232:233], v[236:237], v[112:113], v[180:181] op_sel_hi:[1,0,1]
    v_fmac_f32_dpp v240, v241, v115 row_ror:8 row_mask:0xf bank_mask:0xf
    v_pk_fma_f32 v[234:235], v[238:239], v[112:113], v[196:197] op_sel_hi:[1,0,1]
    v_pk_fma_f32 v[232:233], v[238:239], v[112:113], v[232:233] op_sel:[0,1,0] neg_lo:[1,0,0] neg_hi:[1,0,0]
    v_pk_fma_f32 v[234:235], v[236:237], v[112:113], v[234:235] op_sel:[0,1,0]
    v_pk_fma_f32 v[236:237], v[232:233], v[112:113], v[182:183] op_sel_hi:[1,0,1]
    v_pk_fma_f32 v[238:239], v[234:235], v[112:113], v[198:199] op_sel_hi:[1,0,1]
    v_pk_fma_f32 v[236:237], v[234:235], v[112:113], v[236:237] op_sel:[0,1,0] neg_lo:[1,0,0] neg_hi:[1,0,0]
    v_pk_fma_f32 v[238:239], v[232:233], v[112:113], v[238:239] op_sel:[0,1,0]
    s_waitcnt lgkmcnt(2)
    v_pk_fma_f32 v[184:185], v[0:1], v[160:161], v[184:185] op_sel_hi:[1,0,1]
    v_pk_fma_f32 v[200:201], v[0:1], v[160:161], v[200:201] op_sel:[0,1,0]
    v_fma_f32 v241, v114, v240, v213
    v_pk_fma_f32 v[186:187], v[2:3], v[160:161], v[186:187] op_sel_hi:[1,0,1]
    v_pk_fma_f32 v[202:203], v[2:3], v[160:161], v[202:203] op_sel:[0,1,0]
    v_pk_mul_f32 v[184:185], v[4:5], v[184:185]
    v_fmac_f32_dpp v241, v240, v115 row_ror:8 row_mask:0xf bank_mask:0xf
    v_pk_mul_f32 v[200:201], v[4:5], v[200:201]
    v_pk_mul_f32 v[186:187], v[6:7], v[186:187]
    v_pk_mul_f32 v[202:203], v[6:7], v[202:203]
    v_fma_f32 v240, v114, v241, v214
    v_pk_fma_f32 v[232:233], v[236:237], v[112:113], v[184:185] op_sel_hi:[1,0,1]
    v_pk_fma_f32 v[234:235], v[238:239], v[112:113], v[200:201] op_sel_hi:[1,0,1]
    v_pk_fma_f32 v[232:233], v[238:239], v[112:113], v[232:233] op_sel:[0,1,0] neg_lo:[1,0,0] neg_hi:[1,0,0]
    v_fmac_f32_dpp v240, v241, v115 row_ror:8 row_mask:0xf bank_mask:0xf
    v_pk_fma_f32 v[234:235], v[236:237], v[112:113], v[234:235] op_sel:[0,1,0]
    v_pk_fma_f32 v[236:237], v[232:233], v[112:113], v[186:187] op_sel_hi:[1,0,1]
    v_pk_fma_f32 v[238:239], v[234:235], v[112:113], v[202:203] op_sel_hi:[1,0,1]
    v_pk_fma_f32 v[236:237], v[234:235], v[112:113], v[236:237] op_sel:[0,1,0] neg_lo:[1,0,0] neg_hi:[1,0,0]
    v_pk_fma_f32 v[238:239], v[232:233], v[112:113], v[238:239] op_sel:[0,1,0]
    s_waitcnt lgkmcnt(0)
    v_pk_fma_f32 v[188:189], v[8:9], v[160:161], v[188:189] op_sel_hi:[1,0,1]
    v_pk_fma_f32 v[204:205], v[8:9], v[160:161], v[204:205] op_sel:[0,1,0]
    v_fma_f32 v241, v114, v240, v215
    v_pk_fma_f32 v[190:191], v[10:11], v[160:161], v[190:191] op_sel_hi:[1,0,1]
    v_pk_fma_f32 v[206:207], v[10:11], v[160:161], v[206:207] op_sel:[0,1,0]
    v_pk_mul_f32 v[188:189], v[12:13], v[188:189]
    v_fmac_f32_dpp v241, v240, v115 row_ror:8 row_mask:0xf bank_mask:0xf
    v_pk_mul_f32 v[204:205], v[12:13], v[204:205]
    v_pk_mul_f32 v[190:191], v[14:15], v[190:191]
    v_pk_mul_f32 v[206:207], v[14:15], v[206:207]
    v_pk_fma_f32 v[232:233], v[236:237], v[112:113], v[188:189] op_sel_hi:[1,0,1]
    v_pk_fma_f32 v[234:235], v[238:239], v[112:113], v[204:205] op_sel_hi:[1,0,1]
    v_pk_fma_f32 v[232:233], v[238:239], v[112:113], v[232:233] op_sel:[0,1,0] neg_lo:[1,0,0] neg_hi:[1,0,0]
    v_pk_fma_f32 v[234:235], v[236:237], v[112:113], v[234:235] op_sel:[0,1,0]
    v_pk_fma_f32 v[236:237], v[232:233], v[112:113], v[190:191] op_sel_hi:[1,0,1]
    v_pk_fma_f32 v[238:239], v[234:235], v[112:113], v[206:207] op_sel_hi:[1,0,1]
    v_pk_fma_f32 v[236:237], v[234:235], v[112:113], v[236:237] op_sel:[0,1,0] neg_lo:[1,0,0] neg_hi:[1,0,0]
    v_pk_fma_f32 v[238:239], v[232:233], v[112:113], v[238:239] op_sel:[0,1,0]
    v_mul_f32 v219, v104, v241
    v_fma_f32 v216, v100, v236, v237
    v_fma_f32 v217, v100, v238, v239
    v_fmac_f32_dpp v219, v241, v105 row_ror:8 row_mask:0xf bank_mask:0xf
    v_mov_b32_dpp v218, v241 quad_perm:[1,1,3,3] row_mask:0xf bank_mask:0xf
    v_fma_f32 v216, -v101, v238, v216
    v_fmac_f32 v217, v101, v236
    v_add_f32_dpp v218, v219, v218 quad_perm:[0,0,2,2] row_mask:0xf bank_mask:0xf
    v_mov_b64 v[224:225], v[216:217]
    v_mov_b32 v226, v218
    v_mov_b32 v231, s82
    v_permlane32_swap_b32 v216, v224
    v_permlane32_swap_b32 v217, v225
    v_permlane32_swap_b32 v218, v226
    v_mov_b64 v[220:221], v[216:217]
    v_mov_b32 v222, v218
    v_mov_b64 v[228:229], v[224:225]
    v_mov_b32 v230, v226

    v_permlane16_swap_b32 v218, v222
    v_permlane16_swap_b32 v216, v220
    v_permlane16_swap_b32 v217, v221
    v_permlane16_swap_b32 v226, v230
    v_fmac_f32_dpp v222, v218, v107 row_ror:8 row_mask:0xf bank_mask:0xf
    v_pk_fma_f32 v[220:221], v[216:217], v[102:103], v[220:221] op_sel_hi:[1,0,1]
    v_permlane16_swap_b32 v224, v228
    v_fmac_f32 v222, v106, v218
    v_pk_fma_f32 v[220:221], v[216:217], v[102:103], v[220:221] op_sel:[1,1,0] op_sel_hi:[0,1,1] neg_lo:[1,0,0]
    v_permlane16_swap_b32 v225, v229
    v_fmac_f32_dpp v226, v222, v107 row_ror:8 row_mask:0xf bank_mask:0xf
    v_fmac_f32 v226, v106, v222
    v_pk_fma_f32 v[224:225], v[220:221], v[102:103], v[224:225] op_sel_hi:[1,0,1]
    v_pk_fma_f32 v[224:225], v[220:221], v[102:103], v[224:225] op_sel:[1,1,0] op_sel_hi:[0,1,1] neg_lo:[1,0,0]
    v_fmac_f32_dpp v230, v226, v107 row_ror:8 row_mask:0xf bank_mask:0xf
    v_fmac_f32 v230, v106, v226
    v_pk_fma_f32 v[228:229], v[224:225], v[102:103], v[228:229] op_sel_hi:[1,0,1]
    v_pk_fma_f32 v[228:229], v[224:225], v[102:103], v[228:229] op_sel:[1,1,0] op_sel_hi:[0,1,1] neg_lo:[1,0,0]
    s_mov_b64 exec, 0xffff
    buffer_store_dwordx4 v[228:231], v153, s[92:95], s21 offen sc1
    s_mov_b64 exec, -1
    ds_write_b128 v243, v[248:251] offset:46880
    s_add_u32 m0, s84, 8192
    s_add_u32 s83, s17, 81920
    buffer_load_dwordx4 v159, s[56:59], s83 offen offset:0 lds
    ds_write_b128 v243, v[36:39] offset:51040
    buffer_load_dwordx4 v159, s[60:63], s83 offen offset:2048 lds
    ds_write_b128 v243, v[252:255] offset:30240
    ds_write_b128 v243, v[40:43] offset:34400
    s_waitcnt vmcnt(7)
    s_mul_i32 s3, s81, 8064
    s_lshl_b32 s4, s80, 7
    s_add_u32 s3, s3, s4
    s_add_u32 s3, s3, 8320
    v_add_u32 v166, s3, v164
    s_mul_i32 s3, s81, 4864
    s_sub_u32 s3, s3, s4
    s_sub_u32 s3, s3, 9344
    v_add_u32 v167, s3, v165
    v_add_u32 v48, 1024, v164
    v_add_u32 v49, 2048, v164
    v_add_u32 v50, 3072, v164
    s_waitcnt lgkmcnt(0)
    s_barrier
    ds_read2_b32 v[60:61], v164 offset0:128 offset1:129
    v_mov_b32 v219, 0
    ds_read2_b32 v[62:63], v164 offset0:130 offset1:131
    s_add_u32 s83, s83, 4096
    buffer_load_dwordx4 v159, s[56:59], s83 offen offset:1024 lds
    v_xor_b32 v128, v163, v128
    v_xor_b32 v130, v163, v130
    ds_read_b128 v[64:67], v165 offset:3136
    v_mov_b32_dpp v216, v220 quad_perm:[0,1,2,3] row_mask:4 bank_mask:0xf
    v_mov_b32_dpp v217, v221 quad_perm:[0,1,2,3] row_mask:4 bank_mask:0xf
    ds_read2_b32 v[68:69], v164 offset0:0 offset1:1
    v_mov_b32_dpp v218, v222 quad_perm:[0,1,2,3] row_mask:4 bank_mask:0xf
    v_mov_b32_dpp v216, v224 quad_perm:[0,1,2,3] row_mask:8 bank_mask:0xf
    ds_read2_b32 v[70:71], v164 offset0:2 offset1:3
    v_mov_b32_dpp v217, v225 quad_perm:[0,1,2,3] row_mask:8 bank_mask:0xf
    buffer_load_dwordx4 v159, s[60:63], s83 offen offset:3072 lds
    v_mov_b32_dpp v218, v226 quad_perm:[0,1,2,3] row_mask:8 bank_mask:0xf
    ds_read_b128 v[72:75], v165 offset:2624
    v_mov_b32_dpp v216, v219 quad_perm:[0,1,2,3] row_mask:1 bank_mask:0xf
    v_mov_b32_dpp v217, v219 quad_perm:[0,1,2,3] row_mask:1 bank_mask:0xf
    ds_read_b128 v[76:79], v165 offset:1600
    v_mov_b32_dpp v218, v219 quad_perm:[0,1,2,3] row_mask:1 bank_mask:0xf
    v_mul_f32_dpp v223, -v241, v129 row_ror:8 row_mask:0xf bank_mask:0xf
    ds_read_b128 v[80:83], v165 offset:3648
    v_fma_f32 v223, -v128, v241, v223
    v_mul_f32_dpp v252, -v218, v131 row_ror:8 row_mask:0xf bank_mask:0xf
    s_add_u32 m0, s84, 12288
    s_add_u32 s83, s44, 81920
    s_mov_b32 exec_hi, 0
    buffer_load_dwordx4 v159, s[56:59], s83 offen offset:0 lds
    s_mov_b32 exec_hi, -1
    ds_read_b128 v[84:87], v165 offset:1088
    v_pk_mul_f32 v[248:249], v[124:125], v[216:217] op_sel_hi:[1,0]
    v_pk_mul_f32 v[250:251], v[124:125], v[216:217] op_sel:[0,1]
    ds_read2_b32 v[88:89], v48 offset0:0 offset1:1
    v_pk_fma_f32 v[248:249], v[126:127], v[216:217], v[248:249] op_sel:[0,1,0] neg_lo:[1,0,0] neg_hi:[1,0,0]
    v_pk_fma_f32 v[250:251], v[126:127], v[216:217], v[250:251] op_sel_hi:[1,0,1]
    ds_read2_b32 v[90:91], v48 offset0:2 offset1:3
    v_fma_f32 v252, -v130, v218, v252
    v_fmac_f32 v249, v124, v236
    ds_read_b128 v[92:95], v165 offset:2112
    s_mov_b32 exec_hi, 0
    buffer_load_dwordx4 v159, s[60:63], s83 offen offset:2048 lds
    s_mov_b32 exec_hi, -1
    v_fmac_f32 v251, v124, v238
    v_fma_f32 v249, -v126, v238, v249
    ds_read2_b32 v[96:97], v49 offset0:0 offset1:1
    v_fmac_f32 v251, v126, v236
    v_mov_b32_dpp v219, v223 quad_perm:[0,0,2,2] row_mask:0xf bank_mask:0xf
    ds_read2_b32 v[98:99], v49 offset0:2 offset1:3
    s_mov_b32 exec_lo, 0xaaaaaaaa
    s_mov_b32 exec_hi, 0xaaaaaaaa
    v_add_f32 v252, v252, v219
    s_mov_b64 exec, -1
    v_lshrrev_b32 v29, 4, v152
    ds_read_b128 v[100:103], v165 offset:576
    v_and_b32 v253, 0xf0, v153
    s_add_u32 s83, s83, 4096
    s_mov_b32 exec_hi, 0
    buffer_load_dwordx4 v159, s[56:59], s83 offen offset:1024 lds
    s_mov_b32 exec_hi, -1
    v_lshl_add_u32 v253, v29, 11, v253
    ds_read2_b32 v[104:105], v48 offset0:128 offset1:129
    v_add_u32 v253, s21, v253
    v_lshlrev_b32 v29, 3, v29
    ds_read2_b32 v[106:107], v48 offset0:130 offset1:131
    v_sub_u32 v29, s79, v29
    v_med3_i32 v29, v29, 0, 8
    ds_read_b128 v[108:111], v165 offset:64
    v_mul_lo_u32 v254, v29, s82
    v_mul_f32_dpp v2, -v208, v129 row_ror:8 row_mask:0xf bank_mask:0xf
    s_mov_b32 exec_hi, 0
    buffer_load_dwordx4 v159, s[60:63], s83 offen offset:3072 lds
    s_mov_b32 exec_hi, -1
    v_lshrrev_b32 v159, 5, v152
    v_mul_u32_u24 v159, 5056, v159
    v_add_u32 v159, v158, v159
    ds_read2_b32 v[112:113], v49 offset0:128 offset1:129
    v_pk_mul_f32 v[0:1], v[176:177], v[126:127] op_sel_hi:[1,0]
    v_pk_mul_f32 v[176:177], v[176:177], v[124:125] op_sel_hi:[1,0]
    ds_read2_b32 v[114:115], v49 offset0:130 offset1:131
    v_pk_fma_f32 v[176:177], v[192:193], v[126:127], v[176:177] op_sel_hi:[1,0,1] neg_lo:[1,0,0] neg_hi:[1,0,0]
    v_pk_fma_f32 v[192:193], v[192:193], v[124:125], v[0:1] op_sel_hi:[1,0,1]
    ds_read2_b32 v[116:117], v50 offset0:0 offset1:1
    v_fma_f32 v208, -v128, v208, v2
    v_mul_f32_dpp v2, -v209, v129 row_ror:8 row_mask:0xf bank_mask:0xf
    ds_read2_b32 v[118:119], v50 offset0:2 offset1:3
    s_add_u32 m0, s84, 0
    s_add_u32 s83, s17, 0
    buffer_load_dwordx4 v158, s[56:59], s83 offen offset:0 lds
    v_pk_mul_f32 v[0:1], v[178:179], v[126:127] op_sel_hi:[1,0]
    v_pk_mul_f32 v[178:179], v[178:179], v[124:125] op_sel_hi:[1,0]
    ds_read2_b32 v[120:121], v50 offset0:128 offset1:129
    v_pk_fma_f32 v[178:179], v[194:195], v[126:127], v[178:179] op_sel_hi:[1,0,1] neg_lo:[1,0,0] neg_hi:[1,0,0]
    v_pk_fma_f32 v[194:195], v[194:195], v[124:125], v[0:1] op_sel_hi:[1,0,1]
    ds_read2_b32 v[122:123], v50 offset0:130 offset1:131
    v_fma_f32 v209, -v128, v209, v2
    v_mul_f32_dpp v2, -v210, v129 row_ror:8 row_mask:0xf bank_mask:0xf
    v_pk_mul_f32 v[0:1], v[180:181], v[126:127] op_sel_hi:[1,0]
    v_pk_mul_f32 v[180:181], v[180:181], v[124:125] op_sel_hi:[1,0]
    buffer_load_dwordx4 v158, s[60:63], s83 offen offset:2048 lds
    v_pk_fma_f32 v[180:181], v[196:197], v[126:127], v[180:181] op_sel_hi:[1,0,1] neg_lo:[1,0,0] neg_hi:[1,0,0]
    v_pk_fma_f32 v[196:197], v[196:197], v[124:125], v[0:1] op_sel_hi:[1,0,1]
    v_fma_f32 v210, -v128, v210, v2
    v_mul_f32_dpp v2, -v211, v129 row_ror:8 row_mask:0xf bank_mask:0xf
    v_pk_mul_f32 v[0:1], v[182:183], v[126:127] op_sel_hi:[1,0]
    v_pk_mul_f32 v[182:183], v[182:183], v[124:125] op_sel_hi:[1,0]
    v_pk_fma_f32 v[182:183], v[198:199], v[126:127], v[182:183] op_sel_hi:[1,0,1] neg_lo:[1,0,0] neg_hi:[1,0,0]
    v_pk_fma_f32 v[198:199], v[198:199], v[124:125], v[0:1] op_sel_hi:[1,0,1]
    v_fma_f32 v211, -v128, v211, v2
    v_mul_f32_dpp v2, -v212, v129 row_ror:8 row_mask:0xf bank_mask:0xf
    s_add_u32 s83, s83, 9216
    buffer_load_dwordx4 v158, s[56:59], s83 offen offset:1024 lds
    v_pk_mul_f32 v[0:1], v[184:185], v[126:127] op_sel_hi:[1,0]
    v_pk_mul_f32 v[184:185], v[184:185], v[124:125] op_sel_hi:[1,0]
    v_pk_fma_f32 v[184:185], v[200:201], v[126:127], v[184:185] op_sel_hi:[1,0,1] neg_lo:[1,0,0] neg_hi:[1,0,0]
    v_pk_fma_f32 v[200:201], v[200:201], v[124:125], v[0:1] op_sel_hi:[1,0,1]
    v_fma_f32 v212, -v128, v212, v2
    v_mul_f32_dpp v2, -v213, v129 row_ror:8 row_mask:0xf bank_mask:0xf
    v_pk_mul_f32 v[0:1], v[186:187], v[126:127] op_sel_hi:[1,0]
    v_pk_mul_f32 v[186:187], v[186:187], v[124:125] op_sel_hi:[1,0]
    v_pk_fma_f32 v[186:187], v[202:203], v[126:127], v[186:187] op_sel_hi:[1,0,1] neg_lo:[1,0,0] neg_hi:[1,0,0]
    v_pk_fma_f32 v[202:203], v[202:203], v[124:125], v[0:1] op_sel_hi:[1,0,1]
    buffer_load_dwordx4 v158, s[60:63], s83 offen offset:3072 lds
    v_fma_f32 v213, -v128, v213, v2
    v_mul_f32_dpp v2, -v214, v129 row_ror:8 row_mask:0xf bank_mask:0xf
    v_pk_mul_f32 v[0:1], v[188:189], v[126:127] op_sel_hi:[1,0]
    v_pk_mul_f32 v[188:189], v[188:189], v[124:125] op_sel_hi:[1,0]
    v_pk_fma_f32 v[188:189], v[204:205], v[126:127], v[188:189] op_sel_hi:[1,0,1] neg_lo:[1,0,0] neg_hi:[1,0,0]
    v_pk_fma_f32 v[204:205], v[204:205], v[124:125], v[0:1] op_sel_hi:[1,0,1]
    v_fma_f32 v214, -v128, v214, v2
    v_mul_f32_dpp v2, -v215, v129 row_ror:8 row_mask:0xf bank_mask:0xf
    v_pk_mul_f32 v[0:1], v[190:191], v[126:127] op_sel_hi:[1,0]
    v_pk_mul_f32 v[190:191], v[190:191], v[124:125] op_sel_hi:[1,0]
    v_pk_fma_f32 v[190:191], v[206:207], v[126:127], v[190:191] op_sel_hi:[1,0,1] neg_lo:[1,0,0] neg_hi:[1,0,0]
    v_pk_fma_f32 v[206:207], v[206:207], v[124:125], v[0:1] op_sel_hi:[1,0,1]
    v_fma_f32 v215, -v128, v215, v2
    v_add_u32 v129, 1024, v166
    v_add_u32 v130, 2048, v166
    v_add_u32 v131, 3072, v166
    s_cmp_lg_u32 s13, 0
    s_cbranch_scc1 Lv_1
    s_waitcnt lgkmcnt(15)
    s_waitcnt lgkmcnt(9)
    v_mfma_f32_16x16x32_bf16 v[44:47], v[68:71], v[100:103], 0
    buffer_load_dwordx4 v[244:247], v253, s[92:95], 0 offen offset:2048 sc1
    s_waitcnt vmcnt(14)
    v_lshrrev_b32 v29, 4, v152
    v_mul_u32_u24 v29, 640, v29
    v_mfma_f32_16x16x32_bf16 v[32:35], v[60:63], v[72:75], 0
    buffer_load_dwordx4 v[240:243], v253, s[92:95], 0 offen offset:1792 sc1
    ds_read_b128 a[200:203], v156 offset:4096
    v_add_u32 v30, v154, v29
    v_add_u32 v31, v155, v29
    s_waitcnt lgkmcnt(3)
    v_mfma_f32_16x16x32_bf16 v[32:35], v[116:119], v[108:111], v[32:35]
    ds_read_b64 v[4:5], v154 offset:9600
    ds_read_b64 v[6:7], v155 offset:9600
    ds_read_b64 v[8:9], v30 offset:5120
    ds_read_b64 v[10:11], v31 offset:5120
    buffer_load_dwordx4 v[236:239], v253, s[92:95], 0 offen offset:1536 sc1
    ds_read_b128 a[204:207], v157 offset:4096
    v_add_u32 v30, v30, v29
    v_add_u32 v31, v31, v29
    v_mfma_f32_16x16x32_bf16 v[32:35], v[68:71], v[64:67], v[32:35]
    buffer_load_dwordx4 v[232:235], v253, s[92:95], 0 offen offset:1280 sc1
    ds_read_b128 a[208:211], v156 offset:4608
    v_and_b32 v29, 1, v152
    v_mul_u32_u24 v29, 640, v29
    v_mfma_f32_16x16x32_bf16 v[36:39], v[60:63], v[64:67], 0
    ds_read_b128 v[64:67], v165 offset:3072
    buffer_load_dwordx4 v[228:231], v253, s[92:95], 0 offen offset:1024 sc1
    ds_read_b128 a[212:215], v157 offset:4608
    v_add_u32 v31, v31, v29
    v_mfma_f32_16x16x32_bf16 v[36:39], v[88:91], v[72:75], v[36:39]
    ds_read_b128 v[72:75], v165 offset:2560
    ds_read2_b32 v[12:13], v30 offset1:160
    ds_read2_b32 v[14:15], v30 offset0:1 offset1:161
    ds_read_b64 v[16:17], v31 offset:0
    buffer_load_dwordx4 v[224:227], v253, s[92:95], 0 offen offset:768 sc1
    s_waitcnt lgkmcnt(13)
    v_mfma_f32_16x16x32_bf16 v[36:39], v[120:123], v[108:111], v[36:39]
    ds_read2_b32 v[120:121], v50 offset0:144 offset1:145
    ds_read2_b32 v[122:123], v50 offset0:146 offset1:147
    ds_read_b64 v[18:19], v154 offset:7680
    ds_read_b64 v[20:21], v155 offset:7680
    buffer_load_dwordx4 v[220:223], v253, s[92:95], 0 offen offset:512 sc1
    v_mfma_f32_16x16x32_bf16 v[44:47], v[60:63], v[108:111], v[44:47]
    ds_read2_b32 v[60:61], v164 offset0:144 offset1:145
    ds_read2_b32 v[62:63], v164 offset0:146 offset1:147
    s_add_u32 s6, s100, 71680
    buffer_load_dwordx4 v[216:219], v253, s[92:95], 0 offen offset:256 sc1
    v_bfe_u32 v29, v152, 4, 1
    v_lshlrev_b32 v29, 6, v29
    v_mfma_f32_16x16x32_bf16 v[40:43], v[68:71], v[108:111], 0
    ds_read_b128 v[108:111], v165 offset:0
    s_waitcnt lgkmcnt(11)
    s_add_u32 m0, s84, 4096
    s_add_u32 s83, s17, 5120
    buffer_load_dwordx4 v158, s[56:59], s83 offen offset:0 lds
    v_xor_b32 v22, v29, v153
    v_add_u32 v22, s6, v22
    v_mfma_f32_16x16x32_bf16 v[36:39], v[68:71], v[80:83], v[36:39]
    ds_read2_b32 v[68:69], v164 offset0:16 offset1:17
    ds_read2_b32 v[70:71], v164 offset0:18 offset1:19
    ds_read_b128 v[80:83], v165 offset:3584
    v_and_b32 v24, 3, v152
    v_lshl_add_u32 v24, v24, 8, s6
    v_mfma_f32_16x16x32_bf16 v[32:35], v[88:91], v[92:95], v[32:35]
    ds_read2_b32 v[88:89], v48 offset0:16 offset1:17
    ds_read2_b32 v[90:91], v48 offset0:18 offset1:19
    v_lshl_add_u32 v24, v29, 1, v24
    v_bfe_u32 v29, v152, 2, 2
    v_mfma_f32_16x16x32_bf16 v[36:39], v[104:107], v[92:95], v[36:39]
    ds_read_b128 v[92:95], v165 offset:2048
    v_lshl_add_u32 v24, v29, 4, v24
    v_lshrrev_b32 v23, 5, v152
    v_mfma_f32_16x16x32_bf16 v[36:39], v[96:99], v[76:79], v[36:39]
    buffer_load_dwordx4 v158, s[60:63], s83 offen offset:2048 lds
    v_lshl_add_u32 v24, v23, 3, v24
    v_and_b32 v29, 1, v152
    v_mfma_f32_16x16x32_bf16 v[32:35], v[104:107], v[76:79], v[32:35]
    ds_read2_b32 v[104:105], v48 offset0:144 offset1:145
    ds_read2_b32 v[106:107], v48 offset0:146 offset1:147
    ds_read_b128 v[76:79], v165 offset:1536
    v_lshl_add_u32 v24, v29, 6, v24
    v_xor_b32 v25, 64, v24
    v_mfma_f32_16x16x32_bf16 v[36:39], v[112:115], v[84:87], v[36:39]
    s_lshl_b32 s3, s77, 10
    s_add_u32 s3, s3, 94016
    v_lshl_add_u32 v26, v29, 2, s3
    v_lshlrev_b32 v28, 5, v29
    v_mfma_f32_16x16x32_bf16 v[32:35], v[96:99], v[84:87], v[32:35]
    ds_read2_b32 v[96:97], v49 offset0:16 offset1:17
    ds_read2_b32 v[98:99], v49 offset0:18 offset1:19
    ds_read_b128 v[84:87], v165 offset:1024
    v_bfe_u32 v29, v152, 1, 3
    v_lshl_add_u32 v26, v29, 5, v26
    v_mfma_f32_16x16x32_bf16 v[36:39], v[116:119], v[100:103], v[36:39]
    ds_read2_b32 v[116:117], v50 offset0:16 offset1:17
    ds_read2_b32 v[118:119], v50 offset0:18 offset1:19
    s_add_u32 s83, s83, 9216
    buffer_load_dwordx4 v158, s[56:59], s83 offen offset:1024 lds
    v_and_b32 v29, 1, v29
    v_lshl_add_u32 v28, v29, 4, v28
    v_mfma_f32_16x16x32_bf16 v[32:35], v[112:115], v[100:103], v[32:35]
    ds_read2_b32 v[112:113], v49 offset0:144 offset1:145
    ds_read2_b32 v[114:115], v49 offset0:146 offset1:147
    ds_read_b128 v[100:103], v165 offset:512
    v_and_b32 v29, 0xc0, v153
    v_add_u32 v28, v29, v28
    s_waitcnt lgkmcnt(15)
    v_mfma_f32_16x16x32_bf16 v[32:35], v[60:63], v[72:75], v[32:35]
    v_lshrrev_b32 v29, 4, v152
    v_lshl_add_u32 v26, v29, 3, v26
    v_mfma_f32_16x16x32_bf16 v[40:43], v[68:71], v[108:111], v[40:43]
    v_lshl_add_u32 v27, v29, 7, s3
    v_lshl_add_u32 v27, v152, 3, v27
    s_waitcnt lgkmcnt(14)
    v_mfma_f32_16x16x32_bf16 v[36:39], v[68:71], v[80:83], v[36:39]
    ds_read_b128 v[80:83], v167 offset:3776
    buffer_load_dwordx4 v158, s[60:63], s83 offen offset:3072 lds
    v_mul_u32_u24 v29, 40960, v29
    v_add_u32 v28, v29, v28
    v_mfma_f32_16x16x32_bf16 v[32:35], v[68:71], v[64:67], v[32:35]
    v_xor_b32 v7, v163, v7
    v_xor_b32 v11, v163, v11
    v_mfma_f32_16x16x32_bf16 v[36:39], v[60:63], v[64:67], v[36:39]
    ds_read_b128 v[64:67], v167 offset:3264
    v_xor_b32 v16, v163, v16
    v_xor_b32 v21, v163, v21
    v_mfma_f32_16x16x32_bf16 v[44:47], v[60:63], v[108:111], v[44:47]
    ds_read2_b32 v[60:61], v166 offset0:128 offset1:129
    ds_read2_b32 v[62:63], v166 offset0:130 offset1:131
    s_lshl_b32 s3, s77, 10
    s_add_u32 s3, s3, 0
    v_add_u32 v170, s3, v153
    s_waitcnt lgkmcnt(15)
    v_mfma_f32_16x16x32_bf16 v[36:39], v[88:91], v[72:75], v[36:39]
    ds_read_b128 v[72:75], v167 offset:2752
    s_waitcnt lgkmcnt(11)
    v_mfma_f32_16x16x32_bf16 v[36:39], v[96:99], v[76:79], v[36:39]
    s_waitcnt lgkmcnt(8)
    v_mfma_f32_16x16x32_bf16 v[32:35], v[116:119], v[108:111], v[32:35]
    s_waitcnt lgkmcnt(5)
    v_mfma_f32_16x16x32_bf16 v[44:47], v[68:71], v[100:103], v[44:47]
    ds_read2_b32 v[68:69], v166 offset0:0 offset1:1
    ds_read2_b32 v[70:71], v166 offset0:2 offset1:3
    v_mfma_f32_16x16x32_bf16 v[32:35], v[104:107], v[76:79], v[32:35]
    ds_read_b128 v[76:79], v167 offset:1728
    v_mfma_f32_16x16x32_bf16 v[32:35], v[96:99], v[84:87], v[32:35]
    ds_read2_b32 v[96:97], v130 offset0:0 offset1:1
    ds_read2_b32 v[98:99], v130 offset0:2 offset1:3
    v_mfma_f32_16x16x32_bf16 v[36:39], v[112:115], v[84:87], v[36:39]
    ds_read_b128 v[84:87], v167 offset:1216
    v_mfma_f32_16x16x32_bf16 v[32:35], v[88:91], v[92:95], v[32:35]
    ds_read2_b32 v[88:89], v129 offset0:0 offset1:1
    ds_read2_b32 v[90:91], v129 offset0:2 offset1:3
    v_mfma_f32_16x16x32_bf16 v[36:39], v[120:123], v[108:111], v[36:39]
    ds_read_b128 v[108:111], v167 offset:192
    ds_read2_b32 v[120:121], v131 offset0:128 offset1:129
    ds_read2_b32 v[122:123], v131 offset0:130 offset1:131
    v_mfma_f32_16x16x32_bf16 v[36:39], v[104:107], v[92:95], v[36:39]
    ds_read_b128 v[92:95], v167 offset:2240
    ds_read2_b32 v[104:105], v129 offset0:128 offset1:129
    ds_read2_b32 v[106:107], v129 offset0:130 offset1:131
    v_mfma_f32_16x16x32_bf16 v[32:35], v[112:115], v[100:103], v[32:35]
    ds_read2_b32 v[112:113], v130 offset0:128 offset1:129
    ds_read2_b32 v[114:115], v130 offset0:130 offset1:131
    v_mfma_f32_16x16x32_bf16 v[36:39], v[116:119], v[100:103], v[36:39]
    ds_read_b128 v[100:103], v167 offset:704
    ds_read2_b32 v[116:117], v131 offset0:0 offset1:1
    ds_read2_b32 v[118:119], v131 offset0:2 offset1:3
    s_branch Lw_2
Lv_1:
    s_waitcnt lgkmcnt(15)
    v_mfma_f32_16x16x32_bf16 v[32:35], v[60:63], v[76:79], 0
    buffer_load_dwordx4 v[244:247], v253, s[92:95], 0 offen offset:2048 sc1
    s_waitcnt vmcnt(14)
    v_lshrrev_b32 v29, 4, v152
    v_mul_u32_u24 v29, 640, v29
    v_mfma_f32_16x16x32_bf16 v[44:47], v[60:63], v[84:87], 0
    buffer_load_dwordx4 v[240:243], v253, s[92:95], 0 offen offset:1792 sc1
    ds_read_b128 a[200:203], v156 offset:4096
    v_add_u32 v30, v154, v29
    v_add_u32 v31, v155, v29
    v_mfma_f32_16x16x32_bf16 v[36:39], v[68:71], v[72:75], 0
    ds_read_b128 v[72:75], v165 offset:2560
    ds_read_b128 v[64:67], v167 offset:3264
    ds_read_b128 v[80:83], v167 offset:3776
    ds_read2_b32 v[116:117], v131 offset0:0 offset1:1
    ds_read2_b32 v[118:119], v131 offset0:2 offset1:3
    ds_read2_b32 v[120:121], v131 offset0:128 offset1:129
    ds_read2_b32 v[122:123], v131 offset0:130 offset1:131
    buffer_load_dwordx4 v[236:239], v253, s[92:95], 0 offen offset:1536 sc1
    ds_read_b128 a[204:207], v157 offset:4096
    v_mfma_f32_16x16x32_bf16 v[44:47], v[68:71], v[76:79], v[44:47]
    ds_read_b64 v[4:5], v154 offset:9600
    ds_read_b64 v[6:7], v155 offset:9600
    ds_read_b64 v[8:9], v30 offset:5120
    ds_read_b64 v[10:11], v31 offset:5120
    buffer_load_dwordx4 v[232:235], v253, s[92:95], 0 offen offset:1280 sc1
    ds_read_b128 a[208:211], v156 offset:4608
    v_add_u32 v30, v30, v29
    v_add_u32 v31, v31, v29
    s_waitcnt lgkmcnt(15)
    v_mfma_f32_16x16x32_bf16 v[40:43], v[60:63], v[100:103], 0
    buffer_load_dwordx4 v[228:231], v253, s[92:95], 0 offen offset:1024 sc1
    ds_read_b128 a[212:215], v157 offset:4608
    v_and_b32 v29, 1, v152
    v_mul_u32_u24 v29, 640, v29
    v_mfma_f32_16x16x32_bf16 v[36:39], v[60:63], v[92:95], v[36:39]
    ds_read2_b32 v[60:61], v164 offset0:144 offset1:145
    ds_read2_b32 v[62:63], v164 offset0:146 offset1:147
    buffer_load_dwordx4 v[224:227], v253, s[92:95], 0 offen offset:768 sc1
    v_add_u32 v31, v31, v29
    v_mfma_f32_16x16x32_bf16 v[36:39], v[104:107], v[84:87], v[36:39]
    ds_read2_b32 v[12:13], v30 offset1:160
    ds_read2_b32 v[14:15], v30 offset0:1 offset1:161
    ds_read_b64 v[16:17], v31 offset:0
    ds_read_b64 v[18:19], v154 offset:7680
    buffer_load_dwordx4 v[220:223], v253, s[92:95], 0 offen offset:512 sc1
    v_mfma_f32_16x16x32_bf16 v[40:43], v[68:71], v[84:87], v[40:43]
    ds_read_b64 v[20:21], v155 offset:7680
    s_add_u32 s6, s100, 71680
    buffer_load_dwordx4 v[216:219], v253, s[92:95], 0 offen offset:256 sc1
    v_bfe_u32 v29, v152, 4, 1
    v_lshlrev_b32 v29, 6, v29
    v_mfma_f32_16x16x32_bf16 v[36:39], v[88:91], v[76:79], v[36:39]
    ds_read_b128 v[76:79], v165 offset:1536
    s_waitcnt lgkmcnt(8)
    s_add_u32 m0, s84, 4096
    s_add_u32 s83, s17, 5120
    buffer_load_dwordx4 v158, s[56:59], s83 offen offset:0 lds
    v_xor_b32 v22, v29, v153
    v_add_u32 v22, s6, v22
    v_mfma_f32_16x16x32_bf16 v[32:35], v[68:71], v[92:95], v[32:35]
    ds_read2_b32 v[68:69], v164 offset0:16 offset1:17
    ds_read2_b32 v[70:71], v164 offset0:18 offset1:19
    ds_read_b128 v[92:95], v165 offset:2048
    v_and_b32 v24, 3, v152
    v_lshl_add_u32 v24, v24, 8, s6
    v_mfma_f32_16x16x32_bf16 v[32:35], v[104:107], v[100:103], v[32:35]
    v_lshl_add_u32 v24, v29, 1, v24
    v_bfe_u32 v29, v152, 2, 2
    v_mfma_f32_16x16x32_bf16 v[40:43], v[88:91], v[108:111], v[40:43]
    v_lshl_add_u32 v24, v29, 4, v24
    v_lshrrev_b32 v23, 5, v152
    v_mfma_f32_16x16x32_bf16 v[32:35], v[88:91], v[84:87], v[32:35]
    ds_read_b128 v[84:87], v165 offset:1024
    buffer_load_dwordx4 v158, s[60:63], s83 offen offset:2048 lds
    v_lshl_add_u32 v24, v23, 3, v24
    v_and_b32 v29, 1, v152
    v_mfma_f32_16x16x32_bf16 v[36:39], v[96:99], v[100:103], v[36:39]
    v_lshl_add_u32 v24, v29, 6, v24
    v_xor_b32 v25, 64, v24
    v_mfma_f32_16x16x32_bf16 v[44:47], v[88:91], v[100:103], v[44:47]
    ds_read2_b32 v[88:89], v48 offset0:16 offset1:17
    ds_read2_b32 v[90:91], v48 offset0:18 offset1:19
    ds_read_b128 v[100:103], v165 offset:512
    s_lshl_b32 s3, s77, 10
    v_mfma_f32_16x16x32_bf16 v[32:35], v[96:99], v[108:111], v[32:35]
    ds_read2_b32 v[96:97], v49 offset0:16 offset1:17
    ds_read2_b32 v[98:99], v49 offset0:18 offset1:19
    s_add_u32 s3, s3, 94016
    v_lshl_add_u32 v26, v29, 2, s3
    v_lshlrev_b32 v28, 5, v29
    v_mfma_f32_16x16x32_bf16 v[36:39], v[112:115], v[108:111], v[36:39]
    ds_read2_b32 v[112:113], v49 offset0:144 offset1:145
    ds_read2_b32 v[114:115], v49 offset0:146 offset1:147
    s_add_u32 s83, s83, 9216
    buffer_load_dwordx4 v158, s[56:59], s83 offen offset:1024 lds
    v_bfe_u32 v29, v152, 1, 3
    v_lshl_add_u32 v26, v29, 5, v26
    v_mfma_f32_16x16x32_bf16 v[44:47], v[104:107], v[108:111], v[44:47]
    ds_read2_b32 v[104:105], v48 offset0:144 offset1:145
    ds_read2_b32 v[106:107], v48 offset0:146 offset1:147
    ds_read_b128 v[108:111], v165 offset:0
    v_and_b32 v29, 1, v29
    v_lshl_add_u32 v28, v29, 4, v28
    s_waitcnt lgkmcnt(15)
    s_waitcnt lgkmcnt(14)
    v_mfma_f32_16x16x32_bf16 v[32:35], v[60:63], v[76:79], v[32:35]
    v_and_b32 v29, 0xc0, v153
    v_add_u32 v28, v29, v28
    s_waitcnt lgkmcnt(12)
    v_mfma_f32_16x16x32_bf16 v[36:39], v[68:71], v[72:75], v[36:39]
    ds_read_b128 v[72:75], v167 offset:2752
    v_lshrrev_b32 v29, 4, v152
    v_lshl_add_u32 v26, v29, 3, v26
    s_waitcnt lgkmcnt(12)
    v_mfma_f32_16x16x32_bf16 v[32:35], v[68:71], v[92:95], v[32:35]
    buffer_load_dwordx4 v158, s[60:63], s83 offen offset:3072 lds
    v_lshl_add_u32 v27, v29, 7, s3
    v_lshl_add_u32 v27, v152, 3, v27
    v_mfma_f32_16x16x32_bf16 v[36:39], v[60:63], v[92:95], v[36:39]
    ds_read_b128 v[92:95], v167 offset:2240
    v_mul_u32_u24 v29, 40960, v29
    v_add_u32 v28, v29, v28
    s_waitcnt lgkmcnt(12)
    v_mfma_f32_16x16x32_bf16 v[40:43], v[68:71], v[84:87], v[40:43]
    v_xor_b32 v7, v163, v7
    v_xor_b32 v11, v163, v11
    v_mfma_f32_16x16x32_bf16 v[44:47], v[68:71], v[76:79], v[44:47]
    ds_read2_b32 v[68:69], v166 offset0:0 offset1:1
    ds_read2_b32 v[70:71], v166 offset0:2 offset1:3
    v_xor_b32 v16, v163, v16
    v_xor_b32 v21, v163, v21
    s_waitcnt lgkmcnt(12)
    v_mfma_f32_16x16x32_bf16 v[36:39], v[88:91], v[76:79], v[36:39]
    ds_read_b128 v[76:79], v167 offset:1728
    s_lshl_b32 s3, s77, 10
    s_add_u32 s3, s3, 0
    v_add_u32 v170, s3, v153
    v_mfma_f32_16x16x32_bf16 v[44:47], v[60:63], v[84:87], v[44:47]
    s_waitcnt lgkmcnt(12)
    v_mfma_f32_16x16x32_bf16 v[40:43], v[60:63], v[100:103], v[40:43]
    ds_read2_b32 v[60:61], v166 offset0:128 offset1:129
    ds_read2_b32 v[62:63], v166 offset0:130 offset1:131
    v_mfma_f32_16x16x32_bf16 v[44:47], v[88:91], v[100:103], v[44:47]
    s_waitcnt lgkmcnt(8)
    s_waitcnt lgkmcnt(7)
    v_mfma_f32_16x16x32_bf16 v[44:47], v[104:107], v[108:111], v[44:47]
    v_mfma_f32_16x16x32_bf16 v[40:43], v[88:91], v[108:111], v[40:43]
    v_mfma_f32_16x16x32_bf16 v[32:35], v[88:91], v[84:87], v[32:35]
    ds_read2_b32 v[88:89], v129 offset0:0 offset1:1
    ds_read2_b32 v[90:91], v129 offset0:2 offset1:3
    v_mfma_f32_16x16x32_bf16 v[36:39], v[104:107], v[84:87], v[36:39]
    ds_read_b128 v[84:87], v167 offset:1216
    v_mfma_f32_16x16x32_bf16 v[32:35], v[96:99], v[108:111], v[32:35]
    v_mfma_f32_16x16x32_bf16 v[32:35], v[104:107], v[100:103], v[32:35]
    ds_read2_b32 v[104:105], v129 offset0:128 offset1:129
    ds_read2_b32 v[106:107], v129 offset0:130 offset1:131
    v_mfma_f32_16x16x32_bf16 v[36:39], v[112:115], v[108:111], v[36:39]
    ds_read_b128 v[108:111], v167 offset:192
    ds_read2_b32 v[112:113], v130 offset0:128 offset1:129
    ds_read2_b32 v[114:115], v130 offset0:130 offset1:131
    v_mfma_f32_16x16x32_bf16 v[36:39], v[96:99], v[100:103], v[36:39]
    ds_read2_b32 v[96:97], v130 offset0:0 offset1:1
    ds_read2_b32 v[98:99], v130 offset0:2 offset1:3
    ds_read_b128 v[100:103], v167 offset:704
Lw_2:
L_cchk0:
    s_waitcnt vmcnt(10)
    v_fmac_f32_dpp v242, v246, v7 row_ror:8 row_mask:0xf bank_mask:0xf
    v_fmac_f32 v242, v6, v246
    v_pk_fma_f32 v[240:241], v[244:245], v[4:5], v[240:241] op_sel_hi:[1,0,1]
    v_pk_fma_f32 v[240:241], v[244:245], v[4:5], v[240:241] op_sel:[1,1,0] op_sel_hi:[0,1,1] neg_lo:[1,0,0]
    ds_write_b128 v170, v[32:35] offset:0
    s_waitcnt vmcnt(9)
    v_add3_u32 v169, v247, v243, v239
    v_fmac_f32_dpp v238, v242, v7 row_ror:8 row_mask:0xf bank_mask:0xf
    v_fmac_f32 v238, v6, v242
    v_pk_fma_f32 v[236:237], v[240:241], v[4:5], v[236:237] op_sel_hi:[1,0,1]
    v_pk_fma_f32 v[236:237], v[240:241], v[4:5], v[236:237] op_sel:[1,1,0] op_sel_hi:[0,1,1] neg_lo:[1,0,0]
    s_waitcnt vmcnt(8)
    v_fmac_f32_dpp v234, v238, v7 row_ror:8 row_mask:0xf bank_mask:0xf
    v_fmac_f32 v234, v6, v238
    v_pk_fma_f32 v[232:233], v[236:237], v[4:5], v[232:233] op_sel_hi:[1,0,1]
    v_pk_fma_f32 v[232:233], v[236:237], v[4:5], v[232:233] op_sel:[1,1,0] op_sel_hi:[0,1,1] neg_lo:[1,0,0]
    ds_write_b128 v170, v[36:39] offset:4096
    s_waitcnt vmcnt(7)
    v_add3_u32 v169, v169, v235, v231
    v_fmac_f32_dpp v230, v234, v7 row_ror:8 row_mask:0xf bank_mask:0xf
    v_fmac_f32 v230, v6, v234
    v_pk_fma_f32 v[228:229], v[232:233], v[4:5], v[228:229] op_sel_hi:[1,0,1]
    v_pk_fma_f32 v[228:229], v[232:233], v[4:5], v[228:229] op_sel:[1,1,0] op_sel_hi:[0,1,1] neg_lo:[1,0,0]
    s_waitcnt vmcnt(6)
    v_fmac_f32_dpp v226, v230, v7 row_ror:8 row_mask:0xf bank_mask:0xf
    v_fmac_f32 v226, v6, v230
    v_pk_fma_f32 v[224:225], v[228:229], v[4:5], v[224:225] op_sel_hi:[1,0,1]
    v_pk_fma_f32 v[224:225], v[228:229], v[4:5], v[224:225] op_sel:[1,1,0] op_sel_hi:[0,1,1] neg_lo:[1,0,0]
    ds_write_b128 v170, v[40:43] offset:8192
    s_waitcnt vmcnt(5)
    v_add3_u32 v169, v169, v227, v223
    v_fmac_f32_dpp v222, v226, v7 row_ror:8 row_mask:0xf bank_mask:0xf
    v_fmac_f32 v222, v6, v226
    v_pk_fma_f32 v[220:221], v[224:225], v[4:5], v[220:221] op_sel_hi:[1,0,1]
    v_pk_fma_f32 v[220:221], v[224:225], v[4:5], v[220:221] op_sel:[1,1,0] op_sel_hi:[0,1,1] neg_lo:[1,0,0]
    s_waitcnt vmcnt(4)
    v_add_u32 v169, v169, v219
    v_cmp_ne_u32 vcc, v169, v254
    v_fmac_f32_dpp v218, v222, v7 row_ror:8 row_mask:0xf bank_mask:0xf
    v_fmac_f32 v218, v6, v222
    v_pk_fma_f32 v[216:217], v[220:221], v[4:5], v[216:217] op_sel_hi:[1,0,1]
    v_pk_fma_f32 v[216:217], v[220:221], v[4:5], v[216:217] op_sel:[1,1,0] op_sel_hi:[0,1,1] neg_lo:[1,0,0]
    ds_write_b128 v170, v[44:47] offset:12288
    s_cbranch_vccnz L_cre0
    v_mul_f32_dpp v222, v218, v11 row_ror:8 row_mask:0xf bank_mask:0xf
    v_pk_mul_f32 v[220:221], v[216:217], v[8:9] op_sel_hi:[1,0]
    v_fmac_f32 v222, v10, v218
    v_pk_fma_f32 v[220:221], v[216:217], v[8:9], v[220:221] op_sel:[1,1,0] op_sel_hi:[0,1,1] neg_lo:[1,0,0]

    v_mov_b32 v226, v222
    v_mov_b64 v[224:225], v[220:221]
    s_nop 0
    v_permlane32_swap_b32 v222, v226
    v_permlane32_swap_b32 v220, v224
    v_permlane32_swap_b32 v221, v225
    v_add_f32 v222, v222, v226
    v_pk_add_f32 v[220:221], v[220:221], v[224:225]

    v_mov_b32 v226, v222
    v_mov_b64 v[224:225], v[220:221]
    s_nop 0
    v_permlane16_swap_b32 v222, v226
    v_permlane16_swap_b32 v220, v224
    v_permlane16_swap_b32 v221, v225
    v_add_f32 v222, v222, v226
    v_pk_add_f32 v[220:221], v[220:221], v[224:225]

    v_fma_f32 v252, -v16, v222, v252
    v_pk_fma_f32 v[248:249], v[12:13], v[220:221], v[248:249] op_sel_hi:[1,0,1]
    v_pk_fma_f32 v[250:251], v[12:13], v[220:221], v[250:251] op_sel:[0,1,0]
    v_fmac_f32_dpp v252, -v222, v17 row_ror:8 row_mask:0xf bank_mask:0xf
    v_pk_fma_f32 v[248:249], v[14:15], v[220:221], v[248:249] op_sel:[0,1,0] neg_lo:[1,0,0] neg_hi:[1,0,0]
    v_pk_fma_f32 v[250:251], v[14:15], v[220:221], v[250:251] op_sel_hi:[1,0,1]

    v_fmac_f32_dpp v208, -v252, v21 row_ror:8 row_mask:0xf bank_mask:0xf
    v_fmac_f32 v208, v20, v252
    v_pk_fma_f32 v[176:177], v[248:249], v[18:19], v[176:177] op_sel_hi:[1,0,1]
    v_pk_fma_f32 v[192:193], v[250:251], v[18:19], v[192:193] op_sel_hi:[1,0,1]
    v_fmac_f32_dpp v209, -v208, v21 row_ror:8 row_mask:0xf bank_mask:0xf
    v_fmac_f32 v209, v20, v208
    v_pk_fma_f32 v[176:177], v[250:251], v[18:19], v[176:177] op_sel:[0,1,0] neg_lo:[1,0,0] neg_hi:[1,0,0]
    v_pk_fma_f32 v[192:193], v[248:249], v[18:19], v[192:193] op_sel:[0,1,0]
    v_fmac_f32_dpp v210, -v209, v21 row_ror:8 row_mask:0xf bank_mask:0xf
    v_fmac_f32 v210, v20, v209
    v_pk_fma_f32 v[178:179], v[176:177], v[18:19], v[178:179] op_sel_hi:[1,0,1]
    v_pk_fma_f32 v[194:195], v[192:193], v[18:19], v[194:195] op_sel_hi:[1,0,1]
    v_fmac_f32_dpp v211, -v210, v21 row_ror:8 row_mask:0xf bank_mask:0xf
    v_fmac_f32 v211, v20, v210
    v_pk_fma_f32 v[178:179], v[192:193], v[18:19], v[178:179] op_sel:[0,1,0] neg_lo:[1,0,0] neg_hi:[1,0,0]
    v_pk_fma_f32 v[194:195], v[176:177], v[18:19], v[194:195] op_sel:[0,1,0]
    v_cvt_pk_bf16_f32 v232, v176, v177
    v_cvt_pk_bf16_f32 v233, v178, v179
    v_cvt_pk_bf16_f32 v234, -v192, -v193
    v_cvt_pk_bf16_f32 v235, -v194, -v195

    ds_write_b128 v22, v[232:235] offset:0
    ds_read_b64_tr_b16 v[216:217], v24 offset:0
    ds_read_b64_tr_b16 v[218:219], v25 offset:0
    v_fmac_f32_dpp v212, -v211, v21 row_ror:8 row_mask:0xf bank_mask:0xf
    v_fmac_f32 v212, v20, v211
    v_pk_fma_f32 v[180:181], v[178:179], v[18:19], v[180:181] op_sel_hi:[1,0,1]
    v_pk_fma_f32 v[196:197], v[194:195], v[18:19], v[196:197] op_sel_hi:[1,0,1]
    v_fmac_f32_dpp v213, -v212, v21 row_ror:8 row_mask:0xf bank_mask:0xf
    v_fmac_f32 v213, v20, v212
    v_pk_fma_f32 v[180:181], v[194:195], v[18:19], v[180:181] op_sel:[0,1,0] neg_lo:[1,0,0] neg_hi:[1,0,0]
    v_pk_fma_f32 v[196:197], v[178:179], v[18:19], v[196:197] op_sel:[0,1,0]
    v_fmac_f32_dpp v214, -v213, v21 row_ror:8 row_mask:0xf bank_mask:0xf
    v_fmac_f32 v214, v20, v213
    v_pk_fma_f32 v[182:183], v[180:181], v[18:19], v[182:183] op_sel_hi:[1,0,1]
    v_pk_fma_f32 v[198:199], v[196:197], v[18:19], v[198:199] op_sel_hi:[1,0,1]
    v_fmac_f32_dpp v215, -v214, v21 row_ror:8 row_mask:0xf bank_mask:0xf
    v_fmac_f32 v215, v20, v214
    v_pk_fma_f32 v[182:183], v[196:197], v[18:19], v[182:183] op_sel:[0,1,0] neg_lo:[1,0,0] neg_hi:[1,0,0]
    v_pk_fma_f32 v[198:199], v[180:181], v[18:19], v[198:199] op_sel:[0,1,0]
    v_cvt_pk_bf16_f32 v236, v180, v181
    v_cvt_pk_bf16_f32 v237, v182, v183
    v_cvt_pk_bf16_f32 v238, -v196, -v197
    v_cvt_pk_bf16_f32 v239, -v198, -v199

    ds_write_b128 v22, v[236:239] offset:1024
    ds_read_b64_tr_b16 v[220:221], v24 offset:1024
    ds_read_b64_tr_b16 v[222:223], v25 offset:1024
    v_pk_fma_f32 v[184:185], v[182:183], v[18:19], v[184:185] op_sel_hi:[1,0,1]
    v_pk_fma_f32 v[200:201], v[198:199], v[18:19], v[200:201] op_sel_hi:[1,0,1]
    v_pk_fma_f32 v[184:185], v[198:199], v[18:19], v[184:185] op_sel:[0,1,0] neg_lo:[1,0,0] neg_hi:[1,0,0]
    v_pk_fma_f32 v[200:201], v[182:183], v[18:19], v[200:201] op_sel:[0,1,0]
    v_cvt_pk_bf16_f32 v240, v208, v209
    v_cvt_pk_bf16_f32 v241, v210, v211
    v_cvt_pk_bf16_f32 v242, v212, v213
    v_cvt_pk_bf16_f32 v243, v214, v215
    ds_write2st64_b32 v26, v240, v241 offset0:0 offset1:1
    ds_write2st64_b32 v26, v242, v243 offset0:2 offset1:3
    ds_read_b64_tr_b16 v[244:245], v27 offset:0
    ds_read_b64_tr_b16 v[246:247], v27 offset:128
    v_pk_fma_f32 v[186:187], v[184:185], v[18:19], v[186:187] op_sel_hi:[1,0,1]
    v_pk_fma_f32 v[202:203], v[200:201], v[18:19], v[202:203] op_sel_hi:[1,0,1]
    v_pk_fma_f32 v[186:187], v[200:201], v[18:19], v[186:187] op_sel:[0,1,0] neg_lo:[1,0,0] neg_hi:[1,0,0]
    v_pk_fma_f32 v[202:203], v[184:185], v[18:19], v[202:203] op_sel:[0,1,0]
    v_cvt_pk_bf16_f32 v232, v184, v185
    v_cvt_pk_bf16_f32 v233, v186, v187
    v_cvt_pk_bf16_f32 v234, -v200, -v201
    v_cvt_pk_bf16_f32 v235, -v202, -v203

    ds_write_b128 v22, v[232:235] offset:0
    ds_read_b64_tr_b16 v[224:225], v24 offset:0
    ds_read_b64_tr_b16 v[226:227], v25 offset:0
    s_waitcnt lgkmcnt(10)
    v_and_b32 v216, -2, v216
    v_and_b32 v218, -2, v218
    s_cmp_eq_u32 s88, 0
    s_cbranch_scc1 Lss_3
    buffer_store_dwordx4 v[216:219], v153, s[64:67], s36 offen
Lsd_4:
    v_pk_fma_f32 v[188:189], v[186:187], v[18:19], v[188:189] op_sel_hi:[1,0,1]
    v_pk_fma_f32 v[204:205], v[202:203], v[18:19], v[204:205] op_sel_hi:[1,0,1]
    v_pk_fma_f32 v[188:189], v[202:203], v[18:19], v[188:189] op_sel:[0,1,0] neg_lo:[1,0,0] neg_hi:[1,0,0]
    v_pk_fma_f32 v[204:205], v[186:187], v[18:19], v[204:205] op_sel:[0,1,0]
    v_pk_fma_f32 v[190:191], v[188:189], v[18:19], v[190:191] op_sel_hi:[1,0,1]
    v_pk_fma_f32 v[206:207], v[204:205], v[18:19], v[206:207] op_sel_hi:[1,0,1]
    v_pk_fma_f32 v[190:191], v[204:205], v[18:19], v[190:191] op_sel:[0,1,0] neg_lo:[1,0,0] neg_hi:[1,0,0]
    v_pk_fma_f32 v[206:207], v[188:189], v[18:19], v[206:207] op_sel:[0,1,0]
    v_cvt_pk_bf16_f32 v236, v188, v189
    v_cvt_pk_bf16_f32 v237, v190, v191
    v_cvt_pk_bf16_f32 v238, -v204, -v205
    v_cvt_pk_bf16_f32 v239, -v206, -v207

    ds_write_b128 v22, v[236:239] offset:1024
    ds_read_b64_tr_b16 v[228:229], v24 offset:1024
    ds_read_b64_tr_b16 v[230:231], v25 offset:1024
    s_waitcnt lgkmcnt(10)
    v_and_b32 v220, -2, v220
    v_and_b32 v222, -2, v222
    s_cmp_eq_u32 s88, 0
    s_cbranch_scc1 Lss_5
    buffer_store_dwordx4 v[220:223], v153, s[64:67], s18 offen
Lsd_6:
    s_waitcnt lgkmcnt(6)
    v_and_or_b32 v244, v244, -2, v23
    v_and_or_b32 v246, v246, -2, v23
    s_cmp_eq_u32 s88, 0
    s_cbranch_scc1 Lss_7
    buffer_store_dwordx2 v[244:245], v28, s[64:67], s37 offen offset:0
    buffer_store_dwordx2 v[246:247], v28, s[64:67], s37 offen offset:512
Lsd_8:
    s_waitcnt lgkmcnt(3)
    v_or_b32 v224, 1, v224
    v_or_b32 v226, 1, v226
    s_cmp_eq_u32 s88, 0
    s_cbranch_scc1 Lss_9
    buffer_store_dwordx4 v[224:227], v153, s[64:67], s19 offen
Lsd_10:
    s_waitcnt lgkmcnt(0)
    v_or_b32 v228, 1, v228
    v_or_b32 v230, 1, v230
    s_cmp_eq_u32 s88, 0
    s_cbranch_scc1 Lss_11
    buffer_store_dwordx4 v[228:231], v153, s[64:67], s20 offen
Lsd_12:
    v_mfma_f32_16x16x32_bf16 v[28:31], v[60:63], v[64:67], 0
    v_and_b32 v172, 15, v152
    v_lshrrev_b32 v164, 4, v152
    v_mfma_f32_16x16x32_bf16 v[20:23], v[68:71], v[72:75], 0
    ds_read_b128 a[216:219], v156 offset:8192
    s_lshl_b32 s8, s79, 13
    s_and_b32 s7, s91, 31
    s_lshl_b32 s7, s7, 2
    s_add_u32 s8, s8, 11272192
    s_add_u32 s7, s7, s8
    v_lshlrev_b32 v164, 3, v164
    v_lshl_add_u32 v164, v172, 5, v164
    v_mfma_f32_16x16x32_bf16 v[16:19], v[60:63], v[76:79], 0
    ds_read_b128 a[220:223], v157 offset:8192
    v_xor_b32 v172, 8, v164
    v_mov_b32 v169, s7
    v_mfma_f32_16x16x32_bf16 v[12:15], v[68:71], v[76:79], 0
    ds_read_b128 a[224:227], v156 offset:8704
    s_lshl_b32 s6, s77, 12
    s_add_u32 s6, s6, 0
    v_add_u32 v170, s6, v153
    v_mov_b32 v173, s82
    v_mfma_f32_16x16x32_bf16 v[28:31], v[68:71], v[80:83], v[28:31]
    ds_read_b128 v[80:83], v167 offset:3712
    ds_read_b128 a[228:231], v157 offset:8704
    s_add_u32 s3, s40, 26112
    v_add_u32 v171, s3, v172
    v_mfma_f32_16x16x32_bf16 v[8:11], v[68:71], v[84:87], 0
    v_mfma_f32_16x16x32_bf16 v[16:19], v[88:91], v[84:87], v[16:19]
    s_mov_b32 s13, 40960
    v_mfma_f32_16x16x32_bf16 v[20:23], v[60:63], v[92:95], v[20:23]
    s_mul_i32 s5, s77, 40960
    s_lshl_b32 s22, s16, 5
    v_mfma_f32_16x16x32_bf16 v[28:31], v[88:91], v[72:75], v[28:31]
    s_waitcnt lgkmcnt(0)
    s_add_u32 m0, s84, 8192
    s_add_u32 s83, s17, 40960
    buffer_load_dwordx4 v158, s[56:59], s83 offen offset:0 lds
    v_mfma_f32_16x16x32_bf16 v[24:27], v[68:71], v[64:67], 0
    ds_read_b128 v[64:67], v167 offset:3200
    s_add_u32 s22, s22, s5
    v_mfma_f32_16x16x32_bf16 v[16:19], v[68:71], v[92:95], v[16:19]
    s_lshl_b32 s23, s17, 5
    v_mfma_f32_16x16x32_bf16 v[28:31], v[96:99], v[76:79], v[28:31]
    s_add_u32 s23, s23, s5
    s_lshl_b32 s24, s44, 5
    v_mfma_f32_16x16x32_bf16 v[12:15], v[60:63], v[84:87], v[12:15]
    buffer_load_dwordx4 v158, s[60:63], s83 offen offset:2048 lds
    v_mfma_f32_16x16x32_bf16 v[24:27], v[88:91], v[92:95], v[24:27]
    ds_read_b128 a[248:251], v156 offset:12288
    v_mfma_f32_16x16x32_bf16 v[8:11], v[60:63], v[100:103], v[8:11]
    ds_read_b128 a[252:255], v157 offset:12288
    s_barrier
    v_mfma_f32_16x16x32_bf16 v[20:23], v[88:91], v[76:79], v[20:23]
    ds_read_b128 v[32:35], v170 offset:0
    s_add_u32 s24, s24, s5
    v_mfma_f32_16x16x32_bf16 v[12:15], v[88:91], v[100:103], v[12:15]
    s_add_u32 s83, s83, 9216
    buffer_load_dwordx4 v158, s[56:59], s83 offen offset:1024 lds
    ds_read_b128 v[36:39], v170 offset:1024
    v_mfma_f32_16x16x32_bf16 v[24:27], v[60:63], v[72:75], v[24:27]
    ds_read_b128 v[72:75], v167 offset:2688
    ds_read_b128 v[40:43], v170 offset:2048
    v_mfma_f32_16x16x32_bf16 v[24:27], v[104:107], v[76:79], v[24:27]
    ds_read_b128 v[76:79], v167 offset:1664
    ds_read_b128 v[44:47], v170 offset:3072
    v_mfma_f32_16x16x32_bf16 v[4:7], v[60:63], v[108:111], 0
    ds_read2_b32 v[60:61], v166 offset0:144 offset1:145
    ds_read2_b32 v[62:63], v166 offset0:146 offset1:147
    ds_read_b64 v[48:49], v171
    v_mfma_f32_16x16x32_bf16 v[4:7], v[68:71], v[100:103], v[4:7]
    buffer_load_dwordx4 v158, s[60:63], s83 offen offset:3072 lds
    s_add_u32 s3, s40, s15
    s_add_u32 s3, s3, 3145728
    v_add_u32 v171, s3, v164
    v_and_b32 v57, 8, v164
    v_mfma_f32_16x16x32_bf16 v[0:3], v[68:71], v[108:111], 0
    ds_read2_b32 v[68:69], v166 offset0:16 offset1:17
    ds_read2_b32 v[70:71], v166 offset0:18 offset1:19
    v_and_b32 v164, 0x1f0, v164
    v_lshl_add_u32 v164, v57, 6, v164
    v_mfma_f32_16x16x32_bf16 v[28:31], v[112:115], v[84:87], v[28:31]
    v_mfma_f32_16x16x32_bf16 v[28:31], v[116:119], v[100:103], v[28:31]
    s_cmp_eq_u32 s77, 3
    s_cselect_b32 s5, -122880, s13
    v_mfma_f32_16x16x32_bf16 v[24:27], v[96:99], v[84:87], v[24:27]
    s_waitcnt lgkmcnt(11)
    s_add_u32 m0, s84, 12288
    s_add_u32 s83, s17, 46080
    buffer_load_dwordx4 v158, s[56:59], s83 offen offset:0 lds
    v_mfma_f32_16x16x32_bf16 v[20:23], v[104:107], v[84:87], v[20:23]
    ds_read_b128 v[84:87], v167 offset:1152
    s_waitcnt lgkmcnt(6)
    v_add_f32 v32, v32, v36
    v_add_f32 v33, v33, v37
    v_mfma_f32_16x16x32_bf16 v[8:11], v[88:91], v[108:111], v[8:11]
    ds_read2_b32 v[88:89], v129 offset0:16 offset1:17
    ds_read2_b32 v[90:91], v129 offset0:18 offset1:19
    v_add_f32 v34, v34, v38
    v_add_f32 v35, v35, v39
    v_mfma_f32_16x16x32_bf16 v[28:31], v[104:107], v[92:95], v[28:31]
    ds_read_b128 v[92:95], v167 offset:2176
    v_add_f32 v40, v40, v44
    v_add_f32 v41, v41, v45
    v_mfma_f32_16x16x32_bf16 v[20:23], v[112:115], v[108:111], v[20:23]
    buffer_load_dwordx4 v158, s[60:63], s83 offen offset:2048 lds
    v_add_f32 v42, v42, v46
    v_add_f32 v43, v43, v47
    v_mfma_f32_16x16x32_bf16 v[16:19], v[96:99], v[108:111], v[16:19]
    ds_read_b128 a[232:235], v156 offset:0
    v_add_f32 v32, v32, v40
    v_add_f32 v33, v33, v41
    v_mfma_f32_16x16x32_bf16 v[24:27], v[116:119], v[108:111], v[24:27]
    ds_read2_b32 v[116:117], v131 offset0:16 offset1:17
    ds_read2_b32 v[118:119], v131 offset0:18 offset1:19
    ds_read_b128 a[236:239], v157 offset:0
    s_waitcnt vmcnt(6)
    s_cmp_eq_u32 s88, 0
    s_cbranch_scc1 Lss_13
    global_store_dword v169, v173, s[50:51]
Lsd_14:
    v_add_f32 v34, v34, v42
    v_add_f32 v35, v35, v43
    v_mfma_f32_16x16x32_bf16 v[20:23], v[96:99], v[100:103], v[20:23]
    ds_read2_b32 v[96:97], v130 offset0:16 offset1:17
    ds_read2_b32 v[98:99], v130 offset0:18 offset1:19
    ds_read_b128 a[240:243], v156 offset:512
    v_and_b32 v173, 31, v152
    v_lshl_add_u32 v173, v173, 2, s8
    v_mfma_f32_16x16x32_bf16 v[16:19], v[104:107], v[100:103], v[16:19]
    s_add_u32 s83, s83, 9216
    buffer_load_dwordx4 v158, s[56:59], s83 offen offset:1024 lds
    ds_read_b128 a[244:247], v157 offset:512
    v_mfma_f32_16x16x32_bf16 v[12:15], v[104:107], v[108:111], v[12:15]
    ds_read2_b32 v[104:105], v129 offset0:144 offset1:145
    ds_read2_b32 v[106:107], v129 offset0:146 offset1:147
    s_waitcnt lgkmcnt(15)
    v_and_b32 v36, s86, v49
    v_lshlrev_b32 v37, 16, v49
    v_mfma_f32_16x16x32_bf16 v[24:27], v[112:115], v[100:103], v[24:27]
    ds_read2_b32 v[112:113], v130 offset0:144 offset1:145
    ds_read2_b32 v[114:115], v130 offset0:146 offset1:147
    ds_read_b128 v[100:103], v167 offset:640
    v_and_b32 v38, s86, v48
    v_lshlrev_b32 v39, 16, v48
    v_mfma_f32_16x16x32_bf16 v[28:31], v[120:123], v[108:111], v[28:31]
    ds_read2_b32 v[120:121], v131 offset0:144 offset1:145
    ds_read2_b32 v[122:123], v131 offset0:146 offset1:147
    ds_read_b128 v[108:111], v167 offset:128
    v_mul_f32 v36, s35, v36
    v_mul_f32 v37, s35, v37
    v_mfma_f32_16x16x32_bf16 v[28:31], v[60:63], v[64:67], v[28:31]
    buffer_load_dwordx4 v158, s[60:63], s83 offen offset:3072 lds
    v_mul_f32 v38, s35, v38
    v_mul_f32 v39, s35, v39
    s_waitcnt lgkmcnt(15)
    v_mfma_f32_16x16x32_bf16 v[20:23], v[68:71], v[72:75], v[20:23]
    v_cvt_pk_bf16_f32 v36, 0, v36
    v_cvt_pk_bf16_f32 v37, 0, v37
    v_mfma_f32_16x16x32_bf16 v[16:19], v[60:63], v[76:79], v[16:19]
    v_cvt_pk_bf16_f32 v38, 0, v38
    v_cvt_pk_bf16_f32 v39, 0, v39
    v_mfma_f32_16x16x32_bf16 v[12:15], v[68:71], v[76:79], v[12:15]
    v_cvt_pk_bf16_f32 v32, 0, v32
    v_cvt_pk_bf16_f32 v33, 0, v33
    v_mfma_f32_16x16x32_bf16 v[28:31], v[68:71], v[80:83], v[28:31]
    ds_read_b128 v[80:83], v167 offset:3648
    s_waitcnt lgkmcnt(9)
    s_add_u32 m0, s84, 0
    s_add_u32 s83, s44, 0
    buffer_load_dwordx4 v159, s[56:59], s83 offen offset:0 lds
    v_cvt_pk_bf16_f32 v34, 0, v34
    v_cvt_pk_bf16_f32 v35, 0, v35
    v_mfma_f32_16x16x32_bf16 v[8:11], v[68:71], v[84:87], v[8:11]
    v_add_f32 v32, v32, v36
    v_add_f32 v33, v33, v37
    v_mfma_f32_16x16x32_bf16 v[16:19], v[88:91], v[84:87], v[16:19]
    v_add_f32 v34, v34, v38
    v_add_f32 v35, v35, v39
    v_mfma_f32_16x16x32_bf16 v[20:23], v[60:63], v[92:95], v[20:23]
    v_cvt_pk_bf16_f32 v58, v32, v33
    v_cvt_pk_bf16_f32 v59, v34, v35
    v_mfma_f32_16x16x32_bf16 v[28:31], v[88:91], v[72:75], v[28:31]
    buffer_load_dwordx4 v159, s[60:63], s83 offen offset:2048 lds
    global_store_dwordx2 v171, v[58:59], s[50:51] sc1
    v_mfma_f32_16x16x32_bf16 v[24:27], v[68:71], v[64:67], v[24:27]
    ds_read_b128 v[64:67], v167 offset:3136
    ds_read_b128 v[176:179], v156 offset:4096
    s_mul_i32 s3, s81, 4608
    v_mfma_f32_16x16x32_bf16 v[16:19], v[68:71], v[92:95], v[16:19]
    ds_read_b128 v[180:183], v157 offset:4096
    s_lshl_b32 s4, s80, 10
    s_add_u32 s3, s3, 16896
    v_mfma_f32_16x16x32_bf16 v[28:31], v[96:99], v[76:79], v[28:31]
    ds_read_b128 v[184:187], v156 offset:4608
    s_add_u32 s9, s3, s4
    s_sub_u32 s3, s3, s4
    v_add_u32 v57, s9, v172
    v_add_u32 v171, s3, v172
    v_mfma_f32_16x16x32_bf16 v[12:15], v[60:63], v[84:87], v[12:15]
    s_add_u32 s83, s83, 9216
    buffer_load_dwordx4 v159, s[56:59], s83 offen offset:1024 lds
    ds_read_b128 v[188:191], v157 offset:4608
    v_mfma_f32_16x16x32_bf16 v[24:27], v[88:91], v[92:95], v[24:27]
    ds_read_b64 v[44:45], v57 offset:0
    ds_read_b64 v[46:47], v57 offset:512
    ds_read_b64 v[48:49], v171 offset:3072
    s_waitcnt lgkmcnt(12)
    v_mfma_f32_16x16x32_bf16 v[8:11], v[60:63], v[100:103], v[8:11]
    ds_read_b64 v[50:51], v171 offset:3584
    v_add_u32 v170, 65536, v170
    v_xor_b32 v171, 0x1000, v170
    v_mfma_f32_16x16x32_bf16 v[20:23], v[88:91], v[76:79], v[20:23]
    s_mul_i32 s3, s79, 163840
    s_mul_i32 s4, s77, 10240
    s_add_u32 s3, s3, s4
    v_add_u32 v175, s3, v153
    v_mfma_f32_16x16x32_bf16 v[12:15], v[88:91], v[100:103], v[12:15]
    buffer_load_dwordx4 v159, s[60:63], s83 offen offset:3072 lds
    s_waitcnt lgkmcnt(2)
    v_and_b32 v52, s86, v45
    v_lshlrev_b32 v53, 16, v45
    v_mfma_f32_16x16x32_bf16 v[24:27], v[60:63], v[72:75], v[24:27]
    ds_read_b128 v[72:75], v167 offset:2624
    v_and_b32 v54, s86, v44
    v_lshlrev_b32 v55, 16, v44
    v_mfma_f32_16x16x32_bf16 v[24:27], v[104:107], v[76:79], v[24:27]
    ds_read_b128 v[76:79], v167 offset:1600
    v_and_b32 v56, s86, v47
    v_lshlrev_b32 v57, 16, v47
    v_mfma_f32_16x16x32_bf16 v[4:7], v[60:63], v[108:111], v[4:7]
    ds_read2_b32 v[60:61], v166 offset0:160 offset1:161
    ds_read2_b32 v[62:63], v166 offset0:162 offset1:163
    v_and_b32 v58, s86, v46
    v_lshlrev_b32 v59, 16, v46
    v_mfma_f32_16x16x32_bf16 v[4:7], v[68:71], v[100:103], v[4:7]
    s_add_u32 m0, s84, 4096
    s_add_u32 s83, s44, 40960
    buffer_load_dwordx4 v159, s[56:59], s83 offen offset:0 lds
    v_mul_f32 v52, s34, v52
    v_mul_f32 v53, s34, v53
    v_mfma_f32_16x16x32_bf16 v[0:3], v[68:71], v[108:111], v[0:3]
    ds_read2_b32 v[68:69], v166 offset0:32 offset1:33
    ds_read2_b32 v[70:71], v166 offset0:34 offset1:35
    v_mul_f32 v54, s34, v54
    v_mul_f32 v55, s34, v55
    v_mfma_f32_16x16x32_bf16 v[28:31], v[112:115], v[84:87], v[28:31]
    v_mul_f32 v56, s34, v56
    v_mul_f32 v57, s34, v57
    v_mfma_f32_16x16x32_bf16 v[28:31], v[116:119], v[100:103], v[28:31]
    v_mul_f32 v58, s34, v58
    v_mul_f32 v59, s34, v59
    v_mfma_f32_16x16x32_bf16 v[24:27], v[96:99], v[84:87], v[24:27]
    buffer_load_dwordx4 v159, s[60:63], s83 offen offset:2048 lds
    s_waitcnt vmcnt(12)
    v_cvt_pk_bf16_f32 v52, 0, v52
    v_cvt_pk_bf16_f32 v53, 0, v53
    v_mfma_f32_16x16x32_bf16 v[20:23], v[104:107], v[84:87], v[20:23]
    ds_read_b128 v[84:87], v167 offset:1088
    ds_read_b128 v[192:195], v156 offset:8192
    v_cvt_pk_bf16_f32 v54, 0, v54
    v_cvt_pk_bf16_f32 v55, 0, v55
    v_mfma_f32_16x16x32_bf16 v[8:11], v[88:91], v[108:111], v[8:11]
    ds_read2_b32 v[88:89], v129 offset0:32 offset1:33
    ds_read2_b32 v[90:91], v129 offset0:34 offset1:35
    ds_read_b128 v[196:199], v157 offset:8192
    v_cvt_pk_bf16_f32 v56, 0, v56
    v_cvt_pk_bf16_f32 v57, 0, v57
    v_mfma_f32_16x16x32_bf16 v[28:31], v[104:107], v[92:95], v[28:31]
    ds_read_b128 v[92:95], v167 offset:2112
    ds_read_b128 v[200:203], v156 offset:8704
    v_cvt_pk_bf16_f32 v58, 0, v58
    v_cvt_pk_bf16_f32 v59, 0, v59
    v_mfma_f32_16x16x32_bf16 v[20:23], v[112:115], v[108:111], v[20:23]
    s_add_u32 s83, s83, 9216
    buffer_load_dwordx4 v159, s[56:59], s83 offen offset:1024 lds
    ds_read_b128 v[204:207], v157 offset:8704
    v_mfma_f32_16x16x32_bf16 v[16:19], v[96:99], v[108:111], v[16:19]
    s_waitcnt lgkmcnt(14)
    global_load_dword v169, v173, s[50:51] sc1
    v_and_b32 v32, s86, v49
    v_lshlrev_b32 v33, 16, v49
    v_mfma_f32_16x16x32_bf16 v[24:27], v[116:119], v[108:111], v[24:27]
    ds_read2_b32 v[116:117], v131 offset0:32 offset1:33
    ds_read2_b32 v[118:119], v131 offset0:34 offset1:35
    v_and_b32 v34, s86, v48
    v_lshlrev_b32 v35, 16, v48
    v_mfma_f32_16x16x32_bf16 v[20:23], v[96:99], v[100:103], v[20:23]
    ds_read2_b32 v[96:97], v130 offset0:32 offset1:33
    ds_read2_b32 v[98:99], v130 offset0:34 offset1:35
    v_and_b32 v36, s86, v51
    v_lshlrev_b32 v37, 16, v51
    v_mfma_f32_16x16x32_bf16 v[16:19], v[104:107], v[100:103], v[16:19]
    buffer_load_dwordx4 v159, s[60:63], s83 offen offset:3072 lds
    v_and_b32 v38, s86, v50
    v_lshlrev_b32 v39, 16, v50
    v_mfma_f32_16x16x32_bf16 v[12:15], v[104:107], v[108:111], v[12:15]
    ds_read2_b32 v[104:105], v129 offset0:160 offset1:161
    ds_read2_b32 v[106:107], v129 offset0:162 offset1:163
    v_mul_f32 v32, s34, v32
    v_mul_f32 v33, s34, v33
    v_mfma_f32_16x16x32_bf16 v[24:27], v[112:115], v[100:103], v[24:27]
    ds_read2_b32 v[112:113], v130 offset0:160 offset1:161
    ds_read2_b32 v[114:115], v130 offset0:162 offset1:163
    ds_read_b128 v[100:103], v167 offset:576
    v_mul_f32 v34, s34, v34
    v_mul_f32 v35, s34, v35
    v_mfma_f32_16x16x32_bf16 v[28:31], v[120:123], v[108:111], v[28:31]
    ds_read2_b32 v[120:121], v131 offset0:160 offset1:161
    ds_read2_b32 v[122:123], v131 offset0:162 offset1:163
    ds_read_b128 v[108:111], v167 offset:64
    v_mul_f32 v36, s34, v36
    v_mul_f32 v37, s34, v37
    s_waitcnt lgkmcnt(15)
    v_mfma_f32_16x16x32_bf16 v[28:31], v[60:63], v[64:67], v[28:31]
    s_waitcnt lgkmcnt(12)
    s_add_u32 m0, s84, 8192
    s_add_u32 s83, s16, 40960
    buffer_load_dwordx4 v158, s[56:59], s83 offen offset:0 lds
    v_mul_f32 v38, s34, v38
    v_mul_f32 v39, s34, v39
    v_mfma_f32_16x16x32_bf16 v[20:23], v[68:71], v[72:75], v[20:23]
    v_cvt_pk_bf16_f32 v32, 0, v32
    v_cvt_pk_bf16_f32 v33, 0, v33
    v_mfma_f32_16x16x32_bf16 v[16:19], v[60:63], v[76:79], v[16:19]
    v_cvt_pk_bf16_f32 v34, 0, v34
    v_cvt_pk_bf16_f32 v35, 0, v35
    v_mfma_f32_16x16x32_bf16 v[12:15], v[68:71], v[76:79], v[12:15]
    v_cvt_pk_bf16_f32 v36, 0, v36
    v_cvt_pk_bf16_f32 v37, 0, v37
    v_mfma_f32_16x16x32_bf16 v[28:31], v[68:71], v[80:83], v[28:31]
    ds_read_b128 v[80:83], v167 offset:3584
    buffer_load_dwordx4 v158, s[60:63], s83 offen offset:2048 lds
    s_waitcnt vmcnt(12)
    v_cvt_pk_bf16_f32 v38, 0, v38
    v_cvt_pk_bf16_f32 v39, 0, v39
    v_mfma_f32_16x16x32_bf16 v[8:11], v[68:71], v[84:87], v[8:11]
    ds_read_b128 v[208:211], v156 offset:12288
    v_mfma_f32_16x16x32_bf16 v[16:19], v[88:91], v[84:87], v[16:19]
    ds_read_b128 v[212:215], v157 offset:12288
    v_mfma_f32_16x16x32_bf16 v[20:23], v[60:63], v[92:95], v[20:23]
    ds_read_b128 v[216:219], v156 offset:12800
    s_add_u32 s25, s22, s5
    v_mfma_f32_16x16x32_bf16 v[28:31], v[88:91], v[72:75], v[28:31]
    s_add_u32 s83, s83, 9216
    buffer_load_dwordx4 v158, s[56:59], s83 offen offset:1024 lds
    ds_read_b128 v[220:223], v157 offset:12800
    v_mfma_f32_16x16x32_bf16 v[24:27], v[68:71], v[64:67], v[24:27]
    ds_read_b128 v[64:67], v167 offset:3072
    s_add_u32 s26, s23, s5
    v_mfma_f32_16x16x32_bf16 v[16:19], v[68:71], v[92:95], v[16:19]
    s_add_u32 s27, s24, s5
    s_waitcnt lgkmcnt(14)
    v_mfma_f32_16x16x32_bf16 v[28:31], v[96:99], v[76:79], v[28:31]
    s_cmp_eq_u32 s77, 2
    s_cselect_b32 s5, -122880, s13
    v_mfma_f32_16x16x32_bf16 v[12:15], v[60:63], v[84:87], v[12:15]
    buffer_load_dwordx4 v158, s[60:63], s83 offen offset:3072 lds
    s_add_u32 s28, s25, s5
    v_mfma_f32_16x16x32_bf16 v[24:27], v[88:91], v[92:95], v[24:27]
    s_add_u32 s29, s26, s5
    s_waitcnt lgkmcnt(9)
    v_mfma_f32_16x16x32_bf16 v[8:11], v[60:63], v[100:103], v[8:11]
    s_add_u32 s30, s27, s5
    v_mfma_f32_16x16x32_bf16 v[20:23], v[88:91], v[76:79], v[20:23]
    s_cmp_eq_u32 s77, 1
    s_cselect_b32 s5, -122880, s13
    v_mfma_f32_16x16x32_bf16 v[12:15], v[88:91], v[100:103], v[12:15]
    s_waitcnt lgkmcnt(1)
    s_add_u32 m0, s84, 12288
    s_add_u32 s83, s16, 46080
    buffer_load_dwordx4 v158, s[56:59], s83 offen offset:0 lds
    v_mfma_f32_16x16x32_bf16 v[24:27], v[60:63], v[72:75], v[24:27]
    ds_read_b128 v[72:75], v167 offset:2560
    v_mfma_f32_16x16x32_bf16 v[24:27], v[104:107], v[76:79], v[24:27]
    ds_read_b128 v[76:79], v167 offset:1536
    v_mfma_f32_16x16x32_bf16 v[4:7], v[60:63], v[108:111], v[4:7]
    ds_read2_b32 v[60:61], v166 offset0:176 offset1:177
    ds_read2_b32 v[62:63], v166 offset0:178 offset1:179
    v_mfma_f32_16x16x32_bf16 v[4:7], v[68:71], v[100:103], v[4:7]
    buffer_load_dwordx4 v158, s[60:63], s83 offen offset:2048 lds
    s_add_u32 s31, s28, s5
    v_mfma_f32_16x16x32_bf16 v[0:3], v[68:71], v[108:111], v[0:3]
    ds_read2_b32 v[68:69], v166 offset0:48 offset1:49
    ds_read2_b32 v[70:71], v166 offset0:50 offset1:51
    v_mfma_f32_16x16x32_bf16 v[28:31], v[112:115], v[84:87], v[28:31]
    s_add_u32 s32, s29, s5
    v_mfma_f32_16x16x32_bf16 v[28:31], v[116:119], v[100:103], v[28:31]
    s_add_u32 s33, s30, s5
    v_mfma_f32_16x16x32_bf16 v[24:27], v[96:99], v[84:87], v[24:27]
    s_add_u32 s83, s83, 9216
    buffer_load_dwordx4 v158, s[56:59], s83 offen offset:1024 lds
    v_mfma_f32_16x16x32_bf16 v[20:23], v[104:107], v[84:87], v[20:23]
    ds_read_b128 v[84:87], v167 offset:1024
    s_getpc_b64 s[4:5]
L_pc2:
    s_lshr_b32 s3, s2, 3
    s_lshl_b32 s3, s3, 2
    s_add_u32 s3, s3, s77
    s_lshl_b32 s3, s3, 8
    v_and_b32 v168, 1, v152
    v_lshl_add_u32 v168, v168, 7, s3
    v_min_u32 v168, L_last-L_pc2, v168
    global_load_dword v168, v168, s[4:5]
    v_mfma_f32_16x16x32_bf16 v[8:11], v[88:91], v[108:111], v[8:11]
    ds_read2_b32 v[88:89], v129 offset0:48 offset1:49
    ds_read2_b32 v[90:91], v129 offset0:50 offset1:51
    v_mfma_f32_16x16x32_bf16 v[28:31], v[104:107], v[92:95], v[28:31]
    ds_read_b128 v[92:95], v167 offset:2048
    v_mfma_f32_16x16x32_bf16 v[20:23], v[112:115], v[108:111], v[20:23]
    buffer_load_dwordx4 v158, s[60:63], s83 offen offset:3072 lds
    v_mfma_f32_16x16x32_bf16 v[16:19], v[96:99], v[108:111], v[16:19]
    v_mfma_f32_16x16x32_bf16 v[24:27], v[116:119], v[108:111], v[24:27]
    ds_read2_b32 v[116:117], v131 offset0:48 offset1:49
    ds_read2_b32 v[118:119], v131 offset0:50 offset1:51
    v_mfma_f32_16x16x32_bf16 v[20:23], v[96:99], v[100:103], v[20:23]
    ds_read2_b32 v[96:97], v130 offset0:48 offset1:49
    ds_read2_b32 v[98:99], v130 offset0:50 offset1:51
    v_mfma_f32_16x16x32_bf16 v[16:19], v[104:107], v[100:103], v[16:19]
    v_mfma_f32_16x16x32_bf16 v[12:15], v[104:107], v[108:111], v[12:15]
    ds_read2_b32 v[104:105], v129 offset0:176 offset1:177
    ds_read2_b32 v[106:107], v129 offset0:178 offset1:179
    v_mfma_f32_16x16x32_bf16 v[24:27], v[112:115], v[100:103], v[24:27]
    ds_read2_b32 v[112:113], v130 offset0:176 offset1:177
    ds_read2_b32 v[114:115], v130 offset0:178 offset1:179
    ds_read_b128 v[100:103], v167 offset:512
    v_mfma_f32_16x16x32_bf16 v[28:31], v[120:123], v[108:111], v[28:31]
    ds_read2_b32 v[120:121], v131 offset0:176 offset1:177
    ds_read2_b32 v[122:123], v131 offset0:178 offset1:179
    ds_read_b128 v[108:111], v167 offset:0
    s_cmp_lg_u32 s80, 0
    s_cbranch_scc1 Lv_15
    s_waitcnt lgkmcnt(15)
    v_mfma_f32_16x16x32_bf16 v[16:19], v[60:63], v[76:79], v[16:19]
    s_waitcnt vmcnt(14)
    v_mfma_f32_16x16x32_bf16 v[20:23], v[68:71], v[72:75], v[20:23]
    ds_read_b128 v[224:227], v156 offset:0
    v_mfma_f32_16x16x32_bf16 v[12:15], v[68:71], v[76:79], v[12:15]
    ds_read_b128 v[232:235], v156 offset:512
    v_mfma_f32_16x16x32_bf16 v[12:15], v[60:63], v[84:87], v[12:15]
    ds_read_b128 v[228:231], v157 offset:0
    s_waitcnt lgkmcnt(15)
    v_mfma_f32_16x16x32_bf16 v[20:23], v[88:91], v[76:79], v[20:23]
    ds_read_b128 v[236:239], v157 offset:512
    v_mfma_f32_16x16x32_bf16 v[20:23], v[60:63], v[92:95], v[20:23]
    v_mfma_f32_16x16x32_bf16 v[8:11], v[68:71], v[84:87], v[8:11]
    v_mfma_f32_16x16x32_bf16 v[16:19], v[88:91], v[84:87], v[16:19]
    s_waitcnt lgkmcnt(0)
    s_add_u32 m0, s84, 0
    s_add_u32 s83, s16, 0
    buffer_load_dwordx4 v158, s[56:59], s83 offen offset:0 lds
    v_mfma_f32_16x16x32_bf16 v[16:19], v[68:71], v[92:95], v[16:19]
    v_mfma_f32_16x16x32_bf16 v[20:23], v[104:107], v[84:87], v[20:23]
    v_mfma_f32_16x16x32_bf16 v[20:23], v[96:99], v[100:103], v[20:23]
    v_mfma_f32_16x16x32_bf16 v[16:19], v[104:107], v[100:103], v[16:19]
    buffer_load_dwordx4 v158, s[60:63], s83 offen offset:2048 lds
    s_waitcnt vmcnt(11)
    v_mfma_f32_16x16x32_bf16 v[8:11], v[60:63], v[100:103], v[8:11]
    ds_read_b128 v[240:243], v156 offset:4096
L_fh0:
    v_cmp_ne_u32 vcc, s82, v169
    s_cbranch_vccnz L_fh_re0
    v_mfma_f32_16x16x32_bf16 v[16:19], v[96:99], v[108:111], v[16:19]
    ds_read_b128 v[248:251], v156 offset:4608
    v_mfma_f32_16x16x32_bf16 v[12:15], v[88:91], v[100:103], v[12:15]
    ds_read_b128 v[244:247], v157 offset:4096
    buffer_load_dwordx4 v[40:43], v175, s[64:67], s23 offen offset:0 sc1
    v_mfma_f32_16x16x32_bf16 v[8:11], v[88:91], v[108:111], v[8:11]
    s_add_u32 s83, s83, 9216
    buffer_load_dwordx4 v158, s[56:59], s83 offen offset:1024 lds
    ds_read_b128 v[252:255], v157 offset:4608
    v_mfma_f32_16x16x32_bf16 v[12:15], v[104:107], v[108:111], v[12:15]
    ds_write_b128 v170, v[16:19] offset:2048
    buffer_load_dwordx4 v[44:47], v175, s[64:67], s23 offen offset:1024 sc1
    v_mfma_f32_16x16x32_bf16 v[20:23], v[112:115], v[108:111], v[20:23]
    v_mfma_f32_16x16x32_bf16 v[28:31], v[120:123], v[108:111], v[28:31]
    ds_write_b128 v170, v[8:11] offset:0
    buffer_load_dwordx4 v[48:51], v175, s[64:67], s23 offen offset:2048 sc1
    v_mfma_f32_16x16x32_bf16 v[28:31], v[68:71], v[80:83], v[28:31]
    s_nop 0
    ds_write_b128 v170, v[12:15] offset:1024
    buffer_load_dwordx4 v158, s[60:63], s83 offen offset:3072 lds
    v_mfma_f32_16x16x32_bf16 v[24:27], v[116:119], v[108:111], v[24:27]
    ds_write_b128 v170, v[20:23] offset:3072
    buffer_load_dwordx4 v[120:123], v175, s[64:67], s22 offen offset:0 sc1
    v_mfma_f32_16x16x32_bf16 v[28:31], v[116:119], v[100:103], v[28:31]
    v_mfma_f32_16x16x32_bf16 v[24:27], v[68:71], v[64:67], v[24:27]
    v_mfma_f32_16x16x32_bf16 v[28:31], v[60:63], v[64:67], v[28:31]
    s_waitcnt lgkmcnt(4)
    s_add_u32 m0, s84, 4096
    s_add_u32 s83, s16, 5120
    buffer_load_dwordx4 v158, s[56:59], s83 offen offset:0 lds
    buffer_load_dwordx4 v[80:83], v175, s[64:67], s25 offen offset:0 sc1
    v_mfma_f32_16x16x32_bf16 v[0:3], v[68:71], v[108:111], v[0:3]
    v_mfma_f32_16x16x32_bf16 v[4:7], v[68:71], v[100:103], v[4:7]
    v_mfma_f32_16x16x32_bf16 v[4:7], v[60:63], v[108:111], v[4:7]
    buffer_load_dwordx4 v[116:119], v175, s[64:67], s28 offen offset:0 sc1
    v_mfma_f32_16x16x32_bf16 v[24:27], v[112:115], v[100:103], v[24:27]
    buffer_load_dwordx4 v158, s[60:63], s83 offen offset:2048 lds
    v_mfma_f32_16x16x32_bf16 v[24:27], v[60:63], v[72:75], v[24:27]
    v_mfma_f32_16x16x32_bf16 v[28:31], v[112:115], v[84:87], v[28:31]
    buffer_load_dwordx4 v[64:67], v175, s[64:67], s31 offen offset:0 sc1
    s_waitcnt lgkmcnt(0)
    s_barrier
    v_mfma_f32_16x16x32_bf16 v[28:31], v[88:91], v[72:75], v[28:31]
    ds_read_b128 v[8:11], v171 offset:0
    v_mfma_f32_16x16x32_bf16 v[24:27], v[96:99], v[84:87], v[24:27]
    ds_read_b128 v[12:15], v171 offset:1024
    s_add_u32 s83, s83, 9216
    buffer_load_dwordx4 v158, s[56:59], s83 offen offset:1024 lds
    v_mfma_f32_16x16x32_bf16 v[24:27], v[88:91], v[92:95], v[24:27]
    ds_read_b128 v[16:19], v171 offset:2048
    v_mfma_f32_16x16x32_bf16 v[24:27], v[104:107], v[76:79], v[24:27]
    ds_read_b128 v[20:23], v171 offset:3072
    v_mfma_f32_16x16x32_bf16 v[28:31], v[96:99], v[76:79], v[28:31]
    v_mfma_f32_16x16x32_bf16 v[28:31], v[104:107], v[92:95], v[28:31]
    buffer_load_dwordx4 v158, s[60:63], s83 offen offset:3072 lds
    s_branch Lw_16
Lv_15:
    s_waitcnt lgkmcnt(15)
    v_mfma_f32_16x16x32_bf16 v[24:27], v[68:71], v[64:67], v[24:27]
    s_waitcnt vmcnt(14)
    v_mfma_f32_16x16x32_bf16 v[28:31], v[60:63], v[64:67], v[28:31]
    ds_read_b128 v[224:227], v156 offset:0
    v_mfma_f32_16x16x32_bf16 v[24:27], v[60:63], v[72:75], v[24:27]
    ds_read_b128 v[232:235], v156 offset:512
    v_mfma_f32_16x16x32_bf16 v[28:31], v[68:71], v[80:83], v[28:31]
    ds_read_b128 v[228:231], v157 offset:0
    s_waitcnt lgkmcnt(15)
    v_mfma_f32_16x16x32_bf16 v[28:31], v[88:91], v[72:75], v[28:31]
    ds_read_b128 v[236:239], v157 offset:512
    v_mfma_f32_16x16x32_bf16 v[24:27], v[88:91], v[92:95], v[24:27]
    s_waitcnt lgkmcnt(12)
    v_mfma_f32_16x16x32_bf16 v[28:31], v[96:99], v[76:79], v[28:31]
    v_mfma_f32_16x16x32_bf16 v[24:27], v[96:99], v[84:87], v[24:27]
    s_waitcnt lgkmcnt(0)
    s_add_u32 m0, s84, 0
    s_add_u32 s83, s16, 0
    buffer_load_dwordx4 v158, s[56:59], s83 offen offset:0 lds
    v_mfma_f32_16x16x32_bf16 v[24:27], v[104:107], v[76:79], v[24:27]
    v_mfma_f32_16x16x32_bf16 v[28:31], v[104:107], v[92:95], v[28:31]
    v_mfma_f32_16x16x32_bf16 v[4:7], v[68:71], v[100:103], v[4:7]
    v_mfma_f32_16x16x32_bf16 v[28:31], v[116:119], v[100:103], v[28:31]
    buffer_load_dwordx4 v158, s[60:63], s83 offen offset:2048 lds
    s_waitcnt vmcnt(11)
    v_mfma_f32_16x16x32_bf16 v[4:7], v[60:63], v[108:111], v[4:7]
    ds_read_b128 v[240:243], v156 offset:4096
L_fh1:
    v_cmp_ne_u32 vcc, s82, v169
    s_cbranch_vccnz L_fh_re1
    v_mfma_f32_16x16x32_bf16 v[0:3], v[68:71], v[108:111], v[0:3]
    ds_read_b128 v[248:251], v156 offset:4608
    v_mfma_f32_16x16x32_bf16 v[24:27], v[112:115], v[100:103], v[24:27]
    ds_read_b128 v[244:247], v157 offset:4096
    buffer_load_dwordx4 v[40:43], v175, s[64:67], s23 offen offset:0 sc1
    v_mfma_f32_16x16x32_bf16 v[24:27], v[116:119], v[108:111], v[24:27]
    ds_write_b128 v170, v[4:7] offset:1024
    s_add_u32 s83, s83, 9216
    buffer_load_dwordx4 v158, s[56:59], s83 offen offset:1024 lds
    ds_read_b128 v[252:255], v157 offset:4608
    v_mfma_f32_16x16x32_bf16 v[28:31], v[120:123], v[108:111], v[28:31]
    ds_write_b128 v170, v[0:3] offset:0
    buffer_load_dwordx4 v[44:47], v175, s[64:67], s23 offen offset:1024 sc1
    v_mfma_f32_16x16x32_bf16 v[28:31], v[112:115], v[84:87], v[28:31]
    v_mfma_f32_16x16x32_bf16 v[12:15], v[60:63], v[84:87], v[12:15]
    ds_write_b128 v170, v[24:27] offset:2048
    buffer_load_dwordx4 v[48:51], v175, s[64:67], s23 offen offset:2048 sc1
    v_mfma_f32_16x16x32_bf16 v[12:15], v[88:91], v[100:103], v[12:15]
    buffer_load_dwordx4 v158, s[60:63], s83 offen offset:3072 lds
    v_mfma_f32_16x16x32_bf16 v[12:15], v[104:107], v[108:111], v[12:15]
    s_nop 1
    ds_write_b128 v170, v[28:31] offset:3072
    buffer_load_dwordx4 v[120:123], v175, s[64:67], s22 offen offset:0 sc1
    v_mfma_f32_16x16x32_bf16 v[8:11], v[88:91], v[108:111], v[8:11]
    v_mfma_f32_16x16x32_bf16 v[8:11], v[68:71], v[84:87], v[8:11]
    v_mfma_f32_16x16x32_bf16 v[12:15], v[68:71], v[76:79], v[12:15]
    s_waitcnt lgkmcnt(3)
    s_add_u32 m0, s84, 4096
    s_add_u32 s83, s16, 5120
    buffer_load_dwordx4 v158, s[56:59], s83 offen offset:0 lds
    buffer_load_dwordx4 v[80:83], v175, s[64:67], s25 offen offset:0 sc1
    v_mfma_f32_16x16x32_bf16 v[8:11], v[60:63], v[100:103], v[8:11]
    v_mfma_f32_16x16x32_bf16 v[16:19], v[96:99], v[108:111], v[16:19]
    v_mfma_f32_16x16x32_bf16 v[16:19], v[68:71], v[92:95], v[16:19]
    buffer_load_dwordx4 v[116:119], v175, s[64:67], s28 offen offset:0 sc1
    v_mfma_f32_16x16x32_bf16 v[20:23], v[104:107], v[84:87], v[20:23]
    buffer_load_dwordx4 v158, s[60:63], s83 offen offset:2048 lds
    v_mfma_f32_16x16x32_bf16 v[20:23], v[88:91], v[76:79], v[20:23]
    v_mfma_f32_16x16x32_bf16 v[20:23], v[60:63], v[92:95], v[20:23]
    buffer_load_dwordx4 v[64:67], v175, s[64:67], s31 offen offset:0 sc1
    s_waitcnt lgkmcnt(0)
    s_barrier
    v_mfma_f32_16x16x32_bf16 v[16:19], v[104:107], v[100:103], v[16:19]
    ds_read_b128 v[0:3], v171 offset:0
    v_mfma_f32_16x16x32_bf16 v[16:19], v[60:63], v[76:79], v[16:19]
    ds_read_b128 v[4:7], v171 offset:1024
    s_add_u32 s83, s83, 9216
    buffer_load_dwordx4 v158, s[56:59], s83 offen offset:1024 lds
    v_mfma_f32_16x16x32_bf16 v[20:23], v[68:71], v[72:75], v[20:23]
    ds_read_b128 v[24:27], v171 offset:2048
    v_mfma_f32_16x16x32_bf16 v[16:19], v[88:91], v[84:87], v[16:19]
    ds_read_b128 v[28:31], v171 offset:3072
    v_mfma_f32_16x16x32_bf16 v[20:23], v[112:115], v[108:111], v[20:23]
    v_mfma_f32_16x16x32_bf16 v[20:23], v[96:99], v[100:103], v[20:23]
    buffer_load_dwordx4 v158, s[60:63], s83 offen offset:3072 lds
Lw_16:
    s_waitcnt vmcnt(12)
    v_mfma_f32_16x16x32_bf16 v[132:135], a[232:235], v[40:43], v[132:135]
    s_waitcnt lgkmcnt(2)
    v_add_f32 v0, v0, v8
    v_add_f32 v1, v1, v9
    v_mfma_f32_16x16x32_bf16 v[136:139], v[176:179], v[40:43], v[136:139]
    v_add_f32 v2, v2, v10
    v_add_f32 v3, v3, v11
    v_mfma_f32_16x16x32_bf16 v[140:143], v[192:195], v[40:43], v[140:143]
    buffer_load_dwordx4 v[60:63], v175, s[64:67], s22 offen offset:1024 sc1
    v_add_f32 v4, v4, v12
    v_add_f32 v5, v5, v13
    v_mfma_f32_16x16x32_bf16 v[144:147], v[208:211], v[40:43], v[144:147]
    v_add_f32 v6, v6, v14
    v_add_f32 v7, v7, v15
    v_mfma_f32_16x16x32_bf16 v[148:151], a[216:219], v[40:43], v[148:151]
    v_cvt_pk_bf16_f32 v0, 0, v0
    v_cvt_pk_bf16_f32 v1, 0, v1
    s_waitcnt vmcnt(11)
    v_mfma_f32_16x16x32_bf16 v[132:135], a[236:239], v[44:47], v[132:135]
    v_cvt_pk_bf16_f32 v2, 0, v2
    v_cvt_pk_bf16_f32 v3, 0, v3
    v_mfma_f32_16x16x32_bf16 v[136:139], v[180:183], v[44:47], v[136:139]
    buffer_load_dwordx4 v[68:71], v175, s[64:67], s25 offen offset:1024 sc1
    v_cvt_pk_bf16_f32 v4, 0, v4
    v_cvt_pk_bf16_f32 v5, 0, v5
    v_mfma_f32_16x16x32_bf16 v[140:143], v[196:199], v[44:47], v[140:143]
    v_cvt_pk_bf16_f32 v6, 0, v6
    v_cvt_pk_bf16_f32 v7, 0, v7
    v_mfma_f32_16x16x32_bf16 v[144:147], v[212:215], v[44:47], v[144:147]
    ds_read_b128 v[124:127], v156 offset:8192
    v_add_f32 v0, v0, v52
    v_add_f32 v1, v1, v53
    v_mfma_f32_16x16x32_bf16 v[148:151], a[220:223], v[44:47], v[148:151]
    v_add_f32 v2, v2, v54
    v_add_f32 v3, v3, v55
    s_waitcnt vmcnt(11)
    v_mfma_f32_16x16x32_bf16 v[132:135], a[240:243], v[48:51], v[132:135]
    buffer_load_dwordx4 v[72:75], v175, s[64:67], s28 offen offset:1024 sc1
    v_add_f32 v4, v4, v56
    v_add_f32 v5, v5, v57
    v_mfma_f32_16x16x32_bf16 v[136:139], v[184:187], v[48:51], v[136:139]
    v_add_f32 v6, v6, v58
    v_add_f32 v7, v7, v59
    v_mfma_f32_16x16x32_bf16 v[140:143], v[200:203], v[48:51], v[140:143]
    ds_read_b128 v[128:131], v156 offset:12288
    v_cvt_pk_bf16_f32 v170, v0, v1
    v_cvt_pk_bf16_f32 v171, v2, v3
    v_mfma_f32_16x16x32_bf16 v[144:147], v[216:219], v[48:51], v[144:147]
    v_cvt_pk_bf16_f32 v172, v4, v5
    v_cvt_pk_bf16_f32 v173, v6, v7
    v_mfma_f32_16x16x32_bf16 v[148:151], a[224:227], v[48:51], v[148:151]
    buffer_load_dwordx4 v[76:79], v175, s[64:67], s31 offen offset:1024 sc1
    v_permlane16_swap_b32 v170, v172
    s_waitcnt vmcnt(9)
    v_mfma_f32_16x16x32_bf16 v[148:151], a[200:203], v[120:123], v[148:151]
    v_permlane16_swap_b32 v171, v173
    v_mfma_f32_16x16x32_bf16 v[40:43], a[200:203], v[80:83], 0
    ds_read_b128 v[112:115], v156 offset:0
    s_waitcnt lgkmcnt(3)
    v_add_f32 v16, v16, v24
    v_add_f32 v17, v17, v25
    s_waitcnt vmcnt(6)
    v_mfma_f32_16x16x32_bf16 v[44:47], a[200:203], v[116:119], 0
    v_add_f32 v18, v18, v26
    v_add_f32 v19, v19, v27
    v_mfma_f32_16x16x32_bf16 v[48:51], a[200:203], v[64:67], 0
    buffer_load_dwordx4 v[84:87], v175, s[64:67], s22 offen offset:2048 sc1
    v_add_f32 v20, v20, v28
    v_add_f32 v21, v21, v29
    s_waitcnt lgkmcnt(2)
    v_mfma_f32_16x16x32_bf16 v[140:143], v[124:127], v[120:123], v[140:143]
    v_add_f32 v22, v22, v30
    v_add_f32 v23, v23, v31
    v_mfma_f32_16x16x32_bf16 v[52:55], v[124:127], v[80:83], 0
    v_cvt_pk_bf16_f32 v16, 0, v16
    v_cvt_pk_bf16_f32 v17, 0, v17
    v_mfma_f32_16x16x32_bf16 v[56:59], v[124:127], v[116:119], 0
    v_cvt_pk_bf16_f32 v18, 0, v18
    v_cvt_pk_bf16_f32 v19, 0, v19
    v_mfma_f32_16x16x32_bf16 v[0:3], v[124:127], v[64:67], 0
    s_waitcnt vmcnt(5)
    ds_read_b128 v[124:127], v156 offset:4096
    buffer_load_dwordx4 v[88:91], v175, s[64:67], s25 offen offset:2048 sc1
    v_cvt_pk_bf16_f32 v20, 0, v20
    v_cvt_pk_bf16_f32 v21, 0, v21
    s_waitcnt lgkmcnt(2)
    v_mfma_f32_16x16x32_bf16 v[144:147], v[128:131], v[120:123], v[144:147]
    v_cvt_pk_bf16_f32 v22, 0, v22
    v_cvt_pk_bf16_f32 v23, 0, v23
    v_mfma_f32_16x16x32_bf16 v[4:7], v[128:131], v[80:83], 0
    v_add_f32 v16, v16, v32
    v_add_f32 v17, v17, v33
    v_mfma_f32_16x16x32_bf16 v[8:11], v[128:131], v[116:119], 0
    v_add_f32 v18, v18, v34
    v_add_f32 v19, v19, v35
    v_mfma_f32_16x16x32_bf16 v[12:15], v[128:131], v[64:67], 0
    ds_read_b128 v[128:131], v157 offset:8192
    buffer_load_dwordx4 v[92:95], v175, s[64:67], s28 offen offset:2048 sc1
    v_add_f32 v20, v20, v36
    v_add_f32 v21, v21, v37
    s_waitcnt lgkmcnt(2)
    v_mfma_f32_16x16x32_bf16 v[132:135], v[112:115], v[120:123], v[132:135]
    v_add_f32 v22, v22, v38
    v_add_f32 v23, v23, v39
    v_mfma_f32_16x16x32_bf16 v[28:31], v[112:115], v[80:83], 0
    v_cvt_pk_bf16_f32 v166, v16, v17
    v_cvt_pk_bf16_f32 v167, v18, v19
    v_mfma_f32_16x16x32_bf16 v[32:35], v[112:115], v[116:119], 0
    v_cvt_pk_bf16_f32 v168, v20, v21
    v_cvt_pk_bf16_f32 v169, v22, v23
    v_mfma_f32_16x16x32_bf16 v[36:39], v[112:115], v[64:67], 0
    ds_read_b128 v[112:115], v157 offset:12288
    buffer_load_dwordx4 v[96:99], v175, s[64:67], s31 offen offset:2048 sc1
    v_permlane16_swap_b32 v166, v168
    s_waitcnt lgkmcnt(2)
    v_mfma_f32_16x16x32_bf16 v[136:139], v[124:127], v[120:123], v[136:139]
    v_permlane16_swap_b32 v167, v169
    v_mfma_f32_16x16x32_bf16 v[16:19], v[124:127], v[80:83], 0
    v_mfma_f32_16x16x32_bf16 v[20:23], v[124:127], v[116:119], 0
    v_mfma_f32_16x16x32_bf16 v[24:27], v[124:127], v[64:67], 0
    ds_read_b128 v[124:127], v157 offset:0
    buffer_load_dwordx4 v[100:103], v175, s[64:67], s22 offen offset:3072 sc1
    s_waitcnt vmcnt(7)
    v_mfma_f32_16x16x32_bf16 v[148:151], a[204:207], v[60:63], v[148:151]
    v_mfma_f32_16x16x32_bf16 v[40:43], a[204:207], v[68:71], v[40:43]
    buffer_store_dwordx4 v[170:173], v164, s[68:71], s38 offen sc1
    buffer_store_dwordx4 v[166:169], v164, s[68:71], s39 offen sc1
    s_waitcnt vmcnt(7)
    v_mfma_f32_16x16x32_bf16 v[44:47], a[204:207], v[72:75], v[44:47]
    v_mfma_f32_16x16x32_bf16 v[48:51], a[204:207], v[76:79], v[48:51]
    buffer_load_dwordx4 v[104:107], v175, s[64:67], s25 offen offset:3072 sc1
    s_waitcnt lgkmcnt(2)
    v_mfma_f32_16x16x32_bf16 v[140:143], v[128:131], v[60:63], v[140:143]
    s_movk_i32 s9, 0x70
    v_lshrrev_b32 v164, 3, v152
    v_mfma_f32_16x16x32_bf16 v[52:55], v[128:131], v[68:71], v[52:55]
    v_lshlrev_b32 v164, 12, v164
    v_and_or_b32 v164, v153, s9, v164
    v_mfma_f32_16x16x32_bf16 v[56:59], v[128:131], v[72:75], v[56:59]
    s_mul_i32 s6, s78, 327680
    s_lshl_b32 s5, s79, 7
    v_mfma_f32_16x16x32_bf16 v[0:3], v[128:131], v[76:79], v[0:3]
    ds_read_b128 v[128:131], v157 offset:4096
    buffer_load_dwordx4 v[108:111], v175, s[64:67], s28 offen offset:3072 sc1
    s_waitcnt lgkmcnt(2)
    v_mfma_f32_16x16x32_bf16 v[144:147], v[112:115], v[60:63], v[144:147]
    s_add_u32 s6, s6, s5
    s_lshl_b32 s5, s77, 14
    v_mfma_f32_16x16x32_bf16 v[4:7], v[112:115], v[68:71], v[4:7]
    s_add_u32 s7, s6, s5
    s_add_u32 s7, s7, 262144
    v_mfma_f32_16x16x32_bf16 v[8:11], v[112:115], v[72:75], v[8:11]
    s_lshl_b32 s5, s77, 16
    s_add_u32 s6, s6, s5
    v_mfma_f32_16x16x32_bf16 v[12:15], v[112:115], v[76:79], v[12:15]
    ds_read_b128 v[112:115], v156 offset:8704
    buffer_load_dwordx4 v[120:123], v175, s[64:67], s31 offen offset:3072 sc1
    s_waitcnt lgkmcnt(2)
    v_mfma_f32_16x16x32_bf16 v[132:135], v[124:127], v[60:63], v[132:135]
    s_mov_b32 s5, 3145728
    s_add_u32 s6, s6, s5
    v_mfma_f32_16x16x32_bf16 v[28:31], v[124:127], v[68:71], v[28:31]
    s_add_u32 s7, s7, s5
    s_lshl_b32 s5, s77, 9
    v_mfma_f32_16x16x32_bf16 v[32:35], v[124:127], v[72:75], v[32:35]
    s_mul_i32 s4, s77, 15360
    v_add_u32 v154, s4, v153
    v_mfma_f32_16x16x32_bf16 v[36:39], v[124:127], v[76:79], v[36:39]
    ds_read_b128 v[124:127], v156 offset:12800
    buffer_load_dwordx4 v[80:83], v175, s[64:67], s26 offen offset:0 sc1
    s_waitcnt lgkmcnt(2)
    v_mfma_f32_16x16x32_bf16 v[136:139], v[128:131], v[60:63], v[136:139]
    v_and_b32 v155, 0xf0, v153
    v_lshrrev_b32 v163, 4, v152
    v_mfma_f32_16x16x32_bf16 v[16:19], v[128:131], v[68:71], v[16:19]
    v_lshl_add_u32 v163, v163, 9, v155
    v_lshrrev_b32 v172, 5, v152
    v_mfma_f32_16x16x32_bf16 v[20:23], v[128:131], v[72:75], v[20:23]
    v_lshl_add_u32 v155, v172, 3, v155
    v_mfma_f32_16x16x32_bf16 v[24:27], v[128:131], v[76:79], v[24:27]
    ds_read_b128 v[128:131], v156 offset:512
    buffer_load_dwordx4 v[116:119], v175, s[64:67], s26 offen offset:1024 sc1
    s_waitcnt vmcnt(10)
    v_mfma_f32_16x16x32_bf16 v[148:151], a[208:211], v[84:87], v[148:151]
    s_lshl_b32 s4, s78, 8
    v_add_u32 v155, s4, v155
    v_mfma_f32_16x16x32_bf16 v[40:43], a[208:211], v[88:91], v[40:43]
    s_lshl_b32 s4, s79, 13
    s_waitcnt vmcnt(8)
    v_mfma_f32_16x16x32_bf16 v[44:47], a[208:211], v[92:95], v[44:47]
    s_add_u32 s4, s4, s100
    s_add_u32 s4, s4, 10485760
    v_mfma_f32_16x16x32_bf16 v[48:51], a[208:211], v[96:99], v[48:51]
    buffer_load_dwordx4 v[64:67], v175, s[64:67], s26 offen offset:2048 sc1
    s_waitcnt lgkmcnt(2)
    v_mfma_f32_16x16x32_bf16 v[140:143], v[112:115], v[84:87], v[140:143]
    s_add_u32 s98, s50, s4
    s_addc_u32 s99, s51, 0
    v_mfma_f32_16x16x32_bf16 v[52:55], v[112:115], v[88:91], v[52:55]
    s_add_u32 s4, s100, 61440
    v_lshl_add_u32 v170, v152, 3, s4
    v_mfma_f32_16x16x32_bf16 v[56:59], v[112:115], v[92:95], v[56:59]
    s_add_u32 s4, s5, 69632
    v_lshl_add_u32 v171, v152, 3, s4
    v_mfma_f32_16x16x32_bf16 v[0:3], v[112:115], v[96:99], v[0:3]
    ds_read_b128 v[112:115], v156 offset:4608
    buffer_load_dwordx4 v[60:63], v175, s[64:67], s26 offen offset:3072 sc1
    s_waitcnt lgkmcnt(2)
    v_mfma_f32_16x16x32_bf16 v[144:147], v[124:127], v[84:87], v[144:147]
    v_mfma_f32_16x16x32_bf16 v[4:7], v[124:127], v[88:91], v[4:7]
    v_mfma_f32_16x16x32_bf16 v[8:11], v[124:127], v[92:95], v[8:11]
    v_mfma_f32_16x16x32_bf16 v[12:15], v[124:127], v[96:99], v[12:15]
    ds_read_b128 v[124:127], v157 offset:8704
    buffer_load_dwordx4 v[68:71], v175, s[64:67], s27 offen offset:0 sc1
    s_waitcnt lgkmcnt(2)
    v_mfma_f32_16x16x32_bf16 v[132:135], v[128:131], v[84:87], v[132:135]
    v_mfma_f32_16x16x32_bf16 v[28:31], v[128:131], v[88:91], v[28:31]
    v_mfma_f32_16x16x32_bf16 v[32:35], v[128:131], v[92:95], v[32:35]
    v_mfma_f32_16x16x32_bf16 v[36:39], v[128:131], v[96:99], v[36:39]
    ds_read_b128 v[128:131], v157 offset:12800
    buffer_load_dwordx4 v[72:75], v175, s[64:67], s27 offen offset:1024 sc1
    s_waitcnt lgkmcnt(2)
    v_mfma_f32_16x16x32_bf16 v[136:139], v[112:115], v[84:87], v[136:139]
    v_mfma_f32_16x16x32_bf16 v[16:19], v[112:115], v[88:91], v[16:19]
    v_mfma_f32_16x16x32_bf16 v[20:23], v[112:115], v[92:95], v[20:23]
    v_mfma_f32_16x16x32_bf16 v[24:27], v[112:115], v[96:99], v[24:27]
    ds_read_b128 v[112:115], v157 offset:512
    buffer_load_dwordx4 v[76:79], v175, s[64:67], s29 offen offset:0 sc1
    s_waitcnt vmcnt(9)
    v_mfma_f32_16x16x32_bf16 v[148:151], a[212:215], v[100:103], v[148:151]
    v_mfma_f32_16x16x32_bf16 v[40:43], a[212:215], v[104:107], v[40:43]
    s_waitcnt vmcnt(7)
    v_mfma_f32_16x16x32_bf16 v[44:47], a[212:215], v[108:111], v[44:47]
    v_mfma_f32_16x16x32_bf16 v[48:51], a[212:215], v[120:123], v[48:51]
    buffer_load_dwordx4 v[84:87], v175, s[64:67], s29 offen offset:1024 sc1
    s_waitcnt lgkmcnt(2)
    v_mfma_f32_16x16x32_bf16 v[140:143], v[124:127], v[100:103], v[140:143]
    v_mfma_f32_16x16x32_bf16 v[52:55], v[124:127], v[104:107], v[52:55]
    v_mfma_f32_16x16x32_bf16 v[56:59], v[124:127], v[108:111], v[56:59]
    v_mfma_f32_16x16x32_bf16 v[0:3], v[124:127], v[120:123], v[0:3]
    ds_read_b128 v[124:127], v157 offset:4608
    buffer_load_dwordx4 v[88:91], v175, s[64:67], s29 offen offset:2048 sc1
    s_waitcnt lgkmcnt(2)
    v_mfma_f32_16x16x32_bf16 v[144:147], v[128:131], v[100:103], v[144:147]
    v_mfma_f32_16x16x32_bf16 v[4:7], v[128:131], v[104:107], v[4:7]
    v_mfma_f32_16x16x32_bf16 v[8:11], v[128:131], v[108:111], v[8:11]
    v_mfma_f32_16x16x32_bf16 v[12:15], v[128:131], v[120:123], v[12:15]
    buffer_load_dwordx4 v[92:95], v175, s[64:67], s29 offen offset:3072 sc1
    s_waitcnt lgkmcnt(1)
    v_mfma_f32_16x16x32_bf16 v[132:135], v[112:115], v[100:103], v[132:135]
    v_mfma_f32_16x16x32_bf16 v[28:31], v[112:115], v[104:107], v[28:31]
    v_mfma_f32_16x16x32_bf16 v[32:35], v[112:115], v[108:111], v[32:35]
    v_mfma_f32_16x16x32_bf16 v[36:39], v[112:115], v[120:123], v[36:39]
    buffer_load_dwordx4 v[96:99], v175, s[64:67], s30 offen offset:0 sc1
    s_waitcnt lgkmcnt(0)
    v_mfma_f32_16x16x32_bf16 v[136:139], v[124:127], v[100:103], v[136:139]
    v_mfma_f32_16x16x32_bf16 v[16:19], v[124:127], v[104:107], v[16:19]
    v_mfma_f32_16x16x32_bf16 v[20:23], v[124:127], v[108:111], v[20:23]
    v_mfma_f32_16x16x32_bf16 v[24:27], v[124:127], v[120:123], v[24:27]
    buffer_load_dwordx4 v[100:103], v175, s[64:67], s30 offen offset:1024 sc1
    s_waitcnt vmcnt(10)
    v_mfma_f32_16x16x32_bf16 v[28:31], a[232:235], v[80:83], v[28:31]
    v_mfma_f32_16x16x32_bf16 v[28:31], a[236:239], v[116:119], v[28:31]
    s_waitcnt vmcnt(8)
    v_mfma_f32_16x16x32_bf16 v[28:31], a[240:243], v[64:67], v[28:31]
    v_mfma_f32_16x16x32_bf16 v[28:31], a[244:247], v[60:63], v[28:31]
    buffer_load_dwordx4 v[104:107], v175, s[64:67], s32 offen offset:0 sc1
    s_waitcnt vmcnt(7)
    v_mfma_f32_16x16x32_bf16 v[28:31], v[224:227], v[68:71], v[28:31]
    s_add_u32 s3, s77, 1
    s_and_b32 s3, s3, 3
    v_mfma_f32_16x16x32_bf16 v[28:31], v[228:231], v[72:75], v[28:31]
    s_mul_i32 s3, s3, 15360
    v_add_u32 v165, s3, v153
    v_mfma_f32_16x16x32_bf16 v[16:19], v[176:179], v[80:83], v[16:19]
    v_mfma_f32_16x16x32_bf16 v[16:19], v[180:183], v[116:119], v[16:19]
    buffer_load_dwordx4 v[108:111], v175, s[64:67], s32 offen offset:1024 sc1
    s_mul_i32 s8, s79, 163840
    v_mov_b64 v[112:113], 0
    v_mov_b64 v[114:115], 0
    v_mfma_f32_16x16x32_bf16 v[16:19], v[184:187], v[64:67], v[16:19]
    s_mul_i32 s12, s77, 20480
    s_mul_i32 s9, s78, 2560
    v_mov_b64 v[124:125], 0
    v_mov_b64 v[126:127], 0
    v_mfma_f32_16x16x32_bf16 v[16:19], v[188:191], v[60:63], v[16:19]
    ds_write_b128 v165, v[28:31] offset:0
    s_add_u32 s9, s9, s8
    v_mov_b64 v[128:129], 0
    v_mov_b64 v[130:131], 0
    v_mfma_f32_16x16x32_bf16 v[16:19], v[232:235], v[68:71], v[16:19]
    s_lshl_b32 s85, s85, 4
    s_lshl_b32 s90, s90, 4
    v_mfma_f32_16x16x32_bf16 v[16:19], v[236:239], v[72:75], v[16:19]
    buffer_load_dwordx4 v[120:123], v175, s[64:67], s32 offen offset:2048 sc1
    s_lshl_b32 s72, s72, 4
    v_mfma_f32_16x16x32_bf16 v[52:55], v[192:195], v[80:83], v[52:55]
    s_add_u32 s72, s72, s8
    s_lshl_b32 s73, s73, 4
    v_mfma_f32_16x16x32_bf16 v[52:55], v[196:199], v[116:119], v[52:55]
    s_add_u32 s73, s73, s8
    s_lshl_b32 s74, s74, 4
    v_mfma_f32_16x16x32_bf16 v[52:55], v[200:203], v[64:67], v[52:55]
    s_add_u32 s74, s74, s8
    s_lshl_b32 s75, s75, 4
    v_mfma_f32_16x16x32_bf16 v[52:55], v[204:207], v[60:63], v[52:55]
    ds_write_b128 v165, v[16:19] offset:1024
    s_add_u32 s75, s75, s8
    v_mfma_f32_16x16x32_bf16 v[52:55], v[240:243], v[68:71], v[52:55]
    s_lshl_b32 s76, s76, 4
    s_add_u32 s76, s76, s8
    v_mfma_f32_16x16x32_bf16 v[52:55], v[244:247], v[72:75], v[52:55]
    s_lshl_b32 s8, s81, 13
    v_add_u32 v158, s8, v153
    v_mfma_f32_16x16x32_bf16 v[4:7], v[208:211], v[80:83], v[4:7]
    v_xor_b32 v159, 0x2000, v158
    v_add_u32 v173, s12, v153
    v_mfma_f32_16x16x32_bf16 v[4:7], v[212:215], v[116:119], v[4:7]
    s_add_u32 s12, s12, s9
    v_mfma_f32_16x16x32_bf16 v[4:7], v[216:219], v[64:67], v[4:7]
    v_mfma_f32_16x16x32_bf16 v[4:7], v[220:223], v[60:63], v[4:7]
    ds_write_b128 v165, v[52:55] offset:2048
    v_mfma_f32_16x16x32_bf16 v[4:7], v[248:251], v[68:71], v[4:7]
    v_mfma_f32_16x16x32_bf16 v[4:7], v[252:255], v[72:75], v[4:7]
    v_mfma_f32_16x16x32_bf16 v[40:43], a[216:219], v[80:83], v[40:43]
    buffer_load_dwordx4 v[80:83], v175, s[64:67], s32 offen offset:3072 sc1
    v_mfma_f32_16x16x32_bf16 v[40:43], a[220:223], v[116:119], v[40:43]
    v_mfma_f32_16x16x32_bf16 v[40:43], a[224:227], v[64:67], v[40:43]
    v_mfma_f32_16x16x32_bf16 v[40:43], a[228:231], v[60:63], v[40:43]
    s_nop 2
    ds_write_b128 v165, v[4:7] offset:3072
    v_mfma_f32_16x16x32_bf16 v[40:43], a[248:251], v[68:71], v[40:43]
    buffer_load_dwordx4 v[116:119], v175, s[64:67], s33 offen offset:0 sc1
    v_mfma_f32_16x16x32_bf16 v[40:43], a[252:255], v[72:75], v[40:43]
    s_waitcnt vmcnt(9)
    v_mfma_f32_16x16x32_bf16 v[32:35], a[232:235], v[76:79], v[32:35]
    v_mfma_f32_16x16x32_bf16 v[32:35], a[236:239], v[84:87], v[32:35]
    s_waitcnt vmcnt(7)
    v_mfma_f32_16x16x32_bf16 v[32:35], a[240:243], v[88:91], v[32:35]
    buffer_load_dwordx4 v[64:67], v175, s[64:67], s33 offen offset:1024 sc1
    v_mfma_f32_16x16x32_bf16 v[32:35], a[244:247], v[92:95], v[32:35]
    s_nop 0
    ds_write_b128 v165, v[40:43] offset:4096
    s_waitcnt vmcnt(6)
    v_mfma_f32_16x16x32_bf16 v[32:35], v[224:227], v[96:99], v[32:35]
    s_add_u32 s3, s77, 2
    s_and_b32 s3, s3, 3
    v_mfma_f32_16x16x32_bf16 v[32:35], v[228:231], v[100:103], v[32:35]
    s_mul_i32 s3, s3, 15360
    v_add_u32 v165, s3, v153
    v_mfma_f32_16x16x32_bf16 v[20:23], v[176:179], v[76:79], v[20:23]
    buffer_load_dwordx4 v[60:63], v175, s[64:67], s23 offen offset:3072 sc1
    v_mfma_f32_16x16x32_bf16 v[20:23], v[180:183], v[84:87], v[20:23]
    v_mfma_f32_16x16x32_bf16 v[20:23], v[184:187], v[88:91], v[20:23]
    v_mfma_f32_16x16x32_bf16 v[20:23], v[188:191], v[92:95], v[20:23]
    s_nop 0
    ds_write_b128 v165, v[32:35] offset:5120
    v_mfma_f32_16x16x32_bf16 v[20:23], v[232:235], v[96:99], v[20:23]
    buffer_load_dwordx4 v[68:71], v175, s[64:67], s24 offen offset:0 sc1
    v_mfma_f32_16x16x32_bf16 v[20:23], v[236:239], v[100:103], v[20:23]
    v_mfma_f32_16x16x32_bf16 v[56:59], v[192:195], v[76:79], v[56:59]
    v_mfma_f32_16x16x32_bf16 v[56:59], v[196:199], v[84:87], v[56:59]
    v_mfma_f32_16x16x32_bf16 v[56:59], v[200:203], v[88:91], v[56:59]
    buffer_load_dwordx4 v[72:75], v175, s[64:67], s24 offen offset:1024 sc1
    v_mfma_f32_16x16x32_bf16 v[56:59], v[204:207], v[92:95], v[56:59]
    s_nop 2
    ds_write_b128 v165, v[20:23] offset:6144
    s_lshl_b32 s8, s77, 2
    v_mfma_f32_16x16x32_bf16 v[56:59], v[240:243], v[96:99], v[56:59]
    s_add_u32 s8, s8, 61440
    v_bfe_u32 v172, v152, 2, 2
    v_mfma_f32_16x16x32_bf16 v[56:59], v[244:247], v[100:103], v[56:59]
    v_lshl_add_u32 v166, v172, 5, s8
    v_bfe_u32 v172, v152, 0, 1
    v_mfma_f32_16x16x32_bf16 v[8:11], v[208:211], v[76:79], v[8:11]
    v_lshl_add_u32 v166, v172, 4, v166
    v_bfe_u32 v172, v152, 1, 1
    v_mfma_f32_16x16x32_bf16 v[8:11], v[212:215], v[84:87], v[8:11]
    v_lshl_add_u32 v166, v172, 1, v166
    v_lshrrev_b32 v172, 4, v152
    v_mfma_f32_16x16x32_bf16 v[8:11], v[216:219], v[88:91], v[8:11]
    v_lshl_add_u32 v167, v172, 9, v166
    v_lshl_add_u32 v166, v172, 10, v166
    v_mfma_f32_16x16x32_bf16 v[8:11], v[220:223], v[92:95], v[8:11]
    ds_write_b128 v165, v[56:59] offset:7168
    v_mfma_f32_16x16x32_bf16 v[8:11], v[248:251], v[96:99], v[8:11]
    v_mfma_f32_16x16x32_bf16 v[8:11], v[252:255], v[100:103], v[8:11]
    v_mfma_f32_16x16x32_bf16 v[44:47], a[216:219], v[76:79], v[44:47]
    v_mfma_f32_16x16x32_bf16 v[44:47], a[220:223], v[84:87], v[44:47]
    v_mfma_f32_16x16x32_bf16 v[44:47], a[224:227], v[88:91], v[44:47]
    v_mfma_f32_16x16x32_bf16 v[44:47], a[228:231], v[92:95], v[44:47]
    s_nop 3
    ds_write_b128 v165, v[8:11] offset:8192
    v_mfma_f32_16x16x32_bf16 v[44:47], a[248:251], v[96:99], v[44:47]
    v_mfma_f32_16x16x32_bf16 v[44:47], a[252:255], v[100:103], v[44:47]
    s_waitcnt vmcnt(7)
    v_mfma_f32_16x16x32_bf16 v[36:39], a[232:235], v[104:107], v[36:39]
    v_mfma_f32_16x16x32_bf16 v[36:39], a[236:239], v[108:111], v[36:39]
    s_waitcnt vmcnt(5)
    v_mfma_f32_16x16x32_bf16 v[36:39], a[240:243], v[120:123], v[36:39]
    v_mfma_f32_16x16x32_bf16 v[36:39], a[244:247], v[80:83], v[36:39]
    s_nop 1
    ds_write_b128 v165, v[44:47] offset:9216
    s_waitcnt vmcnt(3)
    v_mfma_f32_16x16x32_bf16 v[36:39], v[224:227], v[116:119], v[36:39]
    s_add_u32 s3, s77, 3
    s_and_b32 s3, s3, 3
    v_mfma_f32_16x16x32_bf16 v[36:39], v[228:231], v[64:67], v[36:39]
    s_mul_i32 s3, s3, 15360
    v_add_u32 v165, s3, v153
    v_mfma_f32_16x16x32_bf16 v[24:27], v[176:179], v[104:107], v[24:27]
    v_mfma_f32_16x16x32_bf16 v[24:27], v[180:183], v[108:111], v[24:27]
    v_mfma_f32_16x16x32_bf16 v[24:27], v[184:187], v[120:123], v[24:27]
    v_mfma_f32_16x16x32_bf16 v[24:27], v[188:191], v[80:83], v[24:27]
    s_nop 1
    ds_write_b128 v165, v[36:39] offset:10240
    v_mfma_f32_16x16x32_bf16 v[24:27], v[232:235], v[116:119], v[24:27]
    v_mfma_f32_16x16x32_bf16 v[24:27], v[236:239], v[64:67], v[24:27]
    s_waitcnt lgkmcnt(1)
    s_barrier
    v_mfma_f32_16x16x32_bf16 v[0:3], v[192:195], v[104:107], v[0:3]
    ds_read_b128 v[28:31], v154 offset:0
    v_mfma_f32_16x16x32_bf16 v[0:3], v[196:199], v[108:111], v[0:3]
    ds_read_b128 v[16:19], v154 offset:1024
    s_add_u32 m0, s100, 61440
    s_nop 0
    buffer_load_dwordx4 v164, s[68:71], s6 offen sc1 lds
    v_mfma_f32_16x16x32_bf16 v[0:3], v[200:203], v[120:123], v[0:3]
    ds_read_b128 v[52:55], v154 offset:2048
    v_mfma_f32_16x16x32_bf16 v[0:3], v[204:207], v[80:83], v[0:3]
    ds_read_b128 v[4:7], v154 offset:3072
    ds_write_b128 v165, v[24:27] offset:11264
    v_mfma_f32_16x16x32_bf16 v[0:3], v[240:243], v[116:119], v[0:3]
    ds_read_b128 v[40:43], v154 offset:4096
    s_add_u32 m0, s100, 62464
    s_add_u32 s83, s6, 32768
    buffer_load_dwordx4 v164, s[68:71], s83 offen sc1 lds
    v_mfma_f32_16x16x32_bf16 v[0:3], v[244:247], v[64:67], v[0:3]
    ds_read_b128 v[32:35], v154 offset:5120
    v_mfma_f32_16x16x32_bf16 v[12:15], v[208:211], v[104:107], v[12:15]
    ds_read_b128 v[20:23], v154 offset:6144
    s_waitcnt lgkmcnt(7)
    v_add_f32 v132, v132, v28
    v_add_f32 v133, v133, v29
    v_mfma_f32_16x16x32_bf16 v[12:15], v[212:215], v[108:111], v[12:15]
    ds_read_b128 v[56:59], v154 offset:7168
    s_add_u32 m0, s5, 69632
    s_mov_b32 exec_hi, 0
    buffer_load_dwordx4 v164, s[68:71], s7 offen sc1 lds
    s_mov_b32 exec_hi, -1
    v_add_f32 v134, v134, v30
    v_add_f32 v135, v135, v31
    v_mfma_f32_16x16x32_bf16 v[12:15], v[216:219], v[120:123], v[12:15]
    ds_read_b128 v[8:11], v154 offset:8192
    s_waitcnt lgkmcnt(8)
    v_add_f32 v136, v136, v16
    v_add_f32 v137, v137, v17
    v_mfma_f32_16x16x32_bf16 v[12:15], v[220:223], v[80:83], v[12:15]
    ds_read_b128 v[44:47], v154 offset:9216
    ds_write_b128 v165, v[0:3] offset:12288
    v_add_f32 v138, v138, v18
    v_add_f32 v139, v139, v19
    v_mfma_f32_16x16x32_bf16 v[12:15], v[248:251], v[116:119], v[12:15]
    s_waitcnt lgkmcnt(9)
    v_add_f32 v140, v140, v52
    v_add_f32 v141, v141, v53
    v_mfma_f32_16x16x32_bf16 v[12:15], v[252:255], v[64:67], v[12:15]
    v_add_f32 v142, v142, v54
    v_add_f32 v143, v143, v55
    v_mfma_f32_16x16x32_bf16 v[48:51], a[216:219], v[104:107], v[48:51]
    s_waitcnt lgkmcnt(8)
    v_add_f32 v144, v144, v4
    v_add_f32 v145, v145, v5
    v_mfma_f32_16x16x32_bf16 v[48:51], a[220:223], v[108:111], v[48:51]
    v_add_f32 v146, v146, v6
    v_add_f32 v147, v147, v7
    v_mfma_f32_16x16x32_bf16 v[48:51], a[224:227], v[120:123], v[48:51]
    s_waitcnt lgkmcnt(6)
    v_add_f32 v148, v148, v40
    v_add_f32 v149, v149, v41
    v_mfma_f32_16x16x32_bf16 v[48:51], a[228:231], v[80:83], v[48:51]
    ds_write_b128 v165, v[12:15] offset:13312
    v_add_f32 v150, v150, v42
    v_add_f32 v151, v151, v43
    v_mfma_f32_16x16x32_bf16 v[48:51], a[248:251], v[116:119], v[48:51]
    v_mfma_f32_16x16x32_bf16 v[48:51], a[252:255], v[64:67], v[48:51]
    s_waitcnt lgkmcnt(6)
    s_waitcnt vmcnt(5)
    v_mfma_f32_16x16x32_bf16 v[32:35], a[244:247], v[60:63], v[32:35]
    s_waitcnt vmcnt(4)
    v_mfma_f32_16x16x32_bf16 v[32:35], v[224:227], v[68:71], v[32:35]
    s_waitcnt vmcnt(3)
    v_mfma_f32_16x16x32_bf16 v[32:35], v[228:231], v[72:75], v[32:35]
    v_mov_b64 v[116:117], 0
    v_mov_b64 v[118:119], 0
    s_waitcnt lgkmcnt(5)
    v_mfma_f32_16x16x32_bf16 v[20:23], v[188:191], v[60:63], v[20:23]
    ds_write_b128 v165, v[48:51] offset:14336
    v_mov_b64 v[120:121], 0
    v_mov_b64 v[122:123], 0
    v_mfma_f32_16x16x32_bf16 v[20:23], v[232:235], v[68:71], v[20:23]
    v_mfma_f32_16x16x32_bf16 v[20:23], v[236:239], v[72:75], v[20:23]
    s_waitcnt lgkmcnt(5)
    v_mfma_f32_16x16x32_bf16 v[56:59], v[204:207], v[60:63], v[56:59]
    v_mfma_f32_16x16x32_bf16 v[56:59], v[240:243], v[68:71], v[56:59]
    v_mfma_f32_16x16x32_bf16 v[56:59], v[244:247], v[72:75], v[56:59]
    s_waitcnt lgkmcnt(0)
    s_barrier
    v_mfma_f32_16x16x32_bf16 v[8:11], v[220:223], v[60:63], v[8:11]
    ds_read_b128 v[28:31], v154 offset:10240
    v_mfma_f32_16x16x32_bf16 v[8:11], v[248:251], v[68:71], v[8:11]
    ds_read_b128 v[16:19], v154 offset:11264
    v_mfma_f32_16x16x32_bf16 v[8:11], v[252:255], v[72:75], v[8:11]
    ds_read_b128 v[52:55], v154 offset:12288
    v_mfma_f32_16x16x32_bf16 v[44:47], a[228:231], v[60:63], v[44:47]
    ds_read_b128 v[4:7], v154 offset:13312
    v_mfma_f32_16x16x32_bf16 v[44:47], a[248:251], v[68:71], v[44:47]
    ds_read_b128 v[40:43], v154 offset:14336
    v_mfma_f32_16x16x32_bf16 v[44:47], a[252:255], v[72:75], v[44:47]
    v_pk_add_f32 v[132:133], v[132:133], v[32:33]
    v_pk_add_f32 v[134:135], v[134:135], v[34:35]
    v_pk_add_f32 v[136:137], v[136:137], v[20:21]
    v_pk_add_f32 v[138:139], v[138:139], v[22:23]
    v_pk_add_f32 v[140:141], v[140:141], v[56:57]
    v_pk_add_f32 v[142:143], v[142:143], v[58:59]
    v_pk_add_f32 v[144:145], v[144:145], v[8:9]
    v_pk_add_f32 v[146:147], v[146:147], v[10:11]
    v_pk_add_f32 v[148:149], v[148:149], v[44:45]
    v_pk_add_f32 v[150:151], v[150:151], v[46:47]
    s_waitcnt lgkmcnt(4)
    v_pk_add_f32 v[132:133], v[132:133], v[28:29]
    v_pk_add_f32 v[134:135], v[134:135], v[30:31]
    s_waitcnt lgkmcnt(3)
    v_pk_add_f32 v[136:137], v[136:137], v[16:17]
    v_pk_add_f32 v[138:139], v[138:139], v[18:19]
    s_waitcnt lgkmcnt(2)
    v_pk_add_f32 v[140:141], v[140:141], v[52:53]
    v_pk_add_f32 v[142:143], v[142:143], v[54:55]
    s_waitcnt lgkmcnt(1)
    v_pk_add_f32 v[144:145], v[144:145], v[4:5]
    v_pk_add_f32 v[146:147], v[146:147], v[6:7]
    s_waitcnt lgkmcnt(0)
    v_pk_add_f32 v[148:149], v[148:149], v[40:41]
    v_pk_add_f32 v[150:151], v[150:151], v[42:43]
    v_pk_add_f32 v[4:5], v[132:133], v[134:135]
    v_pk_mul_f32 v[6:7], v[132:133], v[132:133]
    v_pk_fma_f32 v[6:7], v[134:135], v[134:135], v[6:7]
    v_pk_fma_f32 v[6:7], v[136:137], v[136:137], v[6:7]
    v_pk_add_f32 v[4:5], v[4:5], v[136:137]
    v_pk_fma_f32 v[6:7], v[138:139], v[138:139], v[6:7]
    v_pk_add_f32 v[4:5], v[4:5], v[138:139]
    v_pk_fma_f32 v[6:7], v[140:141], v[140:141], v[6:7]
    v_pk_add_f32 v[4:5], v[4:5], v[140:141]
    v_pk_fma_f32 v[6:7], v[142:143], v[142:143], v[6:7]
    v_pk_add_f32 v[4:5], v[4:5], v[142:143]
    v_pk_fma_f32 v[6:7], v[144:145], v[144:145], v[6:7]
    v_pk_add_f32 v[4:5], v[4:5], v[144:145]
    v_pk_fma_f32 v[6:7], v[146:147], v[146:147], v[6:7]
    v_pk_add_f32 v[4:5], v[4:5], v[146:147]
    v_pk_fma_f32 v[6:7], v[148:149], v[148:149], v[6:7]
    v_pk_add_f32 v[4:5], v[4:5], v[148:149]
    v_pk_fma_f32 v[6:7], v[150:151], v[150:151], v[6:7]
    v_pk_add_f32 v[4:5], v[4:5], v[150:151]
    v_add_f32 v6, v6, v7
    v_add_f32 v4, v4, v5
    v_mov_b32 v1, s82
    s_nop 0
    v_permlane32_swap_b32 v4, v6
    v_add_f32 v4, v4, v6
    v_mov_b32 v6, v4
    s_nop 1
    v_permlane16_swap_b32 v4, v6
    v_add_f32 v0, v4, v6

    s_cmp_eq_u32 s88, 0
    s_cbranch_scc1 Lss_17
    global_store_dwordx2 v155, v[0:1], s[98:99]
Lsd_18:
    s_waitcnt vmcnt(1)
    ds_read2st64_b32 v[8:9], v170 offset1:2
    ds_read2st64_b32 v[10:11], v170 offset0:4 offset1:6
    ds_read_b32 v12, v171
    v_and_b32 v84, 0xf0, v153
    v_lshrrev_b32 v85, 5, v152
    v_lshl_add_u32 v84, v85, 8, v84
    v_bfe_u32 v85, v152, 2, 3
    v_mul_u32_u24 v85, 2560, v85
    v_and_b32 v86, 3, v152
    v_min_u32 v86, 2, v86
    v_lshl_add_u32 v85, v86, 10, v85
    s_mul_i32 s3, s78, 2560
    s_sub_u32 s3, s12, s3
    v_add_u32 v85, s3, v85
    s_waitcnt lgkmcnt(0)
    v_max3_u32 v169, v8, v9, v10
    v_max3_u32 v169, v169, v11, v12
    v_cmp_eq_u32 s[96:97], -1, v169
    s_cmp_lg_u64 s[96:97], 0
    s_cbranch_scc1 L_gcr
L_gc:
    global_load_dwordx4 v[0:3], v163, s[98:99] sc1
    global_load_dwordx4 v[4:7], v163, s[98:99] offset:256 sc1
    s_barrier
    ds_read_u16_d16_hi v112, v166 offset:0
    ds_read_u16_d16_hi v113, v166 offset:128
    ds_read_u16_d16_hi v114, v166 offset:256
    ds_read_u16_d16_hi v115, v166 offset:384
    ds_read_u16_d16_hi v116, v166 offset:512
    ds_read_u16_d16_hi v117, v166 offset:640
    ds_read_u16_d16_hi v118, v166 offset:768
    ds_read_u16_d16_hi v119, v166 offset:896
    ds_read_u16_d16_hi v120, v166 offset:4096
    ds_read_u16_d16_hi v121, v166 offset:4224
    ds_read_u16_d16_hi v122, v166 offset:4352
    ds_read_u16_d16_hi v123, v166 offset:4480
    ds_read_u16_d16_hi v124, v166 offset:4608
    ds_read_u16_d16_hi v125, v166 offset:4736
    ds_read_u16_d16_hi v126, v166 offset:4864
    ds_read_u16_d16_hi v127, v166 offset:4992
    ds_read_u16_d16_hi v128, v167 offset:8192
    ds_read_u16_d16_hi v129, v167 offset:8320
    ds_read_u16_d16_hi v130, v167 offset:8448
    ds_read_u16_d16_hi v131, v167 offset:8576
    s_waitcnt lgkmcnt(0)
    s_waitcnt vmcnt(0)
    L_s1:
    v_min3_u32 v168, v1, v3, v5
    v_max3_u32 v1, v1, v3, v5
    v_min3_u32 v168, v168, v7, s82
    v_max3_u32 v1, v1, v7, s82
    v_cmp_ne_u32 vcc, v168, v1

    s_cbranch_vccnz L_s1r
    v_add_f32 v0, v0, v4
    v_add_f32 v2, v2, v6
    s_nop 1
    v_permlane32_swap_b32 v0, v2
    v_add_f32 v0, v0, v2
    v_mov_b32 v2, v0
    s_nop 1
    v_permlane16_swap_b32 v0, v2
    v_add_f32 v0, v0, v2
    v_mov_b32 v2, v0
    s_nop 1
    v_permlane32_swap_b32 v0, v2
    v_mul_f32 v0, 0x3acccccd, v0
    v_mov_b32 v166, 0x3727c5ac
    v_fmac_f32 v166, 0x3acccccd, v2
    v_fma_f32 v166, -v0, v0, v166
    v_max_f32 v166, 0x3727c5ac, v166
    v_rsq_f32 v166, v166
    s_nop 0
    v_mul_f32_e64 v167, -v0, v166
    v_pk_fma_f32 v[32:33], v[148:149], v[166:167], v[166:167] op_sel:[0,0,1] op_sel_hi:[1,0,1]
    v_pk_fma_f32 v[34:35], v[150:151], v[166:167], v[166:167] op_sel:[0,0,1] op_sel_hi:[1,0,1]
    v_pk_fma_f32 v[16:17], v[132:133], v[166:167], v[166:167] op_sel:[0,0,1] op_sel_hi:[1,0,1]
    v_pk_fma_f32 v[18:19], v[134:135], v[166:167], v[166:167] op_sel:[0,0,1] op_sel_hi:[1,0,1]
    v_pk_fma_f32 v[20:21], v[136:137], v[166:167], v[166:167] op_sel:[0,0,1] op_sel_hi:[1,0,1]
    v_pk_fma_f32 v[22:23], v[138:139], v[166:167], v[166:167] op_sel:[0,0,1] op_sel_hi:[1,0,1]
    v_pk_fma_f32 v[24:25], v[140:141], v[166:167], v[166:167] op_sel:[0,0,1] op_sel_hi:[1,0,1]
    v_pk_fma_f32 v[26:27], v[142:143], v[166:167], v[166:167] op_sel:[0,0,1] op_sel_hi:[1,0,1]
    v_pk_fma_f32 v[28:29], v[144:145], v[166:167], v[166:167] op_sel:[0,0,1] op_sel_hi:[1,0,1]
    v_pk_fma_f32 v[30:31], v[146:147], v[166:167], v[166:167] op_sel:[0,0,1] op_sel_hi:[1,0,1]
    v_pk_fma_f32 v[148:149], v[32:33], v[128:129], v[148:149]
    v_pk_fma_f32 v[150:151], v[34:35], v[130:131], v[150:151]
    v_pk_fma_f32 v[132:133], v[16:17], v[112:113], v[132:133]
    v_pk_fma_f32 v[134:135], v[18:19], v[114:115], v[134:135]
    v_pk_fma_f32 v[136:137], v[20:21], v[116:117], v[136:137]
    v_pk_fma_f32 v[138:139], v[22:23], v[118:119], v[138:139]
    v_pk_fma_f32 v[140:141], v[24:25], v[120:121], v[140:141]
    v_pk_fma_f32 v[142:143], v[26:27], v[122:123], v[142:143]
    v_pk_fma_f32 v[144:145], v[28:29], v[124:125], v[144:145]
    v_pk_fma_f32 v[146:147], v[30:31], v[126:127], v[146:147]
    v_cvt_pk_bf16_f32 v44, v148, v149
    v_cvt_pk_bf16_f32 v45, v150, v151
    v_or_b32 v44, 1, v44
    v_cvt_pk_bf16_f32 v36, v132, v133
    v_cvt_pk_bf16_f32 v37, v134, v135
    v_or_b32 v36, 1, v36
    v_permlane16_swap_b32 v44, v46
    v_permlane16_swap_b32 v45, v47
    v_cvt_pk_bf16_f32 v38, v136, v137
    v_cvt_pk_bf16_f32 v39, v138, v139
    v_or_b32 v38, 1, v38
    v_cvt_pk_bf16_f32 v40, v140, v141
    v_cvt_pk_bf16_f32 v41, v142, v143
    v_or_b32 v40, 1, v40
    v_cvt_pk_bf16_f32 v42, v144, v145
    v_cvt_pk_bf16_f32 v43, v146, v147
    v_or_b32 v42, 1, v42
    s_cmp_eq_u32 s88, 0
    s_cbranch_scc1 Lss_19
    buffer_store_dwordx4 v[36:39], v153, s[64:67], s12 offen
    buffer_store_dwordx4 v[40:43], v153, s[64:67], s12 offen offset:1024
    s_mov_b32 exec_lo, 0xffff
    s_mov_b32 exec_hi, 0xffff
    buffer_store_dwordx4 v[44:47], v84, s[64:67], s12 offen offset:2048
Lsd_20:
    s_mov_b64 exec, -1
    v_pk_add_f32 v[4:5], v[132:133], v[134:135]
    v_pk_mul_f32 v[6:7], v[132:133], v[132:133]
    v_pk_fma_f32 v[6:7], v[134:135], v[134:135], v[6:7]
    v_pk_fma_f32 v[6:7], v[136:137], v[136:137], v[6:7]
    v_pk_add_f32 v[4:5], v[4:5], v[136:137]
    v_pk_fma_f32 v[6:7], v[138:139], v[138:139], v[6:7]
    v_pk_add_f32 v[4:5], v[4:5], v[138:139]
    v_pk_fma_f32 v[6:7], v[140:141], v[140:141], v[6:7]
    v_pk_add_f32 v[4:5], v[4:5], v[140:141]
    v_pk_fma_f32 v[6:7], v[142:143], v[142:143], v[6:7]
    v_pk_add_f32 v[4:5], v[4:5], v[142:143]
    v_pk_fma_f32 v[6:7], v[144:145], v[144:145], v[6:7]
    v_pk_add_f32 v[4:5], v[4:5], v[144:145]
    v_pk_fma_f32 v[6:7], v[146:147], v[146:147], v[6:7]
    v_pk_add_f32 v[4:5], v[4:5], v[146:147]
    v_pk_fma_f32 v[6:7], v[148:149], v[148:149], v[6:7]
    v_pk_add_f32 v[4:5], v[4:5], v[148:149]
    v_pk_fma_f32 v[6:7], v[150:151], v[150:151], v[6:7]
    v_pk_add_f32 v[4:5], v[4:5], v[150:151]
    v_add_f32 v6, v6, v7
    v_add_f32 v4, v4, v5
    v_mov_b32 v1, s82
    s_nop 0
    v_permlane32_swap_b32 v4, v6
    v_add_f32 v4, v4, v6
    v_mov_b32 v6, v4
    s_nop 1
    v_permlane16_swap_b32 v4, v6
    v_add_f32 v0, v4, v6

    s_add_u32 s98, s98, 0x40000
    s_addc_u32 s99, s99, 0
    s_cmp_eq_u32 s88, 0
    s_cbranch_scc1 Lss_21
    global_store_dwordx2 v155, v[0:1], s[98:99]
Lsd_22:
    v_bfe_u32 v122, v152, 2, 2
    s_lshl_b32 s3, s77, 4
    s_add_u32 s3, s3, 92160
    v_lshl_add_u32 v120, v122, 6, s3
    s_lshl_b32 s3, s77, 3
    s_add_u32 s3, s3, 92672
    v_lshl_add_u32 v121, v122, 6, s3
    v_bfe_u32 v122, v152, 0, 2
    v_lshl_add_u32 v120, v122, 2, v120
    v_bfe_u32 v122, v152, 0, 1
    v_lshl_add_u32 v121, v122, 5, v121
    v_bfe_u32 v122, v152, 1, 1
    v_lshl_add_u32 v121, v122, 2, v121
    v_and_b32 v122, 15, v152
    s_lshl_b32 s3, s77, 7
    s_add_u32 s3, s3, 81920
    v_lshl_add_u32 v165, v122, 3, s3
    v_bfe_u32 v171, v152, 1, 2
    s_lshl_b32 s3, s77, 5
    s_add_u32 s3, s3, 82432
    v_lshl_add_u32 v171, v171, 3, s3
    v_not_b32 v122, v152
    v_lshlrev_b32 v122, 28, v122
    v_and_b32 v170, 0x80000000, v122
    v_lshrrev_b32 v122, 4, v152
    s_mov_b32 s3, 92160
    v_lshl_add_u32 v164, v122, 6, s3
    v_and_b32 v48, 1, v152
    v_lshl_add_u32 v50, v48, 5, v164
    v_lshlrev_b32 v48, 2, v48
    v_lshl_add_u32 v48, v122, 8, v48
    v_and_b32 v122, 1, v122
    v_xor_b32 v122, s77, v122
    v_lshl_add_u32 v48, v122, 6, v48
    v_bfe_u32 v122, v152, 1, 2
    v_lshl_add_u32 v48, v122, 4, v48
    v_bfe_u32 v122, v152, 3, 1
    v_lshlrev_b32 v122, 12, v122
    s_mov_b32 s3, 0
    v_add3_u32 v48, v122, v48, s3
    v_xor_b32 v49, 8, v48
L_xp:
    s_sub_u32 s101, s101, 1
    s_cbranch_scc1 L_end
    buffer_load_dword v168, v85, s[64:67], 0 offen sc1
    s_add_u32 m0, s100, 0
    s_nop 0
    buffer_load_dwordx4 v173, s[64:67], s72 offen offset:0 sc1 lds
    s_add_u32 m0, s100, 8192
    s_add_u32 s83, s72, 10240
    buffer_load_dwordx4 v173, s[64:67], s83 offen offset:0 sc1 lds
    s_add_u32 m0, s100, 0
    s_nop 0
    buffer_load_dwordx4 v173, s[64:67], s72 offen offset:1024 sc1 lds
    s_add_u32 m0, s100, 8192
    s_add_u32 s83, s72, 10240
    buffer_load_dwordx4 v173, s[64:67], s83 offen offset:1024 sc1 lds
    s_waitcnt vmcnt(4)
    v_and_b32 v168, 1, v168
    v_cmp_ne_u32 vcc, 1, v168
    s_cbranch_vccnz L_xp
    s_waitcnt vmcnt(2)
    s_barrier
    ds_read_b128 v[56:59], v158 offset:0
    ds_read_b128 v[60:63], v158 offset:2048
    ds_read_b128 v[64:67], v158 offset:4096
    ds_read_b128 v[68:71], v158 offset:6144
    s_add_u32 m0, s100, 16384
    s_nop 0
    buffer_load_dwordx4 v173, s[64:67], s73 offen offset:0 sc1 lds
    buffer_load_dwordx4 v173, s[64:67], s73 offen offset:1024 sc1 lds
    s_add_u32 m0, s100, 24576
    s_add_u32 s83, s73, 10240
    buffer_load_dwordx4 v173, s[64:67], s83 offen offset:0 sc1 lds
    buffer_load_dwordx4 v173, s[64:67], s83 offen offset:1024 sc1 lds
    s_waitcnt vmcnt(4)
    s_barrier
    ds_read_b128 v[72:75], v158 offset:1024
    ds_read_b128 v[76:79], v158 offset:3072
    ds_read_b128 v[80:83], v158 offset:5120
    ds_read_b128 v[84:87], v158 offset:7168
    ds_read_b128 v[88:91], v159 offset:0
    ds_read_b128 v[92:95], v159 offset:2048
    ds_read_b128 v[96:99], v159 offset:4096
    ds_read_b128 v[100:103], v159 offset:6144
    s_waitcnt lgkmcnt(8)
    v_bitop3_b32 v169, v56, v60, v64 bitop3:128
    v_bitop3_b32 v169, v169, v68, 1 bitop3:128
    v_cmp_ne_u32 vcc, 1, v169
    s_cbranch_vccnz L_xc0r
L_xc0:
    v_mfma_f32_16x16x32_bf16 v[0:3], v[56:59], a[0:3], 0
    s_add_u32 m0, s100, 32768
    s_nop 0
    buffer_load_dwordx4 v173, s[64:67], s74 offen offset:0 sc1 lds
    v_mfma_f32_16x16x32_bf16 v[16:19], v[56:59], a[8:11], 0
    v_mfma_f32_16x16x32_bf16 v[32:35], v[56:59], a[16:19], 0
    ds_read_b128 v[56:59], v159 offset:1024
    v_mfma_f32_16x16x32_bf16 v[4:7], v[60:63], a[0:3], 0
    buffer_load_dwordx4 v173, s[64:67], s74 offen offset:1024 sc1 lds
    v_mfma_f32_16x16x32_bf16 v[20:23], v[60:63], a[8:11], 0
    v_mfma_f32_16x16x32_bf16 v[36:39], v[60:63], a[16:19], 0
    ds_read_b128 v[60:63], v159 offset:3072
    v_mfma_f32_16x16x32_bf16 v[8:11], v[64:67], a[0:3], 0
    s_add_u32 m0, s100, 40960
    s_add_u32 s83, s74, 10240
    buffer_load_dwordx4 v173, s[64:67], s83 offen offset:0 sc1 lds
    v_mfma_f32_16x16x32_bf16 v[24:27], v[64:67], a[8:11], 0
    s_waitcnt lgkmcnt(6)
    v_bitop3_b32 v169, v72, v76, v80 bitop3:128
    v_bitop3_b32 v169, v169, v84, 1 bitop3:128
    v_mfma_f32_16x16x32_bf16 v[40:43], v[64:67], a[16:19], 0
    ds_read_b128 v[64:67], v159 offset:5120
    v_cmp_ne_u32 vcc, 1, v169
    v_mfma_f32_16x16x32_bf16 v[12:15], v[68:71], a[0:3], 0
    buffer_load_dwordx4 v173, s[64:67], s83 offen offset:1024 sc1 lds
    v_mfma_f32_16x16x32_bf16 v[28:31], v[68:71], a[8:11], 0
    v_mfma_f32_16x16x32_bf16 v[44:47], v[68:71], a[16:19], 0
    ds_read_b128 v[68:71], v159 offset:7168
    s_cbranch_vccnz L_xc1r
L_xc1:
    v_mfma_f32_16x16x32_bf16 v[0:3], v[72:75], a[4:7], v[0:3]
    global_load_dwordx4 v[104:107], v163, s[98:99] sc1
    v_mfma_f32_16x16x32_bf16 v[16:19], v[72:75], a[12:15], v[16:19]
    v_mfma_f32_16x16x32_bf16 v[32:35], v[72:75], a[20:23], v[32:35]
    global_load_dwordx4 v[108:111], v163, s[98:99] offset:256 sc1
    s_lshl_b32 s3, s78, 2
    v_mfma_f32_16x16x32_bf16 v[4:7], v[76:79], a[4:7], v[4:7]
    s_add_u32 s3, s3, s77
    s_lshl_b32 s3, s3, 13
    v_mfma_f32_16x16x32_bf16 v[20:23], v[76:79], a[12:15], v[20:23]
    s_add_u32 m0, s100, 49152
    s_nop 0
    buffer_load_dwordx4 v173, s[64:67], s75 offen offset:0 sc1 lds
    v_mfma_f32_16x16x32_bf16 v[36:39], v[76:79], a[20:23], v[36:39]
    s_add_u32 s3, s3, 9699328
    v_mfma_f32_16x16x32_bf16 v[8:11], v[80:83], a[4:7], v[8:11]
    s_add_u32 s92, s50, s3
    s_addc_u32 s93, s51, 0
    v_mfma_f32_16x16x32_bf16 v[24:27], v[80:83], a[12:15], v[24:27]
    buffer_load_dwordx4 v173, s[64:67], s75 offen offset:1024 sc1 lds
    s_waitcnt lgkmcnt(4)
    v_bitop3_b32 v169, v88, v92, v96 bitop3:128
    v_bitop3_b32 v169, v169, v100, 1 bitop3:128
    v_mfma_f32_16x16x32_bf16 v[40:43], v[80:83], a[20:23], v[40:43]
    s_movk_i32 s94, 8192
    v_cmp_ne_u32 vcc, 1, v169
    v_mfma_f32_16x16x32_bf16 v[12:15], v[84:87], a[4:7], v[12:15]
    s_sub_u32 s21, 31, s79
    s_lshl_b32 s21, s21, 8
    v_mfma_f32_16x16x32_bf16 v[28:31], v[84:87], a[12:15], v[28:31]
    s_add_u32 m0, s100, 57344
    s_add_u32 s83, s75, 10240
    buffer_load_dwordx4 v173, s[64:67], s83 offen offset:0 sc1 lds
    v_mfma_f32_16x16x32_bf16 v[44:47], v[84:87], a[20:23], v[44:47]
    s_lshl_b32 s3, s77, 12
    s_cbranch_vccnz L_xc2r
L_xc2:
    v_mfma_f32_16x16x32_bf16 v[0:3], v[88:91], a[24:27], v[0:3]
    v_and_b32 v52, 16, v152
    v_lshlrev_b32 v52, 2, v52
    v_mfma_f32_16x16x32_bf16 v[16:19], v[88:91], a[32:35], v[16:19]
    buffer_load_dwordx4 v173, s[64:67], s83 offen offset:1024 sc1 lds
    v_xor_b32 v52, v52, v153
    v_mfma_f32_16x16x32_bf16 v[4:7], v[92:95], a[24:27], v[4:7]
    v_add_u32 v52, s3, v52
    v_mfma_f32_16x16x32_bf16 v[20:23], v[92:95], a[32:35], v[20:23]
    s_waitcnt lgkmcnt(0)
    v_bitop3_b32 v169, v56, v60, v64 bitop3:128
    v_bitop3_b32 v169, v169, v68, 1 bitop3:128
    v_mfma_f32_16x16x32_bf16 v[8:11], v[96:99], a[24:27], v[8:11]
    s_add_u32 m0, s100, 65536
    s_nop 0
    buffer_load_dwordx4 v173, s[64:67], s76 offen offset:0 sc1 lds
    v_cmp_ne_u32 vcc, 1, v169
    v_mfma_f32_16x16x32_bf16 v[24:27], v[96:99], a[32:35], v[24:27]
    ds_read_b64 v[128:129], v165 offset:7680
    ds_read_b64 v[130:131], v171 offset:7680
    v_mfma_f32_16x16x32_bf16 v[12:15], v[100:103], a[24:27], v[12:15]
    s_waitcnt vmcnt(7)
    s_barrier
    v_add_u32 v158, 0x4000, v158
    v_add_u32 v159, 0x4000, v159
    ds_read_b128 v[72:75], v158 offset:0
    ds_read_b128 v[76:79], v158 offset:4096
    v_mfma_f32_16x16x32_bf16 v[28:31], v[100:103], a[32:35], v[28:31]
    buffer_load_dwordx4 v173, s[64:67], s76 offen offset:1024 sc1 lds
    ds_read_b128 v[80:83], v158 offset:2048
    ds_read_b128 v[84:87], v158 offset:6144
    s_cbranch_vccnz L_xc3r
L_xc3:
    v_mfma_f32_16x16x32_bf16 v[0:3], v[56:59], a[28:31], v[0:3]
    ds_read_b128 v[88:91], v158 offset:1024
    ds_read_b128 v[92:95], v158 offset:5120
    v_mfma_f32_16x16x32_bf16 v[16:19], v[56:59], a[36:39], v[16:19]
    ds_read_b128 v[96:99], v158 offset:3072
    ds_read_b128 v[100:103], v158 offset:7168
    v_mfma_f32_16x16x32_bf16 v[4:7], v[60:63], a[28:31], v[4:7]
    s_add_u32 m0, s100, 73728
    s_add_u32 s83, s76, 10240
    buffer_load_dwordx4 v173, s[64:67], s83 offen offset:0 sc1 lds
    ds_read_b128 v[56:59], v158 offset:16384
    v_mfma_f32_16x16x32_bf16 v[20:23], v[60:63], a[36:39], v[20:23]
    ds_read_b128 v[60:63], v158 offset:20480
    s_waitcnt lgkmcnt(6)
    v_bitop3_b32 v169, v72, v76, v80 bitop3:128
    v_bitop3_b32 v169, v169, v84, 1 bitop3:128
    v_mfma_f32_16x16x32_bf16 v[8:11], v[64:67], a[28:31], v[8:11]
    v_cmp_ne_u32 vcc, 1, v169
    v_xor_b32 v131, v170, v131
    v_mfma_f32_16x16x32_bf16 v[24:27], v[64:67], a[36:39], v[24:27]
    buffer_load_dwordx4 v173, s[64:67], s83 offen offset:1024 sc1 lds
    ds_read_b128 v[64:67], v158 offset:18432
    v_mfma_f32_16x16x32_bf16 v[12:15], v[68:71], a[28:31], v[12:15]
    v_mfma_f32_16x16x32_bf16 v[28:31], v[68:71], a[36:39], v[28:31]
    ds_read_b128 v[68:71], v158 offset:22528
    s_cbranch_vccnz L_xc4r
L_xc4:
    v_mfma_f32_16x16x32_bf16 v[0:3], v[72:75], a[40:43], v[0:3]
    v_mfma_f32_16x16x32_bf16 v[16:19], v[72:75], a[48:51], v[16:19]
    v_mfma_f32_16x16x32_bf16 v[32:35], v[72:75], a[56:59], v[32:35]
    ds_read_b128 v[72:75], v158 offset:17408
    v_mfma_f32_16x16x32_bf16 v[40:43], v[76:79], a[56:59], v[40:43]
    ds_read_b128 v[76:79], v158 offset:21504
    s_waitcnt lgkmcnt(6)
    v_bitop3_b32 v169, v88, v92, v96 bitop3:128
    v_bitop3_b32 v169, v169, v100, 1 bitop3:128
    v_mfma_f32_16x16x32_bf16 v[4:7], v[80:83], a[40:43], v[4:7]
    v_cmp_ne_u32 vcc, 1, v169
    v_mfma_f32_16x16x32_bf16 v[20:23], v[80:83], a[48:51], v[20:23]
    v_mfma_f32_16x16x32_bf16 v[36:39], v[80:83], a[56:59], v[36:39]
    ds_read_b128 v[80:83], v158 offset:19456
    v_mfma_f32_16x16x32_bf16 v[44:47], v[84:87], a[56:59], v[44:47]
    ds_read_b128 v[84:87], v158 offset:23552
    s_cbranch_vccnz L_xc5r
L_xc5:
    v_mfma_f32_16x16x32_bf16 v[0:3], v[88:91], a[44:47], v[0:3]
    v_mfma_f32_16x16x32_bf16 v[16:19], v[88:91], a[52:55], v[16:19]
    v_mfma_f32_16x16x32_bf16 v[32:35], v[88:91], a[60:63], v[32:35]
    v_mfma_f32_16x16x32_bf16 v[40:43], v[92:95], a[60:63], v[40:43]
    s_waitcnt lgkmcnt(4)
    v_bitop3_b32 v169, v56, v60, v64 bitop3:128
    v_bitop3_b32 v169, v169, v68, 1 bitop3:128
    v_mfma_f32_16x16x32_bf16 v[4:7], v[96:99], a[44:47], v[4:7]
    v_cmp_ne_u32 vcc, 1, v169
    v_mfma_f32_16x16x32_bf16 v[20:23], v[96:99], a[52:55], v[20:23]
    v_mfma_f32_16x16x32_bf16 v[36:39], v[96:99], a[60:63], v[36:39]
    v_mfma_f32_16x16x32_bf16 v[44:47], v[100:103], a[60:63], v[44:47]
    s_cbranch_vccnz L_xc6r
L_xc6:
    v_mfma_f32_16x16x32_bf16 v[0:3], v[56:59], a[80:83], v[0:3]
    v_mfma_f32_16x16x32_bf16 v[16:19], v[56:59], a[88:91], v[16:19]
    s_waitcnt vmcnt(8)
    L_s2:
    v_min3_u32 v168, v105, v107, v109
    v_max3_u32 v105, v105, v107, v109
    v_min3_u32 v168, v168, v111, s82
    v_max3_u32 v105, v105, v111, s82
    v_cmp_ne_u32 vcc, v168, v105

    s_cbranch_vccnz L_s2r
    v_mfma_f32_16x16x32_bf16 v[32:35], v[56:59], a[96:99], v[32:35]
    v_add_f32 v104, v104, v108
    v_add_f32 v106, v106, v110
    v_mfma_f32_16x16x32_bf16 v[40:43], v[60:63], a[96:99], v[40:43]
    s_waitcnt lgkmcnt(0)
    v_bitop3_b32 v169, v72, v76, v80 bitop3:128
    v_bitop3_b32 v169, v169, v84, 1 bitop3:128
    v_mfma_f32_16x16x32_bf16 v[4:7], v[64:67], a[80:83], v[4:7]
    v_cmp_ne_u32 vcc, 1, v169
    v_permlane32_swap_b32 v104, v106
    v_mfma_f32_16x16x32_bf16 v[20:23], v[64:67], a[88:91], v[20:23]
    v_add_f32 v104, v104, v106
    v_mov_b32 v106, v104
    v_mfma_f32_16x16x32_bf16 v[36:39], v[64:67], a[96:99], v[36:39]
    s_waitcnt vmcnt(0)
    s_barrier
    ds_read_b128 v[88:91], v158 offset:32768
    ds_read_b128 v[92:95], v158 offset:36864
    v_permlane16_swap_b32 v104, v106
    v_add_f32 v104, v104, v106
    v_mfma_f32_16x16x32_bf16 v[44:47], v[68:71], a[96:99], v[44:47]
    ds_read_b128 v[96:99], v158 offset:34816
    ds_read_b128 v[100:103], v158 offset:38912
    v_mov_b32 v106, v104
    s_nop 1
    v_permlane32_swap_b32 v104, v106
    s_cbranch_vccnz L_xc7r
L_xc7:
    v_mfma_f32_16x16x32_bf16 v[0:3], v[72:75], a[84:87], v[0:3]
    ds_read_b128 v[56:59], v158 offset:33792
    ds_read_b128 v[60:63], v158 offset:37888
    v_mul_f32 v104, 0x3acccccd, v104
    v_mov_b32 v166, 0x3727c5ac
    v_mfma_f32_16x16x32_bf16 v[16:19], v[72:75], a[92:95], v[16:19]
    ds_read_b128 v[64:67], v158 offset:35840
    ds_read_b128 v[68:71], v158 offset:39936
    v_fmac_f32 v166, 0x3acccccd, v106
    v_fma_f32 v166, -v104, v104, v166
    v_mfma_f32_16x16x32_bf16 v[32:35], v[72:75], a[100:103], v[32:35]
    ds_read_b128 v[72:75], v158 offset:53248
    v_max_f32 v166, 0x3727c5ac, v166
    v_rsq_f32 v166, v166
    v_mfma_f32_16x16x32_bf16 v[40:43], v[76:79], a[100:103], v[40:43]
    ds_read_b128 v[76:79], v158 offset:54272
    s_waitcnt lgkmcnt(6)
    v_bitop3_b32 v169, v88, v92, v96 bitop3:128
    v_bitop3_b32 v169, v169, v100, 1 bitop3:128
    v_mfma_f32_16x16x32_bf16 v[4:7], v[80:83], a[84:87], v[4:7]
    v_cmp_ne_u32 vcc, 1, v169
    v_mul_f32_e64 v167, -v104, v166
    v_mfma_f32_16x16x32_bf16 v[20:23], v[80:83], a[92:95], v[20:23]
    v_xor_b32 v104, 0x80000000, v104
    v_mfma_f32_16x16x32_bf16 v[36:39], v[80:83], a[100:103], v[36:39]
    ds_read_b128 v[80:83], v158 offset:49152
    v_mfma_f32_16x16x32_bf16 v[44:47], v[84:87], a[100:103], v[44:47]
    ds_read_b128 v[84:87], v158 offset:50176
    s_cbranch_vccnz L_xc8r
L_xc8:
    v_mfma_f32_16x16x32_bf16 v[0:3], v[88:91], a[120:123], v[0:3]
    s_mov_b64 exec, 0xffff
    ds_write2st64_b32 v120, v104, v166 offset1:1
    ds_write2st64_b32 v121, v104, v166 offset1:1
    s_mov_b64 exec, -1
    v_mfma_f32_16x16x32_bf16 v[16:19], v[88:91], a[128:131], v[16:19]
    s_add_u32 s98, s98, 0x40000
    s_addc_u32 s99, s99, 0
    v_mfma_f32_16x16x32_bf16 v[32:35], v[88:91], a[136:139], v[32:35]
    ds_read_b128 v[88:91], v158 offset:55296
    v_mfma_f32_16x16x32_bf16 v[40:43], v[92:95], a[136:139], v[40:43]
    ds_read_b128 v[92:95], v158 offset:56320
    s_waitcnt lgkmcnt(8)
    v_bitop3_b32 v169, v56, v60, v64 bitop3:128
    v_bitop3_b32 v169, v169, v68, 1 bitop3:128
    v_mfma_f32_16x16x32_bf16 v[4:7], v[96:99], a[120:123], v[4:7]
    v_cmp_ne_u32 vcc, 1, v169
    v_mfma_f32_16x16x32_bf16 v[20:23], v[96:99], a[128:131], v[20:23]
    v_mfma_f32_16x16x32_bf16 v[36:39], v[96:99], a[136:139], v[36:39]
    ds_read_b128 v[96:99], v158 offset:51200
    v_mfma_f32_16x16x32_bf16 v[44:47], v[100:103], a[136:139], v[44:47]
    ds_read_b128 v[100:103], v158 offset:52224
    s_cbranch_vccnz L_xc9r
L_xc9:
    v_mfma_f32_16x16x32_bf16 v[0:3], v[56:59], a[124:127], v[0:3]
    v_mfma_f32_16x16x32_bf16 v[16:19], v[56:59], a[132:135], v[16:19]
    v_mfma_f32_16x16x32_bf16 v[32:35], v[56:59], a[140:143], v[32:35]
    ds_read_b128 v[56:59], v159 offset:0
    v_mfma_f32_16x16x32_bf16 v[40:43], v[60:63], a[140:143], v[40:43]
    ds_read_b128 v[60:63], v159 offset:1024
    s_waitcnt lgkmcnt(8)
    v_bitop3_b32 v169, v72, v76, v80 bitop3:128
    v_bitop3_b32 v169, v169, v84, 1 bitop3:128
    v_mfma_f32_16x16x32_bf16 v[4:7], v[64:67], a[124:127], v[4:7]
    v_cmp_ne_u32 vcc, 1, v169
    v_mfma_f32_16x16x32_bf16 v[20:23], v[64:67], a[132:135], v[20:23]
    v_mfma_f32_16x16x32_bf16 v[36:39], v[64:67], a[140:143], v[36:39]
    ds_read_b128 v[64:67], v159 offset:16384
    v_mfma_f32_16x16x32_bf16 v[44:47], v[68:71], a[140:143], v[44:47]
    ds_read_b128 v[68:71], v159 offset:17408
    s_cbranch_vccnz L_xc10r
L_xc10:
    v_mfma_f32_16x16x32_bf16 v[40:43], v[72:75], a[176:179], v[40:43]
    ds_read_b128 v[72:75], v159 offset:32768
    v_mfma_f32_16x16x32_bf16 v[40:43], v[76:79], a[180:183], v[40:43]
    ds_read_b128 v[76:79], v159 offset:33792
    v_mfma_f32_16x16x32_bf16 v[0:3], v[80:83], a[160:163], v[0:3]
    v_mfma_f32_16x16x32_bf16 v[16:19], v[80:83], a[168:171], v[16:19]
    s_waitcnt lgkmcnt(6)
    v_bitop3_b32 v169, v88, v92, v96 bitop3:128
    v_bitop3_b32 v169, v169, v100, 1 bitop3:128
    v_mfma_f32_16x16x32_bf16 v[32:35], v[80:83], a[176:179], v[32:35]
    s_nop 0
    ds_write_b128 v52, v[40:43] offset:2048
    ds_read_b128 v[80:83], v159 offset:49152
    v_cmp_ne_u32 vcc, 1, v169
    v_mfma_f32_16x16x32_bf16 v[0:3], v[84:87], a[164:167], v[0:3]
    v_mfma_f32_16x16x32_bf16 v[16:19], v[84:87], a[172:175], v[16:19]
    v_mfma_f32_16x16x32_bf16 v[32:35], v[84:87], a[180:183], v[32:35]
    ds_read_b128 v[84:87], v159 offset:50176
    s_cbranch_vccnz L_xc11r
L_xc11:
    v_mfma_f32_16x16x32_bf16 v[44:47], v[88:91], a[176:179], v[44:47]
    v_mfma_f32_16x16x32_bf16 v[44:47], v[92:95], a[180:183], v[44:47]
    v_mfma_f32_16x16x32_bf16 v[4:7], v[96:99], a[160:163], v[4:7]
    s_nop 2
    ds_write_b128 v52, v[32:35] offset:0
    v_mfma_f32_16x16x32_bf16 v[20:23], v[96:99], a[168:171], v[20:23]
    s_waitcnt lgkmcnt(6)
    v_bitop3_b32 v169, v56, v60, v64 bitop3:128
    v_bitop3_b32 v169, v169, v68, 1 bitop3:128
    v_cmp_ne_u32 vcc, 1, v169
    v_mfma_f32_16x16x32_bf16 v[36:39], v[96:99], a[176:179], v[36:39]
    v_mfma_f32_16x16x32_bf16 v[4:7], v[100:103], a[164:167], v[4:7]
    ds_write_b128 v52, v[44:47] offset:3072
    v_mfma_f32_16x16x32_bf16 v[20:23], v[100:103], a[172:175], v[20:23]
    v_mfma_f32_16x16x32_bf16 v[36:39], v[100:103], a[180:183], v[36:39]
    s_cbranch_vccnz L_xc12r
L_xc12:
    v_mfma_f32_16x16x32_bf16 v[0:3], v[56:59], a[64:67], v[0:3]
    v_mfma_f32_16x16x32_bf16 v[16:19], v[56:59], a[72:75], v[16:19]
    ds_read_b128 v[56:59], v159 offset:2048
    v_mfma_f32_16x16x32_bf16 v[0:3], v[60:63], a[68:71], v[0:3]
    s_nop 2
    ds_write_b128 v52, v[36:39] offset:1024
    v_mfma_f32_16x16x32_bf16 v[16:19], v[60:63], a[76:79], v[16:19]
    ds_read_b128 v[60:63], v159 offset:3072
    s_waitcnt lgkmcnt(5)
    v_bitop3_b32 v169, v72, v76, v80 bitop3:128
    v_bitop3_b32 v169, v169, v84, 1 bitop3:128
    v_cmp_ne_u32 vcc, 1, v169
    v_mfma_f32_16x16x32_bf16 v[0:3], v[64:67], a[104:107], v[0:3]
    v_mfma_f32_16x16x32_bf16 v[16:19], v[64:67], a[112:115], v[16:19]
    ds_read_b128 v[64:67], v159 offset:18432
    v_mfma_f32_16x16x32_bf16 v[0:3], v[68:71], a[108:111], v[0:3]
    v_mfma_f32_16x16x32_bf16 v[16:19], v[68:71], a[116:119], v[16:19]
    ds_read_b128 v[68:71], v159 offset:19456
    s_cbranch_vccnz L_xc13r
L_xc13:
    v_mfma_f32_16x16x32_bf16 v[0:3], v[72:75], a[144:147], v[0:3]
    v_mfma_f32_16x16x32_bf16 v[16:19], v[72:75], a[152:155], v[16:19]
    ds_read_b128 v[72:75], v159 offset:34816
    v_mfma_f32_16x16x32_bf16 v[0:3], v[76:79], a[148:151], v[0:3]
    v_mfma_f32_16x16x32_bf16 v[16:19], v[76:79], a[156:159], v[16:19]
    ds_read_b128 v[76:79], v159 offset:35840
    s_waitcnt lgkmcnt(2)
    v_bitop3_b32 v169, v56, v60, v64 bitop3:128
    v_bitop3_b32 v169, v169, v68, 1 bitop3:128
    v_cmp_ne_u32 vcc, 1, v169
    s_barrier
    v_mfma_f32_16x16x32_bf16 v[0:3], v[80:83], a[184:187], v[0:3]
    ds_read_b128 v[104:107], v164 offset:0
    v_mfma_f32_16x16x32_bf16 v[16:19], v[80:83], a[192:195], v[16:19]
    ds_read_b128 v[80:83], v159 offset:51200
    ds_read_b128 v[108:111], v164 offset:256
    v_mfma_f32_16x16x32_bf16 v[0:3], v[84:87], a[188:191], v[0:3]
    ds_read_b128 v[112:115], v164 offset:16
    v_mfma_f32_16x16x32_bf16 v[16:19], v[84:87], a[196:199], v[16:19]
    ds_read_b128 v[84:87], v159 offset:52224
    ds_read_b128 v[116:119], v164 offset:272
    s_cbranch_vccnz L_xc14r
L_xc14:
    v_mfma_f32_16x16x32_bf16 v[4:7], v[56:59], a[64:67], v[4:7]
    ds_read2st64_b32 v[32:33], v48 offset0:0 offset1:32
    v_mfma_f32_16x16x32_bf16 v[20:23], v[56:59], a[72:75], v[20:23]
    ds_read_b128 v[56:59], v159 offset:4096
    v_mfma_f32_16x16x32_bf16 v[4:7], v[60:63], a[68:71], v[4:7]
    ds_read2st64_b32 v[34:35], v49 offset0:0 offset1:32
    v_mfma_f32_16x16x32_bf16 v[20:23], v[60:63], a[76:79], v[20:23]
    ds_read_b128 v[60:63], v159 offset:5120
    s_waitcnt lgkmcnt(5)
    v_bitop3_b32 v169, v72, v76, v80 bitop3:128
    v_bitop3_b32 v169, v169, v84, 1 bitop3:128
    v_cmp_ne_u32 vcc, 1, v169
    v_mfma_f32_16x16x32_bf16 v[4:7], v[64:67], a[104:107], v[4:7]
    ds_read2st64_b32 v[36:37], v48 offset0:4 offset1:36
    v_mfma_f32_16x16x32_bf16 v[20:23], v[64:67], a[112:115], v[20:23]
    ds_read_b128 v[64:67], v159 offset:20480
    v_mfma_f32_16x16x32_bf16 v[4:7], v[68:71], a[108:111], v[4:7]
    ds_read2st64_b32 v[38:39], v49 offset0:4 offset1:36
    v_fmac_f32 v0, v104, v160
    v_mfma_f32_16x16x32_bf16 v[20:23], v[68:71], a[116:119], v[20:23]
    ds_read_b128 v[68:71], v159 offset:21504
    s_cbranch_vccnz L_xc15r
L_xc15:
    v_mfma_f32_16x16x32_bf16 v[4:7], v[72:75], a[144:147], v[4:7]
    ds_read2st64_b32 v[40:41], v48 offset0:8 offset1:40
    v_fmac_f32 v1, v105, v160
    v_mfma_f32_16x16x32_bf16 v[20:23], v[72:75], a[152:155], v[20:23]
    ds_read_b128 v[72:75], v159 offset:36864
    v_fmac_f32 v16, v104, v161
    v_mfma_f32_16x16x32_bf16 v[4:7], v[76:79], a[148:151], v[4:7]
    ds_read2st64_b32 v[42:43], v49 offset0:8 offset1:40
    v_fmac_f32 v17, v105, v161
    v_mfma_f32_16x16x32_bf16 v[20:23], v[76:79], a[156:159], v[20:23]
    ds_read_b128 v[76:79], v159 offset:37888
    v_mul_f32 v0, v108, v0
    v_mfma_f32_16x16x32_bf16 v[4:7], v[80:83], a[184:187], v[4:7]
    ds_read2st64_b32 v[44:45], v48 offset0:12 offset1:44
    v_mul_f32 v1, v109, v1
    v_mfma_f32_16x16x32_bf16 v[20:23], v[80:83], a[192:195], v[20:23]
    ds_read_b128 v[80:83], v159 offset:53248
    v_mul_f32 v16, v108, v16
    v_mfma_f32_16x16x32_bf16 v[4:7], v[84:87], a[188:191], v[4:7]
    ds_read2st64_b32 v[46:47], v49 offset0:12 offset1:44
    v_mul_f32 v17, v109, v17
    v_mfma_f32_16x16x32_bf16 v[20:23], v[84:87], a[196:199], v[20:23]
    ds_read_b128 v[84:87], v159 offset:54272
    ds_read_b128 v[88:91], v50 offset:768
    s_waitcnt lgkmcnt(13)
    v_mfma_f32_16x16x32_bf16 v[8:11], v[56:59], a[64:67], v[8:11]
    ds_read_b128 v[92:95], v50 offset:784
    v_fmac_f32 v2, v106, v160
    v_mfma_f32_16x16x32_bf16 v[24:27], v[56:59], a[72:75], v[24:27]
    ds_read_b128 v[56:59], v158 offset:4096
    ds_read_b128 v[52:55], v50 offset:528
    v_mfma_f32_16x16x32_bf16 v[8:11], v[60:63], a[68:71], v[8:11]
    ds_read_b128 v[48:51], v50 offset:512
    v_fmac_f32 v3, v107, v160
    v_mfma_f32_16x16x32_bf16 v[24:27], v[60:63], a[76:79], v[24:27]
    ds_read_b128 v[60:63], v158 offset:5120
    ds_read_b64 v[96:97], v165 offset:8320
    s_waitcnt lgkmcnt(15)
    v_mfma_f32_16x16x32_bf16 v[8:11], v[64:67], a[104:107], v[8:11]
    ds_read_b64 v[98:99], v165 offset:8960
    v_fmac_f32 v18, v106, v161
    v_mfma_f32_16x16x32_bf16 v[24:27], v[64:67], a[112:115], v[24:27]
    ds_read_b128 v[64:67], v158 offset:20480
    ds_read_b64 v[100:101], v171 offset:8320
    v_mfma_f32_16x16x32_bf16 v[8:11], v[68:71], a[108:111], v[8:11]
    ds_read_b64 v[102:103], v171 offset:8960
    v_fmac_f32 v19, v107, v161
    v_mfma_f32_16x16x32_bf16 v[24:27], v[68:71], a[116:119], v[24:27]
    ds_read_b128 v[68:71], v158 offset:21504
    s_waitcnt lgkmcnt(15)
    v_mfma_f32_16x16x32_bf16 v[8:11], v[72:75], a[144:147], v[8:11]
    v_mul_f32 v2, v110, v2
    v_mul_f32 v3, v111, v3
    v_mfma_f32_16x16x32_bf16 v[24:27], v[72:75], a[152:155], v[24:27]
    ds_read_b128 v[72:75], v158 offset:36864
    v_mul_f32 v18, v110, v18
    v_mfma_f32_16x16x32_bf16 v[8:11], v[76:79], a[148:151], v[8:11]
    s_waitcnt lgkmcnt(14)
    v_add_f32 v32, v32, v33
    v_mfma_f32_16x16x32_bf16 v[24:27], v[76:79], a[156:159], v[24:27]
    ds_read_b128 v[76:79], v158 offset:37888
    s_waitcnt lgkmcnt(14)
    v_mfma_f32_16x16x32_bf16 v[8:11], v[80:83], a[184:187], v[8:11]
    v_add_f32 v34, v34, v35
    v_add_f32 v36, v36, v37
    v_mfma_f32_16x16x32_bf16 v[24:27], v[80:83], a[192:195], v[24:27]
    ds_read_b128 v[80:83], v158 offset:53248
    v_add_f32 v38, v38, v39
    v_mfma_f32_16x16x32_bf16 v[8:11], v[84:87], a[188:191], v[8:11]
    v_add_f32 v40, v40, v41
    v_add_f32 v42, v42, v43
    v_mfma_f32_16x16x32_bf16 v[24:27], v[84:87], a[196:199], v[24:27]
    ds_read_b128 v[84:87], v158 offset:54272
    s_waitcnt lgkmcnt(10)
    v_mfma_f32_16x16x32_bf16 v[8:11], v[56:59], a[40:43], v[8:11]
    v_add_f32 v44, v44, v45
    v_add_f32 v46, v46, v47
    v_mfma_f32_16x16x32_bf16 v[24:27], v[56:59], a[48:51], v[24:27]
    ds_read_b128 v[56:59], v159 offset:6144
    v_mfma_f32_16x16x32_bf16 v[8:11], v[60:63], a[44:47], v[8:11]
    v_fma_f32 v48, v48, v162, v32
    v_fma_f32 v49, v49, v162, v34
    v_mfma_f32_16x16x32_bf16 v[24:27], v[60:63], a[52:55], v[24:27]
    ds_read_b128 v[60:63], v159 offset:7168
    s_waitcnt lgkmcnt(6)
    v_mfma_f32_16x16x32_bf16 v[8:11], v[64:67], a[80:83], v[8:11]
    v_fma_f32 v50, v50, v162, v36
    v_fma_f32 v51, v51, v162, v38
    v_mfma_f32_16x16x32_bf16 v[24:27], v[64:67], a[88:91], v[24:27]
    ds_read_b128 v[64:67], v159 offset:22528
    v_fma_f32 v52, v52, v162, v40
    v_mfma_f32_16x16x32_bf16 v[8:11], v[68:71], a[84:87], v[8:11]
    v_fma_f32 v53, v53, v162, v42
    v_fma_f32 v54, v54, v162, v44
    v_mfma_f32_16x16x32_bf16 v[24:27], v[68:71], a[92:95], v[24:27]
    ds_read_b128 v[68:71], v159 offset:23552
    s_waitcnt lgkmcnt(6)
    v_mfma_f32_16x16x32_bf16 v[8:11], v[72:75], a[120:123], v[8:11]
    v_fma_f32 v55, v55, v162, v46
    v_mul_f32 v48, v88, v48
    v_mfma_f32_16x16x32_bf16 v[24:27], v[72:75], a[128:131], v[24:27]
    ds_read_b128 v[72:75], v159 offset:38912
    v_mul_f32 v49, v89, v49
    v_mfma_f32_16x16x32_bf16 v[8:11], v[76:79], a[124:127], v[8:11]
    v_mul_f32 v50, v90, v50
    v_mul_f32 v51, v91, v51
    v_mfma_f32_16x16x32_bf16 v[24:27], v[76:79], a[132:135], v[24:27]
    ds_read_b128 v[76:79], v159 offset:39936
    s_waitcnt lgkmcnt(6)
    v_mfma_f32_16x16x32_bf16 v[8:11], v[80:83], a[160:163], v[8:11]
    v_mul_f32 v52, v92, v52
    v_mul_f32 v53, v93, v53
    v_mfma_f32_16x16x32_bf16 v[24:27], v[80:83], a[168:171], v[24:27]
    ds_read_b128 v[80:83], v159 offset:55296
    v_mul_f32 v54, v94, v54
    v_mfma_f32_16x16x32_bf16 v[8:11], v[84:87], a[164:167], v[8:11]
    v_mul_f32 v55, v95, v55
    v_mul_f32 v19, v111, v19
    v_mfma_f32_16x16x32_bf16 v[24:27], v[84:87], a[172:175], v[24:27]
    ds_read_b128 v[84:87], v159 offset:56320
    s_waitcnt lgkmcnt(6)
    v_mfma_f32_16x16x32_bf16 v[12:15], v[56:59], a[64:67], v[12:15]
    v_xor_b32 v101, v170, v101
    v_mfma_f32_16x16x32_bf16 v[28:31], v[56:59], a[72:75], v[28:31]
    ds_read_b128 v[56:59], v158 offset:6144
    v_xor_b32 v103, v170, v103
    v_mfma_f32_16x16x32_bf16 v[12:15], v[60:63], a[68:71], v[12:15]
    v_fma_f32 v173, v130, v48, v49
    s_nop 1
    v_fmac_f32_dpp v173, v48, v131 row_ror:8 row_mask:0xf bank_mask:0xf
    v_mfma_f32_16x16x32_bf16 v[28:31], v[60:63], a[76:79], v[28:31]
    ds_read_b128 v[60:63], v158 offset:7168
    s_waitcnt lgkmcnt(6)
    v_mfma_f32_16x16x32_bf16 v[12:15], v[64:67], a[104:107], v[12:15]
    v_fma_f32 v172, v130, v173, v50
    s_nop 1
    v_fmac_f32_dpp v172, v173, v131 row_ror:8 row_mask:0xf bank_mask:0xf
    v_mfma_f32_16x16x32_bf16 v[28:31], v[64:67], a[112:115], v[28:31]
    ds_read_b128 v[64:67], v158 offset:22528
    v_fma_f32 v173, v130, v172, v51
    v_mfma_f32_16x16x32_bf16 v[12:15], v[68:71], a[108:111], v[12:15]
    s_nop 0
    v_fmac_f32_dpp v173, v172, v131 row_ror:8 row_mask:0xf bank_mask:0xf
    v_fma_f32 v172, v130, v173, v52
    v_mfma_f32_16x16x32_bf16 v[28:31], v[68:71], a[116:119], v[28:31]
    ds_read_b128 v[68:71], v158 offset:23552
    s_waitcnt lgkmcnt(6)
    v_mfma_f32_16x16x32_bf16 v[12:15], v[72:75], a[144:147], v[12:15]
    v_fmac_f32_dpp v172, v173, v131 row_ror:8 row_mask:0xf bank_mask:0xf
    v_fma_f32 v173, v130, v172, v53
    v_mfma_f32_16x16x32_bf16 v[28:31], v[72:75], a[152:155], v[28:31]
    ds_read_b128 v[72:75], v158 offset:38912
    v_fmac_f32_dpp v173, v172, v131 row_ror:8 row_mask:0xf bank_mask:0xf
    v_mfma_f32_16x16x32_bf16 v[12:15], v[76:79], a[148:151], v[12:15]
    v_fma_f32 v172, v130, v173, v54
    s_nop 1
    v_fmac_f32_dpp v172, v173, v131 row_ror:8 row_mask:0xf bank_mask:0xf
    v_mfma_f32_16x16x32_bf16 v[28:31], v[76:79], a[156:159], v[28:31]
    ds_read_b128 v[76:79], v158 offset:39936
    s_waitcnt lgkmcnt(6)
    v_mfma_f32_16x16x32_bf16 v[12:15], v[80:83], a[184:187], v[12:15]
    v_fma_f32 v173, v130, v172, v55
    s_nop 1
    v_fmac_f32_dpp v173, v172, v131 row_ror:8 row_mask:0xf bank_mask:0xf
    v_mfma_f32_16x16x32_bf16 v[28:31], v[80:83], a[192:195], v[28:31]
    ds_read_b128 v[80:83], v158 offset:55296
    ds_read_b128 v[104:107], v164 offset:32
    v_mfma_f32_16x16x32_bf16 v[12:15], v[84:87], a[188:191], v[12:15]
    ds_read_b128 v[108:111], v164 offset:288
    v_mfma_f32_16x16x32_bf16 v[28:31], v[84:87], a[196:199], v[28:31]
    ds_read_b128 v[84:87], v158 offset:56320
    s_waitcnt lgkmcnt(8)
    v_mfma_f32_16x16x32_bf16 v[12:15], v[56:59], a[40:43], v[12:15]
    v_fma_f32 v124, v0, v128, v2
    v_fma_f32 v125, v1, v128, v3
    v_mfma_f32_16x16x32_bf16 v[28:31], v[56:59], a[48:51], v[28:31]
    v_fma_f32 v126, v16, v128, v18
    v_fma_f32 v127, v17, v128, v19
    v_mfma_f32_16x16x32_bf16 v[12:15], v[60:63], a[44:47], v[12:15]
    v_fma_f32 v124, -v16, v129, v124
    v_fma_f32 v125, -v17, v129, v125
    v_mfma_f32_16x16x32_bf16 v[28:31], v[60:63], a[52:55], v[28:31]
    v_fmac_f32 v126, v0, v129
    s_waitcnt lgkmcnt(6)
    v_mfma_f32_16x16x32_bf16 v[12:15], v[64:67], a[80:83], v[12:15]
    v_fmac_f32 v127, v1, v129
    v_mfma_f32_16x16x32_bf16 v[28:31], v[64:67], a[88:91], v[28:31]
    v_fmac_f32 v4, v112, v160
    v_mfma_f32_16x16x32_bf16 v[12:15], v[68:71], a[84:87], v[12:15]
    v_fmac_f32 v5, v113, v160
    v_fmac_f32 v20, v112, v161
    v_mfma_f32_16x16x32_bf16 v[28:31], v[68:71], a[92:95], v[28:31]
    v_fmac_f32 v21, v113, v161
    s_waitcnt lgkmcnt(4)
    v_mfma_f32_16x16x32_bf16 v[12:15], v[72:75], a[120:123], v[12:15]
    v_mul_f32 v4, v116, v4
    v_mul_f32 v5, v117, v5
    v_mfma_f32_16x16x32_bf16 v[28:31], v[72:75], a[128:131], v[28:31]
    v_mul_f32 v20, v116, v20
    v_mul_f32 v21, v117, v21
    v_mfma_f32_16x16x32_bf16 v[12:15], v[76:79], a[124:127], v[12:15]
    v_fmac_f32 v6, v114, v160
    v_fmac_f32 v7, v115, v160
    v_mfma_f32_16x16x32_bf16 v[28:31], v[76:79], a[132:135], v[28:31]
    v_fmac_f32 v22, v114, v161
    s_waitcnt lgkmcnt(0)
    v_mfma_f32_16x16x32_bf16 v[12:15], v[80:83], a[160:163], v[12:15]
    v_fmac_f32 v23, v115, v161
    v_mul_f32 v6, v118, v6
    v_mfma_f32_16x16x32_bf16 v[28:31], v[80:83], a[168:171], v[28:31]
    v_mul_f32 v7, v119, v7
    v_mul_f32 v22, v118, v22
    v_mfma_f32_16x16x32_bf16 v[12:15], v[84:87], a[164:167], v[12:15]
    v_mul_f32 v23, v119, v23
    v_mfma_f32_16x16x32_bf16 v[28:31], v[84:87], a[172:175], v[28:31]
    ds_read_b128 v[112:115], v164 offset:48
    ds_read_b128 v[116:119], v164 offset:304
    v_pk_fma_f32 v[120:121], v[124:125], v[128:129], v[4:5] op_sel_hi:[1,0,1]
    v_pk_fma_f32 v[122:123], v[126:127], v[128:129], v[20:21] op_sel_hi:[1,0,1]
    v_pk_fma_f32 v[120:121], v[126:127], v[128:129], v[120:121] op_sel:[0,1,0] neg_lo:[1,0,0] neg_hi:[1,0,0]
    v_pk_fma_f32 v[122:123], v[124:125], v[128:129], v[122:123] op_sel:[0,1,0]
    v_pk_fma_f32 v[124:125], v[120:121], v[128:129], v[6:7] op_sel_hi:[1,0,1]
    v_pk_fma_f32 v[126:127], v[122:123], v[128:129], v[22:23] op_sel_hi:[1,0,1]
    v_pk_fma_f32 v[124:125], v[122:123], v[128:129], v[124:125] op_sel:[0,1,0] neg_lo:[1,0,0] neg_hi:[1,0,0]
    v_pk_fma_f32 v[126:127], v[120:121], v[128:129], v[126:127] op_sel:[0,1,0]
    v_pk_fma_f32 v[8:9], v[104:105], v[160:161], v[8:9] op_sel_hi:[1,0,1]
    v_pk_fma_f32 v[24:25], v[104:105], v[160:161], v[24:25] op_sel:[0,1,0]
    v_pk_fma_f32 v[10:11], v[106:107], v[160:161], v[10:11] op_sel_hi:[1,0,1]
    v_pk_fma_f32 v[26:27], v[106:107], v[160:161], v[26:27] op_sel:[0,1,0]
    v_pk_mul_f32 v[8:9], v[108:109], v[8:9]
    v_pk_mul_f32 v[24:25], v[108:109], v[24:25]
    v_pk_mul_f32 v[10:11], v[110:111], v[10:11]
    v_pk_mul_f32 v[26:27], v[110:111], v[26:27]
    v_pk_fma_f32 v[120:121], v[124:125], v[128:129], v[8:9] op_sel_hi:[1,0,1]
    v_pk_fma_f32 v[122:123], v[126:127], v[128:129], v[24:25] op_sel_hi:[1,0,1]
    v_pk_fma_f32 v[120:121], v[126:127], v[128:129], v[120:121] op_sel:[0,1,0] neg_lo:[1,0,0] neg_hi:[1,0,0]
    v_pk_fma_f32 v[122:123], v[124:125], v[128:129], v[122:123] op_sel:[0,1,0]
    v_pk_fma_f32 v[124:125], v[120:121], v[128:129], v[10:11] op_sel_hi:[1,0,1]
    v_pk_fma_f32 v[126:127], v[122:123], v[128:129], v[26:27] op_sel_hi:[1,0,1]
    v_pk_fma_f32 v[124:125], v[122:123], v[128:129], v[124:125] op_sel:[0,1,0] neg_lo:[1,0,0] neg_hi:[1,0,0]
    v_pk_fma_f32 v[126:127], v[120:121], v[128:129], v[126:127] op_sel:[0,1,0]
    s_waitcnt lgkmcnt(0)
    v_pk_fma_f32 v[12:13], v[112:113], v[160:161], v[12:13] op_sel_hi:[1,0,1]
    v_pk_fma_f32 v[28:29], v[112:113], v[160:161], v[28:29] op_sel:[0,1,0]
    v_pk_fma_f32 v[14:15], v[114:115], v[160:161], v[14:15] op_sel_hi:[1,0,1]
    v_pk_fma_f32 v[30:31], v[114:115], v[160:161], v[30:31] op_sel:[0,1,0]
    v_pk_mul_f32 v[12:13], v[116:117], v[12:13]
    v_pk_mul_f32 v[28:29], v[116:117], v[28:29]
    v_pk_mul_f32 v[14:15], v[118:119], v[14:15]
    v_pk_mul_f32 v[30:31], v[118:119], v[30:31]
    v_pk_fma_f32 v[120:121], v[124:125], v[128:129], v[12:13] op_sel_hi:[1,0,1]
    v_pk_fma_f32 v[122:123], v[126:127], v[128:129], v[28:29] op_sel_hi:[1,0,1]
    v_pk_fma_f32 v[120:121], v[126:127], v[128:129], v[120:121] op_sel:[0,1,0] neg_lo:[1,0,0] neg_hi:[1,0,0]
    v_pk_fma_f32 v[122:123], v[124:125], v[128:129], v[122:123] op_sel:[0,1,0]
    v_pk_fma_f32 v[124:125], v[120:121], v[128:129], v[14:15] op_sel_hi:[1,0,1]
    v_pk_fma_f32 v[126:127], v[122:123], v[128:129], v[30:31] op_sel_hi:[1,0,1]
    v_pk_fma_f32 v[124:125], v[122:123], v[128:129], v[124:125] op_sel:[0,1,0] neg_lo:[1,0,0] neg_hi:[1,0,0]
    v_pk_fma_f32 v[126:127], v[120:121], v[128:129], v[126:127] op_sel:[0,1,0]
    v_mul_f32 v59, v100, v173
    v_fma_f32 v56, v96, v124, v125
    v_fma_f32 v57, v96, v126, v127
    v_fmac_f32_dpp v59, v173, v101 row_ror:8 row_mask:0xf bank_mask:0xf
    v_mov_b32_dpp v58, v173 quad_perm:[1,1,3,3] row_mask:0xf bank_mask:0xf
    v_fma_f32 v56, -v97, v126, v56
    v_fmac_f32 v57, v97, v124
    v_add_f32_dpp v58, v59, v58 quad_perm:[0,0,2,2] row_mask:0xf bank_mask:0xf
    v_mov_b64 v[64:65], v[56:57]
    v_mov_b32 v66, v58
    v_mov_b32 v71, s82
    v_permlane32_swap_b32 v56, v64
    v_permlane32_swap_b32 v57, v65
    v_permlane32_swap_b32 v58, v66
    v_mov_b64 v[60:61], v[56:57]
    v_mov_b32 v62, v58
    v_mov_b64 v[68:69], v[64:65]
    v_mov_b32 v70, v66

    v_permlane16_swap_b32 v58, v62
    v_permlane16_swap_b32 v56, v60
    v_permlane16_swap_b32 v57, v61
    v_permlane16_swap_b32 v66, v70
    v_fmac_f32_dpp v62, v58, v103 row_ror:8 row_mask:0xf bank_mask:0xf
    v_pk_fma_f32 v[60:61], v[56:57], v[98:99], v[60:61] op_sel_hi:[1,0,1]
    v_permlane16_swap_b32 v64, v68
    v_fmac_f32 v62, v102, v58
    v_pk_fma_f32 v[60:61], v[56:57], v[98:99], v[60:61] op_sel:[1,1,0] op_sel_hi:[0,1,1] neg_lo:[1,0,0]
    v_permlane16_swap_b32 v65, v69
    v_fmac_f32_dpp v66, v62, v103 row_ror:8 row_mask:0xf bank_mask:0xf
    v_fmac_f32 v66, v102, v62
    v_pk_fma_f32 v[64:65], v[60:61], v[98:99], v[64:65] op_sel_hi:[1,0,1]
    v_pk_fma_f32 v[64:65], v[60:61], v[98:99], v[64:65] op_sel:[1,1,0] op_sel_hi:[0,1,1] neg_lo:[1,0,0]
    v_fmac_f32_dpp v70, v66, v103 row_ror:8 row_mask:0xf bank_mask:0xf
    v_fmac_f32 v70, v102, v66
    v_pk_fma_f32 v[68:69], v[64:65], v[98:99], v[68:69] op_sel_hi:[1,0,1]
    v_pk_fma_f32 v[68:69], v[64:65], v[98:99], v[68:69] op_sel:[1,1,0] op_sel_hi:[0,1,1] neg_lo:[1,0,0]
    s_mov_b64 exec, 0xffff
    buffer_store_dwordx4 v[68:71], v153, s[92:95], s21 offen sc1
    s_mov_b64 exec, -1
    v_and_b32 v110, 1, v152
    v_mul_u32_u24 v110, 640, v110
    v_add_u32 v110, v171, v110
    ds_read2_b32 v[72:73], v165 offset1:160
    ds_read2_b32 v[74:75], v165 offset0:1 offset1:161
    ds_read_b64 v[76:77], v171 offset:0
    ds_read_b64 v[78:79], v110 offset:0
    v_lshrrev_b32 v109, 4, v152
    s_mov_b32 s4, 93696
    v_lshl_add_u32 v108, v109, 5, s4
    v_lshl_add_u32 v109, v109, 4, s4
    ds_read_b128 v[88:91], v108 offset:0
    ds_read_b128 v[92:95], v108 offset:16
    ds_read_b128 v[96:99], v108 offset:128
    ds_read_b128 v[100:103], v108 offset:144
    ds_read_b128 v[104:107], v109 offset:256
    s_lshl_b32 s8, s79, 13
    s_add_u32 s8, s8, 11272192
    s_and_b32 s4, s91, 31
    s_lshl_b32 s4, s4, 2
    s_add_u32 s4, s4, s8
    v_mov_b32 v110, s4
    s_not_b32 s13, s82
    v_mov_b32 v111, s13
    v_and_b32 v87, 31, v152
    v_lshl_add_u32 v87, v87, 2, s8
    s_cmp_eq_u32 s88, 0
    s_cbranch_scc1 Lss_23
    global_store_dword v110, v111, s[50:51]
Lsd_24:
    s_movk_i32 s9, 0x70
    v_lshrrev_b32 v164, 3, v152
    v_lshlrev_b32 v164, 12, v164
    v_and_or_b32 v164, v153, s9, v164
    s_mul_i32 s6, s78, 327680
    s_lshl_b32 s5, s79, 7
    s_add_u32 s6, s6, s5
    s_lshl_b32 s5, s77, 14
    s_add_u32 s7, s6, s5
    s_add_u32 s7, s7, 262144
    s_lshl_b32 s5, s77, 16
    s_add_u32 s6, s6, s5
    s_mov_b32 s5, 3145728
    s_add_u32 s6, s6, s5
    s_add_u32 s7, s7, s5
    s_lshl_b32 s5, s77, 9
    s_barrier
    s_add_u32 m0, s100, 61440
    s_nop 0
    buffer_load_dwordx4 v164, s[68:71], s6 offen sc1 lds
    s_add_u32 m0, s100, 62464
    s_add_u32 s83, s6, 32768
    buffer_load_dwordx4 v164, s[68:71], s83 offen sc1 lds
    s_add_u32 m0, s5, 69632
    s_mov_b32 exec_hi, 0
    buffer_load_dwordx4 v164, s[68:71], s7 offen sc1 lds
    s_mov_b32 exec_hi, -1
    v_mov_b32 v59, 0
    s_waitcnt lgkmcnt(5)
    v_xor_b32 v76, v170, v76
    v_xor_b32 v78, v170, v78
    v_mov_b32_dpp v56, v60 quad_perm:[0,1,2,3] row_mask:4 bank_mask:0xf
    v_mov_b32_dpp v57, v61 quad_perm:[0,1,2,3] row_mask:4 bank_mask:0xf
    v_mov_b32_dpp v58, v62 quad_perm:[0,1,2,3] row_mask:4 bank_mask:0xf
    v_mov_b32_dpp v56, v64 quad_perm:[0,1,2,3] row_mask:8 bank_mask:0xf
    v_mov_b32_dpp v57, v65 quad_perm:[0,1,2,3] row_mask:8 bank_mask:0xf
    v_mov_b32_dpp v58, v66 quad_perm:[0,1,2,3] row_mask:8 bank_mask:0xf
    v_mov_b32_dpp v56, v59 quad_perm:[0,1,2,3] row_mask:1 bank_mask:0xf
    v_mov_b32_dpp v57, v59 quad_perm:[0,1,2,3] row_mask:1 bank_mask:0xf
    v_mov_b32_dpp v58, v59 quad_perm:[0,1,2,3] row_mask:1 bank_mask:0xf
    v_mul_f32_dpp v63, -v173, v77 row_ror:8 row_mask:0xf bank_mask:0xf
    v_fma_f32 v63, -v76, v173, v63
    v_mul_f32_dpp v84, -v58, v79 row_ror:8 row_mask:0xf bank_mask:0xf
    v_pk_mul_f32 v[80:81], v[72:73], v[56:57] op_sel_hi:[1,0]
    v_pk_mul_f32 v[82:83], v[72:73], v[56:57] op_sel:[0,1]
    v_pk_fma_f32 v[80:81], v[74:75], v[56:57], v[80:81] op_sel:[0,1,0] neg_lo:[1,0,0] neg_hi:[1,0,0]
    v_pk_fma_f32 v[82:83], v[74:75], v[56:57], v[82:83] op_sel_hi:[1,0,1]
    v_fma_f32 v84, -v78, v58, v84
    v_fmac_f32 v81, v72, v124
    v_fmac_f32 v83, v72, v126
    v_fma_f32 v81, -v74, v126, v81
    v_fmac_f32 v83, v74, v124
    v_mov_b32_dpp v59, v63 quad_perm:[0,0,2,2] row_mask:0xf bank_mask:0xf
    s_mov_b32 exec_lo, 0xaaaaaaaa
    s_mov_b32 exec_hi, 0xaaaaaaaa
    v_add_f32 v84, v84, v59
    s_mov_b64 exec, -1
    s_waitcnt lgkmcnt(0)
    v_pk_fma_f32 v[112:113], v[132:133], v[166:167], v[166:167] op_sel:[0,0,1] op_sel_hi:[1,0,1]
    v_pk_fma_f32 v[114:115], v[134:135], v[166:167], v[166:167] op_sel:[0,0,1] op_sel_hi:[1,0,1]
    v_pk_fma_f32 v[132:133], v[112:113], v[88:89], v[132:133]
    v_pk_fma_f32 v[134:135], v[114:115], v[90:91], v[134:135]
    v_pk_fma_f32 v[112:113], v[136:137], v[166:167], v[166:167] op_sel:[0,0,1] op_sel_hi:[1,0,1]
    v_pk_fma_f32 v[114:115], v[138:139], v[166:167], v[166:167] op_sel:[0,0,1] op_sel_hi:[1,0,1]
    v_pk_fma_f32 v[136:137], v[112:113], v[92:93], v[136:137]
    v_pk_fma_f32 v[138:139], v[114:115], v[94:95], v[138:139]
    v_pk_fma_f32 v[112:113], v[140:141], v[166:167], v[166:167] op_sel:[0,0,1] op_sel_hi:[1,0,1]
    v_pk_fma_f32 v[114:115], v[142:143], v[166:167], v[166:167] op_sel:[0,0,1] op_sel_hi:[1,0,1]
    v_pk_fma_f32 v[140:141], v[112:113], v[96:97], v[140:141]
    v_pk_fma_f32 v[142:143], v[114:115], v[98:99], v[142:143]
    v_pk_fma_f32 v[112:113], v[144:145], v[166:167], v[166:167] op_sel:[0,0,1] op_sel_hi:[1,0,1]
    v_pk_fma_f32 v[114:115], v[146:147], v[166:167], v[166:167] op_sel:[0,0,1] op_sel_hi:[1,0,1]
    v_pk_fma_f32 v[144:145], v[112:113], v[100:101], v[144:145]
    v_pk_fma_f32 v[146:147], v[114:115], v[102:103], v[146:147]
    v_pk_fma_f32 v[112:113], v[148:149], v[166:167], v[166:167] op_sel:[0,0,1] op_sel_hi:[1,0,1]
    v_pk_fma_f32 v[114:115], v[150:151], v[166:167], v[166:167] op_sel:[0,0,1] op_sel_hi:[1,0,1]
    v_pk_fma_f32 v[148:149], v[112:113], v[104:105], v[148:149]
    v_pk_fma_f32 v[150:151], v[114:115], v[106:107], v[150:151]
    v_lshrrev_b32 v120, 4, v152
    v_and_b32 v85, 0xf0, v153
    v_lshl_add_u32 v85, v120, 11, v85
    v_add_u32 v85, s21, v85
    v_lshlrev_b32 v120, 3, v120
    v_sub_u32 v120, s79, v120
    v_med3_i32 v120, v120, 0, 8
    v_mul_lo_u32 v86, v120, s82
    v_lshrrev_b32 v120, 4, v152
    v_mul_u32_u24 v120, 640, v120
    v_add_u32 v121, v165, v120
    v_add_u32 v122, v171, v120
    ds_read_b64 v[32:33], v165 offset:9600
    ds_read_b64 v[34:35], v171 offset:9600
    ds_read_b64 v[36:37], v121 offset:5120
    ds_read_b64 v[38:39], v122 offset:5120
    v_add_u32 v121, v121, v120
    v_add_u32 v122, v122, v120
    v_and_b32 v120, 1, v152
    v_mul_u32_u24 v120, 640, v120
    v_add_u32 v122, v122, v120
    ds_read2_b32 v[40:41], v121 offset1:160
    ds_read2_b32 v[42:43], v121 offset0:1 offset1:161
    ds_read_b64 v[44:45], v122 offset:0
    v_mul_f32_dpp v126, -v48, v77 row_ror:8 row_mask:0xf bank_mask:0xf
    v_pk_mul_f32 v[124:125], v[0:1], v[74:75] op_sel_hi:[1,0]
    v_pk_mul_f32 v[0:1], v[0:1], v[72:73] op_sel_hi:[1,0]
    v_pk_fma_f32 v[0:1], v[16:17], v[74:75], v[0:1] op_sel_hi:[1,0,1] neg_lo:[1,0,0] neg_hi:[1,0,0]
    v_pk_fma_f32 v[16:17], v[16:17], v[72:73], v[124:125] op_sel_hi:[1,0,1]
    v_fma_f32 v48, -v76, v48, v126
    v_mul_f32_dpp v126, -v49, v77 row_ror:8 row_mask:0xf bank_mask:0xf
    v_pk_mul_f32 v[124:125], v[2:3], v[74:75] op_sel_hi:[1,0]
    v_pk_mul_f32 v[2:3], v[2:3], v[72:73] op_sel_hi:[1,0]
    v_pk_fma_f32 v[2:3], v[18:19], v[74:75], v[2:3] op_sel_hi:[1,0,1] neg_lo:[1,0,0] neg_hi:[1,0,0]
    v_pk_fma_f32 v[18:19], v[18:19], v[72:73], v[124:125] op_sel_hi:[1,0,1]
    v_fma_f32 v49, -v76, v49, v126
    v_mul_f32_dpp v126, -v50, v77 row_ror:8 row_mask:0xf bank_mask:0xf
    v_pk_mul_f32 v[124:125], v[4:5], v[74:75] op_sel_hi:[1,0]
    v_pk_mul_f32 v[4:5], v[4:5], v[72:73] op_sel_hi:[1,0]
    v_pk_fma_f32 v[4:5], v[20:21], v[74:75], v[4:5] op_sel_hi:[1,0,1] neg_lo:[1,0,0] neg_hi:[1,0,0]
    buffer_load_dwordx4 v[116:119], v85, s[92:95], 0 offen offset:2048 sc1
    v_pk_fma_f32 v[20:21], v[20:21], v[72:73], v[124:125] op_sel_hi:[1,0,1]
    v_fma_f32 v50, -v76, v50, v126
    v_mul_f32_dpp v126, -v51, v77 row_ror:8 row_mask:0xf bank_mask:0xf
    v_pk_mul_f32 v[124:125], v[6:7], v[74:75] op_sel_hi:[1,0]
    v_pk_mul_f32 v[6:7], v[6:7], v[72:73] op_sel_hi:[1,0]
    v_pk_fma_f32 v[6:7], v[22:23], v[74:75], v[6:7] op_sel_hi:[1,0,1] neg_lo:[1,0,0] neg_hi:[1,0,0]
    v_pk_fma_f32 v[22:23], v[22:23], v[72:73], v[124:125] op_sel_hi:[1,0,1]
    v_fma_f32 v51, -v76, v51, v126
    v_mul_f32_dpp v126, -v52, v77 row_ror:8 row_mask:0xf bank_mask:0xf
    buffer_load_dwordx4 v[112:115], v85, s[92:95], 0 offen offset:1792 sc1
    v_pk_mul_f32 v[124:125], v[8:9], v[74:75] op_sel_hi:[1,0]
    v_pk_mul_f32 v[8:9], v[8:9], v[72:73] op_sel_hi:[1,0]
    v_pk_fma_f32 v[8:9], v[24:25], v[74:75], v[8:9] op_sel_hi:[1,0,1] neg_lo:[1,0,0] neg_hi:[1,0,0]
    v_pk_fma_f32 v[24:25], v[24:25], v[72:73], v[124:125] op_sel_hi:[1,0,1]
    v_fma_f32 v52, -v76, v52, v126
    v_mul_f32_dpp v126, -v53, v77 row_ror:8 row_mask:0xf bank_mask:0xf
    v_pk_mul_f32 v[124:125], v[10:11], v[74:75] op_sel_hi:[1,0]
    v_pk_mul_f32 v[10:11], v[10:11], v[72:73] op_sel_hi:[1,0]
    v_pk_fma_f32 v[10:11], v[26:27], v[74:75], v[10:11] op_sel_hi:[1,0,1] neg_lo:[1,0,0] neg_hi:[1,0,0]
    buffer_load_dwordx4 v[108:111], v85, s[92:95], 0 offen offset:1536 sc1
    v_pk_fma_f32 v[26:27], v[26:27], v[72:73], v[124:125] op_sel_hi:[1,0,1]
    v_fma_f32 v53, -v76, v53, v126
    v_mul_f32_dpp v126, -v54, v77 row_ror:8 row_mask:0xf bank_mask:0xf
    v_pk_mul_f32 v[124:125], v[12:13], v[74:75] op_sel_hi:[1,0]
    v_pk_mul_f32 v[12:13], v[12:13], v[72:73] op_sel_hi:[1,0]
    v_pk_fma_f32 v[12:13], v[28:29], v[74:75], v[12:13] op_sel_hi:[1,0,1] neg_lo:[1,0,0] neg_hi:[1,0,0]
    v_pk_fma_f32 v[28:29], v[28:29], v[72:73], v[124:125] op_sel_hi:[1,0,1]
    v_fma_f32 v54, -v76, v54, v126
    v_mul_f32_dpp v126, -v55, v77 row_ror:8 row_mask:0xf bank_mask:0xf
    buffer_load_dwordx4 v[104:107], v85, s[92:95], 0 offen offset:1280 sc1
    v_pk_mul_f32 v[124:125], v[14:15], v[74:75] op_sel_hi:[1,0]
    v_pk_mul_f32 v[14:15], v[14:15], v[72:73] op_sel_hi:[1,0]
    v_pk_fma_f32 v[14:15], v[30:31], v[74:75], v[14:15] op_sel_hi:[1,0,1] neg_lo:[1,0,0] neg_hi:[1,0,0]
    v_pk_fma_f32 v[30:31], v[30:31], v[72:73], v[124:125] op_sel_hi:[1,0,1]
    v_fma_f32 v55, -v76, v55, v126
    s_waitcnt lgkmcnt(0)
    v_xor_b32 v35, v170, v35
    v_xor_b32 v39, v170, v39
    v_xor_b32 v44, v170, v44
    buffer_load_dwordx4 v[100:103], v85, s[92:95], 0 offen offset:1024 sc1
    s_add_u32 s6, s100, 71680
    v_bfe_u32 v63, v152, 4, 1
    v_lshlrev_b32 v63, 6, v63
    v_xor_b32 v56, v63, v153
    v_add_u32 v56, s6, v56
    v_and_b32 v58, 3, v152
    v_lshl_add_u32 v58, v58, 8, s6
    v_lshl_add_u32 v58, v63, 1, v58
    v_bfe_u32 v63, v152, 2, 2
    buffer_load_dwordx4 v[96:99], v85, s[92:95], 0 offen offset:768 sc1
    v_lshl_add_u32 v58, v63, 4, v58
    v_lshrrev_b32 v57, 5, v152
    v_lshl_add_u32 v58, v57, 3, v58
    v_and_b32 v63, 1, v152
    v_lshl_add_u32 v58, v63, 6, v58
    v_xor_b32 v59, 64, v58
    s_lshl_b32 s3, s77, 10
    s_add_u32 s3, s3, 94016
    v_lshl_add_u32 v60, v63, 2, s3
    buffer_load_dwordx4 v[92:95], v85, s[92:95], 0 offen offset:512 sc1
    v_lshlrev_b32 v62, 5, v63
    v_bfe_u32 v63, v152, 1, 3
    v_lshl_add_u32 v60, v63, 5, v60
    v_and_b32 v63, 1, v63
    v_lshl_add_u32 v62, v63, 4, v62
    v_and_b32 v63, 0xc0, v153
    v_add_u32 v62, v63, v62
    v_lshrrev_b32 v63, 4, v152
    v_lshl_add_u32 v60, v63, 3, v60
    buffer_load_dwordx4 v[88:91], v85, s[92:95], 0 offen offset:256 sc1
    v_lshl_add_u32 v61, v63, 7, s3
    v_lshl_add_u32 v61, v152, 3, v61
    v_mul_u32_u24 v63, 40960, v63
    v_add_u32 v62, v63, v62
    v_and_b32 v120, 15, v152
    v_min_u32 v120, 9, v120
    v_lshrrev_b32 v121, 4, v152
    v_mul_u32_u24 v121, 40960, v121
    v_lshl_add_u32 v120, v120, 10, v121
    global_load_dword v64, v87, s[50:51] sc1
    v_sub_u32 v121, v175, v153
    v_add_u32 v158, v120, v121
L_cchk1:
    s_waitcnt vmcnt(7)
    v_fmac_f32_dpp v114, v118, v35 row_ror:8 row_mask:0xf bank_mask:0xf
    v_fmac_f32 v114, v34, v118
    v_pk_fma_f32 v[112:113], v[116:117], v[32:33], v[112:113] op_sel_hi:[1,0,1]
    v_pk_fma_f32 v[112:113], v[116:117], v[32:33], v[112:113] op_sel:[1,1,0] op_sel_hi:[0,1,1] neg_lo:[1,0,0]
    s_waitcnt vmcnt(6)
    v_add3_u32 v169, v119, v115, v111
    v_fmac_f32_dpp v110, v114, v35 row_ror:8 row_mask:0xf bank_mask:0xf
    v_fmac_f32 v110, v34, v114
    v_pk_fma_f32 v[108:109], v[112:113], v[32:33], v[108:109] op_sel_hi:[1,0,1]
    v_pk_fma_f32 v[108:109], v[112:113], v[32:33], v[108:109] op_sel:[1,1,0] op_sel_hi:[0,1,1] neg_lo:[1,0,0]
    s_waitcnt vmcnt(5)
    v_fmac_f32_dpp v106, v110, v35 row_ror:8 row_mask:0xf bank_mask:0xf
    v_fmac_f32 v106, v34, v110
    v_pk_fma_f32 v[104:105], v[108:109], v[32:33], v[104:105] op_sel_hi:[1,0,1]
    v_pk_fma_f32 v[104:105], v[108:109], v[32:33], v[104:105] op_sel:[1,1,0] op_sel_hi:[0,1,1] neg_lo:[1,0,0]
    s_waitcnt vmcnt(4)
    v_add3_u32 v169, v169, v107, v103
    v_fmac_f32_dpp v102, v106, v35 row_ror:8 row_mask:0xf bank_mask:0xf
    v_fmac_f32 v102, v34, v106
    v_pk_fma_f32 v[100:101], v[104:105], v[32:33], v[100:101] op_sel_hi:[1,0,1]
    v_pk_fma_f32 v[100:101], v[104:105], v[32:33], v[100:101] op_sel:[1,1,0] op_sel_hi:[0,1,1] neg_lo:[1,0,0]
    s_waitcnt vmcnt(3)
    v_fmac_f32_dpp v98, v102, v35 row_ror:8 row_mask:0xf bank_mask:0xf
    v_fmac_f32 v98, v34, v102
    v_pk_fma_f32 v[96:97], v[100:101], v[32:33], v[96:97] op_sel_hi:[1,0,1]
    v_pk_fma_f32 v[96:97], v[100:101], v[32:33], v[96:97] op_sel:[1,1,0] op_sel_hi:[0,1,1] neg_lo:[1,0,0]
    s_waitcnt vmcnt(2)
    v_add3_u32 v169, v169, v99, v95
    v_fmac_f32_dpp v94, v98, v35 row_ror:8 row_mask:0xf bank_mask:0xf
    v_fmac_f32 v94, v34, v98
    v_pk_fma_f32 v[92:93], v[96:97], v[32:33], v[92:93] op_sel_hi:[1,0,1]
    v_pk_fma_f32 v[92:93], v[96:97], v[32:33], v[92:93] op_sel:[1,1,0] op_sel_hi:[0,1,1] neg_lo:[1,0,0]
    s_waitcnt vmcnt(1)
    v_add_u32 v169, v169, v91
    v_cmp_ne_u32 vcc, v169, v86
    v_fmac_f32_dpp v90, v94, v35 row_ror:8 row_mask:0xf bank_mask:0xf
    v_fmac_f32 v90, v34, v94
    v_pk_fma_f32 v[88:89], v[92:93], v[32:33], v[88:89] op_sel_hi:[1,0,1]
    v_pk_fma_f32 v[88:89], v[92:93], v[32:33], v[88:89] op_sel:[1,1,0] op_sel_hi:[0,1,1] neg_lo:[1,0,0]
    s_cbranch_vccnz L_cre1
    v_mul_f32_dpp v94, v90, v39 row_ror:8 row_mask:0xf bank_mask:0xf
    v_pk_mul_f32 v[92:93], v[88:89], v[36:37] op_sel_hi:[1,0]
    v_fmac_f32 v94, v38, v90
    v_pk_fma_f32 v[92:93], v[88:89], v[36:37], v[92:93] op_sel:[1,1,0] op_sel_hi:[0,1,1] neg_lo:[1,0,0]

    v_mov_b32 v98, v94
    v_mov_b64 v[96:97], v[92:93]
    s_nop 0
    v_permlane32_swap_b32 v94, v98
    v_permlane32_swap_b32 v92, v96
    v_permlane32_swap_b32 v93, v97
    v_add_f32 v94, v94, v98
    v_pk_add_f32 v[92:93], v[92:93], v[96:97]

    v_mov_b32 v98, v94
    v_mov_b64 v[96:97], v[92:93]
    s_nop 0
    v_permlane16_swap_b32 v94, v98
    v_permlane16_swap_b32 v92, v96
    v_permlane16_swap_b32 v93, v97
    v_add_f32 v94, v94, v98
    v_pk_add_f32 v[92:93], v[92:93], v[96:97]

    v_fma_f32 v84, -v44, v94, v84
    v_pk_fma_f32 v[80:81], v[40:41], v[92:93], v[80:81] op_sel_hi:[1,0,1]
    v_pk_fma_f32 v[82:83], v[40:41], v[92:93], v[82:83] op_sel:[0,1,0]
    v_fmac_f32_dpp v84, -v94, v45 row_ror:8 row_mask:0xf bank_mask:0xf
    v_pk_fma_f32 v[80:81], v[42:43], v[92:93], v[80:81] op_sel:[0,1,0] neg_lo:[1,0,0] neg_hi:[1,0,0]
    v_pk_fma_f32 v[82:83], v[42:43], v[92:93], v[82:83] op_sel_hi:[1,0,1]

    v_fmac_f32_dpp v48, -v84, v131 row_ror:8 row_mask:0xf bank_mask:0xf
    v_fmac_f32 v48, v130, v84
    v_pk_fma_f32 v[0:1], v[80:81], v[128:129], v[0:1] op_sel_hi:[1,0,1]
    v_pk_fma_f32 v[16:17], v[82:83], v[128:129], v[16:17] op_sel_hi:[1,0,1]
    v_fmac_f32_dpp v49, -v48, v131 row_ror:8 row_mask:0xf bank_mask:0xf
    v_fmac_f32 v49, v130, v48
    v_pk_fma_f32 v[0:1], v[82:83], v[128:129], v[0:1] op_sel:[0,1,0] neg_lo:[1,0,0] neg_hi:[1,0,0]
    v_pk_fma_f32 v[16:17], v[80:81], v[128:129], v[16:17] op_sel:[0,1,0]
    v_fmac_f32_dpp v50, -v49, v131 row_ror:8 row_mask:0xf bank_mask:0xf
    v_fmac_f32 v50, v130, v49
    v_pk_fma_f32 v[2:3], v[0:1], v[128:129], v[2:3] op_sel_hi:[1,0,1]
    v_pk_fma_f32 v[18:19], v[16:17], v[128:129], v[18:19] op_sel_hi:[1,0,1]
    v_fmac_f32_dpp v51, -v50, v131 row_ror:8 row_mask:0xf bank_mask:0xf
    v_fmac_f32 v51, v130, v50
    v_pk_fma_f32 v[2:3], v[16:17], v[128:129], v[2:3] op_sel:[0,1,0] neg_lo:[1,0,0] neg_hi:[1,0,0]
    v_pk_fma_f32 v[18:19], v[0:1], v[128:129], v[18:19] op_sel:[0,1,0]
    v_cvt_pk_bf16_f32 v104, v0, v1
    v_cvt_pk_bf16_f32 v105, v2, v3
    v_cvt_pk_bf16_f32 v106, -v16, -v17
    v_cvt_pk_bf16_f32 v107, -v18, -v19

    ds_write_b128 v56, v[104:107] offset:0
    ds_read_b64_tr_b16 v[88:89], v58 offset:0
    ds_read_b64_tr_b16 v[90:91], v59 offset:0
    v_fmac_f32_dpp v52, -v51, v131 row_ror:8 row_mask:0xf bank_mask:0xf
    v_fmac_f32 v52, v130, v51
    v_pk_fma_f32 v[4:5], v[2:3], v[128:129], v[4:5] op_sel_hi:[1,0,1]
    v_pk_fma_f32 v[20:21], v[18:19], v[128:129], v[20:21] op_sel_hi:[1,0,1]
    v_fmac_f32_dpp v53, -v52, v131 row_ror:8 row_mask:0xf bank_mask:0xf
    v_fmac_f32 v53, v130, v52
    v_pk_fma_f32 v[4:5], v[18:19], v[128:129], v[4:5] op_sel:[0,1,0] neg_lo:[1,0,0] neg_hi:[1,0,0]
    v_pk_fma_f32 v[20:21], v[2:3], v[128:129], v[20:21] op_sel:[0,1,0]
    v_fmac_f32_dpp v54, -v53, v131 row_ror:8 row_mask:0xf bank_mask:0xf
    v_fmac_f32 v54, v130, v53
    v_pk_fma_f32 v[6:7], v[4:5], v[128:129], v[6:7] op_sel_hi:[1,0,1]
    v_pk_fma_f32 v[22:23], v[20:21], v[128:129], v[22:23] op_sel_hi:[1,0,1]
    v_fmac_f32_dpp v55, -v54, v131 row_ror:8 row_mask:0xf bank_mask:0xf
    v_fmac_f32 v55, v130, v54
    v_pk_fma_f32 v[6:7], v[20:21], v[128:129], v[6:7] op_sel:[0,1,0] neg_lo:[1,0,0] neg_hi:[1,0,0]
    v_pk_fma_f32 v[22:23], v[4:5], v[128:129], v[22:23] op_sel:[0,1,0]
    v_cvt_pk_bf16_f32 v108, v4, v5
    v_cvt_pk_bf16_f32 v109, v6, v7
    v_cvt_pk_bf16_f32 v110, -v20, -v21
    v_cvt_pk_bf16_f32 v111, -v22, -v23

    ds_write_b128 v56, v[108:111] offset:1024
    ds_read_b64_tr_b16 v[92:93], v58 offset:1024
    ds_read_b64_tr_b16 v[94:95], v59 offset:1024
    v_pk_fma_f32 v[8:9], v[6:7], v[128:129], v[8:9] op_sel_hi:[1,0,1]
    v_pk_fma_f32 v[24:25], v[22:23], v[128:129], v[24:25] op_sel_hi:[1,0,1]
    v_pk_fma_f32 v[8:9], v[22:23], v[128:129], v[8:9] op_sel:[0,1,0] neg_lo:[1,0,0] neg_hi:[1,0,0]
    v_pk_fma_f32 v[24:25], v[6:7], v[128:129], v[24:25] op_sel:[0,1,0]
    v_cvt_pk_bf16_f32 v112, v48, v49
    v_cvt_pk_bf16_f32 v113, v50, v51
    v_cvt_pk_bf16_f32 v114, v52, v53
    v_cvt_pk_bf16_f32 v115, v54, v55
    ds_write2st64_b32 v60, v112, v113 offset0:0 offset1:1
    ds_write2st64_b32 v60, v114, v115 offset0:2 offset1:3
    ds_read_b64_tr_b16 v[116:117], v61 offset:0
    ds_read_b64_tr_b16 v[118:119], v61 offset:128
    v_pk_fma_f32 v[10:11], v[8:9], v[128:129], v[10:11] op_sel_hi:[1,0,1]
    v_pk_fma_f32 v[26:27], v[24:25], v[128:129], v[26:27] op_sel_hi:[1,0,1]
    v_pk_fma_f32 v[10:11], v[24:25], v[128:129], v[10:11] op_sel:[0,1,0] neg_lo:[1,0,0] neg_hi:[1,0,0]
    v_pk_fma_f32 v[26:27], v[8:9], v[128:129], v[26:27] op_sel:[0,1,0]
    v_cvt_pk_bf16_f32 v104, v8, v9
    v_cvt_pk_bf16_f32 v105, v10, v11
    v_cvt_pk_bf16_f32 v106, -v24, -v25
    v_cvt_pk_bf16_f32 v107, -v26, -v27

    ds_write_b128 v56, v[104:107] offset:0
    ds_read_b64_tr_b16 v[96:97], v58 offset:0
    ds_read_b64_tr_b16 v[98:99], v59 offset:0
    s_waitcnt vmcnt(0)
L_xr:
    v_cmp_ne_u32 vcc, s13, v64
    s_cbranch_vccnz L_xr_re
    s_waitcnt lgkmcnt(10)
    v_and_b32 v88, -2, v88
    v_and_b32 v90, -2, v90
    s_cmp_eq_u32 s88, 0
    s_cbranch_scc1 Lss_25
    buffer_store_dwordx4 v[88:91], v153, s[64:67], s36 offen
Lsd_26:
    v_pk_fma_f32 v[12:13], v[10:11], v[128:129], v[12:13] op_sel_hi:[1,0,1]
    v_pk_fma_f32 v[28:29], v[26:27], v[128:129], v[28:29] op_sel_hi:[1,0,1]
    v_pk_fma_f32 v[12:13], v[26:27], v[128:129], v[12:13] op_sel:[0,1,0] neg_lo:[1,0,0] neg_hi:[1,0,0]
    v_pk_fma_f32 v[28:29], v[10:11], v[128:129], v[28:29] op_sel:[0,1,0]
    v_pk_fma_f32 v[14:15], v[12:13], v[128:129], v[14:15] op_sel_hi:[1,0,1]
    v_pk_fma_f32 v[30:31], v[28:29], v[128:129], v[30:31] op_sel_hi:[1,0,1]
    v_pk_fma_f32 v[14:15], v[28:29], v[128:129], v[14:15] op_sel:[0,1,0] neg_lo:[1,0,0] neg_hi:[1,0,0]
    v_pk_fma_f32 v[30:31], v[12:13], v[128:129], v[30:31] op_sel:[0,1,0]
    v_cvt_pk_bf16_f32 v108, v12, v13
    v_cvt_pk_bf16_f32 v109, v14, v15
    v_cvt_pk_bf16_f32 v110, -v28, -v29
    v_cvt_pk_bf16_f32 v111, -v30, -v31

    ds_write_b128 v56, v[108:111] offset:1024
    ds_read_b64_tr_b16 v[100:101], v58 offset:1024
    ds_read_b64_tr_b16 v[102:103], v59 offset:1024
    s_waitcnt lgkmcnt(10)
    v_and_b32 v92, -2, v92
    v_and_b32 v94, -2, v94
    s_cmp_eq_u32 s88, 0
    s_cbranch_scc1 Lss_27
    buffer_store_dwordx4 v[92:95], v153, s[64:67], s18 offen
Lsd_28:
    s_waitcnt lgkmcnt(6)
    v_and_b32 v116, -2, v116
    v_and_b32 v118, -2, v118
    s_cmp_eq_u32 s88, 0
    s_cbranch_scc1 Lss_29
    buffer_store_dwordx2 v[116:117], v62, s[64:67], s37 offen offset:0
    buffer_store_dwordx2 v[118:119], v62, s[64:67], s37 offen offset:512
Lsd_30:
    s_waitcnt lgkmcnt(3)
    v_and_b32 v96, -2, v96
    v_and_b32 v98, -2, v98
    s_cmp_eq_u32 s88, 0
    s_cbranch_scc1 Lss_31
    buffer_store_dwordx4 v[96:99], v153, s[64:67], s19 offen
Lsd_32:
    s_waitcnt lgkmcnt(0)
    v_and_b32 v100, -2, v100
    v_and_b32 v102, -2, v102
    s_cmp_eq_u32 s88, 0
    s_cbranch_scc1 Lss_33
    buffer_store_dwordx4 v[100:103], v153, s[64:67], s20 offen
Lsd_34:
    s_lshl_b32 s8, s77, 2
    s_add_u32 s8, s8, 61440
    v_bfe_u32 v121, v152, 4, 2
    v_lshl_add_u32 v120, v121, 5, s8
    v_bfe_u32 v121, v152, 2, 1
    v_lshl_add_u32 v120, v121, 4, v120
    v_bfe_u32 v121, v152, 3, 1
    v_lshl_add_u32 v120, v121, 1, v120
    v_and_b32 v121, 3, v152
    v_lshl_add_u32 v120, v121, 9, v120
    s_barrier
    v_accvgpr_write_b32 a0, 0
    v_accvgpr_write_b32 a1, 0
    v_accvgpr_write_b32 a2, 0
    ds_read_u16_d16_hi a0, v120 offset:0
    v_accvgpr_write_b32 a3, 0
    ds_read_u16_d16_hi a1, v120 offset:128
    v_accvgpr_write_b32 a4, 0
    ds_read_u16_d16_hi a2, v120 offset:256
    v_accvgpr_write_b32 a5, 0
    ds_read_u16_d16_hi a3, v120 offset:384
    v_accvgpr_write_b32 a6, 0
    ds_read_u16_d16_hi a4, v120 offset:2048
    v_accvgpr_write_b32 a7, 0
    ds_read_u16_d16_hi a5, v120 offset:2176
    v_accvgpr_write_b32 a8, 0
    ds_read_u16_d16_hi a6, v120 offset:2304
    v_accvgpr_write_b32 a9, 0
    ds_read_u16_d16_hi a7, v120 offset:2432
    v_accvgpr_write_b32 a10, 0
    ds_read_u16_d16_hi a8, v120 offset:4096
    v_accvgpr_write_b32 a11, 0
    ds_read_u16_d16_hi a9, v120 offset:4224
    v_accvgpr_write_b32 a12, 0
    ds_read_u16_d16_hi a10, v120 offset:4352
    v_accvgpr_write_b32 a13, 0
    ds_read_u16_d16_hi a11, v120 offset:4480
    v_accvgpr_write_b32 a14, 0
    ds_read_u16_d16_hi a12, v120 offset:6144
    v_accvgpr_write_b32 a15, 0
    ds_read_u16_d16_hi a13, v120 offset:6272
    v_accvgpr_write_b32 a16, 0
    ds_read_u16_d16_hi a14, v120 offset:6400
    v_accvgpr_write_b32 a17, 0
    ds_read_u16_d16_hi a15, v120 offset:6528
    v_accvgpr_write_b32 a18, 0
    ds_read_u16_d16_hi a16, v120 offset:8192
    v_accvgpr_write_b32 a19, 0
    ds_read_u16_d16_hi a17, v120 offset:8320
    ds_read_u16_d16_hi a18, v120 offset:8448
    ds_read_u16_d16_hi a19, v120 offset:8576
L_hp:
    s_sub_u32 s101, s101, 1
    s_cbranch_scc1 L_end
    buffer_load_dwordx4 v[40:43], v175, s[64:67], s23 offen offset:0 sc1
    buffer_load_dwordx4 v[44:47], v175, s[64:67], s23 offen offset:1024 sc1
    buffer_load_dwordx4 v[48:51], v175, s[64:67], s23 offen offset:2048 sc1
    buffer_load_dwordx4 v[120:123], v175, s[64:67], s22 offen offset:0 sc1
    buffer_load_dwordx4 v[80:83], v175, s[64:67], s25 offen offset:0 sc1
    buffer_load_dwordx4 v[116:119], v175, s[64:67], s28 offen offset:0 sc1
    buffer_load_dwordx4 v[64:67], v175, s[64:67], s31 offen offset:0 sc1
    s_waitcnt vmcnt(4)
    v_bitop3_b32 v169, v40, v42, v44 bitop3:254
    v_bitop3_b32 v169, v169, v46, v48 bitop3:254
    v_bitop3_b32 v169, v169, v50, 1 bitop3:168
    v_cmp_ne_u32 vcc, 0, v169
    s_cbranch_vccnz Lh1c0r
Lh1c0:
    v_mfma_f32_16x16x32_bf16 v[132:135], a[232:235], v[40:43], v[132:135]
    buffer_load_dwordx4 v[60:63], v175, s[64:67], s22 offen offset:1024 sc1
    v_mfma_f32_16x16x32_bf16 v[136:139], v[176:179], v[40:43], v[136:139]
    v_mfma_f32_16x16x32_bf16 v[140:143], v[192:195], v[40:43], v[140:143]
    v_mfma_f32_16x16x32_bf16 v[144:147], v[208:211], v[40:43], v[144:147]
    v_mfma_f32_16x16x32_bf16 v[148:151], a[216:219], v[40:43], v[148:151]
    buffer_load_dwordx4 v[68:71], v175, s[64:67], s25 offen offset:1024 sc1
    v_mfma_f32_16x16x32_bf16 v[132:135], a[236:239], v[44:47], v[132:135]
    v_mfma_f32_16x16x32_bf16 v[136:139], v[180:183], v[44:47], v[136:139]
    v_mfma_f32_16x16x32_bf16 v[140:143], v[196:199], v[44:47], v[140:143]
    v_mfma_f32_16x16x32_bf16 v[144:147], v[212:215], v[44:47], v[144:147]
    ds_read_b128 v[124:127], v156 offset:8192
    buffer_load_dwordx4 v[72:75], v175, s[64:67], s28 offen offset:1024 sc1
    s_waitcnt vmcnt(3)
    v_bitop3_b32 v169, v120, v122, v80 bitop3:254
    v_bitop3_b32 v169, v169, v82, v116 bitop3:254
    v_mfma_f32_16x16x32_bf16 v[148:151], a[220:223], v[44:47], v[148:151]
    v_bitop3_b32 v169, v169, v118, v64 bitop3:254
    v_bitop3_b32 v169, v169, v66, 1 bitop3:168
    v_mfma_f32_16x16x32_bf16 v[132:135], a[240:243], v[48:51], v[132:135]
    v_cmp_ne_u32 vcc, 0, v169
    v_mfma_f32_16x16x32_bf16 v[136:139], v[184:187], v[48:51], v[136:139]
    v_mfma_f32_16x16x32_bf16 v[140:143], v[200:203], v[48:51], v[140:143]
    ds_read_b128 v[128:131], v156 offset:12288
    buffer_load_dwordx4 v[76:79], v175, s[64:67], s31 offen offset:1024 sc1
    v_mfma_f32_16x16x32_bf16 v[144:147], v[216:219], v[48:51], v[144:147]
    v_mfma_f32_16x16x32_bf16 v[148:151], a[224:227], v[48:51], v[148:151]
    s_cbranch_vccnz Lh1c1r
Lh1c1:
    v_mfma_f32_16x16x32_bf16 v[148:151], a[200:203], v[120:123], v[148:151]
    v_mfma_f32_16x16x32_bf16 v[40:43], a[200:203], v[80:83], 0
    ds_read_b128 v[112:115], v156 offset:0
    buffer_load_dwordx4 v[84:87], v175, s[64:67], s22 offen offset:2048 sc1
    v_mfma_f32_16x16x32_bf16 v[44:47], a[200:203], v[116:119], 0
    v_mfma_f32_16x16x32_bf16 v[48:51], a[200:203], v[64:67], 0
    s_waitcnt lgkmcnt(2)
    v_mfma_f32_16x16x32_bf16 v[140:143], v[124:127], v[120:123], v[140:143]
    v_mfma_f32_16x16x32_bf16 v[52:55], v[124:127], v[80:83], 0
    buffer_load_dwordx4 v[88:91], v175, s[64:67], s25 offen offset:2048 sc1
    v_mfma_f32_16x16x32_bf16 v[56:59], v[124:127], v[116:119], 0
    v_mfma_f32_16x16x32_bf16 v[0:3], v[124:127], v[64:67], 0
    ds_read_b128 v[124:127], v156 offset:4096
    s_waitcnt lgkmcnt(2)
    v_mfma_f32_16x16x32_bf16 v[144:147], v[128:131], v[120:123], v[144:147]
    v_mfma_f32_16x16x32_bf16 v[4:7], v[128:131], v[80:83], 0
    buffer_load_dwordx4 v[92:95], v175, s[64:67], s28 offen offset:2048 sc1
    v_mfma_f32_16x16x32_bf16 v[8:11], v[128:131], v[116:119], 0
    v_mfma_f32_16x16x32_bf16 v[12:15], v[128:131], v[64:67], 0
    ds_read_b128 v[128:131], v157 offset:8192
    s_waitcnt lgkmcnt(2)
    v_mfma_f32_16x16x32_bf16 v[132:135], v[112:115], v[120:123], v[132:135]
    v_mfma_f32_16x16x32_bf16 v[28:31], v[112:115], v[80:83], 0
    buffer_load_dwordx4 v[96:99], v175, s[64:67], s31 offen offset:2048 sc1
    s_waitcnt vmcnt(4)
    v_bitop3_b32 v169, v60, v62, v68 bitop3:254
    v_bitop3_b32 v169, v169, v70, v72 bitop3:254
    v_mfma_f32_16x16x32_bf16 v[32:35], v[112:115], v[116:119], 0
    v_bitop3_b32 v169, v169, v74, v76 bitop3:254
    v_bitop3_b32 v169, v169, v78, 1 bitop3:168
    v_mfma_f32_16x16x32_bf16 v[36:39], v[112:115], v[64:67], 0
    ds_read_b128 v[112:115], v157 offset:12288
    v_cmp_ne_u32 vcc, 0, v169
    s_waitcnt lgkmcnt(2)
    v_mfma_f32_16x16x32_bf16 v[136:139], v[124:127], v[120:123], v[136:139]
    v_mfma_f32_16x16x32_bf16 v[16:19], v[124:127], v[80:83], 0
    buffer_load_dwordx4 v[100:103], v175, s[64:67], s22 offen offset:3072 sc1
    v_mfma_f32_16x16x32_bf16 v[20:23], v[124:127], v[116:119], 0
    v_mfma_f32_16x16x32_bf16 v[24:27], v[124:127], v[64:67], 0
    ds_read_b128 v[124:127], v157 offset:0
    s_cbranch_vccnz Lh1c2r
Lh1c2:
    v_mfma_f32_16x16x32_bf16 v[148:151], a[204:207], v[60:63], v[148:151]
    v_mfma_f32_16x16x32_bf16 v[40:43], a[204:207], v[68:71], v[40:43]
    buffer_load_dwordx4 v[104:107], v175, s[64:67], s25 offen offset:3072 sc1
    v_mfma_f32_16x16x32_bf16 v[44:47], a[204:207], v[72:75], v[44:47]
    v_mfma_f32_16x16x32_bf16 v[48:51], a[204:207], v[76:79], v[48:51]
    s_waitcnt lgkmcnt(2)
    v_mfma_f32_16x16x32_bf16 v[140:143], v[128:131], v[60:63], v[140:143]
    v_mfma_f32_16x16x32_bf16 v[52:55], v[128:131], v[68:71], v[52:55]
    buffer_load_dwordx4 v[108:111], v175, s[64:67], s28 offen offset:3072 sc1
    v_mfma_f32_16x16x32_bf16 v[56:59], v[128:131], v[72:75], v[56:59]
    v_mfma_f32_16x16x32_bf16 v[0:3], v[128:131], v[76:79], v[0:3]
    ds_read_b128 v[128:131], v157 offset:4096
    s_waitcnt lgkmcnt(2)
    v_mfma_f32_16x16x32_bf16 v[144:147], v[112:115], v[60:63], v[144:147]
    v_mfma_f32_16x16x32_bf16 v[4:7], v[112:115], v[68:71], v[4:7]
    buffer_load_dwordx4 v[120:123], v175, s[64:67], s31 offen offset:3072 sc1
    v_mfma_f32_16x16x32_bf16 v[8:11], v[112:115], v[72:75], v[8:11]
    v_mfma_f32_16x16x32_bf16 v[12:15], v[112:115], v[76:79], v[12:15]
    ds_read_b128 v[112:115], v156 offset:8704
    s_waitcnt lgkmcnt(2)
    v_mfma_f32_16x16x32_bf16 v[132:135], v[124:127], v[60:63], v[132:135]
    v_mfma_f32_16x16x32_bf16 v[28:31], v[124:127], v[68:71], v[28:31]
    buffer_load_dwordx4 v[80:83], v175, s[64:67], s26 offen offset:0 sc1
    s_waitcnt vmcnt(5)
    v_bitop3_b32 v169, v84, v86, v88 bitop3:254
    v_bitop3_b32 v169, v169, v90, v92 bitop3:254
    v_mfma_f32_16x16x32_bf16 v[32:35], v[124:127], v[72:75], v[32:35]
    v_bitop3_b32 v169, v169, v94, v96 bitop3:254
    v_bitop3_b32 v169, v169, v98, 1 bitop3:168
    v_mfma_f32_16x16x32_bf16 v[36:39], v[124:127], v[76:79], v[36:39]
    ds_read_b128 v[124:127], v156 offset:12800
    v_cmp_ne_u32 vcc, 0, v169
    s_waitcnt lgkmcnt(2)
    v_mfma_f32_16x16x32_bf16 v[136:139], v[128:131], v[60:63], v[136:139]
    v_mfma_f32_16x16x32_bf16 v[16:19], v[128:131], v[68:71], v[16:19]
    buffer_load_dwordx4 v[116:119], v175, s[64:67], s26 offen offset:1024 sc1
    v_mfma_f32_16x16x32_bf16 v[20:23], v[128:131], v[72:75], v[20:23]
    v_mfma_f32_16x16x32_bf16 v[24:27], v[128:131], v[76:79], v[24:27]
    ds_read_b128 v[128:131], v156 offset:512
    s_cbranch_vccnz Lh1c3r
Lh1c3:
    v_mfma_f32_16x16x32_bf16 v[148:151], a[208:211], v[84:87], v[148:151]
    v_mfma_f32_16x16x32_bf16 v[40:43], a[208:211], v[88:91], v[40:43]
    buffer_load_dwordx4 v[64:67], v175, s[64:67], s26 offen offset:2048 sc1
    v_mfma_f32_16x16x32_bf16 v[44:47], a[208:211], v[92:95], v[44:47]
    v_mfma_f32_16x16x32_bf16 v[48:51], a[208:211], v[96:99], v[48:51]
    s_waitcnt lgkmcnt(2)
    v_mfma_f32_16x16x32_bf16 v[140:143], v[112:115], v[84:87], v[140:143]
    v_mfma_f32_16x16x32_bf16 v[52:55], v[112:115], v[88:91], v[52:55]
    buffer_load_dwordx4 v[60:63], v175, s[64:67], s26 offen offset:3072 sc1
    v_mfma_f32_16x16x32_bf16 v[56:59], v[112:115], v[92:95], v[56:59]
    v_mfma_f32_16x16x32_bf16 v[0:3], v[112:115], v[96:99], v[0:3]
    ds_read_b128 v[112:115], v156 offset:4608
    s_waitcnt lgkmcnt(2)
    v_mfma_f32_16x16x32_bf16 v[144:147], v[124:127], v[84:87], v[144:147]
    v_mfma_f32_16x16x32_bf16 v[4:7], v[124:127], v[88:91], v[4:7]
    buffer_load_dwordx4 v[68:71], v175, s[64:67], s27 offen offset:0 sc1
    v_mfma_f32_16x16x32_bf16 v[8:11], v[124:127], v[92:95], v[8:11]
    v_mfma_f32_16x16x32_bf16 v[12:15], v[124:127], v[96:99], v[12:15]
    ds_read_b128 v[124:127], v157 offset:8704
    s_waitcnt lgkmcnt(2)
    v_mfma_f32_16x16x32_bf16 v[132:135], v[128:131], v[84:87], v[132:135]
    v_mfma_f32_16x16x32_bf16 v[28:31], v[128:131], v[88:91], v[28:31]
    buffer_load_dwordx4 v[72:75], v175, s[64:67], s27 offen offset:1024 sc1
    s_waitcnt vmcnt(6)
    v_bitop3_b32 v169, v100, v102, v104 bitop3:254
    v_bitop3_b32 v169, v169, v106, v108 bitop3:254
    v_mfma_f32_16x16x32_bf16 v[32:35], v[128:131], v[92:95], v[32:35]
    v_bitop3_b32 v169, v169, v110, v120 bitop3:254
    v_bitop3_b32 v169, v169, v122, 1 bitop3:168
    v_mfma_f32_16x16x32_bf16 v[36:39], v[128:131], v[96:99], v[36:39]
    ds_read_b128 v[128:131], v157 offset:12800
    v_cmp_ne_u32 vcc, 0, v169
    s_waitcnt lgkmcnt(2)
    v_mfma_f32_16x16x32_bf16 v[136:139], v[112:115], v[84:87], v[136:139]
    v_mfma_f32_16x16x32_bf16 v[16:19], v[112:115], v[88:91], v[16:19]
    buffer_load_dwordx4 v[76:79], v175, s[64:67], s29 offen offset:0 sc1
    v_mfma_f32_16x16x32_bf16 v[20:23], v[112:115], v[92:95], v[20:23]
    v_mfma_f32_16x16x32_bf16 v[24:27], v[112:115], v[96:99], v[24:27]
    ds_read_b128 v[112:115], v157 offset:512
    s_cbranch_vccnz Lh1c4r
Lh1c4:
    v_mfma_f32_16x16x32_bf16 v[148:151], a[212:215], v[100:103], v[148:151]
    v_mfma_f32_16x16x32_bf16 v[40:43], a[212:215], v[104:107], v[40:43]
    buffer_load_dwordx4 v[84:87], v175, s[64:67], s29 offen offset:1024 sc1
    v_mfma_f32_16x16x32_bf16 v[44:47], a[212:215], v[108:111], v[44:47]
    v_mfma_f32_16x16x32_bf16 v[48:51], a[212:215], v[120:123], v[48:51]
    s_waitcnt lgkmcnt(2)
    v_mfma_f32_16x16x32_bf16 v[140:143], v[124:127], v[100:103], v[140:143]
    v_mfma_f32_16x16x32_bf16 v[52:55], v[124:127], v[104:107], v[52:55]
    buffer_load_dwordx4 v[88:91], v175, s[64:67], s29 offen offset:2048 sc1
    v_mfma_f32_16x16x32_bf16 v[56:59], v[124:127], v[108:111], v[56:59]
    v_mfma_f32_16x16x32_bf16 v[0:3], v[124:127], v[120:123], v[0:3]
    ds_read_b128 v[124:127], v157 offset:4608
    s_waitcnt lgkmcnt(2)
    v_mfma_f32_16x16x32_bf16 v[144:147], v[128:131], v[100:103], v[144:147]
    v_mfma_f32_16x16x32_bf16 v[4:7], v[128:131], v[104:107], v[4:7]
    buffer_load_dwordx4 v[92:95], v175, s[64:67], s29 offen offset:3072 sc1
    v_mfma_f32_16x16x32_bf16 v[8:11], v[128:131], v[108:111], v[8:11]
    v_mfma_f32_16x16x32_bf16 v[12:15], v[128:131], v[120:123], v[12:15]
    s_waitcnt lgkmcnt(1)
    v_mfma_f32_16x16x32_bf16 v[132:135], v[112:115], v[100:103], v[132:135]
    v_mfma_f32_16x16x32_bf16 v[28:31], v[112:115], v[104:107], v[28:31]
    buffer_load_dwordx4 v[96:99], v175, s[64:67], s30 offen offset:0 sc1
    s_waitcnt vmcnt(5)
    v_bitop3_b32 v169, v80, v82, v116 bitop3:254
    v_bitop3_b32 v169, v169, v118, v64 bitop3:254
    v_mfma_f32_16x16x32_bf16 v[32:35], v[112:115], v[108:111], v[32:35]
    v_bitop3_b32 v169, v169, v66, v60 bitop3:254
    v_bitop3_b32 v169, v169, v62, v68 bitop3:254
    v_mfma_f32_16x16x32_bf16 v[36:39], v[112:115], v[120:123], v[36:39]
    v_bitop3_b32 v169, v169, v70, v72 bitop3:254
    v_bitop3_b32 v169, v169, v74, 1 bitop3:168
    s_waitcnt lgkmcnt(0)
    v_mfma_f32_16x16x32_bf16 v[136:139], v[124:127], v[100:103], v[136:139]
    v_cmp_ne_u32 vcc, 0, v169
    v_mfma_f32_16x16x32_bf16 v[16:19], v[124:127], v[104:107], v[16:19]
    buffer_load_dwordx4 v[100:103], v175, s[64:67], s30 offen offset:1024 sc1
    v_mfma_f32_16x16x32_bf16 v[20:23], v[124:127], v[108:111], v[20:23]
    v_mfma_f32_16x16x32_bf16 v[24:27], v[124:127], v[120:123], v[24:27]
    s_cbranch_vccnz Lh1c5r
Lh1c5:
    v_mfma_f32_16x16x32_bf16 v[28:31], a[232:235], v[80:83], v[28:31]
    v_mfma_f32_16x16x32_bf16 v[28:31], a[236:239], v[116:119], v[28:31]
    buffer_load_dwordx4 v[104:107], v175, s[64:67], s32 offen offset:0 sc1
    v_mfma_f32_16x16x32_bf16 v[28:31], a[240:243], v[64:67], v[28:31]
    v_mfma_f32_16x16x32_bf16 v[28:31], a[244:247], v[60:63], v[28:31]
    v_mfma_f32_16x16x32_bf16 v[28:31], v[224:227], v[68:71], v[28:31]
    s_add_u32 s3, s77, 1
    s_and_b32 s3, s3, 3
    v_mfma_f32_16x16x32_bf16 v[28:31], v[228:231], v[72:75], v[28:31]
    s_mul_i32 s3, s3, 15360
    buffer_load_dwordx4 v[108:111], v175, s[64:67], s32 offen offset:1024 sc1
    v_add_u32 v165, s3, v153
    v_mfma_f32_16x16x32_bf16 v[16:19], v[176:179], v[80:83], v[16:19]
    s_mul_i32 s8, s77, 15360
    s_movk_i32 s9, 320
    v_mfma_f32_16x16x32_bf16 v[16:19], v[180:183], v[116:119], v[16:19]
    v_and_b32 v124, 15, v152
    v_lshrrev_b32 v112, 4, v152
    v_mfma_f32_16x16x32_bf16 v[16:19], v[184:187], v[64:67], v[16:19]
    v_bfe_u32 v113, v152, 1, 2
    v_mov_b32 v114, s8
    v_mfma_f32_16x16x32_bf16 v[16:19], v[188:191], v[60:63], v[16:19]
    ds_write_b128 v165, v[28:31] offset:0
    buffer_load_dwordx4 v[120:123], v175, s[64:67], s32 offen offset:2048 sc1
    v_mfma_f32_16x16x32_bf16 v[16:19], v[232:235], v[68:71], v[16:19]
    v_mad_u32_u24 v124, v124, s9, v114
    v_xor_b32 v126, v112, v113
    v_mfma_f32_16x16x32_bf16 v[16:19], v[236:239], v[72:75], v[16:19]
    v_lshl_add_u32 v126, v126, 4, v124
    v_lshrrev_b32 v115, 1, v112
    v_mfma_f32_16x16x32_bf16 v[52:55], v[192:195], v[80:83], v[52:55]
    v_lshl_add_u32 v124, v115, 6, v124
    v_and_b32 v115, 1, v112
    v_mfma_f32_16x16x32_bf16 v[52:55], v[196:199], v[116:119], v[52:55]
    v_lshlrev_b32 v115, 1, v115
    v_xor_b32 v115, v115, v113
    v_mfma_f32_16x16x32_bf16 v[52:55], v[200:203], v[64:67], v[52:55]
    v_lshl_add_u32 v124, v115, 4, v124
    v_xor_b32 v125, 16, v124
    v_mfma_f32_16x16x32_bf16 v[52:55], v[204:207], v[60:63], v[52:55]
    ds_write_b128 v165, v[16:19] offset:1024
    v_lshrrev_b32 v115, 2, v152
    v_mfma_f32_16x16x32_bf16 v[52:55], v[240:243], v[68:71], v[52:55]
    v_mad_u32_u24 v127, v115, s9, v114
    v_bfe_u32 v113, v152, 3, 2
    v_mfma_f32_16x16x32_bf16 v[52:55], v[244:247], v[72:75], v[52:55]
    v_and_b32 v114, 3, v152
    v_xor_b32 v113, v113, v114
    v_mfma_f32_16x16x32_bf16 v[4:7], v[208:211], v[80:83], v[4:7]
    v_lshl_add_u32 v127, v113, 4, v127
    v_mfma_f32_16x16x32_bf16 v[4:7], v[212:215], v[116:119], v[4:7]
    s_lshl_b32 s8, s77, 4
    s_add_u32 s8, s8, 93184
    v_mfma_f32_16x16x32_bf16 v[4:7], v[216:219], v[64:67], v[4:7]
    v_lshl_add_u32 v128, v112, 6, s8
    v_and_b32 v115, 3, v115
    v_mfma_f32_16x16x32_bf16 v[4:7], v[220:223], v[60:63], v[4:7]
    ds_write_b128 v165, v[52:55] offset:2048
    v_lshl_add_u32 v128, v115, 2, v128
    v_mfma_f32_16x16x32_bf16 v[4:7], v[248:251], v[68:71], v[4:7]
    v_lshl_add_u32 v112, v112, 2, v114
    v_lshlrev_b32 v163, 4, v112
    v_mfma_f32_16x16x32_bf16 v[4:7], v[252:255], v[72:75], v[4:7]
    s_waitcnt vmcnt(3)
    v_bitop3_b32 v169, v76, v78, v84 bitop3:254
    v_bitop3_b32 v169, v169, v86, v88 bitop3:254
    v_mfma_f32_16x16x32_bf16 v[40:43], a[216:219], v[80:83], v[40:43]
    buffer_load_dwordx4 v[80:83], v175, s[64:67], s32 offen offset:3072 sc1
    v_bitop3_b32 v169, v169, v90, v92 bitop3:254
    v_bitop3_b32 v169, v169, v94, v96 bitop3:254
    v_mfma_f32_16x16x32_bf16 v[40:43], a[220:223], v[116:119], v[40:43]
    v_bitop3_b32 v169, v169, v98, v100 bitop3:254
    v_bitop3_b32 v169, v169, v102, 1 bitop3:168
    v_mfma_f32_16x16x32_bf16 v[40:43], a[224:227], v[64:67], v[40:43]
    v_cmp_ne_u32 vcc, 0, v169
    v_lshl_add_u32 v163, v115, 9, v163
    v_mfma_f32_16x16x32_bf16 v[40:43], a[228:231], v[60:63], v[40:43]
    ds_write_b128 v165, v[4:7] offset:3072
    ds_read_b32 v128, v128
    v_mfma_f32_16x16x32_bf16 v[40:43], a[248:251], v[68:71], v[40:43]
    buffer_load_dwordx4 v[116:119], v175, s[64:67], s33 offen offset:0 sc1
    s_lshl_b32 s8, s77, 2
    v_mfma_f32_16x16x32_bf16 v[40:43], a[252:255], v[72:75], v[40:43]
    s_cbranch_vccnz Lh1c6r
Lh1c6:
    s_add_u32 s8, s8, 0
    v_mfma_f32_16x16x32_bf16 v[32:35], a[232:235], v[76:79], v[32:35]
    v_bfe_u32 v113, v152, 4, 2
    v_lshl_add_u32 v131, v113, 5, s8
    v_mfma_f32_16x16x32_bf16 v[32:35], a[236:239], v[84:87], v[32:35]
    v_bfe_u32 v113, v152, 2, 1
    v_lshl_add_u32 v131, v113, 4, v131
    v_mfma_f32_16x16x32_bf16 v[32:35], a[240:243], v[88:91], v[32:35]
    buffer_load_dwordx4 v[64:67], v175, s[64:67], s33 offen offset:1024 sc1
    v_bfe_u32 v113, v152, 3, 1
    v_mfma_f32_16x16x32_bf16 v[32:35], a[244:247], v[92:95], v[32:35]
    ds_write_b128 v165, v[40:43] offset:4096
    v_lshl_add_u32 v131, v113, 1, v131
    v_mfma_f32_16x16x32_bf16 v[32:35], v[224:227], v[96:99], v[32:35]
    s_add_u32 s3, s77, 2
    s_and_b32 s3, s3, 3
    v_mfma_f32_16x16x32_bf16 v[32:35], v[228:231], v[100:103], v[32:35]
    s_mul_i32 s3, s3, 15360
    v_add_u32 v165, s3, v153
    v_mfma_f32_16x16x32_bf16 v[20:23], v[176:179], v[76:79], v[20:23]
    buffer_load_dwordx4 v[60:63], v175, s[64:67], s23 offen offset:3072 sc1
    s_mul_i32 s8, s79, 163840
    v_mfma_f32_16x16x32_bf16 v[20:23], v[180:183], v[84:87], v[20:23]
    s_mul_i32 s9, s78, 320
    s_add_u32 s8, s8, s9
    v_mfma_f32_16x16x32_bf16 v[20:23], v[184:187], v[88:91], v[20:23]
    v_mul_u32_u24 v131, 1280, v131
    v_lshl_add_u32 v131, v114, 4, v131
    v_mfma_f32_16x16x32_bf16 v[20:23], v[188:191], v[92:95], v[20:23]
    ds_write_b128 v165, v[32:35] offset:5120
    v_add_u32 v131, s8, v131
    v_mfma_f32_16x16x32_bf16 v[20:23], v[232:235], v[96:99], v[20:23]
    buffer_load_dwordx4 v[68:71], v175, s[64:67], s24 offen offset:0 sc1
    v_mfma_f32_16x16x32_bf16 v[20:23], v[236:239], v[100:103], v[20:23]
    v_mfma_f32_16x16x32_bf16 v[56:59], v[192:195], v[76:79], v[56:59]
    v_mfma_f32_16x16x32_bf16 v[56:59], v[196:199], v[84:87], v[56:59]
    v_mfma_f32_16x16x32_bf16 v[56:59], v[200:203], v[88:91], v[56:59]
    buffer_load_dwordx4 v[72:75], v175, s[64:67], s24 offen offset:1024 sc1
    v_mfma_f32_16x16x32_bf16 v[56:59], v[204:207], v[92:95], v[56:59]
    s_nop 2
    ds_write_b128 v165, v[20:23] offset:6144
    v_mfma_f32_16x16x32_bf16 v[56:59], v[240:243], v[96:99], v[56:59]
    v_mfma_f32_16x16x32_bf16 v[56:59], v[244:247], v[100:103], v[56:59]
    v_mfma_f32_16x16x32_bf16 v[8:11], v[208:211], v[76:79], v[8:11]
    v_mfma_f32_16x16x32_bf16 v[8:11], v[212:215], v[84:87], v[8:11]
    v_mfma_f32_16x16x32_bf16 v[8:11], v[216:219], v[88:91], v[8:11]
    v_mfma_f32_16x16x32_bf16 v[8:11], v[220:223], v[92:95], v[8:11]
    s_nop 3
    ds_write_b128 v165, v[56:59] offset:7168
    v_mfma_f32_16x16x32_bf16 v[8:11], v[248:251], v[96:99], v[8:11]
    v_mfma_f32_16x16x32_bf16 v[8:11], v[252:255], v[100:103], v[8:11]
    s_waitcnt vmcnt(3)
    v_bitop3_b32 v169, v104, v106, v108 bitop3:254
    v_bitop3_b32 v169, v169, v110, v120 bitop3:254
    v_mfma_f32_16x16x32_bf16 v[44:47], a[216:219], v[76:79], v[44:47]
    v_bitop3_b32 v169, v169, v122, v80 bitop3:254
    v_bitop3_b32 v169, v169, v82, v116 bitop3:254
    v_mfma_f32_16x16x32_bf16 v[44:47], a[220:223], v[84:87], v[44:47]
    v_bitop3_b32 v169, v169, v118, v64 bitop3:254
    v_bitop3_b32 v169, v169, v66, 1 bitop3:168
    v_mfma_f32_16x16x32_bf16 v[44:47], a[224:227], v[88:91], v[44:47]
    v_cmp_ne_u32 vcc, 0, v169
    v_mfma_f32_16x16x32_bf16 v[44:47], a[228:231], v[92:95], v[44:47]
    ds_write_b128 v165, v[8:11] offset:8192
    v_mfma_f32_16x16x32_bf16 v[44:47], a[248:251], v[96:99], v[44:47]
    v_mfma_f32_16x16x32_bf16 v[44:47], a[252:255], v[100:103], v[44:47]
    s_cbranch_vccnz Lh1c7r
Lh1c7:
    v_mfma_f32_16x16x32_bf16 v[36:39], a[232:235], v[104:107], v[36:39]
    v_mfma_f32_16x16x32_bf16 v[36:39], a[236:239], v[108:111], v[36:39]
    v_mfma_f32_16x16x32_bf16 v[36:39], a[240:243], v[120:123], v[36:39]
    v_mfma_f32_16x16x32_bf16 v[36:39], a[244:247], v[80:83], v[36:39]
    s_nop 2
    ds_write_b128 v165, v[44:47] offset:9216
    v_mfma_f32_16x16x32_bf16 v[36:39], v[224:227], v[116:119], v[36:39]
    s_add_u32 s3, s77, 3
    s_and_b32 s3, s3, 3
    v_mfma_f32_16x16x32_bf16 v[36:39], v[228:231], v[64:67], v[36:39]
    s_mul_i32 s3, s3, 15360
    v_add_u32 v165, s3, v153
    v_mfma_f32_16x16x32_bf16 v[24:27], v[176:179], v[104:107], v[24:27]
    v_mfma_f32_16x16x32_bf16 v[24:27], v[180:183], v[108:111], v[24:27]
    v_mfma_f32_16x16x32_bf16 v[24:27], v[184:187], v[120:123], v[24:27]
    v_mfma_f32_16x16x32_bf16 v[24:27], v[188:191], v[80:83], v[24:27]
    s_nop 1
    ds_write_b128 v165, v[36:39] offset:10240
    v_mfma_f32_16x16x32_bf16 v[24:27], v[232:235], v[116:119], v[24:27]
    v_mfma_f32_16x16x32_bf16 v[24:27], v[236:239], v[64:67], v[24:27]
    s_waitcnt lgkmcnt(1)
    s_barrier
    v_mfma_f32_16x16x32_bf16 v[0:3], v[192:195], v[104:107], v[0:3]
    ds_read_b128 v[28:31], v154 offset:0
    v_mfma_f32_16x16x32_bf16 v[0:3], v[196:199], v[108:111], v[0:3]
    ds_read_b128 v[16:19], v154 offset:1024
    v_mfma_f32_16x16x32_bf16 v[0:3], v[200:203], v[120:123], v[0:3]
    ds_read_b128 v[52:55], v154 offset:2048
    v_mfma_f32_16x16x32_bf16 v[0:3], v[204:207], v[80:83], v[0:3]
    ds_read_b128 v[4:7], v154 offset:3072
    ds_write_b128 v165, v[24:27] offset:11264
    v_mfma_f32_16x16x32_bf16 v[0:3], v[240:243], v[116:119], v[0:3]
    ds_read_b128 v[40:43], v154 offset:4096
    v_mfma_f32_16x16x32_bf16 v[0:3], v[244:247], v[64:67], v[0:3]
    ds_read_b128 v[32:35], v154 offset:5120
    v_mfma_f32_16x16x32_bf16 v[12:15], v[208:211], v[104:107], v[12:15]
    ds_read_b128 v[20:23], v154 offset:6144
    s_waitcnt lgkmcnt(7)
    v_add_f32 v132, v132, v28
    v_add_f32 v133, v133, v29
    v_mfma_f32_16x16x32_bf16 v[12:15], v[212:215], v[108:111], v[12:15]
    ds_read_b128 v[56:59], v154 offset:7168
    v_add_f32 v134, v134, v30
    v_add_f32 v135, v135, v31
    v_mfma_f32_16x16x32_bf16 v[12:15], v[216:219], v[120:123], v[12:15]
    ds_read_b128 v[8:11], v154 offset:8192
    s_waitcnt lgkmcnt(8)
    v_add_f32 v136, v136, v16
    v_add_f32 v137, v137, v17
    v_mfma_f32_16x16x32_bf16 v[12:15], v[220:223], v[80:83], v[12:15]
    ds_read_b128 v[44:47], v154 offset:9216
    ds_write_b128 v165, v[0:3] offset:12288
    v_add_f32 v138, v138, v18
    v_add_f32 v139, v139, v19
    v_mfma_f32_16x16x32_bf16 v[12:15], v[248:251], v[116:119], v[12:15]
    s_waitcnt lgkmcnt(9)
    v_add_f32 v140, v140, v52
    v_add_f32 v141, v141, v53
    v_mfma_f32_16x16x32_bf16 v[12:15], v[252:255], v[64:67], v[12:15]
    s_waitcnt vmcnt(0)
    v_add_f32 v142, v142, v54
    v_add_f32 v143, v143, v55
    v_bitop3_b32 v169, v60, v62, v68 bitop3:254
    v_mfma_f32_16x16x32_bf16 v[48:51], a[216:219], v[104:107], v[48:51]
    s_waitcnt lgkmcnt(8)
    v_add_f32 v144, v144, v4
    v_add_f32 v145, v145, v5
    v_bitop3_b32 v169, v169, v70, v72 bitop3:254
    v_mfma_f32_16x16x32_bf16 v[48:51], a[220:223], v[108:111], v[48:51]
    v_add_f32 v146, v146, v6
    v_add_f32 v147, v147, v7
    v_bitop3_b32 v169, v169, v74, 1 bitop3:168
    v_mfma_f32_16x16x32_bf16 v[48:51], a[224:227], v[120:123], v[48:51]
    s_waitcnt lgkmcnt(6)
    v_add_f32 v148, v148, v40
    v_add_f32 v149, v149, v41
    v_cmp_ne_u32 vcc, 0, v169
    v_mfma_f32_16x16x32_bf16 v[48:51], a[228:231], v[80:83], v[48:51]
    ds_write_b128 v165, v[12:15] offset:13312
    v_add_f32 v150, v150, v42
    v_add_f32 v151, v151, v43
    v_mfma_f32_16x16x32_bf16 v[48:51], a[248:251], v[116:119], v[48:51]
    v_mfma_f32_16x16x32_bf16 v[48:51], a[252:255], v[64:67], v[48:51]
    s_cbranch_vccnz Lh1c8r
Lh1c8:
    s_waitcnt lgkmcnt(6)
    v_mfma_f32_16x16x32_bf16 v[32:35], a[244:247], v[60:63], v[32:35]
    v_mfma_f32_16x16x32_bf16 v[32:35], v[224:227], v[68:71], v[32:35]
    v_mfma_f32_16x16x32_bf16 v[32:35], v[228:231], v[72:75], v[32:35]
    s_waitcnt lgkmcnt(5)
    v_mfma_f32_16x16x32_bf16 v[20:23], v[188:191], v[60:63], v[20:23]
    s_nop 0
    ds_write_b128 v165, v[48:51] offset:14336
    v_mfma_f32_16x16x32_bf16 v[20:23], v[232:235], v[68:71], v[20:23]
    v_mfma_f32_16x16x32_bf16 v[20:23], v[236:239], v[72:75], v[20:23]
    s_waitcnt lgkmcnt(5)
    v_mfma_f32_16x16x32_bf16 v[56:59], v[204:207], v[60:63], v[56:59]
    v_mfma_f32_16x16x32_bf16 v[56:59], v[240:243], v[68:71], v[56:59]
    v_mfma_f32_16x16x32_bf16 v[56:59], v[244:247], v[72:75], v[56:59]
    s_waitcnt lgkmcnt(0)
    s_barrier
    v_mfma_f32_16x16x32_bf16 v[8:11], v[220:223], v[60:63], v[8:11]
    ds_read_b128 v[28:31], v154 offset:10240
    v_mfma_f32_16x16x32_bf16 v[8:11], v[248:251], v[68:71], v[8:11]
    ds_read_b128 v[16:19], v154 offset:11264
    v_mfma_f32_16x16x32_bf16 v[8:11], v[252:255], v[72:75], v[8:11]
    ds_read_b128 v[52:55], v154 offset:12288
    v_mfma_f32_16x16x32_bf16 v[44:47], a[228:231], v[60:63], v[44:47]
    ds_read_b128 v[4:7], v154 offset:13312
    v_mfma_f32_16x16x32_bf16 v[44:47], a[248:251], v[68:71], v[44:47]
    ds_read_b128 v[40:43], v154 offset:14336
    v_mfma_f32_16x16x32_bf16 v[44:47], a[252:255], v[72:75], v[44:47]
    v_pk_add_f32 v[132:133], v[132:133], v[32:33]
    v_pk_add_f32 v[134:135], v[134:135], v[34:35]
    v_pk_add_f32 v[136:137], v[136:137], v[20:21]
    v_pk_add_f32 v[138:139], v[138:139], v[22:23]
    v_pk_add_f32 v[140:141], v[140:141], v[56:57]
    v_pk_add_f32 v[142:143], v[142:143], v[58:59]
    v_pk_add_f32 v[144:145], v[144:145], v[8:9]
    v_pk_add_f32 v[146:147], v[146:147], v[10:11]
    v_pk_add_f32 v[148:149], v[148:149], v[44:45]
    v_pk_add_f32 v[150:151], v[150:151], v[46:47]
    s_waitcnt lgkmcnt(4)
    v_pk_add_f32 v[132:133], v[132:133], v[28:29]
    v_pk_add_f32 v[134:135], v[134:135], v[30:31]
    s_waitcnt lgkmcnt(3)
    v_pk_add_f32 v[136:137], v[136:137], v[16:17]
    v_pk_add_f32 v[138:139], v[138:139], v[18:19]
    s_waitcnt lgkmcnt(2)
    v_pk_add_f32 v[140:141], v[140:141], v[52:53]
    v_pk_add_f32 v[142:143], v[142:143], v[54:55]
    s_waitcnt lgkmcnt(1)
    v_pk_add_f32 v[144:145], v[144:145], v[4:5]
    v_pk_add_f32 v[146:147], v[146:147], v[6:7]
    s_waitcnt lgkmcnt(0)
    v_pk_add_f32 v[148:149], v[148:149], v[40:41]
    v_pk_add_f32 v[150:151], v[150:151], v[42:43]
    v_pk_add_f32 v[4:5], v[132:133], v[134:135]
    v_pk_mul_f32 v[6:7], v[132:133], v[132:133]
    v_pk_fma_f32 v[6:7], v[134:135], v[134:135], v[6:7]
    v_pk_fma_f32 v[6:7], v[136:137], v[136:137], v[6:7]
    v_pk_add_f32 v[4:5], v[4:5], v[136:137]
    v_pk_fma_f32 v[6:7], v[138:139], v[138:139], v[6:7]
    v_pk_add_f32 v[4:5], v[4:5], v[138:139]
    v_pk_fma_f32 v[6:7], v[140:141], v[140:141], v[6:7]
    v_pk_add_f32 v[4:5], v[4:5], v[140:141]
    v_pk_fma_f32 v[6:7], v[142:143], v[142:143], v[6:7]
    v_pk_add_f32 v[4:5], v[4:5], v[142:143]
    v_pk_fma_f32 v[6:7], v[144:145], v[144:145], v[6:7]
    v_pk_add_f32 v[4:5], v[4:5], v[144:145]
    v_pk_fma_f32 v[6:7], v[146:147], v[146:147], v[6:7]
    v_pk_add_f32 v[4:5], v[4:5], v[146:147]
    v_pk_fma_f32 v[6:7], v[148:149], v[148:149], v[6:7]
    v_pk_add_f32 v[4:5], v[4:5], v[148:149]
    v_pk_fma_f32 v[6:7], v[150:151], v[150:151], v[6:7]
    v_pk_add_f32 v[4:5], v[4:5], v[150:151]
    v_add_f32 v6, v6, v7
    v_add_f32 v4, v4, v5
    v_mov_b32 v1, s82
    s_nop 0
    v_permlane32_swap_b32 v4, v6
    v_add_f32 v4, v4, v6
    v_mov_b32 v6, v4
    s_nop 1
    v_permlane16_swap_b32 v4, v6
    v_add_f32 v0, v4, v6

    s_cmp_eq_u32 s88, 0
    s_cbranch_scc1 Lss_35
    global_store_dwordx2 v155, v[0:1], s[98:99]
Lsd_36:
    ds_write_b128 v124, v[132:135] offset:0
    v_accvgpr_read_b32 v84, a0
    v_accvgpr_read_b32 v85, a1
    ds_write_b128 v125, v[136:139] offset:0
    v_accvgpr_read_b32 v88, a4
    v_accvgpr_read_b32 v89, a5
    ds_write_b128 v124, v[140:143] offset:128
    v_accvgpr_read_b32 v92, a8
    v_accvgpr_read_b32 v93, a9
    ds_write_b128 v125, v[144:147] offset:128
    v_accvgpr_read_b32 v96, a12
    v_accvgpr_read_b32 v97, a13
    ds_write_b128 v126, v[148:151] offset:256
    v_accvgpr_read_b32 v100, a16
    v_accvgpr_read_b32 v101, a17
    ds_read_b128 v[20:23], v127 offset:0
    ds_read_b128 v[24:27], v127 offset:64
    ds_read_b128 v[28:31], v127 offset:128
    ds_read_b128 v[32:35], v127 offset:192
    ds_read_b128 v[36:39], v127 offset:256
    v_accvgpr_read_b32 v86, a2
    v_accvgpr_read_b32 v87, a3
    v_accvgpr_read_b32 v90, a6
    v_accvgpr_read_b32 v91, a7
    v_accvgpr_read_b32 v94, a10
    v_accvgpr_read_b32 v95, a11
    v_accvgpr_read_b32 v98, a14
    v_accvgpr_read_b32 v99, a15
    v_accvgpr_read_b32 v102, a18
    v_accvgpr_read_b32 v103, a19
    global_load_dwordx4 v[0:3], v163, s[98:99] sc1
    global_load_dwordx4 v[4:7], v163, s[98:99] offset:256 sc1
    s_waitcnt lgkmcnt(4)
    v_pk_add_f32 v[60:61], v[20:21], v[128:129] op_sel_hi:[1,0]
    v_pk_add_f32 v[62:63], v[22:23], v[128:129] op_sel_hi:[1,0]
    s_waitcnt lgkmcnt(3)
    v_pk_add_f32 v[64:65], v[24:25], v[128:129] op_sel_hi:[1,0]
    v_pk_add_f32 v[66:67], v[26:27], v[128:129] op_sel_hi:[1,0]
    s_waitcnt lgkmcnt(2)
    v_pk_add_f32 v[68:69], v[28:29], v[128:129] op_sel_hi:[1,0]
    v_pk_add_f32 v[70:71], v[30:31], v[128:129] op_sel_hi:[1,0]
    s_waitcnt lgkmcnt(1)
    v_pk_add_f32 v[72:73], v[32:33], v[128:129] op_sel_hi:[1,0]
    v_pk_add_f32 v[74:75], v[34:35], v[128:129] op_sel_hi:[1,0]
    s_waitcnt lgkmcnt(0)
    v_pk_add_f32 v[76:77], v[36:37], v[128:129] op_sel_hi:[1,0]
    v_pk_add_f32 v[78:79], v[38:39], v[128:129] op_sel_hi:[1,0]
    s_waitcnt vmcnt(0)
    L_s3:
    v_min3_u32 v168, v1, v3, v5
    v_max3_u32 v1, v1, v3, v5
    v_min3_u32 v168, v168, v7, s82
    v_max3_u32 v1, v1, v7, s82
    v_cmp_ne_u32 vcc, v168, v1

    s_cbranch_vccnz L_s3r
    v_add_f32 v0, v0, v4
    v_add_f32 v2, v2, v6
    s_nop 0
    v_add_f32_dpp v0, v0, v0 row_ror:4 row_mask:0xf bank_mask:0xf
    v_add_f32_dpp v2, v2, v2 row_ror:4 row_mask:0xf bank_mask:0xf
    s_nop 0
    v_add_f32_dpp v0, v0, v0 row_ror:8 row_mask:0xf bank_mask:0xf
    v_add_f32_dpp v2, v2, v2 row_ror:8 row_mask:0xf bank_mask:0xf
    s_nop 0
    v_mov_b32_dpp v4, v0 quad_perm:[0,0,0,0] row_mask:0xf bank_mask:1
    v_mov_b32_dpp v6, v2 quad_perm:[0,0,0,0] row_mask:0xf bank_mask:1
    s_nop 0
    v_mov_b32_dpp v4, v0 quad_perm:[1,1,1,1] row_mask:0xf bank_mask:2
    v_mov_b32_dpp v6, v2 quad_perm:[1,1,1,1] row_mask:0xf bank_mask:2
    s_nop 0
    v_mov_b32_dpp v4, v0 quad_perm:[2,2,2,2] row_mask:0xf bank_mask:4
    v_mov_b32_dpp v6, v2 quad_perm:[2,2,2,2] row_mask:0xf bank_mask:4
    s_nop 0
    v_mov_b32_dpp v4, v0 quad_perm:[3,3,3,3] row_mask:0xf bank_mask:8
    v_mov_b32_dpp v6, v2 quad_perm:[3,3,3,3] row_mask:0xf bank_mask:8
    v_mul_f32 v4, 0x3acccccd, v4
    v_mov_b32 v166, 0x3727c5ac
    v_fmac_f32 v166, 0x3acccccd, v6
    v_fma_f32 v166, -v4, v4, v166
    v_max_f32 v166, 0x3727c5ac, v166
    v_rsq_f32 v166, v166
    s_nop 0
    v_mul_f32_e64 v167, -v4, v166
    v_pk_fma_f32 v[20:21], v[20:21], v[166:167], v[166:167] op_sel:[0,0,1] op_sel_hi:[1,0,1]
    v_pk_fma_f32 v[22:23], v[22:23], v[166:167], v[166:167] op_sel:[0,0,1] op_sel_hi:[1,0,1]
    v_pk_fma_f32 v[60:61], v[20:21], v[84:85], v[60:61]
    v_pk_fma_f32 v[62:63], v[22:23], v[86:87], v[62:63]
    global_store_dwordx4 v131, v[60:63], s[46:47] offset:0
    v_pk_fma_f32 v[24:25], v[24:25], v[166:167], v[166:167] op_sel:[0,0,1] op_sel_hi:[1,0,1]
    v_pk_fma_f32 v[26:27], v[26:27], v[166:167], v[166:167] op_sel:[0,0,1] op_sel_hi:[1,0,1]
    v_pk_fma_f32 v[64:65], v[24:25], v[88:89], v[64:65]
    v_pk_fma_f32 v[66:67], v[26:27], v[90:91], v[66:67]
    global_store_dwordx4 v131, v[64:67], s[46:47] offset:64
    v_pk_fma_f32 v[28:29], v[28:29], v[166:167], v[166:167] op_sel:[0,0,1] op_sel_hi:[1,0,1]
    v_pk_fma_f32 v[30:31], v[30:31], v[166:167], v[166:167] op_sel:[0,0,1] op_sel_hi:[1,0,1]
    v_pk_fma_f32 v[68:69], v[28:29], v[92:93], v[68:69]
    v_pk_fma_f32 v[70:71], v[30:31], v[94:95], v[70:71]
    global_store_dwordx4 v131, v[68:71], s[46:47] offset:128
    v_pk_fma_f32 v[32:33], v[32:33], v[166:167], v[166:167] op_sel:[0,0,1] op_sel_hi:[1,0,1]
    v_pk_fma_f32 v[34:35], v[34:35], v[166:167], v[166:167] op_sel:[0,0,1] op_sel_hi:[1,0,1]
    v_pk_fma_f32 v[72:73], v[32:33], v[96:97], v[72:73]
    v_pk_fma_f32 v[74:75], v[34:35], v[98:99], v[74:75]
    global_store_dwordx4 v131, v[72:75], s[46:47] offset:192
    v_pk_fma_f32 v[36:37], v[36:37], v[166:167], v[166:167] op_sel:[0,0,1] op_sel_hi:[1,0,1]
    v_pk_fma_f32 v[38:39], v[38:39], v[166:167], v[166:167] op_sel:[0,0,1] op_sel_hi:[1,0,1]
    v_pk_fma_f32 v[76:77], v[36:37], v[100:101], v[76:77]
    v_pk_fma_f32 v[78:79], v[38:39], v[102:103], v[78:79]
    global_store_dwordx4 v131, v[76:79], s[46:47] offset:256
L_end:
    s_endpgm
L_nonce_re:
    s_sub_u32 s101, s101, 1
    s_cbranch_scc1 L_end
    global_load_dword v224, v224, s[48:49] sc1
    s_waitcnt vmcnt(0)
    s_branch L_nonce
L_kf_re:
    s_sub_u32 s101, s101, 1
    s_cbranch_scc1 L_end
    global_load_dword v224, v169, s[50:51] sc1
    global_load_dwordx2 v[170:171], v168, s[50:51] sc1
    s_waitcnt vmcnt(0)
    s_branch L_kf
L_cre0:
    s_sub_u32 s101, s101, 1
    s_cbranch_scc1 L_end
    buffer_load_dwordx4 v[244:247], v253, s[92:95], 0 offen offset:2048 sc1
    buffer_load_dwordx4 v[240:243], v253, s[92:95], 0 offen offset:1792 sc1
    buffer_load_dwordx4 v[236:239], v253, s[92:95], 0 offen offset:1536 sc1
    buffer_load_dwordx4 v[232:235], v253, s[92:95], 0 offen offset:1280 sc1
    buffer_load_dwordx4 v[228:231], v253, s[92:95], 0 offen offset:1024 sc1
    buffer_load_dwordx4 v[224:227], v253, s[92:95], 0 offen offset:768 sc1
    buffer_load_dwordx4 v[220:223], v253, s[92:95], 0 offen offset:512 sc1
    buffer_load_dwordx4 v[216:219], v253, s[92:95], 0 offen offset:256 sc1
    s_waitcnt vmcnt(0)
    s_branch L_cchk0
Lss_3:
    buffer_store_dwordx4 v[216:219], v153, s[64:67], s36 offen sc1
    s_branch Lsd_4
Lss_5:
    buffer_store_dwordx4 v[220:223], v153, s[64:67], s18 offen sc1
    s_branch Lsd_6
Lss_7:
    buffer_store_dwordx2 v[244:245], v28, s[64:67], s37 offen offset:0 sc1
    buffer_store_dwordx2 v[246:247], v28, s[64:67], s37 offen offset:512 sc1
    s_branch Lsd_8
Lss_9:
    buffer_store_dwordx4 v[224:227], v153, s[64:67], s19 offen sc1
    s_branch Lsd_10
Lss_11:
    buffer_store_dwordx4 v[228:231], v153, s[64:67], s20 offen sc1
    s_branch Lsd_12
Lss_13:
    global_store_dword v169, v173, s[50:51] sc1
    s_branch Lsd_14
L_fh_re0:
    s_sub_u32 s101, s101, 1
    s_cbranch_scc1 L_end
    global_load_dword v169, v173, s[50:51] sc1
    s_waitcnt vmcnt(0)
    s_branch L_fh0
L_fh_re1:
    s_sub_u32 s101, s101, 1
    s_cbranch_scc1 L_end
    global_load_dword v169, v173, s[50:51] sc1
    s_waitcnt vmcnt(0)
    s_branch L_fh1
Lss_17:
    global_store_dwordx2 v155, v[0:1], s[98:99] sc1
    s_branch Lsd_18
L_gcr:
    s_sub_u32 s101, s101, 1
    s_cbranch_scc1 L_end
    s_add_u32 m0, s100, 61440
    s_nop 0
    buffer_load_dwordx4 v164, s[68:71], s6 offen sc1 lds
    s_add_u32 m0, s100, 62464
    s_add_u32 s83, s6, 32768
    buffer_load_dwordx4 v164, s[68:71], s83 offen sc1 lds
    s_add_u32 m0, s5, 69632
    s_mov_b32 exec_hi, 0
    buffer_load_dwordx4 v164, s[68:71], s7 offen sc1 lds
    s_mov_b32 exec_hi, -1
    s_waitcnt vmcnt(0)
    ds_read2st64_b32 v[8:9], v170 offset1:2
    ds_read2st64_b32 v[10:11], v170 offset0:4 offset1:6
    ds_read_b32 v12, v171
    s_waitcnt lgkmcnt(0)
    v_max3_u32 v169, v8, v9, v10
    v_max3_u32 v169, v169, v11, v12
    v_cmp_eq_u32 vcc, -1, v169
    s_cbranch_vccnz L_gcr
    s_branch L_gc
L_s1r:
    s_sub_u32 s101, s101, 1
    s_cbranch_scc1 L_end
    global_load_dwordx4 v[0:3], v163, s[98:99] sc1
    global_load_dwordx4 v[4:7], v163, s[98:99] offset:256 sc1
    s_waitcnt vmcnt(0)
    s_branch L_s1
Lss_19:
    buffer_store_dwordx4 v[36:39], v153, s[64:67], s12 offen sc1
    buffer_store_dwordx4 v[40:43], v153, s[64:67], s12 offen offset:1024 sc1
    s_mov_b32 exec_lo, 0xffff
    s_mov_b32 exec_hi, 0xffff
    buffer_store_dwordx4 v[44:47], v84, s[64:67], s12 offen offset:2048 sc1
    s_branch Lsd_20
Lss_21:
    global_store_dwordx2 v155, v[0:1], s[98:99] sc1
    s_branch Lsd_22
L_xc0r:
    s_sub_u32 s101, s101, 1
    s_cbranch_scc1 L_end
    s_mov_b32 s97, m0
    s_lshl_b32 m0, s81, 13
    s_add_u32 m0, m0, 0
    s_add_u32 s96, s72, s85
    s_add_u32 s96, s96, 0
    buffer_load_dwordx4 v153, s[64:67], s96 offen offset:0 sc1 lds
    s_lshl_b32 m0, s81, 13
    s_add_u32 m0, m0, 2048
    s_add_u32 s96, s72, s85
    s_add_u32 s96, s96, 20480
    buffer_load_dwordx4 v153, s[64:67], s96 offen offset:0 sc1 lds
    s_lshl_b32 m0, s81, 13
    s_add_u32 m0, m0, 4096
    s_add_u32 s96, s72, s85
    s_add_u32 s96, s96, 40960
    buffer_load_dwordx4 v153, s[64:67], s96 offen offset:0 sc1 lds
    s_lshl_b32 m0, s81, 13
    s_add_u32 m0, m0, 6144
    s_add_u32 s96, s72, s85
    s_add_u32 s96, s96, 61440
    buffer_load_dwordx4 v153, s[64:67], s96 offen offset:0 sc1 lds
    s_mov_b32 m0, s97
    s_waitcnt vmcnt(0)
    v_and_b32 v169, 0x23ff, v158
    v_add_u32 v169, 0, v169
    ds_read_b128 v[56:59], v169 offset:0
    v_and_b32 v169, 0x23ff, v158
    v_add_u32 v169, 0, v169
    ds_read_b128 v[60:63], v169 offset:2048
    v_and_b32 v169, 0x23ff, v158
    v_add_u32 v169, 0, v169
    ds_read_b128 v[64:67], v169 offset:4096
    v_and_b32 v169, 0x23ff, v158
    v_add_u32 v169, 0, v169
    ds_read_b128 v[68:71], v169 offset:6144
    s_waitcnt lgkmcnt(0)
    v_bitop3_b32 v169, v56, v60, v64 bitop3:128
    v_bitop3_b32 v169, v169, v68, 1 bitop3:128
    v_cmp_ne_u32 vcc, 1, v169
    s_cbranch_vccnz L_xc0r
    s_branch L_xc0
L_xc1r:
    s_sub_u32 s101, s101, 1
    s_cbranch_scc1 L_end
    s_mov_b32 s97, m0
    s_lshl_b32 m0, s81, 13
    s_add_u32 m0, m0, 0
    s_add_u32 s96, s72, s85
    s_add_u32 s96, s96, 0
    buffer_load_dwordx4 v153, s[64:67], s96 offen offset:1024 sc1 lds
    s_lshl_b32 m0, s81, 13
    s_add_u32 m0, m0, 2048
    s_add_u32 s96, s72, s85
    s_add_u32 s96, s96, 20480
    buffer_load_dwordx4 v153, s[64:67], s96 offen offset:1024 sc1 lds
    s_lshl_b32 m0, s81, 13
    s_add_u32 m0, m0, 4096
    s_add_u32 s96, s72, s85
    s_add_u32 s96, s96, 40960
    buffer_load_dwordx4 v153, s[64:67], s96 offen offset:1024 sc1 lds
    s_lshl_b32 m0, s81, 13
    s_add_u32 m0, m0, 6144
    s_add_u32 s96, s72, s85
    s_add_u32 s96, s96, 61440
    buffer_load_dwordx4 v153, s[64:67], s96 offen offset:1024 sc1 lds
    s_mov_b32 m0, s97
    s_waitcnt vmcnt(0)
    v_and_b32 v169, 0x23ff, v158
    v_add_u32 v169, 0, v169
    ds_read_b128 v[72:75], v169 offset:1024
    v_and_b32 v169, 0x23ff, v158
    v_add_u32 v169, 0, v169
    ds_read_b128 v[76:79], v169 offset:3072
    v_and_b32 v169, 0x23ff, v158
    v_add_u32 v169, 0, v169
    ds_read_b128 v[80:83], v169 offset:5120
    v_and_b32 v169, 0x23ff, v158
    v_add_u32 v169, 0, v169
    ds_read_b128 v[84:87], v169 offset:7168
    s_waitcnt lgkmcnt(0)
    v_bitop3_b32 v169, v72, v76, v80 bitop3:128
    v_bitop3_b32 v169, v169, v84, 1 bitop3:128
    v_cmp_ne_u32 vcc, 1, v169
    s_cbranch_vccnz L_xc1r
    s_branch L_xc1
L_xc2r:
    s_sub_u32 s101, s101, 1
    s_cbranch_scc1 L_end
    s_mov_b32 s97, m0
    s_lshl_b32 m0, s81, 13
    s_xor_b32 m0, m0, 0x2000
    s_add_u32 m0, m0, 0
    s_add_u32 s96, s72, s90
    s_add_u32 s96, s96, 0
    buffer_load_dwordx4 v153, s[64:67], s96 offen offset:0 sc1 lds
    s_lshl_b32 m0, s81, 13
    s_xor_b32 m0, m0, 0x2000
    s_add_u32 m0, m0, 2048
    s_add_u32 s96, s72, s90
    s_add_u32 s96, s96, 20480
    buffer_load_dwordx4 v153, s[64:67], s96 offen offset:0 sc1 lds
    s_lshl_b32 m0, s81, 13
    s_xor_b32 m0, m0, 0x2000
    s_add_u32 m0, m0, 4096
    s_add_u32 s96, s72, s90
    s_add_u32 s96, s96, 40960
    buffer_load_dwordx4 v153, s[64:67], s96 offen offset:0 sc1 lds
    s_lshl_b32 m0, s81, 13
    s_xor_b32 m0, m0, 0x2000
    s_add_u32 m0, m0, 6144
    s_add_u32 s96, s72, s90
    s_add_u32 s96, s96, 61440
    buffer_load_dwordx4 v153, s[64:67], s96 offen offset:0 sc1 lds
    s_mov_b32 m0, s97
    s_waitcnt vmcnt(0)
    v_and_b32 v169, 0x23ff, v159
    v_add_u32 v169, 0, v169
    ds_read_b128 v[88:91], v169 offset:0
    v_and_b32 v169, 0x23ff, v159
    v_add_u32 v169, 0, v169
    ds_read_b128 v[92:95], v169 offset:2048
    v_and_b32 v169, 0x23ff, v159
    v_add_u32 v169, 0, v169
    ds_read_b128 v[96:99], v169 offset:4096
    v_and_b32 v169, 0x23ff, v159
    v_add_u32 v169, 0, v169
    ds_read_b128 v[100:103], v169 offset:6144
    s_waitcnt lgkmcnt(0)
    v_bitop3_b32 v169, v88, v92, v96 bitop3:128
    v_bitop3_b32 v169, v169, v100, 1 bitop3:128
    v_cmp_ne_u32 vcc, 1, v169
    s_cbranch_vccnz L_xc2r
    s_branch L_xc2
L_xc3r:
    s_sub_u32 s101, s101, 1
    s_cbranch_scc1 L_end
    s_mov_b32 s97, m0
    s_lshl_b32 m0, s81, 13
    s_xor_b32 m0, m0, 0x2000
    s_add_u32 m0, m0, 0
    s_add_u32 s96, s72, s90
    s_add_u32 s96, s96, 0
    buffer_load_dwordx4 v153, s[64:67], s96 offen offset:1024 sc1 lds
    s_lshl_b32 m0, s81, 13
    s_xor_b32 m0, m0, 0x2000
    s_add_u32 m0, m0, 2048
    s_add_u32 s96, s72, s90
    s_add_u32 s96, s96, 20480
    buffer_load_dwordx4 v153, s[64:67], s96 offen offset:1024 sc1 lds
    s_lshl_b32 m0, s81, 13
    s_xor_b32 m0, m0, 0x2000
    s_add_u32 m0, m0, 4096
    s_add_u32 s96, s72, s90
    s_add_u32 s96, s96, 40960
    buffer_load_dwordx4 v153, s[64:67], s96 offen offset:1024 sc1 lds
    s_lshl_b32 m0, s81, 13
    s_xor_b32 m0, m0, 0x2000
    s_add_u32 m0, m0, 6144
    s_add_u32 s96, s72, s90
    s_add_u32 s96, s96, 61440
    buffer_load_dwordx4 v153, s[64:67], s96 offen offset:1024 sc1 lds
    s_mov_b32 m0, s97
    s_waitcnt vmcnt(0)
    v_and_b32 v169, 0x23ff, v159
    v_add_u32 v169, 0, v169
    ds_read_b128 v[56:59], v169 offset:1024
    v_and_b32 v169, 0x23ff, v159
    v_add_u32 v169, 0, v169
    ds_read_b128 v[60:63], v169 offset:3072
    v_and_b32 v169, 0x23ff, v159
    v_add_u32 v169, 0, v169
    ds_read_b128 v[64:67], v169 offset:5120
    v_and_b32 v169, 0x23ff, v159
    v_add_u32 v169, 0, v169
    ds_read_b128 v[68:71], v169 offset:7168
    s_waitcnt lgkmcnt(0)
    v_bitop3_b32 v169, v56, v60, v64 bitop3:128
    v_bitop3_b32 v169, v169, v68, 1 bitop3:128
    v_cmp_ne_u32 vcc, 1, v169
    s_cbranch_vccnz L_xc3r
    s_branch L_xc3
L_xc4r:
    s_sub_u32 s101, s101, 1
    s_cbranch_scc1 L_end
    s_mov_b32 s97, m0
    s_lshl_b32 m0, s81, 13
    s_add_u32 m0, m0, 16384
    s_add_u32 s96, s73, s85
    s_add_u32 s96, s96, 0
    buffer_load_dwordx4 v153, s[64:67], s96 offen offset:0 sc1 lds
    s_lshl_b32 m0, s81, 13
    s_add_u32 m0, m0, 20480
    s_add_u32 s96, s73, s85
    s_add_u32 s96, s96, 40960
    buffer_load_dwordx4 v153, s[64:67], s96 offen offset:0 sc1 lds
    s_lshl_b32 m0, s81, 13
    s_add_u32 m0, m0, 18432
    s_add_u32 s96, s73, s85
    s_add_u32 s96, s96, 20480
    buffer_load_dwordx4 v153, s[64:67], s96 offen offset:0 sc1 lds
    s_lshl_b32 m0, s81, 13
    s_add_u32 m0, m0, 22528
    s_add_u32 s96, s73, s85
    s_add_u32 s96, s96, 61440
    buffer_load_dwordx4 v153, s[64:67], s96 offen offset:0 sc1 lds
    s_mov_b32 m0, s97
    s_waitcnt vmcnt(0)
    v_and_b32 v169, 0x23ff, v158
    v_add_u32 v169, 16384, v169
    ds_read_b128 v[72:75], v169 offset:0
    v_and_b32 v169, 0x23ff, v158
    v_add_u32 v169, 16384, v169
    ds_read_b128 v[76:79], v169 offset:4096
    v_and_b32 v169, 0x23ff, v158
    v_add_u32 v169, 16384, v169
    ds_read_b128 v[80:83], v169 offset:2048
    v_and_b32 v169, 0x23ff, v158
    v_add_u32 v169, 16384, v169
    ds_read_b128 v[84:87], v169 offset:6144
    s_waitcnt lgkmcnt(0)
    v_bitop3_b32 v169, v72, v76, v80 bitop3:128
    v_bitop3_b32 v169, v169, v84, 1 bitop3:128
    v_cmp_ne_u32 vcc, 1, v169
    s_cbranch_vccnz L_xc4r
    s_branch L_xc4
L_xc5r:
    s_sub_u32 s101, s101, 1
    s_cbranch_scc1 L_end
    s_mov_b32 s97, m0
    s_lshl_b32 m0, s81, 13
    s_add_u32 m0, m0, 16384
    s_add_u32 s96, s73, s85
    s_add_u32 s96, s96, 0
    buffer_load_dwordx4 v153, s[64:67], s96 offen offset:1024 sc1 lds
    s_lshl_b32 m0, s81, 13
    s_add_u32 m0, m0, 20480
    s_add_u32 s96, s73, s85
    s_add_u32 s96, s96, 40960
    buffer_load_dwordx4 v153, s[64:67], s96 offen offset:1024 sc1 lds
    s_lshl_b32 m0, s81, 13
    s_add_u32 m0, m0, 18432
    s_add_u32 s96, s73, s85
    s_add_u32 s96, s96, 20480
    buffer_load_dwordx4 v153, s[64:67], s96 offen offset:1024 sc1 lds
    s_lshl_b32 m0, s81, 13
    s_add_u32 m0, m0, 22528
    s_add_u32 s96, s73, s85
    s_add_u32 s96, s96, 61440
    buffer_load_dwordx4 v153, s[64:67], s96 offen offset:1024 sc1 lds
    s_mov_b32 m0, s97
    s_waitcnt vmcnt(0)
    v_and_b32 v169, 0x23ff, v158
    v_add_u32 v169, 16384, v169
    ds_read_b128 v[88:91], v169 offset:1024
    v_and_b32 v169, 0x23ff, v158
    v_add_u32 v169, 16384, v169
    ds_read_b128 v[92:95], v169 offset:5120
    v_and_b32 v169, 0x23ff, v158
    v_add_u32 v169, 16384, v169
    ds_read_b128 v[96:99], v169 offset:3072
    v_and_b32 v169, 0x23ff, v158
    v_add_u32 v169, 16384, v169
    ds_read_b128 v[100:103], v169 offset:7168
    s_waitcnt lgkmcnt(0)
    v_bitop3_b32 v169, v88, v92, v96 bitop3:128
    v_bitop3_b32 v169, v169, v100, 1 bitop3:128
    v_cmp_ne_u32 vcc, 1, v169
    s_cbranch_vccnz L_xc5r
    s_branch L_xc5
L_xc6r:
    s_sub_u32 s101, s101, 1
    s_cbranch_scc1 L_end
    s_mov_b32 s97, m0
    s_lshl_b32 m0, s81, 13
    s_add_u32 m0, m0, 32768
    s_add_u32 s96, s74, s85
    s_add_u32 s96, s96, 0
    buffer_load_dwordx4 v153, s[64:67], s96 offen offset:0 sc1 lds
    s_lshl_b32 m0, s81, 13
    s_add_u32 m0, m0, 36864
    s_add_u32 s96, s74, s85
    s_add_u32 s96, s96, 40960
    buffer_load_dwordx4 v153, s[64:67], s96 offen offset:0 sc1 lds
    s_lshl_b32 m0, s81, 13
    s_add_u32 m0, m0, 34816
    s_add_u32 s96, s74, s85
    s_add_u32 s96, s96, 20480
    buffer_load_dwordx4 v153, s[64:67], s96 offen offset:0 sc1 lds
    s_lshl_b32 m0, s81, 13
    s_add_u32 m0, m0, 38912
    s_add_u32 s96, s74, s85
    s_add_u32 s96, s96, 61440
    buffer_load_dwordx4 v153, s[64:67], s96 offen offset:0 sc1 lds
    s_mov_b32 m0, s97
    s_waitcnt vmcnt(0)
    v_and_b32 v169, 0x23ff, v158
    v_add_u32 v169, 32768, v169
    ds_read_b128 v[56:59], v169 offset:0
    v_and_b32 v169, 0x23ff, v158
    v_add_u32 v169, 32768, v169
    ds_read_b128 v[60:63], v169 offset:4096
    v_and_b32 v169, 0x23ff, v158
    v_add_u32 v169, 32768, v169
    ds_read_b128 v[64:67], v169 offset:2048
    v_and_b32 v169, 0x23ff, v158
    v_add_u32 v169, 32768, v169
    ds_read_b128 v[68:71], v169 offset:6144
    s_waitcnt lgkmcnt(0)
    v_bitop3_b32 v169, v56, v60, v64 bitop3:128
    v_bitop3_b32 v169, v169, v68, 1 bitop3:128
    v_cmp_ne_u32 vcc, 1, v169
    s_cbranch_vccnz L_xc6r
    s_branch L_xc6
L_s2r:
    s_sub_u32 s101, s101, 1
    s_cbranch_scc1 L_end
    global_load_dwordx4 v[104:107], v163, s[98:99] sc1
    global_load_dwordx4 v[108:111], v163, s[98:99] offset:256 sc1
    s_waitcnt vmcnt(0)
    s_branch L_s2
L_xc7r:
    s_sub_u32 s101, s101, 1
    s_cbranch_scc1 L_end
    s_mov_b32 s97, m0
    s_lshl_b32 m0, s81, 13
    s_add_u32 m0, m0, 32768
    s_add_u32 s96, s74, s85
    s_add_u32 s96, s96, 0
    buffer_load_dwordx4 v153, s[64:67], s96 offen offset:1024 sc1 lds
    s_lshl_b32 m0, s81, 13
    s_add_u32 m0, m0, 36864
    s_add_u32 s96, s74, s85
    s_add_u32 s96, s96, 40960
    buffer_load_dwordx4 v153, s[64:67], s96 offen offset:1024 sc1 lds
    s_lshl_b32 m0, s81, 13
    s_add_u32 m0, m0, 34816
    s_add_u32 s96, s74, s85
    s_add_u32 s96, s96, 20480
    buffer_load_dwordx4 v153, s[64:67], s96 offen offset:1024 sc1 lds
    s_lshl_b32 m0, s81, 13
    s_add_u32 m0, m0, 38912
    s_add_u32 s96, s74, s85
    s_add_u32 s96, s96, 61440
    buffer_load_dwordx4 v153, s[64:67], s96 offen offset:1024 sc1 lds
    s_mov_b32 m0, s97
    s_waitcnt vmcnt(0)
    v_and_b32 v169, 0x23ff, v158
    v_add_u32 v169, 32768, v169
    ds_read_b128 v[72:75], v169 offset:1024
    v_and_b32 v169, 0x23ff, v158
    v_add_u32 v169, 32768, v169
    ds_read_b128 v[76:79], v169 offset:5120
    v_and_b32 v169, 0x23ff, v158
    v_add_u32 v169, 32768, v169
    ds_read_b128 v[80:83], v169 offset:3072
    v_and_b32 v169, 0x23ff, v158
    v_add_u32 v169, 32768, v169
    ds_read_b128 v[84:87], v169 offset:7168
    s_waitcnt lgkmcnt(0)
    v_bitop3_b32 v169, v72, v76, v80 bitop3:128
    v_bitop3_b32 v169, v169, v84, 1 bitop3:128
    v_cmp_ne_u32 vcc, 1, v169
    s_cbranch_vccnz L_xc7r
    s_branch L_xc7
L_xc8r:
    s_sub_u32 s101, s101, 1
    s_cbranch_scc1 L_end
    s_mov_b32 s97, m0
    s_lshl_b32 m0, s81, 13
    s_add_u32 m0, m0, 49152
    s_add_u32 s96, s75, s85
    s_add_u32 s96, s96, 0
    buffer_load_dwordx4 v153, s[64:67], s96 offen offset:0 sc1 lds
    s_lshl_b32 m0, s81, 13
    s_add_u32 m0, m0, 53248
    s_add_u32 s96, s75, s85
    s_add_u32 s96, s96, 40960
    buffer_load_dwordx4 v153, s[64:67], s96 offen offset:0 sc1 lds
    s_lshl_b32 m0, s81, 13
    s_add_u32 m0, m0, 51200
    s_add_u32 s96, s75, s85
    s_add_u32 s96, s96, 20480
    buffer_load_dwordx4 v153, s[64:67], s96 offen offset:0 sc1 lds
    s_lshl_b32 m0, s81, 13
    s_add_u32 m0, m0, 55296
    s_add_u32 s96, s75, s85
    s_add_u32 s96, s96, 61440
    buffer_load_dwordx4 v153, s[64:67], s96 offen offset:0 sc1 lds
    s_mov_b32 m0, s97
    s_waitcnt vmcnt(0)
    v_and_b32 v169, 0x23ff, v158
    v_add_u32 v169, 49152, v169
    ds_read_b128 v[88:91], v169 offset:0
    v_and_b32 v169, 0x23ff, v158
    v_add_u32 v169, 49152, v169
    ds_read_b128 v[92:95], v169 offset:4096
    v_and_b32 v169, 0x23ff, v158
    v_add_u32 v169, 49152, v169
    ds_read_b128 v[96:99], v169 offset:2048
    v_and_b32 v169, 0x23ff, v158
    v_add_u32 v169, 49152, v169
    ds_read_b128 v[100:103], v169 offset:6144
    s_waitcnt lgkmcnt(0)
    v_bitop3_b32 v169, v88, v92, v96 bitop3:128
    v_bitop3_b32 v169, v169, v100, 1 bitop3:128
    v_cmp_ne_u32 vcc, 1, v169
    s_cbranch_vccnz L_xc8r
    s_branch L_xc8
L_xc9r:
    s_sub_u32 s101, s101, 1
    s_cbranch_scc1 L_end
    s_mov_b32 s97, m0
    s_lshl_b32 m0, s81, 13
    s_add_u32 m0, m0, 49152
    s_add_u32 s96, s75, s85
    s_add_u32 s96, s96, 0
    buffer_load_dwordx4 v153, s[64:67], s96 offen offset:1024 sc1 lds
    s_lshl_b32 m0, s81, 13
    s_add_u32 m0, m0, 53248
    s_add_u32 s96, s75, s85
    s_add_u32 s96, s96, 40960
    buffer_load_dwordx4 v153, s[64:67], s96 offen offset:1024 sc1 lds
    s_lshl_b32 m0, s81, 13
    s_add_u32 m0, m0, 51200
    s_add_u32 s96, s75, s85
    s_add_u32 s96, s96, 20480
    buffer_load_dwordx4 v153, s[64:67], s96 offen offset:1024 sc1 lds
    s_lshl_b32 m0, s81, 13
    s_add_u32 m0, m0, 55296
    s_add_u32 s96, s75, s85
    s_add_u32 s96, s96, 61440
    buffer_load_dwordx4 v153, s[64:67], s96 offen offset:1024 sc1 lds
    s_mov_b32 m0, s97
    s_waitcnt vmcnt(0)
    v_and_b32 v169, 0x23ff, v158
    v_add_u32 v169, 49152, v169
    ds_read_b128 v[56:59], v169 offset:1024
    v_and_b32 v169, 0x23ff, v158
    v_add_u32 v169, 49152, v169
    ds_read_b128 v[60:63], v169 offset:5120
    v_and_b32 v169, 0x23ff, v158
    v_add_u32 v169, 49152, v169
    ds_read_b128 v[64:67], v169 offset:3072
    v_and_b32 v169, 0x23ff, v158
    v_add_u32 v169, 49152, v169
    ds_read_b128 v[68:71], v169 offset:7168
    s_waitcnt lgkmcnt(0)
    v_bitop3_b32 v169, v56, v60, v64 bitop3:128
    v_bitop3_b32 v169, v169, v68, 1 bitop3:128
    v_cmp_ne_u32 vcc, 1, v169
    s_cbranch_vccnz L_xc9r
    s_branch L_xc9
L_xc10r:
    s_sub_u32 s101, s101, 1
    s_cbranch_scc1 L_end
    s_mov_b32 s97, m0
    s_lshl_b32 m0, s81, 13
    s_add_u32 m0, m0, 69632
    s_add_u32 s96, s76, s85
    s_add_u32 s96, s96, 40960
    buffer_load_dwordx4 v153, s[64:67], s96 offen offset:0 sc1 lds
    s_lshl_b32 m0, s81, 13
    s_add_u32 m0, m0, 69632
    s_add_u32 s96, s76, s85
    s_add_u32 s96, s96, 40960
    buffer_load_dwordx4 v153, s[64:67], s96 offen offset:1024 sc1 lds
    s_lshl_b32 m0, s81, 13
    s_add_u32 m0, m0, 65536
    s_add_u32 s96, s76, s85
    s_add_u32 s96, s96, 0
    buffer_load_dwordx4 v153, s[64:67], s96 offen offset:0 sc1 lds
    s_lshl_b32 m0, s81, 13
    s_add_u32 m0, m0, 65536
    s_add_u32 s96, s76, s85
    s_add_u32 s96, s96, 0
    buffer_load_dwordx4 v153, s[64:67], s96 offen offset:1024 sc1 lds
    s_mov_b32 m0, s97
    s_waitcnt vmcnt(0)
    v_and_b32 v169, 0x23ff, v158
    v_add_u32 v169, 65536, v169
    ds_read_b128 v[72:75], v169 offset:4096
    v_and_b32 v169, 0x23ff, v158
    v_add_u32 v169, 65536, v169
    ds_read_b128 v[76:79], v169 offset:5120
    v_and_b32 v169, 0x23ff, v158
    v_add_u32 v169, 65536, v169
    ds_read_b128 v[80:83], v169 offset:0
    v_and_b32 v169, 0x23ff, v158
    v_add_u32 v169, 65536, v169
    ds_read_b128 v[84:87], v169 offset:1024
    s_waitcnt lgkmcnt(0)
    v_bitop3_b32 v169, v72, v76, v80 bitop3:128
    v_bitop3_b32 v169, v169, v84, 1 bitop3:128
    v_cmp_ne_u32 vcc, 1, v169
    s_cbranch_vccnz L_xc10r
    s_branch L_xc10
L_xc11r:
    s_sub_u32 s101, s101, 1
    s_cbranch_scc1 L_end
    s_mov_b32 s97, m0
    s_lshl_b32 m0, s81, 13
    s_add_u32 m0, m0, 71680
    s_add_u32 s96, s76, s85
    s_add_u32 s96, s96, 61440
    buffer_load_dwordx4 v153, s[64:67], s96 offen offset:0 sc1 lds
    s_lshl_b32 m0, s81, 13
    s_add_u32 m0, m0, 71680
    s_add_u32 s96, s76, s85
    s_add_u32 s96, s96, 61440
    buffer_load_dwordx4 v153, s[64:67], s96 offen offset:1024 sc1 lds
    s_lshl_b32 m0, s81, 13
    s_add_u32 m0, m0, 67584
    s_add_u32 s96, s76, s85
    s_add_u32 s96, s96, 20480
    buffer_load_dwordx4 v153, s[64:67], s96 offen offset:0 sc1 lds
    s_lshl_b32 m0, s81, 13
    s_add_u32 m0, m0, 67584
    s_add_u32 s96, s76, s85
    s_add_u32 s96, s96, 20480
    buffer_load_dwordx4 v153, s[64:67], s96 offen offset:1024 sc1 lds
    s_mov_b32 m0, s97
    s_waitcnt vmcnt(0)
    v_and_b32 v169, 0x23ff, v158
    v_add_u32 v169, 65536, v169
    ds_read_b128 v[88:91], v169 offset:6144
    v_and_b32 v169, 0x23ff, v158
    v_add_u32 v169, 65536, v169
    ds_read_b128 v[92:95], v169 offset:7168
    v_and_b32 v169, 0x23ff, v158
    v_add_u32 v169, 65536, v169
    ds_read_b128 v[96:99], v169 offset:2048
    v_and_b32 v169, 0x23ff, v158
    v_add_u32 v169, 65536, v169
    ds_read_b128 v[100:103], v169 offset:3072
    s_waitcnt lgkmcnt(0)
    v_bitop3_b32 v169, v88, v92, v96 bitop3:128
    v_bitop3_b32 v169, v169, v100, 1 bitop3:128
    v_cmp_ne_u32 vcc, 1, v169
    s_cbranch_vccnz L_xc11r
    s_branch L_xc11
L_xc12r:
    s_sub_u32 s101, s101, 1
    s_cbranch_scc1 L_end
    s_mov_b32 s97, m0
    s_lshl_b32 m0, s81, 13
    s_xor_b32 m0, m0, 0x2000
    s_add_u32 m0, m0, 16384
    s_add_u32 s96, s73, s90
    s_add_u32 s96, s96, 0
    buffer_load_dwordx4 v153, s[64:67], s96 offen offset:0 sc1 lds
    s_lshl_b32 m0, s81, 13
    s_xor_b32 m0, m0, 0x2000
    s_add_u32 m0, m0, 16384
    s_add_u32 s96, s73, s90
    s_add_u32 s96, s96, 0
    buffer_load_dwordx4 v153, s[64:67], s96 offen offset:1024 sc1 lds
    s_lshl_b32 m0, s81, 13
    s_xor_b32 m0, m0, 0x2000
    s_add_u32 m0, m0, 32768
    s_add_u32 s96, s74, s90
    s_add_u32 s96, s96, 0
    buffer_load_dwordx4 v153, s[64:67], s96 offen offset:0 sc1 lds
    s_lshl_b32 m0, s81, 13
    s_xor_b32 m0, m0, 0x2000
    s_add_u32 m0, m0, 32768
    s_add_u32 s96, s74, s90
    s_add_u32 s96, s96, 0
    buffer_load_dwordx4 v153, s[64:67], s96 offen offset:1024 sc1 lds
    s_mov_b32 m0, s97
    s_waitcnt vmcnt(0)
    v_and_b32 v169, 0x23ff, v159
    v_add_u32 v169, 16384, v169
    ds_read_b128 v[56:59], v169 offset:0
    v_and_b32 v169, 0x23ff, v159
    v_add_u32 v169, 16384, v169
    ds_read_b128 v[60:63], v169 offset:1024
    v_and_b32 v169, 0x23ff, v159
    v_add_u32 v169, 32768, v169
    ds_read_b128 v[64:67], v169 offset:0
    v_and_b32 v169, 0x23ff, v159
    v_add_u32 v169, 32768, v169
    ds_read_b128 v[68:71], v169 offset:1024
    s_waitcnt lgkmcnt(0)
    v_bitop3_b32 v169, v56, v60, v64 bitop3:128
    v_bitop3_b32 v169, v169, v68, 1 bitop3:128
    v_cmp_ne_u32 vcc, 1, v169
    s_cbranch_vccnz L_xc12r
    s_branch L_xc12
L_xc13r:
    s_sub_u32 s101, s101, 1
    s_cbranch_scc1 L_end
    s_mov_b32 s97, m0
    s_lshl_b32 m0, s81, 13
    s_xor_b32 m0, m0, 0x2000
    s_add_u32 m0, m0, 49152
    s_add_u32 s96, s75, s90
    s_add_u32 s96, s96, 0
    buffer_load_dwordx4 v153, s[64:67], s96 offen offset:0 sc1 lds
    s_lshl_b32 m0, s81, 13
    s_xor_b32 m0, m0, 0x2000
    s_add_u32 m0, m0, 49152
    s_add_u32 s96, s75, s90
    s_add_u32 s96, s96, 0
    buffer_load_dwordx4 v153, s[64:67], s96 offen offset:1024 sc1 lds
    s_lshl_b32 m0, s81, 13
    s_xor_b32 m0, m0, 0x2000
    s_add_u32 m0, m0, 65536
    s_add_u32 s96, s76, s90
    s_add_u32 s96, s96, 0
    buffer_load_dwordx4 v153, s[64:67], s96 offen offset:0 sc1 lds
    s_lshl_b32 m0, s81, 13
    s_xor_b32 m0, m0, 0x2000
    s_add_u32 m0, m0, 65536
    s_add_u32 s96, s76, s90
    s_add_u32 s96, s96, 0
    buffer_load_dwordx4 v153, s[64:67], s96 offen offset:1024 sc1 lds
    s_mov_b32 m0, s97
    s_waitcnt vmcnt(0)
    v_and_b32 v169, 0x23ff, v159
    v_add_u32 v169, 49152, v169
    ds_read_b128 v[72:75], v169 offset:0
    v_and_b32 v169, 0x23ff, v159
    v_add_u32 v169, 49152, v169
    ds_read_b128 v[76:79], v169 offset:1024
    v_and_b32 v169, 0x23ff, v159
    v_add_u32 v169, 65536, v169
    ds_read_b128 v[80:83], v169 offset:0
    v_and_b32 v169, 0x23ff, v159
    v_add_u32 v169, 65536, v169
    ds_read_b128 v[84:87], v169 offset:1024
    s_waitcnt lgkmcnt(0)
    v_bitop3_b32 v169, v72, v76, v80 bitop3:128
    v_bitop3_b32 v169, v169, v84, 1 bitop3:128
    v_cmp_ne_u32 vcc, 1, v169
    s_cbranch_vccnz L_xc13r
    s_branch L_xc13
L_xc14r:
    s_sub_u32 s101, s101, 1
    s_cbranch_scc1 L_end
    s_mov_b32 s97, m0
    s_lshl_b32 m0, s81, 13
    s_xor_b32 m0, m0, 0x2000
    s_add_u32 m0, m0, 18432
    s_add_u32 s96, s73, s90
    s_add_u32 s96, s96, 20480
    buffer_load_dwordx4 v153, s[64:67], s96 offen offset:0 sc1 lds
    s_lshl_b32 m0, s81, 13
    s_xor_b32 m0, m0, 0x2000
    s_add_u32 m0, m0, 18432
    s_add_u32 s96, s73, s90
    s_add_u32 s96, s96, 20480
    buffer_load_dwordx4 v153, s[64:67], s96 offen offset:1024 sc1 lds
    s_lshl_b32 m0, s81, 13
    s_xor_b32 m0, m0, 0x2000
    s_add_u32 m0, m0, 34816
    s_add_u32 s96, s74, s90
    s_add_u32 s96, s96, 20480
    buffer_load_dwordx4 v153, s[64:67], s96 offen offset:0 sc1 lds
    s_lshl_b32 m0, s81, 13
    s_xor_b32 m0, m0, 0x2000
    s_add_u32 m0, m0, 34816
    s_add_u32 s96, s74, s90
    s_add_u32 s96, s96, 20480
    buffer_load_dwordx4 v153, s[64:67], s96 offen offset:1024 sc1 lds
    s_mov_b32 m0, s97
    s_waitcnt vmcnt(0)
    v_and_b32 v169, 0x23ff, v159
    v_add_u32 v169, 16384, v169
    ds_read_b128 v[56:59], v169 offset:2048
    v_and_b32 v169, 0x23ff, v159
    v_add_u32 v169, 16384, v169
    ds_read_b128 v[60:63], v169 offset:3072
    v_and_b32 v169, 0x23ff, v159
    v_add_u32 v169, 32768, v169
    ds_read_b128 v[64:67], v169 offset:2048
    v_and_b32 v169, 0x23ff, v159
    v_add_u32 v169, 32768, v169
    ds_read_b128 v[68:71], v169 offset:3072
    s_waitcnt lgkmcnt(0)
    v_bitop3_b32 v169, v56, v60, v64 bitop3:128
    v_bitop3_b32 v169, v169, v68, 1 bitop3:128
    v_cmp_ne_u32 vcc, 1, v169
    s_cbranch_vccnz L_xc14r
    s_branch L_xc14
L_xc15r:
    s_sub_u32 s101, s101, 1
    s_cbranch_scc1 L_end
    s_mov_b32 s97, m0
    s_lshl_b32 m0, s81, 13
    s_xor_b32 m0, m0, 0x2000
    s_add_u32 m0, m0, 51200
    s_add_u32 s96, s75, s90
    s_add_u32 s96, s96, 20480
    buffer_load_dwordx4 v153, s[64:67], s96 offen offset:0 sc1 lds
    s_lshl_b32 m0, s81, 13
    s_xor_b32 m0, m0, 0x2000
    s_add_u32 m0, m0, 51200
    s_add_u32 s96, s75, s90
    s_add_u32 s96, s96, 20480
    buffer_load_dwordx4 v153, s[64:67], s96 offen offset:1024 sc1 lds
    s_lshl_b32 m0, s81, 13
    s_xor_b32 m0, m0, 0x2000
    s_add_u32 m0, m0, 67584
    s_add_u32 s96, s76, s90
    s_add_u32 s96, s96, 20480
    buffer_load_dwordx4 v153, s[64:67], s96 offen offset:0 sc1 lds
    s_lshl_b32 m0, s81, 13
    s_xor_b32 m0, m0, 0x2000
    s_add_u32 m0, m0, 67584
    s_add_u32 s96, s76, s90
    s_add_u32 s96, s96, 20480
    buffer_load_dwordx4 v153, s[64:67], s96 offen offset:1024 sc1 lds
    s_mov_b32 m0, s97
    s_waitcnt vmcnt(0)
    v_and_b32 v169, 0x23ff, v159
    v_add_u32 v169, 49152, v169
    ds_read_b128 v[72:75], v169 offset:2048
    v_and_b32 v169, 0x23ff, v159
    v_add_u32 v169, 49152, v169
    ds_read_b128 v[76:79], v169 offset:3072
    v_and_b32 v169, 0x23ff, v159
    v_add_u32 v169, 65536, v169
    ds_read_b128 v[80:83], v169 offset:2048
    v_and_b32 v169, 0x23ff, v159
    v_add_u32 v169, 65536, v169
    ds_read_b128 v[84:87], v169 offset:3072
    s_waitcnt lgkmcnt(0)
    v_bitop3_b32 v169, v72, v76, v80 bitop3:128
    v_bitop3_b32 v169, v169, v84, 1 bitop3:128
    v_cmp_ne_u32 vcc, 1, v169
    s_cbranch_vccnz L_xc15r
    s_branch L_xc15
Lss_23:
    global_store_dword v110, v111, s[50:51] sc1
    s_branch Lsd_24
L_cre1:
    s_sub_u32 s101, s101, 1
    s_cbranch_scc1 L_end
    buffer_load_dwordx4 v[116:119], v85, s[92:95], 0 offen offset:2048 sc1
    buffer_load_dwordx4 v[112:115], v85, s[92:95], 0 offen offset:1792 sc1
    buffer_load_dwordx4 v[108:111], v85, s[92:95], 0 offen offset:1536 sc1
    buffer_load_dwordx4 v[104:107], v85, s[92:95], 0 offen offset:1280 sc1
    buffer_load_dwordx4 v[100:103], v85, s[92:95], 0 offen offset:1024 sc1
    buffer_load_dwordx4 v[96:99], v85, s[92:95], 0 offen offset:768 sc1
    buffer_load_dwordx4 v[92:95], v85, s[92:95], 0 offen offset:512 sc1
    buffer_load_dwordx4 v[88:91], v85, s[92:95], 0 offen offset:256 sc1
    s_waitcnt vmcnt(0)
    s_branch L_cchk1
L_xr_re:
    s_sub_u32 s101, s101, 1
    s_cbranch_scc1 L_end
    global_load_dword v64, v87, s[50:51] sc1
    s_waitcnt vmcnt(0)
    s_branch L_xr
Lss_25:
    buffer_store_dwordx4 v[88:91], v153, s[64:67], s36 offen sc1
    s_branch Lsd_26
Lss_27:
    buffer_store_dwordx4 v[92:95], v153, s[64:67], s18 offen sc1
    s_branch Lsd_28
Lss_29:
    buffer_store_dwordx2 v[116:117], v62, s[64:67], s37 offen offset:0 sc1
    buffer_store_dwordx2 v[118:119], v62, s[64:67], s37 offen offset:512 sc1
    s_branch Lsd_30
Lss_31:
    buffer_store_dwordx4 v[96:99], v153, s[64:67], s19 offen sc1
    s_branch Lsd_32
Lss_33:
    buffer_store_dwordx4 v[100:103], v153, s[64:67], s20 offen sc1
    s_branch Lsd_34
Lh1c0r:
    s_sub_u32 s101, s101, 1
    s_cbranch_scc1 L_end
    buffer_load_dwordx4 v[40:43], v175, s[64:67], s23 offen offset:0 sc1
    buffer_load_dwordx4 v[44:47], v175, s[64:67], s23 offen offset:1024 sc1
    buffer_load_dwordx4 v[48:51], v175, s[64:67], s23 offen offset:2048 sc1
    buffer_load_dwordx4 v[120:123], v175, s[64:67], s22 offen offset:0 sc1
    buffer_load_dwordx4 v[80:83], v175, s[64:67], s25 offen offset:0 sc1
    buffer_load_dwordx4 v[116:119], v175, s[64:67], s28 offen offset:0 sc1
    buffer_load_dwordx4 v[64:67], v175, s[64:67], s31 offen offset:0 sc1
    s_waitcnt vmcnt(0)
    v_bitop3_b32 v169, v40, v42, v44 bitop3:254
    v_bitop3_b32 v169, v169, v46, v48 bitop3:254
    v_bitop3_b32 v169, v169, v50, 1 bitop3:168
    v_cmp_ne_u32 vcc, 0, v169
    s_cbranch_vccnz Lh1c0r
    s_branch Lh1c0
Lh1c1r:
    s_sub_u32 s101, s101, 1
    s_cbranch_scc1 L_end
    buffer_load_dwordx4 v[120:123], v175, s[64:67], s22 offen offset:0 sc1
    buffer_load_dwordx4 v[80:83], v175, s[64:67], s25 offen offset:0 sc1
    buffer_load_dwordx4 v[116:119], v175, s[64:67], s28 offen offset:0 sc1
    buffer_load_dwordx4 v[64:67], v175, s[64:67], s31 offen offset:0 sc1
    buffer_load_dwordx4 v[60:63], v175, s[64:67], s22 offen offset:1024 sc1
    buffer_load_dwordx4 v[68:71], v175, s[64:67], s25 offen offset:1024 sc1
    buffer_load_dwordx4 v[72:75], v175, s[64:67], s28 offen offset:1024 sc1
    buffer_load_dwordx4 v[76:79], v175, s[64:67], s31 offen offset:1024 sc1
    s_waitcnt vmcnt(0)
    v_bitop3_b32 v169, v120, v122, v80 bitop3:254
    v_bitop3_b32 v169, v169, v82, v116 bitop3:254
    v_bitop3_b32 v169, v169, v118, v64 bitop3:254
    v_bitop3_b32 v169, v169, v66, 1 bitop3:168
    v_cmp_ne_u32 vcc, 0, v169
    s_cbranch_vccnz Lh1c1r
    s_branch Lh1c1
Lh1c2r:
    s_sub_u32 s101, s101, 1
    s_cbranch_scc1 L_end
    buffer_load_dwordx4 v[60:63], v175, s[64:67], s22 offen offset:1024 sc1
    buffer_load_dwordx4 v[68:71], v175, s[64:67], s25 offen offset:1024 sc1
    buffer_load_dwordx4 v[72:75], v175, s[64:67], s28 offen offset:1024 sc1
    buffer_load_dwordx4 v[76:79], v175, s[64:67], s31 offen offset:1024 sc1
    buffer_load_dwordx4 v[84:87], v175, s[64:67], s22 offen offset:2048 sc1
    buffer_load_dwordx4 v[88:91], v175, s[64:67], s25 offen offset:2048 sc1
    buffer_load_dwordx4 v[92:95], v175, s[64:67], s28 offen offset:2048 sc1
    buffer_load_dwordx4 v[96:99], v175, s[64:67], s31 offen offset:2048 sc1
    buffer_load_dwordx4 v[100:103], v175, s[64:67], s22 offen offset:3072 sc1
    s_waitcnt vmcnt(0)
    v_bitop3_b32 v169, v60, v62, v68 bitop3:254
    v_bitop3_b32 v169, v169, v70, v72 bitop3:254
    v_bitop3_b32 v169, v169, v74, v76 bitop3:254
    v_bitop3_b32 v169, v169, v78, 1 bitop3:168
    v_cmp_ne_u32 vcc, 0, v169
    s_cbranch_vccnz Lh1c2r
    s_branch Lh1c2
Lh1c3r:
    s_sub_u32 s101, s101, 1
    s_cbranch_scc1 L_end
    buffer_load_dwordx4 v[84:87], v175, s[64:67], s22 offen offset:2048 sc1
    buffer_load_dwordx4 v[88:91], v175, s[64:67], s25 offen offset:2048 sc1
    buffer_load_dwordx4 v[92:95], v175, s[64:67], s28 offen offset:2048 sc1
    buffer_load_dwordx4 v[96:99], v175, s[64:67], s31 offen offset:2048 sc1
    buffer_load_dwordx4 v[100:103], v175, s[64:67], s22 offen offset:3072 sc1
    buffer_load_dwordx4 v[104:107], v175, s[64:67], s25 offen offset:3072 sc1
    buffer_load_dwordx4 v[108:111], v175, s[64:67], s28 offen offset:3072 sc1
    buffer_load_dwordx4 v[120:123], v175, s[64:67], s31 offen offset:3072 sc1
    buffer_load_dwordx4 v[80:83], v175, s[64:67], s26 offen offset:0 sc1
    buffer_load_dwordx4 v[116:119], v175, s[64:67], s26 offen offset:1024 sc1
    s_waitcnt vmcnt(0)
    v_bitop3_b32 v169, v84, v86, v88 bitop3:254
    v_bitop3_b32 v169, v169, v90, v92 bitop3:254
    v_bitop3_b32 v169, v169, v94, v96 bitop3:254
    v_bitop3_b32 v169, v169, v98, 1 bitop3:168
    v_cmp_ne_u32 vcc, 0, v169
    s_cbranch_vccnz Lh1c3r
    s_branch Lh1c3
Lh1c4r:
    s_sub_u32 s101, s101, 1
    s_cbranch_scc1 L_end
    buffer_load_dwordx4 v[100:103], v175, s[64:67], s22 offen offset:3072 sc1
    buffer_load_dwordx4 v[104:107], v175, s[64:67], s25 offen offset:3072 sc1
    buffer_load_dwordx4 v[108:111], v175, s[64:67], s28 offen offset:3072 sc1
    buffer_load_dwordx4 v[120:123], v175, s[64:67], s31 offen offset:3072 sc1
    buffer_load_dwordx4 v[80:83], v175, s[64:67], s26 offen offset:0 sc1
    buffer_load_dwordx4 v[116:119], v175, s[64:67], s26 offen offset:1024 sc1
    buffer_load_dwordx4 v[64:67], v175, s[64:67], s26 offen offset:2048 sc1
    buffer_load_dwordx4 v[60:63], v175, s[64:67], s26 offen offset:3072 sc1
    buffer_load_dwordx4 v[68:71], v175, s[64:67], s27 offen offset:0 sc1
    buffer_load_dwordx4 v[72:75], v175, s[64:67], s27 offen offset:1024 sc1
    buffer_load_dwordx4 v[76:79], v175, s[64:67], s29 offen offset:0 sc1
    s_waitcnt vmcnt(0)
    v_bitop3_b32 v169, v100, v102, v104 bitop3:254
    v_bitop3_b32 v169, v169, v106, v108 bitop3:254
    v_bitop3_b32 v169, v169, v110, v120 bitop3:254
    v_bitop3_b32 v169, v169, v122, 1 bitop3:168
    v_cmp_ne_u32 vcc, 0, v169
    s_cbranch_vccnz Lh1c4r
    s_branch Lh1c4
Lh1c5r:
    s_sub_u32 s101, s101, 1
    s_cbranch_scc1 L_end
    buffer_load_dwordx4 v[80:83], v175, s[64:67], s26 offen offset:0 sc1
    buffer_load_dwordx4 v[116:119], v175, s[64:67], s26 offen offset:1024 sc1
    buffer_load_dwordx4 v[64:67], v175, s[64:67], s26 offen offset:2048 sc1
    buffer_load_dwordx4 v[60:63], v175, s[64:67], s26 offen offset:3072 sc1
    buffer_load_dwordx4 v[68:71], v175, s[64:67], s27 offen offset:0 sc1
    buffer_load_dwordx4 v[72:75], v175, s[64:67], s27 offen offset:1024 sc1
    buffer_load_dwordx4 v[76:79], v175, s[64:67], s29 offen offset:0 sc1
    buffer_load_dwordx4 v[84:87], v175, s[64:67], s29 offen offset:1024 sc1
    buffer_load_dwordx4 v[88:91], v175, s[64:67], s29 offen offset:2048 sc1
    buffer_load_dwordx4 v[92:95], v175, s[64:67], s29 offen offset:3072 sc1
    buffer_load_dwordx4 v[96:99], v175, s[64:67], s30 offen offset:0 sc1
    buffer_load_dwordx4 v[100:103], v175, s[64:67], s30 offen offset:1024 sc1
    s_waitcnt vmcnt(0)
    v_bitop3_b32 v169, v80, v82, v116 bitop3:254
    v_bitop3_b32 v169, v169, v118, v64 bitop3:254
    v_bitop3_b32 v169, v169, v66, v60 bitop3:254
    v_bitop3_b32 v169, v169, v62, v68 bitop3:254
    v_bitop3_b32 v169, v169, v70, v72 bitop3:254
    v_bitop3_b32 v169, v169, v74, 1 bitop3:168
    v_cmp_ne_u32 vcc, 0, v169
    s_cbranch_vccnz Lh1c5r
    s_branch Lh1c5
Lh1c6r:
    s_sub_u32 s101, s101, 1
    s_cbranch_scc1 L_end
    buffer_load_dwordx4 v[76:79], v175, s[64:67], s29 offen offset:0 sc1
    buffer_load_dwordx4 v[84:87], v175, s[64:67], s29 offen offset:1024 sc1
    buffer_load_dwordx4 v[88:91], v175, s[64:67], s29 offen offset:2048 sc1
    buffer_load_dwordx4 v[92:95], v175, s[64:67], s29 offen offset:3072 sc1
    buffer_load_dwordx4 v[96:99], v175, s[64:67], s30 offen offset:0 sc1
    buffer_load_dwordx4 v[100:103], v175, s[64:67], s30 offen offset:1024 sc1
    buffer_load_dwordx4 v[104:107], v175, s[64:67], s32 offen offset:0 sc1
    buffer_load_dwordx4 v[108:111], v175, s[64:67], s32 offen offset:1024 sc1
    buffer_load_dwordx4 v[120:123], v175, s[64:67], s32 offen offset:2048 sc1
    buffer_load_dwordx4 v[80:83], v175, s[64:67], s32 offen offset:3072 sc1
    buffer_load_dwordx4 v[116:119], v175, s[64:67], s33 offen offset:0 sc1
    s_waitcnt vmcnt(0)
    v_bitop3_b32 v169, v76, v78, v84 bitop3:254
    v_bitop3_b32 v169, v169, v86, v88 bitop3:254
    v_bitop3_b32 v169, v169, v90, v92 bitop3:254
    v_bitop3_b32 v169, v169, v94, v96 bitop3:254
    v_bitop3_b32 v169, v169, v98, v100 bitop3:254
    v_bitop3_b32 v169, v169, v102, 1 bitop3:168
    v_cmp_ne_u32 vcc, 0, v169
    s_cbranch_vccnz Lh1c6r
    s_branch Lh1c6
Lh1c7r:
    s_sub_u32 s101, s101, 1
    s_cbranch_scc1 L_end
    buffer_load_dwordx4 v[104:107], v175, s[64:67], s32 offen offset:0 sc1
    buffer_load_dwordx4 v[108:111], v175, s[64:67], s32 offen offset:1024 sc1
    buffer_load_dwordx4 v[120:123], v175, s[64:67], s32 offen offset:2048 sc1
    buffer_load_dwordx4 v[80:83], v175, s[64:67], s32 offen offset:3072 sc1
    buffer_load_dwordx4 v[116:119], v175, s[64:67], s33 offen offset:0 sc1
    buffer_load_dwordx4 v[64:67], v175, s[64:67], s33 offen offset:1024 sc1
    buffer_load_dwordx4 v[60:63], v175, s[64:67], s23 offen offset:3072 sc1
    buffer_load_dwordx4 v[68:71], v175, s[64:67], s24 offen offset:0 sc1
    buffer_load_dwordx4 v[72:75], v175, s[64:67], s24 offen offset:1024 sc1
    s_waitcnt vmcnt(0)
    v_bitop3_b32 v169, v104, v106, v108 bitop3:254
    v_bitop3_b32 v169, v169, v110, v120 bitop3:254
    v_bitop3_b32 v169, v169, v122, v80 bitop3:254
    v_bitop3_b32 v169, v169, v82, v116 bitop3:254
    v_bitop3_b32 v169, v169, v118, v64 bitop3:254
    v_bitop3_b32 v169, v169, v66, 1 bitop3:168
    v_cmp_ne_u32 vcc, 0, v169
    s_cbranch_vccnz Lh1c7r
    s_branch Lh1c7
Lh1c8r:
    s_sub_u32 s101, s101, 1
    s_cbranch_scc1 L_end
    buffer_load_dwordx4 v[60:63], v175, s[64:67], s23 offen offset:3072 sc1
    buffer_load_dwordx4 v[68:71], v175, s[64:67], s24 offen offset:0 sc1
    buffer_load_dwordx4 v[72:75], v175, s[64:67], s24 offen offset:1024 sc1
    s_waitcnt vmcnt(0)
    v_bitop3_b32 v169, v60, v62, v68 bitop3:254
    v_bitop3_b32 v169, v169, v70, v72 bitop3:254
    v_bitop3_b32 v169, v169, v74, 1 bitop3:168
    v_cmp_ne_u32 vcc, 0, v169
    s_cbranch_vccnz Lh1c8r
    s_branch Lh1c8
Lss_35:
    global_store_dwordx2 v155, v[0:1], s[98:99] sc1
    s_branch Lsd_36
L_s3r:
    s_sub_u32 s101, s101, 1
    s_cbranch_scc1 L_end
    global_load_dwordx4 v[0:3], v163, s[98:99] sc1
    global_load_dwordx4 v[4:7], v163, s[98:99] offset:256 sc1
    s_waitcnt vmcnt(0)
    s_branch L_s3
L_last:
    s_endpgm
.section .rodata,"a"
.p2align 6
.amdhsa_kernel interleave_layers__ssm_conv_s5__ssm_conv_h3__prompt_kernel
  .amdhsa_next_free_vgpr 512
  .amdhsa_next_free_sgpr 102
  .amdhsa_accum_offset 256
  .amdhsa_group_segment_fixed_size 0
  .amdhsa_kernarg_size 144
  .amdhsa_user_sgpr_count 2
  .amdhsa_user_sgpr_kernarg_segment_ptr 1
  .amdhsa_system_sgpr_workgroup_id_x 1
.end_amdhsa_kernel
```

```asm
; @launch grid=(256,1,1) block=(256,1,1) lds=163840
.amdgcn_target "amdgcn-amd-amdhsa--gfx950"
.text
.globl interleave_layers__ssm_conv_s5__ssm_conv_h3__prompt_kernel
.p2align 8
.type interleave_layers__ssm_conv_s5__ssm_conv_h3__prompt_kernel,@function
interleave_layers__ssm_conv_s5__ssm_conv_h3__prompt_kernel:
    s_cmp_gt_u32 s2, 255
    s_cbranch_scc1 L_end
    s_load_dwordx16 s[32:47], s[0:1], 64
    s_load_dwordx16 s[16:31], s[0:1], 0
    s_load_dwordx4 s[48:51], s[0:1], 128
    s_memrealtime s[6:7]
    v_and_b32 v152, 63, v0
    v_lshrrev_b32 v1, 6, v0
    s_and_b32 s8, s2, 7
    s_lshr_b32 s9, s2, 3
    v_readfirstlane_b32 s77, v1
    s_getpc_b64 s[4:5]
L_pc:
    s_lshl_b32 s3, s9, 2
    s_add_u32 s3, s3, s77
    s_lshl_b32 s3, s3, 9
    v_and_b32 v2, 3, v152
    v_lshl_add_u32 v2, v2, 7, s3
    v_min_u32 v2, L_last-L_pc, v2
    global_load_dword a255, v2, s[4:5]
    s_and_b32 s78, s9, 7
    s_lshr_b32 s10, s9, 3
    s_lshl_b32 s79, s10, 3
    s_add_u32 s79, s79, s8
    v_mov_b32 v174, 0
    s_and_b32 s10, s10, 2
    s_add_u32 s10, s10, s8
    s_add_u32 s10, s10, s78
    s_mov_b32 s12, s10
    v_lshrrev_b32 v12, 3, v152
    v_and_b32 v13, 7, v152
    v_mul_u32_u24 v158, 1280, v12
    v_lshl_add_u32 v14, v13, 4, v158
    s_mul_i32 s5, s79, 81920
    s_lshl_b32 s4, s78, 7
    s_add_u32 s4, s4, s5
    s_mul_i32 s3, s77, 20480
    s_add_u32 s3, s3, s4
    v_add_u32 v70, s3, v14
    s_mul_i32 s8, s77, 4128
    s_mov_b32 s66, 2621440
    s_mov_b32 s67, 0x20000
    s_add_u32 s70, s66, 1024
    s_mov_b32 s71, s67
    v_lshrrev_b32 v145, 1, v0
    v_min_u32 v145, 79, v145
    s_mul_i32 s13, s78, 160
    v_lshl_add_u32 v147, v145, 1, s13
    s_waitcnt lgkmcnt(0)
    s_mov_b64 s[64:65], s[36:37]
    s_sub_u32 s68, s38, 1024
    s_subb_u32 s69, s39, 0
    global_load_ushort v142, v147, s[18:19]
    global_load_ushort v143, v147, s[20:21]
    global_load_ushort v146, v147, s[32:33]
    global_load_ushort v144, v147, s[30:31]
    s_add_u32 m0, s8, 56336
    s_movk_i32 s83, 0
    buffer_load_dwordx4 v70, s[64:67], s83 offen nt lds
    buffer_load_dwordx4 v70, s[68:71], s83 offen offset:1024 nt lds
    s_add_u32 m0, s8, 58400
    s_movk_i32 s83, 10240
    buffer_load_dwordx4 v70, s[64:67], s83 offen nt lds
    buffer_load_dwordx4 v70, s[68:71], s83 offen offset:1024 nt lds
    s_sub_u32 s4, s4, 10240
    v_add_u32 v14, s4, v14
    v_lshrrev_b32 v15, 1, v152
    v_mul_u32_u24 v15, 1280, v15
    v_and_b32 v72, 1, v152
    v_lshl_add_u32 v15, v72, 4, v15
    s_mul_i32 s4, s78, 96
    s_sub_u32 s3, s3, s4
    s_add_u32 s3, s3, 2048
    v_add_u32 v72, s3, v15
    v_cmp_gt_u32 vcc, 40, v152
    v_subrev_u32 v71, 6144, v72
    s_mul_i32 s9, s77, 1536
    v_cndmask_b32 v71, v14, v71, vcc
    s_sub_u32 s9, 54272, s9
    v_lshlrev_b32 v153, 4, v152
    s_movk_i32 s3, 160
    v_cmp_gt_u32 s[96:97], s3, v0
    s_lshl_b32 s3, s78, 9
    v_add_u32 v16, s3, v153
    s_mul_i32 s3, s78, 384
    s_sub_u32 s3, 3584, s3
    v_lshrrev_b32 v17, 5, v152
    v_mad_u32_u24 v16, v17, s3, v16
    s_mul_i32 s13, s12, 52
    s_lshr_b32 s13, s13, 8
    s_mul_i32 s13, s13, 5
    s_sub_u32 s72, s12, s13
    s_mov_b32 m0, s9
    s_nop 0
    buffer_load_dwordx4 v71, s[64:67], 0 offen nt lds
    s_sub_u32 m0, s9, 512
    s_mov_b32 exec_hi, 0
    buffer_load_dwordx4 v72, s[68:71], 0 offen nt lds
    s_mov_b32 m0, 94016
    s_mov_b32 exec_hi, 0xff
    global_load_lds_dwordx4 v16, s[40:41]
    s_mov_b32 exec_hi, -1
    s_or_b32 s3, s2, s77
    s_cmp_lg_u32 s3, 0
    s_cbranch_scc1 L_par
    s_or_b32 s6, s6, 7
    v_mov_b32 v2, 0
    v_mov_b32 v3, s6
    global_store_dword v2, v3, s[48:49] sc1
L_par:
    s_and_b32 s80, s77, 1
    s_lshr_b32 s81, s77, 1
    s_lshl_b32 s84, s77, 14
    s_add_u32 s84, s84, 98304
    s_lshl_b32 s72, s72, 7
    s_mul_i32 s85, s81, 640
    s_sub_u32 s90, 640, s85
    s_lshl_b32 s100, s77, 11
    v_lshrrev_b32 v11, 4, v152
    v_xor_b32 v14, v13, v11
    v_lshlrev_b32 v14, 4, v14
    s_mul_i32 s3, s78, 102400
    s_mul_i32 s4, s77, 20480
    s_add_u32 s3, s3, s4
    v_add3_u32 v158, v158, v14, s3
    v_xor_b32 v159, 64, v158
    v_add_u32 v159, 9216, v159
    s_mov_b64 s[56:57], s[22:23]
    s_mov_b32 s58, 819200
    s_mov_b32 s59, 0x20000
    s_mov_b64 s[60:61], s[24:25]
    s_mov_b32 s62, 819200
    s_mov_b32 s63, 0x20000
    s_sub_u32 s4, 81920, s4
    s_cmp_eq_u32 s80, 0
    s_cselect_b32 s92, s22, s24
    s_cselect_b32 s93, s23, s25
    s_add_u32 s92, s92, s4
    s_addc_u32 s93, s93, 0
    s_sub_u32 s94, 819200, s4
    s_mov_b32 s95, 0x20000
    v_lshrrev_b32 v15, 5, v152
    v_mul_u32_u24 v164, 20480, v15
    v_bfe_u32 v15, v152, 3, 1
    s_movk_i32 s3, 10240
    v_mad_u32_u24 v164, v15, s3, v164
    v_and_b32 v15, 1, v11
    s_movk_i32 s3, 1280
    v_mad_u32_u24 v164, v15, s3, v164
    s_mul_i32 s4, s77, 2560
    s_add_u32 s5, s5, s4
    v_add3_u32 v164, v164, v14, s5
    v_xor_b32 v165, 64, v164
    v_add_u32 v165, 39936, v165
    s_mov_b64 s[52:53], s[16:17]
    s_mov_b32 s54, 2621440
    s_mov_b32 s55, 0x20000
    s_mul_i32 s3, s2, 3200
    s_mul_i32 s4, s77, 7
    v_min_u32 v112, 6, v152
    v_add_u32 v112, s4, v112
    v_min_u32 v112, 24, v112
    v_lshl_add_u32 v112, v112, 7, s3
    s_mul_i32 s3, s78, 10240
    s_add_u32 s3, s3, s5
    v_min_u32 v113, 19, v152
    v_lshl_add_u32 v113, v113, 7, s3
    s_lshl_b32 s4, s78, 6
    s_lshl_b32 s3, s79, 1
    global_load_dword a255, v112, s[22:23]
    s_add_u32 s3, s3, s4
    s_and_b32 s5, s79, 15
    s_lshl_b32 s4, s78, 4
    s_add_u32 s4, s4, s5
    global_load_dword a255, v112, s[24:25]
    s_add_u32 s4, s4, 512
    s_lshl_b32 s14, s3, 12
    s_lshl_b32 s15, s4, 12
    s_lshl_b32 s3, s3, 1
    global_load_dword a255, v113, s[16:17]
    s_lshl_b32 s4, s4, 1
    s_andn2_b32 s4, s4, 3
    s_load_dword s34, s[44:45], s3
    s_load_dword s35, s[44:45], s4
    s_lshl_b32 s5, s77, 10
    s_sub_u32 s5, s5, 4
    s_max_i32 s5, s5, 0
    s_add_u32 s3, s5, s14
    s_load_dword s30, s[42:43], s3
    s_add_u32 s3, s3, 4096
    s_load_dword s31, s[42:43], s3
    s_add_u32 s3, s5, s15
    s_load_dword s32, s[42:43], s3
    s_lshl_b32 s12, s77, 10
    v_add_u32 v243, s12, v153
    s_add_u32 s73, s72, 128
    s_cmp_eq_u32 s73, 640
    s_cselect_b32 s73, 0, s73
    s_add_u32 s74, s73, 128
    s_cmp_eq_u32 s74, 640
    s_cselect_b32 s74, 0, s74
    s_add_u32 s75, s74, 128
    s_cmp_eq_u32 s75, 640
    s_cselect_b32 s75, 0, s75
    s_add_u32 s76, s75, 128
    s_cmp_eq_u32 s76, 640
    s_cselect_b32 s76, 0, s76
    v_and_b32 v10, 15, v152
    v_lshrrev_b32 v14, 1, v10
    v_xor_b32 v14, v14, v11
    v_lshlrev_b32 v14, 4, v14
    v_lshl_add_u32 v14, v10, 7, v14
    v_add_u32 v156, s84, v14
    v_xor_b32 v157, 64, v156
    s_lshl_b32 s3, s81, 13
    v_add_u32 v120, s3, v14
    v_xor_b32 v121, 64, v120
    v_xor_b32 v122, 0x2000, v120
    v_xor_b32 v123, 0x2000, v121
    s_getreg_b32 s89, hwreg(HW_REG_XCC_ID, 0, 3)
    s_mov_b32 s101, 0x20000
    s_mov_b32 s86, 0xffff0000
    s_mov_b32 s87, 0x3f803f80
    v_mov_b32 v116, s87
    v_mov_b32 v117, s87
    v_mov_b32 v118, s87
    v_mov_b32 v119, s87
    v_mov_b32 v224, 0
    v_add_u32 v124, s100, v14
    v_xor_b32 v125, 64, v124
    v_lshrrev_b32 v226, 3, v152
    v_and_b32 v221, 7, v152
    s_lshl_b32 s3, s77, 5
    s_add_u32 s3, s3, 56336
    v_lshl_add_u32 v64, v226, 2, s3
    s_movk_i32 s3, 2064
    v_mad_u32_u24 v64, v221, s3, v64
    v_subrev_u32 v65, 1424, v64
    v_add_u32 v66, 1024, v64
    s_sub_u32 s3, s9, 512
    v_lshl_add_u32 v75, v221, 2, s3
    v_lshl_add_u32 v75, v226, 6, v75
    s_lshl_b32 s4, s78, 2
    s_add_u32 s4, s4, s77
    s_lshl_b32 s3, s4, 16
    s_lshl_b32 s5, s79, 7
    s_add_u32 s3, s3, s5
    s_add_u32 s3, s3, 2048
    v_lshl_add_u32 v76, v226, 13, s3
    v_lshl_add_u32 v76, v221, 4, v76
    s_lshl_b32 s4, s4, 14
    s_add_u32 s4, s4, s5
    s_add_u32 s4, s4, 2097152
    v_lshrrev_b32 v229, 4, v152
    v_lshl_add_u32 v229, v229, 12, s4
    v_and_b32 v228, 15, v152
    v_lshl_add_u32 v229, v228, 3, v229
    s_lshl_b32 s3, s77, 9
    s_add_u32 s3, s3, 79872
    v_lshl_add_u32 v228, v152, 3, s3
    s_lshl_b32 s3, s77, 7
    s_add_u32 s3, s3, 94016
    v_lshl_add_u32 v73, v226, 4, s3
    s_mov_b32 s3, 94528
    v_lshl_add_u32 v74, v221, 4, s3
    v_xor_b32 v226, 3, v226
    s_lshl_b32 s3, s77, 5
    s_add_u32 s3, s3, 79872
    v_lshl_add_u32 v77, v226, 2, s3
    v_lshl_add_u32 v77, v221, 8, v77
    s_lshl_b32 s3, s78, 9
    s_add_u32 s3, s3, 11534336
    v_lshl_add_u32 v168, v152, 3, s3
    s_lshl_b32 s4, s79, 4
    s_add_u32 s3, s3, s4
    s_add_u32 s4, s4, 11534336
    v_and_b32 v169, 7, v152
    v_lshl_add_u32 v169, v169, 9, s4
    s_lshl_b32 s4, s77, 2
    s_add_u32 s3, s3, s4
    v_mov_b32 v223, s3
    s_waitcnt vmcnt(10)
    v_lshlrev_b32 v178, 16, v144
    v_lshlrev_b32 v176, 16, v142
    v_mul_f32 v178, 0x3fb8aa3b, v178
    s_mov_b32 m0, s100
    s_mov_b32 s83, s72
    buffer_load_dwordx4 v164, s[52:55], s83 offen lds
    v_lshlrev_b32 v177, 16, v143
    v_exp_f32 v178, v178
    v_mul_f32 v185, v176, v176
    v_fmac_f32 v185, v177, v177
    v_cvt_pk_bf16_f32 v178, 0, v178
    v_rcp_f32 v185, v185
    v_mul_f32 v179, v178, v176
    v_mul_f32 v180, v178, v177
    v_mul_f32 v179, 0x3fb8aa3b, v179
    v_mul_f32 v180, 0x3e22f983, v180
    v_and_b32 v188, 1, v152
    v_cmp_eq_u32 vcc, 1, v188
    v_mov_b32 v189, 0x44000000
    v_mov_b32 v181, 0x41000000
    v_mov_b32 v198, 0x42800000
    v_mov_b32 v199, 0x41800000
    v_cndmask_b32 v189, v189, v181, vcc
    v_cndmask_b32 v198, v198, v199, vcc
    v_mul_f32 v184, 1.0, v179
    v_mul_f32 v183, 1.0, v180
    v_exp_f32 v184, v184
    buffer_load_dwordx4 v165, s[52:55], s83 offen offset:1024 lds
    v_fract_f32 v183, v183
    v_cos_f32 v182, v183
    v_sin_f32 v183, v183
    v_mul_f32 v182, v184, v182
    v_mul_f32 v183, v184, v183
    v_mul_f32 v192, v189, v179
    v_mul_f32 v191, v189, v180
    v_exp_f32 v192, v192
    v_fract_f32 v191, v191
    v_cos_f32 v190, v191
    v_sin_f32 v191, v191
    v_mul_f32 v190, v192, v190
    v_mul_f32 v191, v192, v191
    v_add_f32 v185, v185, v185
    v_add_f32 v184, -1.0, v182
    v_mul_f32 v186, v184, v176
    v_mul_f32 v187, v183, v176
    v_fmac_f32 v186, v183, v177
    v_fma_f32 v187, -v184, v177, v187
    v_mul_f32 v186, v186, v185
    v_mul_f32 v187, v187, v185
    s_add_u32 m0, s100, 8192
    s_add_u32 s83, s72, 640
    buffer_load_dwordx4 v164, s[52:55], s83 offen lds
    v_cndmask_b32 v186, 1.0, v186, vcc
    v_cndmask_b32 v187, 0, v187, vcc
    v_cndmask_b32 v182, v182, v190, vcc
    v_cndmask_b32 v183, v183, v191, vcc
    v_mul_u32_u24 v188, 640, v188
    v_lshlrev_b32 v181, 3, v145
    v_add_u32 v181, 81920, v181
    v_add_u32 v189, v181, v188
    s_mov_b64 exec, s[96:97]
    ds_write_b64 v189, v[182:183] offset:7680
    s_mov_b64 exec, -1
    v_sub_u32 v189, v181, v188
    v_lshlrev_b32 v188, 3, v188
    v_sub_u32 v188, v181, v188
    s_mov_b64 exec, s[96:97]
    ds_write_b64 v188, v[186:187] offset:5120
    s_mov_b64 exec, -1
    v_mul_f32 v196, v198, v179
    v_mul_f32 v195, v198, v180
    v_exp_f32 v196, v196
    v_fract_f32 v195, v195
    v_cos_f32 v194, v195
    v_sin_f32 v195, v195
    buffer_load_dwordx4 v165, s[52:55], s83 offen offset:1024 lds
    v_mul_f32 v194, v196, v194
    v_mul_f32 v195, v196, v195
    s_mov_b64 exec, s[96:97]
    ds_write_b64 v189, v[194:195] offset:9600
    s_mov_b64 exec, -1
    v_pk_mul_f32 v[200:201], v[186:187], v[190:191] op_sel_hi:[1,0]
    v_pk_fma_f32 v[200:201], v[186:187], v[190:191], v[200:201] op_sel:[1,1,0] op_sel_hi:[0,1,1] neg_lo:[1,0,0]
    s_mov_b64 exec, s[96:97]
    ds_write_b64 v188, v[200:201] offset:5760
    s_mov_b64 exec, -1
    v_pk_mul_f32 v[186:187], v[200:201], v[190:191] op_sel_hi:[1,0]
    v_pk_fma_f32 v[186:187], v[200:201], v[190:191], v[186:187] op_sel:[1,1,0] op_sel_hi:[0,1,1] neg_lo:[1,0,0]
    s_mov_b64 exec, s[96:97]
    ds_write_b64 v188, v[186:187] offset:6400
    s_mov_b64 exec, -1
    v_pk_mul_f32 v[200:201], v[186:187], v[190:191] op_sel_hi:[1,0]
    v_pk_fma_f32 v[200:201], v[186:187], v[190:191], v[200:201] op_sel:[1,1,0] op_sel_hi:[0,1,1] neg_lo:[1,0,0]
    s_mov_b64 exec, s[96:97]
    ds_write_b64 v188, v[200:201] offset:7040
    s_mov_b64 exec, -1
    v_pk_mul_f32 v[186:187], v[200:201], v[190:191] op_sel_hi:[1,0]
    v_pk_fma_f32 v[186:187], v[200:201], v[190:191], v[186:187] op_sel:[1,1,0] op_sel_hi:[0,1,1] neg_lo:[1,0,0]
    s_and_b64 s[96:97], s[96:97], vcc
    s_mov_b64 exec, s[96:97]
    ds_write_b64 v188, v[186:187] offset:7680
    s_mov_b64 exec, -1
    v_pk_mul_f32 v[200:201], v[186:187], v[190:191] op_sel_hi:[1,0]
    v_pk_fma_f32 v[200:201], v[186:187], v[190:191], v[200:201] op_sel:[1,1,0] op_sel_hi:[0,1,1] neg_lo:[1,0,0]
    s_mov_b64 exec, s[96:97]
    ds_write_b64 v188, v[200:201] offset:8320
    s_mov_b64 exec, -1
    s_mov_b32 m0, s84
    s_add_u32 s83, s72, s85
    buffer_load_dwordx4 v158, s[56:59], s83 offen lds
    v_pk_mul_f32 v[186:187], v[200:201], v[190:191] op_sel_hi:[1,0]
    v_pk_fma_f32 v[186:187], v[200:201], v[190:191], v[186:187] op_sel:[1,1,0] op_sel_hi:[0,1,1] neg_lo:[1,0,0]
    s_mov_b64 exec, s[96:97]
    ds_write_b64 v188, v[186:187] offset:8960
    s_mov_b64 exec, -1
    v_pk_mul_f32 v[200:201], v[186:187], v[190:191] op_sel_hi:[1,0]
    v_pk_fma_f32 v[200:201], v[186:187], v[190:191], v[200:201] op_sel:[1,1,0] op_sel_hi:[0,1,1] neg_lo:[1,0,0]
    s_mov_b64 exec, s[96:97]
    ds_write_b64 v188, v[200:201] offset:9600
    s_mov_b64 exec, -1
    v_lshlrev_b32 v188, 2, v145
    v_add_u32 v188, 93696, v188
    v_lshlrev_b32 v189, 16, v146
    s_mov_b64 exec, s[96:97]
    ds_write_b32 v188, v189
    s_mov_b64 exec, -1
    v_and_b32 v230, 15, v152
    v_lshrrev_b32 v231, 1, v230
    s_lshr_b32 s3, s78, 2
    s_lshl_b32 s3, s3, 13
    s_add_u32 s3, s3, s100
    v_lshl_add_u32 v230, v230, 7, s3
    s_and_b32 s3, s78, 3
    s_mul_i32 s3, s3, 10
    s_lshr_b32 s4, s72, 4
    s_sub_u32 s3, s3, s4
    v_lshrrev_b32 v226, 4, v152
    v_add_u32 v128, s3, v226
    buffer_load_dwordx4 v159, s[56:59], s83 offen offset:1024 lds
    v_add_u32 v129, 4, v128
    s_add_u32 s3, s3, 8
    v_lshrrev_b32 v226, 5, v152
    v_add_u32 v130, s3, v226
    v_add_u32 v226, 40, v128
    v_min_u32 v128, v128, v226
    v_lshrrev_b32 v226, 3, v128
    v_lshl_add_u32 v226, v226, 14, v230
    v_and_b32 v128, 7, v128
    v_xor_b32 v128, v128, v231
    v_lshl_add_u32 v128, v128, 4, v226
    v_add_u32 v226, 40, v129
    v_min_u32 v129, v129, v226
    s_waitcnt vmcnt(9)
    s_waitcnt lgkmcnt(0)
    s_barrier
    ds_read2_b32 v[80:81], v75 offset0:136 offset1:144
    ds_read2_b32 v[82:83], v75 offset0:152 offset1:160
    ds_read_b32 v84, v75 offset:672
    ds_read2_b32 v[86:87], v75 offset0:0 offset1:8
    ds_read_b128 v[88:91], v74
    ds_read_b128 v[60:63], v73
    ds_read2_b32 v[40:41], v65 offset0:0 offset1:32
    s_add_u32 m0, s84, 2048
    s_add_u32 s83, s72, s85
    buffer_load_dwordx4 v158, s[60:63], s83 offen lds
    ds_read_b32 v42, v65 offset:256
    ds_read2_b32 v[44:45], v64 offset0:0 offset1:32
    ds_read2_b32 v[46:47], v64 offset0:64 offset1:96
    ds_read2_b32 v[48:49], v64 offset0:128 offset1:160
    ds_read2_b32 v[50:51], v64 offset0:192 offset1:224
    ds_read2_b32 v[52:53], v66 offset0:0 offset1:32
    ds_read2_b32 v[54:55], v66 offset0:64 offset1:96
    ds_read2_b32 v[56:57], v66 offset0:128 offset1:160
    ds_read2_b32 v[58:59], v66 offset0:192 offset1:224
    v_mov_b64 v[208:209], -1
    v_add_u32 v212, 3145728, v229
    v_mov_b64 v[210:211], -1
    v_add_u32 v213, 3145728, v76
    s_waitcnt lgkmcnt(11)
    v_lshlrev_b32 v22, 16, v88
    v_and_b32 v24, s86, v88
    v_lshlrev_b32 v26, 16, v89
    v_and_b32 v28, s86, v89
    v_lshlrev_b32 v23, 16, v90
    v_and_b32 v25, s86, v90
    v_lshlrev_b32 v27, 16, v91
    v_and_b32 v29, s86, v91
    v_lshlrev_b32 v0, 16, v80
    v_and_b32 v1, s86, v80
    buffer_load_dwordx4 v159, s[60:63], s83 offen offset:1024 lds
    v_lshlrev_b32 v2, 16, v81
    v_and_b32 v3, s86, v81
    v_lshlrev_b32 v4, 16, v82
    v_and_b32 v5, s86, v82
    v_lshlrev_b32 v6, 16, v83
    v_and_b32 v7, s86, v83
    v_lshlrev_b32 v8, 16, v84
    v_and_b32 v9, s86, v84
    v_pk_mul_f32 v[30:31], v[0:1], v[28:29]
    v_pk_mul_f32 v[32:33], v[2:3], v[28:29]
    v_pk_mul_f32 v[34:35], v[2:3], v[26:27]
    v_pk_mul_f32 v[36:37], v[4:5], v[26:27]
    v_cvt_pk_bf16_f32 v34, v30, v34
    v_cvt_pk_bf16_f32 v35, v31, v35
    v_cvt_pk_bf16_f32 v36, v32, v36
    v_cvt_pk_bf16_f32 v37, v33, v37
    v_dot2_f32_bf16 v30, v34, s87, 0
    v_dot2_f32_bf16 v31, v35, s87, 0
    v_dot2_f32_bf16 v32, v36, s87, 0
    v_dot2_f32_bf16 v33, v37, s87, 0
    v_pk_mul_f32 v[34:35], v[4:5], v[24:25]
    v_pk_mul_f32 v[36:37], v[6:7], v[24:25]
    v_cvt_pk_bf16_f32 v34, v30, v34
    v_cvt_pk_bf16_f32 v35, v31, v35
    s_add_u32 m0, s84, 4096
    s_add_u32 s83, s72, s85
    buffer_load_dwordx4 v158, s[92:95], s83 offen lds
    v_cvt_pk_bf16_f32 v36, v32, v36
    v_cvt_pk_bf16_f32 v37, v33, v37
    v_dot2_f32_bf16 v30, v34, s87, 0
    v_dot2_f32_bf16 v31, v35, s87, 0
    v_dot2_f32_bf16 v32, v36, s87, 0
    v_dot2_f32_bf16 v33, v37, s87, 0
    v_pk_mul_f32 v[34:35], v[6:7], v[22:23]
    v_pk_mul_f32 v[36:37], v[8:9], v[22:23]
    v_cvt_pk_bf16_f32 v34, v30, v34
    v_cvt_pk_bf16_f32 v35, v31, v35
    v_cvt_pk_bf16_f32 v36, v32, v36
    v_cvt_pk_bf16_f32 v37, v33, v37
    v_dot2_f32_bf16 v30, v34, s87, 0
    v_dot2_f32_bf16 v31, v35, s87, 0
    v_dot2_f32_bf16 v32, v36, s87, 0
    v_dot2_f32_bf16 v33, v37, s87, 0
    v_and_b32 v34, 0xffff, v86
    v_and_b32 v35, s86, v86
    v_and_b32 v36, 0xffff, v87
    v_and_b32 v37, s86, v87
    v_cvt_pk_bf16_f32 v38, v30, v31
    v_cvt_pk_bf16_f32 v39, v32, v33
    v_dot2_f32_bf16 v34, v38, v34, 0
    v_dot2_f32_bf16 v36, v39, v36, 0
    buffer_load_dwordx4 v159, s[92:95], s83 offen offset:1024 lds
    v_dot2_f32_bf16 v35, v38, v35, 0
    v_dot2_f32_bf16 v37, v39, v37, 0
    v_cvt_pk_bf16_f32 v68, v36, v34
    s_nop 1
    v_cvt_pk_bf16_f32 v69, v37, v35
    s_waitcnt lgkmcnt(0)
    ds_write2_b32 v77, v68, v69 offset1:32
    v_lshlrev_b32 v22, 16, v60
    v_and_b32 v24, s86, v60
    v_lshlrev_b32 v26, 16, v61
    v_and_b32 v28, s86, v61
    v_lshlrev_b32 v23, 16, v62
    v_and_b32 v25, s86, v62
    v_lshlrev_b32 v27, 16, v63
    v_and_b32 v29, s86, v63
    v_lshlrev_b32 v0, 16, v40
    v_and_b32 v1, s86, v40
    v_lshlrev_b32 v2, 16, v41
    v_and_b32 v3, s86, v41
    v_lshlrev_b32 v4, 16, v42
    v_and_b32 v5, s86, v42
    v_lshlrev_b32 v6, 16, v44
    v_and_b32 v7, s86, v44
    v_lshlrev_b32 v8, 16, v45
    v_and_b32 v9, s86, v45
    s_add_u32 m0, s84, 6144
    s_add_u32 s83, s72, s90
    buffer_load_dwordx4 v158, s[56:59], s83 offen lds
    v_lshlrev_b32 v10, 16, v46
    v_and_b32 v11, s86, v46
    v_lshlrev_b32 v12, 16, v47
    v_and_b32 v13, s86, v47
    v_lshlrev_b32 v14, 16, v48
    v_and_b32 v15, s86, v48
    v_lshlrev_b32 v16, 16, v49
    v_and_b32 v17, s86, v49
    v_lshlrev_b32 v18, 16, v50
    v_and_b32 v19, s86, v50
    v_lshlrev_b32 v20, 16, v51
    v_and_b32 v21, s86, v51
    v_pk_mul_f32 v[30:31], v[0:1], v[28:29]
    v_pk_mul_f32 v[32:33], v[2:3], v[28:29]
    v_pk_mul_f32 v[34:35], v[2:3], v[26:27]
    v_pk_mul_f32 v[36:37], v[4:5], v[26:27]
    v_cvt_pk_bf16_f32 v34, v30, v34
    v_cvt_pk_bf16_f32 v35, v31, v35
    v_cvt_pk_bf16_f32 v36, v32, v36
    v_cvt_pk_bf16_f32 v37, v33, v37
    v_dot2_f32_bf16 v30, v34, s87, 0
    v_dot2_f32_bf16 v31, v35, s87, 0
    v_dot2_f32_bf16 v32, v36, s87, 0
    v_dot2_f32_bf16 v33, v37, s87, 0
    buffer_load_dwordx4 v159, s[56:59], s83 offen offset:1024 lds
    v_pk_mul_f32 v[34:35], v[4:5], v[24:25]
    v_pk_mul_f32 v[36:37], v[6:7], v[24:25]
    v_cvt_pk_bf16_f32 v34, v30, v34
    v_cvt_pk_bf16_f32 v35, v31, v35
    v_cvt_pk_bf16_f32 v36, v32, v36
    v_cvt_pk_bf16_f32 v37, v33, v37
    v_dot2_f32_bf16 v30, v34, s87, 0
    v_dot2_f32_bf16 v31, v35, s87, 0
    v_dot2_f32_bf16 v32, v36, s87, 0
    v_dot2_f32_bf16 v33, v37, s87, 0
    v_pk_mul_f32 v[34:35], v[6:7], v[22:23]
    v_pk_mul_f32 v[36:37], v[8:9], v[22:23]
    v_cvt_pk_bf16_f32 v34, v30, v34
    v_cvt_pk_bf16_f32 v35, v31, v35
    v_cvt_pk_bf16_f32 v36, v32, v36
    v_cvt_pk_bf16_f32 v37, v33, v37
    v_dot2_f32_bf16 v30, v34, s87, 0
    v_dot2_f32_bf16 v31, v35, s87, 0
    v_dot2_f32_bf16 v32, v36, s87, 0
    v_dot2_f32_bf16 v33, v37, s87, 0
    v_and_b32 v34, 0xffff, v52
    v_and_b32 v35, s86, v52
    v_and_b32 v36, 0xffff, v53
    v_and_b32 v37, s86, v53
    s_add_u32 m0, s84, 8192
    s_add_u32 s83, s72, s90
    buffer_load_dwordx4 v158, s[60:63], s83 offen lds
    v_cvt_pk_bf16_f32 v38, v30, v31
    v_cvt_pk_bf16_f32 v39, v32, v33
    v_dot2_f32_bf16 v34, v38, v34, 0
    v_dot2_f32_bf16 v36, v39, v36, 0
    v_dot2_f32_bf16 v35, v38, v35, 0
    v_dot2_f32_bf16 v37, v39, v37, 0
    s_nop 0
    v_cvt_pk_bf16_f32 v107, v36, v34
    s_nop 0
    v_cvt_pk_bf16_f32 v111, v37, v35
    v_pk_mul_f32 v[30:31], v[4:5], v[28:29]
    v_pk_mul_f32 v[32:33], v[6:7], v[28:29]
    v_pk_mul_f32 v[34:35], v[6:7], v[26:27]
    v_pk_mul_f32 v[36:37], v[8:9], v[26:27]
    v_cvt_pk_bf16_f32 v34, v30, v34
    v_cvt_pk_bf16_f32 v35, v31, v35
    v_cvt_pk_bf16_f32 v36, v32, v36
    v_cvt_pk_bf16_f32 v37, v33, v37
    v_dot2_f32_bf16 v30, v34, s87, 0
    v_dot2_f32_bf16 v31, v35, s87, 0
    v_dot2_f32_bf16 v32, v36, s87, 0
    v_dot2_f32_bf16 v33, v37, s87, 0
    v_pk_mul_f32 v[34:35], v[8:9], v[24:25]
    v_pk_mul_f32 v[36:37], v[10:11], v[24:25]
    v_cvt_pk_bf16_f32 v34, v30, v34
    v_cvt_pk_bf16_f32 v35, v31, v35
    buffer_load_dwordx4 v159, s[60:63], s83 offen offset:1024 lds
    v_cvt_pk_bf16_f32 v36, v32, v36
    v_cvt_pk_bf16_f32 v37, v33, v37
    v_dot2_f32_bf16 v30, v34, s87, 0
    v_dot2_f32_bf16 v31, v35, s87, 0
    v_dot2_f32_bf16 v32, v36, s87, 0
    v_dot2_f32_bf16 v33, v37, s87, 0
    v_pk_mul_f32 v[34:35], v[10:11], v[22:23]
    v_pk_mul_f32 v[36:37], v[12:13], v[22:23]
    v_cvt_pk_bf16_f32 v34, v30, v34
    v_cvt_pk_bf16_f32 v35, v31, v35
    v_cvt_pk_bf16_f32 v36, v32, v36
    v_cvt_pk_bf16_f32 v37, v33, v37
    v_dot2_f32_bf16 v30, v34, s87, 0
    v_dot2_f32_bf16 v31, v35, s87, 0
    v_dot2_f32_bf16 v32, v36, s87, 0
    v_dot2_f32_bf16 v33, v37, s87, 0
    v_and_b32 v34, 0xffff, v54
    v_and_b32 v35, s86, v54
    v_and_b32 v36, 0xffff, v55
    v_and_b32 v37, s86, v55
    v_cvt_pk_bf16_f32 v38, v30, v31
    v_cvt_pk_bf16_f32 v39, v32, v33
    v_dot2_f32_bf16 v34, v38, v34, 0
    v_dot2_f32_bf16 v36, v39, v36, 0
    s_add_u32 m0, s100, 16384
    s_mov_b32 s83, s73
    buffer_load_dwordx4 v164, s[52:55], s83 offen lds
    v_dot2_f32_bf16 v35, v38, v35, 0
    v_dot2_f32_bf16 v37, v39, v37, 0
    v_cvt_pk_bf16_f32 v106, v36, v34
    s_nop 1
    v_cvt_pk_bf16_f32 v110, v37, v35
    v_pk_mul_f32 v[30:31], v[8:9], v[28:29]
    v_pk_mul_f32 v[32:33], v[10:11], v[28:29]
    v_pk_mul_f32 v[34:35], v[10:11], v[26:27]
    v_pk_mul_f32 v[36:37], v[12:13], v[26:27]
    v_cvt_pk_bf16_f32 v34, v30, v34
    v_cvt_pk_bf16_f32 v35, v31, v35
    v_cvt_pk_bf16_f32 v36, v32, v36
    v_cvt_pk_bf16_f32 v37, v33, v37
    v_dot2_f32_bf16 v30, v34, s87, 0
    v_dot2_f32_bf16 v31, v35, s87, 0
    v_dot2_f32_bf16 v32, v36, s87, 0
    v_dot2_f32_bf16 v33, v37, s87, 0
    v_pk_mul_f32 v[34:35], v[12:13], v[24:25]
    v_pk_mul_f32 v[36:37], v[14:15], v[24:25]
    v_cvt_pk_bf16_f32 v34, v30, v34
    v_cvt_pk_bf16_f32 v35, v31, v35
    v_cvt_pk_bf16_f32 v36, v32, v36
    v_cvt_pk_bf16_f32 v37, v33, v37
    v_dot2_f32_bf16 v30, v34, s87, 0
    v_dot2_f32_bf16 v31, v35, s87, 0
    buffer_load_dwordx4 v165, s[52:55], s83 offen offset:1024 lds
    v_dot2_f32_bf16 v32, v36, s87, 0
    v_dot2_f32_bf16 v33, v37, s87, 0
    v_pk_mul_f32 v[34:35], v[14:15], v[22:23]
    v_pk_mul_f32 v[36:37], v[16:17], v[22:23]
    v_cvt_pk_bf16_f32 v34, v30, v34
    v_cvt_pk_bf16_f32 v35, v31, v35
    v_cvt_pk_bf16_f32 v36, v32, v36
    v_cvt_pk_bf16_f32 v37, v33, v37
    v_dot2_f32_bf16 v30, v34, s87, 0
    v_dot2_f32_bf16 v31, v35, s87, 0
    v_dot2_f32_bf16 v32, v36, s87, 0
    v_dot2_f32_bf16 v33, v37, s87, 0
    v_and_b32 v34, 0xffff, v56
    v_and_b32 v35, s86, v56
    v_and_b32 v36, 0xffff, v57
    v_and_b32 v37, s86, v57
    v_cvt_pk_bf16_f32 v38, v30, v31
    v_cvt_pk_bf16_f32 v39, v32, v33
    v_dot2_f32_bf16 v34, v38, v34, 0
    v_dot2_f32_bf16 v36, v39, v36, 0
    v_dot2_f32_bf16 v35, v38, v35, 0
    v_dot2_f32_bf16 v37, v39, v37, 0
    s_nop 0
    v_cvt_pk_bf16_f32 v105, v36, v34
    s_nop 0
    v_cvt_pk_bf16_f32 v109, v37, v35
    s_add_u32 m0, s100, 24576
    s_add_u32 s83, s73, 640
    buffer_load_dwordx4 v164, s[52:55], s83 offen lds
    v_pk_mul_f32 v[30:31], v[12:13], v[28:29]
    v_pk_mul_f32 v[32:33], v[14:15], v[28:29]
    v_pk_mul_f32 v[34:35], v[14:15], v[26:27]
    v_pk_mul_f32 v[36:37], v[16:17], v[26:27]
    v_cvt_pk_bf16_f32 v34, v30, v34
    v_cvt_pk_bf16_f32 v35, v31, v35
    v_cvt_pk_bf16_f32 v36, v32, v36
    v_cvt_pk_bf16_f32 v37, v33, v37
    v_dot2_f32_bf16 v30, v34, s87, 0
    v_dot2_f32_bf16 v31, v35, s87, 0
    v_dot2_f32_bf16 v32, v36, s87, 0
    v_dot2_f32_bf16 v33, v37, s87, 0
    v_pk_mul_f32 v[34:35], v[16:17], v[24:25]
    v_pk_mul_f32 v[36:37], v[18:19], v[24:25]
    v_cvt_pk_bf16_f32 v34, v30, v34
    v_cvt_pk_bf16_f32 v35, v31, v35
    v_cvt_pk_bf16_f32 v36, v32, v36
    v_cvt_pk_bf16_f32 v37, v33, v37
    v_dot2_f32_bf16 v30, v34, s87, 0
    v_dot2_f32_bf16 v31, v35, s87, 0
    v_dot2_f32_bf16 v32, v36, s87, 0
    v_dot2_f32_bf16 v33, v37, s87, 0
    v_pk_mul_f32 v[34:35], v[18:19], v[22:23]
    v_pk_mul_f32 v[36:37], v[20:21], v[22:23]
    buffer_load_dwordx4 v165, s[52:55], s83 offen offset:1024 lds
    v_cvt_pk_bf16_f32 v34, v30, v34
    v_cvt_pk_bf16_f32 v35, v31, v35
    v_cvt_pk_bf16_f32 v36, v32, v36
    v_cvt_pk_bf16_f32 v37, v33, v37
    v_dot2_f32_bf16 v30, v34, s87, 0
    v_dot2_f32_bf16 v31, v35, s87, 0
    v_dot2_f32_bf16 v32, v36, s87, 0
    v_dot2_f32_bf16 v33, v37, s87, 0
    s_waitcnt vmcnt(12)
    ds_read_b128 a[0:3], v156 offset:0
    ds_read_b128 a[4:7], v157 offset:0
    v_and_b32 v34, 0xffff, v58
    v_and_b32 v35, s86, v58
    v_and_b32 v36, 0xffff, v59
    v_and_b32 v37, s86, v59
    s_waitcnt vmcnt(10)
    ds_read_b128 a[8:11], v156 offset:2048
    ds_read_b128 a[12:15], v157 offset:2048
    v_cvt_pk_bf16_f32 v38, v30, v31
    v_cvt_pk_bf16_f32 v39, v32, v33
    v_dot2_f32_bf16 v34, v38, v34, 0
    v_dot2_f32_bf16 v36, v39, v36, 0
    s_waitcnt vmcnt(8)
    ds_read_b128 a[16:19], v156 offset:4096
    ds_read_b128 a[20:23], v157 offset:4096
    v_dot2_f32_bf16 v35, v38, v35, 0
    v_dot2_f32_bf16 v37, v39, v37, 0
    v_cvt_pk_bf16_f32 v104, v36, v34
    s_nop 1
    v_cvt_pk_bf16_f32 v108, v37, v35
    global_store_dwordx4 v76, v[104:107], s[50:51] offset:-2048 sc1
    global_store_dwordx4 v76, v[108:111], s[50:51] offset:2048 sc1
    s_add_u32 m0, s84, 10240
    s_add_u32 s83, s73, s85
    buffer_load_dwordx4 v158, s[56:59], s83 offen lds
    s_waitcnt lgkmcnt(0)
    s_barrier
    ds_read_b128 v[60:63], v120 offset:0
    ds_read_b128 v[64:67], v120 offset:2048
    ds_read_b128 v[68:71], v120 offset:4096
    ds_read_b128 v[72:75], v120 offset:6144
    ds_read_b128 v[76:79], v121 offset:0
    ds_read_b128 v[80:83], v121 offset:2048
    ds_read_b128 v[84:87], v121 offset:4096
    ds_read_b128 v[88:91], v121 offset:6144
    s_waitcnt lgkmcnt(6)
    v_mfma_f32_16x16x32_bf16 v[176:179], v[60:63], a[0:3], 0
    v_lshrrev_b32 v226, 3, v129
    v_mfma_f32_16x16x32_bf16 v[192:195], v[60:63], a[8:11], 0
    v_lshl_add_u32 v226, v226, 14, v230
    v_mfma_f32_16x16x32_bf16 v[32:35], v[60:63], a[16:19], 0
    ds_read_b128 v[60:63], v122 offset:0
    v_and_b32 v129, 7, v129
    v_mfma_f32_16x16x32_bf16 v[48:51], v[116:119], a[0:3], 0
    ds_read_b64 v[170:171], v228
    v_xor_b32 v129, v129, v231
    v_mfma_f32_16x16x32_bf16 v[180:183], v[64:67], a[0:3], 0
    buffer_load_dwordx4 v159, s[56:59], s83 offen offset:1024 lds
    global_load_dword v224, v224, s[48:49] sc1
    v_lshl_add_u32 v129, v129, 4, v226
    v_mfma_f32_16x16x32_bf16 v[196:199], v[64:67], a[8:11], 0
    v_add_u32 v226, 40, v130
    v_min_u32 v130, v130, v226
    v_mfma_f32_16x16x32_bf16 v[36:39], v[64:67], a[16:19], 0
    ds_read_b128 v[64:67], v122 offset:2048
    v_lshrrev_b32 v226, 3, v130
    v_mfma_f32_16x16x32_bf16 v[52:55], v[116:119], a[8:11], 0
    s_add_u32 m0, s84, 12288
    s_add_u32 s83, s73, s85
    buffer_load_dwordx4 v158, s[60:63], s83 offen lds
    s_waitcnt lgkmcnt(7)
    v_mfma_f32_16x16x32_bf16 v[184:187], v[68:71], a[0:3], 0
    v_lshl_add_u32 v226, v226, 14, v230
    v_and_b32 v130, 7, v130
    v_mfma_f32_16x16x32_bf16 v[200:203], v[68:71], a[8:11], 0
    s_waitcnt lgkmcnt(1)
    global_store_dwordx2 v229, v[170:171], s[50:51] sc1
    v_mfma_f32_16x16x32_bf16 v[40:43], v[68:71], a[16:19], 0
    ds_read_b128 v[68:71], v122 offset:4096
    v_xor_b32 v130, v130, v231
    v_mfma_f32_16x16x32_bf16 v[56:59], v[116:119], a[16:19], 0
    buffer_load_dwordx4 v159, s[60:63], s83 offen offset:1024 lds
    v_lshl_add_u32 v130, v130, 4, v226
    v_mfma_f32_16x16x32_bf16 v[188:191], v[72:75], a[0:3], 0
    s_cmp_eq_u32 s77, 0
    s_cselect_b32 s30, 0, s30
    s_cselect_b32 s31, 0, s31
    s_cselect_b32 s32, 0, s32
    v_mfma_f32_16x16x32_bf16 v[204:207], v[72:75], a[8:11], 0
    v_bfe_u32 v226, v152, 4, 1
    v_lshl_add_u32 v130, v226, 3, v130
    v_mfma_f32_16x16x32_bf16 v[44:47], v[72:75], a[16:19], 0
    ds_read_b128 v[72:75], v122 offset:6144
    v_mfma_f32_16x16x32_bf16 v[176:179], v[76:79], a[4:7], v[176:179]
    s_add_u32 m0, s84, 14336
    s_add_u32 s83, s73, s85
    buffer_load_dwordx4 v158, s[92:95], s83 offen lds
    v_mfma_f32_16x16x32_bf16 v[192:195], v[76:79], a[12:15], v[192:195]
    ds_read_b128 v[92:95], v124 offset:0
    v_lshrrev_b32 v167, 4, v152
    s_mov_b32 s4, 93696
    v_mfma_f32_16x16x32_bf16 v[32:35], v[76:79], a[20:23], v[32:35]
    ds_read_b128 v[76:79], v123 offset:0
    ds_read_b128 v[96:99], v125 offset:0
    v_lshl_add_u32 v166, v167, 5, s4
    v_mfma_f32_16x16x32_bf16 v[48:51], v[116:119], a[4:7], v[48:51]
    ds_read_b128 v[100:103], v124 offset:8192
    v_lshl_add_u32 v167, v167, 4, s4
    s_lshl_b32 s3, s81, 12
    v_mfma_f32_16x16x32_bf16 v[180:183], v[80:83], a[4:7], v[180:183]
    buffer_load_dwordx4 v159, s[92:95], s83 offen offset:1024 lds
    s_add_u32 s3, s3, s14
    ds_read_b128 v[104:107], v125 offset:8192
    v_mfma_f32_16x16x32_bf16 v[196:199], v[80:83], a[12:15], v[196:199]
    s_add_u32 s3, s3, 3145728
    s_lshl_b32 s4, s80, 10
    v_mfma_f32_16x16x32_bf16 v[36:39], v[80:83], a[20:23], v[36:39]
    ds_read_b128 v[80:83], v123 offset:2048
    s_add_u32 s38, s3, s4
    v_mfma_f32_16x16x32_bf16 v[52:55], v[116:119], a[12:15], v[52:55]
    s_sub_u32 s39, s3, s4
    v_mfma_f32_16x16x32_bf16 v[184:187], v[84:87], a[4:7], v[184:187]
    s_add_u32 m0, s100, 32768
    s_mov_b32 s83, s74
    buffer_load_dwordx4 v164, s[52:55], s83 offen lds
    v_mfma_f32_16x16x32_bf16 v[200:203], v[84:87], a[12:15], v[200:203]
    s_add_u32 s39, s39, 3072
    s_lshr_b32 s13, s79, 4
    v_mfma_f32_16x16x32_bf16 v[40:43], v[84:87], a[20:23], v[40:43]
    ds_read_b128 v[84:87], v123 offset:4096
    s_sub_u32 s4, 3, s13
    v_mfma_f32_16x16x32_bf16 v[56:59], v[116:119], a[20:23], v[56:59]
    buffer_load_dwordx4 v165, s[52:55], s83 offen offset:1024 lds
    s_waitcnt lgkmcnt(4)
    v_mfma_f32_16x16x32_bf16 v[108:111], v[92:95], v[92:95], 0
    s_cmp_eq_u32 s81, 0
    s_cselect_b32 s3, s4, s13
    v_mfma_f32_16x16x32_bf16 v[232:235], v[116:119], v[92:95], 0
    s_waitcnt vmcnt(18)
    ds_read_b128 a[24:27], v156 offset:6144
    ds_read_b128 a[28:31], v157 offset:6144
    v_mfma_f32_16x16x32_bf16 v[188:191], v[88:91], a[4:7], v[188:191]
    s_waitcnt vmcnt(16)
    ds_read_b128 a[32:35], v156 offset:8192
    ds_read_b128 a[36:39], v157 offset:8192
    v_mfma_f32_16x16x32_bf16 v[204:207], v[88:91], a[12:15], v[204:207]
    s_add_u32 m0, s100, 40960
    s_add_u32 s83, s74, 640
    buffer_load_dwordx4 v164, s[52:55], s83 offen lds
    v_mfma_f32_16x16x32_bf16 v[44:47], v[88:91], a[20:23], v[44:47]
    ds_read_b128 v[88:91], v123 offset:6144
    s_lshl_b32 s3, s3, 1
    v_mfma_f32_16x16x32_bf16 v[108:111], v[96:99], v[96:99], v[108:111]
    s_add_u32 s3, s3, s80
    s_lshl_b32 s40, s3, 9
    v_mfma_f32_16x16x32_bf16 v[232:235], v[116:119], v[96:99], v[232:235]
    s_waitcnt lgkmcnt(3)
    v_mfma_f32_16x16x32_bf16 v[176:179], v[60:63], a[24:27], v[176:179]
    buffer_load_dwordx4 v165, s[52:55], s83 offen offset:1024 lds
    s_waitcnt lgkmcnt(1)
    v_mfma_f32_16x16x32_bf16 v[192:195], v[60:63], a[32:35], v[192:195]
    s_waitcnt vmcnt(14)
    s_barrier
    ds_read_b128 v[60:63], v120 offset:16384
    v_mfma_f32_16x16x32_bf16 v[48:51], v[116:119], a[24:27], v[48:51]
    v_bfe_u32 v230, v152, 1, 2
    v_and_b32 v227, 1, v152
    v_mfma_f32_16x16x32_bf16 v[108:111], v[100:103], v[100:103], v[108:111]
    v_lshlrev_b32 v230, 18, v230
    v_lshl_add_u32 v227, v227, 7, v230
    v_mfma_f32_16x16x32_bf16 v[232:235], v[116:119], v[100:103], v[232:235]
    s_mov_b32 m0, s84
    s_add_u32 s83, s73, s90
    buffer_load_dwordx4 v158, s[56:59], s83 offen lds
    v_mfma_f32_16x16x32_bf16 v[180:183], v[64:67], a[24:27], v[180:183]
    s_lshl_b32 s3, s79, 13
    s_add_u32 s3, s3, s100
    v_mfma_f32_16x16x32_bf16 v[196:199], v[64:67], a[32:35], v[196:199]
    ds_read_b128 v[64:67], v120 offset:18432
    global_store_dwordx2 v212, v[208:209], s[50:51] sc1
    v_mfma_f32_16x16x32_bf16 v[52:55], v[116:119], a[32:35], v[52:55]
    s_lshl_b32 s4, s78, 8
    s_add_u32 s3, s3, s4
    v_mfma_f32_16x16x32_bf16 v[108:111], v[104:107], v[104:107], v[108:111]
    buffer_load_dwordx4 v159, s[56:59], s83 offen offset:1024 lds
    s_add_u32 s3, s3, 10485760
    v_mfma_f32_16x16x32_bf16 v[232:235], v[116:119], v[104:107], v[232:235]
    v_add_u32 v227, s3, v227
    v_mfma_f32_16x16x32_bf16 v[184:187], v[68:71], a[24:27], v[184:187]
    s_lshl_b32 s91, s79, 3
    s_add_u32 s91, s91, s78
    v_mfma_f32_16x16x32_bf16 v[200:203], v[68:71], a[32:35], v[200:203]
    ds_read_b128 v[68:71], v120 offset:20480
    s_add_u32 m0, s84, 2048
    s_add_u32 s83, s73, s90
    buffer_load_dwordx4 v158, s[60:63], s83 offen lds
    ds_read_b128 v[92:95], v124 offset:16384
    v_mfma_f32_16x16x32_bf16 v[188:191], v[72:75], a[24:27], v[188:191]
    s_lshl_b32 s91, s91, 2
    s_add_u32 s91, s91, s77
    ds_read_b128 v[96:99], v125 offset:16384
    v_mfma_f32_16x16x32_bf16 v[204:207], v[72:75], a[32:35], v[204:207]
    ds_read_b128 v[72:75], v120 offset:22528
    ds_read_b128 v[100:103], v124 offset:24576
    v_mfma_f32_16x16x32_bf16 v[176:179], v[76:79], a[28:31], v[176:179]
    s_mul_i32 s3, s91, 5120
    s_add_u32 s3, s3, 2048
    ds_read_b128 v[104:107], v125 offset:24576
    v_mfma_f32_16x16x32_bf16 v[192:195], v[76:79], a[36:39], v[192:195]
    ds_read_b128 v[76:79], v121 offset:16384
    buffer_load_dwordx4 v159, s[60:63], s83 offen offset:1024 lds
    v_mfma_f32_16x16x32_bf16 v[48:51], v[116:119], a[28:31], v[48:51]
    v_min_u32 v242, 7, v152
    v_lshl_add_u32 v242, v242, 7, s3
    v_mfma_f32_16x16x32_bf16 v[180:183], v[80:83], a[28:31], v[180:183]
    v_and_b32 v225, 15, v152
    s_lshl_b32 s3, s77, 6
    v_mfma_f32_16x16x32_bf16 v[196:199], v[80:83], a[36:39], v[196:199]
    ds_read_b128 v[80:83], v121 offset:18432
    s_add_u32 s3, s3, 93440
    v_mfma_f32_16x16x32_bf16 v[52:55], v[116:119], a[36:39], v[52:55]
    s_add_u32 m0, s100, 49152
    s_mov_b32 s83, s75
    buffer_load_dwordx4 v164, s[52:55], s83 offen lds
    s_waitcnt lgkmcnt(10)
    v_mfma_f32_16x16x32_bf16 v[184:187], v[84:87], a[28:31], v[184:187]
    v_lshl_add_u32 v225, v225, 2, s3
    v_bfe_u32 v222, v152, 1, 2
    v_mfma_f32_16x16x32_bf16 v[200:203], v[84:87], a[36:39], v[200:203]
    ds_read_b128 v[84:87], v121 offset:20480
    global_store_dwordx4 v213, v[208:211], s[50:51] offset:-2048 sc1
    s_waitcnt lgkmcnt(6)
    v_mfma_f32_16x16x32_bf16 v[108:111], v[92:95], v[92:95], v[108:111]
    s_waitcnt vmcnt(17)
    ds_read_b128 a[40:43], v156 offset:10240
    ds_read_b128 a[44:47], v157 offset:10240
    v_mfma_f32_16x16x32_bf16 v[232:235], v[116:119], v[92:95], v[232:235]
    buffer_load_dwordx4 v165, s[52:55], s83 offen offset:1024 lds
    s_waitcnt vmcnt(14)
    ds_read_b128 a[48:51], v156 offset:12288
    ds_read_b128 a[52:55], v157 offset:12288
    v_mfma_f32_16x16x32_bf16 v[188:191], v[88:91], a[28:31], v[188:191]
    s_waitcnt vmcnt(12)
    ds_read_b128 a[56:59], v156 offset:14336
    ds_read_b128 a[60:63], v157 offset:14336
    v_mfma_f32_16x16x32_bf16 v[204:207], v[88:91], a[36:39], v[204:207]
    ds_read_b128 v[88:91], v121 offset:22528
    s_lshl_b32 s3, s77, 4
    v_mfma_f32_16x16x32_bf16 v[108:111], v[96:99], v[96:99], v[108:111]
    s_add_u32 s3, s3, 93440
    v_lshl_add_u32 v222, v222, 2, s3
    v_mfma_f32_16x16x32_bf16 v[232:235], v[116:119], v[96:99], v[232:235]
    s_add_u32 m0, s100, 57344
    s_add_u32 s83, s75, 640
    buffer_load_dwordx4 v164, s[52:55], s83 offen lds
    s_waitcnt lgkmcnt(5)
    v_mfma_f32_16x16x32_bf16 v[176:179], v[60:63], a[40:43], v[176:179]
    v_and_b32 v230, 8, v152
    s_waitcnt lgkmcnt(3)
    v_mfma_f32_16x16x32_bf16 v[192:195], v[60:63], a[48:51], v[192:195]
    v_lshl_add_u32 v222, v230, 3, v222
    s_waitcnt lgkmcnt(1)
    v_mfma_f32_16x16x32_bf16 v[32:35], v[60:63], a[56:59], v[32:35]
    ds_read_b128 v[60:63], v122 offset:16384
    buffer_load_dwordx4 v165, s[52:55], s83 offen offset:1024 lds
    v_mfma_f32_16x16x32_bf16 v[48:51], v[116:119], a[40:43], v[48:51]
    s_lshl_b32 s3, s77, 12
    v_and_b32 v220, 16, v152
    v_mfma_f32_16x16x32_bf16 v[108:111], v[100:103], v[100:103], v[108:111]
    v_lshlrev_b32 v220, 2, v220
    v_xor_b32 v220, v220, v153
    v_mfma_f32_16x16x32_bf16 v[232:235], v[116:119], v[100:103], v[232:235]
    v_add_u32 v220, s3, v220
    v_bfe_u32 v230, v152, 2, 2
    v_mfma_f32_16x16x32_bf16 v[180:183], v[64:67], a[40:43], v[180:183]
    s_add_u32 m0, s84, 4096
    s_add_u32 s83, s74, s85
    buffer_load_dwordx4 v158, s[56:59], s83 offen lds
    v_mfma_f32_16x16x32_bf16 v[196:199], v[64:67], a[48:51], v[196:199]
    s_lshl_b32 s3, s77, 4
    s_add_u32 s3, s3, 92160
    v_mfma_f32_16x16x32_bf16 v[36:39], v[64:67], a[56:59], v[36:39]
    ds_read_b128 v[64:67], v122 offset:18432
    global_store_dwordx4 v213, v[208:211], s[50:51] offset:2048 sc1
    v_mfma_f32_16x16x32_bf16 v[52:55], v[116:119], a[48:51], v[52:55]
    v_lshl_add_u32 v126, v230, 6, s3
    s_lshl_b32 s3, s77, 3
    v_mfma_f32_16x16x32_bf16 v[108:111], v[104:107], v[104:107], v[108:111]
    buffer_load_dwordx4 v159, s[56:59], s83 offen offset:1024 lds
    s_add_u32 s3, s3, 92672
    v_mfma_f32_16x16x32_bf16 v[232:235], v[116:119], v[104:107], v[232:235]
    v_lshl_add_u32 v127, v230, 6, s3
    v_mfma_f32_16x16x32_bf16 v[184:187], v[68:71], a[40:43], v[184:187]
    v_bfe_u32 v230, v152, 0, 2
    v_lshl_add_u32 v126, v230, 2, v126
    v_mfma_f32_16x16x32_bf16 v[200:203], v[68:71], a[48:51], v[200:203]
    v_bfe_u32 v230, v152, 0, 1
    v_lshl_add_u32 v127, v230, 5, v127
    v_mfma_f32_16x16x32_bf16 v[40:43], v[68:71], a[56:59], v[40:43]
    ds_read_b128 v[68:71], v122 offset:20480
    s_add_u32 m0, s84, 6144
    s_add_u32 s83, s74, s85
    buffer_load_dwordx4 v158, s[60:63], s83 offen lds
    v_mfma_f32_16x16x32_bf16 v[56:59], v[116:119], a[56:59], v[56:59]
    v_bfe_u32 v230, v152, 1, 1
    v_lshl_add_u32 v127, v230, 2, v127
    v_mfma_f32_16x16x32_bf16 v[188:191], v[72:75], a[40:43], v[188:191]
    v_and_b32 v230, 15, v152
    s_lshl_b32 s3, s77, 7
    v_mfma_f32_16x16x32_bf16 v[204:207], v[72:75], a[48:51], v[204:207]
    s_add_u32 s3, s3, 81920
    v_lshl_add_u32 v154, v230, 3, s3
    v_mfma_f32_16x16x32_bf16 v[44:47], v[72:75], a[56:59], v[44:47]
    ds_read_b128 v[72:75], v122 offset:22528
    buffer_load_dwordx4 v159, s[60:63], s83 offen offset:1024 lds
    v_mfma_f32_16x16x32_bf16 v[176:179], v[76:79], a[44:47], v[176:179]
    s_waitcnt vmcnt(15)
    v_bfe_u32 v155, v152, 1, 2
    s_lshl_b32 s3, s77, 5
    v_mfma_f32_16x16x32_bf16 v[192:195], v[76:79], a[52:55], v[192:195]
    s_add_u32 s3, s3, 82432
    ds_read_b128 v[92:95], v124 offset:32768
    v_lshl_add_u32 v155, v155, 3, s3
    v_mfma_f32_16x16x32_bf16 v[32:35], v[76:79], a[60:63], v[32:35]
    ds_read_b128 v[76:79], v123 offset:16384
    s_add_u32 m0, s84, 8192
    s_add_u32 s83, s74, s85
    buffer_load_dwordx4 v158, s[92:95], s83 offen lds
    ds_read_b128 v[96:99], v125 offset:32768
    v_mfma_f32_16x16x32_bf16 v[48:51], v[116:119], a[44:47], v[48:51]
    ds_read_b128 v[100:103], v124 offset:40960
    v_not_b32 v230, v152
    v_lshlrev_b32 v230, 28, v230
    v_mfma_f32_16x16x32_bf16 v[180:183], v[80:83], a[44:47], v[180:183]
    ds_read_b128 v[104:107], v125 offset:40960
    v_and_b32 v163, 0x80000000, v230
    v_lshrrev_b32 v230, 4, v152
    v_mfma_f32_16x16x32_bf16 v[196:199], v[80:83], a[52:55], v[196:199]
    s_mov_b32 s3, 92160
    v_lshl_add_u32 v216, v230, 6, s3
    v_mfma_f32_16x16x32_bf16 v[36:39], v[80:83], a[60:63], v[36:39]
    ds_read_b128 v[80:83], v123 offset:18432
    buffer_load_dwordx4 v159, s[92:95], s83 offen offset:1024 lds
    v_mfma_f32_16x16x32_bf16 v[52:55], v[116:119], a[52:55], v[52:55]
    v_and_b32 v218, 1, v152
    s_waitcnt lgkmcnt(10)
    v_mfma_f32_16x16x32_bf16 v[184:187], v[84:87], a[44:47], v[184:187]
    v_lshl_add_u32 v217, v218, 5, v216
    v_lshlrev_b32 v218, 2, v218
    v_mfma_f32_16x16x32_bf16 v[200:203], v[84:87], a[52:55], v[200:203]
    v_lshl_add_u32 v218, v230, 8, v218
    v_and_b32 v230, 1, v230
    v_mfma_f32_16x16x32_bf16 v[40:43], v[84:87], a[60:63], v[40:43]
    ds_read_b128 v[84:87], v123 offset:20480
    s_add_u32 m0, s100, 65536
    s_mov_b32 s83, s76
    buffer_load_dwordx4 v164, s[52:55], s83 offen lds
    v_mfma_f32_16x16x32_bf16 v[56:59], v[116:119], a[60:63], v[56:59]
    v_xor_b32 v230, s77, v230
    v_lshl_add_u32 v218, v230, 6, v218
    s_waitcnt lgkmcnt(4)
    v_mfma_f32_16x16x32_bf16 v[108:111], v[92:95], v[92:95], v[108:111]
    v_bfe_u32 v230, v152, 1, 2
    v_lshl_add_u32 v218, v230, 4, v218
    v_mfma_f32_16x16x32_bf16 v[232:235], v[116:119], v[92:95], v[232:235]
    s_waitcnt vmcnt(15)
    ds_read_b128 a[64:67], v156 offset:0
    ds_read_b128 a[68:71], v157 offset:0
    v_mfma_f32_16x16x32_bf16 v[188:191], v[88:91], a[44:47], v[188:191]
    buffer_load_dwordx4 v165, s[52:55], s83 offen offset:1024 lds
    s_waitcnt vmcnt(14)
    ds_read_b128 a[72:75], v156 offset:2048
    ds_read_b128 a[76:79], v157 offset:2048
    v_mfma_f32_16x16x32_bf16 v[204:207], v[88:91], a[52:55], v[204:207]
    v_bfe_u32 v230, v152, 3, 1
    v_lshlrev_b32 v230, 12, v230
    v_mfma_f32_16x16x32_bf16 v[44:47], v[88:91], a[60:63], v[44:47]
    ds_read_b128 v[88:91], v123 offset:22528
    s_mov_b32 s3, 0
    v_mfma_f32_16x16x32_bf16 v[108:111], v[96:99], v[96:99], v[108:111]
    v_add3_u32 v218, v230, v218, s3
    v_xor_b32 v219, 8, v218
    v_mfma_f32_16x16x32_bf16 v[232:235], v[116:119], v[96:99], v[232:235]
    s_add_u32 m0, s100, 73728
    s_add_u32 s83, s76, 640
    buffer_load_dwordx4 v164, s[52:55], s83 offen lds
    s_waitcnt lgkmcnt(3)
    v_mfma_f32_16x16x32_bf16 v[176:179], v[60:63], a[64:67], v[176:179]
    s_mul_i32 s3, s79, 163840
    s_waitcnt lgkmcnt(1)
    v_mfma_f32_16x16x32_bf16 v[192:195], v[60:63], a[72:75], v[192:195]
    s_barrier
    ds_read_b128 v[60:63], v120 offset:32768
    v_mfma_f32_16x16x32_bf16 v[48:51], v[116:119], a[64:67], v[48:51]
    buffer_load_dwordx4 v165, s[52:55], s83 offen offset:1024 lds
    s_mul_i32 s4, s78, 5120
    v_mfma_f32_16x16x32_bf16 v[108:111], v[100:103], v[100:103], v[108:111]
    s_add_u32 s3, s3, s4
    s_lshl_b32 s4, s77, 10
    v_mfma_f32_16x16x32_bf16 v[232:235], v[116:119], v[100:103], v[232:235]
    s_add_u32 s36, s3, s4
    s_add_u32 s18, s36, 40960
    v_mfma_f32_16x16x32_bf16 v[180:183], v[64:67], a[64:67], v[180:183]
    s_add_u32 s19, s36, 81920
    s_add_u32 s20, s36, 122880
    v_mfma_f32_16x16x32_bf16 v[196:199], v[64:67], a[72:75], v[196:199]
    ds_read_b128 v[64:67], v120 offset:34816
    s_add_u32 m0, s84, 10240
    s_add_u32 s83, s74, s90
    buffer_load_dwordx4 v158, s[56:59], s83 offen lds
    v_mfma_f32_16x16x32_bf16 v[52:55], v[116:119], a[72:75], v[52:55]
    s_lshl_b32 s4, s81, 8
    s_add_u32 s3, s3, s4
    v_mfma_f32_16x16x32_bf16 v[108:111], v[104:107], v[104:107], v[108:111]
    s_lshl_b32 s4, s80, 3
    s_add_u32 s3, s3, s4
    v_mfma_f32_16x16x32_bf16 v[232:235], v[116:119], v[104:107], v[232:235]
    s_add_u32 s37, s3, 4096
    v_mfma_f32_16x16x32_bf16 v[184:187], v[68:71], a[64:67], v[184:187]
    buffer_load_dwordx4 v159, s[56:59], s83 offen offset:1024 lds
    s_waitcnt vmcnt(13)
    v_and_b32 v165, 15, v152
    v_mfma_f32_16x16x32_bf16 v[200:203], v[68:71], a[72:75], v[200:203]
    ds_read_b128 v[68:71], v120 offset:36864
    ds_read_b128 v[92:95], v124 offset:49152
    v_lshrrev_b32 v230, 4, v152
    v_mfma_f32_16x16x32_bf16 v[188:191], v[72:75], a[64:67], v[188:191]
    ds_read_b128 v[96:99], v125 offset:49152
    v_add_u32 v164, 1, v165
    v_and_b32 v231, 1, v164
    v_mfma_f32_16x16x32_bf16 v[204:207], v[72:75], a[72:75], v[204:207]
    ds_read_b128 v[72:75], v120 offset:38912
    ds_read_b128 v[100:103], v124 offset:57344
    v_mfma_f32_16x16x32_bf16 v[176:179], v[76:79], a[68:71], v[176:179]
    s_add_u32 m0, s84, 12288
    s_add_u32 s83, s74, s90
    buffer_load_dwordx4 v158, s[60:63], s83 offen lds
    ds_read_b128 v[104:107], v125 offset:57344
    v_mfma_f32_16x16x32_bf16 v[192:195], v[76:79], a[76:79], v[192:195]
    ds_read_b128 v[76:79], v121 offset:32768
    v_sub_u32 v164, v164, v231
    v_mfma_f32_16x16x32_bf16 v[48:51], v[116:119], a[68:71], v[48:51]
    v_mul_u32_u24 v231, 4164, v231
    v_lshl_add_u32 v164, v164, 1, v231
    v_mfma_f32_16x16x32_bf16 v[180:183], v[80:83], a[68:71], v[180:183]
    v_lshlrev_b32 v231, 4, v230
    v_sub_u32 v164, v164, v231
    v_mfma_f32_16x16x32_bf16 v[196:199], v[80:83], a[76:79], v[196:199]
    ds_read_b128 v[80:83], v121 offset:34816
    buffer_load_dwordx4 v159, s[60:63], s83 offen offset:1024 lds
    v_mfma_f32_16x16x32_bf16 v[52:55], v[116:119], a[76:79], v[52:55]
    v_lshl_add_u32 v165, v165, 5, v231
    s_waitcnt lgkmcnt(10)
    v_mfma_f32_16x16x32_bf16 v[184:187], v[84:87], a[68:71], v[184:187]
    s_lshl_b32 s3, s77, 7
    s_add_u32 s4, s3, 30256
    v_mfma_f32_16x16x32_bf16 v[200:203], v[84:87], a[76:79], v[200:203]
    ds_read_b128 v[84:87], v121 offset:36864
    s_add_u32 m0, s84, 14336
    s_add_u32 s83, s75, s85
    buffer_load_dwordx4 v158, s[56:59], s83 offen lds
    s_waitcnt lgkmcnt(6)
    v_mfma_f32_16x16x32_bf16 v[108:111], v[92:95], v[92:95], v[108:111]
    s_waitcnt vmcnt(13)
    ds_read_b128 a[80:83], v156 offset:4096
    ds_read_b128 a[84:87], v157 offset:4096
    v_mfma_f32_16x16x32_bf16 v[232:235], v[116:119], v[92:95], v[232:235]
    s_waitcnt vmcnt(11)
    ds_read_b128 a[88:91], v156 offset:6144
    ds_read_b128 a[92:95], v157 offset:6144
    v_mfma_f32_16x16x32_bf16 v[188:191], v[88:91], a[68:71], v[188:191]
    s_waitcnt vmcnt(9)
    ds_read_b128 a[96:99], v156 offset:8192
    ds_read_b128 a[100:103], v157 offset:8192
    v_mfma_f32_16x16x32_bf16 v[204:207], v[88:91], a[76:79], v[204:207]
    ds_read_b128 v[88:91], v121 offset:38912
    buffer_load_dwordx4 v159, s[56:59], s83 offen offset:1024 lds
    v_mfma_f32_16x16x32_bf16 v[108:111], v[96:99], v[96:99], v[108:111]
    s_sub_u32 s3, 26016, s3
    v_add_u32 v164, s4, v164
    v_mfma_f32_16x16x32_bf16 v[232:235], v[116:119], v[96:99], v[232:235]
    s_waitcnt lgkmcnt(5)
    v_mfma_f32_16x16x32_bf16 v[176:179], v[60:63], a[80:83], v[176:179]
    v_add_u32 v165, s3, v165
    s_waitcnt lgkmcnt(3)
    v_mfma_f32_16x16x32_bf16 v[192:195], v[60:63], a[88:91], v[192:195]
    s_mov_b32 m0, s84
    s_add_u32 s83, s75, s85
    buffer_load_dwordx4 v158, s[60:63], s83 offen lds
    s_waitcnt lgkmcnt(1)
    v_mfma_f32_16x16x32_bf16 v[32:35], v[60:63], a[96:99], v[32:35]
    ds_read_b128 v[60:63], v122 offset:32768
    s_min_u32 s4, s77, 2
    L_nonce:
    v_readfirstlane_b32 s82, v224
    s_cmp_eq_u32 s82, 0
    s_cbranch_scc1 L_nonce_re
    s_xor_b32 s8, s82, s89
    v_mov_b32 v224, s8
    s_mov_b64 exec, 1

    global_store_dword v223, v224, s[50:51] sc1
    s_mov_b64 exec, -1
    v_mfma_f32_16x16x32_bf16 v[48:51], v[116:119], a[80:83], v[48:51]
    s_mul_i32 s3, s4, 4608
    s_add_u32 s3, s3, 16384
    v_mfma_f32_16x16x32_bf16 v[108:111], v[100:103], v[100:103], v[108:111]
    v_lshl_add_u32 v173, v152, 3, s3
    s_mul_i32 s4, s4, 8320
    v_mfma_f32_16x16x32_bf16 v[232:235], v[116:119], v[100:103], v[232:235]
    buffer_load_dwordx4 v159, s[60:63], s83 offen offset:1024 lds
    s_add_u32 s4, s4, 30208
    v_mfma_f32_16x16x32_bf16 v[180:183], v[64:67], a[80:83], v[180:183]
    v_lshrrev_b32 v172, 3, v152
    v_mul_u32_u24 v172, 4132, v172
    v_mfma_f32_16x16x32_bf16 v[196:199], v[64:67], a[88:91], v[196:199]
    v_lshl_add_u32 v172, v152, 2, v172
    v_add_u32 v172, s4, v172
    v_mfma_f32_16x16x32_bf16 v[36:39], v[64:67], a[96:99], v[36:39]
    ds_read_b128 v[64:67], v122 offset:34816
    s_and_b32 s3, s79, 1
    v_mfma_f32_16x16x32_bf16 v[52:55], v[116:119], a[88:91], v[52:55]
    s_lshl_b32 s3, s3, 4
    s_lshr_b32 s35, s35, s3
    v_mfma_f32_16x16x32_bf16 v[108:111], v[104:107], v[104:107], v[108:111]
    s_lshl_b32 s35, s35, 16
    s_lshl_b32 s3, s81, 4
    v_mfma_f32_16x16x32_bf16 v[232:235], v[116:119], v[104:107], v[232:235]
    s_lshr_b32 s34, s34, s3
    v_mfma_f32_16x16x32_bf16 v[184:187], v[68:71], a[80:83], v[184:187]
    global_load_dword a255, v112, s[26:27]
    s_lshl_b32 s34, s34, 16
    v_mfma_f32_16x16x32_bf16 v[200:203], v[68:71], a[88:91], v[200:203]
    s_mov_b64 s[68:69], s[50:51]
    s_mov_b32 s70, 5767168
    v_mfma_f32_16x16x32_bf16 v[40:43], v[68:71], a[96:99], v[40:43]
    ds_read_b128 v[68:71], v122 offset:36864
    global_load_dword a255, v112, s[28:29]
    v_mfma_f32_16x16x32_bf16 v[56:59], v[116:119], a[96:99], v[56:59]
    s_mov_b64 s[64:65], s[46:47]
    s_mov_b32 s66, 5242880
    v_add_u32 v124, 0x10000, v124
    v_mfma_f32_16x16x32_bf16 v[188:191], v[72:75], a[80:83], v[188:191]
    s_add_u32 m0, s84, 2048
    s_add_u32 s83, s75, s85
    buffer_load_dwordx4 v158, s[92:95], s83 offen lds
    v_add_u32 v125, 0x10000, v125
    v_mfma_f32_16x16x32_bf16 v[204:207], v[72:75], a[88:91], v[204:207]
    s_waitcnt vmcnt(12)
    v_mov_b64 v[228:229], 0
    v_mfma_f32_16x16x32_bf16 v[44:47], v[72:75], a[96:99], v[44:47]
    ds_read_b128 v[72:75], v122 offset:38912
    ds_read_b128 v[92:95], v124 offset:0
    v_mfma_f32_16x16x32_bf16 v[176:179], v[76:79], a[84:87], v[176:179]
    buffer_load_dwordx4 v159, s[92:95], s83 offen offset:1024 lds
    ds_read_b128 v[96:99], v125 offset:0
    v_mfma_f32_16x16x32_bf16 v[192:195], v[76:79], a[92:95], v[192:195]
    ds_read_b128 v[100:103], v124 offset:8192
    v_mfma_f32_16x16x32_bf16 v[32:35], v[76:79], a[100:103], v[32:35]
    ds_read_b128 v[76:79], v123 offset:32768
    ds_read_b128 v[104:107], v125 offset:8192
    v_mfma_f32_16x16x32_bf16 v[48:51], v[116:119], a[84:87], v[48:51]
    ds_read_b128 v[142:145], v128
    v_mfma_f32_16x16x32_bf16 v[180:183], v[80:83], a[84:87], v[180:183]
    s_add_u32 m0, s84, 4096
    s_add_u32 s83, s76, s85
    buffer_load_dwordx4 v158, s[56:59], s83 offen lds
    ds_read_b128 v[146:149], v129
    v_mfma_f32_16x16x32_bf16 v[196:199], v[80:83], a[92:95], v[196:199]
    ds_read_b64 v[150:151], v130
    v_mfma_f32_16x16x32_bf16 v[36:39], v[80:83], a[100:103], v[36:39]
    ds_read_b128 v[80:83], v123 offset:34816
    v_mfma_f32_16x16x32_bf16 v[52:55], v[116:119], a[92:95], v[52:55]
    s_waitcnt lgkmcnt(7)
    v_mfma_f32_16x16x32_bf16 v[108:111], v[92:95], v[92:95], v[108:111]
    buffer_load_dwordx4 v159, s[56:59], s83 offen offset:1024 lds
    v_mfma_f32_16x16x32_bf16 v[232:235], v[116:119], v[92:95], v[232:235]
    v_mfma_f32_16x16x32_bf16 v[184:187], v[84:87], a[84:87], v[184:187]
    v_mfma_f32_16x16x32_bf16 v[200:203], v[84:87], a[92:95], v[200:203]
    v_mfma_f32_16x16x32_bf16 v[40:43], v[84:87], a[100:103], v[40:43]
    ds_read_b128 v[84:87], v123 offset:36864
    s_add_u32 m0, s84, 6144
    s_add_u32 s83, s76, s85
    buffer_load_dwordx4 v158, s[60:63], s83 offen lds
    v_mfma_f32_16x16x32_bf16 v[56:59], v[116:119], a[100:103], v[56:59]
    s_waitcnt lgkmcnt(2)
    ds_read_b128 v[0:3], v166 offset:0
    ds_read_b128 v[4:7], v166 offset:16
    v_mfma_f32_16x16x32_bf16 v[108:111], v[96:99], v[96:99], v[108:111]
    ds_read_b128 v[8:11], v166 offset:128
    ds_read_b128 v[12:15], v166 offset:144
    ds_read_b128 v[16:19], v167 offset:256
    v_mfma_f32_16x16x32_bf16 v[232:235], v[116:119], v[96:99], v[232:235]
    s_waitcnt vmcnt(14)
    ds_read_b128 a[104:107], v156 offset:10240
    ds_read_b128 a[108:111], v157 offset:10240
    v_mfma_f32_16x16x32_bf16 v[188:191], v[88:91], a[84:87], v[188:191]
    buffer_load_dwordx4 v159, s[60:63], s83 offen offset:1024 lds
    s_waitcnt vmcnt(13)
    ds_read_b128 a[112:115], v156 offset:12288
    ds_read_b128 a[116:119], v157 offset:12288
    v_mfma_f32_16x16x32_bf16 v[204:207], v[88:91], a[92:95], v[204:207]
    v_lshlrev_b32 v132, 16, v142
    v_and_b32 v133, s86, v142
    v_mfma_f32_16x16x32_bf16 v[44:47], v[88:91], a[100:103], v[44:47]
    ds_read_b128 v[88:91], v123 offset:38912
    v_lshlrev_b32 v134, 16, v143
    v_mfma_f32_16x16x32_bf16 v[108:111], v[100:103], v[100:103], v[108:111]
    s_add_u32 m0, s84, 8192
    s_add_u32 s83, s76, s85
    buffer_load_dwordx4 v158, s[92:95], s83 offen lds
    v_mfma_f32_16x16x32_bf16 v[232:235], v[116:119], v[100:103], v[232:235]
    v_and_b32 v135, s86, v143
    s_waitcnt lgkmcnt(3)
    v_mfma_f32_16x16x32_bf16 v[176:179], v[60:63], a[104:107], v[176:179]
    v_lshlrev_b32 v136, 16, v144
    v_and_b32 v137, s86, v144
    s_waitcnt lgkmcnt(1)
    v_mfma_f32_16x16x32_bf16 v[192:195], v[60:63], a[112:115], v[192:195]
    s_waitcnt lgkmcnt(0)
    s_barrier
    ds_read_b128 v[60:63], v120 offset:49152
    v_mfma_f32_16x16x32_bf16 v[48:51], v[116:119], a[104:107], v[48:51]
    buffer_load_dwordx4 v159, s[92:95], s83 offen offset:1024 lds
    v_lshlrev_b32 v138, 16, v145
    v_and_b32 v139, s86, v145
    v_mfma_f32_16x16x32_bf16 v[108:111], v[104:107], v[104:107], v[108:111]
    v_lshlrev_b32 v140, 16, v146
    v_and_b32 v141, s86, v146
    v_mfma_f32_16x16x32_bf16 v[232:235], v[116:119], v[104:107], v[232:235]
    v_lshlrev_b32 v142, 16, v147
    v_and_b32 v143, s86, v147
    v_mfma_f32_16x16x32_bf16 v[180:183], v[64:67], a[104:107], v[180:183]
    v_lshlrev_b32 v144, 16, v148
    v_and_b32 v145, s86, v148
    v_mfma_f32_16x16x32_bf16 v[196:199], v[64:67], a[112:115], v[196:199]
    ds_read_b128 v[64:67], v120 offset:51200
    s_add_u32 m0, s84, 10240
    s_add_u32 s83, s75, s90
    buffer_load_dwordx4 v158, s[56:59], s83 offen lds
    v_mfma_f32_16x16x32_bf16 v[52:55], v[116:119], a[112:115], v[52:55]
    s_mov_b32 vcc_lo, 0xaaaaaaaa
    s_mov_b32 vcc_hi, 0xaaaaaaaa
    v_cndmask_b32 v108, v108, v109, vcc
    v_cndmask_b32 v110, v110, v111, vcc
    v_mfma_f32_16x16x32_bf16 v[184:187], v[68:71], a[104:107], v[184:187]
    s_mov_b32 vcc_lo, 0xcccccccc
    s_mov_b32 vcc_hi, 0xcccccccc
    v_cndmask_b32 v108, v108, v110, vcc
    v_mfma_f32_16x16x32_bf16 v[200:203], v[68:71], a[112:115], v[200:203]
    ds_read_b128 v[68:71], v120 offset:53248
    s_mov_b32 vcc_lo, 0x00f0000f
    s_mov_b32 vcc_hi, 0xf0000f00
    v_cndmask_b32 v108, 0, v108, vcc
    v_mfma_f32_16x16x32_bf16 v[188:191], v[72:75], a[104:107], v[188:191]
    buffer_load_dwordx4 v159, s[56:59], s83 offen offset:1024 lds
    v_mov_b32 v109, v108
    s_nop 1
    v_permlane32_swap_b32 v108, v109
    v_mfma_f32_16x16x32_bf16 v[204:207], v[72:75], a[112:115], v[204:207]
    ds_read_b128 v[72:75], v120 offset:55296
    v_add_f32 v108, v108, v109
    v_mov_b32 v109, v108
    v_mfma_f32_16x16x32_bf16 v[176:179], v[76:79], a[108:111], v[176:179]
    s_nop 0
    v_permlane16_swap_b32 v108, v109
    v_add_f32 v108, v108, v109
    v_mfma_f32_16x16x32_bf16 v[192:195], v[76:79], a[116:119], v[192:195]
    ds_read_b128 v[76:79], v121 offset:49152
    s_waitcnt vmcnt(15)
    ds_read_b128 a[120:123], v156 offset:14336
    ds_read_b128 a[124:127], v157 offset:14336
    v_mul_f32 v232, 0x3acccccd, v232
    v_mul_f32 v108, 0x3acccccd, v108
    v_mfma_f32_16x16x32_bf16 v[48:51], v[116:119], a[108:111], v[48:51]
    s_add_u32 m0, s84, 12288
    s_add_u32 s83, s75, s90
    buffer_load_dwordx4 v158, s[60:63], s83 offen lds
    v_fma_f32 v108, -v232, v232, v108
    v_max_f32 v108, 0, v108
    v_mfma_f32_16x16x32_bf16 v[180:183], v[80:83], a[108:111], v[180:183]
    v_cvt_pk_bf16_f32 v232, 0, v232
    v_cvt_pk_bf16_f32 v108, 0, v108
    v_mfma_f32_16x16x32_bf16 v[196:199], v[80:83], a[116:119], v[196:199]
    ds_read_b128 v[80:83], v121 offset:51200
    v_add_f32 v108, 0x3727c5ac, v108
    v_cvt_pk_bf16_f32 v108, 0, v108
    v_mfma_f32_16x16x32_bf16 v[52:55], v[116:119], a[116:119], v[52:55]
    buffer_load_dwordx4 v159, s[60:63], s83 offen offset:1024 lds
    s_waitcnt vmcnt(14)
    ds_read_b128 a[128:131], v156 offset:0
    ds_read_b128 a[132:135], v157 offset:0
    v_sqrt_f32 v108, v108
    v_xor_b32 v233, 0x80000000, v232
    v_mfma_f32_16x16x32_bf16 v[184:187], v[84:87], a[108:111], v[184:187]
    s_waitcnt vmcnt(10)
    ds_read_b128 a[136:139], v156 offset:2048
    ds_read_b128 a[140:143], v157 offset:2048
    v_cvt_pk_bf16_f32 v108, 0, v108
    v_rcp_f32 v108, v108
    v_mfma_f32_16x16x32_bf16 v[200:203], v[84:87], a[116:119], v[200:203]
    ds_read_b128 v[84:87], v121 offset:53248
    v_lshlrev_b32 v146, 16, v149
    v_and_b32 v147, s86, v149
    v_mfma_f32_16x16x32_bf16 v[188:191], v[88:91], a[108:111], v[188:191]
    v_lshlrev_b32 v148, 16, v150
    v_and_b32 v149, s86, v150
    v_mfma_f32_16x16x32_bf16 v[204:207], v[88:91], a[116:119], v[204:207]
    ds_read_b128 v[88:91], v121 offset:55296
    s_waitcnt lgkmcnt(7)
    s_add_u32 m0, s84, 14336
    s_add_u32 s83, s76, s90
    buffer_load_dwordx4 v158, s[56:59], s83 offen lds
    v_mfma_f32_16x16x32_bf16 v[176:179], v[60:63], a[120:123], v[176:179]
    v_lshlrev_b32 v150, 16, v151
    v_and_b32 v151, s86, v151
    s_waitcnt lgkmcnt(4)
    v_mfma_f32_16x16x32_bf16 v[192:195], v[60:63], a[128:131], v[192:195]
    v_add_f32 v132, v233, v132
    s_waitcnt lgkmcnt(2)
    v_mfma_f32_16x16x32_bf16 v[32:35], v[60:63], a[136:139], v[32:35]
    v_add_u32 v120, 0x10000, v120
    v_add_u32 v121, 0x10000, v121
    ds_read_b128 v[60:63], v120 offset:0
    v_add_f32 v133, v233, v133
    v_add_f32 v134, v233, v134
    v_mfma_f32_16x16x32_bf16 v[48:51], v[116:119], a[120:123], v[48:51]
    buffer_load_dwordx4 v159, s[56:59], s83 offen offset:1024 lds
    v_add_f32 v135, v233, v135
    v_add_f32 v136, v233, v136
    v_mfma_f32_16x16x32_bf16 v[180:183], v[64:67], a[120:123], v[180:183]
    v_add_f32 v137, v233, v137
    v_add_f32 v138, v233, v138
    v_mfma_f32_16x16x32_bf16 v[196:199], v[64:67], a[128:131], v[196:199]
    v_add_f32 v139, v233, v139
    v_add_f32 v140, v233, v140
    v_mfma_f32_16x16x32_bf16 v[36:39], v[64:67], a[136:139], v[36:39]
    ds_read_b128 v[64:67], v121 offset:0
    v_add_f32 v141, v233, v141
    v_add_f32 v142, v233, v142
    v_mfma_f32_16x16x32_bf16 v[52:55], v[116:119], a[128:131], v[52:55]
    s_mov_b32 m0, s84
    s_add_u32 s83, s76, s90
    buffer_load_dwordx4 v158, s[60:63], s83 offen lds
    v_mfma_f32_16x16x32_bf16 v[184:187], v[68:71], a[120:123], v[184:187]
    v_add_f32 v143, v233, v143
    v_add_f32 v144, v233, v144
    v_mfma_f32_16x16x32_bf16 v[200:203], v[68:71], a[128:131], v[200:203]
    v_add_f32 v145, v233, v145
    v_add_f32 v146, v233, v146
    v_mfma_f32_16x16x32_bf16 v[40:43], v[68:71], a[136:139], v[40:43]
    ds_read_b128 v[68:71], v120 offset:2048
    v_add_f32 v147, v233, v147
    v_add_f32 v148, v233, v148
    v_mfma_f32_16x16x32_bf16 v[56:59], v[116:119], a[136:139], v[56:59]
    buffer_load_dwordx4 v159, s[60:63], s83 offen offset:1024 lds
    v_add_f32 v149, v233, v149
    v_add_f32 v150, v233, v150
    v_mfma_f32_16x16x32_bf16 v[188:191], v[72:75], a[120:123], v[188:191]
    s_mov_b64 s[56:57], s[26:27]
    s_sub_u32 s60, s28, 2048
    s_subb_u32 s61, s29, 0
    v_mfma_f32_16x16x32_bf16 v[204:207], v[72:75], a[128:131], v[204:207]
    s_mov_b32 s62, 821248
    v_bfe_u32 v230, v152, 4, 1
    v_lshlrev_b32 v159, 1, v230
    v_mfma_f32_16x16x32_bf16 v[44:47], v[72:75], a[136:139], v[44:47]
    ds_read_b128 v[72:75], v121 offset:2048
    s_add_u32 s83, s12, s15
    v_add_u32 v175, s83, v153
    global_load_dwordx4 v[252:255], v175, s[42:43]
    v_and_b32 v231, 3, v152
    v_xor_b32 v159, v159, v231
    v_mfma_f32_16x16x32_bf16 v[176:179], v[76:79], a[124:127], v[176:179]
    v_lshrrev_b32 v231, 5, v152
    v_lshl_add_u32 v159, v231, 2, v159
    s_mul_i32 s3, s78, 102400
    s_mul_i32 s4, s77, 320
    s_add_u32 s3, s3, s4
    v_mfma_f32_16x16x32_bf16 v[192:195], v[76:79], a[132:135], v[192:195]
    s_waitcnt vmcnt(13)
    ds_read_b128 a[160:163], v156 offset:4096
    ds_read_b128 a[164:167], v157 offset:4096
    v_lshl_add_u32 v159, v159, 4, s3
    v_bfe_u32 v231, v152, 2, 2
    v_mfma_f32_16x16x32_bf16 v[32:35], v[76:79], a[140:143], v[32:35]
    ds_read_b128 v[76:79], v120 offset:4096
    v_lshl_add_u32 v231, v230, 3, v231
    s_movk_i32 s4, 1280
    v_mad_u32_u24 v159, v231, s4, v159
    s_movk_i32 s4, 10240
    v_mfma_f32_16x16x32_bf16 v[48:51], v[116:119], a[124:127], v[48:51]
    v_mad_u32_u24 v158, v230, s4, v159
    s_lshl_b32 s3, s79, 4
    s_and_b32 s3, s3, 128
    s_lshl_b32 s4, s80, 6
    v_mfma_f32_16x16x32_bf16 v[180:183], v[80:83], a[124:127], v[180:183]
    s_add_u32 s16, s3, s4
    s_xor_b32 s17, s16, 128
    s_lshl_b32 s4, s4, 2
    v_mfma_f32_16x16x32_bf16 v[196:199], v[80:83], a[132:135], v[196:199]
    s_xor_b32 s44, s4, 256
    s_add_u32 s83, s12, s14
    v_add_u32 v175, s83, v153
    global_load_dwordx4 v[244:247], v175, s[42:43]
    v_add_f32 v151, v233, v151
    v_fma_f32 v0, v0, v108, 1.0
    v_mfma_f32_16x16x32_bf16 v[36:39], v[80:83], a[140:143], v[36:39]
    ds_read_b128 v[80:83], v121 offset:4096
    s_add_u32 s83, s12, s14
    v_add_u32 v175, s83, v153
    v_add_u32 v175, 4096, v175
    global_load_dwordx4 v[248:251], v175, s[42:43]
    v_fma_f32 v1, v1, v108, 1.0
    v_fma_f32 v2, v2, v108, 1.0
    v_mfma_f32_16x16x32_bf16 v[52:55], v[116:119], a[132:135], v[52:55]
    global_load_dword v224, v169, s[50:51] sc1
    v_fma_f32 v3, v3, v108, 1.0
    v_fma_f32 v4, v4, v108, 1.0
    s_waitcnt lgkmcnt(8)
    v_mfma_f32_16x16x32_bf16 v[184:187], v[84:87], a[124:127], v[184:187]
    global_load_dwordx2 v[170:171], v168, s[50:51] sc1
    v_fma_f32 v5, v5, v108, 1.0
    v_fma_f32 v6, v6, v108, 1.0
    v_mfma_f32_16x16x32_bf16 v[200:203], v[84:87], a[132:135], v[200:203]
    s_waitcnt vmcnt(15)
    ds_read_b128 a[168:171], v156 offset:6144
    ds_read_b128 a[172:175], v157 offset:6144
    global_load_dword a255, v227, s[50:51] sc1
    v_mfma_f32_16x16x32_bf16 v[40:43], v[84:87], a[140:143], v[40:43]
    ds_read_b128 v[84:87], v120 offset:6144
    v_fma_f32 v7, v7, v108, 1.0
    v_fma_f32 v8, v8, v108, 1.0
    v_mfma_f32_16x16x32_bf16 v[56:59], v[116:119], a[140:143], v[56:59]
    s_waitcnt vmcnt(14)
    ds_read_b128 a[176:179], v156 offset:8192
    ds_read_b128 a[180:183], v157 offset:8192
    global_load_dword a255, v242, s[46:47] offset:-2048
    v_mfma_f32_16x16x32_bf16 v[188:191], v[88:91], a[124:127], v[188:191]
    v_fma_f32 v9, v9, v108, 1.0
    v_fma_f32 v10, v10, v108, 1.0
    v_mfma_f32_16x16x32_bf16 v[204:207], v[88:91], a[132:135], v[204:207]
    v_fma_f32 v11, v11, v108, 1.0
    v_fma_f32 v12, v12, v108, 1.0
    v_mfma_f32_16x16x32_bf16 v[44:47], v[88:91], a[140:143], v[44:47]
    ds_read_b128 v[88:91], v121 offset:6144
    s_waitcnt lgkmcnt(8)
    v_mfma_f32_16x16x32_bf16 v[176:179], v[60:63], a[160:163], v[176:179]
    ds_read_b64 v[112:113], v154 offset:7680
    global_load_dword a255, v242, s[46:47] offset:-1024
    v_fma_f32 v13, v13, v108, 1.0
    v_fma_f32 v14, v14, v108, 1.0
    s_waitcnt lgkmcnt(5)
    v_mfma_f32_16x16x32_bf16 v[192:195], v[60:63], a[168:171], v[192:195]
    ds_read_b64 v[114:115], v155 offset:7680
    v_fma_f32 v15, v15, v108, 1.0
    v_fma_f32 v16, v16, v108, 1.0
    s_waitcnt lgkmcnt(3)
    v_mfma_f32_16x16x32_bf16 v[32:35], v[60:63], a[176:179], v[32:35]
    ds_read_b128 v[60:63], v122 offset:49152
    ds_read_b64 v[100:101], v154 offset:8320
    v_fma_f32 v17, v17, v108, 1.0
    v_fma_f32 v18, v18, v108, 1.0
    v_mfma_f32_16x16x32_bf16 v[48:51], v[116:119], a[160:163], v[48:51]
    ds_read_b64 v[102:103], v154 offset:8960
    v_fma_f32 v19, v19, v108, 1.0
    v_mul_f32 v132, v0, v132
    v_mfma_f32_16x16x32_bf16 v[176:179], v[64:67], a[164:167], v[176:179]
    ds_read_b64 v[104:105], v155 offset:8320
    global_load_dword a255, v242, s[46:47] offset:0
    v_mul_f32 v133, v1, v133
    v_mul_f32 v134, v2, v134
    v_mfma_f32_16x16x32_bf16 v[192:195], v[64:67], a[172:175], v[192:195]
    ds_read_b64 v[106:107], v155 offset:8960
    v_mul_f32 v135, v3, v135
    v_mul_f32 v136, v4, v136
    v_mfma_f32_16x16x32_bf16 v[32:35], v[64:67], a[180:183], v[32:35]
    ds_read_b128 v[64:67], v122 offset:51200
    v_mul_f32 v137, v5, v137
    v_mul_f32 v138, v6, v138
    v_mfma_f32_16x16x32_bf16 v[48:51], v[116:119], a[164:167], v[48:51]
    v_mul_f32 v139, v7, v139
    v_mul_f32 v140, v8, v140
    v_mfma_f32_16x16x32_bf16 v[180:183], v[68:71], a[160:163], v[180:183]
    s_nop 0
    ds_write_b128 v220, v[32:35] offset:0
    global_load_dword a255, v242, s[46:47] offset:1024
    v_mul_f32 v141, v9, v141
    v_mul_f32 v142, v10, v142
    v_mfma_f32_16x16x32_bf16 v[196:199], v[68:71], a[168:171], v[196:199]
    s_waitcnt vmcnt(16)
    ds_read_b128 a[144:147], v156 offset:10240
    ds_read_b128 a[148:151], v157 offset:10240
    v_mfma_f32_16x16x32_bf16 v[36:39], v[68:71], a[176:179], v[36:39]
    ds_read_b128 v[68:71], v122 offset:53248
    v_mul_f32 v143, v11, v143
    v_mul_f32 v144, v12, v144
    v_mfma_f32_16x16x32_bf16 v[52:55], v[116:119], a[168:171], v[52:55]
    v_mul_f32 v145, v13, v145
    v_mul_f32 v146, v14, v146
    v_mfma_f32_16x16x32_bf16 v[180:183], v[72:75], a[164:167], v[180:183]
    s_mov_b64 exec, 0xffff
    ds_write_b32 v126, v232 offset:1024
    ds_write2st64_b32 v126, v233, v108 offset1:1
    ds_write2st64_b32 v127, v233, v108 offset1:1
    s_mov_b64 exec, -1
    v_mfma_f32_16x16x32_bf16 v[196:199], v[72:75], a[172:175], v[196:199]
    s_waitcnt lgkmcnt(13)
    global_load_dword a255, v242, s[46:47] offset:2048
    v_mul_f32 v147, v15, v147
    v_mul_f32 v148, v16, v148
    v_mfma_f32_16x16x32_bf16 v[36:39], v[72:75], a[180:183], v[36:39]
    ds_read_b128 v[72:75], v122 offset:55296
    v_mul_f32 v149, v17, v149
    v_mul_f32 v150, v18, v150
    v_mfma_f32_16x16x32_bf16 v[52:55], v[116:119], a[172:175], v[52:55]
    v_mul_f32 v151, v19, v151
    v_xor_b32 v115, v163, v115
    v_mfma_f32_16x16x32_bf16 v[184:187], v[76:79], a[160:163], v[184:187]
    s_waitcnt vmcnt(15)
    ds_read_b128 a[152:155], v156 offset:12288
    ds_read_b128 a[156:159], v157 offset:12288
    v_mfma_f32_16x16x32_bf16 v[200:203], v[76:79], a[168:171], v[200:203]
    ds_write_b128 v220, v[36:39] offset:1024
    s_waitcnt lgkmcnt(12)
    v_xor_b32 v105, v163, v105
    v_xor_b32 v107, v163, v107
    v_mfma_f32_16x16x32_bf16 v[40:43], v[76:79], a[176:179], v[40:43]
    ds_read_b128 v[76:79], v123 offset:49152
    v_mfma_f32_16x16x32_bf16 v[56:59], v[116:119], a[176:179], v[56:59]
    v_mfma_f32_16x16x32_bf16 v[184:187], v[80:83], a[164:167], v[184:187]
    v_mfma_f32_16x16x32_bf16 v[200:203], v[80:83], a[172:175], v[200:203]
    v_mfma_f32_16x16x32_bf16 v[40:43], v[80:83], a[180:183], v[40:43]
    ds_read_b128 v[80:83], v123 offset:51200
    v_mfma_f32_16x16x32_bf16 v[56:59], v[116:119], a[180:183], v[56:59]
    v_mfma_f32_16x16x32_bf16 v[188:191], v[84:87], a[160:163], v[188:191]
    s_waitcnt vmcnt(13)
    ds_read_b128 a[184:187], v156 offset:14336
    ds_read_b128 a[188:191], v157 offset:14336
    v_mfma_f32_16x16x32_bf16 v[204:207], v[84:87], a[168:171], v[204:207]
    s_nop 0
    ds_write_b128 v220, v[40:43] offset:2048
    v_mfma_f32_16x16x32_bf16 v[44:47], v[84:87], a[176:179], v[44:47]
    ds_read_b128 v[84:87], v123 offset:53248
    v_mfma_f32_16x16x32_bf16 v[188:191], v[88:91], a[164:167], v[188:191]
    v_mfma_f32_16x16x32_bf16 v[204:207], v[88:91], a[172:175], v[204:207]
    v_mfma_f32_16x16x32_bf16 v[44:47], v[88:91], a[180:183], v[44:47]
    ds_read_b128 v[88:91], v123 offset:55296
    s_waitcnt lgkmcnt(15)
    v_mfma_f32_16x16x32_bf16 v[176:179], v[60:63], a[144:147], v[176:179]
    s_waitcnt lgkmcnt(8)
    v_mfma_f32_16x16x32_bf16 v[192:195], v[60:63], a[152:155], v[192:195]
    v_add_u32 v122, 0x10000, v122
    v_add_u32 v123, 0x10000, v123
    ds_read_b128 v[60:63], v122 offset:0
    ds_write_b128 v220, v[44:47] offset:3072
    v_mfma_f32_16x16x32_bf16 v[48:51], v[116:119], a[144:147], v[48:51]
    s_waitcnt vmcnt(11)
    ds_read_b128 a[192:195], v156 offset:0
    ds_read_b128 a[196:199], v157 offset:0
    v_mfma_f32_16x16x32_bf16 v[180:183], v[64:67], a[144:147], v[180:183]
    v_and_b32 v226, 3, v152
    v_lshl_add_u32 v156, v226, 6, s84
    v_mfma_f32_16x16x32_bf16 v[196:199], v[64:67], a[152:155], v[196:199]
    ds_read_b128 v[64:67], v123 offset:0
    s_mov_b64 exec, 0xffff
    ds_write_b32 v225, v56
    s_mov_b64 exec, -1
    v_bfe_u32 v226, v152, 2, 1
    v_lshl_add_u32 v156, v226, 10, v156
    v_mfma_f32_16x16x32_bf16 v[52:55], v[116:119], a[152:155], v[52:55]
    v_bfe_u32 v226, v152, 3, 1
    v_lshl_add_u32 v156, v226, 8, v156
    v_mfma_f32_16x16x32_bf16 v[184:187], v[68:71], a[144:147], v[184:187]
    v_lshlrev_b32 v226, 1, v226
    v_bfe_u32 v221, v152, 4, 1
    v_mfma_f32_16x16x32_bf16 v[200:203], v[68:71], a[152:155], v[200:203]
    ds_read_b128 v[68:71], v122 offset:2048
    v_xor_b32 v226, v226, v221
    v_lshl_add_u32 v156, v226, 4, v156
    v_mfma_f32_16x16x32_bf16 v[188:191], v[72:75], a[144:147], v[188:191]
    v_lshrrev_b32 v226, 5, v152
    v_lshl_add_u32 v156, v226, 11, v156
    v_mfma_f32_16x16x32_bf16 v[204:207], v[72:75], a[152:155], v[204:207]
    ds_read_b128 v[72:75], v123 offset:2048
    v_xor_b32 v157, 32, v156
    s_waitcnt lgkmcnt(13)
    v_mfma_f32_16x16x32_bf16 v[176:179], v[76:79], a[148:151], v[176:179]
    s_lshl_b32 s3, s78, 2
    s_add_u32 s3, s3, s77
    s_lshl_b32 s3, s3, 13
    s_waitcnt lgkmcnt(0)
    s_barrier
    v_mfma_f32_16x16x32_bf16 v[192:195], v[76:79], a[156:159], v[192:195]
    ds_read_b128 v[76:79], v122 offset:4096
    s_add_u32 s3, s3, 9437184
    ds_read2st64_b32 v[16:17], v218 offset0:0 offset1:32
    v_mov_b32 v36, s30
    v_mfma_f32_16x16x32_bf16 v[48:51], v[116:119], a[148:151], v[48:51]
    s_add_u32 s92, s50, s3
    s_addc_u32 s93, s51, 0
    s_movk_i32 s94, 8192
    s_waitcnt vmcnt(9)
    v_mov_b32_dpp v36, v247 wave_shr:1 row_mask:0xf bank_mask:0xf
    v_alignbit_b32 v33, v245, v244, 16
    v_mfma_f32_16x16x32_bf16 v[180:183], v[80:83], a[148:151], v[180:183]
    s_sub_u32 s21, 31, s79
    s_lshl_b32 s21, s21, 8
    ds_read2st64_b32 v[18:19], v219 offset0:0 offset1:32
    v_alignbit_b32 v34, v246, v245, 16
    v_alignbit_b32 v35, v247, v246, 16
    v_mfma_f32_16x16x32_bf16 v[196:199], v[80:83], a[156:159], v[196:199]
    ds_read_b128 v[80:83], v123 offset:4096
    v_alignbit_b32 v32, v244, v36, 16
    v_mov_b32 v40, s31
    v_mfma_f32_16x16x32_bf16 v[52:55], v[116:119], a[156:159], v[52:55]
    ds_read2st64_b32 v[20:21], v218 offset0:4 offset1:36
    s_waitcnt vmcnt(8)
    v_mov_b32_dpp v40, v251 wave_shr:1 row_mask:0xf bank_mask:0xf
    v_alignbit_b32 v37, v249, v248, 16
    v_mfma_f32_16x16x32_bf16 v[184:187], v[84:87], a[148:151], v[184:187]
    s_waitcnt vmcnt(6)
    L_kf:
    v_xor_b32 v224, s82, v224
    v_xor_b32 v170, s82, v170
    v_xor_b32 v171, s82, v171
    v_max3_u32 v170, v170, v171, v224
    v_cmp_lt_u32 vcc, 7, v170
    s_cbranch_vccnz L_kf_re
    v_cmp_ne_u32 vcc, s89, v224
    s_lshl_b32 s5, s77, 10
    s_cmp_eq_u32 vcc_hi, 0
    s_cselect_b32 s88, 1, 0

    s_add_u32 m0, s5, 26112
    s_add_u32 s83, s5, s15
    buffer_load_dwordx4 v153, s[68:71], s83 offen sc1 lds
    v_alignbit_b32 v38, v250, v249, 16
    v_alignbit_b32 v39, v251, v250, 16
    v_mfma_f32_16x16x32_bf16 v[200:203], v[84:87], a[156:159], v[200:203]
    ds_read_b128 v[84:87], v122 offset:6144
    ds_read2st64_b32 v[22:23], v219 offset0:4 offset1:36
    v_alignbit_b32 v36, v248, v40, 16
    v_mov_b32 v44, s32
    v_mfma_f32_16x16x32_bf16 v[188:191], v[88:91], a[148:151], v[188:191]
    s_nop 0
    v_mov_b32_dpp v44, v255 wave_shr:1 row_mask:0xf bank_mask:0xf
    v_alignbit_b32 v41, v253, v252, 16
    v_mfma_f32_16x16x32_bf16 v[204:207], v[88:91], a[156:159], v[204:207]
    ds_read_b128 v[88:91], v123 offset:6144
    ds_read2st64_b32 v[24:25], v218 offset0:8 offset1:40
    v_alignbit_b32 v42, v254, v253, 16
    v_alignbit_b32 v43, v255, v254, 16
    v_mfma_f32_16x16x32_bf16 v[176:179], v[60:63], a[184:187], v[176:179]
    s_add_u32 m0, s5, 16896
    s_add_u32 s83, s5, s14
    buffer_load_dwordx4 v153, s[68:71], s83 offen sc1 lds
    v_alignbit_b32 v40, v252, v44, 16
    v_mfma_f32_16x16x32_bf16 v[192:195], v[60:63], a[192:195], v[192:195]
    ds_read2st64_b32 v[26:27], v219 offset0:8 offset1:40
    v_mfma_f32_16x16x32_bf16 v[48:51], v[116:119], a[184:187], v[48:51]
    v_mfma_f32_16x16x32_bf16 v[176:179], v[64:67], a[188:191], v[176:179]
    ds_read2st64_b32 v[28:29], v218 offset0:12 offset1:44
    s_add_u32 m0, s5, 21504
    s_add_u32 s83, s5, s14
    s_add_u32 s83, s83, 4096
    buffer_load_dwordx4 v153, s[68:71], s83 offen sc1 lds
    v_mfma_f32_16x16x32_bf16 v[192:195], v[64:67], a[196:199], v[192:195]
    ds_write_b64 v173, v[228:229]
    v_mfma_f32_16x16x32_bf16 v[48:51], v[116:119], a[188:191], v[48:51]
    ds_read2st64_b32 v[30:31], v219 offset0:12 offset1:44
    v_mfma_f32_16x16x32_bf16 v[180:183], v[68:71], a[184:187], v[180:183]
    ds_read2_b32 v[230:231], v222 offset1:32
    v_and_b32 v120, 1, v152
    v_mul_u32_u24 v120, 640, v120
    v_add_u32 v120, v155, v120
    v_mfma_f32_16x16x32_bf16 v[196:199], v[68:71], a[192:195], v[196:199]
    ds_read_b128 v[92:95], v217 offset:768
    s_add_u32 m0, s84, 4096
    s_add_u32 s83, s16, 81920
    buffer_load_dwordx4 v159, s[56:59], s83 offen offset:0 lds
    v_mfma_f32_16x16x32_bf16 v[52:55], v[116:119], a[192:195], v[52:55]
    ds_read_b128 v[96:99], v217 offset:784
    s_mov_b64 exec, 0x7fff
    ds_write_b32 v172, v228
    s_mov_b64 exec, -1
    v_mfma_f32_16x16x32_bf16 v[180:183], v[72:75], a[188:191], v[180:183]
    ds_read_b128 v[212:215], v217 offset:528
    ds_read2_b32 v[124:125], v154 offset1:160
    ds_read2_b32 v[126:127], v154 offset0:1 offset1:161
    ds_read_b64 v[128:129], v155 offset:0
    v_mfma_f32_16x16x32_bf16 v[196:199], v[72:75], a[196:199], v[196:199]
    ds_read_b128 v[208:211], v217 offset:512
    ds_read_b64 v[130:131], v120 offset:0
    s_waitcnt lgkmcnt(10)
    v_add_f32 v16, v16, v17
    v_add_f32 v18, v18, v19
    v_mfma_f32_16x16x32_bf16 v[52:55], v[116:119], a[196:199], v[52:55]
    ds_read_b128 v[0:3], v216 offset:0
    buffer_load_dwordx4 v159, s[60:63], s83 offen offset:2048 lds
    v_add_f32 v20, v20, v21
    v_add_f32 v22, v22, v23
    v_mfma_f32_16x16x32_bf16 v[184:187], v[76:79], a[184:187], v[184:187]
    ds_read_b128 v[4:7], v216 offset:256
    ds_write_b128 v243, v[244:247] offset:38560
    v_add_f32 v24, v24, v25
    v_add_f32 v26, v26, v27
    v_mfma_f32_16x16x32_bf16 v[200:203], v[76:79], a[192:195], v[200:203]
    ds_read_b128 v[8:11], v216 offset:16
    v_add_f32 v28, v28, v29
    v_add_f32 v30, v30, v31
    v_mfma_f32_16x16x32_bf16 v[184:187], v[80:83], a[188:191], v[184:187]
    ds_read_b128 v[12:15], v216 offset:272
    s_waitcnt lgkmcnt(6)
    v_add_f32 v162, v230, v231
    v_fma_f32 v208, v208, v162, v16
    v_mfma_f32_16x16x32_bf16 v[200:203], v[80:83], a[196:199], v[200:203]
    s_add_u32 s83, s83, 4096
    buffer_load_dwordx4 v159, s[56:59], s83 offen offset:1024 lds
    v_fma_f32 v209, v209, v162, v18
    v_fma_f32 v210, v210, v162, v20
    v_mfma_f32_16x16x32_bf16 v[188:191], v[84:87], a[184:187], v[188:191]
    ds_write_b128 v243, v[32:35] offset:42720
    v_fma_f32 v211, v211, v162, v22
    v_fma_f32 v212, v212, v162, v24
    v_mfma_f32_16x16x32_bf16 v[204:207], v[84:87], a[192:195], v[204:207]
    v_fma_f32 v213, v213, v162, v26
    v_fma_f32 v214, v214, v162, v28
    v_mfma_f32_16x16x32_bf16 v[188:191], v[88:91], a[188:191], v[188:191]
    v_fma_f32 v215, v215, v162, v30
    v_mul_f32 v208, v92, v208
    v_mfma_f32_16x16x32_bf16 v[204:207], v[88:91], a[196:199], v[204:207]
    buffer_load_dwordx4 v159, s[60:63], s83 offen offset:3072 lds
    v_mul_f32 v209, v93, v209
    v_mul_f32 v210, v94, v210
    v_mul_f32 v211, v95, v211
    v_mul_f32 v212, v96, v212
    v_mul_f32 v213, v97, v213
    v_mul_f32 v214, v98, v214
    v_mul_f32 v215, v99, v215
    v_mov_b32 v160, v48
    v_mov_b32 v161, v52
    s_waitcnt lgkmcnt(4)
    v_pk_fma_f32 v[176:177], v[0:1], v[160:161], v[176:177] op_sel_hi:[1,0,1]
    v_pk_fma_f32 v[192:193], v[0:1], v[160:161], v[192:193] op_sel:[0,1,0]
    v_fma_f32 v241, v114, v208, v209
    v_pk_fma_f32 v[178:179], v[2:3], v[160:161], v[178:179] op_sel_hi:[1,0,1]
    v_pk_fma_f32 v[194:195], v[2:3], v[160:161], v[194:195] op_sel:[0,1,0]
    v_pk_mul_f32 v[176:177], v[4:5], v[176:177]
    v_fmac_f32_dpp v241, v208, v115 row_ror:8 row_mask:0xf bank_mask:0xf
    v_pk_mul_f32 v[192:193], v[4:5], v[192:193]
    v_pk_mul_f32 v[178:179], v[6:7], v[178:179]
    v_pk_mul_f32 v[194:195], v[6:7], v[194:195]
    v_fma_f32 v240, v114, v241, v210
    ds_read_b128 v[0:3], v216 offset:32
    ds_read_b128 v[4:7], v216 offset:288
    v_pk_fma_f32 v[236:237], v[176:177], v[112:113], v[178:179] op_sel_hi:[1,0,1]
    v_fmac_f32_dpp v240, v241, v115 row_ror:8 row_mask:0xf bank_mask:0xf
    v_pk_fma_f32 v[238:239], v[192:193], v[112:113], v[194:195] op_sel_hi:[1,0,1]
    v_pk_fma_f32 v[236:237], v[192:193], v[112:113], v[236:237] op_sel:[0,1,0] neg_lo:[1,0,0] neg_hi:[1,0,0]
    v_pk_fma_f32 v[238:239], v[176:177], v[112:113], v[238:239] op_sel:[0,1,0]
    s_waitcnt lgkmcnt(3)
    v_pk_fma_f32 v[180:181], v[8:9], v[160:161], v[180:181] op_sel_hi:[1,0,1]
    v_pk_fma_f32 v[196:197], v[8:9], v[160:161], v[196:197] op_sel:[0,1,0]
    v_fma_f32 v241, v114, v240, v211
    v_pk_fma_f32 v[182:183], v[10:11], v[160:161], v[182:183] op_sel_hi:[1,0,1]
    v_pk_fma_f32 v[198:199], v[10:11], v[160:161], v[198:199] op_sel:[0,1,0]
    v_pk_mul_f32 v[180:181], v[12:13], v[180:181]
    v_fmac_f32_dpp v241, v240, v115 row_ror:8 row_mask:0xf bank_mask:0xf
    v_pk_mul_f32 v[196:197], v[12:13], v[196:197]
    v_pk_mul_f32 v[182:183], v[14:15], v[182:183]
    v_pk_mul_f32 v[198:199], v[14:15], v[198:199]
    v_fma_f32 v240, v114, v241, v212
    ds_read_b128 v[8:11], v216 offset:48
    ds_read_b128 v[12:15], v216 offset:304
    v_pk_fma_f32 v[232:233], v[236:237], v[112:113], v[180:181] op_sel_hi:[1,0,1]
    v_fmac_f32_dpp v240, v241, v115 row_ror:8 row_mask:0xf bank_mask:0xf
    v_pk_fma_f32 v[234:235], v[238:239], v[112:113], v[196:197] op_sel_hi:[1,0,1]
    v_pk_fma_f32 v[232:233], v[238:239], v[112:113], v[232:233] op_sel:[0,1,0] neg_lo:[1,0,0] neg_hi:[1,0,0]
    v_pk_fma_f32 v[234:235], v[236:237], v[112:113], v[234:235] op_sel:[0,1,0]
    v_pk_fma_f32 v[236:237], v[232:233], v[112:113], v[182:183] op_sel_hi:[1,0,1]
    v_pk_fma_f32 v[238:239], v[234:235], v[112:113], v[198:199] op_sel_hi:[1,0,1]
    v_pk_fma_f32 v[236:237], v[234:235], v[112:113], v[236:237] op_sel:[0,1,0] neg_lo:[1,0,0] neg_hi:[1,0,0]
    v_pk_fma_f32 v[238:239], v[232:233], v[112:113], v[238:239] op_sel:[0,1,0]
    s_waitcnt lgkmcnt(2)
    v_pk_fma_f32 v[184:185], v[0:1], v[160:161], v[184:185] op_sel_hi:[1,0,1]
    v_pk_fma_f32 v[200:201], v[0:1], v[160:161], v[200:201] op_sel:[0,1,0]
    v_fma_f32 v241, v114, v240, v213
    v_pk_fma_f32 v[186:187], v[2:3], v[160:161], v[186:187] op_sel_hi:[1,0,1]
    v_pk_fma_f32 v[202:203], v[2:3], v[160:161], v[202:203] op_sel:[0,1,0]
    v_pk_mul_f32 v[184:185], v[4:5], v[184:185]
    v_fmac_f32_dpp v241, v240, v115 row_ror:8 row_mask:0xf bank_mask:0xf
    v_pk_mul_f32 v[200:201], v[4:5], v[200:201]
    v_pk_mul_f32 v[186:187], v[6:7], v[186:187]
    v_pk_mul_f32 v[202:203], v[6:7], v[202:203]
    v_fma_f32 v240, v114, v241, v214
    v_pk_fma_f32 v[232:233], v[236:237], v[112:113], v[184:185] op_sel_hi:[1,0,1]
    v_pk_fma_f32 v[234:235], v[238:239], v[112:113], v[200:201] op_sel_hi:[1,0,1]
    v_pk_fma_f32 v[232:233], v[238:239], v[112:113], v[232:233] op_sel:[0,1,0] neg_lo:[1,0,0] neg_hi:[1,0,0]
    v_fmac_f32_dpp v240, v241, v115 row_ror:8 row_mask:0xf bank_mask:0xf
    v_pk_fma_f32 v[234:235], v[236:237], v[112:113], v[234:235] op_sel:[0,1,0]
    v_pk_fma_f32 v[236:237], v[232:233], v[112:113], v[186:187] op_sel_hi:[1,0,1]
    v_pk_fma_f32 v[238:239], v[234:235], v[112:113], v[202:203] op_sel_hi:[1,0,1]
    v_pk_fma_f32 v[236:237], v[234:235], v[112:113], v[236:237] op_sel:[0,1,0] neg_lo:[1,0,0] neg_hi:[1,0,0]
    v_pk_fma_f32 v[238:239], v[232:233], v[112:113], v[238:239] op_sel:[0,1,0]
    s_waitcnt lgkmcnt(0)
    v_pk_fma_f32 v[188:189], v[8:9], v[160:161], v[188:189] op_sel_hi:[1,0,1]
    v_pk_fma_f32 v[204:205], v[8:9], v[160:161], v[204:205] op_sel:[0,1,0]
    v_fma_f32 v241, v114, v240, v215
    v_pk_fma_f32 v[190:191], v[10:11], v[160:161], v[190:191] op_sel_hi:[1,0,1]
    v_pk_fma_f32 v[206:207], v[10:11], v[160:161], v[206:207] op_sel:[0,1,0]
    v_pk_mul_f32 v[188:189], v[12:13], v[188:189]
    v_fmac_f32_dpp v241, v240, v115 row_ror:8 row_mask:0xf bank_mask:0xf
    v_pk_mul_f32 v[204:205], v[12:13], v[204:205]
    v_pk_mul_f32 v[190:191], v[14:15], v[190:191]
    v_pk_mul_f32 v[206:207], v[14:15], v[206:207]
    v_pk_fma_f32 v[232:233], v[236:237], v[112:113], v[188:189] op_sel_hi:[1,0,1]
    v_pk_fma_f32 v[234:235], v[238:239], v[112:113], v[204:205] op_sel_hi:[1,0,1]
    v_pk_fma_f32 v[232:233], v[238:239], v[112:113], v[232:233] op_sel:[0,1,0] neg_lo:[1,0,0] neg_hi:[1,0,0]
    v_pk_fma_f32 v[234:235], v[236:237], v[112:113], v[234:235] op_sel:[0,1,0]
    v_pk_fma_f32 v[236:237], v[232:233], v[112:113], v[190:191] op_sel_hi:[1,0,1]
    v_pk_fma_f32 v[238:239], v[234:235], v[112:113], v[206:207] op_sel_hi:[1,0,1]
    v_pk_fma_f32 v[236:237], v[234:235], v[112:113], v[236:237] op_sel:[0,1,0] neg_lo:[1,0,0] neg_hi:[1,0,0]
    v_pk_fma_f32 v[238:239], v[232:233], v[112:113], v[238:239] op_sel:[0,1,0]
    v_mul_f32 v219, v104, v241
    v_fma_f32 v216, v100, v236, v237
    v_fma_f32 v217, v100, v238, v239
    v_fmac_f32_dpp v219, v241, v105 row_ror:8 row_mask:0xf bank_mask:0xf
    v_mov_b32_dpp v218, v241 quad_perm:[1,1,3,3] row_mask:0xf bank_mask:0xf
    v_fma_f32 v216, -v101, v238, v216
    v_fmac_f32 v217, v101, v236
    v_add_f32_dpp v218, v219, v218 quad_perm:[0,0,2,2] row_mask:0xf bank_mask:0xf
    v_mov_b64 v[224:225], v[216:217]
    v_mov_b32 v226, v218
    v_mov_b32 v231, s82
    v_permlane32_swap_b32 v216, v224
    v_permlane32_swap_b32 v217, v225
    v_permlane32_swap_b32 v218, v226
    v_mov_b64 v[220:221], v[216:217]
    v_mov_b32 v222, v218
    v_mov_b64 v[228:229], v[224:225]
    v_mov_b32 v230, v226

    v_permlane16_swap_b32 v218, v222
    v_permlane16_swap_b32 v216, v220
    v_permlane16_swap_b32 v217, v221
    v_permlane16_swap_b32 v226, v230
    v_fmac_f32_dpp v222, v218, v107 row_ror:8 row_mask:0xf bank_mask:0xf
    v_pk_fma_f32 v[220:221], v[216:217], v[102:103], v[220:221] op_sel_hi:[1,0,1]
    v_permlane16_swap_b32 v224, v228
    v_fmac_f32 v222, v106, v218
    v_pk_fma_f32 v[220:221], v[216:217], v[102:103], v[220:221] op_sel:[1,1,0] op_sel_hi:[0,1,1] neg_lo:[1,0,0]
    v_permlane16_swap_b32 v225, v229
    v_fmac_f32_dpp v226, v222, v107 row_ror:8 row_mask:0xf bank_mask:0xf
    v_fmac_f32 v226, v106, v222
    v_pk_fma_f32 v[224:225], v[220:221], v[102:103], v[224:225] op_sel_hi:[1,0,1]
    v_pk_fma_f32 v[224:225], v[220:221], v[102:103], v[224:225] op_sel:[1,1,0] op_sel_hi:[0,1,1] neg_lo:[1,0,0]
    v_fmac_f32_dpp v230, v226, v107 row_ror:8 row_mask:0xf bank_mask:0xf
    v_fmac_f32 v230, v106, v226
    v_pk_fma_f32 v[228:229], v[224:225], v[102:103], v[228:229] op_sel_hi:[1,0,1]
    v_pk_fma_f32 v[228:229], v[224:225], v[102:103], v[228:229] op_sel:[1,1,0] op_sel_hi:[0,1,1] neg_lo:[1,0,0]
    s_mov_b64 exec, 0xffff
    buffer_store_dwordx4 v[228:231], v153, s[92:95], s21 offen sc1
    s_mov_b64 exec, -1
    ds_write_b128 v243, v[248:251] offset:46880
    s_add_u32 m0, s84, 8192
    s_add_u32 s83, s17, 81920
    buffer_load_dwordx4 v159, s[56:59], s83 offen offset:0 lds
    ds_write_b128 v243, v[36:39] offset:51040
    buffer_load_dwordx4 v159, s[60:63], s83 offen offset:2048 lds
    ds_write_b128 v243, v[252:255] offset:30240
    ds_write_b128 v243, v[40:43] offset:34400
    s_waitcnt vmcnt(7)
    s_mul_i32 s3, s81, 8064
    s_lshl_b32 s4, s80, 7
    s_add_u32 s3, s3, s4
    s_add_u32 s3, s3, 8320
    v_add_u32 v166, s3, v164
    s_mul_i32 s3, s81, 4864
    s_sub_u32 s3, s3, s4
    s_sub_u32 s3, s3, 9344
    v_add_u32 v167, s3, v165
    v_add_u32 v48, 1024, v164
    v_add_u32 v49, 2048, v164
    v_add_u32 v50, 3072, v164
    s_waitcnt lgkmcnt(0)
    s_barrier
    ds_read2_b32 v[60:61], v164 offset0:128 offset1:129
    v_mov_b32 v219, 0
    ds_read2_b32 v[62:63], v164 offset0:130 offset1:131
    s_add_u32 s83, s83, 4096
    buffer_load_dwordx4 v159, s[56:59], s83 offen offset:1024 lds
    v_xor_b32 v128, v163, v128
    v_xor_b32 v130, v163, v130
    ds_read_b128 v[64:67], v165 offset:3136
    v_mov_b32_dpp v216, v220 quad_perm:[0,1,2,3] row_mask:4 bank_mask:0xf
    v_mov_b32_dpp v217, v221 quad_perm:[0,1,2,3] row_mask:4 bank_mask:0xf
    ds_read2_b32 v[68:69], v164 offset0:0 offset1:1
    v_mov_b32_dpp v218, v222 quad_perm:[0,1,2,3] row_mask:4 bank_mask:0xf
    v_mov_b32_dpp v216, v224 quad_perm:[0,1,2,3] row_mask:8 bank_mask:0xf
    ds_read2_b32 v[70:71], v164 offset0:2 offset1:3
    v_mov_b32_dpp v217, v225 quad_perm:[0,1,2,3] row_mask:8 bank_mask:0xf
    buffer_load_dwordx4 v159, s[60:63], s83 offen offset:3072 lds
    v_mov_b32_dpp v218, v226 quad_perm:[0,1,2,3] row_mask:8 bank_mask:0xf
    ds_read_b128 v[72:75], v165 offset:2624
    v_mov_b32_dpp v216, v219 quad_perm:[0,1,2,3] row_mask:1 bank_mask:0xf
    v_mov_b32_dpp v217, v219 quad_perm:[0,1,2,3] row_mask:1 bank_mask:0xf
    ds_read_b128 v[76:79], v165 offset:1600
    v_mov_b32_dpp v218, v219 quad_perm:[0,1,2,3] row_mask:1 bank_mask:0xf
    v_mul_f32_dpp v223, -v241, v129 row_ror:8 row_mask:0xf bank_mask:0xf
    ds_read_b128 v[80:83], v165 offset:3648
    v_fma_f32 v223, -v128, v241, v223
    v_mul_f32_dpp v252, -v218, v131 row_ror:8 row_mask:0xf bank_mask:0xf
    s_add_u32 m0, s84, 12288
    s_add_u32 s83, s44, 81920
    s_mov_b32 exec_hi, 0
    buffer_load_dwordx4 v159, s[56:59], s83 offen offset:0 lds
    s_mov_b32 exec_hi, -1
    ds_read_b128 v[84:87], v165 offset:1088
    v_pk_mul_f32 v[248:249], v[124:125], v[216:217] op_sel_hi:[1,0]
    v_pk_mul_f32 v[250:251], v[124:125], v[216:217] op_sel:[0,1]
    ds_read2_b32 v[88:89], v48 offset0:0 offset1:1
    v_pk_fma_f32 v[248:249], v[126:127], v[216:217], v[248:249] op_sel:[0,1,0] neg_lo:[1,0,0] neg_hi:[1,0,0]
    v_pk_fma_f32 v[250:251], v[126:127], v[216:217], v[250:251] op_sel_hi:[1,0,1]
    ds_read2_b32 v[90:91], v48 offset0:2 offset1:3
    v_fma_f32 v252, -v130, v218, v252
    v_fmac_f32 v249, v124, v236
    ds_read_b128 v[92:95], v165 offset:2112
    s_mov_b32 exec_hi, 0
    buffer_load_dwordx4 v159, s[60:63], s83 offen offset:2048 lds
    s_mov_b32 exec_hi, -1
    v_fmac_f32 v251, v124, v238
    v_fma_f32 v249, -v126, v238, v249
    ds_read2_b32 v[96:97], v49 offset0:0 offset1:1
    v_fmac_f32 v251, v126, v236
    v_mov_b32_dpp v219, v223 quad_perm:[0,0,2,2] row_mask:0xf bank_mask:0xf
    ds_read2_b32 v[98:99], v49 offset0:2 offset1:3
    s_mov_b32 exec_lo, 0xaaaaaaaa
    s_mov_b32 exec_hi, 0xaaaaaaaa
    v_add_f32 v252, v252, v219
    s_mov_b64 exec, -1
    v_lshrrev_b32 v29, 4, v152
    ds_read_b128 v[100:103], v165 offset:576
    v_and_b32 v253, 0xf0, v153
    s_add_u32 s83, s83, 4096
    s_mov_b32 exec_hi, 0
    buffer_load_dwordx4 v159, s[56:59], s83 offen offset:1024 lds
    s_mov_b32 exec_hi, -1
    v_lshl_add_u32 v253, v29, 11, v253
    ds_read2_b32 v[104:105], v48 offset0:128 offset1:129
    v_add_u32 v253, s21, v253
    v_lshlrev_b32 v29, 3, v29
    ds_read2_b32 v[106:107], v48 offset0:130 offset1:131
    v_sub_u32 v29, s79, v29
    v_med3_i32 v29, v29, 0, 8
    ds_read_b128 v[108:111], v165 offset:64
    v_mul_lo_u32 v254, v29, s82
    v_mul_f32_dpp v2, -v208, v129 row_ror:8 row_mask:0xf bank_mask:0xf
    s_mov_b32 exec_hi, 0
    buffer_load_dwordx4 v159, s[60:63], s83 offen offset:3072 lds
    s_mov_b32 exec_hi, -1
    v_lshrrev_b32 v159, 5, v152
    v_mul_u32_u24 v159, 5056, v159
    v_add_u32 v159, v158, v159
    ds_read2_b32 v[112:113], v49 offset0:128 offset1:129
    v_pk_mul_f32 v[0:1], v[176:177], v[126:127] op_sel_hi:[1,0]
    v_pk_mul_f32 v[176:177], v[176:177], v[124:125] op_sel_hi:[1,0]
    ds_read2_b32 v[114:115], v49 offset0:130 offset1:131
    v_pk_fma_f32 v[176:177], v[192:193], v[126:127], v[176:177] op_sel_hi:[1,0,1] neg_lo:[1,0,0] neg_hi:[1,0,0]
    v_pk_fma_f32 v[192:193], v[192:193], v[124:125], v[0:1] op_sel_hi:[1,0,1]
    ds_read2_b32 v[116:117], v50 offset0:0 offset1:1
    v_fma_f32 v208, -v128, v208, v2
    v_mul_f32_dpp v2, -v209, v129 row_ror:8 row_mask:0xf bank_mask:0xf
    ds_read2_b32 v[118:119], v50 offset0:2 offset1:3
    s_add_u32 m0, s84, 0
    s_add_u32 s83, s17, 0
    buffer_load_dwordx4 v158, s[56:59], s83 offen offset:0 lds
    v_pk_mul_f32 v[0:1], v[178:179], v[126:127] op_sel_hi:[1,0]
    v_pk_mul_f32 v[178:179], v[178:179], v[124:125] op_sel_hi:[1,0]
    ds_read2_b32 v[120:121], v50 offset0:128 offset1:129
    v_pk_fma_f32 v[178:179], v[194:195], v[126:127], v[178:179] op_sel_hi:[1,0,1] neg_lo:[1,0,0] neg_hi:[1,0,0]
    v_pk_fma_f32 v[194:195], v[194:195], v[124:125], v[0:1] op_sel_hi:[1,0,1]
    ds_read2_b32 v[122:123], v50 offset0:130 offset1:131
    v_fma_f32 v209, -v128, v209, v2
    v_mul_f32_dpp v2, -v210, v129 row_ror:8 row_mask:0xf bank_mask:0xf
    v_pk_mul_f32 v[0:1], v[180:181], v[126:127] op_sel_hi:[1,0]
    v_pk_mul_f32 v[180:181], v[180:181], v[124:125] op_sel_hi:[1,0]
    buffer_load_dwordx4 v158, s[60:63], s83 offen offset:2048 lds
    v_pk_fma_f32 v[180:181], v[196:197], v[126:127], v[180:181] op_sel_hi:[1,0,1] neg_lo:[1,0,0] neg_hi:[1,0,0]
    v_pk_fma_f32 v[196:197], v[196:197], v[124:125], v[0:1] op_sel_hi:[1,0,1]
    v_fma_f32 v210, -v128, v210, v2
    v_mul_f32_dpp v2, -v211, v129 row_ror:8 row_mask:0xf bank_mask:0xf
    v_pk_mul_f32 v[0:1], v[182:183], v[126:127] op_sel_hi:[1,0]
    v_pk_mul_f32 v[182:183], v[182:183], v[124:125] op_sel_hi:[1,0]
    v_pk_fma_f32 v[182:183], v[198:199], v[126:127], v[182:183] op_sel_hi:[1,0,1] neg_lo:[1,0,0] neg_hi:[1,0,0]
    v_pk_fma_f32 v[198:199], v[198:199], v[124:125], v[0:1] op_sel_hi:[1,0,1]
    v_fma_f32 v211, -v128, v211, v2
    v_mul_f32_dpp v2, -v212, v129 row_ror:8 row_mask:0xf bank_mask:0xf
    s_add_u32 s83, s83, 9216
    buffer_load_dwordx4 v158, s[56:59], s83 offen offset:1024 lds
    v_pk_mul_f32 v[0:1], v[184:185], v[126:127] op_sel_hi:[1,0]
    v_pk_mul_f32 v[184:185], v[184:185], v[124:125] op_sel_hi:[1,0]
    v_pk_fma_f32 v[184:185], v[200:201], v[126:127], v[184:185] op_sel_hi:[1,0,1] neg_lo:[1,0,0] neg_hi:[1,0,0]
    v_pk_fma_f32 v[200:201], v[200:201], v[124:125], v[0:1] op_sel_hi:[1,0,1]
    v_fma_f32 v212, -v128, v212, v2
    v_mul_f32_dpp v2, -v213, v129 row_ror:8 row_mask:0xf bank_mask:0xf
    v_pk_mul_f32 v[0:1], v[186:187], v[126:127] op_sel_hi:[1,0]
    v_pk_mul_f32 v[186:187], v[186:187], v[124:125] op_sel_hi:[1,0]
    v_pk_fma_f32 v[186:187], v[202:203], v[126:127], v[186:187] op_sel_hi:[1,0,1] neg_lo:[1,0,0] neg_hi:[1,0,0]
    v_pk_fma_f32 v[202:203], v[202:203], v[124:125], v[0:1] op_sel_hi:[1,0,1]
    buffer_load_dwordx4 v158, s[60:63], s83 offen offset:3072 lds
    v_fma_f32 v213, -v128, v213, v2
    v_mul_f32_dpp v2, -v214, v129 row_ror:8 row_mask:0xf bank_mask:0xf
    v_pk_mul_f32 v[0:1], v[188:189], v[126:127] op_sel_hi:[1,0]
    v_pk_mul_f32 v[188:189], v[188:189], v[124:125] op_sel_hi:[1,0]
    v_pk_fma_f32 v[188:189], v[204:205], v[126:127], v[188:189] op_sel_hi:[1,0,1] neg_lo:[1,0,0] neg_hi:[1,0,0]
    v_pk_fma_f32 v[204:205], v[204:205], v[124:125], v[0:1] op_sel_hi:[1,0,1]
    v_fma_f32 v214, -v128, v214, v2
    v_mul_f32_dpp v2, -v215, v129 row_ror:8 row_mask:0xf bank_mask:0xf
    v_pk_mul_f32 v[0:1], v[190:191], v[126:127] op_sel_hi:[1,0]
    v_pk_mul_f32 v[190:191], v[190:191], v[124:125] op_sel_hi:[1,0]
    v_pk_fma_f32 v[190:191], v[206:207], v[126:127], v[190:191] op_sel_hi:[1,0,1] neg_lo:[1,0,0] neg_hi:[1,0,0]
    v_pk_fma_f32 v[206:207], v[206:207], v[124:125], v[0:1] op_sel_hi:[1,0,1]
    v_fma_f32 v215, -v128, v215, v2
    v_add_u32 v129, 1024, v166
    v_add_u32 v130, 2048, v166
    v_add_u32 v131, 3072, v166
    s_cmp_lg_u32 s13, 0
    s_cbranch_scc1 Lv_1
    s_waitcnt lgkmcnt(15)
    s_waitcnt lgkmcnt(9)
    v_mfma_f32_16x16x32_bf16 v[44:47], v[68:71], v[100:103], 0
    buffer_load_dwordx4 v[244:247], v253, s[92:95], 0 offen offset:2048 sc1
    s_waitcnt vmcnt(14)
    v_lshrrev_b32 v29, 4, v152
    v_mul_u32_u24 v29, 640, v29
    v_mfma_f32_16x16x32_bf16 v[32:35], v[60:63], v[72:75], 0
    buffer_load_dwordx4 v[240:243], v253, s[92:95], 0 offen offset:1792 sc1
    ds_read_b128 a[200:203], v156 offset:4096
    v_add_u32 v30, v154, v29
    v_add_u32 v31, v155, v29
    s_waitcnt lgkmcnt(3)
    v_mfma_f32_16x16x32_bf16 v[32:35], v[116:119], v[108:111], v[32:35]
    ds_read_b64 v[4:5], v154 offset:9600
    ds_read_b64 v[6:7], v155 offset:9600
    ds_read_b64 v[8:9], v30 offset:5120
    ds_read_b64 v[10:11], v31 offset:5120
    buffer_load_dwordx4 v[236:239], v253, s[92:95], 0 offen offset:1536 sc1
    ds_read_b128 a[204:207], v157 offset:4096
    v_add_u32 v30, v30, v29
    v_add_u32 v31, v31, v29
    v_mfma_f32_16x16x32_bf16 v[32:35], v[68:71], v[64:67], v[32:35]
    buffer_load_dwordx4 v[232:235], v253, s[92:95], 0 offen offset:1280 sc1
    ds_read_b128 a[208:211], v156 offset:4608
    v_and_b32 v29, 1, v152
    v_mul_u32_u24 v29, 640, v29
    v_mfma_f32_16x16x32_bf16 v[36:39], v[60:63], v[64:67], 0
    ds_read_b128 v[64:67], v165 offset:3072
    buffer_load_dwordx4 v[228:231], v253, s[92:95], 0 offen offset:1024 sc1
    ds_read_b128 a[212:215], v157 offset:4608
    v_add_u32 v31, v31, v29
    v_mfma_f32_16x16x32_bf16 v[36:39], v[88:91], v[72:75], v[36:39]
    ds_read_b128 v[72:75], v165 offset:2560
    ds_read2_b32 v[12:13], v30 offset1:160
    ds_read2_b32 v[14:15], v30 offset0:1 offset1:161
    ds_read_b64 v[16:17], v31 offset:0
    buffer_load_dwordx4 v[224:227], v253, s[92:95], 0 offen offset:768 sc1
    s_waitcnt lgkmcnt(13)
    v_mfma_f32_16x16x32_bf16 v[36:39], v[120:123], v[108:111], v[36:39]
    ds_read2_b32 v[120:121], v50 offset0:144 offset1:145
    ds_read2_b32 v[122:123], v50 offset0:146 offset1:147
    ds_read_b64 v[18:19], v154 offset:7680
    ds_read_b64 v[20:21], v155 offset:7680
    buffer_load_dwordx4 v[220:223], v253, s[92:95], 0 offen offset:512 sc1
    v_mfma_f32_16x16x32_bf16 v[44:47], v[60:63], v[108:111], v[44:47]
    ds_read2_b32 v[60:61], v164 offset0:144 offset1:145
    ds_read2_b32 v[62:63], v164 offset0:146 offset1:147
    s_add_u32 s6, s100, 71680
    buffer_load_dwordx4 v[216:219], v253, s[92:95], 0 offen offset:256 sc1
    v_bfe_u32 v29, v152, 4, 1
    v_lshlrev_b32 v29, 6, v29
    v_mfma_f32_16x16x32_bf16 v[40:43], v[68:71], v[108:111], 0
    ds_read_b128 v[108:111], v165 offset:0
    s_waitcnt lgkmcnt(11)
    s_add_u32 m0, s84, 4096
    s_add_u32 s83, s17, 5120
    buffer_load_dwordx4 v158, s[56:59], s83 offen offset:0 lds
    v_xor_b32 v22, v29, v153
    v_add_u32 v22, s6, v22
    v_mfma_f32_16x16x32_bf16 v[36:39], v[68:71], v[80:83], v[36:39]
    ds_read2_b32 v[68:69], v164 offset0:16 offset1:17
    ds_read2_b32 v[70:71], v164 offset0:18 offset1:19
    ds_read_b128 v[80:83], v165 offset:3584
    v_and_b32 v24, 3, v152
    v_lshl_add_u32 v24, v24, 8, s6
    v_mfma_f32_16x16x32_bf16 v[32:35], v[88:91], v[92:95], v[32:35]
    ds_read2_b32 v[88:89], v48 offset0:16 offset1:17
    ds_read2_b32 v[90:91], v48 offset0:18 offset1:19
    v_lshl_add_u32 v24, v29, 1, v24
    v_bfe_u32 v29, v152, 2, 2
    v_mfma_f32_16x16x32_bf16 v[36:39], v[104:107], v[92:95], v[36:39]
    ds_read_b128 v[92:95], v165 offset:2048
    v_lshl_add_u32 v24, v29, 4, v24
    v_lshrrev_b32 v23, 5, v152
    v_mfma_f32_16x16x32_bf16 v[36:39], v[96:99], v[76:79], v[36:39]
    buffer_load_dwordx4 v158, s[60:63], s83 offen offset:2048 lds
    v_lshl_add_u32 v24, v23, 3, v24
    v_and_b32 v29, 1, v152
    v_mfma_f32_16x16x32_bf16 v[32:35], v[104:107], v[76:79], v[32:35]
    ds_read2_b32 v[104:105], v48 offset0:144 offset1:145
    ds_read2_b32 v[106:107], v48 offset0:146 offset1:147
    ds_read_b128 v[76:79], v165 offset:1536
    v_lshl_add_u32 v24, v29, 6, v24
    v_xor_b32 v25, 64, v24
    v_mfma_f32_16x16x32_bf16 v[36:39], v[112:115], v[84:87], v[36:39]
    s_lshl_b32 s3, s77, 10
    s_add_u32 s3, s3, 94016
    v_lshl_add_u32 v26, v29, 2, s3
    v_lshlrev_b32 v28, 5, v29
    v_mfma_f32_16x16x32_bf16 v[32:35], v[96:99], v[84:87], v[32:35]
    ds_read2_b32 v[96:97], v49 offset0:16 offset1:17
    ds_read2_b32 v[98:99], v49 offset0:18 offset1:19
    ds_read_b128 v[84:87], v165 offset:1024
    v_bfe_u32 v29, v152, 1, 3
    v_lshl_add_u32 v26, v29, 5, v26
    v_mfma_f32_16x16x32_bf16 v[36:39], v[116:119], v[100:103], v[36:39]
    ds_read2_b32 v[116:117], v50 offset0:16 offset1:17
    ds_read2_b32 v[118:119], v50 offset0:18 offset1:19
    s_add_u32 s83, s83, 9216
    buffer_load_dwordx4 v158, s[56:59], s83 offen offset:1024 lds
    v_and_b32 v29, 1, v29
    v_lshl_add_u32 v28, v29, 4, v28
    v_mfma_f32_16x16x32_bf16 v[32:35], v[112:115], v[100:103], v[32:35]
    ds_read2_b32 v[112:113], v49 offset0:144 offset1:145
    ds_read2_b32 v[114:115], v49 offset0:146 offset1:147
    ds_read_b128 v[100:103], v165 offset:512
    v_and_b32 v29, 0xc0, v153
    v_add_u32 v28, v29, v28
    s_waitcnt lgkmcnt(15)
    v_mfma_f32_16x16x32_bf16 v[32:35], v[60:63], v[72:75], v[32:35]
    v_lshrrev_b32 v29, 4, v152
    v_lshl_add_u32 v26, v29, 3, v26
    v_mfma_f32_16x16x32_bf16 v[40:43], v[68:71], v[108:111], v[40:43]
    v_lshl_add_u32 v27, v29, 7, s3
    v_lshl_add_u32 v27, v152, 3, v27
    s_waitcnt lgkmcnt(14)
    v_mfma_f32_16x16x32_bf16 v[36:39], v[68:71], v[80:83], v[36:39]
    ds_read_b128 v[80:83], v167 offset:3776
    buffer_load_dwordx4 v158, s[60:63], s83 offen offset:3072 lds
    v_mul_u32_u24 v29, 40960, v29
    v_add_u32 v28, v29, v28
    v_mfma_f32_16x16x32_bf16 v[32:35], v[68:71], v[64:67], v[32:35]
    v_xor_b32 v7, v163, v7
    v_xor_b32 v11, v163, v11
    v_mfma_f32_16x16x32_bf16 v[36:39], v[60:63], v[64:67], v[36:39]
    ds_read_b128 v[64:67], v167 offset:3264
    v_xor_b32 v16, v163, v16
    v_xor_b32 v21, v163, v21
    v_mfma_f32_16x16x32_bf16 v[44:47], v[60:63], v[108:111], v[44:47]
    ds_read2_b32 v[60:61], v166 offset0:128 offset1:129
    ds_read2_b32 v[62:63], v166 offset0:130 offset1:131
    s_lshl_b32 s3, s77, 10
    s_add_u32 s3, s3, 0
    v_add_u32 v170, s3, v153
    s_waitcnt lgkmcnt(15)
    v_mfma_f32_16x16x32_bf16 v[36:39], v[88:91], v[72:75], v[36:39]
    ds_read_b128 v[72:75], v167 offset:2752
    s_waitcnt lgkmcnt(11)
    v_mfma_f32_16x16x32_bf16 v[36:39], v[96:99], v[76:79], v[36:39]
    s_waitcnt lgkmcnt(8)
    v_mfma_f32_16x16x32_bf16 v[32:35], v[116:119], v[108:111], v[32:35]
    s_waitcnt lgkmcnt(5)
    v_mfma_f32_16x16x32_bf16 v[44:47], v[68:71], v[100:103], v[44:47]
    ds_read2_b32 v[68:69], v166 offset0:0 offset1:1
    ds_read2_b32 v[70:71], v166 offset0:2 offset1:3
    v_mfma_f32_16x16x32_bf16 v[32:35], v[104:107], v[76:79], v[32:35]
    ds_read_b128 v[76:79], v167 offset:1728
    v_mfma_f32_16x16x32_bf16 v[32:35], v[96:99], v[84:87], v[32:35]
    ds_read2_b32 v[96:97], v130 offset0:0 offset1:1
    ds_read2_b32 v[98:99], v130 offset0:2 offset1:3
    v_mfma_f32_16x16x32_bf16 v[36:39], v[112:115], v[84:87], v[36:39]
    ds_read_b128 v[84:87], v167 offset:1216
    v_mfma_f32_16x16x32_bf16 v[32:35], v[88:91], v[92:95], v[32:35]
    ds_read2_b32 v[88:89], v129 offset0:0 offset1:1
    ds_read2_b32 v[90:91], v129 offset0:2 offset1:3
    v_mfma_f32_16x16x32_bf16 v[36:39], v[120:123], v[108:111], v[36:39]
    ds_read_b128 v[108:111], v167 offset:192
    ds_read2_b32 v[120:121], v131 offset0:128 offset1:129
    ds_read2_b32 v[122:123], v131 offset0:130 offset1:131
    v_mfma_f32_16x16x32_bf16 v[36:39], v[104:107], v[92:95], v[36:39]
    ds_read_b128 v[92:95], v167 offset:2240
    ds_read2_b32 v[104:105], v129 offset0:128 offset1:129
    ds_read2_b32 v[106:107], v129 offset0:130 offset1:131
    v_mfma_f32_16x16x32_bf16 v[32:35], v[112:115], v[100:103], v[32:35]
    ds_read2_b32 v[112:113], v130 offset0:128 offset1:129
    ds_read2_b32 v[114:115], v130 offset0:130 offset1:131
    v_mfma_f32_16x16x32_bf16 v[36:39], v[116:119], v[100:103], v[36:39]
    ds_read_b128 v[100:103], v167 offset:704
    ds_read2_b32 v[116:117], v131 offset0:0 offset1:1
    ds_read2_b32 v[118:119], v131 offset0:2 offset1:3
    s_branch Lw_2
Lv_1:
    s_waitcnt lgkmcnt(15)
    v_mfma_f32_16x16x32_bf16 v[32:35], v[60:63], v[76:79], 0
    buffer_load_dwordx4 v[244:247], v253, s[92:95], 0 offen offset:2048 sc1
    s_waitcnt vmcnt(14)
    v_lshrrev_b32 v29, 4, v152
    v_mul_u32_u24 v29, 640, v29
    v_mfma_f32_16x16x32_bf16 v[44:47], v[60:63], v[84:87], 0
    buffer_load_dwordx4 v[240:243], v253, s[92:95], 0 offen offset:1792 sc1
    ds_read_b128 a[200:203], v156 offset:4096
    v_add_u32 v30, v154, v29
    v_add_u32 v31, v155, v29
    v_mfma_f32_16x16x32_bf16 v[36:39], v[68:71], v[72:75], 0
    ds_read_b128 v[72:75], v165 offset:2560
    ds_read_b128 v[64:67], v167 offset:3264
    ds_read_b128 v[80:83], v167 offset:3776
    ds_read2_b32 v[116:117], v131 offset0:0 offset1:1
    ds_read2_b32 v[118:119], v131 offset0:2 offset1:3
    ds_read2_b32 v[120:121], v131 offset0:128 offset1:129
    ds_read2_b32 v[122:123], v131 offset0:130 offset1:131
    buffer_load_dwordx4 v[236:239], v253, s[92:95], 0 offen offset:1536 sc1
    ds_read_b128 a[204:207], v157 offset:4096
    v_mfma_f32_16x16x32_bf16 v[44:47], v[68:71], v[76:79], v[44:47]
    ds_read_b64 v[4:5], v154 offset:9600
    ds_read_b64 v[6:7], v155 offset:9600
    ds_read_b64 v[8:9], v30 offset:5120
    ds_read_b64 v[10:11], v31 offset:5120
    buffer_load_dwordx4 v[232:235], v253, s[92:95], 0 offen offset:1280 sc1
    ds_read_b128 a[208:211], v156 offset:4608
    v_add_u32 v30, v30, v29
    v_add_u32 v31, v31, v29
    s_waitcnt lgkmcnt(15)
    v_mfma_f32_16x16x32_bf16 v[40:43], v[60:63], v[100:103], 0
    buffer_load_dwordx4 v[228:231], v253, s[92:95], 0 offen offset:1024 sc1
    ds_read_b128 a[212:215], v157 offset:4608
    v_and_b32 v29, 1, v152
    v_mul_u32_u24 v29, 640, v29
    v_mfma_f32_16x16x32_bf16 v[36:39], v[60:63], v[92:95], v[36:39]
    ds_read2_b32 v[60:61], v164 offset0:144 offset1:145
    ds_read2_b32 v[62:63], v164 offset0:146 offset1:147
    buffer_load_dwordx4 v[224:227], v253, s[92:95], 0 offen offset:768 sc1
    v_add_u32 v31, v31, v29
    v_mfma_f32_16x16x32_bf16 v[36:39], v[104:107], v[84:87], v[36:39]
    ds_read2_b32 v[12:13], v30 offset1:160
    ds_read2_b32 v[14:15], v30 offset0:1 offset1:161
    ds_read_b64 v[16:17], v31 offset:0
    ds_read_b64 v[18:19], v154 offset:7680
    buffer_load_dwordx4 v[220:223], v253, s[92:95], 0 offen offset:512 sc1
    v_mfma_f32_16x16x32_bf16 v[40:43], v[68:71], v[84:87], v[40:43]
    ds_read_b64 v[20:21], v155 offset:7680
    s_add_u32 s6, s100, 71680
    buffer_load_dwordx4 v[216:219], v253, s[92:95], 0 offen offset:256 sc1
    v_bfe_u32 v29, v152, 4, 1
    v_lshlrev_b32 v29, 6, v29
    v_mfma_f32_16x16x32_bf16 v[36:39], v[88:91], v[76:79], v[36:39]
    ds_read_b128 v[76:79], v165 offset:1536
    s_waitcnt lgkmcnt(8)
    s_add_u32 m0, s84, 4096
    s_add_u32 s83, s17, 5120
    buffer_load_dwordx4 v158, s[56:59], s83 offen offset:0 lds
    v_xor_b32 v22, v29, v153
    v_add_u32 v22, s6, v22
    v_mfma_f32_16x16x32_bf16 v[32:35], v[68:71], v[92:95], v[32:35]
    ds_read2_b32 v[68:69], v164 offset0:16 offset1:17
    ds_read2_b32 v[70:71], v164 offset0:18 offset1:19
    ds_read_b128 v[92:95], v165 offset:2048
    v_and_b32 v24, 3, v152
    v_lshl_add_u32 v24, v24, 8, s6
    v_mfma_f32_16x16x32_bf16 v[32:35], v[104:107], v[100:103], v[32:35]
    v_lshl_add_u32 v24, v29, 1, v24
    v_bfe_u32 v29, v152, 2, 2
    v_mfma_f32_16x16x32_bf16 v[40:43], v[88:91], v[108:111], v[40:43]
    v_lshl_add_u32 v24, v29, 4, v24
    v_lshrrev_b32 v23, 5, v152
    v_mfma_f32_16x16x32_bf16 v[32:35], v[88:91], v[84:87], v[32:35]
    ds_read_b128 v[84:87], v165 offset:1024
    buffer_load_dwordx4 v158, s[60:63], s83 offen offset:2048 lds
    v_lshl_add_u32 v24, v23, 3, v24
    v_and_b32 v29, 1, v152
    v_mfma_f32_16x16x32_bf16 v[36:39], v[96:99], v[100:103], v[36:39]
    v_lshl_add_u32 v24, v29, 6, v24
    v_xor_b32 v25, 64, v24
    v_mfma_f32_16x16x32_bf16 v[44:47], v[88:91], v[100:103], v[44:47]
    ds_read2_b32 v[88:89], v48 offset0:16 offset1:17
    ds_read2_b32 v[90:91], v48 offset0:18 offset1:19
    ds_read_b128 v[100:103], v165 offset:512
    s_lshl_b32 s3, s77, 10
    v_mfma_f32_16x16x32_bf16 v[32:35], v[96:99], v[108:111], v[32:35]
    ds_read2_b32 v[96:97], v49 offset0:16 offset1:17
    ds_read2_b32 v[98:99], v49 offset0:18 offset1:19
    s_add_u32 s3, s3, 94016
    v_lshl_add_u32 v26, v29, 2, s3
    v_lshlrev_b32 v28, 5, v29
    v_mfma_f32_16x16x32_bf16 v[36:39], v[112:115], v[108:111], v[36:39]
    ds_read2_b32 v[112:113], v49 offset0:144 offset1:145
    ds_read2_b32 v[114:115], v49 offset0:146 offset1:147
    s_add_u32 s83, s83, 9216
    buffer_load_dwordx4 v158, s[56:59], s83 offen offset:1024 lds
    v_bfe_u32 v29, v152, 1, 3
    v_lshl_add_u32 v26, v29, 5, v26
    v_mfma_f32_16x16x32_bf16 v[44:47], v[104:107], v[108:111], v[44:47]
    ds_read2_b32 v[104:105], v48 offset0:144 offset1:145
    ds_read2_b32 v[106:107], v48 offset0:146 offset1:147
    ds_read_b128 v[108:111], v165 offset:0
    v_and_b32 v29, 1, v29
    v_lshl_add_u32 v28, v29, 4, v28
    s_waitcnt lgkmcnt(15)
    s_waitcnt lgkmcnt(14)
    v_mfma_f32_16x16x32_bf16 v[32:35], v[60:63], v[76:79], v[32:35]
    v_and_b32 v29, 0xc0, v153
    v_add_u32 v28, v29, v28
    s_waitcnt lgkmcnt(12)
    v_mfma_f32_16x16x32_bf16 v[36:39], v[68:71], v[72:75], v[36:39]
    ds_read_b128 v[72:75], v167 offset:2752
    v_lshrrev_b32 v29, 4, v152
    v_lshl_add_u32 v26, v29, 3, v26
    s_waitcnt lgkmcnt(12)
    v_mfma_f32_16x16x32_bf16 v[32:35], v[68:71], v[92:95], v[32:35]
    buffer_load_dwordx4 v158, s[60:63], s83 offen offset:3072 lds
    v_lshl_add_u32 v27, v29, 7, s3
    v_lshl_add_u32 v27, v152, 3, v27
    v_mfma_f32_16x16x32_bf16 v[36:39], v[60:63], v[92:95], v[36:39]
    ds_read_b128 v[92:95], v167 offset:2240
    v_mul_u32_u24 v29, 40960, v29
    v_add_u32 v28, v29, v28
    s_waitcnt lgkmcnt(12)
    v_mfma_f32_16x16x32_bf16 v[40:43], v[68:71], v[84:87], v[40:43]
    v_xor_b32 v7, v163, v7
    v_xor_b32 v11, v163, v11
    v_mfma_f32_16x16x32_bf16 v[44:47], v[68:71], v[76:79], v[44:47]
    ds_read2_b32 v[68:69], v166 offset0:0 offset1:1
    ds_read2_b32 v[70:71], v166 offset0:2 offset1:3
    v_xor_b32 v16, v163, v16
    v_xor_b32 v21, v163, v21
    s_waitcnt lgkmcnt(12)
    v_mfma_f32_16x16x32_bf16 v[36:39], v[88:91], v[76:79], v[36:39]
    ds_read_b128 v[76:79], v167 offset:1728
    s_lshl_b32 s3, s77, 10
    s_add_u32 s3, s3, 0
    v_add_u32 v170, s3, v153
    v_mfma_f32_16x16x32_bf16 v[44:47], v[60:63], v[84:87], v[44:47]
    s_waitcnt lgkmcnt(12)
    v_mfma_f32_16x16x32_bf16 v[40:43], v[60:63], v[100:103], v[40:43]
    ds_read2_b32 v[60:61], v166 offset0:128 offset1:129
    ds_read2_b32 v[62:63], v166 offset0:130 offset1:131
    v_mfma_f32_16x16x32_bf16 v[44:47], v[88:91], v[100:103], v[44:47]
    s_waitcnt lgkmcnt(8)
    s_waitcnt lgkmcnt(7)
    v_mfma_f32_16x16x32_bf16 v[44:47], v[104:107], v[108:111], v[44:47]
    v_mfma_f32_16x16x32_bf16 v[40:43], v[88:91], v[108:111], v[40:43]
    v_mfma_f32_16x16x32_bf16 v[32:35], v[88:91], v[84:87], v[32:35]
    ds_read2_b32 v[88:89], v129 offset0:0 offset1:1
    ds_read2_b32 v[90:91], v129 offset0:2 offset1:3
    v_mfma_f32_16x16x32_bf16 v[36:39], v[104:107], v[84:87], v[36:39]
    ds_read_b128 v[84:87], v167 offset:1216
    v_mfma_f32_16x16x32_bf16 v[32:35], v[96:99], v[108:111], v[32:35]
    v_mfma_f32_16x16x32_bf16 v[32:35], v[104:107], v[100:103], v[32:35]
    ds_read2_b32 v[104:105], v129 offset0:128 offset1:129
    ds_read2_b32 v[106:107], v129 offset0:130 offset1:131
    v_mfma_f32_16x16x32_bf16 v[36:39], v[112:115], v[108:111], v[36:39]
    ds_read_b128 v[108:111], v167 offset:192
    ds_read2_b32 v[112:113], v130 offset0:128 offset1:129
    ds_read2_b32 v[114:115], v130 offset0:130 offset1:131
    v_mfma_f32_16x16x32_bf16 v[36:39], v[96:99], v[100:103], v[36:39]
    ds_read2_b32 v[96:97], v130 offset0:0 offset1:1
    ds_read2_b32 v[98:99], v130 offset0:2 offset1:3
    ds_read_b128 v[100:103], v167 offset:704
Lw_2:
L_cchk0:
    s_waitcnt vmcnt(10)
    v_fmac_f32_dpp v242, v246, v7 row_ror:8 row_mask:0xf bank_mask:0xf
    v_fmac_f32 v242, v6, v246
    v_pk_fma_f32 v[240:241], v[244:245], v[4:5], v[240:241] op_sel_hi:[1,0,1]
    v_pk_fma_f32 v[240:241], v[244:245], v[4:5], v[240:241] op_sel:[1,1,0] op_sel_hi:[0,1,1] neg_lo:[1,0,0]
    ds_write_b128 v170, v[32:35] offset:0
    s_waitcnt vmcnt(9)
    v_add3_u32 v169, v247, v243, v239
    v_fmac_f32_dpp v238, v242, v7 row_ror:8 row_mask:0xf bank_mask:0xf
    v_fmac_f32 v238, v6, v242
    v_pk_fma_f32 v[236:237], v[240:241], v[4:5], v[236:237] op_sel_hi:[1,0,1]
    v_pk_fma_f32 v[236:237], v[240:241], v[4:5], v[236:237] op_sel:[1,1,0] op_sel_hi:[0,1,1] neg_lo:[1,0,0]
    s_waitcnt vmcnt(8)
    v_fmac_f32_dpp v234, v238, v7 row_ror:8 row_mask:0xf bank_mask:0xf
    v_fmac_f32 v234, v6, v238
    v_pk_fma_f32 v[232:233], v[236:237], v[4:5], v[232:233] op_sel_hi:[1,0,1]
    v_pk_fma_f32 v[232:233], v[236:237], v[4:5], v[232:233] op_sel:[1,1,0] op_sel_hi:[0,1,1] neg_lo:[1,0,0]
    ds_write_b128 v170, v[36:39] offset:4096
    s_waitcnt vmcnt(7)
    v_add3_u32 v169, v169, v235, v231
    v_fmac_f32_dpp v230, v234, v7 row_ror:8 row_mask:0xf bank_mask:0xf
    v_fmac_f32 v230, v6, v234
    v_pk_fma_f32 v[228:229], v[232:233], v[4:5], v[228:229] op_sel_hi:[1,0,1]
    v_pk_fma_f32 v[228:229], v[232:233], v[4:5], v[228:229] op_sel:[1,1,0] op_sel_hi:[0,1,1] neg_lo:[1,0,0]
    s_waitcnt vmcnt(6)
    v_fmac_f32_dpp v226, v230, v7 row_ror:8 row_mask:0xf bank_mask:0xf
    v_fmac_f32 v226, v6, v230
    v_pk_fma_f32 v[224:225], v[228:229], v[4:5], v[224:225] op_sel_hi:[1,0,1]
    v_pk_fma_f32 v[224:225], v[228:229], v[4:5], v[224:225] op_sel:[1,1,0] op_sel_hi:[0,1,1] neg_lo:[1,0,0]
    ds_write_b128 v170, v[40:43] offset:8192
    s_waitcnt vmcnt(5)
    v_add3_u32 v169, v169, v227, v223
    v_fmac_f32_dpp v222, v226, v7 row_ror:8 row_mask:0xf bank_mask:0xf
    v_fmac_f32 v222, v6, v226
    v_pk_fma_f32 v[220:221], v[224:225], v[4:5], v[220:221] op_sel_hi:[1,0,1]
    v_pk_fma_f32 v[220:221], v[224:225], v[4:5], v[220:221] op_sel:[1,1,0] op_sel_hi:[0,1,1] neg_lo:[1,0,0]
    s_waitcnt vmcnt(4)
    v_add_u32 v169, v169, v219
    v_cmp_ne_u32 vcc, v169, v254
    v_fmac_f32_dpp v218, v222, v7 row_ror:8 row_mask:0xf bank_mask:0xf
    v_fmac_f32 v218, v6, v222
    v_pk_fma_f32 v[216:217], v[220:221], v[4:5], v[216:217] op_sel_hi:[1,0,1]
    v_pk_fma_f32 v[216:217], v[220:221], v[4:5], v[216:217] op_sel:[1,1,0] op_sel_hi:[0,1,1] neg_lo:[1,0,0]
    ds_write_b128 v170, v[44:47] offset:12288
    s_cbranch_vccnz L_cre0
    v_mul_f32_dpp v222, v218, v11 row_ror:8 row_mask:0xf bank_mask:0xf
    v_pk_mul_f32 v[220:221], v[216:217], v[8:9] op_sel_hi:[1,0]
    v_fmac_f32 v222, v10, v218
    v_pk_fma_f32 v[220:221], v[216:217], v[8:9], v[220:221] op_sel:[1,1,0] op_sel_hi:[0,1,1] neg_lo:[1,0,0]

    v_mov_b32 v226, v222
    v_mov_b64 v[224:225], v[220:221]
    s_nop 0
    v_permlane32_swap_b32 v222, v226
    v_permlane32_swap_b32 v220, v224
    v_permlane32_swap_b32 v221, v225
    v_add_f32 v222, v222, v226
    v_pk_add_f32 v[220:221], v[220:221], v[224:225]

    v_mov_b32 v226, v222
    v_mov_b64 v[224:225], v[220:221]
    s_nop 0
    v_permlane16_swap_b32 v222, v226
    v_permlane16_swap_b32 v220, v224
    v_permlane16_swap_b32 v221, v225
    v_add_f32 v222, v222, v226
    v_pk_add_f32 v[220:221], v[220:221], v[224:225]

    v_fma_f32 v252, -v16, v222, v252
    v_pk_fma_f32 v[248:249], v[12:13], v[220:221], v[248:249] op_sel_hi:[1,0,1]
    v_pk_fma_f32 v[250:251], v[12:13], v[220:221], v[250:251] op_sel:[0,1,0]
    v_fmac_f32_dpp v252, -v222, v17 row_ror:8 row_mask:0xf bank_mask:0xf
    v_pk_fma_f32 v[248:249], v[14:15], v[220:221], v[248:249] op_sel:[0,1,0] neg_lo:[1,0,0] neg_hi:[1,0,0]
    v_pk_fma_f32 v[250:251], v[14:15], v[220:221], v[250:251] op_sel_hi:[1,0,1]

    s_cmp_eq_u32 s88, 0
    s_cbranch_scc1 L_p2s0
    v_fmac_f32_dpp v208, -v252, v21 row_ror:8 row_mask:0xf bank_mask:0xf
    v_fmac_f32 v208, v20, v252
    v_pk_fma_f32 v[176:177], v[248:249], v[18:19], v[176:177] op_sel_hi:[1,0,1]
    v_pk_fma_f32 v[192:193], v[250:251], v[18:19], v[192:193] op_sel_hi:[1,0,1]
    v_fmac_f32_dpp v209, -v208, v21 row_ror:8 row_mask:0xf bank_mask:0xf
    v_fmac_f32 v209, v20, v208
    v_pk_fma_f32 v[176:177], v[250:251], v[18:19], v[176:177] op_sel:[0,1,0] neg_lo:[1,0,0] neg_hi:[1,0,0]
    v_pk_fma_f32 v[192:193], v[248:249], v[18:19], v[192:193] op_sel:[0,1,0]
    v_fmac_f32_dpp v210, -v209, v21 row_ror:8 row_mask:0xf bank_mask:0xf
    v_fmac_f32 v210, v20, v209
    v_pk_fma_f32 v[178:179], v[176:177], v[18:19], v[178:179] op_sel_hi:[1,0,1]
    v_pk_fma_f32 v[194:195], v[192:193], v[18:19], v[194:195] op_sel_hi:[1,0,1]
    v_fmac_f32_dpp v211, -v210, v21 row_ror:8 row_mask:0xf bank_mask:0xf
    v_fmac_f32 v211, v20, v210
    v_pk_fma_f32 v[178:179], v[192:193], v[18:19], v[178:179] op_sel:[0,1,0] neg_lo:[1,0,0] neg_hi:[1,0,0]
    v_pk_fma_f32 v[194:195], v[176:177], v[18:19], v[194:195] op_sel:[0,1,0]
    v_cvt_pk_bf16_f32 v232, v176, v177
    v_cvt_pk_bf16_f32 v233, v178, v179
    v_cvt_pk_bf16_f32 v234, -v192, -v193
    v_cvt_pk_bf16_f32 v235, -v194, -v195

    ds_write_b128 v22, v[232:235] offset:0
    ds_read_b64_tr_b16 v[216:217], v24 offset:0
    ds_read_b64_tr_b16 v[218:219], v25 offset:0
    v_fmac_f32_dpp v212, -v211, v21 row_ror:8 row_mask:0xf bank_mask:0xf
    v_fmac_f32 v212, v20, v211
    v_pk_fma_f32 v[180:181], v[178:179], v[18:19], v[180:181] op_sel_hi:[1,0,1]
    v_pk_fma_f32 v[196:197], v[194:195], v[18:19], v[196:197] op_sel_hi:[1,0,1]
    v_fmac_f32_dpp v213, -v212, v21 row_ror:8 row_mask:0xf bank_mask:0xf
    v_fmac_f32 v213, v20, v212
    v_pk_fma_f32 v[180:181], v[194:195], v[18:19], v[180:181] op_sel:[0,1,0] neg_lo:[1,0,0] neg_hi:[1,0,0]
    v_pk_fma_f32 v[196:197], v[178:179], v[18:19], v[196:197] op_sel:[0,1,0]
    v_fmac_f32_dpp v214, -v213, v21 row_ror:8 row_mask:0xf bank_mask:0xf
    v_fmac_f32 v214, v20, v213
    v_pk_fma_f32 v[182:183], v[180:181], v[18:19], v[182:183] op_sel_hi:[1,0,1]
    v_pk_fma_f32 v[198:199], v[196:197], v[18:19], v[198:199] op_sel_hi:[1,0,1]
    v_fmac_f32_dpp v215, -v214, v21 row_ror:8 row_mask:0xf bank_mask:0xf
    v_fmac_f32 v215, v20, v214
    v_pk_fma_f32 v[182:183], v[196:197], v[18:19], v[182:183] op_sel:[0,1,0] neg_lo:[1,0,0] neg_hi:[1,0,0]
    v_pk_fma_f32 v[198:199], v[180:181], v[18:19], v[198:199] op_sel:[0,1,0]
    v_cvt_pk_bf16_f32 v236, v180, v181
    v_cvt_pk_bf16_f32 v237, v182, v183
    v_cvt_pk_bf16_f32 v238, -v196, -v197
    v_cvt_pk_bf16_f32 v239, -v198, -v199

    ds_write_b128 v22, v[236:239] offset:1024
    ds_read_b64_tr_b16 v[220:221], v24 offset:1024
    ds_read_b64_tr_b16 v[222:223], v25 offset:1024
    v_pk_fma_f32 v[184:185], v[182:183], v[18:19], v[184:185] op_sel_hi:[1,0,1]
    v_pk_fma_f32 v[200:201], v[198:199], v[18:19], v[200:201] op_sel_hi:[1,0,1]
    v_pk_fma_f32 v[184:185], v[198:199], v[18:19], v[184:185] op_sel:[0,1,0] neg_lo:[1,0,0] neg_hi:[1,0,0]
    v_pk_fma_f32 v[200:201], v[182:183], v[18:19], v[200:201] op_sel:[0,1,0]
    v_cvt_pk_bf16_f32 v240, v208, v209
    v_cvt_pk_bf16_f32 v241, v210, v211
    v_cvt_pk_bf16_f32 v242, v212, v213
    v_cvt_pk_bf16_f32 v243, v214, v215
    ds_write2st64_b32 v26, v240, v241 offset0:0 offset1:1
    ds_write2st64_b32 v26, v242, v243 offset0:2 offset1:3
    ds_read_b64_tr_b16 v[244:245], v27 offset:0
    ds_read_b64_tr_b16 v[246:247], v27 offset:128
    v_pk_fma_f32 v[186:187], v[184:185], v[18:19], v[186:187] op_sel_hi:[1,0,1]
    v_pk_fma_f32 v[202:203], v[200:201], v[18:19], v[202:203] op_sel_hi:[1,0,1]
    v_pk_fma_f32 v[186:187], v[200:201], v[18:19], v[186:187] op_sel:[0,1,0] neg_lo:[1,0,0] neg_hi:[1,0,0]
    v_pk_fma_f32 v[202:203], v[184:185], v[18:19], v[202:203] op_sel:[0,1,0]
    v_cvt_pk_bf16_f32 v232, v184, v185
    v_cvt_pk_bf16_f32 v233, v186, v187
    v_cvt_pk_bf16_f32 v234, -v200, -v201
    v_cvt_pk_bf16_f32 v235, -v202, -v203

    ds_write_b128 v22, v[232:235] offset:0
    ds_read_b64_tr_b16 v[224:225], v24 offset:0
    ds_read_b64_tr_b16 v[226:227], v25 offset:0
    s_waitcnt lgkmcnt(10)
    v_and_b32 v216, -2, v216
    v_and_b32 v218, -2, v218
    buffer_store_dwordx4 v[216:219], v153, s[64:67], s36 offen
    v_pk_fma_f32 v[188:189], v[186:187], v[18:19], v[188:189] op_sel_hi:[1,0,1]
    v_pk_fma_f32 v[204:205], v[202:203], v[18:19], v[204:205] op_sel_hi:[1,0,1]
    v_pk_fma_f32 v[188:189], v[202:203], v[18:19], v[188:189] op_sel:[0,1,0] neg_lo:[1,0,0] neg_hi:[1,0,0]
    v_pk_fma_f32 v[204:205], v[186:187], v[18:19], v[204:205] op_sel:[0,1,0]
    v_pk_fma_f32 v[190:191], v[188:189], v[18:19], v[190:191] op_sel_hi:[1,0,1]
    v_pk_fma_f32 v[206:207], v[204:205], v[18:19], v[206:207] op_sel_hi:[1,0,1]
    v_pk_fma_f32 v[190:191], v[204:205], v[18:19], v[190:191] op_sel:[0,1,0] neg_lo:[1,0,0] neg_hi:[1,0,0]
    v_pk_fma_f32 v[206:207], v[188:189], v[18:19], v[206:207] op_sel:[0,1,0]
    v_cvt_pk_bf16_f32 v236, v188, v189
    v_cvt_pk_bf16_f32 v237, v190, v191
    v_cvt_pk_bf16_f32 v238, -v204, -v205
    v_cvt_pk_bf16_f32 v239, -v206, -v207

    ds_write_b128 v22, v[236:239] offset:1024
    ds_read_b64_tr_b16 v[228:229], v24 offset:1024
    ds_read_b64_tr_b16 v[230:231], v25 offset:1024
    s_waitcnt lgkmcnt(10)
    v_and_b32 v220, -2, v220
    v_and_b32 v222, -2, v222
    buffer_store_dwordx4 v[220:223], v153, s[64:67], s18 offen
    s_waitcnt lgkmcnt(6)
    v_and_or_b32 v244, v244, -2, v23
    v_and_or_b32 v246, v246, -2, v23
    buffer_store_dwordx2 v[244:245], v28, s[64:67], s37 offen offset:0
    buffer_store_dwordx2 v[246:247], v28, s[64:67], s37 offen offset:512
    s_waitcnt lgkmcnt(3)
    v_or_b32 v224, 1, v224
    v_or_b32 v226, 1, v226
    buffer_store_dwordx4 v[224:227], v153, s[64:67], s19 offen
    s_waitcnt lgkmcnt(0)
    v_or_b32 v228, 1, v228
    v_or_b32 v230, 1, v230
    buffer_store_dwordx4 v[228:231], v153, s[64:67], s20 offen
L_p2e0:
    v_mfma_f32_16x16x32_bf16 v[28:31], v[60:63], v[64:67], 0
    v_and_b32 v172, 15, v152
    v_lshrrev_b32 v164, 4, v152
    v_mfma_f32_16x16x32_bf16 v[20:23], v[68:71], v[72:75], 0
    ds_read_b128 a[216:219], v156 offset:8192
    s_lshl_b32 s8, s79, 13
    s_and_b32 s7, s91, 31
    s_lshl_b32 s7, s7, 2
    s_add_u32 s8, s8, 11272192
    s_add_u32 s7, s7, s8
    v_lshlrev_b32 v164, 3, v164
    v_lshl_add_u32 v164, v172, 5, v164
    v_mfma_f32_16x16x32_bf16 v[16:19], v[60:63], v[76:79], 0
    ds_read_b128 a[220:223], v157 offset:8192
    v_xor_b32 v172, 8, v164
    v_mov_b32 v169, s7
    v_mfma_f32_16x16x32_bf16 v[12:15], v[68:71], v[76:79], 0
    ds_read_b128 a[224:227], v156 offset:8704
    s_lshl_b32 s6, s77, 12
    s_add_u32 s6, s6, 0
    v_add_u32 v170, s6, v153
    v_mov_b32 v173, s82
    v_mfma_f32_16x16x32_bf16 v[28:31], v[68:71], v[80:83], v[28:31]
    ds_read_b128 v[80:83], v167 offset:3712
    ds_read_b128 a[228:231], v157 offset:8704
    s_add_u32 s3, s40, 26112
    v_add_u32 v171, s3, v172
    v_mfma_f32_16x16x32_bf16 v[8:11], v[68:71], v[84:87], 0
    v_mfma_f32_16x16x32_bf16 v[16:19], v[88:91], v[84:87], v[16:19]
    s_mov_b32 s13, 40960
    v_mfma_f32_16x16x32_bf16 v[20:23], v[60:63], v[92:95], v[20:23]
    s_mul_i32 s5, s77, 40960
    s_lshl_b32 s22, s16, 5
    v_mfma_f32_16x16x32_bf16 v[28:31], v[88:91], v[72:75], v[28:31]
    s_waitcnt lgkmcnt(0)
    s_add_u32 m0, s84, 8192
    s_add_u32 s83, s17, 40960
    buffer_load_dwordx4 v158, s[56:59], s83 offen offset:0 lds
    v_mfma_f32_16x16x32_bf16 v[24:27], v[68:71], v[64:67], 0
    ds_read_b128 v[64:67], v167 offset:3200
    s_add_u32 s22, s22, s5
    v_mfma_f32_16x16x32_bf16 v[16:19], v[68:71], v[92:95], v[16:19]
    s_lshl_b32 s23, s17, 5
    v_mfma_f32_16x16x32_bf16 v[28:31], v[96:99], v[76:79], v[28:31]
    s_add_u32 s23, s23, s5
    s_lshl_b32 s24, s44, 5
    v_mfma_f32_16x16x32_bf16 v[12:15], v[60:63], v[84:87], v[12:15]
    buffer_load_dwordx4 v158, s[60:63], s83 offen offset:2048 lds
    v_mfma_f32_16x16x32_bf16 v[24:27], v[88:91], v[92:95], v[24:27]
    ds_read_b128 a[248:251], v156 offset:12288
    v_mfma_f32_16x16x32_bf16 v[8:11], v[60:63], v[100:103], v[8:11]
    ds_read_b128 a[252:255], v157 offset:12288
    s_barrier
    v_mfma_f32_16x16x32_bf16 v[20:23], v[88:91], v[76:79], v[20:23]
    ds_read_b128 v[32:35], v170 offset:0
    s_add_u32 s24, s24, s5
    v_mfma_f32_16x16x32_bf16 v[12:15], v[88:91], v[100:103], v[12:15]
    s_add_u32 s83, s83, 9216
    buffer_load_dwordx4 v158, s[56:59], s83 offen offset:1024 lds
    ds_read_b128 v[36:39], v170 offset:1024
    v_mfma_f32_16x16x32_bf16 v[24:27], v[60:63], v[72:75], v[24:27]
    ds_read_b128 v[72:75], v167 offset:2688
    ds_read_b128 v[40:43], v170 offset:2048
    v_mfma_f32_16x16x32_bf16 v[24:27], v[104:107], v[76:79], v[24:27]
    ds_read_b128 v[76:79], v167 offset:1664
    ds_read_b128 v[44:47], v170 offset:3072
    v_mfma_f32_16x16x32_bf16 v[4:7], v[60:63], v[108:111], 0
    ds_read2_b32 v[60:61], v166 offset0:144 offset1:145
    ds_read2_b32 v[62:63], v166 offset0:146 offset1:147
    ds_read_b64 v[48:49], v171
    v_mfma_f32_16x16x32_bf16 v[4:7], v[68:71], v[100:103], v[4:7]
    buffer_load_dwordx4 v158, s[60:63], s83 offen offset:3072 lds
    s_add_u32 s3, s40, s15
    s_add_u32 s3, s3, 3145728
    v_add_u32 v171, s3, v164
    v_and_b32 v57, 8, v164
    v_mfma_f32_16x16x32_bf16 v[0:3], v[68:71], v[108:111], 0
    ds_read2_b32 v[68:69], v166 offset0:16 offset1:17
    ds_read2_b32 v[70:71], v166 offset0:18 offset1:19
    v_and_b32 v164, 0x1f0, v164
    v_lshl_add_u32 v164, v57, 6, v164
    v_mfma_f32_16x16x32_bf16 v[28:31], v[112:115], v[84:87], v[28:31]
    v_mfma_f32_16x16x32_bf16 v[28:31], v[116:119], v[100:103], v[28:31]
    s_cmp_eq_u32 s77, 3
    s_cselect_b32 s5, -122880, s13
    v_mfma_f32_16x16x32_bf16 v[24:27], v[96:99], v[84:87], v[24:27]
    s_waitcnt lgkmcnt(11)
    s_add_u32 m0, s84, 12288
    s_add_u32 s83, s17, 46080
    buffer_load_dwordx4 v158, s[56:59], s83 offen offset:0 lds
    v_mfma_f32_16x16x32_bf16 v[20:23], v[104:107], v[84:87], v[20:23]
    ds_read_b128 v[84:87], v167 offset:1152
    s_waitcnt lgkmcnt(6)
    v_add_f32 v32, v32, v36
    v_add_f32 v33, v33, v37
    v_mfma_f32_16x16x32_bf16 v[8:11], v[88:91], v[108:111], v[8:11]
    ds_read2_b32 v[88:89], v129 offset0:16 offset1:17
    ds_read2_b32 v[90:91], v129 offset0:18 offset1:19
    v_add_f32 v34, v34, v38
    v_add_f32 v35, v35, v39
    v_mfma_f32_16x16x32_bf16 v[28:31], v[104:107], v[92:95], v[28:31]
    ds_read_b128 v[92:95], v167 offset:2176
    v_add_f32 v40, v40, v44
    v_add_f32 v41, v41, v45
    v_mfma_f32_16x16x32_bf16 v[20:23], v[112:115], v[108:111], v[20:23]
    buffer_load_dwordx4 v158, s[60:63], s83 offen offset:2048 lds
    v_add_f32 v42, v42, v46
    v_add_f32 v43, v43, v47
    v_mfma_f32_16x16x32_bf16 v[16:19], v[96:99], v[108:111], v[16:19]
    ds_read_b128 a[232:235], v156 offset:0
    v_add_f32 v32, v32, v40
    v_add_f32 v33, v33, v41
    v_mfma_f32_16x16x32_bf16 v[24:27], v[116:119], v[108:111], v[24:27]
    ds_read2_b32 v[116:117], v131 offset0:16 offset1:17
    ds_read2_b32 v[118:119], v131 offset0:18 offset1:19
    ds_read_b128 a[236:239], v157 offset:0
    s_waitcnt vmcnt(6)
    s_cmp_eq_u32 s88, 0
    s_cbranch_scc1 Lss_3
    global_store_dword v169, v173, s[50:51]
Lsd_4:
    v_add_f32 v34, v34, v42
    v_add_f32 v35, v35, v43
    v_mfma_f32_16x16x32_bf16 v[20:23], v[96:99], v[100:103], v[20:23]
    ds_read2_b32 v[96:97], v130 offset0:16 offset1:17
    ds_read2_b32 v[98:99], v130 offset0:18 offset1:19
    ds_read_b128 a[240:243], v156 offset:512
    v_and_b32 v173, 31, v152
    v_lshl_add_u32 v173, v173, 2, s8
    v_mfma_f32_16x16x32_bf16 v[16:19], v[104:107], v[100:103], v[16:19]
    s_add_u32 s83, s83, 9216
    buffer_load_dwordx4 v158, s[56:59], s83 offen offset:1024 lds
    ds_read_b128 a[244:247], v157 offset:512
    v_mfma_f32_16x16x32_bf16 v[12:15], v[104:107], v[108:111], v[12:15]
    ds_read2_b32 v[104:105], v129 offset0:144 offset1:145
    ds_read2_b32 v[106:107], v129 offset0:146 offset1:147
    s_waitcnt lgkmcnt(15)
    v_and_b32 v36, s86, v49
    v_lshlrev_b32 v37, 16, v49
    v_mfma_f32_16x16x32_bf16 v[24:27], v[112:115], v[100:103], v[24:27]
    ds_read2_b32 v[112:113], v130 offset0:144 offset1:145
    ds_read2_b32 v[114:115], v130 offset0:146 offset1:147
    ds_read_b128 v[100:103], v167 offset:640
    v_and_b32 v38, s86, v48
    v_lshlrev_b32 v39, 16, v48
    v_mfma_f32_16x16x32_bf16 v[28:31], v[120:123], v[108:111], v[28:31]
    ds_read2_b32 v[120:121], v131 offset0:144 offset1:145
    ds_read2_b32 v[122:123], v131 offset0:146 offset1:147
    ds_read_b128 v[108:111], v167 offset:128
    v_mul_f32 v36, s35, v36
    v_mul_f32 v37, s35, v37
    v_mfma_f32_16x16x32_bf16 v[28:31], v[60:63], v[64:67], v[28:31]
    buffer_load_dwordx4 v158, s[60:63], s83 offen offset:3072 lds
    v_mul_f32 v38, s35, v38
    v_mul_f32 v39, s35, v39
    s_waitcnt lgkmcnt(15)
    v_mfma_f32_16x16x32_bf16 v[20:23], v[68:71], v[72:75], v[20:23]
    v_cvt_pk_bf16_f32 v36, 0, v36
    v_cvt_pk_bf16_f32 v37, 0, v37
    v_mfma_f32_16x16x32_bf16 v[16:19], v[60:63], v[76:79], v[16:19]
    v_cvt_pk_bf16_f32 v38, 0, v38
    v_cvt_pk_bf16_f32 v39, 0, v39
    v_mfma_f32_16x16x32_bf16 v[12:15], v[68:71], v[76:79], v[12:15]
    v_cvt_pk_bf16_f32 v32, 0, v32
    v_cvt_pk_bf16_f32 v33, 0, v33
    v_mfma_f32_16x16x32_bf16 v[28:31], v[68:71], v[80:83], v[28:31]
    ds_read_b128 v[80:83], v167 offset:3648
    s_waitcnt lgkmcnt(9)
    s_add_u32 m0, s84, 0
    s_add_u32 s83, s44, 0
    buffer_load_dwordx4 v159, s[56:59], s83 offen offset:0 lds
    v_cvt_pk_bf16_f32 v34, 0, v34
    v_cvt_pk_bf16_f32 v35, 0, v35
    v_mfma_f32_16x16x32_bf16 v[8:11], v[68:71], v[84:87], v[8:11]
    v_add_f32 v32, v32, v36
    v_add_f32 v33, v33, v37
    v_mfma_f32_16x16x32_bf16 v[16:19], v[88:91], v[84:87], v[16:19]
    v_add_f32 v34, v34, v38
    v_add_f32 v35, v35, v39
    v_mfma_f32_16x16x32_bf16 v[20:23], v[60:63], v[92:95], v[20:23]
    v_cvt_pk_bf16_f32 v58, v32, v33
    v_cvt_pk_bf16_f32 v59, v34, v35
    v_mfma_f32_16x16x32_bf16 v[28:31], v[88:91], v[72:75], v[28:31]
    buffer_load_dwordx4 v159, s[60:63], s83 offen offset:2048 lds
    global_store_dwordx2 v171, v[58:59], s[50:51] sc1
    v_mfma_f32_16x16x32_bf16 v[24:27], v[68:71], v[64:67], v[24:27]
    ds_read_b128 v[64:67], v167 offset:3136
    ds_read_b128 v[176:179], v156 offset:4096
    s_mul_i32 s3, s81, 4608
    v_mfma_f32_16x16x32_bf16 v[16:19], v[68:71], v[92:95], v[16:19]
    ds_read_b128 v[180:183], v157 offset:4096
    s_lshl_b32 s4, s80, 10
    s_add_u32 s3, s3, 16896
    v_mfma_f32_16x16x32_bf16 v[28:31], v[96:99], v[76:79], v[28:31]
    ds_read_b128 v[184:187], v156 offset:4608
    s_add_u32 s9, s3, s4
    s_sub_u32 s3, s3, s4
    v_add_u32 v57, s9, v172
    v_add_u32 v171, s3, v172
    v_mfma_f32_16x16x32_bf16 v[12:15], v[60:63], v[84:87], v[12:15]
    s_add_u32 s83, s83, 9216
    buffer_load_dwordx4 v159, s[56:59], s83 offen offset:1024 lds
    ds_read_b128 v[188:191], v157 offset:4608
    v_mfma_f32_16x16x32_bf16 v[24:27], v[88:91], v[92:95], v[24:27]
    ds_read_b64 v[44:45], v57 offset:0
    ds_read_b64 v[46:47], v57 offset:512
    ds_read_b64 v[48:49], v171 offset:3072
    s_waitcnt lgkmcnt(12)
    v_mfma_f32_16x16x32_bf16 v[8:11], v[60:63], v[100:103], v[8:11]
    ds_read_b64 v[50:51], v171 offset:3584
    v_add_u32 v170, 65536, v170
    v_xor_b32 v171, 0x1000, v170
    v_mfma_f32_16x16x32_bf16 v[20:23], v[88:91], v[76:79], v[20:23]
    s_mul_i32 s3, s79, 163840
    s_mul_i32 s4, s77, 10240
    s_add_u32 s3, s3, s4
    v_add_u32 v175, s3, v153
    v_mfma_f32_16x16x32_bf16 v[12:15], v[88:91], v[100:103], v[12:15]
    buffer_load_dwordx4 v159, s[60:63], s83 offen offset:3072 lds
    s_waitcnt lgkmcnt(2)
    v_and_b32 v52, s86, v45
    v_lshlrev_b32 v53, 16, v45
    v_mfma_f32_16x16x32_bf16 v[24:27], v[60:63], v[72:75], v[24:27]
    ds_read_b128 v[72:75], v167 offset:2624
    v_and_b32 v54, s86, v44
    v_lshlrev_b32 v55, 16, v44
    v_mfma_f32_16x16x32_bf16 v[24:27], v[104:107], v[76:79], v[24:27]
    ds_read_b128 v[76:79], v167 offset:1600
    v_and_b32 v56, s86, v47
    v_lshlrev_b32 v57, 16, v47
    v_mfma_f32_16x16x32_bf16 v[4:7], v[60:63], v[108:111], v[4:7]
    ds_read2_b32 v[60:61], v166 offset0:160 offset1:161
    ds_read2_b32 v[62:63], v166 offset0:162 offset1:163
    v_and_b32 v58, s86, v46
    v_lshlrev_b32 v59, 16, v46
    v_mfma_f32_16x16x32_bf16 v[4:7], v[68:71], v[100:103], v[4:7]
    s_add_u32 m0, s84, 4096
    s_add_u32 s83, s44, 40960
    buffer_load_dwordx4 v159, s[56:59], s83 offen offset:0 lds
    v_mul_f32 v52, s34, v52
    v_mul_f32 v53, s34, v53
    v_mfma_f32_16x16x32_bf16 v[0:3], v[68:71], v[108:111], v[0:3]
    ds_read2_b32 v[68:69], v166 offset0:32 offset1:33
    ds_read2_b32 v[70:71], v166 offset0:34 offset1:35
    v_mul_f32 v54, s34, v54
    v_mul_f32 v55, s34, v55
    v_mfma_f32_16x16x32_bf16 v[28:31], v[112:115], v[84:87], v[28:31]
    v_mul_f32 v56, s34, v56
    v_mul_f32 v57, s34, v57
    v_mfma_f32_16x16x32_bf16 v[28:31], v[116:119], v[100:103], v[28:31]
    v_mul_f32 v58, s34, v58
    v_mul_f32 v59, s34, v59
    v_mfma_f32_16x16x32_bf16 v[24:27], v[96:99], v[84:87], v[24:27]
    buffer_load_dwordx4 v159, s[60:63], s83 offen offset:2048 lds
    s_waitcnt vmcnt(12)
    v_cvt_pk_bf16_f32 v52, 0, v52
    v_cvt_pk_bf16_f32 v53, 0, v53
    v_mfma_f32_16x16x32_bf16 v[20:23], v[104:107], v[84:87], v[20:23]
    ds_read_b128 v[84:87], v167 offset:1088
    ds_read_b128 v[192:195], v156 offset:8192
    v_cvt_pk_bf16_f32 v54, 0, v54
    v_cvt_pk_bf16_f32 v55, 0, v55
    v_mfma_f32_16x16x32_bf16 v[8:11], v[88:91], v[108:111], v[8:11]
    ds_read2_b32 v[88:89], v129 offset0:32 offset1:33
    ds_read2_b32 v[90:91], v129 offset0:34 offset1:35
    ds_read_b128 v[196:199], v157 offset:8192
    v_cvt_pk_bf16_f32 v56, 0, v56
    v_cvt_pk_bf16_f32 v57, 0, v57
    v_mfma_f32_16x16x32_bf16 v[28:31], v[104:107], v[92:95], v[28:31]
    ds_read_b128 v[92:95], v167 offset:2112
    ds_read_b128 v[200:203], v156 offset:8704
    v_cvt_pk_bf16_f32 v58, 0, v58
    v_cvt_pk_bf16_f32 v59, 0, v59
    v_mfma_f32_16x16x32_bf16 v[20:23], v[112:115], v[108:111], v[20:23]
    s_add_u32 s83, s83, 9216
    buffer_load_dwordx4 v159, s[56:59], s83 offen offset:1024 lds
    ds_read_b128 v[204:207], v157 offset:8704
    v_mfma_f32_16x16x32_bf16 v[16:19], v[96:99], v[108:111], v[16:19]
    s_waitcnt lgkmcnt(14)
    v_and_b32 v32, s86, v49
    v_lshlrev_b32 v33, 16, v49
    v_mfma_f32_16x16x32_bf16 v[24:27], v[116:119], v[108:111], v[24:27]
    ds_read2_b32 v[116:117], v131 offset0:32 offset1:33
    ds_read2_b32 v[118:119], v131 offset0:34 offset1:35
    v_and_b32 v34, s86, v48
    v_lshlrev_b32 v35, 16, v48
    v_mfma_f32_16x16x32_bf16 v[20:23], v[96:99], v[100:103], v[20:23]
    ds_read2_b32 v[96:97], v130 offset0:32 offset1:33
    ds_read2_b32 v[98:99], v130 offset0:34 offset1:35
    v_and_b32 v36, s86, v51
    v_lshlrev_b32 v37, 16, v51
    v_mfma_f32_16x16x32_bf16 v[16:19], v[104:107], v[100:103], v[16:19]
    buffer_load_dwordx4 v159, s[60:63], s83 offen offset:3072 lds
    v_and_b32 v38, s86, v50
    v_lshlrev_b32 v39, 16, v50
    v_mfma_f32_16x16x32_bf16 v[12:15], v[104:107], v[108:111], v[12:15]
    ds_read2_b32 v[104:105], v129 offset0:160 offset1:161
    ds_read2_b32 v[106:107], v129 offset0:162 offset1:163
    v_mul_f32 v32, s34, v32
    v_mul_f32 v33, s34, v33
    v_mfma_f32_16x16x32_bf16 v[24:27], v[112:115], v[100:103], v[24:27]
    ds_read2_b32 v[112:113], v130 offset0:160 offset1:161
    ds_read2_b32 v[114:115], v130 offset0:162 offset1:163
    ds_read_b128 v[100:103], v167 offset:576
    v_mul_f32 v34, s34, v34
    v_mul_f32 v35, s34, v35
    v_mfma_f32_16x16x32_bf16 v[28:31], v[120:123], v[108:111], v[28:31]
    ds_read2_b32 v[120:121], v131 offset0:160 offset1:161
    ds_read2_b32 v[122:123], v131 offset0:162 offset1:163
    ds_read_b128 v[108:111], v167 offset:64
    v_mul_f32 v36, s34, v36
    v_mul_f32 v37, s34, v37
    s_waitcnt lgkmcnt(15)
    v_mfma_f32_16x16x32_bf16 v[28:31], v[60:63], v[64:67], v[28:31]
    s_waitcnt lgkmcnt(12)
    s_add_u32 m0, s84, 8192
    s_add_u32 s83, s16, 40960
    buffer_load_dwordx4 v158, s[56:59], s83 offen offset:0 lds
    v_mul_f32 v38, s34, v38
    v_mul_f32 v39, s34, v39
    v_mfma_f32_16x16x32_bf16 v[20:23], v[68:71], v[72:75], v[20:23]
    v_cvt_pk_bf16_f32 v32, 0, v32
    v_cvt_pk_bf16_f32 v33, 0, v33
    v_mfma_f32_16x16x32_bf16 v[16:19], v[60:63], v[76:79], v[16:19]
    v_cvt_pk_bf16_f32 v34, 0, v34
    v_cvt_pk_bf16_f32 v35, 0, v35
    v_mfma_f32_16x16x32_bf16 v[12:15], v[68:71], v[76:79], v[12:15]
    v_cvt_pk_bf16_f32 v36, 0, v36
    v_cvt_pk_bf16_f32 v37, 0, v37
    v_mfma_f32_16x16x32_bf16 v[28:31], v[68:71], v[80:83], v[28:31]
    ds_read_b128 v[80:83], v167 offset:3584
    buffer_load_dwordx4 v158, s[60:63], s83 offen offset:2048 lds
    s_waitcnt vmcnt(11)
    v_cvt_pk_bf16_f32 v38, 0, v38
    v_cvt_pk_bf16_f32 v39, 0, v39
    v_mfma_f32_16x16x32_bf16 v[8:11], v[68:71], v[84:87], v[8:11]
    ds_read_b128 v[208:211], v156 offset:12288
    v_mfma_f32_16x16x32_bf16 v[16:19], v[88:91], v[84:87], v[16:19]
    ds_read_b128 v[212:215], v157 offset:12288
    v_mfma_f32_16x16x32_bf16 v[20:23], v[60:63], v[92:95], v[20:23]
    ds_read_b128 v[216:219], v156 offset:12800
    s_add_u32 s25, s22, s5
    v_mfma_f32_16x16x32_bf16 v[28:31], v[88:91], v[72:75], v[28:31]
    s_add_u32 s83, s83, 9216
    buffer_load_dwordx4 v158, s[56:59], s83 offen offset:1024 lds
    ds_read_b128 v[220:223], v157 offset:12800
    global_load_dword v169, v173, s[50:51] sc1
    v_mfma_f32_16x16x32_bf16 v[24:27], v[68:71], v[64:67], v[24:27]
    ds_read_b128 v[64:67], v167 offset:3072
    s_add_u32 s26, s23, s5
    v_mfma_f32_16x16x32_bf16 v[16:19], v[68:71], v[92:95], v[16:19]
    s_add_u32 s27, s24, s5
    s_waitcnt lgkmcnt(14)
    v_mfma_f32_16x16x32_bf16 v[28:31], v[96:99], v[76:79], v[28:31]
    s_cmp_eq_u32 s77, 2
    s_cselect_b32 s5, -122880, s13
    v_mfma_f32_16x16x32_bf16 v[12:15], v[60:63], v[84:87], v[12:15]
    buffer_load_dwordx4 v158, s[60:63], s83 offen offset:3072 lds
    s_add_u32 s28, s25, s5
    v_mfma_f32_16x16x32_bf16 v[24:27], v[88:91], v[92:95], v[24:27]
    s_add_u32 s29, s26, s5
    s_waitcnt lgkmcnt(9)
    v_mfma_f32_16x16x32_bf16 v[8:11], v[60:63], v[100:103], v[8:11]
    s_add_u32 s30, s27, s5
    v_mfma_f32_16x16x32_bf16 v[20:23], v[88:91], v[76:79], v[20:23]
    s_cmp_eq_u32 s77, 1
    s_cselect_b32 s5, -122880, s13
    v_mfma_f32_16x16x32_bf16 v[12:15], v[88:91], v[100:103], v[12:15]
    s_waitcnt lgkmcnt(1)
    s_add_u32 m0, s84, 12288
    s_add_u32 s83, s16, 46080
    buffer_load_dwordx4 v158, s[56:59], s83 offen offset:0 lds
    v_mfma_f32_16x16x32_bf16 v[24:27], v[60:63], v[72:75], v[24:27]
    ds_read_b128 v[72:75], v167 offset:2560
    v_mfma_f32_16x16x32_bf16 v[24:27], v[104:107], v[76:79], v[24:27]
    ds_read_b128 v[76:79], v167 offset:1536
    v_mfma_f32_16x16x32_bf16 v[4:7], v[60:63], v[108:111], v[4:7]
    ds_read2_b32 v[60:61], v166 offset0:176 offset1:177
    ds_read2_b32 v[62:63], v166 offset0:178 offset1:179
    v_mfma_f32_16x16x32_bf16 v[4:7], v[68:71], v[100:103], v[4:7]
    buffer_load_dwordx4 v158, s[60:63], s83 offen offset:2048 lds
    s_add_u32 s31, s28, s5
    v_mfma_f32_16x16x32_bf16 v[0:3], v[68:71], v[108:111], v[0:3]
    ds_read2_b32 v[68:69], v166 offset0:48 offset1:49
    ds_read2_b32 v[70:71], v166 offset0:50 offset1:51
    v_mfma_f32_16x16x32_bf16 v[28:31], v[112:115], v[84:87], v[28:31]
    s_add_u32 s32, s29, s5
    v_mfma_f32_16x16x32_bf16 v[28:31], v[116:119], v[100:103], v[28:31]
    s_add_u32 s33, s30, s5
    v_mfma_f32_16x16x32_bf16 v[24:27], v[96:99], v[84:87], v[24:27]
    s_add_u32 s83, s83, 9216
    buffer_load_dwordx4 v158, s[56:59], s83 offen offset:1024 lds
    v_mfma_f32_16x16x32_bf16 v[20:23], v[104:107], v[84:87], v[20:23]
    ds_read_b128 v[84:87], v167 offset:1024
    s_getpc_b64 s[4:5]
L_pc2:
    s_lshr_b32 s3, s2, 3
    s_lshl_b32 s3, s3, 2
    s_add_u32 s3, s3, s77
    s_lshl_b32 s3, s3, 8
    v_and_b32 v168, 1, v152
    v_lshl_add_u32 v168, v168, 7, s3
    v_min_u32 v168, L_last-L_pc2, v168
    global_load_dword v168, v168, s[4:5]
    v_mfma_f32_16x16x32_bf16 v[8:11], v[88:91], v[108:111], v[8:11]
    ds_read2_b32 v[88:89], v129 offset0:48 offset1:49
    ds_read2_b32 v[90:91], v129 offset0:50 offset1:51
    v_mfma_f32_16x16x32_bf16 v[28:31], v[104:107], v[92:95], v[28:31]
    ds_read_b128 v[92:95], v167 offset:2048
    v_mfma_f32_16x16x32_bf16 v[20:23], v[112:115], v[108:111], v[20:23]
    buffer_load_dwordx4 v158, s[60:63], s83 offen offset:3072 lds
    v_mfma_f32_16x16x32_bf16 v[16:19], v[96:99], v[108:111], v[16:19]
    v_mfma_f32_16x16x32_bf16 v[24:27], v[116:119], v[108:111], v[24:27]
    ds_read2_b32 v[116:117], v131 offset0:48 offset1:49
    ds_read2_b32 v[118:119], v131 offset0:50 offset1:51
    v_mfma_f32_16x16x32_bf16 v[20:23], v[96:99], v[100:103], v[20:23]
    ds_read2_b32 v[96:97], v130 offset0:48 offset1:49
    ds_read2_b32 v[98:99], v130 offset0:50 offset1:51
    v_mfma_f32_16x16x32_bf16 v[16:19], v[104:107], v[100:103], v[16:19]
    v_mfma_f32_16x16x32_bf16 v[12:15], v[104:107], v[108:111], v[12:15]
    ds_read2_b32 v[104:105], v129 offset0:176 offset1:177
    ds_read2_b32 v[106:107], v129 offset0:178 offset1:179
    v_mfma_f32_16x16x32_bf16 v[24:27], v[112:115], v[100:103], v[24:27]
    ds_read2_b32 v[112:113], v130 offset0:176 offset1:177
    ds_read2_b32 v[114:115], v130 offset0:178 offset1:179
    ds_read_b128 v[100:103], v167 offset:512
    v_mfma_f32_16x16x32_bf16 v[28:31], v[120:123], v[108:111], v[28:31]
    ds_read2_b32 v[120:121], v131 offset0:176 offset1:177
    ds_read2_b32 v[122:123], v131 offset0:178 offset1:179
    ds_read_b128 v[108:111], v167 offset:0
    s_cmp_lg_u32 s80, 0
    s_cbranch_scc1 Lv_5
    s_waitcnt lgkmcnt(15)
    v_mfma_f32_16x16x32_bf16 v[16:19], v[60:63], v[76:79], v[16:19]
    s_waitcnt vmcnt(14)
    v_mfma_f32_16x16x32_bf16 v[20:23], v[68:71], v[72:75], v[20:23]
    ds_read_b128 v[224:227], v156 offset:0
    v_mfma_f32_16x16x32_bf16 v[12:15], v[68:71], v[76:79], v[12:15]
    ds_read_b128 v[232:235], v156 offset:512
    v_mfma_f32_16x16x32_bf16 v[12:15], v[60:63], v[84:87], v[12:15]
    ds_read_b128 v[228:231], v157 offset:0
    s_waitcnt lgkmcnt(15)
    v_mfma_f32_16x16x32_bf16 v[20:23], v[88:91], v[76:79], v[20:23]
    ds_read_b128 v[236:239], v157 offset:512
    v_mfma_f32_16x16x32_bf16 v[20:23], v[60:63], v[92:95], v[20:23]
    v_mfma_f32_16x16x32_bf16 v[8:11], v[68:71], v[84:87], v[8:11]
    v_mfma_f32_16x16x32_bf16 v[16:19], v[88:91], v[84:87], v[16:19]
    s_waitcnt lgkmcnt(0)
    s_add_u32 m0, s84, 0
    s_add_u32 s83, s16, 0
    buffer_load_dwordx4 v158, s[56:59], s83 offen offset:0 lds
    v_mfma_f32_16x16x32_bf16 v[16:19], v[68:71], v[92:95], v[16:19]
    v_mfma_f32_16x16x32_bf16 v[20:23], v[104:107], v[84:87], v[20:23]
    v_mfma_f32_16x16x32_bf16 v[20:23], v[96:99], v[100:103], v[20:23]
    v_mfma_f32_16x16x32_bf16 v[16:19], v[104:107], v[100:103], v[16:19]
    buffer_load_dwordx4 v158, s[60:63], s83 offen offset:2048 lds
    s_waitcnt vmcnt(12)
    v_mfma_f32_16x16x32_bf16 v[8:11], v[60:63], v[100:103], v[8:11]
    ds_read_b128 v[240:243], v156 offset:4096
    s_waitcnt vmcnt(8)
L_fh0:
    v_cmp_ne_u32 vcc, s82, v169
    s_cbranch_vccnz L_fh_re0
    v_mfma_f32_16x16x32_bf16 v[16:19], v[96:99], v[108:111], v[16:19]
    ds_read_b128 v[248:251], v156 offset:4608
    v_mfma_f32_16x16x32_bf16 v[12:15], v[88:91], v[100:103], v[12:15]
    ds_read_b128 v[244:247], v157 offset:4096
    buffer_load_dwordx4 v[40:43], v175, s[64:67], s23 offen offset:0 sc1
    v_mfma_f32_16x16x32_bf16 v[8:11], v[88:91], v[108:111], v[8:11]
    s_add_u32 s83, s83, 9216
    buffer_load_dwordx4 v158, s[56:59], s83 offen offset:1024 lds
    ds_read_b128 v[252:255], v157 offset:4608
    v_mfma_f32_16x16x32_bf16 v[12:15], v[104:107], v[108:111], v[12:15]
    ds_write_b128 v170, v[16:19] offset:2048
    buffer_load_dwordx4 v[44:47], v175, s[64:67], s23 offen offset:1024 sc1
    v_mfma_f32_16x16x32_bf16 v[20:23], v[112:115], v[108:111], v[20:23]
    v_mfma_f32_16x16x32_bf16 v[28:31], v[120:123], v[108:111], v[28:31]
    ds_write_b128 v170, v[8:11] offset:0
    buffer_load_dwordx4 v[48:51], v175, s[64:67], s23 offen offset:2048 sc1
    v_mfma_f32_16x16x32_bf16 v[28:31], v[68:71], v[80:83], v[28:31]
    s_nop 0
    ds_write_b128 v170, v[12:15] offset:1024
    buffer_load_dwordx4 v158, s[60:63], s83 offen offset:3072 lds
    v_mfma_f32_16x16x32_bf16 v[24:27], v[116:119], v[108:111], v[24:27]
    ds_write_b128 v170, v[20:23] offset:3072
    buffer_load_dwordx4 v[120:123], v175, s[64:67], s22 offen offset:0 sc1
    v_mfma_f32_16x16x32_bf16 v[28:31], v[116:119], v[100:103], v[28:31]
    v_mfma_f32_16x16x32_bf16 v[24:27], v[68:71], v[64:67], v[24:27]
    v_mfma_f32_16x16x32_bf16 v[28:31], v[60:63], v[64:67], v[28:31]
    s_waitcnt lgkmcnt(4)
    s_add_u32 m0, s84, 4096
    s_add_u32 s83, s16, 5120
    buffer_load_dwordx4 v158, s[56:59], s83 offen offset:0 lds
    buffer_load_dwordx4 v[80:83], v175, s[64:67], s25 offen offset:0 sc1
    v_mfma_f32_16x16x32_bf16 v[0:3], v[68:71], v[108:111], v[0:3]
    v_mfma_f32_16x16x32_bf16 v[4:7], v[68:71], v[100:103], v[4:7]
    v_mfma_f32_16x16x32_bf16 v[4:7], v[60:63], v[108:111], v[4:7]
    buffer_load_dwordx4 v[116:119], v175, s[64:67], s28 offen offset:0 sc1
    v_mfma_f32_16x16x32_bf16 v[24:27], v[112:115], v[100:103], v[24:27]
    buffer_load_dwordx4 v158, s[60:63], s83 offen offset:2048 lds
    v_mfma_f32_16x16x32_bf16 v[24:27], v[60:63], v[72:75], v[24:27]
    v_mfma_f32_16x16x32_bf16 v[28:31], v[112:115], v[84:87], v[28:31]
    buffer_load_dwordx4 v[64:67], v175, s[64:67], s31 offen offset:0 sc1
    s_waitcnt lgkmcnt(0)
    s_barrier
    v_mfma_f32_16x16x32_bf16 v[28:31], v[88:91], v[72:75], v[28:31]
    ds_read_b128 v[8:11], v171 offset:0
    v_mfma_f32_16x16x32_bf16 v[24:27], v[96:99], v[84:87], v[24:27]
    ds_read_b128 v[12:15], v171 offset:1024
    s_add_u32 s83, s83, 9216
    buffer_load_dwordx4 v158, s[56:59], s83 offen offset:1024 lds
    v_mfma_f32_16x16x32_bf16 v[24:27], v[88:91], v[92:95], v[24:27]
    ds_read_b128 v[16:19], v171 offset:2048
    v_mfma_f32_16x16x32_bf16 v[24:27], v[104:107], v[76:79], v[24:27]
    ds_read_b128 v[20:23], v171 offset:3072
    v_mfma_f32_16x16x32_bf16 v[28:31], v[96:99], v[76:79], v[28:31]
    v_mfma_f32_16x16x32_bf16 v[28:31], v[104:107], v[92:95], v[28:31]
    buffer_load_dwordx4 v158, s[60:63], s83 offen offset:3072 lds
    s_branch Lw_6
Lv_5:
    s_waitcnt lgkmcnt(15)
    v_mfma_f32_16x16x32_bf16 v[24:27], v[68:71], v[64:67], v[24:27]
    s_waitcnt vmcnt(14)
    v_mfma_f32_16x16x32_bf16 v[28:31], v[60:63], v[64:67], v[28:31]
    ds_read_b128 v[224:227], v156 offset:0
    v_mfma_f32_16x16x32_bf16 v[24:27], v[60:63], v[72:75], v[24:27]
    ds_read_b128 v[232:235], v156 offset:512
    v_mfma_f32_16x16x32_bf16 v[28:31], v[68:71], v[80:83], v[28:31]
    ds_read_b128 v[228:231], v157 offset:0
    s_waitcnt lgkmcnt(15)
    v_mfma_f32_16x16x32_bf16 v[28:31], v[88:91], v[72:75], v[28:31]
    ds_read_b128 v[236:239], v157 offset:512
    v_mfma_f32_16x16x32_bf16 v[24:27], v[88:91], v[92:95], v[24:27]
    s_waitcnt lgkmcnt(12)
    v_mfma_f32_16x16x32_bf16 v[28:31], v[96:99], v[76:79], v[28:31]
    v_mfma_f32_16x16x32_bf16 v[24:27], v[96:99], v[84:87], v[24:27]
    s_waitcnt lgkmcnt(0)
    s_add_u32 m0, s84, 0
    s_add_u32 s83, s16, 0
    buffer_load_dwordx4 v158, s[56:59], s83 offen offset:0 lds
    v_mfma_f32_16x16x32_bf16 v[24:27], v[104:107], v[76:79], v[24:27]
    v_mfma_f32_16x16x32_bf16 v[28:31], v[104:107], v[92:95], v[28:31]
    v_mfma_f32_16x16x32_bf16 v[4:7], v[68:71], v[100:103], v[4:7]
    v_mfma_f32_16x16x32_bf16 v[28:31], v[116:119], v[100:103], v[28:31]
    buffer_load_dwordx4 v158, s[60:63], s83 offen offset:2048 lds
    s_waitcnt vmcnt(12)
    v_mfma_f32_16x16x32_bf16 v[4:7], v[60:63], v[108:111], v[4:7]
    ds_read_b128 v[240:243], v156 offset:4096
    s_waitcnt vmcnt(8)
L_fh1:
    v_cmp_ne_u32 vcc, s82, v169
    s_cbranch_vccnz L_fh_re1
    v_mfma_f32_16x16x32_bf16 v[0:3], v[68:71], v[108:111], v[0:3]
    ds_read_b128 v[248:251], v156 offset:4608
    v_mfma_f32_16x16x32_bf16 v[24:27], v[112:115], v[100:103], v[24:27]
    ds_read_b128 v[244:247], v157 offset:4096
    buffer_load_dwordx4 v[40:43], v175, s[64:67], s23 offen offset:0 sc1
    v_mfma_f32_16x16x32_bf16 v[24:27], v[116:119], v[108:111], v[24:27]
    ds_write_b128 v170, v[4:7] offset:1024
    s_add_u32 s83, s83, 9216
    buffer_load_dwordx4 v158, s[56:59], s83 offen offset:1024 lds
    ds_read_b128 v[252:255], v157 offset:4608
    v_mfma_f32_16x16x32_bf16 v[28:31], v[120:123], v[108:111], v[28:31]
    ds_write_b128 v170, v[0:3] offset:0
    buffer_load_dwordx4 v[44:47], v175, s[64:67], s23 offen offset:1024 sc1
    v_mfma_f32_16x16x32_bf16 v[28:31], v[112:115], v[84:87], v[28:31]
    v_mfma_f32_16x16x32_bf16 v[12:15], v[60:63], v[84:87], v[12:15]
    ds_write_b128 v170, v[24:27] offset:2048
    buffer_load_dwordx4 v[48:51], v175, s[64:67], s23 offen offset:2048 sc1
    v_mfma_f32_16x16x32_bf16 v[12:15], v[88:91], v[100:103], v[12:15]
    buffer_load_dwordx4 v158, s[60:63], s83 offen offset:3072 lds
    v_mfma_f32_16x16x32_bf16 v[12:15], v[104:107], v[108:111], v[12:15]
    s_nop 1
    ds_write_b128 v170, v[28:31] offset:3072
    buffer_load_dwordx4 v[120:123], v175, s[64:67], s22 offen offset:0 sc1
    v_mfma_f32_16x16x32_bf16 v[8:11], v[88:91], v[108:111], v[8:11]
    v_mfma_f32_16x16x32_bf16 v[8:11], v[68:71], v[84:87], v[8:11]
    v_mfma_f32_16x16x32_bf16 v[12:15], v[68:71], v[76:79], v[12:15]
    s_waitcnt lgkmcnt(3)
    s_add_u32 m0, s84, 4096
    s_add_u32 s83, s16, 5120
    buffer_load_dwordx4 v158, s[56:59], s83 offen offset:0 lds
    buffer_load_dwordx4 v[80:83], v175, s[64:67], s25 offen offset:0 sc1
    v_mfma_f32_16x16x32_bf16 v[8:11], v[60:63], v[100:103], v[8:11]
    v_mfma_f32_16x16x32_bf16 v[16:19], v[96:99], v[108:111], v[16:19]
    v_mfma_f32_16x16x32_bf16 v[16:19], v[68:71], v[92:95], v[16:19]
    buffer_load_dwordx4 v[116:119], v175, s[64:67], s28 offen offset:0 sc1
    v_mfma_f32_16x16x32_bf16 v[20:23], v[104:107], v[84:87], v[20:23]
    buffer_load_dwordx4 v158, s[60:63], s83 offen offset:2048 lds
    v_mfma_f32_16x16x32_bf16 v[20:23], v[88:91], v[76:79], v[20:23]
    v_mfma_f32_16x16x32_bf16 v[20:23], v[60:63], v[92:95], v[20:23]
    buffer_load_dwordx4 v[64:67], v175, s[64:67], s31 offen offset:0 sc1
    s_waitcnt lgkmcnt(0)
    s_barrier
    v_mfma_f32_16x16x32_bf16 v[16:19], v[104:107], v[100:103], v[16:19]
    ds_read_b128 v[0:3], v171 offset:0
    v_mfma_f32_16x16x32_bf16 v[16:19], v[60:63], v[76:79], v[16:19]
    ds_read_b128 v[4:7], v171 offset:1024
    s_add_u32 s83, s83, 9216
    buffer_load_dwordx4 v158, s[56:59], s83 offen offset:1024 lds
    v_mfma_f32_16x16x32_bf16 v[20:23], v[68:71], v[72:75], v[20:23]
    ds_read_b128 v[24:27], v171 offset:2048
    v_mfma_f32_16x16x32_bf16 v[16:19], v[88:91], v[84:87], v[16:19]
    ds_read_b128 v[28:31], v171 offset:3072
    v_mfma_f32_16x16x32_bf16 v[20:23], v[112:115], v[108:111], v[20:23]
    v_mfma_f32_16x16x32_bf16 v[20:23], v[96:99], v[100:103], v[20:23]
    buffer_load_dwordx4 v158, s[60:63], s83 offen offset:3072 lds
Lw_6:
    s_waitcnt vmcnt(12)
    v_mfma_f32_16x16x32_bf16 v[132:135], a[232:235], v[40:43], v[132:135]
    s_waitcnt lgkmcnt(2)
    v_add_f32 v0, v0, v8
    v_add_f32 v1, v1, v9
    v_mfma_f32_16x16x32_bf16 v[136:139], v[176:179], v[40:43], v[136:139]
    v_add_f32 v2, v2, v10
    v_add_f32 v3, v3, v11
    v_mfma_f32_16x16x32_bf16 v[140:143], v[192:195], v[40:43], v[140:143]
    buffer_load_dwordx4 v[60:63], v175, s[64:67], s22 offen offset:1024 sc1
    v_add_f32 v4, v4, v12
    v_add_f32 v5, v5, v13
    v_mfma_f32_16x16x32_bf16 v[144:147], v[208:211], v[40:43], v[144:147]
    v_add_f32 v6, v6, v14
    v_add_f32 v7, v7, v15
    v_mfma_f32_16x16x32_bf16 v[148:151], a[216:219], v[40:43], v[148:151]
    v_cvt_pk_bf16_f32 v0, 0, v0
    v_cvt_pk_bf16_f32 v1, 0, v1
    s_waitcnt vmcnt(11)
    v_mfma_f32_16x16x32_bf16 v[132:135], a[236:239], v[44:47], v[132:135]
    v_cvt_pk_bf16_f32 v2, 0, v2
    v_cvt_pk_bf16_f32 v3, 0, v3
    v_mfma_f32_16x16x32_bf16 v[136:139], v[180:183], v[44:47], v[136:139]
    buffer_load_dwordx4 v[68:71], v175, s[64:67], s25 offen offset:1024 sc1
    v_cvt_pk_bf16_f32 v4, 0, v4
    v_cvt_pk_bf16_f32 v5, 0, v5
    v_mfma_f32_16x16x32_bf16 v[140:143], v[196:199], v[44:47], v[140:143]
    v_cvt_pk_bf16_f32 v6, 0, v6
    v_cvt_pk_bf16_f32 v7, 0, v7
    v_mfma_f32_16x16x32_bf16 v[144:147], v[212:215], v[44:47], v[144:147]
    ds_read_b128 v[124:127], v156 offset:8192
    v_add_f32 v0, v0, v52
    v_add_f32 v1, v1, v53
    v_mfma_f32_16x16x32_bf16 v[148:151], a[220:223], v[44:47], v[148:151]
    v_add_f32 v2, v2, v54
    v_add_f32 v3, v3, v55
    s_waitcnt vmcnt(11)
    v_mfma_f32_16x16x32_bf16 v[132:135], a[240:243], v[48:51], v[132:135]
    buffer_load_dwordx4 v[72:75], v175, s[64:67], s28 offen offset:1024 sc1
    v_add_f32 v4, v4, v56
    v_add_f32 v5, v5, v57
    v_mfma_f32_16x16x32_bf16 v[136:139], v[184:187], v[48:51], v[136:139]
    v_add_f32 v6, v6, v58
    v_add_f32 v7, v7, v59
    v_mfma_f32_16x16x32_bf16 v[140:143], v[200:203], v[48:51], v[140:143]
    ds_read_b128 v[128:131], v156 offset:12288
    v_cvt_pk_bf16_f32 v170, v0, v1
    v_cvt_pk_bf16_f32 v171, v2, v3
    v_mfma_f32_16x16x32_bf16 v[144:147], v[216:219], v[48:51], v[144:147]
    v_cvt_pk_bf16_f32 v172, v4, v5
    v_cvt_pk_bf16_f32 v173, v6, v7
    v_mfma_f32_16x16x32_bf16 v[148:151], a[224:227], v[48:51], v[148:151]
    buffer_load_dwordx4 v[76:79], v175, s[64:67], s31 offen offset:1024 sc1
    v_permlane16_swap_b32 v170, v172
    s_waitcnt vmcnt(9)
    v_mfma_f32_16x16x32_bf16 v[148:151], a[200:203], v[120:123], v[148:151]
    v_permlane16_swap_b32 v171, v173
    v_mfma_f32_16x16x32_bf16 v[40:43], a[200:203], v[80:83], 0
    ds_read_b128 v[112:115], v156 offset:0
    s_waitcnt lgkmcnt(3)
    v_add_f32 v16, v16, v24
    v_add_f32 v17, v17, v25
    s_waitcnt vmcnt(6)
    v_mfma_f32_16x16x32_bf16 v[44:47], a[200:203], v[116:119], 0
    v_add_f32 v18, v18, v26
    v_add_f32 v19, v19, v27
    v_mfma_f32_16x16x32_bf16 v[48:51], a[200:203], v[64:67], 0
    buffer_load_dwordx4 v[84:87], v175, s[64:67], s22 offen offset:2048 sc1
    v_add_f32 v20, v20, v28
    v_add_f32 v21, v21, v29
    s_waitcnt lgkmcnt(2)
    v_mfma_f32_16x16x32_bf16 v[140:143], v[124:127], v[120:123], v[140:143]
    v_add_f32 v22, v22, v30
    v_add_f32 v23, v23, v31
    v_mfma_f32_16x16x32_bf16 v[52:55], v[124:127], v[80:83], 0
    v_cvt_pk_bf16_f32 v16, 0, v16
    v_cvt_pk_bf16_f32 v17, 0, v17
    v_mfma_f32_16x16x32_bf16 v[56:59], v[124:127], v[116:119], 0
    v_cvt_pk_bf16_f32 v18, 0, v18
    v_cvt_pk_bf16_f32 v19, 0, v19
    v_mfma_f32_16x16x32_bf16 v[0:3], v[124:127], v[64:67], 0
    s_waitcnt vmcnt(5)
    ds_read_b128 v[124:127], v156 offset:4096
    buffer_load_dwordx4 v[88:91], v175, s[64:67], s25 offen offset:2048 sc1
    v_cvt_pk_bf16_f32 v20, 0, v20
    v_cvt_pk_bf16_f32 v21, 0, v21
    s_waitcnt lgkmcnt(2)
    v_mfma_f32_16x16x32_bf16 v[144:147], v[128:131], v[120:123], v[144:147]
    v_cvt_pk_bf16_f32 v22, 0, v22
    v_cvt_pk_bf16_f32 v23, 0, v23
    v_mfma_f32_16x16x32_bf16 v[4:7], v[128:131], v[80:83], 0
    v_add_f32 v16, v16, v32
    v_add_f32 v17, v17, v33
    v_mfma_f32_16x16x32_bf16 v[8:11], v[128:131], v[116:119], 0
    v_add_f32 v18, v18, v34
    v_add_f32 v19, v19, v35
    v_mfma_f32_16x16x32_bf16 v[12:15], v[128:131], v[64:67], 0
    ds_read_b128 v[128:131], v157 offset:8192
    buffer_load_dwordx4 v[92:95], v175, s[64:67], s28 offen offset:2048 sc1
    v_add_f32 v20, v20, v36
    v_add_f32 v21, v21, v37
    s_waitcnt lgkmcnt(2)
    v_mfma_f32_16x16x32_bf16 v[132:135], v[112:115], v[120:123], v[132:135]
    v_add_f32 v22, v22, v38
    v_add_f32 v23, v23, v39
    v_mfma_f32_16x16x32_bf16 v[28:31], v[112:115], v[80:83], 0
    v_cvt_pk_bf16_f32 v166, v16, v17
    v_cvt_pk_bf16_f32 v167, v18, v19
    v_mfma_f32_16x16x32_bf16 v[32:35], v[112:115], v[116:119], 0
    v_cvt_pk_bf16_f32 v168, v20, v21
    v_cvt_pk_bf16_f32 v169, v22, v23
    v_mfma_f32_16x16x32_bf16 v[36:39], v[112:115], v[64:67], 0
    ds_read_b128 v[112:115], v157 offset:12288
    buffer_load_dwordx4 v[96:99], v175, s[64:67], s31 offen offset:2048 sc1
    v_permlane16_swap_b32 v166, v168
    s_waitcnt lgkmcnt(2)
    v_mfma_f32_16x16x32_bf16 v[136:139], v[124:127], v[120:123], v[136:139]
    v_permlane16_swap_b32 v167, v169
    v_mfma_f32_16x16x32_bf16 v[16:19], v[124:127], v[80:83], 0
    v_mfma_f32_16x16x32_bf16 v[20:23], v[124:127], v[116:119], 0
    v_mfma_f32_16x16x32_bf16 v[24:27], v[124:127], v[64:67], 0
    ds_read_b128 v[124:127], v157 offset:0
    buffer_load_dwordx4 v[100:103], v175, s[64:67], s22 offen offset:3072 sc1
    s_waitcnt vmcnt(7)
    v_mfma_f32_16x16x32_bf16 v[148:151], a[204:207], v[60:63], v[148:151]
    v_mfma_f32_16x16x32_bf16 v[40:43], a[204:207], v[68:71], v[40:43]
    buffer_store_dwordx4 v[170:173], v164, s[68:71], s38 offen sc1
    buffer_store_dwordx4 v[166:169], v164, s[68:71], s39 offen sc1
    s_waitcnt vmcnt(7)
    v_mfma_f32_16x16x32_bf16 v[44:47], a[204:207], v[72:75], v[44:47]
    v_mfma_f32_16x16x32_bf16 v[48:51], a[204:207], v[76:79], v[48:51]
    buffer_load_dwordx4 v[104:107], v175, s[64:67], s25 offen offset:3072 sc1
    s_waitcnt lgkmcnt(2)
    v_mfma_f32_16x16x32_bf16 v[140:143], v[128:131], v[60:63], v[140:143]
    s_movk_i32 s9, 0x70
    v_lshrrev_b32 v164, 3, v152
    v_mfma_f32_16x16x32_bf16 v[52:55], v[128:131], v[68:71], v[52:55]
    v_lshlrev_b32 v164, 12, v164
    v_and_or_b32 v164, v153, s9, v164
    v_mfma_f32_16x16x32_bf16 v[56:59], v[128:131], v[72:75], v[56:59]
    s_mul_i32 s6, s78, 327680
    s_lshl_b32 s5, s79, 7
    v_mfma_f32_16x16x32_bf16 v[0:3], v[128:131], v[76:79], v[0:3]
    ds_read_b128 v[128:131], v157 offset:4096
    buffer_load_dwordx4 v[108:111], v175, s[64:67], s28 offen offset:3072 sc1
    s_waitcnt lgkmcnt(2)
    v_mfma_f32_16x16x32_bf16 v[144:147], v[112:115], v[60:63], v[144:147]
    s_add_u32 s6, s6, s5
    s_lshl_b32 s5, s77, 14
    v_mfma_f32_16x16x32_bf16 v[4:7], v[112:115], v[68:71], v[4:7]
    s_add_u32 s7, s6, s5
    s_add_u32 s7, s7, 262144
    v_mfma_f32_16x16x32_bf16 v[8:11], v[112:115], v[72:75], v[8:11]
    s_lshl_b32 s5, s77, 16
    s_add_u32 s6, s6, s5
    v_mfma_f32_16x16x32_bf16 v[12:15], v[112:115], v[76:79], v[12:15]
    ds_read_b128 v[112:115], v156 offset:8704
    buffer_load_dwordx4 v[120:123], v175, s[64:67], s31 offen offset:3072 sc1
    s_waitcnt lgkmcnt(2)
    v_mfma_f32_16x16x32_bf16 v[132:135], v[124:127], v[60:63], v[132:135]
    s_mov_b32 s5, 3145728
    s_add_u32 s6, s6, s5
    v_mfma_f32_16x16x32_bf16 v[28:31], v[124:127], v[68:71], v[28:31]
    s_add_u32 s7, s7, s5
    s_lshl_b32 s5, s77, 9
    v_mfma_f32_16x16x32_bf16 v[32:35], v[124:127], v[72:75], v[32:35]
    s_mul_i32 s4, s77, 15360
    v_add_u32 v154, s4, v153
    v_mfma_f32_16x16x32_bf16 v[36:39], v[124:127], v[76:79], v[36:39]
    ds_read_b128 v[124:127], v156 offset:12800
    buffer_load_dwordx4 v[80:83], v175, s[64:67], s26 offen offset:0 sc1
    s_waitcnt lgkmcnt(2)
    v_mfma_f32_16x16x32_bf16 v[136:139], v[128:131], v[60:63], v[136:139]
    v_and_b32 v155, 0xf0, v153
    v_lshrrev_b32 v163, 4, v152
    v_mfma_f32_16x16x32_bf16 v[16:19], v[128:131], v[68:71], v[16:19]
    v_lshl_add_u32 v163, v163, 9, v155
    v_lshrrev_b32 v172, 5, v152
    v_mfma_f32_16x16x32_bf16 v[20:23], v[128:131], v[72:75], v[20:23]
    v_lshl_add_u32 v155, v172, 3, v155
    v_mfma_f32_16x16x32_bf16 v[24:27], v[128:131], v[76:79], v[24:27]
    ds_read_b128 v[128:131], v156 offset:512
    buffer_load_dwordx4 v[116:119], v175, s[64:67], s26 offen offset:1024 sc1
    s_waitcnt vmcnt(10)
    v_mfma_f32_16x16x32_bf16 v[148:151], a[208:211], v[84:87], v[148:151]
    s_lshl_b32 s4, s78, 8
    v_add_u32 v155, s4, v155
    v_mfma_f32_16x16x32_bf16 v[40:43], a[208:211], v[88:91], v[40:43]
    s_lshl_b32 s4, s79, 13
    s_waitcnt vmcnt(8)
    v_mfma_f32_16x16x32_bf16 v[44:47], a[208:211], v[92:95], v[44:47]
    s_add_u32 s4, s4, s100
    s_add_u32 s4, s4, 10485760
    v_mfma_f32_16x16x32_bf16 v[48:51], a[208:211], v[96:99], v[48:51]
    buffer_load_dwordx4 v[64:67], v175, s[64:67], s26 offen offset:2048 sc1
    s_waitcnt lgkmcnt(2)
    v_mfma_f32_16x16x32_bf16 v[140:143], v[112:115], v[84:87], v[140:143]
    s_add_u32 s98, s50, s4
    s_addc_u32 s99, s51, 0
    v_mfma_f32_16x16x32_bf16 v[52:55], v[112:115], v[88:91], v[52:55]
    s_add_u32 s4, s100, 61440
    v_lshl_add_u32 v170, v152, 3, s4
    v_mfma_f32_16x16x32_bf16 v[56:59], v[112:115], v[92:95], v[56:59]
    s_add_u32 s4, s5, 69632
    v_lshl_add_u32 v171, v152, 3, s4
    v_mfma_f32_16x16x32_bf16 v[0:3], v[112:115], v[96:99], v[0:3]
    ds_read_b128 v[112:115], v156 offset:4608
    buffer_load_dwordx4 v[60:63], v175, s[64:67], s26 offen offset:3072 sc1
    s_waitcnt lgkmcnt(2)
    v_mfma_f32_16x16x32_bf16 v[144:147], v[124:127], v[84:87], v[144:147]
    v_mfma_f32_16x16x32_bf16 v[4:7], v[124:127], v[88:91], v[4:7]
    v_mfma_f32_16x16x32_bf16 v[8:11], v[124:127], v[92:95], v[8:11]
    v_mfma_f32_16x16x32_bf16 v[12:15], v[124:127], v[96:99], v[12:15]
    ds_read_b128 v[124:127], v157 offset:8704
    buffer_load_dwordx4 v[68:71], v175, s[64:67], s27 offen offset:0 sc1
    s_waitcnt lgkmcnt(2)
    v_mfma_f32_16x16x32_bf16 v[132:135], v[128:131], v[84:87], v[132:135]
    v_mfma_f32_16x16x32_bf16 v[28:31], v[128:131], v[88:91], v[28:31]
    v_mfma_f32_16x16x32_bf16 v[32:35], v[128:131], v[92:95], v[32:35]
    v_mfma_f32_16x16x32_bf16 v[36:39], v[128:131], v[96:99], v[36:39]
    ds_read_b128 v[128:131], v157 offset:12800
    buffer_load_dwordx4 v[72:75], v175, s[64:67], s27 offen offset:1024 sc1
    s_waitcnt lgkmcnt(2)
    v_mfma_f32_16x16x32_bf16 v[136:139], v[112:115], v[84:87], v[136:139]
    v_mfma_f32_16x16x32_bf16 v[16:19], v[112:115], v[88:91], v[16:19]
    v_mfma_f32_16x16x32_bf16 v[20:23], v[112:115], v[92:95], v[20:23]
    v_mfma_f32_16x16x32_bf16 v[24:27], v[112:115], v[96:99], v[24:27]
    ds_read_b128 v[112:115], v157 offset:512
    buffer_load_dwordx4 v[76:79], v175, s[64:67], s29 offen offset:0 sc1
    s_waitcnt vmcnt(9)
    v_mfma_f32_16x16x32_bf16 v[148:151], a[212:215], v[100:103], v[148:151]
    v_mfma_f32_16x16x32_bf16 v[40:43], a[212:215], v[104:107], v[40:43]
    s_waitcnt vmcnt(7)
    v_mfma_f32_16x16x32_bf16 v[44:47], a[212:215], v[108:111], v[44:47]
    v_mfma_f32_16x16x32_bf16 v[48:51], a[212:215], v[120:123], v[48:51]
    buffer_load_dwordx4 v[84:87], v175, s[64:67], s29 offen offset:1024 sc1
    s_waitcnt lgkmcnt(2)
    v_mfma_f32_16x16x32_bf16 v[140:143], v[124:127], v[100:103], v[140:143]
    v_mfma_f32_16x16x32_bf16 v[52:55], v[124:127], v[104:107], v[52:55]
    v_mfma_f32_16x16x32_bf16 v[56:59], v[124:127], v[108:111], v[56:59]
    v_mfma_f32_16x16x32_bf16 v[0:3], v[124:127], v[120:123], v[0:3]
    ds_read_b128 v[124:127], v157 offset:4608
    buffer_load_dwordx4 v[88:91], v175, s[64:67], s29 offen offset:2048 sc1
    s_waitcnt lgkmcnt(2)
    v_mfma_f32_16x16x32_bf16 v[144:147], v[128:131], v[100:103], v[144:147]
    v_mfma_f32_16x16x32_bf16 v[4:7], v[128:131], v[104:107], v[4:7]
    v_mfma_f32_16x16x32_bf16 v[8:11], v[128:131], v[108:111], v[8:11]
    v_mfma_f32_16x16x32_bf16 v[12:15], v[128:131], v[120:123], v[12:15]
    buffer_load_dwordx4 v[92:95], v175, s[64:67], s29 offen offset:3072 sc1
    s_waitcnt lgkmcnt(1)
    v_mfma_f32_16x16x32_bf16 v[132:135], v[112:115], v[100:103], v[132:135]
    v_mfma_f32_16x16x32_bf16 v[28:31], v[112:115], v[104:107], v[28:31]
    v_mfma_f32_16x16x32_bf16 v[32:35], v[112:115], v[108:111], v[32:35]
    v_mfma_f32_16x16x32_bf16 v[36:39], v[112:115], v[120:123], v[36:39]
    buffer_load_dwordx4 v[96:99], v175, s[64:67], s30 offen offset:0 sc1
    s_waitcnt lgkmcnt(0)
    v_mfma_f32_16x16x32_bf16 v[136:139], v[124:127], v[100:103], v[136:139]
    v_mfma_f32_16x16x32_bf16 v[16:19], v[124:127], v[104:107], v[16:19]
    v_mfma_f32_16x16x32_bf16 v[20:23], v[124:127], v[108:111], v[20:23]
    v_mfma_f32_16x16x32_bf16 v[24:27], v[124:127], v[120:123], v[24:27]
    buffer_load_dwordx4 v[100:103], v175, s[64:67], s30 offen offset:1024 sc1
    s_waitcnt vmcnt(10)
    v_mfma_f32_16x16x32_bf16 v[28:31], a[232:235], v[80:83], v[28:31]
    v_mfma_f32_16x16x32_bf16 v[28:31], a[236:239], v[116:119], v[28:31]
    s_waitcnt vmcnt(8)
    v_mfma_f32_16x16x32_bf16 v[28:31], a[240:243], v[64:67], v[28:31]
    v_mfma_f32_16x16x32_bf16 v[28:31], a[244:247], v[60:63], v[28:31]
    buffer_load_dwordx4 v[104:107], v175, s[64:67], s32 offen offset:0 sc1
    s_waitcnt vmcnt(7)
    v_mfma_f32_16x16x32_bf16 v[28:31], v[224:227], v[68:71], v[28:31]
    s_add_u32 s3, s77, 1
    s_and_b32 s3, s3, 3
    v_mfma_f32_16x16x32_bf16 v[28:31], v[228:231], v[72:75], v[28:31]
    s_mul_i32 s3, s3, 15360
    v_add_u32 v165, s3, v153
    v_mfma_f32_16x16x32_bf16 v[16:19], v[176:179], v[80:83], v[16:19]
    v_mfma_f32_16x16x32_bf16 v[16:19], v[180:183], v[116:119], v[16:19]
    buffer_load_dwordx4 v[108:111], v175, s[64:67], s32 offen offset:1024 sc1
    s_mul_i32 s8, s79, 163840
    v_mov_b64 v[112:113], 0
    v_mov_b64 v[114:115], 0
    v_mfma_f32_16x16x32_bf16 v[16:19], v[184:187], v[64:67], v[16:19]
    s_mul_i32 s12, s77, 20480
    s_mul_i32 s9, s78, 2560
    v_mov_b64 v[124:125], 0
    v_mov_b64 v[126:127], 0
    v_mfma_f32_16x16x32_bf16 v[16:19], v[188:191], v[60:63], v[16:19]
    ds_write_b128 v165, v[28:31] offset:0
    s_add_u32 s9, s9, s8
    v_mov_b64 v[128:129], 0
    v_mov_b64 v[130:131], 0
    v_mfma_f32_16x16x32_bf16 v[16:19], v[232:235], v[68:71], v[16:19]
    s_lshl_b32 s85, s85, 4
    s_lshl_b32 s90, s90, 4
    v_mfma_f32_16x16x32_bf16 v[16:19], v[236:239], v[72:75], v[16:19]
    buffer_load_dwordx4 v[120:123], v175, s[64:67], s32 offen offset:2048 sc1
    s_lshl_b32 s72, s72, 4
    v_mfma_f32_16x16x32_bf16 v[52:55], v[192:195], v[80:83], v[52:55]
    s_add_u32 s72, s72, s8
    s_lshl_b32 s73, s73, 4
    v_mfma_f32_16x16x32_bf16 v[52:55], v[196:199], v[116:119], v[52:55]
    s_add_u32 s73, s73, s8
    s_lshl_b32 s74, s74, 4
    v_mfma_f32_16x16x32_bf16 v[52:55], v[200:203], v[64:67], v[52:55]
    s_add_u32 s74, s74, s8
    s_lshl_b32 s75, s75, 4
    v_mfma_f32_16x16x32_bf16 v[52:55], v[204:207], v[60:63], v[52:55]
    ds_write_b128 v165, v[16:19] offset:1024
    s_add_u32 s75, s75, s8
    v_mfma_f32_16x16x32_bf16 v[52:55], v[240:243], v[68:71], v[52:55]
    s_lshl_b32 s76, s76, 4
    s_add_u32 s76, s76, s8
    v_mfma_f32_16x16x32_bf16 v[52:55], v[244:247], v[72:75], v[52:55]
    s_lshl_b32 s8, s81, 13
    v_add_u32 v158, s8, v153
    v_mfma_f32_16x16x32_bf16 v[4:7], v[208:211], v[80:83], v[4:7]
    v_xor_b32 v159, 0x2000, v158
    v_add_u32 v173, s12, v153
    v_mfma_f32_16x16x32_bf16 v[4:7], v[212:215], v[116:119], v[4:7]
    s_add_u32 s12, s12, s9
    v_mfma_f32_16x16x32_bf16 v[4:7], v[216:219], v[64:67], v[4:7]
    v_mfma_f32_16x16x32_bf16 v[4:7], v[220:223], v[60:63], v[4:7]
    ds_write_b128 v165, v[52:55] offset:2048
    v_mfma_f32_16x16x32_bf16 v[4:7], v[248:251], v[68:71], v[4:7]
    v_mfma_f32_16x16x32_bf16 v[4:7], v[252:255], v[72:75], v[4:7]
    v_mfma_f32_16x16x32_bf16 v[40:43], a[216:219], v[80:83], v[40:43]
    buffer_load_dwordx4 v[80:83], v175, s[64:67], s32 offen offset:3072 sc1
    v_mfma_f32_16x16x32_bf16 v[40:43], a[220:223], v[116:119], v[40:43]
    v_mfma_f32_16x16x32_bf16 v[40:43], a[224:227], v[64:67], v[40:43]
    v_mfma_f32_16x16x32_bf16 v[40:43], a[228:231], v[60:63], v[40:43]
    s_nop 2
    ds_write_b128 v165, v[4:7] offset:3072
    v_mfma_f32_16x16x32_bf16 v[40:43], a[248:251], v[68:71], v[40:43]
    buffer_load_dwordx4 v[116:119], v175, s[64:67], s33 offen offset:0 sc1
    v_mfma_f32_16x16x32_bf16 v[40:43], a[252:255], v[72:75], v[40:43]
    s_waitcnt vmcnt(9)
    v_mfma_f32_16x16x32_bf16 v[32:35], a[232:235], v[76:79], v[32:35]
    v_mfma_f32_16x16x32_bf16 v[32:35], a[236:239], v[84:87], v[32:35]
    s_waitcnt vmcnt(7)
    v_mfma_f32_16x16x32_bf16 v[32:35], a[240:243], v[88:91], v[32:35]
    buffer_load_dwordx4 v[64:67], v175, s[64:67], s33 offen offset:1024 sc1
    v_mfma_f32_16x16x32_bf16 v[32:35], a[244:247], v[92:95], v[32:35]
    s_nop 0
    ds_write_b128 v165, v[40:43] offset:4096
    s_waitcnt vmcnt(6)
    v_mfma_f32_16x16x32_bf16 v[32:35], v[224:227], v[96:99], v[32:35]
    s_add_u32 s3, s77, 2
    s_and_b32 s3, s3, 3
    v_mfma_f32_16x16x32_bf16 v[32:35], v[228:231], v[100:103], v[32:35]
    s_mul_i32 s3, s3, 15360
    v_add_u32 v165, s3, v153
    v_mfma_f32_16x16x32_bf16 v[20:23], v[176:179], v[76:79], v[20:23]
    buffer_load_dwordx4 v[60:63], v175, s[64:67], s23 offen offset:3072 sc1
    v_mfma_f32_16x16x32_bf16 v[20:23], v[180:183], v[84:87], v[20:23]
    v_mfma_f32_16x16x32_bf16 v[20:23], v[184:187], v[88:91], v[20:23]
    v_mfma_f32_16x16x32_bf16 v[20:23], v[188:191], v[92:95], v[20:23]
    s_nop 0
    ds_write_b128 v165, v[32:35] offset:5120
    v_mfma_f32_16x16x32_bf16 v[20:23], v[232:235], v[96:99], v[20:23]
    buffer_load_dwordx4 v[68:71], v175, s[64:67], s24 offen offset:0 sc1
    v_mfma_f32_16x16x32_bf16 v[20:23], v[236:239], v[100:103], v[20:23]
    v_mfma_f32_16x16x32_bf16 v[56:59], v[192:195], v[76:79], v[56:59]
    v_mfma_f32_16x16x32_bf16 v[56:59], v[196:199], v[84:87], v[56:59]
    v_mfma_f32_16x16x32_bf16 v[56:59], v[200:203], v[88:91], v[56:59]
    buffer_load_dwordx4 v[72:75], v175, s[64:67], s24 offen offset:1024 sc1
    v_mfma_f32_16x16x32_bf16 v[56:59], v[204:207], v[92:95], v[56:59]
    s_nop 2
    ds_write_b128 v165, v[20:23] offset:6144
    s_lshl_b32 s8, s77, 2
    v_mfma_f32_16x16x32_bf16 v[56:59], v[240:243], v[96:99], v[56:59]
    s_add_u32 s8, s8, 61440
    v_bfe_u32 v172, v152, 2, 2
    v_mfma_f32_16x16x32_bf16 v[56:59], v[244:247], v[100:103], v[56:59]
    v_lshl_add_u32 v166, v172, 5, s8
    v_bfe_u32 v172, v152, 0, 1
    v_mfma_f32_16x16x32_bf16 v[8:11], v[208:211], v[76:79], v[8:11]
    v_lshl_add_u32 v166, v172, 4, v166
    v_bfe_u32 v172, v152, 1, 1
    v_mfma_f32_16x16x32_bf16 v[8:11], v[212:215], v[84:87], v[8:11]
    v_lshl_add_u32 v166, v172, 1, v166
    v_lshrrev_b32 v172, 4, v152
    v_mfma_f32_16x16x32_bf16 v[8:11], v[216:219], v[88:91], v[8:11]
    v_lshl_add_u32 v167, v172, 9, v166
    v_lshl_add_u32 v166, v172, 10, v166
    v_mfma_f32_16x16x32_bf16 v[8:11], v[220:223], v[92:95], v[8:11]
    ds_write_b128 v165, v[56:59] offset:7168
    v_mfma_f32_16x16x32_bf16 v[8:11], v[248:251], v[96:99], v[8:11]
    v_mfma_f32_16x16x32_bf16 v[8:11], v[252:255], v[100:103], v[8:11]
    v_mfma_f32_16x16x32_bf16 v[44:47], a[216:219], v[76:79], v[44:47]
    v_mfma_f32_16x16x32_bf16 v[44:47], a[220:223], v[84:87], v[44:47]
    v_mfma_f32_16x16x32_bf16 v[44:47], a[224:227], v[88:91], v[44:47]
    v_mfma_f32_16x16x32_bf16 v[44:47], a[228:231], v[92:95], v[44:47]
    s_nop 3
    ds_write_b128 v165, v[8:11] offset:8192
    v_mfma_f32_16x16x32_bf16 v[44:47], a[248:251], v[96:99], v[44:47]
    v_mfma_f32_16x16x32_bf16 v[44:47], a[252:255], v[100:103], v[44:47]
    s_waitcnt vmcnt(7)
    v_mfma_f32_16x16x32_bf16 v[36:39], a[232:235], v[104:107], v[36:39]
    v_mfma_f32_16x16x32_bf16 v[36:39], a[236:239], v[108:111], v[36:39]
    s_waitcnt vmcnt(5)
    v_mfma_f32_16x16x32_bf16 v[36:39], a[240:243], v[120:123], v[36:39]
    v_mfma_f32_16x16x32_bf16 v[36:39], a[244:247], v[80:83], v[36:39]
    s_nop 1
    ds_write_b128 v165, v[44:47] offset:9216
    s_waitcnt vmcnt(3)
    v_mfma_f32_16x16x32_bf16 v[36:39], v[224:227], v[116:119], v[36:39]
    s_add_u32 s3, s77, 3
    s_and_b32 s3, s3, 3
    v_mfma_f32_16x16x32_bf16 v[36:39], v[228:231], v[64:67], v[36:39]
    s_mul_i32 s3, s3, 15360
    v_add_u32 v165, s3, v153
    v_mfma_f32_16x16x32_bf16 v[24:27], v[176:179], v[104:107], v[24:27]
    v_mfma_f32_16x16x32_bf16 v[24:27], v[180:183], v[108:111], v[24:27]
    v_mfma_f32_16x16x32_bf16 v[24:27], v[184:187], v[120:123], v[24:27]
    v_mfma_f32_16x16x32_bf16 v[24:27], v[188:191], v[80:83], v[24:27]
    s_nop 1
    ds_write_b128 v165, v[36:39] offset:10240
    v_mfma_f32_16x16x32_bf16 v[24:27], v[232:235], v[116:119], v[24:27]
    v_mfma_f32_16x16x32_bf16 v[24:27], v[236:239], v[64:67], v[24:27]
    s_waitcnt lgkmcnt(1)
    s_barrier
    v_mfma_f32_16x16x32_bf16 v[0:3], v[192:195], v[104:107], v[0:3]
    ds_read_b128 v[28:31], v154 offset:0
    v_mfma_f32_16x16x32_bf16 v[0:3], v[196:199], v[108:111], v[0:3]
    ds_read_b128 v[16:19], v154 offset:1024
    s_add_u32 m0, s100, 61440
    s_nop 0
    buffer_load_dwordx4 v164, s[68:71], s6 offen sc1 lds
    v_mfma_f32_16x16x32_bf16 v[0:3], v[200:203], v[120:123], v[0:3]
    ds_read_b128 v[52:55], v154 offset:2048
    v_mfma_f32_16x16x32_bf16 v[0:3], v[204:207], v[80:83], v[0:3]
    ds_read_b128 v[4:7], v154 offset:3072
    ds_write_b128 v165, v[24:27] offset:11264
    v_mfma_f32_16x16x32_bf16 v[0:3], v[240:243], v[116:119], v[0:3]
    ds_read_b128 v[40:43], v154 offset:4096
    s_add_u32 m0, s100, 62464
    s_add_u32 s83, s6, 32768
    buffer_load_dwordx4 v164, s[68:71], s83 offen sc1 lds
    v_mfma_f32_16x16x32_bf16 v[0:3], v[244:247], v[64:67], v[0:3]
    ds_read_b128 v[32:35], v154 offset:5120
    v_mfma_f32_16x16x32_bf16 v[12:15], v[208:211], v[104:107], v[12:15]
    ds_read_b128 v[20:23], v154 offset:6144
    s_waitcnt lgkmcnt(7)
    v_add_f32 v132, v132, v28
    v_add_f32 v133, v133, v29
    v_mfma_f32_16x16x32_bf16 v[12:15], v[212:215], v[108:111], v[12:15]
    ds_read_b128 v[56:59], v154 offset:7168
    s_add_u32 m0, s5, 69632
    s_mov_b32 exec_hi, 0
    buffer_load_dwordx4 v164, s[68:71], s7 offen sc1 lds
    s_mov_b32 exec_hi, -1
    v_add_f32 v134, v134, v30
    v_add_f32 v135, v135, v31
    v_mfma_f32_16x16x32_bf16 v[12:15], v[216:219], v[120:123], v[12:15]
    ds_read_b128 v[8:11], v154 offset:8192
    s_waitcnt lgkmcnt(8)
    v_add_f32 v136, v136, v16
    v_add_f32 v137, v137, v17
    v_mfma_f32_16x16x32_bf16 v[12:15], v[220:223], v[80:83], v[12:15]
    ds_read_b128 v[44:47], v154 offset:9216
    ds_write_b128 v165, v[0:3] offset:12288
    v_add_f32 v138, v138, v18
    v_add_f32 v139, v139, v19
    v_mfma_f32_16x16x32_bf16 v[12:15], v[248:251], v[116:119], v[12:15]
    s_waitcnt lgkmcnt(9)
    v_add_f32 v140, v140, v52
    v_add_f32 v141, v141, v53
    v_mfma_f32_16x16x32_bf16 v[12:15], v[252:255], v[64:67], v[12:15]
    v_add_f32 v142, v142, v54
    v_add_f32 v143, v143, v55
    v_mfma_f32_16x16x32_bf16 v[48:51], a[216:219], v[104:107], v[48:51]
    s_waitcnt lgkmcnt(8)
    v_add_f32 v144, v144, v4
    v_add_f32 v145, v145, v5
    v_mfma_f32_16x16x32_bf16 v[48:51], a[220:223], v[108:111], v[48:51]
    v_add_f32 v146, v146, v6
    v_add_f32 v147, v147, v7
    v_mfma_f32_16x16x32_bf16 v[48:51], a[224:227], v[120:123], v[48:51]
    s_waitcnt lgkmcnt(6)
    v_add_f32 v148, v148, v40
    v_add_f32 v149, v149, v41
    v_mfma_f32_16x16x32_bf16 v[48:51], a[228:231], v[80:83], v[48:51]
    ds_write_b128 v165, v[12:15] offset:13312
    v_add_f32 v150, v150, v42
    v_add_f32 v151, v151, v43
    v_mfma_f32_16x16x32_bf16 v[48:51], a[248:251], v[116:119], v[48:51]
    v_mfma_f32_16x16x32_bf16 v[48:51], a[252:255], v[64:67], v[48:51]
    s_waitcnt lgkmcnt(6)
    s_waitcnt vmcnt(5)
    v_mfma_f32_16x16x32_bf16 v[32:35], a[244:247], v[60:63], v[32:35]
    s_waitcnt vmcnt(4)
    v_mfma_f32_16x16x32_bf16 v[32:35], v[224:227], v[68:71], v[32:35]
    s_waitcnt vmcnt(3)
    v_mfma_f32_16x16x32_bf16 v[32:35], v[228:231], v[72:75], v[32:35]
    v_mov_b64 v[116:117], 0
    v_mov_b64 v[118:119], 0
    s_waitcnt lgkmcnt(5)
    v_mfma_f32_16x16x32_bf16 v[20:23], v[188:191], v[60:63], v[20:23]
    ds_write_b128 v165, v[48:51] offset:14336
    v_mov_b64 v[120:121], 0
    v_mov_b64 v[122:123], 0
    v_mfma_f32_16x16x32_bf16 v[20:23], v[232:235], v[68:71], v[20:23]
    v_mfma_f32_16x16x32_bf16 v[20:23], v[236:239], v[72:75], v[20:23]
    s_waitcnt lgkmcnt(5)
    v_mfma_f32_16x16x32_bf16 v[56:59], v[204:207], v[60:63], v[56:59]
    v_mfma_f32_16x16x32_bf16 v[56:59], v[240:243], v[68:71], v[56:59]
    v_mfma_f32_16x16x32_bf16 v[56:59], v[244:247], v[72:75], v[56:59]
    s_waitcnt lgkmcnt(0)
    s_barrier
    v_mfma_f32_16x16x32_bf16 v[8:11], v[220:223], v[60:63], v[8:11]
    ds_read_b128 v[28:31], v154 offset:10240
    v_mfma_f32_16x16x32_bf16 v[8:11], v[248:251], v[68:71], v[8:11]
    ds_read_b128 v[16:19], v154 offset:11264
    v_mfma_f32_16x16x32_bf16 v[8:11], v[252:255], v[72:75], v[8:11]
    ds_read_b128 v[52:55], v154 offset:12288
    v_mfma_f32_16x16x32_bf16 v[44:47], a[228:231], v[60:63], v[44:47]
    ds_read_b128 v[4:7], v154 offset:13312
    v_mfma_f32_16x16x32_bf16 v[44:47], a[248:251], v[68:71], v[44:47]
    ds_read_b128 v[40:43], v154 offset:14336
    v_mfma_f32_16x16x32_bf16 v[44:47], a[252:255], v[72:75], v[44:47]
    v_pk_add_f32 v[132:133], v[132:133], v[32:33]
    v_pk_add_f32 v[134:135], v[134:135], v[34:35]
    v_pk_add_f32 v[136:137], v[136:137], v[20:21]
    v_pk_add_f32 v[138:139], v[138:139], v[22:23]
    v_pk_add_f32 v[140:141], v[140:141], v[56:57]
    v_pk_add_f32 v[142:143], v[142:143], v[58:59]
    v_pk_add_f32 v[144:145], v[144:145], v[8:9]
    v_pk_add_f32 v[146:147], v[146:147], v[10:11]
    v_pk_add_f32 v[148:149], v[148:149], v[44:45]
    v_pk_add_f32 v[150:151], v[150:151], v[46:47]
    s_waitcnt lgkmcnt(4)
    v_pk_add_f32 v[132:133], v[132:133], v[28:29]
    v_pk_add_f32 v[134:135], v[134:135], v[30:31]
    s_waitcnt lgkmcnt(3)
    v_pk_add_f32 v[136:137], v[136:137], v[16:17]
    v_pk_add_f32 v[138:139], v[138:139], v[18:19]
    s_waitcnt lgkmcnt(2)
    v_pk_add_f32 v[140:141], v[140:141], v[52:53]
    v_pk_add_f32 v[142:143], v[142:143], v[54:55]
    s_waitcnt lgkmcnt(1)
    v_pk_add_f32 v[144:145], v[144:145], v[4:5]
    v_pk_add_f32 v[146:147], v[146:147], v[6:7]
    s_waitcnt lgkmcnt(0)
    v_pk_add_f32 v[148:149], v[148:149], v[40:41]
    v_pk_add_f32 v[150:151], v[150:151], v[42:43]
    v_pk_add_f32 v[4:5], v[132:133], v[134:135]
    v_pk_mul_f32 v[6:7], v[132:133], v[132:133]
    v_pk_fma_f32 v[6:7], v[134:135], v[134:135], v[6:7]
    v_pk_fma_f32 v[6:7], v[136:137], v[136:137], v[6:7]
    v_pk_add_f32 v[4:5], v[4:5], v[136:137]
    v_pk_fma_f32 v[6:7], v[138:139], v[138:139], v[6:7]
    v_pk_add_f32 v[4:5], v[4:5], v[138:139]
    v_pk_fma_f32 v[6:7], v[140:141], v[140:141], v[6:7]
    v_pk_add_f32 v[4:5], v[4:5], v[140:141]
    v_pk_fma_f32 v[6:7], v[142:143], v[142:143], v[6:7]
    v_pk_add_f32 v[4:5], v[4:5], v[142:143]
    v_pk_fma_f32 v[6:7], v[144:145], v[144:145], v[6:7]
    v_pk_add_f32 v[4:5], v[4:5], v[144:145]
    v_pk_fma_f32 v[6:7], v[146:147], v[146:147], v[6:7]
    v_pk_add_f32 v[4:5], v[4:5], v[146:147]
    v_pk_fma_f32 v[6:7], v[148:149], v[148:149], v[6:7]
    v_pk_add_f32 v[4:5], v[4:5], v[148:149]
    v_pk_fma_f32 v[6:7], v[150:151], v[150:151], v[6:7]
    v_pk_add_f32 v[4:5], v[4:5], v[150:151]
    v_add_f32 v6, v6, v7
    v_add_f32 v4, v4, v5
    v_mov_b32 v1, s82
    s_nop 0
    v_permlane32_swap_b32 v4, v6
    v_add_f32 v4, v4, v6
    v_mov_b32 v6, v4
    s_nop 1
    v_permlane16_swap_b32 v4, v6
    v_add_f32 v0, v4, v6

    s_cmp_eq_u32 s88, 0
    s_cbranch_scc1 Lss_7
    global_store_dwordx2 v155, v[0:1], s[98:99]
Lsd_8:
    s_waitcnt vmcnt(1)
    ds_read2st64_b32 v[8:9], v170 offset1:2
    ds_read2st64_b32 v[10:11], v170 offset0:4 offset1:6
    ds_read_b32 v12, v171
    v_and_b32 v84, 0xf0, v153
    v_lshrrev_b32 v85, 5, v152
    v_lshl_add_u32 v84, v85, 8, v84
    v_bfe_u32 v85, v152, 2, 3
    v_mul_u32_u24 v85, 2560, v85
    v_and_b32 v86, 3, v152
    v_min_u32 v86, 2, v86
    v_lshl_add_u32 v85, v86, 10, v85
    s_mul_i32 s3, s78, 2560
    s_sub_u32 s3, s12, s3
    v_add_u32 v85, s3, v85
    s_waitcnt lgkmcnt(0)
    v_max3_u32 v169, v8, v9, v10
    v_max3_u32 v169, v169, v11, v12
    v_cmp_eq_u32 s[96:97], -1, v169
    s_cmp_lg_u64 s[96:97], 0
    s_cbranch_scc1 L_gcr
L_gc:
    global_load_dwordx4 v[0:3], v163, s[98:99] sc1
    global_load_dwordx4 v[4:7], v163, s[98:99] offset:256 sc1
    s_barrier
    ds_read_u16_d16_hi v112, v166 offset:0
    ds_read_u16_d16_hi v113, v166 offset:128
    ds_read_u16_d16_hi v114, v166 offset:256
    ds_read_u16_d16_hi v115, v166 offset:384
    ds_read_u16_d16_hi v116, v166 offset:512
    ds_read_u16_d16_hi v117, v166 offset:640
    ds_read_u16_d16_hi v118, v166 offset:768
    ds_read_u16_d16_hi v119, v166 offset:896
    ds_read_u16_d16_hi v120, v166 offset:4096
    ds_read_u16_d16_hi v121, v166 offset:4224
    ds_read_u16_d16_hi v122, v166 offset:4352
    ds_read_u16_d16_hi v123, v166 offset:4480
    ds_read_u16_d16_hi v124, v166 offset:4608
    ds_read_u16_d16_hi v125, v166 offset:4736
    ds_read_u16_d16_hi v126, v166 offset:4864
    ds_read_u16_d16_hi v127, v166 offset:4992
    ds_read_u16_d16_hi v128, v167 offset:8192
    ds_read_u16_d16_hi v129, v167 offset:8320
    ds_read_u16_d16_hi v130, v167 offset:8448
    ds_read_u16_d16_hi v131, v167 offset:8576
    s_waitcnt lgkmcnt(0)
    s_waitcnt vmcnt(0)
    L_s1:
    v_min3_u32 v168, v1, v3, v5
    v_max3_u32 v1, v1, v3, v5
    v_min3_u32 v168, v168, v7, s82
    v_max3_u32 v1, v1, v7, s82
    v_cmp_ne_u32 vcc, v168, v1

    s_cbranch_vccz L_s1r
    s_sub_u32 s101, s101, 1
    s_cbranch_scc1 L_end
    global_load_dwordx4 v[0:3], v163, s[98:99] sc1
    global_load_dwordx4 v[4:7], v163, s[98:99] offset:256 sc1
    s_waitcnt vmcnt(0)
    s_branch L_s1
L_s1r:
    v_add_f32 v0, v0, v4
    v_add_f32 v2, v2, v6
    s_nop 1
    v_permlane32_swap_b32 v0, v2
    v_add_f32 v0, v0, v2
    v_mov_b32 v2, v0
    s_nop 1
    v_permlane16_swap_b32 v0, v2
    v_add_f32 v0, v0, v2
    v_mov_b32 v2, v0
    s_nop 1
    v_permlane32_swap_b32 v0, v2
    v_mul_f32 v0, 0x3acccccd, v0
    v_mov_b32 v166, 0x3727c5ac
    v_fmac_f32 v166, 0x3acccccd, v2
    v_fma_f32 v166, -v0, v0, v166
    v_max_f32 v166, 0x3727c5ac, v166
    v_rsq_f32 v166, v166
    s_nop 0
    v_mul_f32_e64 v167, -v0, v166
    v_pk_fma_f32 v[32:33], v[148:149], v[166:167], v[166:167] op_sel:[0,0,1] op_sel_hi:[1,0,1]
    v_pk_fma_f32 v[34:35], v[150:151], v[166:167], v[166:167] op_sel:[0,0,1] op_sel_hi:[1,0,1]
    v_pk_fma_f32 v[16:17], v[132:133], v[166:167], v[166:167] op_sel:[0,0,1] op_sel_hi:[1,0,1]
    v_pk_fma_f32 v[18:19], v[134:135], v[166:167], v[166:167] op_sel:[0,0,1] op_sel_hi:[1,0,1]
    v_pk_fma_f32 v[20:21], v[136:137], v[166:167], v[166:167] op_sel:[0,0,1] op_sel_hi:[1,0,1]
    v_pk_fma_f32 v[22:23], v[138:139], v[166:167], v[166:167] op_sel:[0,0,1] op_sel_hi:[1,0,1]
    v_pk_fma_f32 v[24:25], v[140:141], v[166:167], v[166:167] op_sel:[0,0,1] op_sel_hi:[1,0,1]
    v_pk_fma_f32 v[26:27], v[142:143], v[166:167], v[166:167] op_sel:[0,0,1] op_sel_hi:[1,0,1]
    v_pk_fma_f32 v[28:29], v[144:145], v[166:167], v[166:167] op_sel:[0,0,1] op_sel_hi:[1,0,1]
    v_pk_fma_f32 v[30:31], v[146:147], v[166:167], v[166:167] op_sel:[0,0,1] op_sel_hi:[1,0,1]
    v_pk_fma_f32 v[148:149], v[32:33], v[128:129], v[148:149]
    v_pk_fma_f32 v[150:151], v[34:35], v[130:131], v[150:151]
    v_pk_fma_f32 v[132:133], v[16:17], v[112:113], v[132:133]
    v_pk_fma_f32 v[134:135], v[18:19], v[114:115], v[134:135]
    v_pk_fma_f32 v[136:137], v[20:21], v[116:117], v[136:137]
    v_pk_fma_f32 v[138:139], v[22:23], v[118:119], v[138:139]
    v_pk_fma_f32 v[140:141], v[24:25], v[120:121], v[140:141]
    v_pk_fma_f32 v[142:143], v[26:27], v[122:123], v[142:143]
    v_pk_fma_f32 v[144:145], v[28:29], v[124:125], v[144:145]
    v_pk_fma_f32 v[146:147], v[30:31], v[126:127], v[146:147]
    v_cvt_pk_bf16_f32 v44, v148, v149
    v_cvt_pk_bf16_f32 v45, v150, v151
    v_or_b32 v44, 1, v44
    v_cvt_pk_bf16_f32 v36, v132, v133
    v_cvt_pk_bf16_f32 v37, v134, v135
    v_or_b32 v36, 1, v36
    v_permlane16_swap_b32 v44, v46
    v_permlane16_swap_b32 v45, v47
    v_cvt_pk_bf16_f32 v38, v136, v137
    v_cvt_pk_bf16_f32 v39, v138, v139
    v_or_b32 v38, 1, v38
    v_cvt_pk_bf16_f32 v40, v140, v141
    v_cvt_pk_bf16_f32 v41, v142, v143
    v_or_b32 v40, 1, v40
    v_cvt_pk_bf16_f32 v42, v144, v145
    v_cvt_pk_bf16_f32 v43, v146, v147
    v_or_b32 v42, 1, v42
    s_cmp_eq_u32 s88, 0
    s_cbranch_scc1 Lss_9
    buffer_store_dwordx4 v[36:39], v153, s[64:67], s12 offen
    buffer_store_dwordx4 v[40:43], v153, s[64:67], s12 offen offset:1024
    s_mov_b32 exec_lo, 0xffff
    s_mov_b32 exec_hi, 0xffff
    buffer_store_dwordx4 v[44:47], v84, s[64:67], s12 offen offset:2048
Lsd_10:
    s_mov_b64 exec, -1
    v_pk_add_f32 v[4:5], v[132:133], v[134:135]
    v_pk_mul_f32 v[6:7], v[132:133], v[132:133]
    v_pk_fma_f32 v[6:7], v[134:135], v[134:135], v[6:7]
    v_pk_fma_f32 v[6:7], v[136:137], v[136:137], v[6:7]
    v_pk_add_f32 v[4:5], v[4:5], v[136:137]
    v_pk_fma_f32 v[6:7], v[138:139], v[138:139], v[6:7]
    v_pk_add_f32 v[4:5], v[4:5], v[138:139]
    v_pk_fma_f32 v[6:7], v[140:141], v[140:141], v[6:7]
    v_pk_add_f32 v[4:5], v[4:5], v[140:141]
    v_pk_fma_f32 v[6:7], v[142:143], v[142:143], v[6:7]
    v_pk_add_f32 v[4:5], v[4:5], v[142:143]
    v_pk_fma_f32 v[6:7], v[144:145], v[144:145], v[6:7]
    v_pk_add_f32 v[4:5], v[4:5], v[144:145]
    v_pk_fma_f32 v[6:7], v[146:147], v[146:147], v[6:7]
    v_pk_add_f32 v[4:5], v[4:5], v[146:147]
    v_pk_fma_f32 v[6:7], v[148:149], v[148:149], v[6:7]
    v_pk_add_f32 v[4:5], v[4:5], v[148:149]
    v_pk_fma_f32 v[6:7], v[150:151], v[150:151], v[6:7]
    v_pk_add_f32 v[4:5], v[4:5], v[150:151]
    v_add_f32 v6, v6, v7
    v_add_f32 v4, v4, v5
    v_mov_b32 v1, s82
    s_nop 0
    v_permlane32_swap_b32 v4, v6
    v_add_f32 v4, v4, v6
    v_mov_b32 v6, v4
    s_nop 1
    v_permlane16_swap_b32 v4, v6
    v_add_f32 v0, v4, v6

    s_add_u32 s98, s98, 0x40000
    s_addc_u32 s99, s99, 0
    s_cmp_eq_u32 s88, 0
    s_cbranch_scc1 Lss_11
    global_store_dwordx2 v155, v[0:1], s[98:99]
Lsd_12:
    v_bfe_u32 v122, v152, 2, 2
    s_lshl_b32 s3, s77, 4
    s_add_u32 s3, s3, 92160
    v_lshl_add_u32 v120, v122, 6, s3
    s_lshl_b32 s3, s77, 3
    s_add_u32 s3, s3, 92672
    v_lshl_add_u32 v121, v122, 6, s3
    v_bfe_u32 v122, v152, 0, 2
    v_lshl_add_u32 v120, v122, 2, v120
    v_bfe_u32 v122, v152, 0, 1
    v_lshl_add_u32 v121, v122, 5, v121
    v_bfe_u32 v122, v152, 1, 1
    v_lshl_add_u32 v121, v122, 2, v121
    v_and_b32 v122, 15, v152
    s_lshl_b32 s3, s77, 7
    s_add_u32 s3, s3, 81920
    v_lshl_add_u32 v165, v122, 3, s3
    v_bfe_u32 v171, v152, 1, 2
    s_lshl_b32 s3, s77, 5
    s_add_u32 s3, s3, 82432
    v_lshl_add_u32 v171, v171, 3, s3
    v_not_b32 v122, v152
    v_lshlrev_b32 v122, 28, v122
    v_and_b32 v170, 0x80000000, v122
    v_lshrrev_b32 v122, 4, v152
    s_mov_b32 s3, 92160
    v_lshl_add_u32 v164, v122, 6, s3
    v_and_b32 v48, 1, v152
    v_lshl_add_u32 v50, v48, 5, v164
    v_lshlrev_b32 v48, 2, v48
    v_lshl_add_u32 v48, v122, 8, v48
    v_and_b32 v122, 1, v122
    v_xor_b32 v122, s77, v122
    v_lshl_add_u32 v48, v122, 6, v48
    v_bfe_u32 v122, v152, 1, 2
    v_lshl_add_u32 v48, v122, 4, v48
    v_bfe_u32 v122, v152, 3, 1
    v_lshlrev_b32 v122, 12, v122
    s_mov_b32 s3, 0
    v_add3_u32 v48, v122, v48, s3
    v_xor_b32 v49, 8, v48
    ds_read_b64 v[128:129], v165 offset:7680
    ds_read_b64 v[130:131], v171 offset:7680
    s_lshl_b32 s3, s78, 2
    s_add_u32 s3, s3, s77
    s_lshl_b32 s3, s3, 13
    s_add_u32 s3, s3, 9699328
    s_add_u32 s92, s50, s3
    s_addc_u32 s93, s51, 0
    s_movk_i32 s94, 8192
    s_sub_u32 s21, 31, s79
    s_lshl_b32 s21, s21, 8
    s_lshl_b32 s3, s77, 12
    v_and_b32 v52, 16, v152
    v_lshlrev_b32 v52, 2, v52
    v_xor_b32 v52, v52, v153
    v_add_u32 v52, s3, v52
    s_waitcnt lgkmcnt(0)
    v_xor_b32 v131, v170, v131
L_xp:
    s_sub_u32 s101, s101, 1
    s_cbranch_scc1 L_end
    buffer_load_dword v168, v85, s[64:67], 0 offen sc1
    s_add_u32 m0, s100, 0
    s_nop 0
    buffer_load_dwordx4 v173, s[64:67], s72 offen offset:0 sc1 lds
    s_add_u32 m0, s100, 8192
    s_add_u32 s83, s72, 10240
    buffer_load_dwordx4 v173, s[64:67], s83 offen offset:0 sc1 lds
    s_add_u32 m0, s100, 0
    s_nop 0
    buffer_load_dwordx4 v173, s[64:67], s72 offen offset:1024 sc1 lds
    s_add_u32 m0, s100, 8192
    s_add_u32 s83, s72, 10240
    buffer_load_dwordx4 v173, s[64:67], s83 offen offset:1024 sc1 lds
    s_waitcnt vmcnt(4)
    v_and_b32 v168, 1, v168
    v_cmp_ne_u32 vcc, 1, v168
    s_cbranch_vccnz L_xp
    s_waitcnt vmcnt(2)
    s_barrier
    ds_read_b128 v[56:59], v158 offset:0
    ds_read_b128 v[60:63], v158 offset:2048
    ds_read_b128 v[64:67], v158 offset:4096
    ds_read_b128 v[68:71], v158 offset:6144
    s_add_u32 m0, s100, 16384
    s_nop 0
    buffer_load_dwordx4 v173, s[64:67], s73 offen offset:0 sc1 lds
    buffer_load_dwordx4 v173, s[64:67], s73 offen offset:1024 sc1 lds
    s_add_u32 m0, s100, 24576
    s_add_u32 s83, s73, 10240
    buffer_load_dwordx4 v173, s[64:67], s83 offen offset:0 sc1 lds
    buffer_load_dwordx4 v173, s[64:67], s83 offen offset:1024 sc1 lds
    s_waitcnt vmcnt(4)
    s_barrier
    ds_read_b128 v[72:75], v158 offset:1024
    ds_read_b128 v[76:79], v158 offset:3072
    ds_read_b128 v[80:83], v158 offset:5120
    ds_read_b128 v[84:87], v158 offset:7168
    ds_read_b128 v[88:91], v159 offset:0
    ds_read_b128 v[92:95], v159 offset:2048
    ds_read_b128 v[96:99], v159 offset:4096
    ds_read_b128 v[100:103], v159 offset:6144
    s_waitcnt lgkmcnt(8)
    v_bitop3_b32 v169, v56, v60, v64 bitop3:128
    v_bitop3_b32 v169, v169, v68, 1 bitop3:128
    v_cmp_ne_u32 vcc, 1, v169
    s_cbranch_vccnz L_xc0r
L_xc0:
    v_mfma_f32_16x16x32_bf16 v[0:3], v[56:59], a[0:3], 0
    s_add_u32 m0, s100, 32768
    s_nop 0
    buffer_load_dwordx4 v173, s[64:67], s74 offen offset:0 sc1 lds
    v_mfma_f32_16x16x32_bf16 v[16:19], v[56:59], a[8:11], 0
    v_mfma_f32_16x16x32_bf16 v[32:35], v[56:59], a[16:19], 0
    ds_read_b128 v[56:59], v159 offset:1024
    v_mfma_f32_16x16x32_bf16 v[4:7], v[60:63], a[0:3], 0
    buffer_load_dwordx4 v173, s[64:67], s74 offen offset:1024 sc1 lds
    v_mfma_f32_16x16x32_bf16 v[20:23], v[60:63], a[8:11], 0
    v_mfma_f32_16x16x32_bf16 v[36:39], v[60:63], a[16:19], 0
    ds_read_b128 v[60:63], v159 offset:3072
    v_mfma_f32_16x16x32_bf16 v[8:11], v[64:67], a[0:3], 0
    s_add_u32 m0, s100, 40960
    s_add_u32 s83, s74, 10240
    buffer_load_dwordx4 v173, s[64:67], s83 offen offset:0 sc1 lds
    v_mfma_f32_16x16x32_bf16 v[24:27], v[64:67], a[8:11], 0
    s_waitcnt lgkmcnt(6)
    v_bitop3_b32 v169, v72, v76, v80 bitop3:128
    v_bitop3_b32 v169, v169, v84, 1 bitop3:128
    v_mfma_f32_16x16x32_bf16 v[40:43], v[64:67], a[16:19], 0
    ds_read_b128 v[64:67], v159 offset:5120
    v_cmp_ne_u32 vcc, 1, v169
    v_mfma_f32_16x16x32_bf16 v[12:15], v[68:71], a[0:3], 0
    buffer_load_dwordx4 v173, s[64:67], s83 offen offset:1024 sc1 lds
    v_mfma_f32_16x16x32_bf16 v[28:31], v[68:71], a[8:11], 0
    v_mfma_f32_16x16x32_bf16 v[44:47], v[68:71], a[16:19], 0
    ds_read_b128 v[68:71], v159 offset:7168
    s_cbranch_vccnz L_xc1r
L_xc1:
    v_mfma_f32_16x16x32_bf16 v[0:3], v[72:75], a[4:7], v[0:3]
    global_load_dwordx4 v[104:107], v163, s[98:99] sc1
    v_mfma_f32_16x16x32_bf16 v[16:19], v[72:75], a[12:15], v[16:19]
    v_mfma_f32_16x16x32_bf16 v[32:35], v[72:75], a[20:23], v[32:35]
    global_load_dwordx4 v[108:111], v163, s[98:99] offset:256 sc1
    v_mfma_f32_16x16x32_bf16 v[4:7], v[76:79], a[4:7], v[4:7]
    v_mfma_f32_16x16x32_bf16 v[20:23], v[76:79], a[12:15], v[20:23]
    s_add_u32 m0, s100, 49152
    s_nop 0
    buffer_load_dwordx4 v173, s[64:67], s75 offen offset:0 sc1 lds
    v_mfma_f32_16x16x32_bf16 v[36:39], v[76:79], a[20:23], v[36:39]
    v_mfma_f32_16x16x32_bf16 v[8:11], v[80:83], a[4:7], v[8:11]
    v_mfma_f32_16x16x32_bf16 v[24:27], v[80:83], a[12:15], v[24:27]
    buffer_load_dwordx4 v173, s[64:67], s75 offen offset:1024 sc1 lds
    s_waitcnt lgkmcnt(4)
    v_bitop3_b32 v169, v88, v92, v96 bitop3:128
    v_bitop3_b32 v169, v169, v100, 1 bitop3:128
    v_mfma_f32_16x16x32_bf16 v[40:43], v[80:83], a[20:23], v[40:43]
    v_cmp_ne_u32 vcc, 1, v169
    v_mfma_f32_16x16x32_bf16 v[12:15], v[84:87], a[4:7], v[12:15]
    v_mfma_f32_16x16x32_bf16 v[28:31], v[84:87], a[12:15], v[28:31]
    s_add_u32 m0, s100, 57344
    s_add_u32 s83, s75, 10240
    buffer_load_dwordx4 v173, s[64:67], s83 offen offset:0 sc1 lds
    v_mfma_f32_16x16x32_bf16 v[44:47], v[84:87], a[20:23], v[44:47]
    s_cbranch_vccnz L_xc2r
L_xc2:
    v_mfma_f32_16x16x32_bf16 v[0:3], v[88:91], a[24:27], v[0:3]
    v_mfma_f32_16x16x32_bf16 v[16:19], v[88:91], a[32:35], v[16:19]
    buffer_load_dwordx4 v173, s[64:67], s83 offen offset:1024 sc1 lds
    v_mfma_f32_16x16x32_bf16 v[4:7], v[92:95], a[24:27], v[4:7]
    v_mfma_f32_16x16x32_bf16 v[20:23], v[92:95], a[32:35], v[20:23]
    s_waitcnt lgkmcnt(0)
    v_bitop3_b32 v169, v56, v60, v64 bitop3:128
    v_bitop3_b32 v169, v169, v68, 1 bitop3:128
    v_mfma_f32_16x16x32_bf16 v[8:11], v[96:99], a[24:27], v[8:11]
    s_add_u32 m0, s100, 65536
    s_nop 0
    buffer_load_dwordx4 v173, s[64:67], s76 offen offset:0 sc1 lds
    v_cmp_ne_u32 vcc, 1, v169
    v_mfma_f32_16x16x32_bf16 v[24:27], v[96:99], a[32:35], v[24:27]
    v_mfma_f32_16x16x32_bf16 v[12:15], v[100:103], a[24:27], v[12:15]
    s_waitcnt vmcnt(7)
    s_barrier
    v_add_u32 v158, 0x4000, v158
    v_add_u32 v159, 0x4000, v159
    ds_read_b128 v[72:75], v158 offset:0
    ds_read_b128 v[76:79], v158 offset:4096
    v_mfma_f32_16x16x32_bf16 v[28:31], v[100:103], a[32:35], v[28:31]
    buffer_load_dwordx4 v173, s[64:67], s76 offen offset:1024 sc1 lds
    ds_read_b128 v[80:83], v158 offset:2048
    ds_read_b128 v[84:87], v158 offset:6144
    s_cbranch_vccnz L_xc3r
L_xc3:
    v_mfma_f32_16x16x32_bf16 v[0:3], v[56:59], a[28:31], v[0:3]
    ds_read_b128 v[88:91], v158 offset:1024
    ds_read_b128 v[92:95], v158 offset:5120
    v_mfma_f32_16x16x32_bf16 v[16:19], v[56:59], a[36:39], v[16:19]
    ds_read_b128 v[96:99], v158 offset:3072
    ds_read_b128 v[100:103], v158 offset:7168
    v_mfma_f32_16x16x32_bf16 v[4:7], v[60:63], a[28:31], v[4:7]
    s_add_u32 m0, s100, 73728
    s_add_u32 s83, s76, 10240
    buffer_load_dwordx4 v173, s[64:67], s83 offen offset:0 sc1 lds
    ds_read_b128 v[56:59], v158 offset:16384
    v_mfma_f32_16x16x32_bf16 v[20:23], v[60:63], a[36:39], v[20:23]
    ds_read_b128 v[60:63], v158 offset:20480
    s_waitcnt lgkmcnt(6)
    v_bitop3_b32 v169, v72, v76, v80 bitop3:128
    v_bitop3_b32 v169, v169, v84, 1 bitop3:128
    v_mfma_f32_16x16x32_bf16 v[8:11], v[64:67], a[28:31], v[8:11]
    v_cmp_ne_u32 vcc, 1, v169
    v_mfma_f32_16x16x32_bf16 v[24:27], v[64:67], a[36:39], v[24:27]
    buffer_load_dwordx4 v173, s[64:67], s83 offen offset:1024 sc1 lds
    ds_read_b128 v[64:67], v158 offset:18432
    v_mfma_f32_16x16x32_bf16 v[12:15], v[68:71], a[28:31], v[12:15]
    v_mfma_f32_16x16x32_bf16 v[28:31], v[68:71], a[36:39], v[28:31]
    ds_read_b128 v[68:71], v158 offset:22528
    s_cbranch_vccnz L_xc4r
L_xc4:
    v_mfma_f32_16x16x32_bf16 v[0:3], v[72:75], a[40:43], v[0:3]
    v_mfma_f32_16x16x32_bf16 v[16:19], v[72:75], a[48:51], v[16:19]
    v_mfma_f32_16x16x32_bf16 v[32:35], v[72:75], a[56:59], v[32:35]
    ds_read_b128 v[72:75], v158 offset:17408
    v_mfma_f32_16x16x32_bf16 v[40:43], v[76:79], a[56:59], v[40:43]
    ds_read_b128 v[76:79], v158 offset:21504
    s_waitcnt lgkmcnt(6)
    v_bitop3_b32 v169, v88, v92, v96 bitop3:128
    v_bitop3_b32 v169, v169, v100, 1 bitop3:128
    v_mfma_f32_16x16x32_bf16 v[4:7], v[80:83], a[40:43], v[4:7]
    v_cmp_ne_u32 vcc, 1, v169
    v_mfma_f32_16x16x32_bf16 v[20:23], v[80:83], a[48:51], v[20:23]
    v_mfma_f32_16x16x32_bf16 v[36:39], v[80:83], a[56:59], v[36:39]
    ds_read_b128 v[80:83], v158 offset:19456
    v_mfma_f32_16x16x32_bf16 v[44:47], v[84:87], a[56:59], v[44:47]
    ds_read_b128 v[84:87], v158 offset:23552
    s_cbranch_vccnz L_xc5r
L_xc5:
    v_mfma_f32_16x16x32_bf16 v[0:3], v[88:91], a[44:47], v[0:3]
    v_mfma_f32_16x16x32_bf16 v[16:19], v[88:91], a[52:55], v[16:19]
    v_mfma_f32_16x16x32_bf16 v[32:35], v[88:91], a[60:63], v[32:35]
    v_mfma_f32_16x16x32_bf16 v[40:43], v[92:95], a[60:63], v[40:43]
    s_waitcnt lgkmcnt(4)
    v_bitop3_b32 v169, v56, v60, v64 bitop3:128
    v_bitop3_b32 v169, v169, v68, 1 bitop3:128
    v_mfma_f32_16x16x32_bf16 v[4:7], v[96:99], a[44:47], v[4:7]
    v_cmp_ne_u32 vcc, 1, v169
    v_mfma_f32_16x16x32_bf16 v[20:23], v[96:99], a[52:55], v[20:23]
    v_mfma_f32_16x16x32_bf16 v[36:39], v[96:99], a[60:63], v[36:39]
    v_mfma_f32_16x16x32_bf16 v[44:47], v[100:103], a[60:63], v[44:47]
    s_cbranch_vccnz L_xc6r
L_xc6:
    v_mfma_f32_16x16x32_bf16 v[0:3], v[56:59], a[80:83], v[0:3]
    v_mfma_f32_16x16x32_bf16 v[16:19], v[56:59], a[88:91], v[16:19]
    s_waitcnt vmcnt(8)
    L_s2:
    v_min3_u32 v168, v105, v107, v109
    v_max3_u32 v105, v105, v107, v109
    v_min3_u32 v168, v168, v111, s82
    v_max3_u32 v105, v105, v111, s82
    v_cmp_ne_u32 vcc, v168, v105

    s_cbranch_vccnz L_s2r
    v_mfma_f32_16x16x32_bf16 v[32:35], v[56:59], a[96:99], v[32:35]
    v_add_f32 v104, v104, v108
    v_add_f32 v106, v106, v110
    v_mfma_f32_16x16x32_bf16 v[40:43], v[60:63], a[96:99], v[40:43]
    s_waitcnt lgkmcnt(0)
    v_bitop3_b32 v169, v72, v76, v80 bitop3:128
    v_bitop3_b32 v169, v169, v84, 1 bitop3:128
    v_mfma_f32_16x16x32_bf16 v[4:7], v[64:67], a[80:83], v[4:7]
    v_cmp_ne_u32 vcc, 1, v169
    v_permlane32_swap_b32 v104, v106
    v_mfma_f32_16x16x32_bf16 v[20:23], v[64:67], a[88:91], v[20:23]
    v_add_f32 v104, v104, v106
    v_mov_b32 v106, v104
    v_mfma_f32_16x16x32_bf16 v[36:39], v[64:67], a[96:99], v[36:39]
    s_waitcnt vmcnt(0)
    s_barrier
    ds_read_b128 v[88:91], v158 offset:32768
    ds_read_b128 v[92:95], v158 offset:36864
    v_permlane16_swap_b32 v104, v106
    v_add_f32 v104, v104, v106
    v_mfma_f32_16x16x32_bf16 v[44:47], v[68:71], a[96:99], v[44:47]
    ds_read_b128 v[96:99], v158 offset:34816
    ds_read_b128 v[100:103], v158 offset:38912
    v_mov_b32 v106, v104
    s_nop 1
    v_permlane32_swap_b32 v104, v106
    s_cbranch_vccnz L_xc7r
L_xc7:
    v_mfma_f32_16x16x32_bf16 v[0:3], v[72:75], a[84:87], v[0:3]
    ds_read_b128 v[56:59], v158 offset:33792
    ds_read_b128 v[60:63], v158 offset:37888
    v_mul_f32 v104, 0x3acccccd, v104
    v_mov_b32 v166, 0x3727c5ac
    v_mfma_f32_16x16x32_bf16 v[16:19], v[72:75], a[92:95], v[16:19]
    ds_read_b128 v[64:67], v158 offset:35840
    ds_read_b128 v[68:71], v158 offset:39936
    v_fmac_f32 v166, 0x3acccccd, v106
    v_fma_f32 v166, -v104, v104, v166
    v_mfma_f32_16x16x32_bf16 v[32:35], v[72:75], a[100:103], v[32:35]
    ds_read_b128 v[72:75], v158 offset:53248
    v_max_f32 v166, 0x3727c5ac, v166
    v_rsq_f32 v166, v166
    v_mfma_f32_16x16x32_bf16 v[40:43], v[76:79], a[100:103], v[40:43]
    ds_read_b128 v[76:79], v158 offset:54272
    s_waitcnt lgkmcnt(6)
    v_bitop3_b32 v169, v88, v92, v96 bitop3:128
    v_bitop3_b32 v169, v169, v100, 1 bitop3:128
    v_mfma_f32_16x16x32_bf16 v[4:7], v[80:83], a[84:87], v[4:7]
    v_cmp_ne_u32 vcc, 1, v169
    v_mul_f32_e64 v167, -v104, v166
    v_mfma_f32_16x16x32_bf16 v[20:23], v[80:83], a[92:95], v[20:23]
    v_xor_b32 v104, 0x80000000, v104
    v_mfma_f32_16x16x32_bf16 v[36:39], v[80:83], a[100:103], v[36:39]
    ds_read_b128 v[80:83], v158 offset:49152
    v_mfma_f32_16x16x32_bf16 v[44:47], v[84:87], a[100:103], v[44:47]
    ds_read_b128 v[84:87], v158 offset:50176
    s_cbranch_vccnz L_xc8r
L_xc8:
    v_mfma_f32_16x16x32_bf16 v[0:3], v[88:91], a[120:123], v[0:3]
    s_mov_b64 exec, 0xffff
    ds_write2st64_b32 v120, v104, v166 offset1:1
    ds_write2st64_b32 v121, v104, v166 offset1:1
    s_mov_b64 exec, -1
    v_mfma_f32_16x16x32_bf16 v[16:19], v[88:91], a[128:131], v[16:19]
    s_add_u32 s98, s98, 0x40000
    s_addc_u32 s99, s99, 0
    v_mfma_f32_16x16x32_bf16 v[32:35], v[88:91], a[136:139], v[32:35]
    ds_read_b128 v[88:91], v158 offset:55296
    v_mfma_f32_16x16x32_bf16 v[40:43], v[92:95], a[136:139], v[40:43]
    ds_read_b128 v[92:95], v158 offset:56320
    s_waitcnt lgkmcnt(8)
    v_bitop3_b32 v169, v56, v60, v64 bitop3:128
    v_bitop3_b32 v169, v169, v68, 1 bitop3:128
    v_mfma_f32_16x16x32_bf16 v[4:7], v[96:99], a[120:123], v[4:7]
    v_cmp_ne_u32 vcc, 1, v169
    v_mfma_f32_16x16x32_bf16 v[20:23], v[96:99], a[128:131], v[20:23]
    v_mfma_f32_16x16x32_bf16 v[36:39], v[96:99], a[136:139], v[36:39]
    ds_read_b128 v[96:99], v158 offset:51200
    v_mfma_f32_16x16x32_bf16 v[44:47], v[100:103], a[136:139], v[44:47]
    ds_read_b128 v[100:103], v158 offset:52224
    s_cbranch_vccnz L_xc9r
L_xc9:
    v_mfma_f32_16x16x32_bf16 v[0:3], v[56:59], a[124:127], v[0:3]
    v_mfma_f32_16x16x32_bf16 v[16:19], v[56:59], a[132:135], v[16:19]
    v_mfma_f32_16x16x32_bf16 v[32:35], v[56:59], a[140:143], v[32:35]
    ds_read_b128 v[56:59], v159 offset:0
    v_mfma_f32_16x16x32_bf16 v[40:43], v[60:63], a[140:143], v[40:43]
    ds_read_b128 v[60:63], v159 offset:1024
    s_waitcnt lgkmcnt(8)
    v_bitop3_b32 v169, v72, v76, v80 bitop3:128
    v_bitop3_b32 v169, v169, v84, 1 bitop3:128
    v_mfma_f32_16x16x32_bf16 v[4:7], v[64:67], a[124:127], v[4:7]
    v_cmp_ne_u32 vcc, 1, v169
    v_mfma_f32_16x16x32_bf16 v[20:23], v[64:67], a[132:135], v[20:23]
    v_mfma_f32_16x16x32_bf16 v[36:39], v[64:67], a[140:143], v[36:39]
    ds_read_b128 v[64:67], v159 offset:16384
    v_mfma_f32_16x16x32_bf16 v[44:47], v[68:71], a[140:143], v[44:47]
    ds_read_b128 v[68:71], v159 offset:17408
    s_cbranch_vccnz L_xc10r
L_xc10:
    v_mfma_f32_16x16x32_bf16 v[40:43], v[72:75], a[176:179], v[40:43]
    ds_read_b128 v[72:75], v159 offset:32768
    v_mfma_f32_16x16x32_bf16 v[40:43], v[76:79], a[180:183], v[40:43]
    ds_read_b128 v[76:79], v159 offset:33792
    v_mfma_f32_16x16x32_bf16 v[0:3], v[80:83], a[160:163], v[0:3]
    v_mfma_f32_16x16x32_bf16 v[16:19], v[80:83], a[168:171], v[16:19]
    s_waitcnt lgkmcnt(6)
    v_bitop3_b32 v169, v88, v92, v96 bitop3:128
    v_bitop3_b32 v169, v169, v100, 1 bitop3:128
    v_mfma_f32_16x16x32_bf16 v[32:35], v[80:83], a[176:179], v[32:35]
    s_nop 0
    ds_write_b128 v52, v[40:43] offset:2048
    ds_read_b128 v[80:83], v159 offset:49152
    v_cmp_ne_u32 vcc, 1, v169
    v_mfma_f32_16x16x32_bf16 v[0:3], v[84:87], a[164:167], v[0:3]
    v_mfma_f32_16x16x32_bf16 v[16:19], v[84:87], a[172:175], v[16:19]
    v_mfma_f32_16x16x32_bf16 v[32:35], v[84:87], a[180:183], v[32:35]
    ds_read_b128 v[84:87], v159 offset:50176
    s_cbranch_vccnz L_xc11r
L_xc11:
    v_mfma_f32_16x16x32_bf16 v[44:47], v[88:91], a[176:179], v[44:47]
    v_mfma_f32_16x16x32_bf16 v[44:47], v[92:95], a[180:183], v[44:47]
    v_mfma_f32_16x16x32_bf16 v[4:7], v[96:99], a[160:163], v[4:7]
    s_nop 2
    ds_write_b128 v52, v[32:35] offset:0
    v_mfma_f32_16x16x32_bf16 v[20:23], v[96:99], a[168:171], v[20:23]
    s_waitcnt lgkmcnt(6)
    v_bitop3_b32 v169, v56, v60, v64 bitop3:128
    v_bitop3_b32 v169, v169, v68, 1 bitop3:128
    v_cmp_ne_u32 vcc, 1, v169
    v_mfma_f32_16x16x32_bf16 v[36:39], v[96:99], a[176:179], v[36:39]
    v_mfma_f32_16x16x32_bf16 v[4:7], v[100:103], a[164:167], v[4:7]
    ds_write_b128 v52, v[44:47] offset:3072
    v_mfma_f32_16x16x32_bf16 v[20:23], v[100:103], a[172:175], v[20:23]
    v_mfma_f32_16x16x32_bf16 v[36:39], v[100:103], a[180:183], v[36:39]
    s_cbranch_vccnz L_xc12r
L_xc12:
    v_mfma_f32_16x16x32_bf16 v[0:3], v[56:59], a[64:67], v[0:3]
    v_mfma_f32_16x16x32_bf16 v[16:19], v[56:59], a[72:75], v[16:19]
    ds_read_b128 v[56:59], v159 offset:2048
    v_mfma_f32_16x16x32_bf16 v[0:3], v[60:63], a[68:71], v[0:3]
    s_nop 2
    ds_write_b128 v52, v[36:39] offset:1024
    v_mfma_f32_16x16x32_bf16 v[16:19], v[60:63], a[76:79], v[16:19]
    ds_read_b128 v[60:63], v159 offset:3072
    s_waitcnt lgkmcnt(5)
    v_bitop3_b32 v169, v72, v76, v80 bitop3:128
    v_bitop3_b32 v169, v169, v84, 1 bitop3:128
    v_cmp_ne_u32 vcc, 1, v169
    v_mfma_f32_16x16x32_bf16 v[0:3], v[64:67], a[104:107], v[0:3]
    v_mfma_f32_16x16x32_bf16 v[16:19], v[64:67], a[112:115], v[16:19]
    ds_read_b128 v[64:67], v159 offset:18432
    v_mfma_f32_16x16x32_bf16 v[0:3], v[68:71], a[108:111], v[0:3]
    v_mfma_f32_16x16x32_bf16 v[16:19], v[68:71], a[116:119], v[16:19]
    ds_read_b128 v[68:71], v159 offset:19456
    s_cbranch_vccnz L_xc13r
L_xc13:
    v_mfma_f32_16x16x32_bf16 v[0:3], v[72:75], a[144:147], v[0:3]
    v_mfma_f32_16x16x32_bf16 v[16:19], v[72:75], a[152:155], v[16:19]
    ds_read_b128 v[72:75], v159 offset:34816
    v_mfma_f32_16x16x32_bf16 v[0:3], v[76:79], a[148:151], v[0:3]
    v_mfma_f32_16x16x32_bf16 v[16:19], v[76:79], a[156:159], v[16:19]
    ds_read_b128 v[76:79], v159 offset:35840
    s_waitcnt lgkmcnt(2)
    v_bitop3_b32 v169, v56, v60, v64 bitop3:128
    v_bitop3_b32 v169, v169, v68, 1 bitop3:128
    v_cmp_ne_u32 vcc, 1, v169
    s_barrier
    v_mfma_f32_16x16x32_bf16 v[0:3], v[80:83], a[184:187], v[0:3]
    ds_read_b128 v[104:107], v164 offset:0
    v_mfma_f32_16x16x32_bf16 v[16:19], v[80:83], a[192:195], v[16:19]
    ds_read_b128 v[80:83], v159 offset:51200
    ds_read_b128 v[108:111], v164 offset:256
    v_mfma_f32_16x16x32_bf16 v[0:3], v[84:87], a[188:191], v[0:3]
    ds_read_b128 v[112:115], v164 offset:16
    v_mfma_f32_16x16x32_bf16 v[16:19], v[84:87], a[196:199], v[16:19]
    ds_read_b128 v[84:87], v159 offset:52224
    ds_read_b128 v[116:119], v164 offset:272
    s_cbranch_vccnz L_xc14r
L_xc14:
    v_mfma_f32_16x16x32_bf16 v[4:7], v[56:59], a[64:67], v[4:7]
    ds_read2st64_b32 v[32:33], v48 offset0:0 offset1:32
    v_mfma_f32_16x16x32_bf16 v[20:23], v[56:59], a[72:75], v[20:23]
    ds_read_b128 v[56:59], v159 offset:4096
    v_mfma_f32_16x16x32_bf16 v[4:7], v[60:63], a[68:71], v[4:7]
    ds_read2st64_b32 v[34:35], v49 offset0:0 offset1:32
    v_mfma_f32_16x16x32_bf16 v[20:23], v[60:63], a[76:79], v[20:23]
    ds_read_b128 v[60:63], v159 offset:5120
    s_waitcnt lgkmcnt(5)
    v_bitop3_b32 v169, v72, v76, v80 bitop3:128
    v_bitop3_b32 v169, v169, v84, 1 bitop3:128
    v_cmp_ne_u32 vcc, 1, v169
    v_mfma_f32_16x16x32_bf16 v[4:7], v[64:67], a[104:107], v[4:7]
    ds_read2st64_b32 v[36:37], v48 offset0:4 offset1:36
    v_mfma_f32_16x16x32_bf16 v[20:23], v[64:67], a[112:115], v[20:23]
    ds_read_b128 v[64:67], v159 offset:20480
    v_mfma_f32_16x16x32_bf16 v[4:7], v[68:71], a[108:111], v[4:7]
    ds_read2st64_b32 v[38:39], v49 offset0:4 offset1:36
    v_fmac_f32 v0, v104, v160
    v_mfma_f32_16x16x32_bf16 v[20:23], v[68:71], a[116:119], v[20:23]
    ds_read_b128 v[68:71], v159 offset:21504
    s_cbranch_vccnz L_xc15r
L_xc15:
    v_mfma_f32_16x16x32_bf16 v[4:7], v[72:75], a[144:147], v[4:7]
    ds_read2st64_b32 v[40:41], v48 offset0:8 offset1:40
    v_fmac_f32 v1, v105, v160
    v_mfma_f32_16x16x32_bf16 v[20:23], v[72:75], a[152:155], v[20:23]
    ds_read_b128 v[72:75], v159 offset:36864
    v_fmac_f32 v16, v104, v161
    v_mfma_f32_16x16x32_bf16 v[4:7], v[76:79], a[148:151], v[4:7]
    ds_read2st64_b32 v[42:43], v49 offset0:8 offset1:40
    v_fmac_f32 v17, v105, v161
    v_mfma_f32_16x16x32_bf16 v[20:23], v[76:79], a[156:159], v[20:23]
    ds_read_b128 v[76:79], v159 offset:37888
    v_mul_f32 v0, v108, v0
    v_mfma_f32_16x16x32_bf16 v[4:7], v[80:83], a[184:187], v[4:7]
    ds_read2st64_b32 v[44:45], v48 offset0:12 offset1:44
    v_mul_f32 v1, v109, v1
    v_mfma_f32_16x16x32_bf16 v[20:23], v[80:83], a[192:195], v[20:23]
    ds_read_b128 v[80:83], v159 offset:53248
    v_mul_f32 v16, v108, v16
    v_mfma_f32_16x16x32_bf16 v[4:7], v[84:87], a[188:191], v[4:7]
    ds_read2st64_b32 v[46:47], v49 offset0:12 offset1:44
    v_mul_f32 v17, v109, v17
    v_mfma_f32_16x16x32_bf16 v[20:23], v[84:87], a[196:199], v[20:23]
    ds_read_b128 v[84:87], v159 offset:54272
    ds_read_b128 v[88:91], v50 offset:768
    s_waitcnt lgkmcnt(13)
    v_mfma_f32_16x16x32_bf16 v[8:11], v[56:59], a[64:67], v[8:11]
    ds_read_b128 v[92:95], v50 offset:784
    v_fmac_f32 v2, v106, v160
    v_mfma_f32_16x16x32_bf16 v[24:27], v[56:59], a[72:75], v[24:27]
    ds_read_b128 v[56:59], v158 offset:4096
    ds_read_b128 v[52:55], v50 offset:528
    v_mfma_f32_16x16x32_bf16 v[8:11], v[60:63], a[68:71], v[8:11]
    ds_read_b128 v[48:51], v50 offset:512
    v_fmac_f32 v3, v107, v160
    v_mfma_f32_16x16x32_bf16 v[24:27], v[60:63], a[76:79], v[24:27]
    ds_read_b128 v[60:63], v158 offset:5120
    ds_read_b64 v[96:97], v165 offset:8320
    s_waitcnt lgkmcnt(15)
    v_mfma_f32_16x16x32_bf16 v[8:11], v[64:67], a[104:107], v[8:11]
    ds_read_b64 v[98:99], v165 offset:8960
    v_fmac_f32 v18, v106, v161
    v_mfma_f32_16x16x32_bf16 v[24:27], v[64:67], a[112:115], v[24:27]
    ds_read_b128 v[64:67], v158 offset:20480
    ds_read_b64 v[100:101], v171 offset:8320
    v_mfma_f32_16x16x32_bf16 v[8:11], v[68:71], a[108:111], v[8:11]
    ds_read_b64 v[102:103], v171 offset:8960
    v_fmac_f32 v19, v107, v161
    v_mfma_f32_16x16x32_bf16 v[24:27], v[68:71], a[116:119], v[24:27]
    ds_read_b128 v[68:71], v158 offset:21504
    s_waitcnt lgkmcnt(15)
    v_mfma_f32_16x16x32_bf16 v[8:11], v[72:75], a[144:147], v[8:11]
    v_mul_f32 v2, v110, v2
    v_mul_f32 v3, v111, v3
    v_mfma_f32_16x16x32_bf16 v[24:27], v[72:75], a[152:155], v[24:27]
    ds_read_b128 v[72:75], v158 offset:36864
    v_mul_f32 v18, v110, v18
    v_mfma_f32_16x16x32_bf16 v[8:11], v[76:79], a[148:151], v[8:11]
    s_waitcnt lgkmcnt(14)
    v_add_f32 v32, v32, v33
    v_mfma_f32_16x16x32_bf16 v[24:27], v[76:79], a[156:159], v[24:27]
    ds_read_b128 v[76:79], v158 offset:37888
    s_waitcnt lgkmcnt(14)
    v_mfma_f32_16x16x32_bf16 v[8:11], v[80:83], a[184:187], v[8:11]
    v_add_f32 v34, v34, v35
    v_add_f32 v36, v36, v37
    v_mfma_f32_16x16x32_bf16 v[24:27], v[80:83], a[192:195], v[24:27]
    ds_read_b128 v[80:83], v158 offset:53248
    v_add_f32 v38, v38, v39
    v_mfma_f32_16x16x32_bf16 v[8:11], v[84:87], a[188:191], v[8:11]
    v_add_f32 v40, v40, v41
    v_add_f32 v42, v42, v43
    v_mfma_f32_16x16x32_bf16 v[24:27], v[84:87], a[196:199], v[24:27]
    ds_read_b128 v[84:87], v158 offset:54272
    s_waitcnt lgkmcnt(10)
    v_mfma_f32_16x16x32_bf16 v[8:11], v[56:59], a[40:43], v[8:11]
    v_add_f32 v44, v44, v45
    v_add_f32 v46, v46, v47
    v_mfma_f32_16x16x32_bf16 v[24:27], v[56:59], a[48:51], v[24:27]
    ds_read_b128 v[56:59], v159 offset:6144
    v_mfma_f32_16x16x32_bf16 v[8:11], v[60:63], a[44:47], v[8:11]
    v_fma_f32 v48, v48, v162, v32
    v_fma_f32 v49, v49, v162, v34
    v_mfma_f32_16x16x32_bf16 v[24:27], v[60:63], a[52:55], v[24:27]
    ds_read_b128 v[60:63], v159 offset:7168
    s_waitcnt lgkmcnt(6)
    v_mfma_f32_16x16x32_bf16 v[8:11], v[64:67], a[80:83], v[8:11]
    v_fma_f32 v50, v50, v162, v36
    v_fma_f32 v51, v51, v162, v38
    v_mfma_f32_16x16x32_bf16 v[24:27], v[64:67], a[88:91], v[24:27]
    ds_read_b128 v[64:67], v159 offset:22528
    v_fma_f32 v52, v52, v162, v40
    v_mfma_f32_16x16x32_bf16 v[8:11], v[68:71], a[84:87], v[8:11]
    v_fma_f32 v53, v53, v162, v42
    v_fma_f32 v54, v54, v162, v44
    v_mfma_f32_16x16x32_bf16 v[24:27], v[68:71], a[92:95], v[24:27]
    ds_read_b128 v[68:71], v159 offset:23552
    s_waitcnt lgkmcnt(6)
    v_mfma_f32_16x16x32_bf16 v[8:11], v[72:75], a[120:123], v[8:11]
    v_fma_f32 v55, v55, v162, v46
    v_mul_f32 v48, v88, v48
    v_mfma_f32_16x16x32_bf16 v[24:27], v[72:75], a[128:131], v[24:27]
    ds_read_b128 v[72:75], v159 offset:38912
    v_mul_f32 v49, v89, v49
    v_mfma_f32_16x16x32_bf16 v[8:11], v[76:79], a[124:127], v[8:11]
    v_mul_f32 v50, v90, v50
    v_mul_f32 v51, v91, v51
    v_mfma_f32_16x16x32_bf16 v[24:27], v[76:79], a[132:135], v[24:27]
    ds_read_b128 v[76:79], v159 offset:39936
    s_waitcnt lgkmcnt(6)
    v_mfma_f32_16x16x32_bf16 v[8:11], v[80:83], a[160:163], v[8:11]
    v_mul_f32 v52, v92, v52
    v_mul_f32 v53, v93, v53
    v_mfma_f32_16x16x32_bf16 v[24:27], v[80:83], a[168:171], v[24:27]
    ds_read_b128 v[80:83], v159 offset:55296
    v_mul_f32 v54, v94, v54
    v_mfma_f32_16x16x32_bf16 v[8:11], v[84:87], a[164:167], v[8:11]
    v_mul_f32 v55, v95, v55
    v_mul_f32 v19, v111, v19
    v_mfma_f32_16x16x32_bf16 v[24:27], v[84:87], a[172:175], v[24:27]
    ds_read_b128 v[84:87], v159 offset:56320
    s_waitcnt lgkmcnt(6)
    v_mfma_f32_16x16x32_bf16 v[12:15], v[56:59], a[64:67], v[12:15]
    v_xor_b32 v101, v170, v101
    v_mfma_f32_16x16x32_bf16 v[28:31], v[56:59], a[72:75], v[28:31]
    ds_read_b128 v[56:59], v158 offset:6144
    v_xor_b32 v103, v170, v103
    v_mfma_f32_16x16x32_bf16 v[12:15], v[60:63], a[68:71], v[12:15]
    v_fma_f32 v173, v130, v48, v49
    s_nop 1
    v_fmac_f32_dpp v173, v48, v131 row_ror:8 row_mask:0xf bank_mask:0xf
    v_mfma_f32_16x16x32_bf16 v[28:31], v[60:63], a[76:79], v[28:31]
    ds_read_b128 v[60:63], v158 offset:7168
    s_waitcnt lgkmcnt(6)
    v_mfma_f32_16x16x32_bf16 v[12:15], v[64:67], a[104:107], v[12:15]
    v_fma_f32 v172, v130, v173, v50
    s_nop 1
    v_fmac_f32_dpp v172, v173, v131 row_ror:8 row_mask:0xf bank_mask:0xf
    v_mfma_f32_16x16x32_bf16 v[28:31], v[64:67], a[112:115], v[28:31]
    ds_read_b128 v[64:67], v158 offset:22528
    v_fma_f32 v173, v130, v172, v51
    v_mfma_f32_16x16x32_bf16 v[12:15], v[68:71], a[108:111], v[12:15]
    s_nop 0
    v_fmac_f32_dpp v173, v172, v131 row_ror:8 row_mask:0xf bank_mask:0xf
    v_fma_f32 v172, v130, v173, v52
    v_mfma_f32_16x16x32_bf16 v[28:31], v[68:71], a[116:119], v[28:31]
    ds_read_b128 v[68:71], v158 offset:23552
    s_waitcnt lgkmcnt(6)
    v_mfma_f32_16x16x32_bf16 v[12:15], v[72:75], a[144:147], v[12:15]
    v_fmac_f32_dpp v172, v173, v131 row_ror:8 row_mask:0xf bank_mask:0xf
    v_fma_f32 v173, v130, v172, v53
    v_mfma_f32_16x16x32_bf16 v[28:31], v[72:75], a[152:155], v[28:31]
    ds_read_b128 v[72:75], v158 offset:38912
    v_fmac_f32_dpp v173, v172, v131 row_ror:8 row_mask:0xf bank_mask:0xf
    v_mfma_f32_16x16x32_bf16 v[12:15], v[76:79], a[148:151], v[12:15]
    v_fma_f32 v172, v130, v173, v54
    s_nop 1
    v_fmac_f32_dpp v172, v173, v131 row_ror:8 row_mask:0xf bank_mask:0xf
    v_mfma_f32_16x16x32_bf16 v[28:31], v[76:79], a[156:159], v[28:31]
    ds_read_b128 v[76:79], v158 offset:39936
    s_waitcnt lgkmcnt(6)
    v_mfma_f32_16x16x32_bf16 v[12:15], v[80:83], a[184:187], v[12:15]
    v_fma_f32 v173, v130, v172, v55
    s_nop 1
    v_fmac_f32_dpp v173, v172, v131 row_ror:8 row_mask:0xf bank_mask:0xf
    v_mfma_f32_16x16x32_bf16 v[28:31], v[80:83], a[192:195], v[28:31]
    ds_read_b128 v[80:83], v158 offset:55296
    ds_read_b128 v[104:107], v164 offset:32
    v_mfma_f32_16x16x32_bf16 v[12:15], v[84:87], a[188:191], v[12:15]
    ds_read_b128 v[108:111], v164 offset:288
    v_mfma_f32_16x16x32_bf16 v[28:31], v[84:87], a[196:199], v[28:31]
    ds_read_b128 v[84:87], v158 offset:56320
    s_waitcnt lgkmcnt(8)
    v_mfma_f32_16x16x32_bf16 v[12:15], v[56:59], a[40:43], v[12:15]
    v_fma_f32 v124, v0, v128, v2
    v_fma_f32 v125, v1, v128, v3
    v_mfma_f32_16x16x32_bf16 v[28:31], v[56:59], a[48:51], v[28:31]
    v_fma_f32 v126, v16, v128, v18
    v_fma_f32 v127, v17, v128, v19
    v_mfma_f32_16x16x32_bf16 v[12:15], v[60:63], a[44:47], v[12:15]
    v_fma_f32 v124, -v16, v129, v124
    v_fma_f32 v125, -v17, v129, v125
    v_mfma_f32_16x16x32_bf16 v[28:31], v[60:63], a[52:55], v[28:31]
    v_fmac_f32 v126, v0, v129
    s_waitcnt lgkmcnt(6)
    v_mfma_f32_16x16x32_bf16 v[12:15], v[64:67], a[80:83], v[12:15]
    v_fmac_f32 v127, v1, v129
    v_mfma_f32_16x16x32_bf16 v[28:31], v[64:67], a[88:91], v[28:31]
    v_fmac_f32 v4, v112, v160
    v_mfma_f32_16x16x32_bf16 v[12:15], v[68:71], a[84:87], v[12:15]
    v_fmac_f32 v5, v113, v160
    v_fmac_f32 v20, v112, v161
    v_mfma_f32_16x16x32_bf16 v[28:31], v[68:71], a[92:95], v[28:31]
    v_fmac_f32 v21, v113, v161
    s_waitcnt lgkmcnt(4)
    v_mfma_f32_16x16x32_bf16 v[12:15], v[72:75], a[120:123], v[12:15]
    v_mul_f32 v4, v116, v4
    v_mul_f32 v5, v117, v5
    v_mfma_f32_16x16x32_bf16 v[28:31], v[72:75], a[128:131], v[28:31]
    v_mul_f32 v20, v116, v20
    v_mul_f32 v21, v117, v21
    v_mfma_f32_16x16x32_bf16 v[12:15], v[76:79], a[124:127], v[12:15]
    v_fmac_f32 v6, v114, v160
    v_fmac_f32 v7, v115, v160
    v_mfma_f32_16x16x32_bf16 v[28:31], v[76:79], a[132:135], v[28:31]
    v_fmac_f32 v22, v114, v161
    s_waitcnt lgkmcnt(0)
    v_mfma_f32_16x16x32_bf16 v[12:15], v[80:83], a[160:163], v[12:15]
    v_fmac_f32 v23, v115, v161
    v_mul_f32 v6, v118, v6
    v_mfma_f32_16x16x32_bf16 v[28:31], v[80:83], a[168:171], v[28:31]
    v_mul_f32 v7, v119, v7
    v_mul_f32 v22, v118, v22
    v_mfma_f32_16x16x32_bf16 v[12:15], v[84:87], a[164:167], v[12:15]
    v_mul_f32 v23, v119, v23
    v_mfma_f32_16x16x32_bf16 v[28:31], v[84:87], a[172:175], v[28:31]
    ds_read_b128 v[112:115], v164 offset:48
    ds_read_b128 v[116:119], v164 offset:304
    v_pk_fma_f32 v[120:121], v[124:125], v[128:129], v[4:5] op_sel_hi:[1,0,1]
    v_pk_fma_f32 v[122:123], v[126:127], v[128:129], v[20:21] op_sel_hi:[1,0,1]
    v_pk_fma_f32 v[120:121], v[126:127], v[128:129], v[120:121] op_sel:[0,1,0] neg_lo:[1,0,0] neg_hi:[1,0,0]
    v_pk_fma_f32 v[122:123], v[124:125], v[128:129], v[122:123] op_sel:[0,1,0]
    v_pk_fma_f32 v[124:125], v[120:121], v[128:129], v[6:7] op_sel_hi:[1,0,1]
    v_pk_fma_f32 v[126:127], v[122:123], v[128:129], v[22:23] op_sel_hi:[1,0,1]
    v_pk_fma_f32 v[124:125], v[122:123], v[128:129], v[124:125] op_sel:[0,1,0] neg_lo:[1,0,0] neg_hi:[1,0,0]
    v_pk_fma_f32 v[126:127], v[120:121], v[128:129], v[126:127] op_sel:[0,1,0]
    v_pk_fma_f32 v[8:9], v[104:105], v[160:161], v[8:9] op_sel_hi:[1,0,1]
    v_pk_fma_f32 v[24:25], v[104:105], v[160:161], v[24:25] op_sel:[0,1,0]
    v_pk_fma_f32 v[10:11], v[106:107], v[160:161], v[10:11] op_sel_hi:[1,0,1]
    v_pk_fma_f32 v[26:27], v[106:107], v[160:161], v[26:27] op_sel:[0,1,0]
    v_pk_mul_f32 v[8:9], v[108:109], v[8:9]
    v_pk_mul_f32 v[24:25], v[108:109], v[24:25]
    v_pk_mul_f32 v[10:11], v[110:111], v[10:11]
    v_pk_mul_f32 v[26:27], v[110:111], v[26:27]
    v_pk_fma_f32 v[120:121], v[124:125], v[128:129], v[8:9] op_sel_hi:[1,0,1]
    v_pk_fma_f32 v[122:123], v[126:127], v[128:129], v[24:25] op_sel_hi:[1,0,1]
    v_pk_fma_f32 v[120:121], v[126:127], v[128:129], v[120:121] op_sel:[0,1,0] neg_lo:[1,0,0] neg_hi:[1,0,0]
    v_pk_fma_f32 v[122:123], v[124:125], v[128:129], v[122:123] op_sel:[0,1,0]
    v_pk_fma_f32 v[124:125], v[120:121], v[128:129], v[10:11] op_sel_hi:[1,0,1]
    v_pk_fma_f32 v[126:127], v[122:123], v[128:129], v[26:27] op_sel_hi:[1,0,1]
    v_pk_fma_f32 v[124:125], v[122:123], v[128:129], v[124:125] op_sel:[0,1,0] neg_lo:[1,0,0] neg_hi:[1,0,0]
    v_pk_fma_f32 v[126:127], v[120:121], v[128:129], v[126:127] op_sel:[0,1,0]
    s_waitcnt lgkmcnt(0)
    v_pk_fma_f32 v[12:13], v[112:113], v[160:161], v[12:13] op_sel_hi:[1,0,1]
    v_pk_fma_f32 v[28:29], v[112:113], v[160:161], v[28:29] op_sel:[0,1,0]
    v_pk_fma_f32 v[14:15], v[114:115], v[160:161], v[14:15] op_sel_hi:[1,0,1]
    v_pk_fma_f32 v[30:31], v[114:115], v[160:161], v[30:31] op_sel:[0,1,0]
    v_pk_mul_f32 v[12:13], v[116:117], v[12:13]
    v_pk_mul_f32 v[28:29], v[116:117], v[28:29]
    v_pk_mul_f32 v[14:15], v[118:119], v[14:15]
    v_pk_mul_f32 v[30:31], v[118:119], v[30:31]
    v_pk_fma_f32 v[120:121], v[124:125], v[128:129], v[12:13] op_sel_hi:[1,0,1]
    v_pk_fma_f32 v[122:123], v[126:127], v[128:129], v[28:29] op_sel_hi:[1,0,1]
    v_pk_fma_f32 v[120:121], v[126:127], v[128:129], v[120:121] op_sel:[0,1,0] neg_lo:[1,0,0] neg_hi:[1,0,0]
    v_pk_fma_f32 v[122:123], v[124:125], v[128:129], v[122:123] op_sel:[0,1,0]
    v_pk_fma_f32 v[124:125], v[120:121], v[128:129], v[14:15] op_sel_hi:[1,0,1]
    v_pk_fma_f32 v[126:127], v[122:123], v[128:129], v[30:31] op_sel_hi:[1,0,1]
    v_pk_fma_f32 v[124:125], v[122:123], v[128:129], v[124:125] op_sel:[0,1,0] neg_lo:[1,0,0] neg_hi:[1,0,0]
    v_pk_fma_f32 v[126:127], v[120:121], v[128:129], v[126:127] op_sel:[0,1,0]
    v_mul_f32 v59, v100, v173
    v_fma_f32 v56, v96, v124, v125
    v_fma_f32 v57, v96, v126, v127
    v_fmac_f32_dpp v59, v173, v101 row_ror:8 row_mask:0xf bank_mask:0xf
    v_mov_b32_dpp v58, v173 quad_perm:[1,1,3,3] row_mask:0xf bank_mask:0xf
    v_fma_f32 v56, -v97, v126, v56
    v_fmac_f32 v57, v97, v124
    v_add_f32_dpp v58, v59, v58 quad_perm:[0,0,2,2] row_mask:0xf bank_mask:0xf
    v_mov_b64 v[64:65], v[56:57]
    v_mov_b32 v66, v58
    v_mov_b32 v71, s82
    v_permlane32_swap_b32 v56, v64
    v_permlane32_swap_b32 v57, v65
    v_permlane32_swap_b32 v58, v66
    v_mov_b64 v[60:61], v[56:57]
    v_mov_b32 v62, v58
    v_mov_b64 v[68:69], v[64:65]
    v_mov_b32 v70, v66

    v_permlane16_swap_b32 v58, v62
    v_permlane16_swap_b32 v56, v60
    v_permlane16_swap_b32 v57, v61
    v_permlane16_swap_b32 v66, v70
    v_fmac_f32_dpp v62, v58, v103 row_ror:8 row_mask:0xf bank_mask:0xf
    v_pk_fma_f32 v[60:61], v[56:57], v[98:99], v[60:61] op_sel_hi:[1,0,1]
    v_permlane16_swap_b32 v64, v68
    v_fmac_f32 v62, v102, v58
    v_pk_fma_f32 v[60:61], v[56:57], v[98:99], v[60:61] op_sel:[1,1,0] op_sel_hi:[0,1,1] neg_lo:[1,0,0]
    v_permlane16_swap_b32 v65, v69
    v_fmac_f32_dpp v66, v62, v103 row_ror:8 row_mask:0xf bank_mask:0xf
    v_fmac_f32 v66, v102, v62
    v_pk_fma_f32 v[64:65], v[60:61], v[98:99], v[64:65] op_sel_hi:[1,0,1]
    v_pk_fma_f32 v[64:65], v[60:61], v[98:99], v[64:65] op_sel:[1,1,0] op_sel_hi:[0,1,1] neg_lo:[1,0,0]
    v_fmac_f32_dpp v70, v66, v103 row_ror:8 row_mask:0xf bank_mask:0xf
    v_fmac_f32 v70, v102, v66
    v_pk_fma_f32 v[68:69], v[64:65], v[98:99], v[68:69] op_sel_hi:[1,0,1]
    v_pk_fma_f32 v[68:69], v[64:65], v[98:99], v[68:69] op_sel:[1,1,0] op_sel_hi:[0,1,1] neg_lo:[1,0,0]
    s_mov_b64 exec, 0xffff
    buffer_store_dwordx4 v[68:71], v153, s[92:95], s21 offen sc1
    s_mov_b64 exec, -1
    v_and_b32 v110, 1, v152
    v_mul_u32_u24 v110, 640, v110
    v_add_u32 v110, v171, v110
    ds_read2_b32 v[72:73], v165 offset1:160
    ds_read2_b32 v[74:75], v165 offset0:1 offset1:161
    ds_read_b64 v[76:77], v171 offset:0
    ds_read_b64 v[78:79], v110 offset:0
    v_lshrrev_b32 v109, 4, v152
    s_mov_b32 s4, 93696
    v_lshl_add_u32 v108, v109, 5, s4
    v_lshl_add_u32 v109, v109, 4, s4
    ds_read_b128 v[88:91], v108 offset:0
    ds_read_b128 v[92:95], v108 offset:16
    ds_read_b128 v[96:99], v108 offset:128
    ds_read_b128 v[100:103], v108 offset:144
    ds_read_b128 v[104:107], v109 offset:256
    s_lshl_b32 s8, s79, 13
    s_add_u32 s8, s8, 11272192
    s_and_b32 s4, s91, 31
    s_lshl_b32 s4, s4, 2
    s_add_u32 s4, s4, s8
    v_mov_b32 v110, s4
    s_not_b32 s13, s82
    v_mov_b32 v111, s13
    v_and_b32 v87, 31, v152
    v_lshl_add_u32 v87, v87, 2, s8
    s_cmp_eq_u32 s88, 0
    s_cbranch_scc1 Lss_13
    global_store_dword v110, v111, s[50:51]
Lsd_14:
    s_movk_i32 s9, 0x70
    v_lshrrev_b32 v164, 3, v152
    v_lshlrev_b32 v164, 12, v164
    v_and_or_b32 v164, v153, s9, v164
    s_mul_i32 s6, s78, 327680
    s_lshl_b32 s5, s79, 7
    s_add_u32 s6, s6, s5
    s_lshl_b32 s5, s77, 14
    s_add_u32 s7, s6, s5
    s_add_u32 s7, s7, 262144
    s_lshl_b32 s5, s77, 16
    s_add_u32 s6, s6, s5
    s_mov_b32 s5, 3145728
    s_add_u32 s6, s6, s5
    s_add_u32 s7, s7, s5
    s_lshl_b32 s5, s77, 9
    s_barrier
    s_add_u32 m0, s100, 61440
    s_nop 0
    buffer_load_dwordx4 v164, s[68:71], s6 offen sc1 lds
    s_add_u32 m0, s100, 62464
    s_add_u32 s83, s6, 32768
    buffer_load_dwordx4 v164, s[68:71], s83 offen sc1 lds
    s_add_u32 m0, s5, 69632
    s_mov_b32 exec_hi, 0
    buffer_load_dwordx4 v164, s[68:71], s7 offen sc1 lds
    s_mov_b32 exec_hi, -1
    v_mov_b32 v59, 0
    s_waitcnt lgkmcnt(5)
    v_xor_b32 v76, v170, v76
    v_xor_b32 v78, v170, v78
    v_mov_b32_dpp v56, v60 quad_perm:[0,1,2,3] row_mask:4 bank_mask:0xf
    v_mov_b32_dpp v57, v61 quad_perm:[0,1,2,3] row_mask:4 bank_mask:0xf
    v_mov_b32_dpp v58, v62 quad_perm:[0,1,2,3] row_mask:4 bank_mask:0xf
    v_mov_b32_dpp v56, v64 quad_perm:[0,1,2,3] row_mask:8 bank_mask:0xf
    v_mov_b32_dpp v57, v65 quad_perm:[0,1,2,3] row_mask:8 bank_mask:0xf
    v_mov_b32_dpp v58, v66 quad_perm:[0,1,2,3] row_mask:8 bank_mask:0xf
    v_mov_b32_dpp v56, v59 quad_perm:[0,1,2,3] row_mask:1 bank_mask:0xf
    v_mov_b32_dpp v57, v59 quad_perm:[0,1,2,3] row_mask:1 bank_mask:0xf
    v_mov_b32_dpp v58, v59 quad_perm:[0,1,2,3] row_mask:1 bank_mask:0xf
    v_mul_f32_dpp v63, -v173, v77 row_ror:8 row_mask:0xf bank_mask:0xf
    v_fma_f32 v63, -v76, v173, v63
    v_mul_f32_dpp v84, -v58, v79 row_ror:8 row_mask:0xf bank_mask:0xf
    v_pk_mul_f32 v[80:81], v[72:73], v[56:57] op_sel_hi:[1,0]
    v_pk_mul_f32 v[82:83], v[72:73], v[56:57] op_sel:[0,1]
    v_pk_fma_f32 v[80:81], v[74:75], v[56:57], v[80:81] op_sel:[0,1,0] neg_lo:[1,0,0] neg_hi:[1,0,0]
    v_pk_fma_f32 v[82:83], v[74:75], v[56:57], v[82:83] op_sel_hi:[1,0,1]
    v_fma_f32 v84, -v78, v58, v84
    v_fmac_f32 v81, v72, v124
    v_fmac_f32 v83, v72, v126
    v_fma_f32 v81, -v74, v126, v81
    v_fmac_f32 v83, v74, v124
    v_mov_b32_dpp v59, v63 quad_perm:[0,0,2,2] row_mask:0xf bank_mask:0xf
    s_mov_b32 exec_lo, 0xaaaaaaaa
    s_mov_b32 exec_hi, 0xaaaaaaaa
    v_add_f32 v84, v84, v59
    s_mov_b64 exec, -1
    s_waitcnt lgkmcnt(0)
    v_pk_fma_f32 v[112:113], v[132:133], v[166:167], v[166:167] op_sel:[0,0,1] op_sel_hi:[1,0,1]
    v_pk_fma_f32 v[114:115], v[134:135], v[166:167], v[166:167] op_sel:[0,0,1] op_sel_hi:[1,0,1]
    v_pk_fma_f32 v[132:133], v[112:113], v[88:89], v[132:133]
    v_pk_fma_f32 v[134:135], v[114:115], v[90:91], v[134:135]
    v_pk_fma_f32 v[112:113], v[136:137], v[166:167], v[166:167] op_sel:[0,0,1] op_sel_hi:[1,0,1]
    v_pk_fma_f32 v[114:115], v[138:139], v[166:167], v[166:167] op_sel:[0,0,1] op_sel_hi:[1,0,1]
    v_pk_fma_f32 v[136:137], v[112:113], v[92:93], v[136:137]
    v_pk_fma_f32 v[138:139], v[114:115], v[94:95], v[138:139]
    v_pk_fma_f32 v[112:113], v[140:141], v[166:167], v[166:167] op_sel:[0,0,1] op_sel_hi:[1,0,1]
    v_pk_fma_f32 v[114:115], v[142:143], v[166:167], v[166:167] op_sel:[0,0,1] op_sel_hi:[1,0,1]
    v_pk_fma_f32 v[140:141], v[112:113], v[96:97], v[140:141]
    v_pk_fma_f32 v[142:143], v[114:115], v[98:99], v[142:143]
    v_pk_fma_f32 v[112:113], v[144:145], v[166:167], v[166:167] op_sel:[0,0,1] op_sel_hi:[1,0,1]
    v_pk_fma_f32 v[114:115], v[146:147], v[166:167], v[166:167] op_sel:[0,0,1] op_sel_hi:[1,0,1]
    v_pk_fma_f32 v[144:145], v[112:113], v[100:101], v[144:145]
    v_pk_fma_f32 v[146:147], v[114:115], v[102:103], v[146:147]
    v_pk_fma_f32 v[112:113], v[148:149], v[166:167], v[166:167] op_sel:[0,0,1] op_sel_hi:[1,0,1]
    v_pk_fma_f32 v[114:115], v[150:151], v[166:167], v[166:167] op_sel:[0,0,1] op_sel_hi:[1,0,1]
    v_pk_fma_f32 v[148:149], v[112:113], v[104:105], v[148:149]
    v_pk_fma_f32 v[150:151], v[114:115], v[106:107], v[150:151]
    v_lshrrev_b32 v120, 4, v152
    v_and_b32 v85, 0xf0, v153
    v_lshl_add_u32 v85, v120, 11, v85
    v_add_u32 v85, s21, v85
    v_lshlrev_b32 v120, 3, v120
    v_sub_u32 v120, s79, v120
    v_med3_i32 v120, v120, 0, 8
    v_mul_lo_u32 v86, v120, s82
    v_lshrrev_b32 v120, 4, v152
    v_mul_u32_u24 v120, 640, v120
    v_add_u32 v121, v165, v120
    v_add_u32 v122, v171, v120
    ds_read_b64 v[32:33], v165 offset:9600
    ds_read_b64 v[34:35], v171 offset:9600
    ds_read_b64 v[36:37], v121 offset:5120
    ds_read_b64 v[38:39], v122 offset:5120
    v_add_u32 v121, v121, v120
    v_add_u32 v122, v122, v120
    v_and_b32 v120, 1, v152
    v_mul_u32_u24 v120, 640, v120
    v_add_u32 v122, v122, v120
    ds_read2_b32 v[40:41], v121 offset1:160
    ds_read2_b32 v[42:43], v121 offset0:1 offset1:161
    ds_read_b64 v[44:45], v122 offset:0
    v_mul_f32_dpp v126, -v48, v77 row_ror:8 row_mask:0xf bank_mask:0xf
    v_pk_mul_f32 v[124:125], v[0:1], v[74:75] op_sel_hi:[1,0]
    v_pk_mul_f32 v[0:1], v[0:1], v[72:73] op_sel_hi:[1,0]
    v_pk_fma_f32 v[0:1], v[16:17], v[74:75], v[0:1] op_sel_hi:[1,0,1] neg_lo:[1,0,0] neg_hi:[1,0,0]
    v_pk_fma_f32 v[16:17], v[16:17], v[72:73], v[124:125] op_sel_hi:[1,0,1]
    v_fma_f32 v48, -v76, v48, v126
    v_mul_f32_dpp v126, -v49, v77 row_ror:8 row_mask:0xf bank_mask:0xf
    v_pk_mul_f32 v[124:125], v[2:3], v[74:75] op_sel_hi:[1,0]
    v_pk_mul_f32 v[2:3], v[2:3], v[72:73] op_sel_hi:[1,0]
    v_pk_fma_f32 v[2:3], v[18:19], v[74:75], v[2:3] op_sel_hi:[1,0,1] neg_lo:[1,0,0] neg_hi:[1,0,0]
    v_pk_fma_f32 v[18:19], v[18:19], v[72:73], v[124:125] op_sel_hi:[1,0,1]
    v_fma_f32 v49, -v76, v49, v126
    v_mul_f32_dpp v126, -v50, v77 row_ror:8 row_mask:0xf bank_mask:0xf
    v_pk_mul_f32 v[124:125], v[4:5], v[74:75] op_sel_hi:[1,0]
    v_pk_mul_f32 v[4:5], v[4:5], v[72:73] op_sel_hi:[1,0]
    v_pk_fma_f32 v[4:5], v[20:21], v[74:75], v[4:5] op_sel_hi:[1,0,1] neg_lo:[1,0,0] neg_hi:[1,0,0]
    v_pk_fma_f32 v[20:21], v[20:21], v[72:73], v[124:125] op_sel_hi:[1,0,1]
    v_fma_f32 v50, -v76, v50, v126
    v_mul_f32_dpp v126, -v51, v77 row_ror:8 row_mask:0xf bank_mask:0xf
    v_pk_mul_f32 v[124:125], v[6:7], v[74:75] op_sel_hi:[1,0]
    v_pk_mul_f32 v[6:7], v[6:7], v[72:73] op_sel_hi:[1,0]
    v_pk_fma_f32 v[6:7], v[22:23], v[74:75], v[6:7] op_sel_hi:[1,0,1] neg_lo:[1,0,0] neg_hi:[1,0,0]
    v_pk_fma_f32 v[22:23], v[22:23], v[72:73], v[124:125] op_sel_hi:[1,0,1]
    v_fma_f32 v51, -v76, v51, v126
    v_mul_f32_dpp v126, -v52, v77 row_ror:8 row_mask:0xf bank_mask:0xf
    v_pk_mul_f32 v[124:125], v[8:9], v[74:75] op_sel_hi:[1,0]
    v_pk_mul_f32 v[8:9], v[8:9], v[72:73] op_sel_hi:[1,0]
    v_pk_fma_f32 v[8:9], v[24:25], v[74:75], v[8:9] op_sel_hi:[1,0,1] neg_lo:[1,0,0] neg_hi:[1,0,0]
    v_pk_fma_f32 v[24:25], v[24:25], v[72:73], v[124:125] op_sel_hi:[1,0,1]
    v_fma_f32 v52, -v76, v52, v126
    v_mul_f32_dpp v126, -v53, v77 row_ror:8 row_mask:0xf bank_mask:0xf
    v_pk_mul_f32 v[124:125], v[10:11], v[74:75] op_sel_hi:[1,0]
    v_pk_mul_f32 v[10:11], v[10:11], v[72:73] op_sel_hi:[1,0]
    v_pk_fma_f32 v[10:11], v[26:27], v[74:75], v[10:11] op_sel_hi:[1,0,1] neg_lo:[1,0,0] neg_hi:[1,0,0]
    v_pk_fma_f32 v[26:27], v[26:27], v[72:73], v[124:125] op_sel_hi:[1,0,1]
    v_fma_f32 v53, -v76, v53, v126
    buffer_load_dwordx4 v[116:119], v85, s[92:95], 0 offen offset:2048 sc1
    v_mul_f32_dpp v126, -v54, v77 row_ror:8 row_mask:0xf bank_mask:0xf
    v_pk_mul_f32 v[124:125], v[12:13], v[74:75] op_sel_hi:[1,0]
    v_pk_mul_f32 v[12:13], v[12:13], v[72:73] op_sel_hi:[1,0]
    v_pk_fma_f32 v[12:13], v[28:29], v[74:75], v[12:13] op_sel_hi:[1,0,1] neg_lo:[1,0,0] neg_hi:[1,0,0]
    v_pk_fma_f32 v[28:29], v[28:29], v[72:73], v[124:125] op_sel_hi:[1,0,1]
    v_fma_f32 v54, -v76, v54, v126
    buffer_load_dwordx4 v[112:115], v85, s[92:95], 0 offen offset:1792 sc1
    v_mul_f32_dpp v126, -v55, v77 row_ror:8 row_mask:0xf bank_mask:0xf
    v_pk_mul_f32 v[124:125], v[14:15], v[74:75] op_sel_hi:[1,0]
    v_pk_mul_f32 v[14:15], v[14:15], v[72:73] op_sel_hi:[1,0]
    v_pk_fma_f32 v[14:15], v[30:31], v[74:75], v[14:15] op_sel_hi:[1,0,1] neg_lo:[1,0,0] neg_hi:[1,0,0]
    v_pk_fma_f32 v[30:31], v[30:31], v[72:73], v[124:125] op_sel_hi:[1,0,1]
    v_fma_f32 v55, -v76, v55, v126
    buffer_load_dwordx4 v[108:111], v85, s[92:95], 0 offen offset:1536 sc1
    s_waitcnt lgkmcnt(0)
    v_xor_b32 v35, v170, v35
    v_xor_b32 v39, v170, v39
    v_xor_b32 v44, v170, v44
    s_add_u32 s6, s100, 71680
    v_bfe_u32 v63, v152, 4, 1
    buffer_load_dwordx4 v[104:107], v85, s[92:95], 0 offen offset:1280 sc1
    v_lshlrev_b32 v63, 6, v63
    v_xor_b32 v56, v63, v153
    v_add_u32 v56, s6, v56
    v_and_b32 v58, 3, v152
    v_lshl_add_u32 v58, v58, 8, s6
    v_lshl_add_u32 v58, v63, 1, v58
    buffer_load_dwordx4 v[100:103], v85, s[92:95], 0 offen offset:1024 sc1
    v_bfe_u32 v63, v152, 2, 2
    v_lshl_add_u32 v58, v63, 4, v58
    v_lshrrev_b32 v57, 5, v152
    v_lshl_add_u32 v58, v57, 3, v58
    v_and_b32 v63, 1, v152
    v_lshl_add_u32 v58, v63, 6, v58
    buffer_load_dwordx4 v[96:99], v85, s[92:95], 0 offen offset:768 sc1
    v_xor_b32 v59, 64, v58
    s_lshl_b32 s3, s77, 10
    s_add_u32 s3, s3, 94016
    v_lshl_add_u32 v60, v63, 2, s3
    v_lshlrev_b32 v62, 5, v63
    v_bfe_u32 v63, v152, 1, 3
    buffer_load_dwordx4 v[92:95], v85, s[92:95], 0 offen offset:512 sc1
    v_lshl_add_u32 v60, v63, 5, v60
    v_and_b32 v63, 1, v63
    v_lshl_add_u32 v62, v63, 4, v62
    v_and_b32 v63, 0xc0, v153
    v_add_u32 v62, v63, v62
    v_lshrrev_b32 v63, 4, v152
    buffer_load_dwordx4 v[88:91], v85, s[92:95], 0 offen offset:256 sc1
    v_lshl_add_u32 v60, v63, 3, v60
    v_lshl_add_u32 v61, v63, 7, s3
    v_lshl_add_u32 v61, v152, 3, v61
    v_mul_u32_u24 v63, 40960, v63
    v_add_u32 v62, v63, v62
    v_and_b32 v120, 15, v152
    global_load_dword v64, v87, s[50:51] sc1
    v_min_u32 v120, 9, v120
    v_lshrrev_b32 v121, 4, v152
    v_mul_u32_u24 v121, 40960, v121
    v_lshl_add_u32 v120, v120, 10, v121
    v_sub_u32 v121, v175, v153
    v_add_u32 v158, v120, v121
L_cchk1:
    s_waitcnt vmcnt(7)
    v_fmac_f32_dpp v114, v118, v35 row_ror:8 row_mask:0xf bank_mask:0xf
    v_fmac_f32 v114, v34, v118
    v_pk_fma_f32 v[112:113], v[116:117], v[32:33], v[112:113] op_sel_hi:[1,0,1]
    v_pk_fma_f32 v[112:113], v[116:117], v[32:33], v[112:113] op_sel:[1,1,0] op_sel_hi:[0,1,1] neg_lo:[1,0,0]
    s_waitcnt vmcnt(6)
    v_add3_u32 v169, v119, v115, v111
    v_fmac_f32_dpp v110, v114, v35 row_ror:8 row_mask:0xf bank_mask:0xf
    v_fmac_f32 v110, v34, v114
    v_pk_fma_f32 v[108:109], v[112:113], v[32:33], v[108:109] op_sel_hi:[1,0,1]
    v_pk_fma_f32 v[108:109], v[112:113], v[32:33], v[108:109] op_sel:[1,1,0] op_sel_hi:[0,1,1] neg_lo:[1,0,0]
    s_waitcnt vmcnt(5)
    v_fmac_f32_dpp v106, v110, v35 row_ror:8 row_mask:0xf bank_mask:0xf
    v_fmac_f32 v106, v34, v110
    v_pk_fma_f32 v[104:105], v[108:109], v[32:33], v[104:105] op_sel_hi:[1,0,1]
    v_pk_fma_f32 v[104:105], v[108:109], v[32:33], v[104:105] op_sel:[1,1,0] op_sel_hi:[0,1,1] neg_lo:[1,0,0]
    s_waitcnt vmcnt(4)
    v_add3_u32 v169, v169, v107, v103
    v_fmac_f32_dpp v102, v106, v35 row_ror:8 row_mask:0xf bank_mask:0xf
    v_fmac_f32 v102, v34, v106
    v_pk_fma_f32 v[100:101], v[104:105], v[32:33], v[100:101] op_sel_hi:[1,0,1]
    v_pk_fma_f32 v[100:101], v[104:105], v[32:33], v[100:101] op_sel:[1,1,0] op_sel_hi:[0,1,1] neg_lo:[1,0,0]
    s_waitcnt vmcnt(3)
    v_fmac_f32_dpp v98, v102, v35 row_ror:8 row_mask:0xf bank_mask:0xf
    v_fmac_f32 v98, v34, v102
    v_pk_fma_f32 v[96:97], v[100:101], v[32:33], v[96:97] op_sel_hi:[1,0,1]
    v_pk_fma_f32 v[96:97], v[100:101], v[32:33], v[96:97] op_sel:[1,1,0] op_sel_hi:[0,1,1] neg_lo:[1,0,0]
    s_waitcnt vmcnt(2)
    v_add3_u32 v169, v169, v99, v95
    v_fmac_f32_dpp v94, v98, v35 row_ror:8 row_mask:0xf bank_mask:0xf
    v_fmac_f32 v94, v34, v98
    v_pk_fma_f32 v[92:93], v[96:97], v[32:33], v[92:93] op_sel_hi:[1,0,1]
    v_pk_fma_f32 v[92:93], v[96:97], v[32:33], v[92:93] op_sel:[1,1,0] op_sel_hi:[0,1,1] neg_lo:[1,0,0]
    s_waitcnt vmcnt(1)
    v_add_u32 v169, v169, v91
    v_cmp_ne_u32 vcc, v169, v86
    v_fmac_f32_dpp v90, v94, v35 row_ror:8 row_mask:0xf bank_mask:0xf
    v_fmac_f32 v90, v34, v94
    v_pk_fma_f32 v[88:89], v[92:93], v[32:33], v[88:89] op_sel_hi:[1,0,1]
    v_pk_fma_f32 v[88:89], v[92:93], v[32:33], v[88:89] op_sel:[1,1,0] op_sel_hi:[0,1,1] neg_lo:[1,0,0]
    s_cbranch_vccnz L_cre1
    v_mul_f32_dpp v94, v90, v39 row_ror:8 row_mask:0xf bank_mask:0xf
    v_pk_mul_f32 v[92:93], v[88:89], v[36:37] op_sel_hi:[1,0]
    v_fmac_f32 v94, v38, v90
    v_pk_fma_f32 v[92:93], v[88:89], v[36:37], v[92:93] op_sel:[1,1,0] op_sel_hi:[0,1,1] neg_lo:[1,0,0]

    v_mov_b32 v98, v94
    v_mov_b64 v[96:97], v[92:93]
    s_nop 0
    v_permlane32_swap_b32 v94, v98
    v_permlane32_swap_b32 v92, v96
    v_permlane32_swap_b32 v93, v97
    v_add_f32 v94, v94, v98
    v_pk_add_f32 v[92:93], v[92:93], v[96:97]

    v_mov_b32 v98, v94
    v_mov_b64 v[96:97], v[92:93]
    s_nop 0
    v_permlane16_swap_b32 v94, v98
    v_permlane16_swap_b32 v92, v96
    v_permlane16_swap_b32 v93, v97
    v_add_f32 v94, v94, v98
    v_pk_add_f32 v[92:93], v[92:93], v[96:97]

    v_fma_f32 v84, -v44, v94, v84
    v_pk_fma_f32 v[80:81], v[40:41], v[92:93], v[80:81] op_sel_hi:[1,0,1]
    v_pk_fma_f32 v[82:83], v[40:41], v[92:93], v[82:83] op_sel:[0,1,0]
    v_fmac_f32_dpp v84, -v94, v45 row_ror:8 row_mask:0xf bank_mask:0xf
    v_pk_fma_f32 v[80:81], v[42:43], v[92:93], v[80:81] op_sel:[0,1,0] neg_lo:[1,0,0] neg_hi:[1,0,0]
    v_pk_fma_f32 v[82:83], v[42:43], v[92:93], v[82:83] op_sel_hi:[1,0,1]

    s_waitcnt vmcnt(0)
L_xr:
    v_cmp_ne_u32 vcc, s13, v64
    s_cbranch_vccnz L_xr_re
    s_cmp_eq_u32 s88, 0
    s_cbranch_scc1 L_p2s1
    v_fmac_f32_dpp v48, -v84, v131 row_ror:8 row_mask:0xf bank_mask:0xf
    v_fmac_f32 v48, v130, v84
    v_pk_fma_f32 v[0:1], v[80:81], v[128:129], v[0:1] op_sel_hi:[1,0,1]
    v_pk_fma_f32 v[16:17], v[82:83], v[128:129], v[16:17] op_sel_hi:[1,0,1]
    v_fmac_f32_dpp v49, -v48, v131 row_ror:8 row_mask:0xf bank_mask:0xf
    v_fmac_f32 v49, v130, v48
    v_pk_fma_f32 v[0:1], v[82:83], v[128:129], v[0:1] op_sel:[0,1,0] neg_lo:[1,0,0] neg_hi:[1,0,0]
    v_pk_fma_f32 v[16:17], v[80:81], v[128:129], v[16:17] op_sel:[0,1,0]
    v_fmac_f32_dpp v50, -v49, v131 row_ror:8 row_mask:0xf bank_mask:0xf
    v_fmac_f32 v50, v130, v49
    v_pk_fma_f32 v[2:3], v[0:1], v[128:129], v[2:3] op_sel_hi:[1,0,1]
    v_pk_fma_f32 v[18:19], v[16:17], v[128:129], v[18:19] op_sel_hi:[1,0,1]
    v_fmac_f32_dpp v51, -v50, v131 row_ror:8 row_mask:0xf bank_mask:0xf
    v_fmac_f32 v51, v130, v50
    v_pk_fma_f32 v[2:3], v[16:17], v[128:129], v[2:3] op_sel:[0,1,0] neg_lo:[1,0,0] neg_hi:[1,0,0]
    v_pk_fma_f32 v[18:19], v[0:1], v[128:129], v[18:19] op_sel:[0,1,0]
    v_cvt_pk_bf16_f32 v104, v0, v1
    v_cvt_pk_bf16_f32 v105, v2, v3
    v_cvt_pk_bf16_f32 v106, -v16, -v17
    v_cvt_pk_bf16_f32 v107, -v18, -v19

    ds_write_b128 v56, v[104:107] offset:0
    ds_read_b64_tr_b16 v[88:89], v58 offset:0
    ds_read_b64_tr_b16 v[90:91], v59 offset:0
    v_fmac_f32_dpp v52, -v51, v131 row_ror:8 row_mask:0xf bank_mask:0xf
    v_fmac_f32 v52, v130, v51
    v_pk_fma_f32 v[4:5], v[2:3], v[128:129], v[4:5] op_sel_hi:[1,0,1]
    v_pk_fma_f32 v[20:21], v[18:19], v[128:129], v[20:21] op_sel_hi:[1,0,1]
    v_fmac_f32_dpp v53, -v52, v131 row_ror:8 row_mask:0xf bank_mask:0xf
    v_fmac_f32 v53, v130, v52
    v_pk_fma_f32 v[4:5], v[18:19], v[128:129], v[4:5] op_sel:[0,1,0] neg_lo:[1,0,0] neg_hi:[1,0,0]
    v_pk_fma_f32 v[20:21], v[2:3], v[128:129], v[20:21] op_sel:[0,1,0]
    v_fmac_f32_dpp v54, -v53, v131 row_ror:8 row_mask:0xf bank_mask:0xf
    v_fmac_f32 v54, v130, v53
    v_pk_fma_f32 v[6:7], v[4:5], v[128:129], v[6:7] op_sel_hi:[1,0,1]
    v_pk_fma_f32 v[22:23], v[20:21], v[128:129], v[22:23] op_sel_hi:[1,0,1]
    v_fmac_f32_dpp v55, -v54, v131 row_ror:8 row_mask:0xf bank_mask:0xf
    v_fmac_f32 v55, v130, v54
    v_pk_fma_f32 v[6:7], v[20:21], v[128:129], v[6:7] op_sel:[0,1,0] neg_lo:[1,0,0] neg_hi:[1,0,0]
    v_pk_fma_f32 v[22:23], v[4:5], v[128:129], v[22:23] op_sel:[0,1,0]
    v_cvt_pk_bf16_f32 v108, v4, v5
    v_cvt_pk_bf16_f32 v109, v6, v7
    v_cvt_pk_bf16_f32 v110, -v20, -v21
    v_cvt_pk_bf16_f32 v111, -v22, -v23

    ds_write_b128 v56, v[108:111] offset:1024
    ds_read_b64_tr_b16 v[92:93], v58 offset:1024
    ds_read_b64_tr_b16 v[94:95], v59 offset:1024
    v_pk_fma_f32 v[8:9], v[6:7], v[128:129], v[8:9] op_sel_hi:[1,0,1]
    v_pk_fma_f32 v[24:25], v[22:23], v[128:129], v[24:25] op_sel_hi:[1,0,1]
    v_pk_fma_f32 v[8:9], v[22:23], v[128:129], v[8:9] op_sel:[0,1,0] neg_lo:[1,0,0] neg_hi:[1,0,0]
    v_pk_fma_f32 v[24:25], v[6:7], v[128:129], v[24:25] op_sel:[0,1,0]
    v_cvt_pk_bf16_f32 v112, v48, v49
    v_cvt_pk_bf16_f32 v113, v50, v51
    v_cvt_pk_bf16_f32 v114, v52, v53
    v_cvt_pk_bf16_f32 v115, v54, v55
    ds_write2st64_b32 v60, v112, v113 offset0:0 offset1:1
    ds_write2st64_b32 v60, v114, v115 offset0:2 offset1:3
    ds_read_b64_tr_b16 v[116:117], v61 offset:0
    ds_read_b64_tr_b16 v[118:119], v61 offset:128
    v_pk_fma_f32 v[10:11], v[8:9], v[128:129], v[10:11] op_sel_hi:[1,0,1]
    v_pk_fma_f32 v[26:27], v[24:25], v[128:129], v[26:27] op_sel_hi:[1,0,1]
    v_pk_fma_f32 v[10:11], v[24:25], v[128:129], v[10:11] op_sel:[0,1,0] neg_lo:[1,0,0] neg_hi:[1,0,0]
    v_pk_fma_f32 v[26:27], v[8:9], v[128:129], v[26:27] op_sel:[0,1,0]
    v_cvt_pk_bf16_f32 v104, v8, v9
    v_cvt_pk_bf16_f32 v105, v10, v11
    v_cvt_pk_bf16_f32 v106, -v24, -v25
    v_cvt_pk_bf16_f32 v107, -v26, -v27

    ds_write_b128 v56, v[104:107] offset:0
    ds_read_b64_tr_b16 v[96:97], v58 offset:0
    ds_read_b64_tr_b16 v[98:99], v59 offset:0
    s_waitcnt lgkmcnt(10)
    v_and_b32 v88, -2, v88
    v_and_b32 v90, -2, v90
    buffer_store_dwordx4 v[88:91], v153, s[64:67], s36 offen
    v_pk_fma_f32 v[12:13], v[10:11], v[128:129], v[12:13] op_sel_hi:[1,0,1]
    v_pk_fma_f32 v[28:29], v[26:27], v[128:129], v[28:29] op_sel_hi:[1,0,1]
    v_pk_fma_f32 v[12:13], v[26:27], v[128:129], v[12:13] op_sel:[0,1,0] neg_lo:[1,0,0] neg_hi:[1,0,0]
    v_pk_fma_f32 v[28:29], v[10:11], v[128:129], v[28:29] op_sel:[0,1,0]
    v_pk_fma_f32 v[14:15], v[12:13], v[128:129], v[14:15] op_sel_hi:[1,0,1]
    v_pk_fma_f32 v[30:31], v[28:29], v[128:129], v[30:31] op_sel_hi:[1,0,1]
    v_pk_fma_f32 v[14:15], v[28:29], v[128:129], v[14:15] op_sel:[0,1,0] neg_lo:[1,0,0] neg_hi:[1,0,0]
    v_pk_fma_f32 v[30:31], v[12:13], v[128:129], v[30:31] op_sel:[0,1,0]
    v_cvt_pk_bf16_f32 v108, v12, v13
    v_cvt_pk_bf16_f32 v109, v14, v15
    v_cvt_pk_bf16_f32 v110, -v28, -v29
    v_cvt_pk_bf16_f32 v111, -v30, -v31

    ds_write_b128 v56, v[108:111] offset:1024
    ds_read_b64_tr_b16 v[100:101], v58 offset:1024
    ds_read_b64_tr_b16 v[102:103], v59 offset:1024
    s_waitcnt lgkmcnt(10)
    v_and_b32 v92, -2, v92
    v_and_b32 v94, -2, v94
    buffer_store_dwordx4 v[92:95], v153, s[64:67], s18 offen
    s_waitcnt lgkmcnt(6)
    v_and_b32 v116, -2, v116
    v_and_b32 v118, -2, v118
    buffer_store_dwordx2 v[116:117], v62, s[64:67], s37 offen offset:0
    buffer_store_dwordx2 v[118:119], v62, s[64:67], s37 offen offset:512
    s_waitcnt lgkmcnt(3)
    v_and_b32 v96, -2, v96
    v_and_b32 v98, -2, v98
    buffer_store_dwordx4 v[96:99], v153, s[64:67], s19 offen
    s_waitcnt lgkmcnt(0)
    v_and_b32 v100, -2, v100
    v_and_b32 v102, -2, v102
    buffer_store_dwordx4 v[100:103], v153, s[64:67], s20 offen
L_p2e1:
    s_lshl_b32 s8, s77, 2
    s_add_u32 s8, s8, 61440
    v_bfe_u32 v121, v152, 4, 2
    v_lshl_add_u32 v120, v121, 5, s8
    v_bfe_u32 v121, v152, 2, 1
    v_lshl_add_u32 v120, v121, 4, v120
    v_bfe_u32 v121, v152, 3, 1
    v_lshl_add_u32 v120, v121, 1, v120
    v_and_b32 v121, 3, v152
    v_lshl_add_u32 v120, v121, 9, v120
    s_barrier
    v_accvgpr_write_b32 a0, 0
    v_accvgpr_write_b32 a1, 0
    v_accvgpr_write_b32 a2, 0
    ds_read_u16_d16_hi a0, v120 offset:0
    v_accvgpr_write_b32 a3, 0
    ds_read_u16_d16_hi a1, v120 offset:128
    v_accvgpr_write_b32 a4, 0
    ds_read_u16_d16_hi a2, v120 offset:256
    v_accvgpr_write_b32 a5, 0
    ds_read_u16_d16_hi a3, v120 offset:384
    v_accvgpr_write_b32 a6, 0
    ds_read_u16_d16_hi a4, v120 offset:2048
    v_accvgpr_write_b32 a7, 0
    ds_read_u16_d16_hi a5, v120 offset:2176
    v_accvgpr_write_b32 a8, 0
    ds_read_u16_d16_hi a6, v120 offset:2304
    v_accvgpr_write_b32 a9, 0
    ds_read_u16_d16_hi a7, v120 offset:2432
    v_accvgpr_write_b32 a10, 0
    ds_read_u16_d16_hi a8, v120 offset:4096
    v_accvgpr_write_b32 a11, 0
    ds_read_u16_d16_hi a9, v120 offset:4224
    v_accvgpr_write_b32 a12, 0
    ds_read_u16_d16_hi a10, v120 offset:4352
    v_accvgpr_write_b32 a13, 0
    ds_read_u16_d16_hi a11, v120 offset:4480
    v_accvgpr_write_b32 a14, 0
    ds_read_u16_d16_hi a12, v120 offset:6144
    v_accvgpr_write_b32 a15, 0
    ds_read_u16_d16_hi a13, v120 offset:6272
    v_accvgpr_write_b32 a16, 0
    ds_read_u16_d16_hi a14, v120 offset:6400
    v_accvgpr_write_b32 a17, 0
    ds_read_u16_d16_hi a15, v120 offset:6528
    v_accvgpr_write_b32 a18, 0
    ds_read_u16_d16_hi a16, v120 offset:8192
    v_accvgpr_write_b32 a19, 0
    ds_read_u16_d16_hi a17, v120 offset:8320
    ds_read_u16_d16_hi a18, v120 offset:8448
    ds_read_u16_d16_hi a19, v120 offset:8576
L_hp:
    s_sub_u32 s101, s101, 1
    s_cbranch_scc1 L_end
    buffer_load_dwordx4 v[40:43], v175, s[64:67], s23 offen offset:0 sc1
    buffer_load_dwordx4 v[44:47], v175, s[64:67], s23 offen offset:1024 sc1
    buffer_load_dwordx4 v[48:51], v175, s[64:67], s23 offen offset:2048 sc1
    buffer_load_dwordx4 v[120:123], v175, s[64:67], s22 offen offset:0 sc1
    buffer_load_dwordx4 v[80:83], v175, s[64:67], s25 offen offset:0 sc1
    buffer_load_dwordx4 v[116:119], v175, s[64:67], s28 offen offset:0 sc1
    buffer_load_dwordx4 v[64:67], v175, s[64:67], s31 offen offset:0 sc1
    s_waitcnt vmcnt(4)
    v_bitop3_b32 v169, v40, v42, v44 bitop3:254
    v_bitop3_b32 v169, v169, v46, v48 bitop3:254
    v_bitop3_b32 v169, v169, v50, 1 bitop3:168
    v_cmp_ne_u32 vcc, 0, v169
    s_cbranch_vccnz Lh1c0r
Lh1c0:
    v_mfma_f32_16x16x32_bf16 v[132:135], a[232:235], v[40:43], v[132:135]
    buffer_load_dwordx4 v[60:63], v175, s[64:67], s22 offen offset:1024 sc1
    v_mfma_f32_16x16x32_bf16 v[136:139], v[176:179], v[40:43], v[136:139]
    v_mfma_f32_16x16x32_bf16 v[140:143], v[192:195], v[40:43], v[140:143]
    v_mfma_f32_16x16x32_bf16 v[144:147], v[208:211], v[40:43], v[144:147]
    v_mfma_f32_16x16x32_bf16 v[148:151], a[216:219], v[40:43], v[148:151]
    buffer_load_dwordx4 v[68:71], v175, s[64:67], s25 offen offset:1024 sc1
    v_mfma_f32_16x16x32_bf16 v[132:135], a[236:239], v[44:47], v[132:135]
    v_mfma_f32_16x16x32_bf16 v[136:139], v[180:183], v[44:47], v[136:139]
    v_mfma_f32_16x16x32_bf16 v[140:143], v[196:199], v[44:47], v[140:143]
    v_mfma_f32_16x16x32_bf16 v[144:147], v[212:215], v[44:47], v[144:147]
    ds_read_b128 v[124:127], v156 offset:8192
    buffer_load_dwordx4 v[72:75], v175, s[64:67], s28 offen offset:1024 sc1
    s_waitcnt vmcnt(3)
    v_bitop3_b32 v169, v120, v122, v80 bitop3:254
    v_bitop3_b32 v169, v169, v82, v116 bitop3:254
    v_mfma_f32_16x16x32_bf16 v[148:151], a[220:223], v[44:47], v[148:151]
    v_bitop3_b32 v169, v169, v118, v64 bitop3:254
    v_bitop3_b32 v169, v169, v66, 1 bitop3:168
    v_mfma_f32_16x16x32_bf16 v[132:135], a[240:243], v[48:51], v[132:135]
    v_cmp_ne_u32 vcc, 0, v169
    v_mfma_f32_16x16x32_bf16 v[136:139], v[184:187], v[48:51], v[136:139]
    v_mfma_f32_16x16x32_bf16 v[140:143], v[200:203], v[48:51], v[140:143]
    ds_read_b128 v[128:131], v156 offset:12288
    buffer_load_dwordx4 v[76:79], v175, s[64:67], s31 offen offset:1024 sc1
    v_mfma_f32_16x16x32_bf16 v[144:147], v[216:219], v[48:51], v[144:147]
    v_mfma_f32_16x16x32_bf16 v[148:151], a[224:227], v[48:51], v[148:151]
    s_cbranch_vccnz Lh1c1r
Lh1c1:
    v_mfma_f32_16x16x32_bf16 v[148:151], a[200:203], v[120:123], v[148:151]
    v_mfma_f32_16x16x32_bf16 v[40:43], a[200:203], v[80:83], 0
    ds_read_b128 v[112:115], v156 offset:0
    buffer_load_dwordx4 v[84:87], v175, s[64:67], s22 offen offset:2048 sc1
    v_mfma_f32_16x16x32_bf16 v[44:47], a[200:203], v[116:119], 0
    v_mfma_f32_16x16x32_bf16 v[48:51], a[200:203], v[64:67], 0
    s_waitcnt lgkmcnt(2)
    v_mfma_f32_16x16x32_bf16 v[140:143], v[124:127], v[120:123], v[140:143]
    v_mfma_f32_16x16x32_bf16 v[52:55], v[124:127], v[80:83], 0
    buffer_load_dwordx4 v[88:91], v175, s[64:67], s25 offen offset:2048 sc1
    v_mfma_f32_16x16x32_bf16 v[56:59], v[124:127], v[116:119], 0
    v_mfma_f32_16x16x32_bf16 v[0:3], v[124:127], v[64:67], 0
    ds_read_b128 v[124:127], v156 offset:4096
    s_waitcnt lgkmcnt(2)
    v_mfma_f32_16x16x32_bf16 v[144:147], v[128:131], v[120:123], v[144:147]
    v_mfma_f32_16x16x32_bf16 v[4:7], v[128:131], v[80:83], 0
    buffer_load_dwordx4 v[92:95], v175, s[64:67], s28 offen offset:2048 sc1
    v_mfma_f32_16x16x32_bf16 v[8:11], v[128:131], v[116:119], 0
    v_mfma_f32_16x16x32_bf16 v[12:15], v[128:131], v[64:67], 0
    ds_read_b128 v[128:131], v157 offset:8192
    s_waitcnt lgkmcnt(2)
    v_mfma_f32_16x16x32_bf16 v[132:135], v[112:115], v[120:123], v[132:135]
    v_mfma_f32_16x16x32_bf16 v[28:31], v[112:115], v[80:83], 0
    buffer_load_dwordx4 v[96:99], v175, s[64:67], s31 offen offset:2048 sc1
    s_waitcnt vmcnt(4)
    v_bitop3_b32 v169, v60, v62, v68 bitop3:254
    v_bitop3_b32 v169, v169, v70, v72 bitop3:254
    v_mfma_f32_16x16x32_bf16 v[32:35], v[112:115], v[116:119], 0
    v_bitop3_b32 v169, v169, v74, v76 bitop3:254
    v_bitop3_b32 v169, v169, v78, 1 bitop3:168
    v_mfma_f32_16x16x32_bf16 v[36:39], v[112:115], v[64:67], 0
    ds_read_b128 v[112:115], v157 offset:12288
    v_cmp_ne_u32 vcc, 0, v169
    s_waitcnt lgkmcnt(2)
    v_mfma_f32_16x16x32_bf16 v[136:139], v[124:127], v[120:123], v[136:139]
    v_mfma_f32_16x16x32_bf16 v[16:19], v[124:127], v[80:83], 0
    buffer_load_dwordx4 v[100:103], v175, s[64:67], s22 offen offset:3072 sc1
    v_mfma_f32_16x16x32_bf16 v[20:23], v[124:127], v[116:119], 0
    v_mfma_f32_16x16x32_bf16 v[24:27], v[124:127], v[64:67], 0
    ds_read_b128 v[124:127], v157 offset:0
    s_cbranch_vccnz Lh1c2r
Lh1c2:
    v_mfma_f32_16x16x32_bf16 v[148:151], a[204:207], v[60:63], v[148:151]
    v_mfma_f32_16x16x32_bf16 v[40:43], a[204:207], v[68:71], v[40:43]
    buffer_load_dwordx4 v[104:107], v175, s[64:67], s25 offen offset:3072 sc1
    v_mfma_f32_16x16x32_bf16 v[44:47], a[204:207], v[72:75], v[44:47]
    v_mfma_f32_16x16x32_bf16 v[48:51], a[204:207], v[76:79], v[48:51]
    s_waitcnt lgkmcnt(2)
    v_mfma_f32_16x16x32_bf16 v[140:143], v[128:131], v[60:63], v[140:143]
    v_mfma_f32_16x16x32_bf16 v[52:55], v[128:131], v[68:71], v[52:55]
    buffer_load_dwordx4 v[108:111], v175, s[64:67], s28 offen offset:3072 sc1
    v_mfma_f32_16x16x32_bf16 v[56:59], v[128:131], v[72:75], v[56:59]
    v_mfma_f32_16x16x32_bf16 v[0:3], v[128:131], v[76:79], v[0:3]
    ds_read_b128 v[128:131], v157 offset:4096
    s_waitcnt lgkmcnt(2)
    v_mfma_f32_16x16x32_bf16 v[144:147], v[112:115], v[60:63], v[144:147]
    v_mfma_f32_16x16x32_bf16 v[4:7], v[112:115], v[68:71], v[4:7]
    buffer_load_dwordx4 v[120:123], v175, s[64:67], s31 offen offset:3072 sc1
    v_mfma_f32_16x16x32_bf16 v[8:11], v[112:115], v[72:75], v[8:11]
    v_mfma_f32_16x16x32_bf16 v[12:15], v[112:115], v[76:79], v[12:15]
    ds_read_b128 v[112:115], v156 offset:8704
    s_waitcnt lgkmcnt(2)
    v_mfma_f32_16x16x32_bf16 v[132:135], v[124:127], v[60:63], v[132:135]
    v_mfma_f32_16x16x32_bf16 v[28:31], v[124:127], v[68:71], v[28:31]
    buffer_load_dwordx4 v[80:83], v175, s[64:67], s26 offen offset:0 sc1
    s_waitcnt vmcnt(5)
    v_bitop3_b32 v169, v84, v86, v88 bitop3:254
    v_bitop3_b32 v169, v169, v90, v92 bitop3:254
    v_mfma_f32_16x16x32_bf16 v[32:35], v[124:127], v[72:75], v[32:35]
    v_bitop3_b32 v169, v169, v94, v96 bitop3:254
    v_bitop3_b32 v169, v169, v98, 1 bitop3:168
    v_mfma_f32_16x16x32_bf16 v[36:39], v[124:127], v[76:79], v[36:39]
    ds_read_b128 v[124:127], v156 offset:12800
    v_cmp_ne_u32 vcc, 0, v169
    s_waitcnt lgkmcnt(2)
    v_mfma_f32_16x16x32_bf16 v[136:139], v[128:131], v[60:63], v[136:139]
    v_mfma_f32_16x16x32_bf16 v[16:19], v[128:131], v[68:71], v[16:19]
    buffer_load_dwordx4 v[116:119], v175, s[64:67], s26 offen offset:1024 sc1
    v_mfma_f32_16x16x32_bf16 v[20:23], v[128:131], v[72:75], v[20:23]
    v_mfma_f32_16x16x32_bf16 v[24:27], v[128:131], v[76:79], v[24:27]
    ds_read_b128 v[128:131], v156 offset:512
    s_cbranch_vccnz Lh1c3r
Lh1c3:
    v_mfma_f32_16x16x32_bf16 v[148:151], a[208:211], v[84:87], v[148:151]
    v_mfma_f32_16x16x32_bf16 v[40:43], a[208:211], v[88:91], v[40:43]
    buffer_load_dwordx4 v[64:67], v175, s[64:67], s26 offen offset:2048 sc1
    v_mfma_f32_16x16x32_bf16 v[44:47], a[208:211], v[92:95], v[44:47]
    v_mfma_f32_16x16x32_bf16 v[48:51], a[208:211], v[96:99], v[48:51]
    s_waitcnt lgkmcnt(2)
    v_mfma_f32_16x16x32_bf16 v[140:143], v[112:115], v[84:87], v[140:143]
    v_mfma_f32_16x16x32_bf16 v[52:55], v[112:115], v[88:91], v[52:55]
    buffer_load_dwordx4 v[60:63], v175, s[64:67], s26 offen offset:3072 sc1
    v_mfma_f32_16x16x32_bf16 v[56:59], v[112:115], v[92:95], v[56:59]
    v_mfma_f32_16x16x32_bf16 v[0:3], v[112:115], v[96:99], v[0:3]
    ds_read_b128 v[112:115], v156 offset:4608
    s_waitcnt lgkmcnt(2)
    v_mfma_f32_16x16x32_bf16 v[144:147], v[124:127], v[84:87], v[144:147]
    v_mfma_f32_16x16x32_bf16 v[4:7], v[124:127], v[88:91], v[4:7]
    buffer_load_dwordx4 v[68:71], v175, s[64:67], s27 offen offset:0 sc1
    v_mfma_f32_16x16x32_bf16 v[8:11], v[124:127], v[92:95], v[8:11]
    v_mfma_f32_16x16x32_bf16 v[12:15], v[124:127], v[96:99], v[12:15]
    ds_read_b128 v[124:127], v157 offset:8704
    s_waitcnt lgkmcnt(2)
    v_mfma_f32_16x16x32_bf16 v[132:135], v[128:131], v[84:87], v[132:135]
    v_mfma_f32_16x16x32_bf16 v[28:31], v[128:131], v[88:91], v[28:31]
    buffer_load_dwordx4 v[72:75], v175, s[64:67], s27 offen offset:1024 sc1
    s_waitcnt vmcnt(6)
    v_bitop3_b32 v169, v100, v102, v104 bitop3:254
    v_bitop3_b32 v169, v169, v106, v108 bitop3:254
    v_mfma_f32_16x16x32_bf16 v[32:35], v[128:131], v[92:95], v[32:35]
    v_bitop3_b32 v169, v169, v110, v120 bitop3:254
    v_bitop3_b32 v169, v169, v122, 1 bitop3:168
    v_mfma_f32_16x16x32_bf16 v[36:39], v[128:131], v[96:99], v[36:39]
    ds_read_b128 v[128:131], v157 offset:12800
    v_cmp_ne_u32 vcc, 0, v169
    s_waitcnt lgkmcnt(2)
    v_mfma_f32_16x16x32_bf16 v[136:139], v[112:115], v[84:87], v[136:139]
    v_mfma_f32_16x16x32_bf16 v[16:19], v[112:115], v[88:91], v[16:19]
    buffer_load_dwordx4 v[76:79], v175, s[64:67], s29 offen offset:0 sc1
    v_mfma_f32_16x16x32_bf16 v[20:23], v[112:115], v[92:95], v[20:23]
    v_mfma_f32_16x16x32_bf16 v[24:27], v[112:115], v[96:99], v[24:27]
    ds_read_b128 v[112:115], v157 offset:512
    s_cbranch_vccnz Lh1c4r
Lh1c4:
    v_mfma_f32_16x16x32_bf16 v[148:151], a[212:215], v[100:103], v[148:151]
    v_mfma_f32_16x16x32_bf16 v[40:43], a[212:215], v[104:107], v[40:43]
    buffer_load_dwordx4 v[84:87], v175, s[64:67], s29 offen offset:1024 sc1
    v_mfma_f32_16x16x32_bf16 v[44:47], a[212:215], v[108:111], v[44:47]
    v_mfma_f32_16x16x32_bf16 v[48:51], a[212:215], v[120:123], v[48:51]
    s_waitcnt lgkmcnt(2)
    v_mfma_f32_16x16x32_bf16 v[140:143], v[124:127], v[100:103], v[140:143]
    v_mfma_f32_16x16x32_bf16 v[52:55], v[124:127], v[104:107], v[52:55]
    buffer_load_dwordx4 v[88:91], v175, s[64:67], s29 offen offset:2048 sc1
    v_mfma_f32_16x16x32_bf16 v[56:59], v[124:127], v[108:111], v[56:59]
    v_mfma_f32_16x16x32_bf16 v[0:3], v[124:127], v[120:123], v[0:3]
    ds_read_b128 v[124:127], v157 offset:4608
    s_waitcnt lgkmcnt(2)
    v_mfma_f32_16x16x32_bf16 v[144:147], v[128:131], v[100:103], v[144:147]
    v_mfma_f32_16x16x32_bf16 v[4:7], v[128:131], v[104:107], v[4:7]
    buffer_load_dwordx4 v[92:95], v175, s[64:67], s29 offen offset:3072 sc1
    v_mfma_f32_16x16x32_bf16 v[8:11], v[128:131], v[108:111], v[8:11]
    v_mfma_f32_16x16x32_bf16 v[12:15], v[128:131], v[120:123], v[12:15]
    s_waitcnt lgkmcnt(1)
    v_mfma_f32_16x16x32_bf16 v[132:135], v[112:115], v[100:103], v[132:135]
    v_mfma_f32_16x16x32_bf16 v[28:31], v[112:115], v[104:107], v[28:31]
    buffer_load_dwordx4 v[96:99], v175, s[64:67], s30 offen offset:0 sc1
    s_waitcnt vmcnt(5)
    v_bitop3_b32 v169, v80, v82, v116 bitop3:254
    v_bitop3_b32 v169, v169, v118, v64 bitop3:254
    v_mfma_f32_16x16x32_bf16 v[32:35], v[112:115], v[108:111], v[32:35]
    v_bitop3_b32 v169, v169, v66, v60 bitop3:254
    v_bitop3_b32 v169, v169, v62, v68 bitop3:254
    v_mfma_f32_16x16x32_bf16 v[36:39], v[112:115], v[120:123], v[36:39]
    v_bitop3_b32 v169, v169, v70, v72 bitop3:254
    v_bitop3_b32 v169, v169, v74, 1 bitop3:168
    s_waitcnt lgkmcnt(0)
    v_mfma_f32_16x16x32_bf16 v[136:139], v[124:127], v[100:103], v[136:139]
    v_cmp_ne_u32 vcc, 0, v169
    v_mfma_f32_16x16x32_bf16 v[16:19], v[124:127], v[104:107], v[16:19]
    buffer_load_dwordx4 v[100:103], v175, s[64:67], s30 offen offset:1024 sc1
    v_mfma_f32_16x16x32_bf16 v[20:23], v[124:127], v[108:111], v[20:23]
    v_mfma_f32_16x16x32_bf16 v[24:27], v[124:127], v[120:123], v[24:27]
    s_cbranch_vccnz Lh1c5r
Lh1c5:
    v_mfma_f32_16x16x32_bf16 v[28:31], a[232:235], v[80:83], v[28:31]
    v_mfma_f32_16x16x32_bf16 v[28:31], a[236:239], v[116:119], v[28:31]
    buffer_load_dwordx4 v[104:107], v175, s[64:67], s32 offen offset:0 sc1
    v_mfma_f32_16x16x32_bf16 v[28:31], a[240:243], v[64:67], v[28:31]
    v_mfma_f32_16x16x32_bf16 v[28:31], a[244:247], v[60:63], v[28:31]
    v_mfma_f32_16x16x32_bf16 v[28:31], v[224:227], v[68:71], v[28:31]
    s_add_u32 s3, s77, 1
    s_and_b32 s3, s3, 3
    v_mfma_f32_16x16x32_bf16 v[28:31], v[228:231], v[72:75], v[28:31]
    s_mul_i32 s3, s3, 15360
    buffer_load_dwordx4 v[108:111], v175, s[64:67], s32 offen offset:1024 sc1
    v_add_u32 v165, s3, v153
    v_mfma_f32_16x16x32_bf16 v[16:19], v[176:179], v[80:83], v[16:19]
    s_mul_i32 s8, s77, 15360
    s_movk_i32 s9, 320
    v_mfma_f32_16x16x32_bf16 v[16:19], v[180:183], v[116:119], v[16:19]
    v_and_b32 v124, 15, v152
    v_lshrrev_b32 v112, 4, v152
    v_mfma_f32_16x16x32_bf16 v[16:19], v[184:187], v[64:67], v[16:19]
    v_bfe_u32 v113, v152, 1, 2
    v_mov_b32 v114, s8
    v_mfma_f32_16x16x32_bf16 v[16:19], v[188:191], v[60:63], v[16:19]
    ds_write_b128 v165, v[28:31] offset:0
    buffer_load_dwordx4 v[120:123], v175, s[64:67], s32 offen offset:2048 sc1
    v_mfma_f32_16x16x32_bf16 v[16:19], v[232:235], v[68:71], v[16:19]
    v_mad_u32_u24 v124, v124, s9, v114
    v_xor_b32 v126, v112, v113
    v_mfma_f32_16x16x32_bf16 v[16:19], v[236:239], v[72:75], v[16:19]
    v_lshl_add_u32 v126, v126, 4, v124
    v_lshrrev_b32 v115, 1, v112
    v_mfma_f32_16x16x32_bf16 v[52:55], v[192:195], v[80:83], v[52:55]
    v_lshl_add_u32 v124, v115, 6, v124
    v_and_b32 v115, 1, v112
    v_mfma_f32_16x16x32_bf16 v[52:55], v[196:199], v[116:119], v[52:55]
    v_lshlrev_b32 v115, 1, v115
    v_xor_b32 v115, v115, v113
    v_mfma_f32_16x16x32_bf16 v[52:55], v[200:203], v[64:67], v[52:55]
    v_lshl_add_u32 v124, v115, 4, v124
    v_xor_b32 v125, 16, v124
    v_mfma_f32_16x16x32_bf16 v[52:55], v[204:207], v[60:63], v[52:55]
    ds_write_b128 v165, v[16:19] offset:1024
    v_lshrrev_b32 v115, 2, v152
    v_mfma_f32_16x16x32_bf16 v[52:55], v[240:243], v[68:71], v[52:55]
    v_mad_u32_u24 v127, v115, s9, v114
    v_bfe_u32 v113, v152, 3, 2
    v_mfma_f32_16x16x32_bf16 v[52:55], v[244:247], v[72:75], v[52:55]
    v_and_b32 v114, 3, v152
    v_xor_b32 v113, v113, v114
    v_mfma_f32_16x16x32_bf16 v[4:7], v[208:211], v[80:83], v[4:7]
    v_lshl_add_u32 v127, v113, 4, v127
    v_mfma_f32_16x16x32_bf16 v[4:7], v[212:215], v[116:119], v[4:7]
    s_lshl_b32 s8, s77, 4
    s_add_u32 s8, s8, 93184
    v_mfma_f32_16x16x32_bf16 v[4:7], v[216:219], v[64:67], v[4:7]
    v_lshl_add_u32 v128, v112, 6, s8
    v_and_b32 v115, 3, v115
    v_mfma_f32_16x16x32_bf16 v[4:7], v[220:223], v[60:63], v[4:7]
    ds_write_b128 v165, v[52:55] offset:2048
    v_lshl_add_u32 v128, v115, 2, v128
    v_mfma_f32_16x16x32_bf16 v[4:7], v[248:251], v[68:71], v[4:7]
    v_lshl_add_u32 v112, v112, 2, v114
    v_lshlrev_b32 v163, 4, v112
    v_mfma_f32_16x16x32_bf16 v[4:7], v[252:255], v[72:75], v[4:7]
    s_waitcnt vmcnt(3)
    v_bitop3_b32 v169, v76, v78, v84 bitop3:254
    v_bitop3_b32 v169, v169, v86, v88 bitop3:254
    v_mfma_f32_16x16x32_bf16 v[40:43], a[216:219], v[80:83], v[40:43]
    buffer_load_dwordx4 v[80:83], v175, s[64:67], s32 offen offset:3072 sc1
    v_bitop3_b32 v169, v169, v90, v92 bitop3:254
    v_bitop3_b32 v169, v169, v94, v96 bitop3:254
    v_mfma_f32_16x16x32_bf16 v[40:43], a[220:223], v[116:119], v[40:43]
    v_bitop3_b32 v169, v169, v98, v100 bitop3:254
    v_bitop3_b32 v169, v169, v102, 1 bitop3:168
    v_mfma_f32_16x16x32_bf16 v[40:43], a[224:227], v[64:67], v[40:43]
    v_cmp_ne_u32 vcc, 0, v169
    v_lshl_add_u32 v163, v115, 9, v163
    v_mfma_f32_16x16x32_bf16 v[40:43], a[228:231], v[60:63], v[40:43]
    ds_write_b128 v165, v[4:7] offset:3072
    ds_read_b32 v128, v128
    v_mfma_f32_16x16x32_bf16 v[40:43], a[248:251], v[68:71], v[40:43]
    buffer_load_dwordx4 v[116:119], v175, s[64:67], s33 offen offset:0 sc1
    s_lshl_b32 s8, s77, 2
    v_mfma_f32_16x16x32_bf16 v[40:43], a[252:255], v[72:75], v[40:43]
    s_cbranch_vccnz Lh1c6r
Lh1c6:
    s_add_u32 s8, s8, 0
    v_mfma_f32_16x16x32_bf16 v[32:35], a[232:235], v[76:79], v[32:35]
    v_bfe_u32 v113, v152, 4, 2
    v_lshl_add_u32 v131, v113, 5, s8
    v_mfma_f32_16x16x32_bf16 v[32:35], a[236:239], v[84:87], v[32:35]
    v_bfe_u32 v113, v152, 2, 1
    v_lshl_add_u32 v131, v113, 4, v131
    v_mfma_f32_16x16x32_bf16 v[32:35], a[240:243], v[88:91], v[32:35]
    buffer_load_dwordx4 v[64:67], v175, s[64:67], s33 offen offset:1024 sc1
    v_bfe_u32 v113, v152, 3, 1
    v_mfma_f32_16x16x32_bf16 v[32:35], a[244:247], v[92:95], v[32:35]
    ds_write_b128 v165, v[40:43] offset:4096
    v_lshl_add_u32 v131, v113, 1, v131
    v_mfma_f32_16x16x32_bf16 v[32:35], v[224:227], v[96:99], v[32:35]
    s_add_u32 s3, s77, 2
    s_and_b32 s3, s3, 3
    v_mfma_f32_16x16x32_bf16 v[32:35], v[228:231], v[100:103], v[32:35]
    s_mul_i32 s3, s3, 15360
    v_add_u32 v165, s3, v153
    v_mfma_f32_16x16x32_bf16 v[20:23], v[176:179], v[76:79], v[20:23]
    buffer_load_dwordx4 v[60:63], v175, s[64:67], s23 offen offset:3072 sc1
    s_mul_i32 s8, s79, 163840
    v_mfma_f32_16x16x32_bf16 v[20:23], v[180:183], v[84:87], v[20:23]
    s_mul_i32 s9, s78, 320
    s_add_u32 s8, s8, s9
    v_mfma_f32_16x16x32_bf16 v[20:23], v[184:187], v[88:91], v[20:23]
    v_mul_u32_u24 v131, 1280, v131
    v_lshl_add_u32 v131, v114, 4, v131
    v_mfma_f32_16x16x32_bf16 v[20:23], v[188:191], v[92:95], v[20:23]
    ds_write_b128 v165, v[32:35] offset:5120
    v_add_u32 v131, s8, v131
    v_mfma_f32_16x16x32_bf16 v[20:23], v[232:235], v[96:99], v[20:23]
    buffer_load_dwordx4 v[68:71], v175, s[64:67], s24 offen offset:0 sc1
    v_mfma_f32_16x16x32_bf16 v[20:23], v[236:239], v[100:103], v[20:23]
    v_mfma_f32_16x16x32_bf16 v[56:59], v[192:195], v[76:79], v[56:59]
    v_mfma_f32_16x16x32_bf16 v[56:59], v[196:199], v[84:87], v[56:59]
    v_mfma_f32_16x16x32_bf16 v[56:59], v[200:203], v[88:91], v[56:59]
    buffer_load_dwordx4 v[72:75], v175, s[64:67], s24 offen offset:1024 sc1
    v_mfma_f32_16x16x32_bf16 v[56:59], v[204:207], v[92:95], v[56:59]
    s_nop 2
    ds_write_b128 v165, v[20:23] offset:6144
    v_mfma_f32_16x16x32_bf16 v[56:59], v[240:243], v[96:99], v[56:59]
    v_mfma_f32_16x16x32_bf16 v[56:59], v[244:247], v[100:103], v[56:59]
    v_mfma_f32_16x16x32_bf16 v[8:11], v[208:211], v[76:79], v[8:11]
    v_mfma_f32_16x16x32_bf16 v[8:11], v[212:215], v[84:87], v[8:11]
    v_mfma_f32_16x16x32_bf16 v[8:11], v[216:219], v[88:91], v[8:11]
    v_mfma_f32_16x16x32_bf16 v[8:11], v[220:223], v[92:95], v[8:11]
    s_nop 3
    ds_write_b128 v165, v[56:59] offset:7168
    v_mfma_f32_16x16x32_bf16 v[8:11], v[248:251], v[96:99], v[8:11]
    v_mfma_f32_16x16x32_bf16 v[8:11], v[252:255], v[100:103], v[8:11]
    s_waitcnt vmcnt(3)
    v_bitop3_b32 v169, v104, v106, v108 bitop3:254
    v_bitop3_b32 v169, v169, v110, v120 bitop3:254
    v_mfma_f32_16x16x32_bf16 v[44:47], a[216:219], v[76:79], v[44:47]
    v_bitop3_b32 v169, v169, v122, v80 bitop3:254
    v_bitop3_b32 v169, v169, v82, v116 bitop3:254
    v_mfma_f32_16x16x32_bf16 v[44:47], a[220:223], v[84:87], v[44:47]
    v_bitop3_b32 v169, v169, v118, v64 bitop3:254
    v_bitop3_b32 v169, v169, v66, 1 bitop3:168
    v_mfma_f32_16x16x32_bf16 v[44:47], a[224:227], v[88:91], v[44:47]
    v_cmp_ne_u32 vcc, 0, v169
    v_mfma_f32_16x16x32_bf16 v[44:47], a[228:231], v[92:95], v[44:47]
    ds_write_b128 v165, v[8:11] offset:8192
    v_mfma_f32_16x16x32_bf16 v[44:47], a[248:251], v[96:99], v[44:47]
    v_mfma_f32_16x16x32_bf16 v[44:47], a[252:255], v[100:103], v[44:47]
    s_cbranch_vccnz Lh1c7r
Lh1c7:
    v_mfma_f32_16x16x32_bf16 v[36:39], a[232:235], v[104:107], v[36:39]
    v_mfma_f32_16x16x32_bf16 v[36:39], a[236:239], v[108:111], v[36:39]
    v_mfma_f32_16x16x32_bf16 v[36:39], a[240:243], v[120:123], v[36:39]
    v_mfma_f32_16x16x32_bf16 v[36:39], a[244:247], v[80:83], v[36:39]
    s_nop 2
    ds_write_b128 v165, v[44:47] offset:9216
    v_mfma_f32_16x16x32_bf16 v[36:39], v[224:227], v[116:119], v[36:39]
    s_add_u32 s3, s77, 3
    s_and_b32 s3, s3, 3
    v_mfma_f32_16x16x32_bf16 v[36:39], v[228:231], v[64:67], v[36:39]
    s_mul_i32 s3, s3, 15360
    v_add_u32 v165, s3, v153
    v_mfma_f32_16x16x32_bf16 v[24:27], v[176:179], v[104:107], v[24:27]
    v_mfma_f32_16x16x32_bf16 v[24:27], v[180:183], v[108:111], v[24:27]
    v_mfma_f32_16x16x32_bf16 v[24:27], v[184:187], v[120:123], v[24:27]
    v_mfma_f32_16x16x32_bf16 v[24:27], v[188:191], v[80:83], v[24:27]
    s_nop 1
    ds_write_b128 v165, v[36:39] offset:10240
    v_mfma_f32_16x16x32_bf16 v[24:27], v[232:235], v[116:119], v[24:27]
    v_mfma_f32_16x16x32_bf16 v[24:27], v[236:239], v[64:67], v[24:27]
    s_waitcnt lgkmcnt(1)
    s_barrier
    v_mfma_f32_16x16x32_bf16 v[0:3], v[192:195], v[104:107], v[0:3]
    ds_read_b128 v[28:31], v154 offset:0
    v_mfma_f32_16x16x32_bf16 v[0:3], v[196:199], v[108:111], v[0:3]
    ds_read_b128 v[16:19], v154 offset:1024
    v_mfma_f32_16x16x32_bf16 v[0:3], v[200:203], v[120:123], v[0:3]
    ds_read_b128 v[52:55], v154 offset:2048
    v_mfma_f32_16x16x32_bf16 v[0:3], v[204:207], v[80:83], v[0:3]
    ds_read_b128 v[4:7], v154 offset:3072
    ds_write_b128 v165, v[24:27] offset:11264
    v_mfma_f32_16x16x32_bf16 v[0:3], v[240:243], v[116:119], v[0:3]
    ds_read_b128 v[40:43], v154 offset:4096
    v_mfma_f32_16x16x32_bf16 v[0:3], v[244:247], v[64:67], v[0:3]
    ds_read_b128 v[32:35], v154 offset:5120
    v_mfma_f32_16x16x32_bf16 v[12:15], v[208:211], v[104:107], v[12:15]
    ds_read_b128 v[20:23], v154 offset:6144
    s_waitcnt lgkmcnt(7)
    v_add_f32 v132, v132, v28
    v_add_f32 v133, v133, v29
    v_mfma_f32_16x16x32_bf16 v[12:15], v[212:215], v[108:111], v[12:15]
    ds_read_b128 v[56:59], v154 offset:7168
    v_add_f32 v134, v134, v30
    v_add_f32 v135, v135, v31
    v_mfma_f32_16x16x32_bf16 v[12:15], v[216:219], v[120:123], v[12:15]
    ds_read_b128 v[8:11], v154 offset:8192
    s_waitcnt lgkmcnt(8)
    v_add_f32 v136, v136, v16
    v_add_f32 v137, v137, v17
    v_mfma_f32_16x16x32_bf16 v[12:15], v[220:223], v[80:83], v[12:15]
    ds_read_b128 v[44:47], v154 offset:9216
    ds_write_b128 v165, v[0:3] offset:12288
    v_add_f32 v138, v138, v18
    v_add_f32 v139, v139, v19
    v_mfma_f32_16x16x32_bf16 v[12:15], v[248:251], v[116:119], v[12:15]
    s_waitcnt lgkmcnt(9)
    v_add_f32 v140, v140, v52
    v_add_f32 v141, v141, v53
    v_mfma_f32_16x16x32_bf16 v[12:15], v[252:255], v[64:67], v[12:15]
    s_waitcnt vmcnt(0)
    v_add_f32 v142, v142, v54
    v_add_f32 v143, v143, v55
    v_bitop3_b32 v169, v60, v62, v68 bitop3:254
    v_mfma_f32_16x16x32_bf16 v[48:51], a[216:219], v[104:107], v[48:51]
    s_waitcnt lgkmcnt(8)
    v_add_f32 v144, v144, v4
    v_add_f32 v145, v145, v5
    v_bitop3_b32 v169, v169, v70, v72 bitop3:254
    v_mfma_f32_16x16x32_bf16 v[48:51], a[220:223], v[108:111], v[48:51]
    v_add_f32 v146, v146, v6
    v_add_f32 v147, v147, v7
    v_bitop3_b32 v169, v169, v74, 1 bitop3:168
    v_mfma_f32_16x16x32_bf16 v[48:51], a[224:227], v[120:123], v[48:51]
    s_waitcnt lgkmcnt(6)
    v_add_f32 v148, v148, v40
    v_add_f32 v149, v149, v41
    v_cmp_ne_u32 vcc, 0, v169
    v_mfma_f32_16x16x32_bf16 v[48:51], a[228:231], v[80:83], v[48:51]
    ds_write_b128 v165, v[12:15] offset:13312
    v_add_f32 v150, v150, v42
    v_add_f32 v151, v151, v43
    v_mfma_f32_16x16x32_bf16 v[48:51], a[248:251], v[116:119], v[48:51]
    v_mfma_f32_16x16x32_bf16 v[48:51], a[252:255], v[64:67], v[48:51]
    s_cbranch_vccnz Lh1c8r
Lh1c8:
    s_waitcnt lgkmcnt(6)
    v_mfma_f32_16x16x32_bf16 v[32:35], a[244:247], v[60:63], v[32:35]
    v_mfma_f32_16x16x32_bf16 v[32:35], v[224:227], v[68:71], v[32:35]
    v_mfma_f32_16x16x32_bf16 v[32:35], v[228:231], v[72:75], v[32:35]
    s_waitcnt lgkmcnt(5)
    v_mfma_f32_16x16x32_bf16 v[20:23], v[188:191], v[60:63], v[20:23]
    s_nop 0
    ds_write_b128 v165, v[48:51] offset:14336
    v_mfma_f32_16x16x32_bf16 v[20:23], v[232:235], v[68:71], v[20:23]
    v_mfma_f32_16x16x32_bf16 v[20:23], v[236:239], v[72:75], v[20:23]
    s_waitcnt lgkmcnt(5)
    v_mfma_f32_16x16x32_bf16 v[56:59], v[204:207], v[60:63], v[56:59]
    v_mfma_f32_16x16x32_bf16 v[56:59], v[240:243], v[68:71], v[56:59]
    v_mfma_f32_16x16x32_bf16 v[56:59], v[244:247], v[72:75], v[56:59]
    s_waitcnt lgkmcnt(0)
    s_barrier
    v_mfma_f32_16x16x32_bf16 v[8:11], v[220:223], v[60:63], v[8:11]
    ds_read_b128 v[28:31], v154 offset:10240
    v_mfma_f32_16x16x32_bf16 v[8:11], v[248:251], v[68:71], v[8:11]
    ds_read_b128 v[16:19], v154 offset:11264
    v_mfma_f32_16x16x32_bf16 v[8:11], v[252:255], v[72:75], v[8:11]
    ds_read_b128 v[52:55], v154 offset:12288
    v_mfma_f32_16x16x32_bf16 v[44:47], a[228:231], v[60:63], v[44:47]
    ds_read_b128 v[4:7], v154 offset:13312
    v_mfma_f32_16x16x32_bf16 v[44:47], a[248:251], v[68:71], v[44:47]
    ds_read_b128 v[40:43], v154 offset:14336
    v_mfma_f32_16x16x32_bf16 v[44:47], a[252:255], v[72:75], v[44:47]
    v_pk_add_f32 v[132:133], v[132:133], v[32:33]
    v_pk_add_f32 v[134:135], v[134:135], v[34:35]
    v_pk_add_f32 v[136:137], v[136:137], v[20:21]
    v_pk_add_f32 v[138:139], v[138:139], v[22:23]
    v_pk_add_f32 v[140:141], v[140:141], v[56:57]
    v_pk_add_f32 v[142:143], v[142:143], v[58:59]
    v_pk_add_f32 v[144:145], v[144:145], v[8:9]
    v_pk_add_f32 v[146:147], v[146:147], v[10:11]
    v_pk_add_f32 v[148:149], v[148:149], v[44:45]
    v_pk_add_f32 v[150:151], v[150:151], v[46:47]
    s_waitcnt lgkmcnt(4)
    v_pk_add_f32 v[132:133], v[132:133], v[28:29]
    v_pk_add_f32 v[134:135], v[134:135], v[30:31]
    s_waitcnt lgkmcnt(3)
    v_pk_add_f32 v[136:137], v[136:137], v[16:17]
    v_pk_add_f32 v[138:139], v[138:139], v[18:19]
    s_waitcnt lgkmcnt(2)
    v_pk_add_f32 v[140:141], v[140:141], v[52:53]
    v_pk_add_f32 v[142:143], v[142:143], v[54:55]
    s_waitcnt lgkmcnt(1)
    v_pk_add_f32 v[144:145], v[144:145], v[4:5]
    v_pk_add_f32 v[146:147], v[146:147], v[6:7]
    s_waitcnt lgkmcnt(0)
    v_pk_add_f32 v[148:149], v[148:149], v[40:41]
    v_pk_add_f32 v[150:151], v[150:151], v[42:43]
    v_pk_add_f32 v[4:5], v[132:133], v[134:135]
    v_pk_mul_f32 v[6:7], v[132:133], v[132:133]
    v_pk_fma_f32 v[6:7], v[134:135], v[134:135], v[6:7]
    v_pk_fma_f32 v[6:7], v[136:137], v[136:137], v[6:7]
    v_pk_add_f32 v[4:5], v[4:5], v[136:137]
    v_pk_fma_f32 v[6:7], v[138:139], v[138:139], v[6:7]
    v_pk_add_f32 v[4:5], v[4:5], v[138:139]
    v_pk_fma_f32 v[6:7], v[140:141], v[140:141], v[6:7]
    v_pk_add_f32 v[4:5], v[4:5], v[140:141]
    v_pk_fma_f32 v[6:7], v[142:143], v[142:143], v[6:7]
    v_pk_add_f32 v[4:5], v[4:5], v[142:143]
    v_pk_fma_f32 v[6:7], v[144:145], v[144:145], v[6:7]
    v_pk_add_f32 v[4:5], v[4:5], v[144:145]
    v_pk_fma_f32 v[6:7], v[146:147], v[146:147], v[6:7]
    v_pk_add_f32 v[4:5], v[4:5], v[146:147]
    v_pk_fma_f32 v[6:7], v[148:149], v[148:149], v[6:7]
    v_pk_add_f32 v[4:5], v[4:5], v[148:149]
    v_pk_fma_f32 v[6:7], v[150:151], v[150:151], v[6:7]
    v_pk_add_f32 v[4:5], v[4:5], v[150:151]
    v_add_f32 v6, v6, v7
    v_add_f32 v4, v4, v5
    v_mov_b32 v1, s82
    s_nop 0
    v_permlane32_swap_b32 v4, v6
    v_add_f32 v4, v4, v6
    v_mov_b32 v6, v4
    s_nop 1
    v_permlane16_swap_b32 v4, v6
    v_add_f32 v0, v4, v6

    s_cmp_eq_u32 s88, 0
    s_cbranch_scc1 Lss_15
    global_store_dwordx2 v155, v[0:1], s[98:99]
Lsd_16:
    ds_write_b128 v124, v[132:135] offset:0
    v_accvgpr_read_b32 v84, a0
    v_accvgpr_read_b32 v85, a1
    ds_write_b128 v125, v[136:139] offset:0
    v_accvgpr_read_b32 v88, a4
    v_accvgpr_read_b32 v89, a5
    ds_write_b128 v124, v[140:143] offset:128
    v_accvgpr_read_b32 v92, a8
    v_accvgpr_read_b32 v93, a9
    ds_write_b128 v125, v[144:147] offset:128
    v_accvgpr_read_b32 v96, a12
    v_accvgpr_read_b32 v97, a13
    ds_write_b128 v126, v[148:151] offset:256
    v_accvgpr_read_b32 v100, a16
    v_accvgpr_read_b32 v101, a17
    ds_read_b128 v[20:23], v127 offset:0
    ds_read_b128 v[24:27], v127 offset:64
    ds_read_b128 v[28:31], v127 offset:128
    ds_read_b128 v[32:35], v127 offset:192
    ds_read_b128 v[36:39], v127 offset:256
    v_accvgpr_read_b32 v86, a2
    v_accvgpr_read_b32 v87, a3
    v_accvgpr_read_b32 v90, a6
    v_accvgpr_read_b32 v91, a7
    v_accvgpr_read_b32 v94, a10
    v_accvgpr_read_b32 v95, a11
    v_accvgpr_read_b32 v98, a14
    v_accvgpr_read_b32 v99, a15
    v_accvgpr_read_b32 v102, a18
    v_accvgpr_read_b32 v103, a19
    global_load_dwordx4 v[0:3], v163, s[98:99] sc1
    global_load_dwordx4 v[4:7], v163, s[98:99] offset:256 sc1
    s_waitcnt lgkmcnt(4)
    v_pk_add_f32 v[60:61], v[20:21], v[128:129] op_sel_hi:[1,0]
    v_pk_add_f32 v[62:63], v[22:23], v[128:129] op_sel_hi:[1,0]
    s_waitcnt lgkmcnt(3)
    v_pk_add_f32 v[64:65], v[24:25], v[128:129] op_sel_hi:[1,0]
    v_pk_add_f32 v[66:67], v[26:27], v[128:129] op_sel_hi:[1,0]
    s_waitcnt lgkmcnt(2)
    v_pk_add_f32 v[68:69], v[28:29], v[128:129] op_sel_hi:[1,0]
    v_pk_add_f32 v[70:71], v[30:31], v[128:129] op_sel_hi:[1,0]
    s_waitcnt lgkmcnt(1)
    v_pk_add_f32 v[72:73], v[32:33], v[128:129] op_sel_hi:[1,0]
    v_pk_add_f32 v[74:75], v[34:35], v[128:129] op_sel_hi:[1,0]
    s_waitcnt lgkmcnt(0)
    v_pk_add_f32 v[76:77], v[36:37], v[128:129] op_sel_hi:[1,0]
    v_pk_add_f32 v[78:79], v[38:39], v[128:129] op_sel_hi:[1,0]
    s_waitcnt vmcnt(0)
    L_s3:
    v_min3_u32 v168, v1, v3, v5
    v_max3_u32 v1, v1, v3, v5
    v_min3_u32 v168, v168, v7, s82
    v_max3_u32 v1, v1, v7, s82
    v_cmp_ne_u32 vcc, v168, v1

    s_cbranch_vccz L_s3r
    s_sub_u32 s101, s101, 1
    s_cbranch_scc1 L_end
    global_load_dwordx4 v[0:3], v163, s[98:99] sc1
    global_load_dwordx4 v[4:7], v163, s[98:99] offset:256 sc1
    s_waitcnt vmcnt(0)
    s_branch L_s3
L_s3r:
    v_add_f32 v0, v0, v4
    v_add_f32 v2, v2, v6
    s_nop 0
    v_add_f32_dpp v0, v0, v0 row_ror:4 row_mask:0xf bank_mask:0xf
    v_add_f32_dpp v2, v2, v2 row_ror:4 row_mask:0xf bank_mask:0xf
    s_nop 0
    v_add_f32_dpp v0, v0, v0 row_ror:8 row_mask:0xf bank_mask:0xf
    v_add_f32_dpp v2, v2, v2 row_ror:8 row_mask:0xf bank_mask:0xf
    s_nop 0
    v_mov_b32_dpp v4, v0 quad_perm:[0,0,0,0] row_mask:0xf bank_mask:1
    v_mov_b32_dpp v6, v2 quad_perm:[0,0,0,0] row_mask:0xf bank_mask:1
    s_nop 0
    v_mov_b32_dpp v4, v0 quad_perm:[1,1,1,1] row_mask:0xf bank_mask:2
    v_mov_b32_dpp v6, v2 quad_perm:[1,1,1,1] row_mask:0xf bank_mask:2
    s_nop 0
    v_mov_b32_dpp v4, v0 quad_perm:[2,2,2,2] row_mask:0xf bank_mask:4
    v_mov_b32_dpp v6, v2 quad_perm:[2,2,2,2] row_mask:0xf bank_mask:4
    s_nop 0
    v_mov_b32_dpp v4, v0 quad_perm:[3,3,3,3] row_mask:0xf bank_mask:8
    v_mov_b32_dpp v6, v2 quad_perm:[3,3,3,3] row_mask:0xf bank_mask:8
    v_mul_f32 v4, 0x3acccccd, v4
    v_mov_b32 v166, 0x3727c5ac
    v_fmac_f32 v166, 0x3acccccd, v6
    v_fma_f32 v166, -v4, v4, v166
    v_max_f32 v166, 0x3727c5ac, v166
    v_rsq_f32 v166, v166
    s_nop 0
    v_mul_f32_e64 v167, -v4, v166
    v_pk_fma_f32 v[20:21], v[20:21], v[166:167], v[166:167] op_sel:[0,0,1] op_sel_hi:[1,0,1]
    v_pk_fma_f32 v[22:23], v[22:23], v[166:167], v[166:167] op_sel:[0,0,1] op_sel_hi:[1,0,1]
    v_pk_fma_f32 v[60:61], v[20:21], v[84:85], v[60:61]
    v_pk_fma_f32 v[62:63], v[22:23], v[86:87], v[62:63]
    global_store_dwordx4 v131, v[60:63], s[46:47] offset:0
    v_pk_fma_f32 v[24:25], v[24:25], v[166:167], v[166:167] op_sel:[0,0,1] op_sel_hi:[1,0,1]
    v_pk_fma_f32 v[26:27], v[26:27], v[166:167], v[166:167] op_sel:[0,0,1] op_sel_hi:[1,0,1]
    v_pk_fma_f32 v[64:65], v[24:25], v[88:89], v[64:65]
    v_pk_fma_f32 v[66:67], v[26:27], v[90:91], v[66:67]
    global_store_dwordx4 v131, v[64:67], s[46:47] offset:64
    v_pk_fma_f32 v[28:29], v[28:29], v[166:167], v[166:167] op_sel:[0,0,1] op_sel_hi:[1,0,1]
    v_pk_fma_f32 v[30:31], v[30:31], v[166:167], v[166:167] op_sel:[0,0,1] op_sel_hi:[1,0,1]
    v_pk_fma_f32 v[68:69], v[28:29], v[92:93], v[68:69]
    v_pk_fma_f32 v[70:71], v[30:31], v[94:95], v[70:71]
    global_store_dwordx4 v131, v[68:71], s[46:47] offset:128
    v_pk_fma_f32 v[32:33], v[32:33], v[166:167], v[166:167] op_sel:[0,0,1] op_sel_hi:[1,0,1]
    v_pk_fma_f32 v[34:35], v[34:35], v[166:167], v[166:167] op_sel:[0,0,1] op_sel_hi:[1,0,1]
    v_pk_fma_f32 v[72:73], v[32:33], v[96:97], v[72:73]
    v_pk_fma_f32 v[74:75], v[34:35], v[98:99], v[74:75]
    global_store_dwordx4 v131, v[72:75], s[46:47] offset:192
    v_pk_fma_f32 v[36:37], v[36:37], v[166:167], v[166:167] op_sel:[0,0,1] op_sel_hi:[1,0,1]
    v_pk_fma_f32 v[38:39], v[38:39], v[166:167], v[166:167] op_sel:[0,0,1] op_sel_hi:[1,0,1]
    v_pk_fma_f32 v[76:77], v[36:37], v[100:101], v[76:77]
    v_pk_fma_f32 v[78:79], v[38:39], v[102:103], v[78:79]
    global_store_dwordx4 v131, v[76:79], s[46:47] offset:256
L_end:
    s_endpgm
L_nonce_re:
    s_sub_u32 s101, s101, 1
    s_cbranch_scc1 L_end
    global_load_dword v224, v224, s[48:49] sc1
    s_waitcnt vmcnt(0)
    s_branch L_nonce
L_kf_re:
    s_sub_u32 s101, s101, 1
    s_cbranch_scc1 L_end
    global_load_dword v224, v169, s[50:51] sc1
    global_load_dwordx2 v[170:171], v168, s[50:51] sc1
    s_waitcnt vmcnt(0)
    s_branch L_kf
L_cre0:
    s_sub_u32 s101, s101, 1
    s_cbranch_scc1 L_end
    buffer_load_dwordx4 v[244:247], v253, s[92:95], 0 offen offset:2048 sc1
    buffer_load_dwordx4 v[240:243], v253, s[92:95], 0 offen offset:1792 sc1
    buffer_load_dwordx4 v[236:239], v253, s[92:95], 0 offen offset:1536 sc1
    buffer_load_dwordx4 v[232:235], v253, s[92:95], 0 offen offset:1280 sc1
    buffer_load_dwordx4 v[228:231], v253, s[92:95], 0 offen offset:1024 sc1
    buffer_load_dwordx4 v[224:227], v253, s[92:95], 0 offen offset:768 sc1
    buffer_load_dwordx4 v[220:223], v253, s[92:95], 0 offen offset:512 sc1
    buffer_load_dwordx4 v[216:219], v253, s[92:95], 0 offen offset:256 sc1
    s_waitcnt vmcnt(0)
    s_branch L_cchk0
L_p2s0:
    v_fmac_f32_dpp v208, -v252, v21 row_ror:8 row_mask:0xf bank_mask:0xf
    v_fmac_f32 v208, v20, v252
    v_pk_fma_f32 v[176:177], v[248:249], v[18:19], v[176:177] op_sel_hi:[1,0,1]
    v_pk_fma_f32 v[192:193], v[250:251], v[18:19], v[192:193] op_sel_hi:[1,0,1]
    v_fmac_f32_dpp v209, -v208, v21 row_ror:8 row_mask:0xf bank_mask:0xf
    v_fmac_f32 v209, v20, v208
    v_pk_fma_f32 v[176:177], v[250:251], v[18:19], v[176:177] op_sel:[0,1,0] neg_lo:[1,0,0] neg_hi:[1,0,0]
    v_pk_fma_f32 v[192:193], v[248:249], v[18:19], v[192:193] op_sel:[0,1,0]
    v_fmac_f32_dpp v210, -v209, v21 row_ror:8 row_mask:0xf bank_mask:0xf
    v_fmac_f32 v210, v20, v209
    v_pk_fma_f32 v[178:179], v[176:177], v[18:19], v[178:179] op_sel_hi:[1,0,1]
    v_pk_fma_f32 v[194:195], v[192:193], v[18:19], v[194:195] op_sel_hi:[1,0,1]
    v_fmac_f32_dpp v211, -v210, v21 row_ror:8 row_mask:0xf bank_mask:0xf
    v_fmac_f32 v211, v20, v210
    v_pk_fma_f32 v[178:179], v[192:193], v[18:19], v[178:179] op_sel:[0,1,0] neg_lo:[1,0,0] neg_hi:[1,0,0]
    v_pk_fma_f32 v[194:195], v[176:177], v[18:19], v[194:195] op_sel:[0,1,0]
    v_cvt_pk_bf16_f32 v232, v176, v177
    v_cvt_pk_bf16_f32 v233, v178, v179
    v_cvt_pk_bf16_f32 v234, -v192, -v193
    v_cvt_pk_bf16_f32 v235, -v194, -v195

    ds_write_b128 v22, v[232:235] offset:0
    ds_read_b64_tr_b16 v[216:217], v24 offset:0
    ds_read_b64_tr_b16 v[218:219], v25 offset:0
    v_fmac_f32_dpp v212, -v211, v21 row_ror:8 row_mask:0xf bank_mask:0xf
    v_fmac_f32 v212, v20, v211
    v_pk_fma_f32 v[180:181], v[178:179], v[18:19], v[180:181] op_sel_hi:[1,0,1]
    v_pk_fma_f32 v[196:197], v[194:195], v[18:19], v[196:197] op_sel_hi:[1,0,1]
    v_fmac_f32_dpp v213, -v212, v21 row_ror:8 row_mask:0xf bank_mask:0xf
    v_fmac_f32 v213, v20, v212
    v_pk_fma_f32 v[180:181], v[194:195], v[18:19], v[180:181] op_sel:[0,1,0] neg_lo:[1,0,0] neg_hi:[1,0,0]
    v_pk_fma_f32 v[196:197], v[178:179], v[18:19], v[196:197] op_sel:[0,1,0]
    v_fmac_f32_dpp v214, -v213, v21 row_ror:8 row_mask:0xf bank_mask:0xf
    v_fmac_f32 v214, v20, v213
    v_pk_fma_f32 v[182:183], v[180:181], v[18:19], v[182:183] op_sel_hi:[1,0,1]
    v_pk_fma_f32 v[198:199], v[196:197], v[18:19], v[198:199] op_sel_hi:[1,0,1]
    v_fmac_f32_dpp v215, -v214, v21 row_ror:8 row_mask:0xf bank_mask:0xf
    v_fmac_f32 v215, v20, v214
    v_pk_fma_f32 v[182:183], v[196:197], v[18:19], v[182:183] op_sel:[0,1,0] neg_lo:[1,0,0] neg_hi:[1,0,0]
    v_pk_fma_f32 v[198:199], v[180:181], v[18:19], v[198:199] op_sel:[0,1,0]
    v_cvt_pk_bf16_f32 v236, v180, v181
    v_cvt_pk_bf16_f32 v237, v182, v183
    v_cvt_pk_bf16_f32 v238, -v196, -v197
    v_cvt_pk_bf16_f32 v239, -v198, -v199

    ds_write_b128 v22, v[236:239] offset:1024
    ds_read_b64_tr_b16 v[220:221], v24 offset:1024
    ds_read_b64_tr_b16 v[222:223], v25 offset:1024
    v_pk_fma_f32 v[184:185], v[182:183], v[18:19], v[184:185] op_sel_hi:[1,0,1]
    v_pk_fma_f32 v[200:201], v[198:199], v[18:19], v[200:201] op_sel_hi:[1,0,1]
    v_pk_fma_f32 v[184:185], v[198:199], v[18:19], v[184:185] op_sel:[0,1,0] neg_lo:[1,0,0] neg_hi:[1,0,0]
    v_pk_fma_f32 v[200:201], v[182:183], v[18:19], v[200:201] op_sel:[0,1,0]
    v_cvt_pk_bf16_f32 v240, v208, v209
    v_cvt_pk_bf16_f32 v241, v210, v211
    v_cvt_pk_bf16_f32 v242, v212, v213
    v_cvt_pk_bf16_f32 v243, v214, v215
    ds_write2st64_b32 v26, v240, v241 offset0:0 offset1:1
    ds_write2st64_b32 v26, v242, v243 offset0:2 offset1:3
    ds_read_b64_tr_b16 v[244:245], v27 offset:0
    ds_read_b64_tr_b16 v[246:247], v27 offset:128
    v_pk_fma_f32 v[186:187], v[184:185], v[18:19], v[186:187] op_sel_hi:[1,0,1]
    v_pk_fma_f32 v[202:203], v[200:201], v[18:19], v[202:203] op_sel_hi:[1,0,1]
    v_pk_fma_f32 v[186:187], v[200:201], v[18:19], v[186:187] op_sel:[0,1,0] neg_lo:[1,0,0] neg_hi:[1,0,0]
    v_pk_fma_f32 v[202:203], v[184:185], v[18:19], v[202:203] op_sel:[0,1,0]
    v_cvt_pk_bf16_f32 v232, v184, v185
    v_cvt_pk_bf16_f32 v233, v186, v187
    v_cvt_pk_bf16_f32 v234, -v200, -v201
    v_cvt_pk_bf16_f32 v235, -v202, -v203

    ds_write_b128 v22, v[232:235] offset:0
    ds_read_b64_tr_b16 v[224:225], v24 offset:0
    ds_read_b64_tr_b16 v[226:227], v25 offset:0
    s_waitcnt lgkmcnt(10)
    v_and_b32 v216, -2, v216
    v_and_b32 v218, -2, v218
    buffer_store_dwordx4 v[216:219], v153, s[64:67], s36 offen sc1
    v_pk_fma_f32 v[188:189], v[186:187], v[18:19], v[188:189] op_sel_hi:[1,0,1]
    v_pk_fma_f32 v[204:205], v[202:203], v[18:19], v[204:205] op_sel_hi:[1,0,1]
    v_pk_fma_f32 v[188:189], v[202:203], v[18:19], v[188:189] op_sel:[0,1,0] neg_lo:[1,0,0] neg_hi:[1,0,0]
    v_pk_fma_f32 v[204:205], v[186:187], v[18:19], v[204:205] op_sel:[0,1,0]
    v_pk_fma_f32 v[190:191], v[188:189], v[18:19], v[190:191] op_sel_hi:[1,0,1]
    v_pk_fma_f32 v[206:207], v[204:205], v[18:19], v[206:207] op_sel_hi:[1,0,1]
    v_pk_fma_f32 v[190:191], v[204:205], v[18:19], v[190:191] op_sel:[0,1,0] neg_lo:[1,0,0] neg_hi:[1,0,0]
    v_pk_fma_f32 v[206:207], v[188:189], v[18:19], v[206:207] op_sel:[0,1,0]
    v_cvt_pk_bf16_f32 v236, v188, v189
    v_cvt_pk_bf16_f32 v237, v190, v191
    v_cvt_pk_bf16_f32 v238, -v204, -v205
    v_cvt_pk_bf16_f32 v239, -v206, -v207

    ds_write_b128 v22, v[236:239] offset:1024
    ds_read_b64_tr_b16 v[228:229], v24 offset:1024
    ds_read_b64_tr_b16 v[230:231], v25 offset:1024
    s_waitcnt lgkmcnt(10)
    v_and_b32 v220, -2, v220
    v_and_b32 v222, -2, v222
    buffer_store_dwordx4 v[220:223], v153, s[64:67], s18 offen sc1
    s_waitcnt lgkmcnt(6)
    v_and_or_b32 v244, v244, -2, v23
    v_and_or_b32 v246, v246, -2, v23
    buffer_store_dwordx2 v[244:245], v28, s[64:67], s37 offen offset:0 sc1
    buffer_store_dwordx2 v[246:247], v28, s[64:67], s37 offen offset:512 sc1
    s_waitcnt lgkmcnt(3)
    v_or_b32 v224, 1, v224
    v_or_b32 v226, 1, v226
    buffer_store_dwordx4 v[224:227], v153, s[64:67], s19 offen sc1
    s_waitcnt lgkmcnt(0)
    v_or_b32 v228, 1, v228
    v_or_b32 v230, 1, v230
    buffer_store_dwordx4 v[228:231], v153, s[64:67], s20 offen sc1
    s_branch L_p2e0
Lss_3:
    global_store_dword v169, v173, s[50:51] sc1
    s_branch Lsd_4
L_fh_re0:
    s_sub_u32 s101, s101, 1
    s_cbranch_scc1 L_end
    global_load_dword v169, v173, s[50:51] sc1
    s_waitcnt vmcnt(0)
    s_branch L_fh0
L_fh_re1:
    s_sub_u32 s101, s101, 1
    s_cbranch_scc1 L_end
    global_load_dword v169, v173, s[50:51] sc1
    s_waitcnt vmcnt(0)
    s_branch L_fh1
Lss_7:
    global_store_dwordx2 v155, v[0:1], s[98:99] sc1
    s_branch Lsd_8
L_gcr:
    s_sub_u32 s101, s101, 1
    s_cbranch_scc1 L_end
    s_add_u32 m0, s100, 61440
    s_nop 0
    buffer_load_dwordx4 v164, s[68:71], s6 offen sc1 lds
    s_add_u32 m0, s100, 62464
    s_add_u32 s83, s6, 32768
    buffer_load_dwordx4 v164, s[68:71], s83 offen sc1 lds
    s_add_u32 m0, s5, 69632
    s_mov_b32 exec_hi, 0
    buffer_load_dwordx4 v164, s[68:71], s7 offen sc1 lds
    s_mov_b32 exec_hi, -1
    s_waitcnt vmcnt(0)
    ds_read2st64_b32 v[8:9], v170 offset1:2
    ds_read2st64_b32 v[10:11], v170 offset0:4 offset1:6
    ds_read_b32 v12, v171
    s_waitcnt lgkmcnt(0)
    v_max3_u32 v169, v8, v9, v10
    v_max3_u32 v169, v169, v11, v12
    v_cmp_eq_u32 vcc, -1, v169
    s_cbranch_vccnz L_gcr
    s_branch L_gc
Lss_9:
    buffer_store_dwordx4 v[36:39], v153, s[64:67], s12 offen sc1
    buffer_store_dwordx4 v[40:43], v153, s[64:67], s12 offen offset:1024 sc1
    s_mov_b32 exec_lo, 0xffff
    s_mov_b32 exec_hi, 0xffff
    buffer_store_dwordx4 v[44:47], v84, s[64:67], s12 offen offset:2048 sc1
    s_branch Lsd_10
Lss_11:
    global_store_dwordx2 v155, v[0:1], s[98:99] sc1
    s_branch Lsd_12
L_xc0r:
    s_sub_u32 s101, s101, 1
    s_cbranch_scc1 L_end
    s_mov_b32 s97, m0
    s_lshl_b32 m0, s81, 13
    s_add_u32 m0, m0, 0
    s_add_u32 s96, s72, s85
    s_add_u32 s96, s96, 0
    buffer_load_dwordx4 v153, s[64:67], s96 offen offset:0 sc1 lds
    s_lshl_b32 m0, s81, 13
    s_add_u32 m0, m0, 2048
    s_add_u32 s96, s72, s85
    s_add_u32 s96, s96, 20480
    buffer_load_dwordx4 v153, s[64:67], s96 offen offset:0 sc1 lds
    s_lshl_b32 m0, s81, 13
    s_add_u32 m0, m0, 4096
    s_add_u32 s96, s72, s85
    s_add_u32 s96, s96, 40960
    buffer_load_dwordx4 v153, s[64:67], s96 offen offset:0 sc1 lds
    s_lshl_b32 m0, s81, 13
    s_add_u32 m0, m0, 6144
    s_add_u32 s96, s72, s85
    s_add_u32 s96, s96, 61440
    buffer_load_dwordx4 v153, s[64:67], s96 offen offset:0 sc1 lds
    s_mov_b32 m0, s97
    s_waitcnt vmcnt(0)
    v_and_b32 v169, 0x23ff, v158
    v_add_u32 v169, 0, v169
    ds_read_b128 v[56:59], v169 offset:0
    v_and_b32 v169, 0x23ff, v158
    v_add_u32 v169, 0, v169
    ds_read_b128 v[60:63], v169 offset:2048
    v_and_b32 v169, 0x23ff, v158
    v_add_u32 v169, 0, v169
    ds_read_b128 v[64:67], v169 offset:4096
    v_and_b32 v169, 0x23ff, v158
    v_add_u32 v169, 0, v169
    ds_read_b128 v[68:71], v169 offset:6144
    s_waitcnt lgkmcnt(0)
    v_bitop3_b32 v169, v56, v60, v64 bitop3:128
    v_bitop3_b32 v169, v169, v68, 1 bitop3:128
    v_cmp_ne_u32 vcc, 1, v169
    s_cbranch_vccnz L_xc0r
    s_branch L_xc0
L_xc1r:
    s_sub_u32 s101, s101, 1
    s_cbranch_scc1 L_end
    s_mov_b32 s97, m0
    s_lshl_b32 m0, s81, 13
    s_add_u32 m0, m0, 0
    s_add_u32 s96, s72, s85
    s_add_u32 s96, s96, 0
    buffer_load_dwordx4 v153, s[64:67], s96 offen offset:1024 sc1 lds
    s_lshl_b32 m0, s81, 13
    s_add_u32 m0, m0, 2048
    s_add_u32 s96, s72, s85
    s_add_u32 s96, s96, 20480
    buffer_load_dwordx4 v153, s[64:67], s96 offen offset:1024 sc1 lds
    s_lshl_b32 m0, s81, 13
    s_add_u32 m0, m0, 4096
    s_add_u32 s96, s72, s85
    s_add_u32 s96, s96, 40960
    buffer_load_dwordx4 v153, s[64:67], s96 offen offset:1024 sc1 lds
    s_lshl_b32 m0, s81, 13
    s_add_u32 m0, m0, 6144
    s_add_u32 s96, s72, s85
    s_add_u32 s96, s96, 61440
    buffer_load_dwordx4 v153, s[64:67], s96 offen offset:1024 sc1 lds
    s_mov_b32 m0, s97
    s_waitcnt vmcnt(0)
    v_and_b32 v169, 0x23ff, v158
    v_add_u32 v169, 0, v169
    ds_read_b128 v[72:75], v169 offset:1024
    v_and_b32 v169, 0x23ff, v158
    v_add_u32 v169, 0, v169
    ds_read_b128 v[76:79], v169 offset:3072
    v_and_b32 v169, 0x23ff, v158
    v_add_u32 v169, 0, v169
    ds_read_b128 v[80:83], v169 offset:5120
    v_and_b32 v169, 0x23ff, v158
    v_add_u32 v169, 0, v169
    ds_read_b128 v[84:87], v169 offset:7168
    s_waitcnt lgkmcnt(0)
    v_bitop3_b32 v169, v72, v76, v80 bitop3:128
    v_bitop3_b32 v169, v169, v84, 1 bitop3:128
    v_cmp_ne_u32 vcc, 1, v169
    s_cbranch_vccnz L_xc1r
    s_branch L_xc1
L_xc2r:
    s_sub_u32 s101, s101, 1
    s_cbranch_scc1 L_end
    s_mov_b32 s97, m0
    s_lshl_b32 m0, s81, 13
    s_xor_b32 m0, m0, 0x2000
    s_add_u32 m0, m0, 0
    s_add_u32 s96, s72, s90
    s_add_u32 s96, s96, 0
    buffer_load_dwordx4 v153, s[64:67], s96 offen offset:0 sc1 lds
    s_lshl_b32 m0, s81, 13
    s_xor_b32 m0, m0, 0x2000
    s_add_u32 m0, m0, 2048
    s_add_u32 s96, s72, s90
    s_add_u32 s96, s96, 20480
    buffer_load_dwordx4 v153, s[64:67], s96 offen offset:0 sc1 lds
    s_lshl_b32 m0, s81, 13
    s_xor_b32 m0, m0, 0x2000
    s_add_u32 m0, m0, 4096
    s_add_u32 s96, s72, s90
    s_add_u32 s96, s96, 40960
    buffer_load_dwordx4 v153, s[64:67], s96 offen offset:0 sc1 lds
    s_lshl_b32 m0, s81, 13
    s_xor_b32 m0, m0, 0x2000
    s_add_u32 m0, m0, 6144
    s_add_u32 s96, s72, s90
    s_add_u32 s96, s96, 61440
    buffer_load_dwordx4 v153, s[64:67], s96 offen offset:0 sc1 lds
    s_mov_b32 m0, s97
    s_waitcnt vmcnt(0)
    v_and_b32 v169, 0x23ff, v159
    v_add_u32 v169, 0, v169
    ds_read_b128 v[88:91], v169 offset:0
    v_and_b32 v169, 0x23ff, v159
    v_add_u32 v169, 0, v169
    ds_read_b128 v[92:95], v169 offset:2048
    v_and_b32 v169, 0x23ff, v159
    v_add_u32 v169, 0, v169
    ds_read_b128 v[96:99], v169 offset:4096
    v_and_b32 v169, 0x23ff, v159
    v_add_u32 v169, 0, v169
    ds_read_b128 v[100:103], v169 offset:6144
    s_waitcnt lgkmcnt(0)
    v_bitop3_b32 v169, v88, v92, v96 bitop3:128
    v_bitop3_b32 v169, v169, v100, 1 bitop3:128
    v_cmp_ne_u32 vcc, 1, v169
    s_cbranch_vccnz L_xc2r
    s_branch L_xc2
L_xc3r:
    s_sub_u32 s101, s101, 1
    s_cbranch_scc1 L_end
    s_mov_b32 s97, m0
    s_lshl_b32 m0, s81, 13
    s_xor_b32 m0, m0, 0x2000
    s_add_u32 m0, m0, 0
    s_add_u32 s96, s72, s90
    s_add_u32 s96, s96, 0
    buffer_load_dwordx4 v153, s[64:67], s96 offen offset:1024 sc1 lds
    s_lshl_b32 m0, s81, 13
    s_xor_b32 m0, m0, 0x2000
    s_add_u32 m0, m0, 2048
    s_add_u32 s96, s72, s90
    s_add_u32 s96, s96, 20480
    buffer_load_dwordx4 v153, s[64:67], s96 offen offset:1024 sc1 lds
    s_lshl_b32 m0, s81, 13
    s_xor_b32 m0, m0, 0x2000
    s_add_u32 m0, m0, 4096
    s_add_u32 s96, s72, s90
    s_add_u32 s96, s96, 40960
    buffer_load_dwordx4 v153, s[64:67], s96 offen offset:1024 sc1 lds
    s_lshl_b32 m0, s81, 13
    s_xor_b32 m0, m0, 0x2000
    s_add_u32 m0, m0, 6144
    s_add_u32 s96, s72, s90
    s_add_u32 s96, s96, 61440
    buffer_load_dwordx4 v153, s[64:67], s96 offen offset:1024 sc1 lds
    s_mov_b32 m0, s97
    s_waitcnt vmcnt(0)
    v_and_b32 v169, 0x23ff, v159
    v_add_u32 v169, 0, v169
    ds_read_b128 v[56:59], v169 offset:1024
    v_and_b32 v169, 0x23ff, v159
    v_add_u32 v169, 0, v169
    ds_read_b128 v[60:63], v169 offset:3072
    v_and_b32 v169, 0x23ff, v159
    v_add_u32 v169, 0, v169
    ds_read_b128 v[64:67], v169 offset:5120
    v_and_b32 v169, 0x23ff, v159
    v_add_u32 v169, 0, v169
    ds_read_b128 v[68:71], v169 offset:7168
    s_waitcnt lgkmcnt(0)
    v_bitop3_b32 v169, v56, v60, v64 bitop3:128
    v_bitop3_b32 v169, v169, v68, 1 bitop3:128
    v_cmp_ne_u32 vcc, 1, v169
    s_cbranch_vccnz L_xc3r
    s_branch L_xc3
L_xc4r:
    s_sub_u32 s101, s101, 1
    s_cbranch_scc1 L_end
    s_mov_b32 s97, m0
    s_lshl_b32 m0, s81, 13
    s_add_u32 m0, m0, 16384
    s_add_u32 s96, s73, s85
    s_add_u32 s96, s96, 0
    buffer_load_dwordx4 v153, s[64:67], s96 offen offset:0 sc1 lds
    s_lshl_b32 m0, s81, 13
    s_add_u32 m0, m0, 20480
    s_add_u32 s96, s73, s85
    s_add_u32 s96, s96, 40960
    buffer_load_dwordx4 v153, s[64:67], s96 offen offset:0 sc1 lds
    s_lshl_b32 m0, s81, 13
    s_add_u32 m0, m0, 18432
    s_add_u32 s96, s73, s85
    s_add_u32 s96, s96, 20480
    buffer_load_dwordx4 v153, s[64:67], s96 offen offset:0 sc1 lds
    s_lshl_b32 m0, s81, 13
    s_add_u32 m0, m0, 22528
    s_add_u32 s96, s73, s85
    s_add_u32 s96, s96, 61440
    buffer_load_dwordx4 v153, s[64:67], s96 offen offset:0 sc1 lds
    s_mov_b32 m0, s97
    s_waitcnt vmcnt(0)
    v_and_b32 v169, 0x23ff, v158
    v_add_u32 v169, 16384, v169
    ds_read_b128 v[72:75], v169 offset:0
    v_and_b32 v169, 0x23ff, v158
    v_add_u32 v169, 16384, v169
    ds_read_b128 v[76:79], v169 offset:4096
    v_and_b32 v169, 0x23ff, v158
    v_add_u32 v169, 16384, v169
    ds_read_b128 v[80:83], v169 offset:2048
    v_and_b32 v169, 0x23ff, v158
    v_add_u32 v169, 16384, v169
    ds_read_b128 v[84:87], v169 offset:6144
    s_waitcnt lgkmcnt(0)
    v_bitop3_b32 v169, v72, v76, v80 bitop3:128
    v_bitop3_b32 v169, v169, v84, 1 bitop3:128
    v_cmp_ne_u32 vcc, 1, v169
    s_cbranch_vccnz L_xc4r
    s_branch L_xc4
L_xc5r:
    s_sub_u32 s101, s101, 1
    s_cbranch_scc1 L_end
    s_mov_b32 s97, m0
    s_lshl_b32 m0, s81, 13
    s_add_u32 m0, m0, 16384
    s_add_u32 s96, s73, s85
    s_add_u32 s96, s96, 0
    buffer_load_dwordx4 v153, s[64:67], s96 offen offset:1024 sc1 lds
    s_lshl_b32 m0, s81, 13
    s_add_u32 m0, m0, 20480
    s_add_u32 s96, s73, s85
    s_add_u32 s96, s96, 40960
    buffer_load_dwordx4 v153, s[64:67], s96 offen offset:1024 sc1 lds
    s_lshl_b32 m0, s81, 13
    s_add_u32 m0, m0, 18432
    s_add_u32 s96, s73, s85
    s_add_u32 s96, s96, 20480
    buffer_load_dwordx4 v153, s[64:67], s96 offen offset:1024 sc1 lds
    s_lshl_b32 m0, s81, 13
    s_add_u32 m0, m0, 22528
    s_add_u32 s96, s73, s85
    s_add_u32 s96, s96, 61440
    buffer_load_dwordx4 v153, s[64:67], s96 offen offset:1024 sc1 lds
    s_mov_b32 m0, s97
    s_waitcnt vmcnt(0)
    v_and_b32 v169, 0x23ff, v158
    v_add_u32 v169, 16384, v169
    ds_read_b128 v[88:91], v169 offset:1024
    v_and_b32 v169, 0x23ff, v158
    v_add_u32 v169, 16384, v169
    ds_read_b128 v[92:95], v169 offset:5120
    v_and_b32 v169, 0x23ff, v158
    v_add_u32 v169, 16384, v169
    ds_read_b128 v[96:99], v169 offset:3072
    v_and_b32 v169, 0x23ff, v158
    v_add_u32 v169, 16384, v169
    ds_read_b128 v[100:103], v169 offset:7168
    s_waitcnt lgkmcnt(0)
    v_bitop3_b32 v169, v88, v92, v96 bitop3:128
    v_bitop3_b32 v169, v169, v100, 1 bitop3:128
    v_cmp_ne_u32 vcc, 1, v169
    s_cbranch_vccnz L_xc5r
    s_branch L_xc5
L_xc6r:
    s_sub_u32 s101, s101, 1
    s_cbranch_scc1 L_end
    s_mov_b32 s97, m0
    s_lshl_b32 m0, s81, 13
    s_add_u32 m0, m0, 32768
    s_add_u32 s96, s74, s85
    s_add_u32 s96, s96, 0
    buffer_load_dwordx4 v153, s[64:67], s96 offen offset:0 sc1 lds
    s_lshl_b32 m0, s81, 13
    s_add_u32 m0, m0, 36864
    s_add_u32 s96, s74, s85
    s_add_u32 s96, s96, 40960
    buffer_load_dwordx4 v153, s[64:67], s96 offen offset:0 sc1 lds
    s_lshl_b32 m0, s81, 13
    s_add_u32 m0, m0, 34816
    s_add_u32 s96, s74, s85
    s_add_u32 s96, s96, 20480
    buffer_load_dwordx4 v153, s[64:67], s96 offen offset:0 sc1 lds
    s_lshl_b32 m0, s81, 13
    s_add_u32 m0, m0, 38912
    s_add_u32 s96, s74, s85
    s_add_u32 s96, s96, 61440
    buffer_load_dwordx4 v153, s[64:67], s96 offen offset:0 sc1 lds
    s_mov_b32 m0, s97
    s_waitcnt vmcnt(0)
    v_and_b32 v169, 0x23ff, v158
    v_add_u32 v169, 32768, v169
    ds_read_b128 v[56:59], v169 offset:0
    v_and_b32 v169, 0x23ff, v158
    v_add_u32 v169, 32768, v169
    ds_read_b128 v[60:63], v169 offset:4096
    v_and_b32 v169, 0x23ff, v158
    v_add_u32 v169, 32768, v169
    ds_read_b128 v[64:67], v169 offset:2048
    v_and_b32 v169, 0x23ff, v158
    v_add_u32 v169, 32768, v169
    ds_read_b128 v[68:71], v169 offset:6144
    s_waitcnt lgkmcnt(0)
    v_bitop3_b32 v169, v56, v60, v64 bitop3:128
    v_bitop3_b32 v169, v169, v68, 1 bitop3:128
    v_cmp_ne_u32 vcc, 1, v169
    s_cbranch_vccnz L_xc6r
    s_branch L_xc6
L_s2r:
    s_sub_u32 s101, s101, 1
    s_cbranch_scc1 L_end
    global_load_dwordx4 v[104:107], v163, s[98:99] sc1
    global_load_dwordx4 v[108:111], v163, s[98:99] offset:256 sc1
    s_waitcnt vmcnt(0)
    s_branch L_s2
L_xc7r:
    s_sub_u32 s101, s101, 1
    s_cbranch_scc1 L_end
    s_mov_b32 s97, m0
    s_lshl_b32 m0, s81, 13
    s_add_u32 m0, m0, 32768
    s_add_u32 s96, s74, s85
    s_add_u32 s96, s96, 0
    buffer_load_dwordx4 v153, s[64:67], s96 offen offset:1024 sc1 lds
    s_lshl_b32 m0, s81, 13
    s_add_u32 m0, m0, 36864
    s_add_u32 s96, s74, s85
    s_add_u32 s96, s96, 40960
    buffer_load_dwordx4 v153, s[64:67], s96 offen offset:1024 sc1 lds
    s_lshl_b32 m0, s81, 13
    s_add_u32 m0, m0, 34816
    s_add_u32 s96, s74, s85
    s_add_u32 s96, s96, 20480
    buffer_load_dwordx4 v153, s[64:67], s96 offen offset:1024 sc1 lds
    s_lshl_b32 m0, s81, 13
    s_add_u32 m0, m0, 38912
    s_add_u32 s96, s74, s85
    s_add_u32 s96, s96, 61440
    buffer_load_dwordx4 v153, s[64:67], s96 offen offset:1024 sc1 lds
    s_mov_b32 m0, s97
    s_waitcnt vmcnt(0)
    v_and_b32 v169, 0x23ff, v158
    v_add_u32 v169, 32768, v169
    ds_read_b128 v[72:75], v169 offset:1024
    v_and_b32 v169, 0x23ff, v158
    v_add_u32 v169, 32768, v169
    ds_read_b128 v[76:79], v169 offset:5120
    v_and_b32 v169, 0x23ff, v158
    v_add_u32 v169, 32768, v169
    ds_read_b128 v[80:83], v169 offset:3072
    v_and_b32 v169, 0x23ff, v158
    v_add_u32 v169, 32768, v169
    ds_read_b128 v[84:87], v169 offset:7168
    s_waitcnt lgkmcnt(0)
    v_bitop3_b32 v169, v72, v76, v80 bitop3:128
    v_bitop3_b32 v169, v169, v84, 1 bitop3:128
    v_cmp_ne_u32 vcc, 1, v169
    s_cbranch_vccnz L_xc7r
    s_branch L_xc7
L_xc8r:
    s_sub_u32 s101, s101, 1
    s_cbranch_scc1 L_end
    s_mov_b32 s97, m0
    s_lshl_b32 m0, s81, 13
    s_add_u32 m0, m0, 49152
    s_add_u32 s96, s75, s85
    s_add_u32 s96, s96, 0
    buffer_load_dwordx4 v153, s[64:67], s96 offen offset:0 sc1 lds
    s_lshl_b32 m0, s81, 13
    s_add_u32 m0, m0, 53248
    s_add_u32 s96, s75, s85
    s_add_u32 s96, s96, 40960
    buffer_load_dwordx4 v153, s[64:67], s96 offen offset:0 sc1 lds
    s_lshl_b32 m0, s81, 13
    s_add_u32 m0, m0, 51200
    s_add_u32 s96, s75, s85
    s_add_u32 s96, s96, 20480
    buffer_load_dwordx4 v153, s[64:67], s96 offen offset:0 sc1 lds
    s_lshl_b32 m0, s81, 13
    s_add_u32 m0, m0, 55296
    s_add_u32 s96, s75, s85
    s_add_u32 s96, s96, 61440
    buffer_load_dwordx4 v153, s[64:67], s96 offen offset:0 sc1 lds
    s_mov_b32 m0, s97
    s_waitcnt vmcnt(0)
    v_and_b32 v169, 0x23ff, v158
    v_add_u32 v169, 49152, v169
    ds_read_b128 v[88:91], v169 offset:0
    v_and_b32 v169, 0x23ff, v158
    v_add_u32 v169, 49152, v169
    ds_read_b128 v[92:95], v169 offset:4096
    v_and_b32 v169, 0x23ff, v158
    v_add_u32 v169, 49152, v169
    ds_read_b128 v[96:99], v169 offset:2048
    v_and_b32 v169, 0x23ff, v158
    v_add_u32 v169, 49152, v169
    ds_read_b128 v[100:103], v169 offset:6144
    s_waitcnt lgkmcnt(0)
    v_bitop3_b32 v169, v88, v92, v96 bitop3:128
    v_bitop3_b32 v169, v169, v100, 1 bitop3:128
    v_cmp_ne_u32 vcc, 1, v169
    s_cbranch_vccnz L_xc8r
    s_branch L_xc8
L_xc9r:
    s_sub_u32 s101, s101, 1
    s_cbranch_scc1 L_end
    s_mov_b32 s97, m0
    s_lshl_b32 m0, s81, 13
    s_add_u32 m0, m0, 49152
    s_add_u32 s96, s75, s85
    s_add_u32 s96, s96, 0
    buffer_load_dwordx4 v153, s[64:67], s96 offen offset:1024 sc1 lds
    s_lshl_b32 m0, s81, 13
    s_add_u32 m0, m0, 53248
    s_add_u32 s96, s75, s85
    s_add_u32 s96, s96, 40960
    buffer_load_dwordx4 v153, s[64:67], s96 offen offset:1024 sc1 lds
    s_lshl_b32 m0, s81, 13
    s_add_u32 m0, m0, 51200
    s_add_u32 s96, s75, s85
    s_add_u32 s96, s96, 20480
    buffer_load_dwordx4 v153, s[64:67], s96 offen offset:1024 sc1 lds
    s_lshl_b32 m0, s81, 13
    s_add_u32 m0, m0, 55296
    s_add_u32 s96, s75, s85
    s_add_u32 s96, s96, 61440
    buffer_load_dwordx4 v153, s[64:67], s96 offen offset:1024 sc1 lds
    s_mov_b32 m0, s97
    s_waitcnt vmcnt(0)
    v_and_b32 v169, 0x23ff, v158
    v_add_u32 v169, 49152, v169
    ds_read_b128 v[56:59], v169 offset:1024
    v_and_b32 v169, 0x23ff, v158
    v_add_u32 v169, 49152, v169
    ds_read_b128 v[60:63], v169 offset:5120
    v_and_b32 v169, 0x23ff, v158
    v_add_u32 v169, 49152, v169
    ds_read_b128 v[64:67], v169 offset:3072
    v_and_b32 v169, 0x23ff, v158
    v_add_u32 v169, 49152, v169
    ds_read_b128 v[68:71], v169 offset:7168
    s_waitcnt lgkmcnt(0)
    v_bitop3_b32 v169, v56, v60, v64 bitop3:128
    v_bitop3_b32 v169, v169, v68, 1 bitop3:128
    v_cmp_ne_u32 vcc, 1, v169
    s_cbranch_vccnz L_xc9r
    s_branch L_xc9
L_xc10r:
    s_sub_u32 s101, s101, 1
    s_cbranch_scc1 L_end
    s_mov_b32 s97, m0
    s_lshl_b32 m0, s81, 13
    s_add_u32 m0, m0, 69632
    s_add_u32 s96, s76, s85
    s_add_u32 s96, s96, 40960
    buffer_load_dwordx4 v153, s[64:67], s96 offen offset:0 sc1 lds
    s_lshl_b32 m0, s81, 13
    s_add_u32 m0, m0, 69632
    s_add_u32 s96, s76, s85
    s_add_u32 s96, s96, 40960
    buffer_load_dwordx4 v153, s[64:67], s96 offen offset:1024 sc1 lds
    s_lshl_b32 m0, s81, 13
    s_add_u32 m0, m0, 65536
    s_add_u32 s96, s76, s85
    s_add_u32 s96, s96, 0
    buffer_load_dwordx4 v153, s[64:67], s96 offen offset:0 sc1 lds
    s_lshl_b32 m0, s81, 13
    s_add_u32 m0, m0, 65536
    s_add_u32 s96, s76, s85
    s_add_u32 s96, s96, 0
    buffer_load_dwordx4 v153, s[64:67], s96 offen offset:1024 sc1 lds
    s_mov_b32 m0, s97
    s_waitcnt vmcnt(0)
    v_and_b32 v169, 0x23ff, v158
    v_add_u32 v169, 65536, v169
    ds_read_b128 v[72:75], v169 offset:4096
    v_and_b32 v169, 0x23ff, v158
    v_add_u32 v169, 65536, v169
    ds_read_b128 v[76:79], v169 offset:5120
    v_and_b32 v169, 0x23ff, v158
    v_add_u32 v169, 65536, v169
    ds_read_b128 v[80:83], v169 offset:0
    v_and_b32 v169, 0x23ff, v158
    v_add_u32 v169, 65536, v169
    ds_read_b128 v[84:87], v169 offset:1024
    s_waitcnt lgkmcnt(0)
    v_bitop3_b32 v169, v72, v76, v80 bitop3:128
    v_bitop3_b32 v169, v169, v84, 1 bitop3:128
    v_cmp_ne_u32 vcc, 1, v169
    s_cbranch_vccnz L_xc10r
    s_branch L_xc10
L_xc11r:
    s_sub_u32 s101, s101, 1
    s_cbranch_scc1 L_end
    s_mov_b32 s97, m0
    s_lshl_b32 m0, s81, 13
    s_add_u32 m0, m0, 71680
    s_add_u32 s96, s76, s85
    s_add_u32 s96, s96, 61440
    buffer_load_dwordx4 v153, s[64:67], s96 offen offset:0 sc1 lds
    s_lshl_b32 m0, s81, 13
    s_add_u32 m0, m0, 71680
    s_add_u32 s96, s76, s85
    s_add_u32 s96, s96, 61440
    buffer_load_dwordx4 v153, s[64:67], s96 offen offset:1024 sc1 lds
    s_lshl_b32 m0, s81, 13
    s_add_u32 m0, m0, 67584
    s_add_u32 s96, s76, s85
    s_add_u32 s96, s96, 20480
    buffer_load_dwordx4 v153, s[64:67], s96 offen offset:0 sc1 lds
    s_lshl_b32 m0, s81, 13
    s_add_u32 m0, m0, 67584
    s_add_u32 s96, s76, s85
    s_add_u32 s96, s96, 20480
    buffer_load_dwordx4 v153, s[64:67], s96 offen offset:1024 sc1 lds
    s_mov_b32 m0, s97
    s_waitcnt vmcnt(0)
    v_and_b32 v169, 0x23ff, v158
    v_add_u32 v169, 65536, v169
    ds_read_b128 v[88:91], v169 offset:6144
    v_and_b32 v169, 0x23ff, v158
    v_add_u32 v169, 65536, v169
    ds_read_b128 v[92:95], v169 offset:7168
    v_and_b32 v169, 0x23ff, v158
    v_add_u32 v169, 65536, v169
    ds_read_b128 v[96:99], v169 offset:2048
    v_and_b32 v169, 0x23ff, v158
    v_add_u32 v169, 65536, v169
    ds_read_b128 v[100:103], v169 offset:3072
    s_waitcnt lgkmcnt(0)
    v_bitop3_b32 v169, v88, v92, v96 bitop3:128
    v_bitop3_b32 v169, v169, v100, 1 bitop3:128
    v_cmp_ne_u32 vcc, 1, v169
    s_cbranch_vccnz L_xc11r
    s_branch L_xc11
L_xc12r:
    s_sub_u32 s101, s101, 1
    s_cbranch_scc1 L_end
    s_mov_b32 s97, m0
    s_lshl_b32 m0, s81, 13
    s_xor_b32 m0, m0, 0x2000
    s_add_u32 m0, m0, 16384
    s_add_u32 s96, s73, s90
    s_add_u32 s96, s96, 0
    buffer_load_dwordx4 v153, s[64:67], s96 offen offset:0 sc1 lds
    s_lshl_b32 m0, s81, 13
    s_xor_b32 m0, m0, 0x2000
    s_add_u32 m0, m0, 16384
    s_add_u32 s96, s73, s90
    s_add_u32 s96, s96, 0
    buffer_load_dwordx4 v153, s[64:67], s96 offen offset:1024 sc1 lds
    s_lshl_b32 m0, s81, 13
    s_xor_b32 m0, m0, 0x2000
    s_add_u32 m0, m0, 32768
    s_add_u32 s96, s74, s90
    s_add_u32 s96, s96, 0
    buffer_load_dwordx4 v153, s[64:67], s96 offen offset:0 sc1 lds
    s_lshl_b32 m0, s81, 13
    s_xor_b32 m0, m0, 0x2000
    s_add_u32 m0, m0, 32768
    s_add_u32 s96, s74, s90
    s_add_u32 s96, s96, 0
    buffer_load_dwordx4 v153, s[64:67], s96 offen offset:1024 sc1 lds
    s_mov_b32 m0, s97
    s_waitcnt vmcnt(0)
    v_and_b32 v169, 0x23ff, v159
    v_add_u32 v169, 16384, v169
    ds_read_b128 v[56:59], v169 offset:0
    v_and_b32 v169, 0x23ff, v159
    v_add_u32 v169, 16384, v169
    ds_read_b128 v[60:63], v169 offset:1024
    v_and_b32 v169, 0x23ff, v159
    v_add_u32 v169, 32768, v169
    ds_read_b128 v[64:67], v169 offset:0
    v_and_b32 v169, 0x23ff, v159
    v_add_u32 v169, 32768, v169
    ds_read_b128 v[68:71], v169 offset:1024
    s_waitcnt lgkmcnt(0)
    v_bitop3_b32 v169, v56, v60, v64 bitop3:128
    v_bitop3_b32 v169, v169, v68, 1 bitop3:128
    v_cmp_ne_u32 vcc, 1, v169
    s_cbranch_vccnz L_xc12r
    s_branch L_xc12
L_xc13r:
    s_sub_u32 s101, s101, 1
    s_cbranch_scc1 L_end
    s_mov_b32 s97, m0
    s_lshl_b32 m0, s81, 13
    s_xor_b32 m0, m0, 0x2000
    s_add_u32 m0, m0, 49152
    s_add_u32 s96, s75, s90
    s_add_u32 s96, s96, 0
    buffer_load_dwordx4 v153, s[64:67], s96 offen offset:0 sc1 lds
    s_lshl_b32 m0, s81, 13
    s_xor_b32 m0, m0, 0x2000
    s_add_u32 m0, m0, 49152
    s_add_u32 s96, s75, s90
    s_add_u32 s96, s96, 0
    buffer_load_dwordx4 v153, s[64:67], s96 offen offset:1024 sc1 lds
    s_lshl_b32 m0, s81, 13
    s_xor_b32 m0, m0, 0x2000
    s_add_u32 m0, m0, 65536
    s_add_u32 s96, s76, s90
    s_add_u32 s96, s96, 0
    buffer_load_dwordx4 v153, s[64:67], s96 offen offset:0 sc1 lds
    s_lshl_b32 m0, s81, 13
    s_xor_b32 m0, m0, 0x2000
    s_add_u32 m0, m0, 65536
    s_add_u32 s96, s76, s90
    s_add_u32 s96, s96, 0
    buffer_load_dwordx4 v153, s[64:67], s96 offen offset:1024 sc1 lds
    s_mov_b32 m0, s97
    s_waitcnt vmcnt(0)
    v_and_b32 v169, 0x23ff, v159
    v_add_u32 v169, 49152, v169
    ds_read_b128 v[72:75], v169 offset:0
    v_and_b32 v169, 0x23ff, v159
    v_add_u32 v169, 49152, v169
    ds_read_b128 v[76:79], v169 offset:1024
    v_and_b32 v169, 0x23ff, v159
    v_add_u32 v169, 65536, v169
    ds_read_b128 v[80:83], v169 offset:0
    v_and_b32 v169, 0x23ff, v159
    v_add_u32 v169, 65536, v169
    ds_read_b128 v[84:87], v169 offset:1024
    s_waitcnt lgkmcnt(0)
    v_bitop3_b32 v169, v72, v76, v80 bitop3:128
    v_bitop3_b32 v169, v169, v84, 1 bitop3:128
    v_cmp_ne_u32 vcc, 1, v169
    s_cbranch_vccnz L_xc13r
    s_branch L_xc13
L_xc14r:
    s_sub_u32 s101, s101, 1
    s_cbranch_scc1 L_end
    s_mov_b32 s97, m0
    s_lshl_b32 m0, s81, 13
    s_xor_b32 m0, m0, 0x2000
    s_add_u32 m0, m0, 18432
    s_add_u32 s96, s73, s90
    s_add_u32 s96, s96, 20480
    buffer_load_dwordx4 v153, s[64:67], s96 offen offset:0 sc1 lds
    s_lshl_b32 m0, s81, 13
    s_xor_b32 m0, m0, 0x2000
    s_add_u32 m0, m0, 18432
    s_add_u32 s96, s73, s90
    s_add_u32 s96, s96, 20480
    buffer_load_dwordx4 v153, s[64:67], s96 offen offset:1024 sc1 lds
    s_lshl_b32 m0, s81, 13
    s_xor_b32 m0, m0, 0x2000
    s_add_u32 m0, m0, 34816
    s_add_u32 s96, s74, s90
    s_add_u32 s96, s96, 20480
    buffer_load_dwordx4 v153, s[64:67], s96 offen offset:0 sc1 lds
    s_lshl_b32 m0, s81, 13
    s_xor_b32 m0, m0, 0x2000
    s_add_u32 m0, m0, 34816
    s_add_u32 s96, s74, s90
    s_add_u32 s96, s96, 20480
    buffer_load_dwordx4 v153, s[64:67], s96 offen offset:1024 sc1 lds
    s_mov_b32 m0, s97
    s_waitcnt vmcnt(0)
    v_and_b32 v169, 0x23ff, v159
    v_add_u32 v169, 16384, v169
    ds_read_b128 v[56:59], v169 offset:2048
    v_and_b32 v169, 0x23ff, v159
    v_add_u32 v169, 16384, v169
    ds_read_b128 v[60:63], v169 offset:3072
    v_and_b32 v169, 0x23ff, v159
    v_add_u32 v169, 32768, v169
    ds_read_b128 v[64:67], v169 offset:2048
    v_and_b32 v169, 0x23ff, v159
    v_add_u32 v169, 32768, v169
    ds_read_b128 v[68:71], v169 offset:3072
    s_waitcnt lgkmcnt(0)
    v_bitop3_b32 v169, v56, v60, v64 bitop3:128
    v_bitop3_b32 v169, v169, v68, 1 bitop3:128
    v_cmp_ne_u32 vcc, 1, v169
    s_cbranch_vccnz L_xc14r
    s_branch L_xc14
L_xc15r:
    s_sub_u32 s101, s101, 1
    s_cbranch_scc1 L_end
    s_mov_b32 s97, m0
    s_lshl_b32 m0, s81, 13
    s_xor_b32 m0, m0, 0x2000
    s_add_u32 m0, m0, 51200
    s_add_u32 s96, s75, s90
    s_add_u32 s96, s96, 20480
    buffer_load_dwordx4 v153, s[64:67], s96 offen offset:0 sc1 lds
    s_lshl_b32 m0, s81, 13
    s_xor_b32 m0, m0, 0x2000
    s_add_u32 m0, m0, 51200
    s_add_u32 s96, s75, s90
    s_add_u32 s96, s96, 20480
    buffer_load_dwordx4 v153, s[64:67], s96 offen offset:1024 sc1 lds
    s_lshl_b32 m0, s81, 13
    s_xor_b32 m0, m0, 0x2000
    s_add_u32 m0, m0, 67584
    s_add_u32 s96, s76, s90
    s_add_u32 s96, s96, 20480
    buffer_load_dwordx4 v153, s[64:67], s96 offen offset:0 sc1 lds
    s_lshl_b32 m0, s81, 13
    s_xor_b32 m0, m0, 0x2000
    s_add_u32 m0, m0, 67584
    s_add_u32 s96, s76, s90
    s_add_u32 s96, s96, 20480
    buffer_load_dwordx4 v153, s[64:67], s96 offen offset:1024 sc1 lds
    s_mov_b32 m0, s97
    s_waitcnt vmcnt(0)
    v_and_b32 v169, 0x23ff, v159
    v_add_u32 v169, 49152, v169
    ds_read_b128 v[72:75], v169 offset:2048
    v_and_b32 v169, 0x23ff, v159
    v_add_u32 v169, 49152, v169
    ds_read_b128 v[76:79], v169 offset:3072
    v_and_b32 v169, 0x23ff, v159
    v_add_u32 v169, 65536, v169
    ds_read_b128 v[80:83], v169 offset:2048
    v_and_b32 v169, 0x23ff, v159
    v_add_u32 v169, 65536, v169
    ds_read_b128 v[84:87], v169 offset:3072
    s_waitcnt lgkmcnt(0)
    v_bitop3_b32 v169, v72, v76, v80 bitop3:128
    v_bitop3_b32 v169, v169, v84, 1 bitop3:128
    v_cmp_ne_u32 vcc, 1, v169
    s_cbranch_vccnz L_xc15r
    s_branch L_xc15
Lss_13:
    global_store_dword v110, v111, s[50:51] sc1
    s_branch Lsd_14
L_cre1:
    s_sub_u32 s101, s101, 1
    s_cbranch_scc1 L_end
    buffer_load_dwordx4 v[116:119], v85, s[92:95], 0 offen offset:2048 sc1
    buffer_load_dwordx4 v[112:115], v85, s[92:95], 0 offen offset:1792 sc1
    buffer_load_dwordx4 v[108:111], v85, s[92:95], 0 offen offset:1536 sc1
    buffer_load_dwordx4 v[104:107], v85, s[92:95], 0 offen offset:1280 sc1
    buffer_load_dwordx4 v[100:103], v85, s[92:95], 0 offen offset:1024 sc1
    buffer_load_dwordx4 v[96:99], v85, s[92:95], 0 offen offset:768 sc1
    buffer_load_dwordx4 v[92:95], v85, s[92:95], 0 offen offset:512 sc1
    buffer_load_dwordx4 v[88:91], v85, s[92:95], 0 offen offset:256 sc1
    s_waitcnt vmcnt(0)
    s_branch L_cchk1
L_xr_re:
    s_sub_u32 s101, s101, 1
    s_cbranch_scc1 L_end
    global_load_dword v64, v87, s[50:51] sc1
    s_waitcnt vmcnt(0)
    s_branch L_xr
L_p2s1:
    v_fmac_f32_dpp v48, -v84, v131 row_ror:8 row_mask:0xf bank_mask:0xf
    v_fmac_f32 v48, v130, v84
    v_pk_fma_f32 v[0:1], v[80:81], v[128:129], v[0:1] op_sel_hi:[1,0,1]
    v_pk_fma_f32 v[16:17], v[82:83], v[128:129], v[16:17] op_sel_hi:[1,0,1]
    v_fmac_f32_dpp v49, -v48, v131 row_ror:8 row_mask:0xf bank_mask:0xf
    v_fmac_f32 v49, v130, v48
    v_pk_fma_f32 v[0:1], v[82:83], v[128:129], v[0:1] op_sel:[0,1,0] neg_lo:[1,0,0] neg_hi:[1,0,0]
    v_pk_fma_f32 v[16:17], v[80:81], v[128:129], v[16:17] op_sel:[0,1,0]
    v_fmac_f32_dpp v50, -v49, v131 row_ror:8 row_mask:0xf bank_mask:0xf
    v_fmac_f32 v50, v130, v49
    v_pk_fma_f32 v[2:3], v[0:1], v[128:129], v[2:3] op_sel_hi:[1,0,1]
    v_pk_fma_f32 v[18:19], v[16:17], v[128:129], v[18:19] op_sel_hi:[1,0,1]
    v_fmac_f32_dpp v51, -v50, v131 row_ror:8 row_mask:0xf bank_mask:0xf
    v_fmac_f32 v51, v130, v50
    v_pk_fma_f32 v[2:3], v[16:17], v[128:129], v[2:3] op_sel:[0,1,0] neg_lo:[1,0,0] neg_hi:[1,0,0]
    v_pk_fma_f32 v[18:19], v[0:1], v[128:129], v[18:19] op_sel:[0,1,0]
    v_cvt_pk_bf16_f32 v104, v0, v1
    v_cvt_pk_bf16_f32 v105, v2, v3
    v_cvt_pk_bf16_f32 v106, -v16, -v17
    v_cvt_pk_bf16_f32 v107, -v18, -v19

    ds_write_b128 v56, v[104:107] offset:0
    ds_read_b64_tr_b16 v[88:89], v58 offset:0
    ds_read_b64_tr_b16 v[90:91], v59 offset:0
    v_fmac_f32_dpp v52, -v51, v131 row_ror:8 row_mask:0xf bank_mask:0xf
    v_fmac_f32 v52, v130, v51
    v_pk_fma_f32 v[4:5], v[2:3], v[128:129], v[4:5] op_sel_hi:[1,0,1]
    v_pk_fma_f32 v[20:21], v[18:19], v[128:129], v[20:21] op_sel_hi:[1,0,1]
    v_fmac_f32_dpp v53, -v52, v131 row_ror:8 row_mask:0xf bank_mask:0xf
    v_fmac_f32 v53, v130, v52
    v_pk_fma_f32 v[4:5], v[18:19], v[128:129], v[4:5] op_sel:[0,1,0] neg_lo:[1,0,0] neg_hi:[1,0,0]
    v_pk_fma_f32 v[20:21], v[2:3], v[128:129], v[20:21] op_sel:[0,1,0]
    v_fmac_f32_dpp v54, -v53, v131 row_ror:8 row_mask:0xf bank_mask:0xf
    v_fmac_f32 v54, v130, v53
    v_pk_fma_f32 v[6:7], v[4:5], v[128:129], v[6:7] op_sel_hi:[1,0,1]
    v_pk_fma_f32 v[22:23], v[20:21], v[128:129], v[22:23] op_sel_hi:[1,0,1]
    v_fmac_f32_dpp v55, -v54, v131 row_ror:8 row_mask:0xf bank_mask:0xf
    v_fmac_f32 v55, v130, v54
    v_pk_fma_f32 v[6:7], v[20:21], v[128:129], v[6:7] op_sel:[0,1,0] neg_lo:[1,0,0] neg_hi:[1,0,0]
    v_pk_fma_f32 v[22:23], v[4:5], v[128:129], v[22:23] op_sel:[0,1,0]
    v_cvt_pk_bf16_f32 v108, v4, v5
    v_cvt_pk_bf16_f32 v109, v6, v7
    v_cvt_pk_bf16_f32 v110, -v20, -v21
    v_cvt_pk_bf16_f32 v111, -v22, -v23

    ds_write_b128 v56, v[108:111] offset:1024
    ds_read_b64_tr_b16 v[92:93], v58 offset:1024
    ds_read_b64_tr_b16 v[94:95], v59 offset:1024
    v_pk_fma_f32 v[8:9], v[6:7], v[128:129], v[8:9] op_sel_hi:[1,0,1]
    v_pk_fma_f32 v[24:25], v[22:23], v[128:129], v[24:25] op_sel_hi:[1,0,1]
    v_pk_fma_f32 v[8:9], v[22:23], v[128:129], v[8:9] op_sel:[0,1,0] neg_lo:[1,0,0] neg_hi:[1,0,0]
    v_pk_fma_f32 v[24:25], v[6:7], v[128:129], v[24:25] op_sel:[0,1,0]
    v_cvt_pk_bf16_f32 v112, v48, v49
    v_cvt_pk_bf16_f32 v113, v50, v51
    v_cvt_pk_bf16_f32 v114, v52, v53
    v_cvt_pk_bf16_f32 v115, v54, v55
    ds_write2st64_b32 v60, v112, v113 offset0:0 offset1:1
    ds_write2st64_b32 v60, v114, v115 offset0:2 offset1:3
    ds_read_b64_tr_b16 v[116:117], v61 offset:0
    ds_read_b64_tr_b16 v[118:119], v61 offset:128
    v_pk_fma_f32 v[10:11], v[8:9], v[128:129], v[10:11] op_sel_hi:[1,0,1]
    v_pk_fma_f32 v[26:27], v[24:25], v[128:129], v[26:27] op_sel_hi:[1,0,1]
    v_pk_fma_f32 v[10:11], v[24:25], v[128:129], v[10:11] op_sel:[0,1,0] neg_lo:[1,0,0] neg_hi:[1,0,0]
    v_pk_fma_f32 v[26:27], v[8:9], v[128:129], v[26:27] op_sel:[0,1,0]
    v_cvt_pk_bf16_f32 v104, v8, v9
    v_cvt_pk_bf16_f32 v105, v10, v11
    v_cvt_pk_bf16_f32 v106, -v24, -v25
    v_cvt_pk_bf16_f32 v107, -v26, -v27

    ds_write_b128 v56, v[104:107] offset:0
    ds_read_b64_tr_b16 v[96:97], v58 offset:0
    ds_read_b64_tr_b16 v[98:99], v59 offset:0
    s_waitcnt lgkmcnt(10)
    v_and_b32 v88, -2, v88
    v_and_b32 v90, -2, v90
    buffer_store_dwordx4 v[88:91], v153, s[64:67], s36 offen sc1
    v_pk_fma_f32 v[12:13], v[10:11], v[128:129], v[12:13] op_sel_hi:[1,0,1]
    v_pk_fma_f32 v[28:29], v[26:27], v[128:129], v[28:29] op_sel_hi:[1,0,1]
    v_pk_fma_f32 v[12:13], v[26:27], v[128:129], v[12:13] op_sel:[0,1,0] neg_lo:[1,0,0] neg_hi:[1,0,0]
    v_pk_fma_f32 v[28:29], v[10:11], v[128:129], v[28:29] op_sel:[0,1,0]
    v_pk_fma_f32 v[14:15], v[12:13], v[128:129], v[14:15] op_sel_hi:[1,0,1]
    v_pk_fma_f32 v[30:31], v[28:29], v[128:129], v[30:31] op_sel_hi:[1,0,1]
    v_pk_fma_f32 v[14:15], v[28:29], v[128:129], v[14:15] op_sel:[0,1,0] neg_lo:[1,0,0] neg_hi:[1,0,0]
    v_pk_fma_f32 v[30:31], v[12:13], v[128:129], v[30:31] op_sel:[0,1,0]
    v_cvt_pk_bf16_f32 v108, v12, v13
    v_cvt_pk_bf16_f32 v109, v14, v15
    v_cvt_pk_bf16_f32 v110, -v28, -v29
    v_cvt_pk_bf16_f32 v111, -v30, -v31

    ds_write_b128 v56, v[108:111] offset:1024
    ds_read_b64_tr_b16 v[100:101], v58 offset:1024
    ds_read_b64_tr_b16 v[102:103], v59 offset:1024
    s_waitcnt lgkmcnt(10)
    v_and_b32 v92, -2, v92
    v_and_b32 v94, -2, v94
    buffer_store_dwordx4 v[92:95], v153, s[64:67], s18 offen sc1
    s_waitcnt lgkmcnt(6)
    v_and_b32 v116, -2, v116
    v_and_b32 v118, -2, v118
    buffer_store_dwordx2 v[116:117], v62, s[64:67], s37 offen offset:0 sc1
    buffer_store_dwordx2 v[118:119], v62, s[64:67], s37 offen offset:512 sc1
    s_waitcnt lgkmcnt(3)
    v_and_b32 v96, -2, v96
    v_and_b32 v98, -2, v98
    buffer_store_dwordx4 v[96:99], v153, s[64:67], s19 offen sc1
    s_waitcnt lgkmcnt(0)
    v_and_b32 v100, -2, v100
    v_and_b32 v102, -2, v102
    buffer_store_dwordx4 v[100:103], v153, s[64:67], s20 offen sc1
    s_branch L_p2e1
Lh1c0r:
    s_sub_u32 s101, s101, 1
    s_cbranch_scc1 L_end
    buffer_load_dwordx4 v[40:43], v175, s[64:67], s23 offen offset:0 sc1
    buffer_load_dwordx4 v[44:47], v175, s[64:67], s23 offen offset:1024 sc1
    buffer_load_dwordx4 v[48:51], v175, s[64:67], s23 offen offset:2048 sc1
    buffer_load_dwordx4 v[120:123], v175, s[64:67], s22 offen offset:0 sc1
    buffer_load_dwordx4 v[80:83], v175, s[64:67], s25 offen offset:0 sc1
    buffer_load_dwordx4 v[116:119], v175, s[64:67], s28 offen offset:0 sc1
    buffer_load_dwordx4 v[64:67], v175, s[64:67], s31 offen offset:0 sc1
    s_waitcnt vmcnt(0)
    v_bitop3_b32 v169, v40, v42, v44 bitop3:254
    v_bitop3_b32 v169, v169, v46, v48 bitop3:254
    v_bitop3_b32 v169, v169, v50, 1 bitop3:168
    v_cmp_ne_u32 vcc, 0, v169
    s_cbranch_vccnz Lh1c0r
    s_branch Lh1c0
Lh1c1r:
    s_sub_u32 s101, s101, 1
    s_cbranch_scc1 L_end
    buffer_load_dwordx4 v[120:123], v175, s[64:67], s22 offen offset:0 sc1
    buffer_load_dwordx4 v[80:83], v175, s[64:67], s25 offen offset:0 sc1
    buffer_load_dwordx4 v[116:119], v175, s[64:67], s28 offen offset:0 sc1
    buffer_load_dwordx4 v[64:67], v175, s[64:67], s31 offen offset:0 sc1
    buffer_load_dwordx4 v[60:63], v175, s[64:67], s22 offen offset:1024 sc1
    buffer_load_dwordx4 v[68:71], v175, s[64:67], s25 offen offset:1024 sc1
    buffer_load_dwordx4 v[72:75], v175, s[64:67], s28 offen offset:1024 sc1
    buffer_load_dwordx4 v[76:79], v175, s[64:67], s31 offen offset:1024 sc1
    s_waitcnt vmcnt(0)
    v_bitop3_b32 v169, v120, v122, v80 bitop3:254
    v_bitop3_b32 v169, v169, v82, v116 bitop3:254
    v_bitop3_b32 v169, v169, v118, v64 bitop3:254
    v_bitop3_b32 v169, v169, v66, 1 bitop3:168
    v_cmp_ne_u32 vcc, 0, v169
    s_cbranch_vccnz Lh1c1r
    s_branch Lh1c1
Lh1c2r:
    s_sub_u32 s101, s101, 1
    s_cbranch_scc1 L_end
    buffer_load_dwordx4 v[60:63], v175, s[64:67], s22 offen offset:1024 sc1
    buffer_load_dwordx4 v[68:71], v175, s[64:67], s25 offen offset:1024 sc1
    buffer_load_dwordx4 v[72:75], v175, s[64:67], s28 offen offset:1024 sc1
    buffer_load_dwordx4 v[76:79], v175, s[64:67], s31 offen offset:1024 sc1
    buffer_load_dwordx4 v[84:87], v175, s[64:67], s22 offen offset:2048 sc1
    buffer_load_dwordx4 v[88:91], v175, s[64:67], s25 offen offset:2048 sc1
    buffer_load_dwordx4 v[92:95], v175, s[64:67], s28 offen offset:2048 sc1
    buffer_load_dwordx4 v[96:99], v175, s[64:67], s31 offen offset:2048 sc1
    buffer_load_dwordx4 v[100:103], v175, s[64:67], s22 offen offset:3072 sc1
    s_waitcnt vmcnt(0)
    v_bitop3_b32 v169, v60, v62, v68 bitop3:254
    v_bitop3_b32 v169, v169, v70, v72 bitop3:254
    v_bitop3_b32 v169, v169, v74, v76 bitop3:254
    v_bitop3_b32 v169, v169, v78, 1 bitop3:168
    v_cmp_ne_u32 vcc, 0, v169
    s_cbranch_vccnz Lh1c2r
    s_branch Lh1c2
Lh1c3r:
    s_sub_u32 s101, s101, 1
    s_cbranch_scc1 L_end
    buffer_load_dwordx4 v[84:87], v175, s[64:67], s22 offen offset:2048 sc1
    buffer_load_dwordx4 v[88:91], v175, s[64:67], s25 offen offset:2048 sc1
    buffer_load_dwordx4 v[92:95], v175, s[64:67], s28 offen offset:2048 sc1
    buffer_load_dwordx4 v[96:99], v175, s[64:67], s31 offen offset:2048 sc1
    buffer_load_dwordx4 v[100:103], v175, s[64:67], s22 offen offset:3072 sc1
    buffer_load_dwordx4 v[104:107], v175, s[64:67], s25 offen offset:3072 sc1
    buffer_load_dwordx4 v[108:111], v175, s[64:67], s28 offen offset:3072 sc1
    buffer_load_dwordx4 v[120:123], v175, s[64:67], s31 offen offset:3072 sc1
    buffer_load_dwordx4 v[80:83], v175, s[64:67], s26 offen offset:0 sc1
    buffer_load_dwordx4 v[116:119], v175, s[64:67], s26 offen offset:1024 sc1
    s_waitcnt vmcnt(0)
    v_bitop3_b32 v169, v84, v86, v88 bitop3:254
    v_bitop3_b32 v169, v169, v90, v92 bitop3:254
    v_bitop3_b32 v169, v169, v94, v96 bitop3:254
    v_bitop3_b32 v169, v169, v98, 1 bitop3:168
    v_cmp_ne_u32 vcc, 0, v169
    s_cbranch_vccnz Lh1c3r
    s_branch Lh1c3
Lh1c4r:
    s_sub_u32 s101, s101, 1
    s_cbranch_scc1 L_end
    buffer_load_dwordx4 v[100:103], v175, s[64:67], s22 offen offset:3072 sc1
    buffer_load_dwordx4 v[104:107], v175, s[64:67], s25 offen offset:3072 sc1
    buffer_load_dwordx4 v[108:111], v175, s[64:67], s28 offen offset:3072 sc1
    buffer_load_dwordx4 v[120:123], v175, s[64:67], s31 offen offset:3072 sc1
    buffer_load_dwordx4 v[80:83], v175, s[64:67], s26 offen offset:0 sc1
    buffer_load_dwordx4 v[116:119], v175, s[64:67], s26 offen offset:1024 sc1
    buffer_load_dwordx4 v[64:67], v175, s[64:67], s26 offen offset:2048 sc1
    buffer_load_dwordx4 v[60:63], v175, s[64:67], s26 offen offset:3072 sc1
    buffer_load_dwordx4 v[68:71], v175, s[64:67], s27 offen offset:0 sc1
    buffer_load_dwordx4 v[72:75], v175, s[64:67], s27 offen offset:1024 sc1
    buffer_load_dwordx4 v[76:79], v175, s[64:67], s29 offen offset:0 sc1
    s_waitcnt vmcnt(0)
    v_bitop3_b32 v169, v100, v102, v104 bitop3:254
    v_bitop3_b32 v169, v169, v106, v108 bitop3:254
    v_bitop3_b32 v169, v169, v110, v120 bitop3:254
    v_bitop3_b32 v169, v169, v122, 1 bitop3:168
    v_cmp_ne_u32 vcc, 0, v169
    s_cbranch_vccnz Lh1c4r
    s_branch Lh1c4
Lh1c5r:
    s_sub_u32 s101, s101, 1
    s_cbranch_scc1 L_end
    buffer_load_dwordx4 v[80:83], v175, s[64:67], s26 offen offset:0 sc1
    buffer_load_dwordx4 v[116:119], v175, s[64:67], s26 offen offset:1024 sc1
    buffer_load_dwordx4 v[64:67], v175, s[64:67], s26 offen offset:2048 sc1
    buffer_load_dwordx4 v[60:63], v175, s[64:67], s26 offen offset:3072 sc1
    buffer_load_dwordx4 v[68:71], v175, s[64:67], s27 offen offset:0 sc1
    buffer_load_dwordx4 v[72:75], v175, s[64:67], s27 offen offset:1024 sc1
    buffer_load_dwordx4 v[76:79], v175, s[64:67], s29 offen offset:0 sc1
    buffer_load_dwordx4 v[84:87], v175, s[64:67], s29 offen offset:1024 sc1
    buffer_load_dwordx4 v[88:91], v175, s[64:67], s29 offen offset:2048 sc1
    buffer_load_dwordx4 v[92:95], v175, s[64:67], s29 offen offset:3072 sc1
    buffer_load_dwordx4 v[96:99], v175, s[64:67], s30 offen offset:0 sc1
    buffer_load_dwordx4 v[100:103], v175, s[64:67], s30 offen offset:1024 sc1
    s_waitcnt vmcnt(0)
    v_bitop3_b32 v169, v80, v82, v116 bitop3:254
    v_bitop3_b32 v169, v169, v118, v64 bitop3:254
    v_bitop3_b32 v169, v169, v66, v60 bitop3:254
    v_bitop3_b32 v169, v169, v62, v68 bitop3:254
    v_bitop3_b32 v169, v169, v70, v72 bitop3:254
    v_bitop3_b32 v169, v169, v74, 1 bitop3:168
    v_cmp_ne_u32 vcc, 0, v169
    s_cbranch_vccnz Lh1c5r
    s_branch Lh1c5
Lh1c6r:
    s_sub_u32 s101, s101, 1
    s_cbranch_scc1 L_end
    buffer_load_dwordx4 v[76:79], v175, s[64:67], s29 offen offset:0 sc1
    buffer_load_dwordx4 v[84:87], v175, s[64:67], s29 offen offset:1024 sc1
    buffer_load_dwordx4 v[88:91], v175, s[64:67], s29 offen offset:2048 sc1
    buffer_load_dwordx4 v[92:95], v175, s[64:67], s29 offen offset:3072 sc1
    buffer_load_dwordx4 v[96:99], v175, s[64:67], s30 offen offset:0 sc1
    buffer_load_dwordx4 v[100:103], v175, s[64:67], s30 offen offset:1024 sc1
    buffer_load_dwordx4 v[104:107], v175, s[64:67], s32 offen offset:0 sc1
    buffer_load_dwordx4 v[108:111], v175, s[64:67], s32 offen offset:1024 sc1
    buffer_load_dwordx4 v[120:123], v175, s[64:67], s32 offen offset:2048 sc1
    buffer_load_dwordx4 v[80:83], v175, s[64:67], s32 offen offset:3072 sc1
    buffer_load_dwordx4 v[116:119], v175, s[64:67], s33 offen offset:0 sc1
    s_waitcnt vmcnt(0)
    v_bitop3_b32 v169, v76, v78, v84 bitop3:254
    v_bitop3_b32 v169, v169, v86, v88 bitop3:254
    v_bitop3_b32 v169, v169, v90, v92 bitop3:254
    v_bitop3_b32 v169, v169, v94, v96 bitop3:254
    v_bitop3_b32 v169, v169, v98, v100 bitop3:254
    v_bitop3_b32 v169, v169, v102, 1 bitop3:168
    v_cmp_ne_u32 vcc, 0, v169
    s_cbranch_vccnz Lh1c6r
    s_branch Lh1c6
Lh1c7r:
    s_sub_u32 s101, s101, 1
    s_cbranch_scc1 L_end
    buffer_load_dwordx4 v[104:107], v175, s[64:67], s32 offen offset:0 sc1
    buffer_load_dwordx4 v[108:111], v175, s[64:67], s32 offen offset:1024 sc1
    buffer_load_dwordx4 v[120:123], v175, s[64:67], s32 offen offset:2048 sc1
    buffer_load_dwordx4 v[80:83], v175, s[64:67], s32 offen offset:3072 sc1
    buffer_load_dwordx4 v[116:119], v175, s[64:67], s33 offen offset:0 sc1
    buffer_load_dwordx4 v[64:67], v175, s[64:67], s33 offen offset:1024 sc1
    buffer_load_dwordx4 v[60:63], v175, s[64:67], s23 offen offset:3072 sc1
    buffer_load_dwordx4 v[68:71], v175, s[64:67], s24 offen offset:0 sc1
    buffer_load_dwordx4 v[72:75], v175, s[64:67], s24 offen offset:1024 sc1
    s_waitcnt vmcnt(0)
    v_bitop3_b32 v169, v104, v106, v108 bitop3:254
    v_bitop3_b32 v169, v169, v110, v120 bitop3:254
    v_bitop3_b32 v169, v169, v122, v80 bitop3:254
    v_bitop3_b32 v169, v169, v82, v116 bitop3:254
    v_bitop3_b32 v169, v169, v118, v64 bitop3:254
    v_bitop3_b32 v169, v169, v66, 1 bitop3:168
    v_cmp_ne_u32 vcc, 0, v169
    s_cbranch_vccnz Lh1c7r
    s_branch Lh1c7
Lh1c8r:
    s_sub_u32 s101, s101, 1
    s_cbranch_scc1 L_end
    buffer_load_dwordx4 v[60:63], v175, s[64:67], s23 offen offset:3072 sc1
    buffer_load_dwordx4 v[68:71], v175, s[64:67], s24 offen offset:0 sc1
    buffer_load_dwordx4 v[72:75], v175, s[64:67], s24 offen offset:1024 sc1
    s_waitcnt vmcnt(0)
    v_bitop3_b32 v169, v60, v62, v68 bitop3:254
    v_bitop3_b32 v169, v169, v70, v72 bitop3:254
    v_bitop3_b32 v169, v169, v74, 1 bitop3:168
    v_cmp_ne_u32 vcc, 0, v169
    s_cbranch_vccnz Lh1c8r
    s_branch Lh1c8
Lss_15:
    global_store_dwordx2 v155, v[0:1], s[98:99] sc1
    s_branch Lsd_16
L_last:
    s_endpgm
.section .rodata,"a"
.p2align 6
.amdhsa_kernel interleave_layers__ssm_conv_s5__ssm_conv_h3__prompt_kernel
  .amdhsa_next_free_vgpr 512
  .amdhsa_next_free_sgpr 102
  .amdhsa_accum_offset 256
  .amdhsa_group_segment_fixed_size 0
  .amdhsa_kernarg_size 144
  .amdhsa_user_sgpr_count 2
  .amdhsa_user_sgpr_kernarg_segment_ptr 1
  .amdhsa_system_sgpr_workgroup_id_x 1
.end_amdhsa_kernel
```

```asm
; @launch grid=(256,1,1) block=(256,1,1) lds=163840
.amdgcn_target "amdgcn-amd-amdhsa--gfx950"
.text
.globl interleave_layers__ssm_conv_s5__ssm_conv_h3__prompt_kernel
.p2align 8
.type interleave_layers__ssm_conv_s5__ssm_conv_h3__prompt_kernel,@function
interleave_layers__ssm_conv_s5__ssm_conv_h3__prompt_kernel:
    s_cmp_gt_u32 s2, 255
    s_cbranch_scc1 L_end
    s_load_dwordx16 s[32:47], s[0:1], 64
    s_load_dwordx16 s[16:31], s[0:1], 0
    s_load_dwordx4 s[48:51], s[0:1], 128
    s_memrealtime s[6:7]
    v_and_b32 v152, 63, v0
    v_lshrrev_b32 v1, 6, v0
    s_and_b32 s8, s2, 7
    s_lshr_b32 s9, s2, 3
    v_readfirstlane_b32 s77, v1
    s_getpc_b64 s[4:5]
L_pc:
    s_lshl_b32 s3, s9, 2
    s_add_u32 s3, s3, s77
    s_lshl_b32 s3, s3, 9
    v_and_b32 v2, 3, v152
    v_lshl_add_u32 v2, v2, 7, s3
    v_min_u32 v2, L_last-L_pc, v2
    global_load_dword a255, v2, s[4:5]
    s_and_b32 s78, s9, 7
    s_lshr_b32 s10, s9, 3
    s_lshl_b32 s79, s10, 3
    s_add_u32 s79, s79, s8
    v_mov_b32 v174, 0
    s_and_b32 s10, s10, 2
    s_add_u32 s10, s10, s8
    s_add_u32 s10, s10, s78
    s_mov_b32 s12, s10
    v_lshrrev_b32 v12, 3, v152
    v_and_b32 v13, 7, v152
    v_mul_u32_u24 v158, 1280, v12
    v_lshl_add_u32 v14, v13, 4, v158
    s_mul_i32 s5, s79, 81920
    s_lshl_b32 s4, s78, 7
    s_add_u32 s4, s4, s5
    s_mul_i32 s3, s77, 20480
    s_add_u32 s3, s3, s4
    v_add_u32 v70, s3, v14
    s_mul_i32 s8, s77, 4128
    s_mov_b32 s66, 2621440
    s_mov_b32 s67, 0x20000
    s_add_u32 s70, s66, 1024
    s_mov_b32 s71, s67
    v_lshrrev_b32 v145, 1, v0
    v_min_u32 v145, 79, v145
    s_mul_i32 s13, s78, 160
    v_lshl_add_u32 v147, v145, 1, s13
    s_waitcnt lgkmcnt(0)
    s_mov_b64 s[64:65], s[36:37]
    s_sub_u32 s68, s38, 1024
    s_subb_u32 s69, s39, 0
    global_load_ushort v142, v147, s[18:19]
    global_load_ushort v143, v147, s[20:21]
    global_load_ushort v146, v147, s[32:33]
    global_load_ushort v144, v147, s[30:31]
    s_add_u32 m0, s8, 56336
    s_movk_i32 s83, 0
    buffer_load_dwordx4 v70, s[64:67], s83 offen nt lds
    buffer_load_dwordx4 v70, s[68:71], s83 offen offset:1024 nt lds
    s_add_u32 m0, s8, 58400
    s_movk_i32 s83, 10240
    buffer_load_dwordx4 v70, s[64:67], s83 offen nt lds
    buffer_load_dwordx4 v70, s[68:71], s83 offen offset:1024 nt lds
    s_sub_u32 s4, s4, 10240
    v_add_u32 v14, s4, v14
    v_lshrrev_b32 v15, 1, v152
    v_mul_u32_u24 v15, 1280, v15
    v_and_b32 v72, 1, v152
    v_lshl_add_u32 v15, v72, 4, v15
    s_mul_i32 s4, s78, 96
    s_sub_u32 s3, s3, s4
    s_add_u32 s3, s3, 2048
    v_add_u32 v72, s3, v15
    v_cmp_gt_u32 vcc, 40, v152
    v_subrev_u32 v71, 6144, v72
    s_mul_i32 s9, s77, 1536
    v_cndmask_b32 v71, v14, v71, vcc
    s_sub_u32 s9, 54272, s9
    v_lshlrev_b32 v153, 4, v152
    s_movk_i32 s3, 160
    v_cmp_gt_u32 s[96:97], s3, v0
    s_lshl_b32 s3, s78, 9
    v_add_u32 v16, s3, v153
    s_mul_i32 s3, s78, 384
    s_sub_u32 s3, 3584, s3
    v_lshrrev_b32 v17, 5, v152
    v_mad_u32_u24 v16, v17, s3, v16
    s_mul_i32 s13, s12, 52
    s_lshr_b32 s13, s13, 8
    s_mul_i32 s13, s13, 5
    s_sub_u32 s72, s12, s13
    s_mov_b32 m0, s9
    s_nop 0
    buffer_load_dwordx4 v71, s[64:67], 0 offen nt lds
    s_sub_u32 m0, s9, 512
    s_mov_b32 exec_hi, 0
    buffer_load_dwordx4 v72, s[68:71], 0 offen nt lds
    s_mov_b32 m0, 94016
    s_mov_b32 exec_hi, 0xff
    global_load_lds_dwordx4 v16, s[40:41]
    s_mov_b32 exec_hi, -1
    s_or_b32 s3, s2, s77
    s_cmp_lg_u32 s3, 0
    s_cbranch_scc1 L_par
    s_or_b32 s6, s6, 7
    v_mov_b32 v2, 0
    v_mov_b32 v3, s6
    global_store_dword v2, v3, s[48:49] sc1
L_par:
    s_and_b32 s80, s77, 1
    s_lshr_b32 s81, s77, 1
    s_lshl_b32 s84, s77, 14
    s_add_u32 s84, s84, 98304
    s_lshl_b32 s72, s72, 7
    s_mul_i32 s85, s81, 640
    s_sub_u32 s90, 640, s85
    s_lshl_b32 s100, s77, 11
    v_lshrrev_b32 v11, 4, v152
    v_xor_b32 v14, v13, v11
    v_lshlrev_b32 v14, 4, v14
    s_mul_i32 s3, s78, 102400
    s_mul_i32 s4, s77, 20480
    s_add_u32 s3, s3, s4
    v_add3_u32 v158, v158, v14, s3
    v_xor_b32 v159, 64, v158
    v_add_u32 v159, 9216, v159
    s_mov_b64 s[56:57], s[22:23]
    s_mov_b32 s58, 819200
    s_mov_b32 s59, 0x20000
    s_mov_b64 s[60:61], s[24:25]
    s_mov_b32 s62, 819200
    s_mov_b32 s63, 0x20000
    s_sub_u32 s4, 81920, s4
    s_cmp_eq_u32 s80, 0
    s_cselect_b32 s92, s22, s24
    s_cselect_b32 s93, s23, s25
    s_add_u32 s92, s92, s4
    s_addc_u32 s93, s93, 0
    s_sub_u32 s94, 819200, s4
    s_mov_b32 s95, 0x20000
    v_lshrrev_b32 v15, 5, v152
    v_mul_u32_u24 v164, 20480, v15
    v_bfe_u32 v15, v152, 3, 1
    s_movk_i32 s3, 10240
    v_mad_u32_u24 v164, v15, s3, v164
    v_and_b32 v15, 1, v11
    s_movk_i32 s3, 1280
    v_mad_u32_u24 v164, v15, s3, v164
    s_mul_i32 s4, s77, 2560
    s_add_u32 s5, s5, s4
    v_add3_u32 v164, v164, v14, s5
    v_xor_b32 v165, 64, v164
    v_add_u32 v165, 39936, v165
    s_mov_b64 s[52:53], s[16:17]
    s_mov_b32 s54, 2621440
    s_mov_b32 s55, 0x20000
    s_mul_i32 s3, s2, 3200
    s_mul_i32 s4, s77, 7
    v_min_u32 v112, 6, v152
    v_add_u32 v112, s4, v112
    v_min_u32 v112, 24, v112
    v_lshl_add_u32 v112, v112, 7, s3
    s_mul_i32 s3, s78, 10240
    s_add_u32 s3, s3, s5
    v_min_u32 v113, 19, v152
    v_lshl_add_u32 v113, v113, 7, s3
    s_lshl_b32 s4, s78, 6
    s_lshl_b32 s3, s79, 1
    global_load_dword a255, v112, s[22:23]
    s_add_u32 s3, s3, s4
    s_and_b32 s5, s79, 15
    s_lshl_b32 s4, s78, 4
    s_add_u32 s4, s4, s5
    global_load_dword a255, v112, s[24:25]
    s_add_u32 s4, s4, 512
    s_lshl_b32 s14, s3, 12
    s_lshl_b32 s15, s4, 12
    s_lshl_b32 s3, s3, 1
    global_load_dword a255, v113, s[16:17]
    s_lshl_b32 s4, s4, 1
    s_andn2_b32 s4, s4, 3
    s_load_dword s34, s[44:45], s3
    s_load_dword s35, s[44:45], s4
    s_lshl_b32 s5, s77, 10
    s_sub_u32 s5, s5, 4
    s_max_i32 s5, s5, 0
    s_add_u32 s3, s5, s14
    s_load_dword s30, s[42:43], s3
    s_add_u32 s3, s3, 4096
    s_load_dword s31, s[42:43], s3
    s_add_u32 s3, s5, s15
    s_load_dword s32, s[42:43], s3
    s_lshl_b32 s12, s77, 10
    v_add_u32 v243, s12, v153
    s_add_u32 s73, s72, 128
    s_cmp_eq_u32 s73, 640
    s_cselect_b32 s73, 0, s73
    s_add_u32 s74, s73, 128
    s_cmp_eq_u32 s74, 640
    s_cselect_b32 s74, 0, s74
    s_add_u32 s75, s74, 128
    s_cmp_eq_u32 s75, 640
    s_cselect_b32 s75, 0, s75
    s_add_u32 s76, s75, 128
    s_cmp_eq_u32 s76, 640
    s_cselect_b32 s76, 0, s76
    v_and_b32 v10, 15, v152
    v_lshrrev_b32 v14, 1, v10
    v_xor_b32 v14, v14, v11
    v_lshlrev_b32 v14, 4, v14
    v_lshl_add_u32 v14, v10, 7, v14
    v_add_u32 v156, s84, v14
    v_xor_b32 v157, 64, v156
    s_lshl_b32 s3, s81, 13
    v_add_u32 v120, s3, v14
    v_xor_b32 v121, 64, v120
    v_xor_b32 v122, 0x2000, v120
    v_xor_b32 v123, 0x2000, v121
    s_getreg_b32 s89, hwreg(HW_REG_XCC_ID, 0, 3)
    s_mov_b32 s101, 0x20000
    s_mov_b32 s86, 0xffff0000
    s_mov_b32 s87, 0x3f803f80
    v_mov_b32 v116, s87
    v_mov_b32 v117, s87
    v_mov_b32 v118, s87
    v_mov_b32 v119, s87
    v_mov_b32 v224, 0
    v_add_u32 v124, s100, v14
    v_xor_b32 v125, 64, v124
    v_lshrrev_b32 v226, 3, v152
    v_and_b32 v221, 7, v152
    s_lshl_b32 s3, s77, 5
    s_add_u32 s3, s3, 56336
    v_lshl_add_u32 v64, v226, 2, s3
    s_movk_i32 s3, 2064
    v_mad_u32_u24 v64, v221, s3, v64
    v_subrev_u32 v65, 1424, v64
    v_add_u32 v66, 1024, v64
    s_sub_u32 s3, s9, 512
    v_lshl_add_u32 v75, v221, 2, s3
    v_lshl_add_u32 v75, v226, 6, v75
    s_lshl_b32 s4, s78, 2
    s_add_u32 s4, s4, s77
    s_lshl_b32 s3, s4, 16
    s_lshl_b32 s5, s79, 7
    s_add_u32 s3, s3, s5
    s_add_u32 s3, s3, 2048
    v_lshl_add_u32 v76, v226, 13, s3
    v_lshl_add_u32 v76, v221, 4, v76
    s_lshl_b32 s4, s4, 14
    s_add_u32 s4, s4, s5
    s_add_u32 s4, s4, 2097152
    v_lshrrev_b32 v229, 4, v152
    v_lshl_add_u32 v229, v229, 12, s4
    v_and_b32 v228, 15, v152
    v_lshl_add_u32 v229, v228, 3, v229
    s_lshl_b32 s3, s77, 9
    s_add_u32 s3, s3, 79872
    v_lshl_add_u32 v228, v152, 3, s3
    s_lshl_b32 s3, s77, 7
    s_add_u32 s3, s3, 94016
    v_lshl_add_u32 v73, v226, 4, s3
    s_mov_b32 s3, 94528
    v_lshl_add_u32 v74, v221, 4, s3
    v_xor_b32 v226, 3, v226
    s_lshl_b32 s3, s77, 5
    s_add_u32 s3, s3, 79872
    v_lshl_add_u32 v77, v226, 2, s3
    v_lshl_add_u32 v77, v221, 8, v77
    s_lshl_b32 s3, s78, 9
    s_add_u32 s3, s3, 11534336
    v_lshl_add_u32 v168, v152, 3, s3
    s_lshl_b32 s4, s79, 4
    s_add_u32 s3, s3, s4
    s_add_u32 s4, s4, 11534336
    v_and_b32 v169, 7, v152
    v_lshl_add_u32 v169, v169, 9, s4
    s_lshl_b32 s4, s77, 2
    s_add_u32 s3, s3, s4
    v_mov_b32 v223, s3
    s_waitcnt vmcnt(10)
    v_lshlrev_b32 v178, 16, v144
    v_lshlrev_b32 v176, 16, v142
    v_mul_f32 v178, 0x3fb8aa3b, v178
    s_mov_b32 m0, s100
    s_mov_b32 s83, s72
    buffer_load_dwordx4 v164, s[52:55], s83 offen lds
    v_lshlrev_b32 v177, 16, v143
    v_exp_f32 v178, v178
    v_mul_f32 v185, v176, v176
    v_fmac_f32 v185, v177, v177
    v_cvt_pk_bf16_f32 v178, 0, v178
    v_rcp_f32 v185, v185
    v_mul_f32 v179, v178, v176
    v_mul_f32 v180, v178, v177
    v_mul_f32 v179, 0x3fb8aa3b, v179
    v_mul_f32 v180, 0x3e22f983, v180
    v_and_b32 v188, 1, v152
    v_cmp_eq_u32 vcc, 1, v188
    v_mov_b32 v189, 0x44000000
    v_mov_b32 v181, 0x41000000
    v_mov_b32 v198, 0x42800000
    v_mov_b32 v199, 0x41800000
    v_cndmask_b32 v189, v189, v181, vcc
    v_cndmask_b32 v198, v198, v199, vcc
    v_mul_f32 v184, 1.0, v179
    v_mul_f32 v183, 1.0, v180
    v_exp_f32 v184, v184
    buffer_load_dwordx4 v165, s[52:55], s83 offen offset:1024 lds
    v_fract_f32 v183, v183
    v_cos_f32 v182, v183
    v_sin_f32 v183, v183
    v_mul_f32 v182, v184, v182
    v_mul_f32 v183, v184, v183
    v_mul_f32 v192, v189, v179
    v_mul_f32 v191, v189, v180
    v_exp_f32 v192, v192
    v_fract_f32 v191, v191
    v_cos_f32 v190, v191
    v_sin_f32 v191, v191
    v_mul_f32 v190, v192, v190
    v_mul_f32 v191, v192, v191
    v_add_f32 v185, v185, v185
    v_add_f32 v184, -1.0, v182
    v_mul_f32 v186, v184, v176
    v_mul_f32 v187, v183, v176
    v_fmac_f32 v186, v183, v177
    v_fma_f32 v187, -v184, v177, v187
    v_mul_f32 v186, v186, v185
    v_mul_f32 v187, v187, v185
    s_add_u32 m0, s100, 8192
    s_add_u32 s83, s72, 640
    buffer_load_dwordx4 v164, s[52:55], s83 offen lds
    v_cndmask_b32 v186, 1.0, v186, vcc
    v_cndmask_b32 v187, 0, v187, vcc
    v_cndmask_b32 v182, v182, v190, vcc
    v_cndmask_b32 v183, v183, v191, vcc
    v_mul_u32_u24 v188, 640, v188
    v_lshlrev_b32 v181, 3, v145
    v_add_u32 v181, 81920, v181
    v_add_u32 v189, v181, v188
    s_mov_b64 exec, s[96:97]
    ds_write_b64 v189, v[182:183] offset:7680
    s_mov_b64 exec, -1
    v_sub_u32 v189, v181, v188
    v_lshlrev_b32 v188, 3, v188
    v_sub_u32 v188, v181, v188
    s_mov_b64 exec, s[96:97]
    ds_write_b64 v188, v[186:187] offset:5120
    s_mov_b64 exec, -1
    v_mul_f32 v196, v198, v179
    v_mul_f32 v195, v198, v180
    v_exp_f32 v196, v196
    v_fract_f32 v195, v195
    v_cos_f32 v194, v195
    v_sin_f32 v195, v195
    buffer_load_dwordx4 v165, s[52:55], s83 offen offset:1024 lds
    v_mul_f32 v194, v196, v194
    v_mul_f32 v195, v196, v195
    s_mov_b64 exec, s[96:97]
    ds_write_b64 v189, v[194:195] offset:9600
    s_mov_b64 exec, -1
    v_pk_mul_f32 v[200:201], v[186:187], v[190:191] op_sel_hi:[1,0]
    v_pk_fma_f32 v[200:201], v[186:187], v[190:191], v[200:201] op_sel:[1,1,0] op_sel_hi:[0,1,1] neg_lo:[1,0,0]
    s_mov_b64 exec, s[96:97]
    ds_write_b64 v188, v[200:201] offset:5760
    s_mov_b64 exec, -1
    v_pk_mul_f32 v[186:187], v[200:201], v[190:191] op_sel_hi:[1,0]
    v_pk_fma_f32 v[186:187], v[200:201], v[190:191], v[186:187] op_sel:[1,1,0] op_sel_hi:[0,1,1] neg_lo:[1,0,0]
    s_mov_b64 exec, s[96:97]
    ds_write_b64 v188, v[186:187] offset:6400
    s_mov_b64 exec, -1
    v_pk_mul_f32 v[200:201], v[186:187], v[190:191] op_sel_hi:[1,0]
    v_pk_fma_f32 v[200:201], v[186:187], v[190:191], v[200:201] op_sel:[1,1,0] op_sel_hi:[0,1,1] neg_lo:[1,0,0]
    s_mov_b64 exec, s[96:97]
    ds_write_b64 v188, v[200:201] offset:7040
    s_mov_b64 exec, -1
    v_pk_mul_f32 v[186:187], v[200:201], v[190:191] op_sel_hi:[1,0]
    v_pk_fma_f32 v[186:187], v[200:201], v[190:191], v[186:187] op_sel:[1,1,0] op_sel_hi:[0,1,1] neg_lo:[1,0,0]
    s_and_b64 s[96:97], s[96:97], vcc
    s_mov_b64 exec, s[96:97]
    ds_write_b64 v188, v[186:187] offset:7680
    s_mov_b64 exec, -1
    v_pk_mul_f32 v[200:201], v[186:187], v[190:191] op_sel_hi:[1,0]
    v_pk_fma_f32 v[200:201], v[186:187], v[190:191], v[200:201] op_sel:[1,1,0] op_sel_hi:[0,1,1] neg_lo:[1,0,0]
    s_mov_b64 exec, s[96:97]
    ds_write_b64 v188, v[200:201] offset:8320
    s_mov_b64 exec, -1
    s_mov_b32 m0, s84
    s_add_u32 s83, s72, s85
    buffer_load_dwordx4 v158, s[56:59], s83 offen lds
    v_pk_mul_f32 v[186:187], v[200:201], v[190:191] op_sel_hi:[1,0]
    v_pk_fma_f32 v[186:187], v[200:201], v[190:191], v[186:187] op_sel:[1,1,0] op_sel_hi:[0,1,1] neg_lo:[1,0,0]
    s_mov_b64 exec, s[96:97]
    ds_write_b64 v188, v[186:187] offset:8960
    s_mov_b64 exec, -1
    v_pk_mul_f32 v[200:201], v[186:187], v[190:191] op_sel_hi:[1,0]
    v_pk_fma_f32 v[200:201], v[186:187], v[190:191], v[200:201] op_sel:[1,1,0] op_sel_hi:[0,1,1] neg_lo:[1,0,0]
    s_mov_b64 exec, s[96:97]
    ds_write_b64 v188, v[200:201] offset:9600
    s_mov_b64 exec, -1
    v_lshlrev_b32 v188, 2, v145
    v_add_u32 v188, 93696, v188
    v_lshlrev_b32 v189, 16, v146
    s_mov_b64 exec, s[96:97]
    ds_write_b32 v188, v189
    s_mov_b64 exec, -1
    v_and_b32 v230, 15, v152
    v_lshrrev_b32 v231, 1, v230
    s_lshr_b32 s3, s78, 2
    s_lshl_b32 s3, s3, 13
    s_add_u32 s3, s3, s100
    v_lshl_add_u32 v230, v230, 7, s3
    s_and_b32 s3, s78, 3
    s_mul_i32 s3, s3, 10
    s_lshr_b32 s4, s72, 4
    s_sub_u32 s3, s3, s4
    v_lshrrev_b32 v226, 4, v152
    v_add_u32 v128, s3, v226
    buffer_load_dwordx4 v159, s[56:59], s83 offen offset:1024 lds
    v_add_u32 v129, 4, v128
    s_add_u32 s3, s3, 8
    v_lshrrev_b32 v226, 5, v152
    v_add_u32 v130, s3, v226
    v_add_u32 v226, 40, v128
    v_min_u32 v128, v128, v226
    v_lshrrev_b32 v226, 3, v128
    v_lshl_add_u32 v226, v226, 14, v230
    v_and_b32 v128, 7, v128
    v_xor_b32 v128, v128, v231
    v_lshl_add_u32 v128, v128, 4, v226
    v_add_u32 v226, 40, v129
    v_min_u32 v129, v129, v226
    s_waitcnt vmcnt(9)
    s_waitcnt lgkmcnt(0)
    s_barrier
    ds_read2_b32 v[80:81], v75 offset0:136 offset1:144
    ds_read2_b32 v[82:83], v75 offset0:152 offset1:160
    ds_read_b32 v84, v75 offset:672
    ds_read2_b32 v[86:87], v75 offset0:0 offset1:8
    ds_read_b128 v[88:91], v74
    ds_read_b128 v[60:63], v73
    ds_read2_b32 v[40:41], v65 offset0:0 offset1:32
    s_add_u32 m0, s84, 2048
    s_add_u32 s83, s72, s85
    buffer_load_dwordx4 v158, s[60:63], s83 offen lds
    ds_read_b32 v42, v65 offset:256
    ds_read2_b32 v[44:45], v64 offset0:0 offset1:32
    ds_read2_b32 v[46:47], v64 offset0:64 offset1:96
    ds_read2_b32 v[48:49], v64 offset0:128 offset1:160
    ds_read2_b32 v[50:51], v64 offset0:192 offset1:224
    ds_read2_b32 v[52:53], v66 offset0:0 offset1:32
    ds_read2_b32 v[54:55], v66 offset0:64 offset1:96
    ds_read2_b32 v[56:57], v66 offset0:128 offset1:160
    ds_read2_b32 v[58:59], v66 offset0:192 offset1:224
    v_mov_b64 v[208:209], -1
    v_add_u32 v212, 3145728, v229
    v_mov_b64 v[210:211], -1
    v_add_u32 v213, 3145728, v76
    s_waitcnt lgkmcnt(11)
    v_lshlrev_b32 v22, 16, v88
    v_and_b32 v24, s86, v88
    v_lshlrev_b32 v26, 16, v89
    v_and_b32 v28, s86, v89
    v_lshlrev_b32 v23, 16, v90
    v_and_b32 v25, s86, v90
    v_lshlrev_b32 v27, 16, v91
    v_and_b32 v29, s86, v91
    v_lshlrev_b32 v0, 16, v80
    v_and_b32 v1, s86, v80
    buffer_load_dwordx4 v159, s[60:63], s83 offen offset:1024 lds
    v_lshlrev_b32 v2, 16, v81
    v_and_b32 v3, s86, v81
    v_lshlrev_b32 v4, 16, v82
    v_and_b32 v5, s86, v82
    v_lshlrev_b32 v6, 16, v83
    v_and_b32 v7, s86, v83
    v_lshlrev_b32 v8, 16, v84
    v_and_b32 v9, s86, v84
    v_pk_mul_f32 v[30:31], v[0:1], v[28:29]
    v_pk_mul_f32 v[32:33], v[2:3], v[28:29]
    v_pk_mul_f32 v[34:35], v[2:3], v[26:27]
    v_pk_mul_f32 v[36:37], v[4:5], v[26:27]
    v_cvt_pk_bf16_f32 v34, v30, v34
    v_cvt_pk_bf16_f32 v35, v31, v35
    v_cvt_pk_bf16_f32 v36, v32, v36
    v_cvt_pk_bf16_f32 v37, v33, v37
    v_dot2_f32_bf16 v30, v34, s87, 0
    v_dot2_f32_bf16 v31, v35, s87, 0
    v_dot2_f32_bf16 v32, v36, s87, 0
    v_dot2_f32_bf16 v33, v37, s87, 0
    v_pk_mul_f32 v[34:35], v[4:5], v[24:25]
    v_pk_mul_f32 v[36:37], v[6:7], v[24:25]
    v_cvt_pk_bf16_f32 v34, v30, v34
    v_cvt_pk_bf16_f32 v35, v31, v35
    s_add_u32 m0, s84, 4096
    s_add_u32 s83, s72, s85
    buffer_load_dwordx4 v158, s[92:95], s83 offen lds
    v_cvt_pk_bf16_f32 v36, v32, v36
    v_cvt_pk_bf16_f32 v37, v33, v37
    v_dot2_f32_bf16 v30, v34, s87, 0
    v_dot2_f32_bf16 v31, v35, s87, 0
    v_dot2_f32_bf16 v32, v36, s87, 0
    v_dot2_f32_bf16 v33, v37, s87, 0
    v_pk_mul_f32 v[34:35], v[6:7], v[22:23]
    v_pk_mul_f32 v[36:37], v[8:9], v[22:23]
    v_cvt_pk_bf16_f32 v34, v30, v34
    v_cvt_pk_bf16_f32 v35, v31, v35
    v_cvt_pk_bf16_f32 v36, v32, v36
    v_cvt_pk_bf16_f32 v37, v33, v37
    v_dot2_f32_bf16 v30, v34, s87, 0
    v_dot2_f32_bf16 v31, v35, s87, 0
    v_dot2_f32_bf16 v32, v36, s87, 0
    v_dot2_f32_bf16 v33, v37, s87, 0
    v_and_b32 v34, 0xffff, v86
    v_and_b32 v35, s86, v86
    v_and_b32 v36, 0xffff, v87
    v_and_b32 v37, s86, v87
    v_cvt_pk_bf16_f32 v38, v30, v31
    v_cvt_pk_bf16_f32 v39, v32, v33
    v_dot2_f32_bf16 v34, v38, v34, 0
    v_dot2_f32_bf16 v36, v39, v36, 0
    buffer_load_dwordx4 v159, s[92:95], s83 offen offset:1024 lds
    v_dot2_f32_bf16 v35, v38, v35, 0
    v_dot2_f32_bf16 v37, v39, v37, 0
    v_cvt_pk_bf16_f32 v68, v36, v34
    s_nop 1
    v_cvt_pk_bf16_f32 v69, v37, v35
    s_waitcnt lgkmcnt(0)
    ds_write2_b32 v77, v68, v69 offset1:32
    v_lshlrev_b32 v22, 16, v60
    v_and_b32 v24, s86, v60
    v_lshlrev_b32 v26, 16, v61
    v_and_b32 v28, s86, v61
    v_lshlrev_b32 v23, 16, v62
    v_and_b32 v25, s86, v62
    v_lshlrev_b32 v27, 16, v63
    v_and_b32 v29, s86, v63
    v_lshlrev_b32 v0, 16, v40
    v_and_b32 v1, s86, v40
    v_lshlrev_b32 v2, 16, v41
    v_and_b32 v3, s86, v41
    v_lshlrev_b32 v4, 16, v42
    v_and_b32 v5, s86, v42
    v_lshlrev_b32 v6, 16, v44
    v_and_b32 v7, s86, v44
    v_lshlrev_b32 v8, 16, v45
    v_and_b32 v9, s86, v45
    s_add_u32 m0, s84, 6144
    s_add_u32 s83, s72, s90
    buffer_load_dwordx4 v158, s[56:59], s83 offen lds
    v_lshlrev_b32 v10, 16, v46
    v_and_b32 v11, s86, v46
    v_lshlrev_b32 v12, 16, v47
    v_and_b32 v13, s86, v47
    v_lshlrev_b32 v14, 16, v48
    v_and_b32 v15, s86, v48
    v_lshlrev_b32 v16, 16, v49
    v_and_b32 v17, s86, v49
    v_lshlrev_b32 v18, 16, v50
    v_and_b32 v19, s86, v50
    v_lshlrev_b32 v20, 16, v51
    v_and_b32 v21, s86, v51
    v_pk_mul_f32 v[30:31], v[0:1], v[28:29]
    v_pk_mul_f32 v[32:33], v[2:3], v[28:29]
    v_pk_mul_f32 v[34:35], v[2:3], v[26:27]
    v_pk_mul_f32 v[36:37], v[4:5], v[26:27]
    v_cvt_pk_bf16_f32 v34, v30, v34
    v_cvt_pk_bf16_f32 v35, v31, v35
    v_cvt_pk_bf16_f32 v36, v32, v36
    v_cvt_pk_bf16_f32 v37, v33, v37
    v_dot2_f32_bf16 v30, v34, s87, 0
    v_dot2_f32_bf16 v31, v35, s87, 0
    v_dot2_f32_bf16 v32, v36, s87, 0
    v_dot2_f32_bf16 v33, v37, s87, 0
    buffer_load_dwordx4 v159, s[56:59], s83 offen offset:1024 lds
    v_pk_mul_f32 v[34:35], v[4:5], v[24:25]
    v_pk_mul_f32 v[36:37], v[6:7], v[24:25]
    v_cvt_pk_bf16_f32 v34, v30, v34
    v_cvt_pk_bf16_f32 v35, v31, v35
    v_cvt_pk_bf16_f32 v36, v32, v36
    v_cvt_pk_bf16_f32 v37, v33, v37
    v_dot2_f32_bf16 v30, v34, s87, 0
    v_dot2_f32_bf16 v31, v35, s87, 0
    v_dot2_f32_bf16 v32, v36, s87, 0
    v_dot2_f32_bf16 v33, v37, s87, 0
    v_pk_mul_f32 v[34:35], v[6:7], v[22:23]
    v_pk_mul_f32 v[36:37], v[8:9], v[22:23]
    v_cvt_pk_bf16_f32 v34, v30, v34
    v_cvt_pk_bf16_f32 v35, v31, v35
    v_cvt_pk_bf16_f32 v36, v32, v36
    v_cvt_pk_bf16_f32 v37, v33, v37
    v_dot2_f32_bf16 v30, v34, s87, 0
    v_dot2_f32_bf16 v31, v35, s87, 0
    v_dot2_f32_bf16 v32, v36, s87, 0
    v_dot2_f32_bf16 v33, v37, s87, 0
    v_and_b32 v34, 0xffff, v52
    v_and_b32 v35, s86, v52
    v_and_b32 v36, 0xffff, v53
    v_and_b32 v37, s86, v53
    s_add_u32 m0, s84, 8192
    s_add_u32 s83, s72, s90
    buffer_load_dwordx4 v158, s[60:63], s83 offen lds
    v_cvt_pk_bf16_f32 v38, v30, v31
    v_cvt_pk_bf16_f32 v39, v32, v33
    v_dot2_f32_bf16 v34, v38, v34, 0
    v_dot2_f32_bf16 v36, v39, v36, 0
    v_dot2_f32_bf16 v35, v38, v35, 0
    v_dot2_f32_bf16 v37, v39, v37, 0
    s_nop 0
    v_cvt_pk_bf16_f32 v107, v36, v34
    s_nop 0
    v_cvt_pk_bf16_f32 v111, v37, v35
    v_pk_mul_f32 v[30:31], v[4:5], v[28:29]
    v_pk_mul_f32 v[32:33], v[6:7], v[28:29]
    v_pk_mul_f32 v[34:35], v[6:7], v[26:27]
    v_pk_mul_f32 v[36:37], v[8:9], v[26:27]
    v_cvt_pk_bf16_f32 v34, v30, v34
    v_cvt_pk_bf16_f32 v35, v31, v35
    v_cvt_pk_bf16_f32 v36, v32, v36
    v_cvt_pk_bf16_f32 v37, v33, v37
    v_dot2_f32_bf16 v30, v34, s87, 0
    v_dot2_f32_bf16 v31, v35, s87, 0
    v_dot2_f32_bf16 v32, v36, s87, 0
    v_dot2_f32_bf16 v33, v37, s87, 0
    v_pk_mul_f32 v[34:35], v[8:9], v[24:25]
    v_pk_mul_f32 v[36:37], v[10:11], v[24:25]
    v_cvt_pk_bf16_f32 v34, v30, v34
    v_cvt_pk_bf16_f32 v35, v31, v35
    buffer_load_dwordx4 v159, s[60:63], s83 offen offset:1024 lds
    v_cvt_pk_bf16_f32 v36, v32, v36
    v_cvt_pk_bf16_f32 v37, v33, v37
    v_dot2_f32_bf16 v30, v34, s87, 0
    v_dot2_f32_bf16 v31, v35, s87, 0
    v_dot2_f32_bf16 v32, v36, s87, 0
    v_dot2_f32_bf16 v33, v37, s87, 0
    v_pk_mul_f32 v[34:35], v[10:11], v[22:23]
    v_pk_mul_f32 v[36:37], v[12:13], v[22:23]
    v_cvt_pk_bf16_f32 v34, v30, v34
    v_cvt_pk_bf16_f32 v35, v31, v35
    v_cvt_pk_bf16_f32 v36, v32, v36
    v_cvt_pk_bf16_f32 v37, v33, v37
    v_dot2_f32_bf16 v30, v34, s87, 0
    v_dot2_f32_bf16 v31, v35, s87, 0
    v_dot2_f32_bf16 v32, v36, s87, 0
    v_dot2_f32_bf16 v33, v37, s87, 0
    v_and_b32 v34, 0xffff, v54
    v_and_b32 v35, s86, v54
    v_and_b32 v36, 0xffff, v55
    v_and_b32 v37, s86, v55
    v_cvt_pk_bf16_f32 v38, v30, v31
    v_cvt_pk_bf16_f32 v39, v32, v33
    v_dot2_f32_bf16 v34, v38, v34, 0
    v_dot2_f32_bf16 v36, v39, v36, 0
    s_add_u32 m0, s100, 16384
    s_mov_b32 s83, s73
    buffer_load_dwordx4 v164, s[52:55], s83 offen lds
    v_dot2_f32_bf16 v35, v38, v35, 0
    v_dot2_f32_bf16 v37, v39, v37, 0
    v_cvt_pk_bf16_f32 v106, v36, v34
    s_nop 1
    v_cvt_pk_bf16_f32 v110, v37, v35
    v_pk_mul_f32 v[30:31], v[8:9], v[28:29]
    v_pk_mul_f32 v[32:33], v[10:11], v[28:29]
    v_pk_mul_f32 v[34:35], v[10:11], v[26:27]
    v_pk_mul_f32 v[36:37], v[12:13], v[26:27]
    v_cvt_pk_bf16_f32 v34, v30, v34
    v_cvt_pk_bf16_f32 v35, v31, v35
    v_cvt_pk_bf16_f32 v36, v32, v36
    v_cvt_pk_bf16_f32 v37, v33, v37
    v_dot2_f32_bf16 v30, v34, s87, 0
    v_dot2_f32_bf16 v31, v35, s87, 0
    v_dot2_f32_bf16 v32, v36, s87, 0
    v_dot2_f32_bf16 v33, v37, s87, 0
    v_pk_mul_f32 v[34:35], v[12:13], v[24:25]
    v_pk_mul_f32 v[36:37], v[14:15], v[24:25]
    v_cvt_pk_bf16_f32 v34, v30, v34
    v_cvt_pk_bf16_f32 v35, v31, v35
    v_cvt_pk_bf16_f32 v36, v32, v36
    v_cvt_pk_bf16_f32 v37, v33, v37
    v_dot2_f32_bf16 v30, v34, s87, 0
    v_dot2_f32_bf16 v31, v35, s87, 0
    buffer_load_dwordx4 v165, s[52:55], s83 offen offset:1024 lds
    v_dot2_f32_bf16 v32, v36, s87, 0
    v_dot2_f32_bf16 v33, v37, s87, 0
    v_pk_mul_f32 v[34:35], v[14:15], v[22:23]
    v_pk_mul_f32 v[36:37], v[16:17], v[22:23]
    v_cvt_pk_bf16_f32 v34, v30, v34
    v_cvt_pk_bf16_f32 v35, v31, v35
    v_cvt_pk_bf16_f32 v36, v32, v36
    v_cvt_pk_bf16_f32 v37, v33, v37
    v_dot2_f32_bf16 v30, v34, s87, 0
    v_dot2_f32_bf16 v31, v35, s87, 0
    v_dot2_f32_bf16 v32, v36, s87, 0
    v_dot2_f32_bf16 v33, v37, s87, 0
    v_and_b32 v34, 0xffff, v56
    v_and_b32 v35, s86, v56
    v_and_b32 v36, 0xffff, v57
    v_and_b32 v37, s86, v57
    v_cvt_pk_bf16_f32 v38, v30, v31
    v_cvt_pk_bf16_f32 v39, v32, v33
    v_dot2_f32_bf16 v34, v38, v34, 0
    v_dot2_f32_bf16 v36, v39, v36, 0
    v_dot2_f32_bf16 v35, v38, v35, 0
    v_dot2_f32_bf16 v37, v39, v37, 0
    s_nop 0
    v_cvt_pk_bf16_f32 v105, v36, v34
    s_nop 0
    v_cvt_pk_bf16_f32 v109, v37, v35
    s_add_u32 m0, s100, 24576
    s_add_u32 s83, s73, 640
    buffer_load_dwordx4 v164, s[52:55], s83 offen lds
    v_pk_mul_f32 v[30:31], v[12:13], v[28:29]
    v_pk_mul_f32 v[32:33], v[14:15], v[28:29]
    v_pk_mul_f32 v[34:35], v[14:15], v[26:27]
    v_pk_mul_f32 v[36:37], v[16:17], v[26:27]
    v_cvt_pk_bf16_f32 v34, v30, v34
    v_cvt_pk_bf16_f32 v35, v31, v35
    v_cvt_pk_bf16_f32 v36, v32, v36
    v_cvt_pk_bf16_f32 v37, v33, v37
    v_dot2_f32_bf16 v30, v34, s87, 0
    v_dot2_f32_bf16 v31, v35, s87, 0
    v_dot2_f32_bf16 v32, v36, s87, 0
    v_dot2_f32_bf16 v33, v37, s87, 0
    v_pk_mul_f32 v[34:35], v[16:17], v[24:25]
    v_pk_mul_f32 v[36:37], v[18:19], v[24:25]
    v_cvt_pk_bf16_f32 v34, v30, v34
    v_cvt_pk_bf16_f32 v35, v31, v35
    v_cvt_pk_bf16_f32 v36, v32, v36
    v_cvt_pk_bf16_f32 v37, v33, v37
    v_dot2_f32_bf16 v30, v34, s87, 0
    v_dot2_f32_bf16 v31, v35, s87, 0
    v_dot2_f32_bf16 v32, v36, s87, 0
    v_dot2_f32_bf16 v33, v37, s87, 0
    v_pk_mul_f32 v[34:35], v[18:19], v[22:23]
    v_pk_mul_f32 v[36:37], v[20:21], v[22:23]
    buffer_load_dwordx4 v165, s[52:55], s83 offen offset:1024 lds
    v_cvt_pk_bf16_f32 v34, v30, v34
    v_cvt_pk_bf16_f32 v35, v31, v35
    v_cvt_pk_bf16_f32 v36, v32, v36
    v_cvt_pk_bf16_f32 v37, v33, v37
    v_dot2_f32_bf16 v30, v34, s87, 0
    v_dot2_f32_bf16 v31, v35, s87, 0
    v_dot2_f32_bf16 v32, v36, s87, 0
    v_dot2_f32_bf16 v33, v37, s87, 0
    s_waitcnt vmcnt(12)
    ds_read_b128 a[0:3], v156 offset:0
    ds_read_b128 a[4:7], v157 offset:0
    v_and_b32 v34, 0xffff, v58
    v_and_b32 v35, s86, v58
    v_and_b32 v36, 0xffff, v59
    v_and_b32 v37, s86, v59
    s_waitcnt vmcnt(10)
    ds_read_b128 a[8:11], v156 offset:2048
    ds_read_b128 a[12:15], v157 offset:2048
    v_cvt_pk_bf16_f32 v38, v30, v31
    v_cvt_pk_bf16_f32 v39, v32, v33
    v_dot2_f32_bf16 v34, v38, v34, 0
    v_dot2_f32_bf16 v36, v39, v36, 0
    s_waitcnt vmcnt(8)
    ds_read_b128 a[16:19], v156 offset:4096
    ds_read_b128 a[20:23], v157 offset:4096
    v_dot2_f32_bf16 v35, v38, v35, 0
    v_dot2_f32_bf16 v37, v39, v37, 0
    v_cvt_pk_bf16_f32 v104, v36, v34
    s_nop 1
    v_cvt_pk_bf16_f32 v108, v37, v35
    global_store_dwordx4 v76, v[104:107], s[50:51] offset:-2048 sc1
    global_store_dwordx4 v76, v[108:111], s[50:51] offset:2048 sc1
    s_add_u32 m0, s84, 10240
    s_add_u32 s83, s73, s85
    buffer_load_dwordx4 v158, s[56:59], s83 offen lds
    s_waitcnt lgkmcnt(0)
    s_barrier
    ds_read_b128 v[60:63], v120 offset:0
    ds_read_b128 v[64:67], v120 offset:2048
    ds_read_b128 v[68:71], v120 offset:4096
    ds_read_b128 v[72:75], v120 offset:6144
    ds_read_b128 v[76:79], v121 offset:0
    ds_read_b128 v[80:83], v121 offset:2048
    ds_read_b128 v[84:87], v121 offset:4096
    ds_read_b128 v[88:91], v121 offset:6144
    s_waitcnt lgkmcnt(6)
    v_mfma_f32_16x16x32_bf16 v[176:179], v[60:63], a[0:3], 0
    v_lshrrev_b32 v226, 3, v129
    v_mfma_f32_16x16x32_bf16 v[192:195], v[60:63], a[8:11], 0
    v_lshl_add_u32 v226, v226, 14, v230
    v_mfma_f32_16x16x32_bf16 v[32:35], v[60:63], a[16:19], 0
    ds_read_b128 v[60:63], v122 offset:0
    v_and_b32 v129, 7, v129
    v_mfma_f32_16x16x32_bf16 v[48:51], v[116:119], a[0:3], 0
    ds_read_b64 v[170:171], v228
    v_xor_b32 v129, v129, v231
    v_mfma_f32_16x16x32_bf16 v[180:183], v[64:67], a[0:3], 0
    buffer_load_dwordx4 v159, s[56:59], s83 offen offset:1024 lds
    global_load_dword v224, v224, s[48:49] sc1
    v_lshl_add_u32 v129, v129, 4, v226
    v_mfma_f32_16x16x32_bf16 v[196:199], v[64:67], a[8:11], 0
    v_add_u32 v226, 40, v130
    v_min_u32 v130, v130, v226
    v_mfma_f32_16x16x32_bf16 v[36:39], v[64:67], a[16:19], 0
    ds_read_b128 v[64:67], v122 offset:2048
    v_lshrrev_b32 v226, 3, v130
    v_mfma_f32_16x16x32_bf16 v[52:55], v[116:119], a[8:11], 0
    s_add_u32 m0, s84, 12288
    s_add_u32 s83, s73, s85
    buffer_load_dwordx4 v158, s[60:63], s83 offen lds
    s_waitcnt lgkmcnt(7)
    v_mfma_f32_16x16x32_bf16 v[184:187], v[68:71], a[0:3], 0
    v_lshl_add_u32 v226, v226, 14, v230
    v_and_b32 v130, 7, v130
    v_mfma_f32_16x16x32_bf16 v[200:203], v[68:71], a[8:11], 0
    s_waitcnt lgkmcnt(1)
    global_store_dwordx2 v229, v[170:171], s[50:51] sc1
    v_mfma_f32_16x16x32_bf16 v[40:43], v[68:71], a[16:19], 0
    ds_read_b128 v[68:71], v122 offset:4096
    v_xor_b32 v130, v130, v231
    v_mfma_f32_16x16x32_bf16 v[56:59], v[116:119], a[16:19], 0
    buffer_load_dwordx4 v159, s[60:63], s83 offen offset:1024 lds
    v_lshl_add_u32 v130, v130, 4, v226
    v_mfma_f32_16x16x32_bf16 v[188:191], v[72:75], a[0:3], 0
    s_cmp_eq_u32 s77, 0
    s_cselect_b32 s30, 0, s30
    s_cselect_b32 s31, 0, s31
    s_cselect_b32 s32, 0, s32
    v_mfma_f32_16x16x32_bf16 v[204:207], v[72:75], a[8:11], 0
    v_bfe_u32 v226, v152, 4, 1
    v_lshl_add_u32 v130, v226, 3, v130
    v_mfma_f32_16x16x32_bf16 v[44:47], v[72:75], a[16:19], 0
    ds_read_b128 v[72:75], v122 offset:6144
    v_mfma_f32_16x16x32_bf16 v[176:179], v[76:79], a[4:7], v[176:179]
    s_add_u32 m0, s84, 14336
    s_add_u32 s83, s73, s85
    buffer_load_dwordx4 v158, s[92:95], s83 offen lds
    v_mfma_f32_16x16x32_bf16 v[192:195], v[76:79], a[12:15], v[192:195]
    ds_read_b128 v[92:95], v124 offset:0
    v_lshrrev_b32 v167, 4, v152
    s_mov_b32 s4, 93696
    v_mfma_f32_16x16x32_bf16 v[32:35], v[76:79], a[20:23], v[32:35]
    ds_read_b128 v[76:79], v123 offset:0
    ds_read_b128 v[96:99], v125 offset:0
    v_lshl_add_u32 v166, v167, 5, s4
    v_mfma_f32_16x16x32_bf16 v[48:51], v[116:119], a[4:7], v[48:51]
    ds_read_b128 v[100:103], v124 offset:8192
    v_lshl_add_u32 v167, v167, 4, s4
    s_lshl_b32 s3, s81, 12
    v_mfma_f32_16x16x32_bf16 v[180:183], v[80:83], a[4:7], v[180:183]
    buffer_load_dwordx4 v159, s[92:95], s83 offen offset:1024 lds
    s_add_u32 s3, s3, s14
    ds_read_b128 v[104:107], v125 offset:8192
    v_mfma_f32_16x16x32_bf16 v[196:199], v[80:83], a[12:15], v[196:199]
    s_add_u32 s3, s3, 3145728
    s_lshl_b32 s4, s80, 10
    v_mfma_f32_16x16x32_bf16 v[36:39], v[80:83], a[20:23], v[36:39]
    ds_read_b128 v[80:83], v123 offset:2048
    s_add_u32 s38, s3, s4
    v_mfma_f32_16x16x32_bf16 v[52:55], v[116:119], a[12:15], v[52:55]
    s_sub_u32 s39, s3, s4
    v_mfma_f32_16x16x32_bf16 v[184:187], v[84:87], a[4:7], v[184:187]
    s_add_u32 m0, s100, 32768
    s_mov_b32 s83, s74
    buffer_load_dwordx4 v164, s[52:55], s83 offen lds
    v_mfma_f32_16x16x32_bf16 v[200:203], v[84:87], a[12:15], v[200:203]
    s_add_u32 s39, s39, 3072
    s_lshr_b32 s13, s79, 4
    v_mfma_f32_16x16x32_bf16 v[40:43], v[84:87], a[20:23], v[40:43]
    ds_read_b128 v[84:87], v123 offset:4096
    s_sub_u32 s4, 3, s13
    v_mfma_f32_16x16x32_bf16 v[56:59], v[116:119], a[20:23], v[56:59]
    buffer_load_dwordx4 v165, s[52:55], s83 offen offset:1024 lds
    s_waitcnt lgkmcnt(4)
    v_mfma_f32_16x16x32_bf16 v[108:111], v[92:95], v[92:95], 0
    s_cmp_eq_u32 s81, 0
    s_cselect_b32 s3, s4, s13
    v_mfma_f32_16x16x32_bf16 v[232:235], v[116:119], v[92:95], 0
    s_waitcnt vmcnt(18)
    ds_read_b128 a[24:27], v156 offset:6144
    ds_read_b128 a[28:31], v157 offset:6144
    v_mfma_f32_16x16x32_bf16 v[188:191], v[88:91], a[4:7], v[188:191]
    s_waitcnt vmcnt(16)
    ds_read_b128 a[32:35], v156 offset:8192
    ds_read_b128 a[36:39], v157 offset:8192
    v_mfma_f32_16x16x32_bf16 v[204:207], v[88:91], a[12:15], v[204:207]
    s_add_u32 m0, s100, 40960
    s_add_u32 s83, s74, 640
    buffer_load_dwordx4 v164, s[52:55], s83 offen lds
    v_mfma_f32_16x16x32_bf16 v[44:47], v[88:91], a[20:23], v[44:47]
    ds_read_b128 v[88:91], v123 offset:6144
    s_lshl_b32 s3, s3, 1
    v_mfma_f32_16x16x32_bf16 v[108:111], v[96:99], v[96:99], v[108:111]
    s_add_u32 s3, s3, s80
    s_lshl_b32 s40, s3, 9
    v_mfma_f32_16x16x32_bf16 v[232:235], v[116:119], v[96:99], v[232:235]
    s_waitcnt lgkmcnt(3)
    v_mfma_f32_16x16x32_bf16 v[176:179], v[60:63], a[24:27], v[176:179]
    buffer_load_dwordx4 v165, s[52:55], s83 offen offset:1024 lds
    s_waitcnt lgkmcnt(1)
    v_mfma_f32_16x16x32_bf16 v[192:195], v[60:63], a[32:35], v[192:195]
    s_waitcnt vmcnt(14)
    s_barrier
    ds_read_b128 v[60:63], v120 offset:16384
    v_mfma_f32_16x16x32_bf16 v[48:51], v[116:119], a[24:27], v[48:51]
    v_bfe_u32 v230, v152, 1, 2
    v_and_b32 v227, 1, v152
    v_mfma_f32_16x16x32_bf16 v[108:111], v[100:103], v[100:103], v[108:111]
    v_lshlrev_b32 v230, 18, v230
    v_lshl_add_u32 v227, v227, 7, v230
    v_mfma_f32_16x16x32_bf16 v[232:235], v[116:119], v[100:103], v[232:235]
    s_mov_b32 m0, s84
    s_add_u32 s83, s73, s90
    buffer_load_dwordx4 v158, s[56:59], s83 offen lds
    v_mfma_f32_16x16x32_bf16 v[180:183], v[64:67], a[24:27], v[180:183]
    s_lshl_b32 s3, s79, 13
    s_add_u32 s3, s3, s100
    v_mfma_f32_16x16x32_bf16 v[196:199], v[64:67], a[32:35], v[196:199]
    ds_read_b128 v[64:67], v120 offset:18432
    global_store_dwordx2 v212, v[208:209], s[50:51] sc1
    v_mfma_f32_16x16x32_bf16 v[52:55], v[116:119], a[32:35], v[52:55]
    s_lshl_b32 s4, s78, 8
    s_add_u32 s3, s3, s4
    v_mfma_f32_16x16x32_bf16 v[108:111], v[104:107], v[104:107], v[108:111]
    buffer_load_dwordx4 v159, s[56:59], s83 offen offset:1024 lds
    s_add_u32 s3, s3, 10485760
    v_mfma_f32_16x16x32_bf16 v[232:235], v[116:119], v[104:107], v[232:235]
    v_add_u32 v227, s3, v227
    v_mfma_f32_16x16x32_bf16 v[184:187], v[68:71], a[24:27], v[184:187]
    s_lshl_b32 s91, s79, 3
    s_add_u32 s91, s91, s78
    v_mfma_f32_16x16x32_bf16 v[200:203], v[68:71], a[32:35], v[200:203]
    ds_read_b128 v[68:71], v120 offset:20480
    s_add_u32 m0, s84, 2048
    s_add_u32 s83, s73, s90
    buffer_load_dwordx4 v158, s[60:63], s83 offen lds
    ds_read_b128 v[92:95], v124 offset:16384
    v_mfma_f32_16x16x32_bf16 v[188:191], v[72:75], a[24:27], v[188:191]
    s_lshl_b32 s91, s91, 2
    s_add_u32 s91, s91, s77
    ds_read_b128 v[96:99], v125 offset:16384
    v_mfma_f32_16x16x32_bf16 v[204:207], v[72:75], a[32:35], v[204:207]
    ds_read_b128 v[72:75], v120 offset:22528
    ds_read_b128 v[100:103], v124 offset:24576
    v_mfma_f32_16x16x32_bf16 v[176:179], v[76:79], a[28:31], v[176:179]
    s_mul_i32 s3, s91, 5120
    s_add_u32 s3, s3, 2048
    ds_read_b128 v[104:107], v125 offset:24576
    v_mfma_f32_16x16x32_bf16 v[192:195], v[76:79], a[36:39], v[192:195]
    ds_read_b128 v[76:79], v121 offset:16384
    buffer_load_dwordx4 v159, s[60:63], s83 offen offset:1024 lds
    v_mfma_f32_16x16x32_bf16 v[48:51], v[116:119], a[28:31], v[48:51]
    v_min_u32 v242, 7, v152
    v_lshl_add_u32 v242, v242, 7, s3
    v_mfma_f32_16x16x32_bf16 v[180:183], v[80:83], a[28:31], v[180:183]
    v_and_b32 v225, 15, v152
    s_lshl_b32 s3, s77, 6
    v_mfma_f32_16x16x32_bf16 v[196:199], v[80:83], a[36:39], v[196:199]
    ds_read_b128 v[80:83], v121 offset:18432
    s_add_u32 s3, s3, 93440
    v_mfma_f32_16x16x32_bf16 v[52:55], v[116:119], a[36:39], v[52:55]
    s_add_u32 m0, s100, 49152
    s_mov_b32 s83, s75
    buffer_load_dwordx4 v164, s[52:55], s83 offen lds
    s_waitcnt lgkmcnt(10)
    v_mfma_f32_16x16x32_bf16 v[184:187], v[84:87], a[28:31], v[184:187]
    v_lshl_add_u32 v225, v225, 2, s3
    v_bfe_u32 v222, v152, 1, 2
    v_mfma_f32_16x16x32_bf16 v[200:203], v[84:87], a[36:39], v[200:203]
    ds_read_b128 v[84:87], v121 offset:20480
    global_store_dwordx4 v213, v[208:211], s[50:51] offset:-2048 sc1
    s_waitcnt lgkmcnt(6)
    v_mfma_f32_16x16x32_bf16 v[108:111], v[92:95], v[92:95], v[108:111]
    s_waitcnt vmcnt(17)
    ds_read_b128 a[40:43], v156 offset:10240
    ds_read_b128 a[44:47], v157 offset:10240
    v_mfma_f32_16x16x32_bf16 v[232:235], v[116:119], v[92:95], v[232:235]
    buffer_load_dwordx4 v165, s[52:55], s83 offen offset:1024 lds
    s_waitcnt vmcnt(14)
    ds_read_b128 a[48:51], v156 offset:12288
    ds_read_b128 a[52:55], v157 offset:12288
    v_mfma_f32_16x16x32_bf16 v[188:191], v[88:91], a[28:31], v[188:191]
    s_waitcnt vmcnt(12)
    ds_read_b128 a[56:59], v156 offset:14336
    ds_read_b128 a[60:63], v157 offset:14336
    v_mfma_f32_16x16x32_bf16 v[204:207], v[88:91], a[36:39], v[204:207]
    ds_read_b128 v[88:91], v121 offset:22528
    s_lshl_b32 s3, s77, 4
    v_mfma_f32_16x16x32_bf16 v[108:111], v[96:99], v[96:99], v[108:111]
    s_add_u32 s3, s3, 93440
    v_lshl_add_u32 v222, v222, 2, s3
    v_mfma_f32_16x16x32_bf16 v[232:235], v[116:119], v[96:99], v[232:235]
    s_add_u32 m0, s100, 57344
    s_add_u32 s83, s75, 640
    buffer_load_dwordx4 v164, s[52:55], s83 offen lds
    s_waitcnt lgkmcnt(5)
    v_mfma_f32_16x16x32_bf16 v[176:179], v[60:63], a[40:43], v[176:179]
    v_and_b32 v230, 8, v152
    s_waitcnt lgkmcnt(3)
    v_mfma_f32_16x16x32_bf16 v[192:195], v[60:63], a[48:51], v[192:195]
    v_lshl_add_u32 v222, v230, 3, v222
    s_waitcnt lgkmcnt(1)
    v_mfma_f32_16x16x32_bf16 v[32:35], v[60:63], a[56:59], v[32:35]
    ds_read_b128 v[60:63], v122 offset:16384
    buffer_load_dwordx4 v165, s[52:55], s83 offen offset:1024 lds
    v_mfma_f32_16x16x32_bf16 v[48:51], v[116:119], a[40:43], v[48:51]
    s_lshl_b32 s3, s77, 12
    v_and_b32 v220, 16, v152
    v_mfma_f32_16x16x32_bf16 v[108:111], v[100:103], v[100:103], v[108:111]
    v_lshlrev_b32 v220, 2, v220
    v_xor_b32 v220, v220, v153
    v_mfma_f32_16x16x32_bf16 v[232:235], v[116:119], v[100:103], v[232:235]
    v_add_u32 v220, s3, v220
    v_bfe_u32 v230, v152, 2, 2
    v_mfma_f32_16x16x32_bf16 v[180:183], v[64:67], a[40:43], v[180:183]
    s_add_u32 m0, s84, 4096
    s_add_u32 s83, s74, s85
    buffer_load_dwordx4 v158, s[56:59], s83 offen lds
    v_mfma_f32_16x16x32_bf16 v[196:199], v[64:67], a[48:51], v[196:199]
    s_lshl_b32 s3, s77, 4
    s_add_u32 s3, s3, 92160
    v_mfma_f32_16x16x32_bf16 v[36:39], v[64:67], a[56:59], v[36:39]
    ds_read_b128 v[64:67], v122 offset:18432
    global_store_dwordx4 v213, v[208:211], s[50:51] offset:2048 sc1
    v_mfma_f32_16x16x32_bf16 v[52:55], v[116:119], a[48:51], v[52:55]
    v_lshl_add_u32 v126, v230, 6, s3
    s_lshl_b32 s3, s77, 3
    v_mfma_f32_16x16x32_bf16 v[108:111], v[104:107], v[104:107], v[108:111]
    buffer_load_dwordx4 v159, s[56:59], s83 offen offset:1024 lds
    s_add_u32 s3, s3, 92672
    v_mfma_f32_16x16x32_bf16 v[232:235], v[116:119], v[104:107], v[232:235]
    v_lshl_add_u32 v127, v230, 6, s3
    v_mfma_f32_16x16x32_bf16 v[184:187], v[68:71], a[40:43], v[184:187]
    v_bfe_u32 v230, v152, 0, 2
    v_lshl_add_u32 v126, v230, 2, v126
    v_mfma_f32_16x16x32_bf16 v[200:203], v[68:71], a[48:51], v[200:203]
    v_bfe_u32 v230, v152, 0, 1
    v_lshl_add_u32 v127, v230, 5, v127
    v_mfma_f32_16x16x32_bf16 v[40:43], v[68:71], a[56:59], v[40:43]
    ds_read_b128 v[68:71], v122 offset:20480
    s_add_u32 m0, s84, 6144
    s_add_u32 s83, s74, s85
    buffer_load_dwordx4 v158, s[60:63], s83 offen lds
    v_mfma_f32_16x16x32_bf16 v[56:59], v[116:119], a[56:59], v[56:59]
    v_bfe_u32 v230, v152, 1, 1
    v_lshl_add_u32 v127, v230, 2, v127
    v_mfma_f32_16x16x32_bf16 v[188:191], v[72:75], a[40:43], v[188:191]
    v_and_b32 v230, 15, v152
    s_lshl_b32 s3, s77, 7
    v_mfma_f32_16x16x32_bf16 v[204:207], v[72:75], a[48:51], v[204:207]
    s_add_u32 s3, s3, 81920
    v_lshl_add_u32 v154, v230, 3, s3
    v_mfma_f32_16x16x32_bf16 v[44:47], v[72:75], a[56:59], v[44:47]
    ds_read_b128 v[72:75], v122 offset:22528
    buffer_load_dwordx4 v159, s[60:63], s83 offen offset:1024 lds
    v_mfma_f32_16x16x32_bf16 v[176:179], v[76:79], a[44:47], v[176:179]
    s_waitcnt vmcnt(15)
    v_bfe_u32 v155, v152, 1, 2
    s_lshl_b32 s3, s77, 5
    v_mfma_f32_16x16x32_bf16 v[192:195], v[76:79], a[52:55], v[192:195]
    s_add_u32 s3, s3, 82432
    ds_read_b128 v[92:95], v124 offset:32768
    v_lshl_add_u32 v155, v155, 3, s3
    v_mfma_f32_16x16x32_bf16 v[32:35], v[76:79], a[60:63], v[32:35]
    ds_read_b128 v[76:79], v123 offset:16384
    s_add_u32 m0, s84, 8192
    s_add_u32 s83, s74, s85
    buffer_load_dwordx4 v158, s[92:95], s83 offen lds
    ds_read_b128 v[96:99], v125 offset:32768
    v_mfma_f32_16x16x32_bf16 v[48:51], v[116:119], a[44:47], v[48:51]
    ds_read_b128 v[100:103], v124 offset:40960
    v_not_b32 v230, v152
    v_lshlrev_b32 v230, 28, v230
    v_mfma_f32_16x16x32_bf16 v[180:183], v[80:83], a[44:47], v[180:183]
    ds_read_b128 v[104:107], v125 offset:40960
    v_and_b32 v163, 0x80000000, v230
    v_lshrrev_b32 v230, 4, v152
    v_mfma_f32_16x16x32_bf16 v[196:199], v[80:83], a[52:55], v[196:199]
    s_mov_b32 s3, 92160
    v_lshl_add_u32 v216, v230, 6, s3
    v_mfma_f32_16x16x32_bf16 v[36:39], v[80:83], a[60:63], v[36:39]
    ds_read_b128 v[80:83], v123 offset:18432
    buffer_load_dwordx4 v159, s[92:95], s83 offen offset:1024 lds
    v_mfma_f32_16x16x32_bf16 v[52:55], v[116:119], a[52:55], v[52:55]
    v_and_b32 v218, 1, v152
    s_waitcnt lgkmcnt(10)
    v_mfma_f32_16x16x32_bf16 v[184:187], v[84:87], a[44:47], v[184:187]
    v_lshl_add_u32 v217, v218, 5, v216
    v_lshlrev_b32 v218, 2, v218
    v_mfma_f32_16x16x32_bf16 v[200:203], v[84:87], a[52:55], v[200:203]
    v_lshl_add_u32 v218, v230, 8, v218
    v_and_b32 v230, 1, v230
    v_mfma_f32_16x16x32_bf16 v[40:43], v[84:87], a[60:63], v[40:43]
    ds_read_b128 v[84:87], v123 offset:20480
    s_add_u32 m0, s100, 65536
    s_mov_b32 s83, s76
    buffer_load_dwordx4 v164, s[52:55], s83 offen lds
    v_mfma_f32_16x16x32_bf16 v[56:59], v[116:119], a[60:63], v[56:59]
    v_xor_b32 v230, s77, v230
    v_lshl_add_u32 v218, v230, 6, v218
    s_waitcnt lgkmcnt(4)
    v_mfma_f32_16x16x32_bf16 v[108:111], v[92:95], v[92:95], v[108:111]
    v_bfe_u32 v230, v152, 1, 2
    v_lshl_add_u32 v218, v230, 4, v218
    v_mfma_f32_16x16x32_bf16 v[232:235], v[116:119], v[92:95], v[232:235]
    s_waitcnt vmcnt(15)
    ds_read_b128 a[64:67], v156 offset:0
    ds_read_b128 a[68:71], v157 offset:0
    v_mfma_f32_16x16x32_bf16 v[188:191], v[88:91], a[44:47], v[188:191]
    buffer_load_dwordx4 v165, s[52:55], s83 offen offset:1024 lds
    s_waitcnt vmcnt(14)
    ds_read_b128 a[72:75], v156 offset:2048
    ds_read_b128 a[76:79], v157 offset:2048
    v_mfma_f32_16x16x32_bf16 v[204:207], v[88:91], a[52:55], v[204:207]
    v_bfe_u32 v230, v152, 3, 1
    v_lshlrev_b32 v230, 12, v230
    v_mfma_f32_16x16x32_bf16 v[44:47], v[88:91], a[60:63], v[44:47]
    ds_read_b128 v[88:91], v123 offset:22528
    s_mov_b32 s3, 0
    v_mfma_f32_16x16x32_bf16 v[108:111], v[96:99], v[96:99], v[108:111]
    v_add3_u32 v218, v230, v218, s3
    v_xor_b32 v219, 8, v218
    v_mfma_f32_16x16x32_bf16 v[232:235], v[116:119], v[96:99], v[232:235]
    s_add_u32 m0, s100, 73728
    s_add_u32 s83, s76, 640
    buffer_load_dwordx4 v164, s[52:55], s83 offen lds
    s_waitcnt lgkmcnt(3)
    v_mfma_f32_16x16x32_bf16 v[176:179], v[60:63], a[64:67], v[176:179]
    s_mul_i32 s3, s79, 163840
    s_waitcnt lgkmcnt(1)
    v_mfma_f32_16x16x32_bf16 v[192:195], v[60:63], a[72:75], v[192:195]
    s_barrier
    ds_read_b128 v[60:63], v120 offset:32768
    v_mfma_f32_16x16x32_bf16 v[48:51], v[116:119], a[64:67], v[48:51]
    buffer_load_dwordx4 v165, s[52:55], s83 offen offset:1024 lds
    s_mul_i32 s4, s78, 5120
    v_mfma_f32_16x16x32_bf16 v[108:111], v[100:103], v[100:103], v[108:111]
    s_add_u32 s3, s3, s4
    s_lshl_b32 s4, s77, 10
    v_mfma_f32_16x16x32_bf16 v[232:235], v[116:119], v[100:103], v[232:235]
    s_add_u32 s36, s3, s4
    s_add_u32 s18, s36, 40960
    v_mfma_f32_16x16x32_bf16 v[180:183], v[64:67], a[64:67], v[180:183]
    s_add_u32 s19, s36, 81920
    s_add_u32 s20, s36, 122880
    v_mfma_f32_16x16x32_bf16 v[196:199], v[64:67], a[72:75], v[196:199]
    ds_read_b128 v[64:67], v120 offset:34816
    s_add_u32 m0, s84, 10240
    s_add_u32 s83, s74, s90
    buffer_load_dwordx4 v158, s[56:59], s83 offen lds
    v_mfma_f32_16x16x32_bf16 v[52:55], v[116:119], a[72:75], v[52:55]
    s_lshl_b32 s4, s81, 8
    s_add_u32 s3, s3, s4
    v_mfma_f32_16x16x32_bf16 v[108:111], v[104:107], v[104:107], v[108:111]
    s_lshl_b32 s4, s80, 3
    s_add_u32 s3, s3, s4
    v_mfma_f32_16x16x32_bf16 v[232:235], v[116:119], v[104:107], v[232:235]
    s_add_u32 s37, s3, 4096
    v_mfma_f32_16x16x32_bf16 v[184:187], v[68:71], a[64:67], v[184:187]
    buffer_load_dwordx4 v159, s[56:59], s83 offen offset:1024 lds
    s_waitcnt vmcnt(13)
    v_and_b32 v165, 15, v152
    v_mfma_f32_16x16x32_bf16 v[200:203], v[68:71], a[72:75], v[200:203]
    ds_read_b128 v[68:71], v120 offset:36864
    ds_read_b128 v[92:95], v124 offset:49152
    v_lshrrev_b32 v230, 4, v152
    v_mfma_f32_16x16x32_bf16 v[188:191], v[72:75], a[64:67], v[188:191]
    ds_read_b128 v[96:99], v125 offset:49152
    v_add_u32 v164, 1, v165
    v_and_b32 v231, 1, v164
    v_mfma_f32_16x16x32_bf16 v[204:207], v[72:75], a[72:75], v[204:207]
    ds_read_b128 v[72:75], v120 offset:38912
    ds_read_b128 v[100:103], v124 offset:57344
    v_mfma_f32_16x16x32_bf16 v[176:179], v[76:79], a[68:71], v[176:179]
    s_add_u32 m0, s84, 12288
    s_add_u32 s83, s74, s90
    buffer_load_dwordx4 v158, s[60:63], s83 offen lds
    ds_read_b128 v[104:107], v125 offset:57344
    v_mfma_f32_16x16x32_bf16 v[192:195], v[76:79], a[76:79], v[192:195]
    ds_read_b128 v[76:79], v121 offset:32768
    v_sub_u32 v164, v164, v231
    v_mfma_f32_16x16x32_bf16 v[48:51], v[116:119], a[68:71], v[48:51]
    v_mul_u32_u24 v231, 4164, v231
    v_lshl_add_u32 v164, v164, 1, v231
    v_mfma_f32_16x16x32_bf16 v[180:183], v[80:83], a[68:71], v[180:183]
    v_lshlrev_b32 v231, 4, v230
    v_sub_u32 v164, v164, v231
    v_mfma_f32_16x16x32_bf16 v[196:199], v[80:83], a[76:79], v[196:199]
    ds_read_b128 v[80:83], v121 offset:34816
    buffer_load_dwordx4 v159, s[60:63], s83 offen offset:1024 lds
    v_mfma_f32_16x16x32_bf16 v[52:55], v[116:119], a[76:79], v[52:55]
    v_lshl_add_u32 v165, v165, 5, v231
    s_waitcnt lgkmcnt(10)
    v_mfma_f32_16x16x32_bf16 v[184:187], v[84:87], a[68:71], v[184:187]
    s_lshl_b32 s3, s77, 7
    s_add_u32 s4, s3, 30256
    v_mfma_f32_16x16x32_bf16 v[200:203], v[84:87], a[76:79], v[200:203]
    ds_read_b128 v[84:87], v121 offset:36864
    s_add_u32 m0, s84, 14336
    s_add_u32 s83, s75, s85
    buffer_load_dwordx4 v158, s[56:59], s83 offen lds
    s_waitcnt lgkmcnt(6)
    v_mfma_f32_16x16x32_bf16 v[108:111], v[92:95], v[92:95], v[108:111]
    s_waitcnt vmcnt(13)
    ds_read_b128 a[80:83], v156 offset:4096
    ds_read_b128 a[84:87], v157 offset:4096
    v_mfma_f32_16x16x32_bf16 v[232:235], v[116:119], v[92:95], v[232:235]
    s_waitcnt vmcnt(11)
    ds_read_b128 a[88:91], v156 offset:6144
    ds_read_b128 a[92:95], v157 offset:6144
    v_mfma_f32_16x16x32_bf16 v[188:191], v[88:91], a[68:71], v[188:191]
    s_waitcnt vmcnt(9)
    ds_read_b128 a[96:99], v156 offset:8192
    ds_read_b128 a[100:103], v157 offset:8192
    v_mfma_f32_16x16x32_bf16 v[204:207], v[88:91], a[76:79], v[204:207]
    ds_read_b128 v[88:91], v121 offset:38912
    buffer_load_dwordx4 v159, s[56:59], s83 offen offset:1024 lds
    v_mfma_f32_16x16x32_bf16 v[108:111], v[96:99], v[96:99], v[108:111]
    s_sub_u32 s3, 26016, s3
    v_add_u32 v164, s4, v164
    v_mfma_f32_16x16x32_bf16 v[232:235], v[116:119], v[96:99], v[232:235]
    s_waitcnt lgkmcnt(5)
    v_mfma_f32_16x16x32_bf16 v[176:179], v[60:63], a[80:83], v[176:179]
    v_add_u32 v165, s3, v165
    s_waitcnt lgkmcnt(3)
    v_mfma_f32_16x16x32_bf16 v[192:195], v[60:63], a[88:91], v[192:195]
    s_mov_b32 m0, s84
    s_add_u32 s83, s75, s85
    buffer_load_dwordx4 v158, s[60:63], s83 offen lds
    s_waitcnt lgkmcnt(1)
    v_mfma_f32_16x16x32_bf16 v[32:35], v[60:63], a[96:99], v[32:35]
    ds_read_b128 v[60:63], v122 offset:32768
    s_min_u32 s4, s77, 2
    L_nonce:
    v_readfirstlane_b32 s82, v224
    s_cmp_eq_u32 s82, 0
    s_cbranch_scc1 L_nonce_re
    s_xor_b32 s8, s82, s89
    v_mov_b32 v224, s8
    s_mov_b64 exec, 1

    global_store_dword v223, v224, s[50:51] sc1
    s_mov_b64 exec, -1
    v_mfma_f32_16x16x32_bf16 v[48:51], v[116:119], a[80:83], v[48:51]
    s_mul_i32 s3, s4, 4608
    s_add_u32 s3, s3, 16384
    v_mfma_f32_16x16x32_bf16 v[108:111], v[100:103], v[100:103], v[108:111]
    v_lshl_add_u32 v173, v152, 3, s3
    s_mul_i32 s4, s4, 8320
    v_mfma_f32_16x16x32_bf16 v[232:235], v[116:119], v[100:103], v[232:235]
    buffer_load_dwordx4 v159, s[60:63], s83 offen offset:1024 lds
    s_add_u32 s4, s4, 30208
    v_mfma_f32_16x16x32_bf16 v[180:183], v[64:67], a[80:83], v[180:183]
    v_lshrrev_b32 v172, 3, v152
    v_mul_u32_u24 v172, 4132, v172
    v_mfma_f32_16x16x32_bf16 v[196:199], v[64:67], a[88:91], v[196:199]
    v_lshl_add_u32 v172, v152, 2, v172
    v_add_u32 v172, s4, v172
    v_mfma_f32_16x16x32_bf16 v[36:39], v[64:67], a[96:99], v[36:39]
    ds_read_b128 v[64:67], v122 offset:34816
    s_and_b32 s3, s79, 1
    v_mfma_f32_16x16x32_bf16 v[52:55], v[116:119], a[88:91], v[52:55]
    s_lshl_b32 s3, s3, 4
    s_lshr_b32 s35, s35, s3
    v_mfma_f32_16x16x32_bf16 v[108:111], v[104:107], v[104:107], v[108:111]
    s_lshl_b32 s35, s35, 16
    s_lshl_b32 s3, s81, 4
    v_mfma_f32_16x16x32_bf16 v[232:235], v[116:119], v[104:107], v[232:235]
    s_lshr_b32 s34, s34, s3
    v_mfma_f32_16x16x32_bf16 v[184:187], v[68:71], a[80:83], v[184:187]
    global_load_dword a255, v112, s[26:27]
    s_lshl_b32 s34, s34, 16
    v_mfma_f32_16x16x32_bf16 v[200:203], v[68:71], a[88:91], v[200:203]
    s_mov_b64 s[68:69], s[50:51]
    s_mov_b32 s70, 5767168
    v_mfma_f32_16x16x32_bf16 v[40:43], v[68:71], a[96:99], v[40:43]
    ds_read_b128 v[68:71], v122 offset:36864
    global_load_dword a255, v112, s[28:29]
    v_mfma_f32_16x16x32_bf16 v[56:59], v[116:119], a[96:99], v[56:59]
    s_mov_b64 s[64:65], s[46:47]
    s_mov_b32 s66, 5242880
    v_add_u32 v124, 0x10000, v124
    v_mfma_f32_16x16x32_bf16 v[188:191], v[72:75], a[80:83], v[188:191]
    s_add_u32 m0, s84, 2048
    s_add_u32 s83, s75, s85
    buffer_load_dwordx4 v158, s[92:95], s83 offen lds
    v_add_u32 v125, 0x10000, v125
    v_mfma_f32_16x16x32_bf16 v[204:207], v[72:75], a[88:91], v[204:207]
    s_waitcnt vmcnt(12)
    v_mov_b64 v[228:229], 0
    v_mfma_f32_16x16x32_bf16 v[44:47], v[72:75], a[96:99], v[44:47]
    ds_read_b128 v[72:75], v122 offset:38912
    ds_read_b128 v[92:95], v124 offset:0
    v_mfma_f32_16x16x32_bf16 v[176:179], v[76:79], a[84:87], v[176:179]
    buffer_load_dwordx4 v159, s[92:95], s83 offen offset:1024 lds
    ds_read_b128 v[96:99], v125 offset:0
    v_mfma_f32_16x16x32_bf16 v[192:195], v[76:79], a[92:95], v[192:195]
    ds_read_b128 v[100:103], v124 offset:8192
    v_mfma_f32_16x16x32_bf16 v[32:35], v[76:79], a[100:103], v[32:35]
    ds_read_b128 v[76:79], v123 offset:32768
    ds_read_b128 v[104:107], v125 offset:8192
    v_mfma_f32_16x16x32_bf16 v[48:51], v[116:119], a[84:87], v[48:51]
    ds_read_b128 v[142:145], v128
    v_mfma_f32_16x16x32_bf16 v[180:183], v[80:83], a[84:87], v[180:183]
    s_add_u32 m0, s84, 4096
    s_add_u32 s83, s76, s85
    buffer_load_dwordx4 v158, s[56:59], s83 offen lds
    ds_read_b128 v[146:149], v129
    v_mfma_f32_16x16x32_bf16 v[196:199], v[80:83], a[92:95], v[196:199]
    ds_read_b64 v[150:151], v130
    v_mfma_f32_16x16x32_bf16 v[36:39], v[80:83], a[100:103], v[36:39]
    ds_read_b128 v[80:83], v123 offset:34816
    v_mfma_f32_16x16x32_bf16 v[52:55], v[116:119], a[92:95], v[52:55]
    s_waitcnt lgkmcnt(7)
    v_mfma_f32_16x16x32_bf16 v[108:111], v[92:95], v[92:95], v[108:111]
    buffer_load_dwordx4 v159, s[56:59], s83 offen offset:1024 lds
    v_mfma_f32_16x16x32_bf16 v[232:235], v[116:119], v[92:95], v[232:235]
    v_mfma_f32_16x16x32_bf16 v[184:187], v[84:87], a[84:87], v[184:187]
    v_mfma_f32_16x16x32_bf16 v[200:203], v[84:87], a[92:95], v[200:203]
    v_mfma_f32_16x16x32_bf16 v[40:43], v[84:87], a[100:103], v[40:43]
    ds_read_b128 v[84:87], v123 offset:36864
    s_add_u32 m0, s84, 6144
    s_add_u32 s83, s76, s85
    buffer_load_dwordx4 v158, s[60:63], s83 offen lds
    v_mfma_f32_16x16x32_bf16 v[56:59], v[116:119], a[100:103], v[56:59]
    s_waitcnt lgkmcnt(2)
    ds_read_b128 v[0:3], v166 offset:0
    ds_read_b128 v[4:7], v166 offset:16
    v_mfma_f32_16x16x32_bf16 v[108:111], v[96:99], v[96:99], v[108:111]
    ds_read_b128 v[8:11], v166 offset:128
    ds_read_b128 v[12:15], v166 offset:144
    ds_read_b128 v[16:19], v167 offset:256
    v_mfma_f32_16x16x32_bf16 v[232:235], v[116:119], v[96:99], v[232:235]
    s_waitcnt vmcnt(14)
    ds_read_b128 a[104:107], v156 offset:10240
    ds_read_b128 a[108:111], v157 offset:10240
    v_mfma_f32_16x16x32_bf16 v[188:191], v[88:91], a[84:87], v[188:191]
    buffer_load_dwordx4 v159, s[60:63], s83 offen offset:1024 lds
    s_waitcnt vmcnt(13)
    ds_read_b128 a[112:115], v156 offset:12288
    ds_read_b128 a[116:119], v157 offset:12288
    v_mfma_f32_16x16x32_bf16 v[204:207], v[88:91], a[92:95], v[204:207]
    v_lshlrev_b32 v132, 16, v142
    v_and_b32 v133, s86, v142
    v_mfma_f32_16x16x32_bf16 v[44:47], v[88:91], a[100:103], v[44:47]
    ds_read_b128 v[88:91], v123 offset:38912
    v_lshlrev_b32 v134, 16, v143
    v_mfma_f32_16x16x32_bf16 v[108:111], v[100:103], v[100:103], v[108:111]
    s_add_u32 m0, s84, 8192
    s_add_u32 s83, s76, s85
    buffer_load_dwordx4 v158, s[92:95], s83 offen lds
    v_mfma_f32_16x16x32_bf16 v[232:235], v[116:119], v[100:103], v[232:235]
    v_and_b32 v135, s86, v143
    s_waitcnt lgkmcnt(3)
    v_mfma_f32_16x16x32_bf16 v[176:179], v[60:63], a[104:107], v[176:179]
    v_lshlrev_b32 v136, 16, v144
    v_and_b32 v137, s86, v144
    s_waitcnt lgkmcnt(1)
    v_mfma_f32_16x16x32_bf16 v[192:195], v[60:63], a[112:115], v[192:195]
    s_waitcnt lgkmcnt(0)
    s_barrier
    ds_read_b128 v[60:63], v120 offset:49152
    v_mfma_f32_16x16x32_bf16 v[48:51], v[116:119], a[104:107], v[48:51]
    buffer_load_dwordx4 v159, s[92:95], s83 offen offset:1024 lds
    v_lshlrev_b32 v138, 16, v145
    v_and_b32 v139, s86, v145
    v_mfma_f32_16x16x32_bf16 v[108:111], v[104:107], v[104:107], v[108:111]
    v_lshlrev_b32 v140, 16, v146
    v_and_b32 v141, s86, v146
    v_mfma_f32_16x16x32_bf16 v[232:235], v[116:119], v[104:107], v[232:235]
    v_lshlrev_b32 v142, 16, v147
    v_and_b32 v143, s86, v147
    v_mfma_f32_16x16x32_bf16 v[180:183], v[64:67], a[104:107], v[180:183]
    v_lshlrev_b32 v144, 16, v148
    v_and_b32 v145, s86, v148
    v_mfma_f32_16x16x32_bf16 v[196:199], v[64:67], a[112:115], v[196:199]
    ds_read_b128 v[64:67], v120 offset:51200
    s_add_u32 m0, s84, 10240
    s_add_u32 s83, s75, s90
    buffer_load_dwordx4 v158, s[56:59], s83 offen lds
    v_mfma_f32_16x16x32_bf16 v[52:55], v[116:119], a[112:115], v[52:55]
    s_mov_b32 vcc_lo, 0xaaaaaaaa
    s_mov_b32 vcc_hi, 0xaaaaaaaa
    v_cndmask_b32 v108, v108, v109, vcc
    v_cndmask_b32 v110, v110, v111, vcc
    v_mfma_f32_16x16x32_bf16 v[184:187], v[68:71], a[104:107], v[184:187]
    s_mov_b32 vcc_lo, 0xcccccccc
    s_mov_b32 vcc_hi, 0xcccccccc
    v_cndmask_b32 v108, v108, v110, vcc
    v_mfma_f32_16x16x32_bf16 v[200:203], v[68:71], a[112:115], v[200:203]
    ds_read_b128 v[68:71], v120 offset:53248
    s_mov_b32 vcc_lo, 0x00f0000f
    s_mov_b32 vcc_hi, 0xf0000f00
    v_cndmask_b32 v108, 0, v108, vcc
    v_mfma_f32_16x16x32_bf16 v[188:191], v[72:75], a[104:107], v[188:191]
    buffer_load_dwordx4 v159, s[56:59], s83 offen offset:1024 lds
    v_mov_b32 v109, v108
    s_nop 1
    v_permlane32_swap_b32 v108, v109
    v_mfma_f32_16x16x32_bf16 v[204:207], v[72:75], a[112:115], v[204:207]
    ds_read_b128 v[72:75], v120 offset:55296
    v_add_f32 v108, v108, v109
    v_mov_b32 v109, v108
    v_mfma_f32_16x16x32_bf16 v[176:179], v[76:79], a[108:111], v[176:179]
    s_nop 0
    v_permlane16_swap_b32 v108, v109
    v_add_f32 v108, v108, v109
    v_mfma_f32_16x16x32_bf16 v[192:195], v[76:79], a[116:119], v[192:195]
    ds_read_b128 v[76:79], v121 offset:49152
    s_waitcnt vmcnt(15)
    ds_read_b128 a[120:123], v156 offset:14336
    ds_read_b128 a[124:127], v157 offset:14336
    v_mul_f32 v232, 0x3acccccd, v232
    v_mul_f32 v108, 0x3acccccd, v108
    v_mfma_f32_16x16x32_bf16 v[48:51], v[116:119], a[108:111], v[48:51]
    s_add_u32 m0, s84, 12288
    s_add_u32 s83, s75, s90
    buffer_load_dwordx4 v158, s[60:63], s83 offen lds
    v_fma_f32 v108, -v232, v232, v108
    v_max_f32 v108, 0, v108
    v_mfma_f32_16x16x32_bf16 v[180:183], v[80:83], a[108:111], v[180:183]
    v_cvt_pk_bf16_f32 v232, 0, v232
    v_cvt_pk_bf16_f32 v108, 0, v108
    v_mfma_f32_16x16x32_bf16 v[196:199], v[80:83], a[116:119], v[196:199]
    ds_read_b128 v[80:83], v121 offset:51200
    v_add_f32 v108, 0x3727c5ac, v108
    v_cvt_pk_bf16_f32 v108, 0, v108
    v_mfma_f32_16x16x32_bf16 v[52:55], v[116:119], a[116:119], v[52:55]
    buffer_load_dwordx4 v159, s[60:63], s83 offen offset:1024 lds
    s_waitcnt vmcnt(14)
    ds_read_b128 a[128:131], v156 offset:0
    ds_read_b128 a[132:135], v157 offset:0
    v_sqrt_f32 v108, v108
    v_xor_b32 v233, 0x80000000, v232
    v_mfma_f32_16x16x32_bf16 v[184:187], v[84:87], a[108:111], v[184:187]
    s_waitcnt vmcnt(10)
    ds_read_b128 a[136:139], v156 offset:2048
    ds_read_b128 a[140:143], v157 offset:2048
    v_cvt_pk_bf16_f32 v108, 0, v108
    v_rcp_f32 v108, v108
    v_mfma_f32_16x16x32_bf16 v[200:203], v[84:87], a[116:119], v[200:203]
    ds_read_b128 v[84:87], v121 offset:53248
    v_lshlrev_b32 v146, 16, v149
    v_and_b32 v147, s86, v149
    v_mfma_f32_16x16x32_bf16 v[188:191], v[88:91], a[108:111], v[188:191]
    v_lshlrev_b32 v148, 16, v150
    v_and_b32 v149, s86, v150
    v_mfma_f32_16x16x32_bf16 v[204:207], v[88:91], a[116:119], v[204:207]
    ds_read_b128 v[88:91], v121 offset:55296
    s_waitcnt lgkmcnt(7)
    s_add_u32 m0, s84, 14336
    s_add_u32 s83, s76, s90
    buffer_load_dwordx4 v158, s[56:59], s83 offen lds
    v_mfma_f32_16x16x32_bf16 v[176:179], v[60:63], a[120:123], v[176:179]
    v_lshlrev_b32 v150, 16, v151
    v_and_b32 v151, s86, v151
    s_waitcnt lgkmcnt(4)
    v_mfma_f32_16x16x32_bf16 v[192:195], v[60:63], a[128:131], v[192:195]
    v_add_f32 v132, v233, v132
    s_waitcnt lgkmcnt(2)
    v_mfma_f32_16x16x32_bf16 v[32:35], v[60:63], a[136:139], v[32:35]
    v_add_u32 v120, 0x10000, v120
    v_add_u32 v121, 0x10000, v121
    ds_read_b128 v[60:63], v120 offset:0
    v_add_f32 v133, v233, v133
    v_add_f32 v134, v233, v134
    v_mfma_f32_16x16x32_bf16 v[48:51], v[116:119], a[120:123], v[48:51]
    buffer_load_dwordx4 v159, s[56:59], s83 offen offset:1024 lds
    v_add_f32 v135, v233, v135
    v_add_f32 v136, v233, v136
    v_mfma_f32_16x16x32_bf16 v[180:183], v[64:67], a[120:123], v[180:183]
    v_add_f32 v137, v233, v137
    v_add_f32 v138, v233, v138
    v_mfma_f32_16x16x32_bf16 v[196:199], v[64:67], a[128:131], v[196:199]
    v_add_f32 v139, v233, v139
    v_add_f32 v140, v233, v140
    v_mfma_f32_16x16x32_bf16 v[36:39], v[64:67], a[136:139], v[36:39]
    ds_read_b128 v[64:67], v121 offset:0
    v_add_f32 v141, v233, v141
    v_add_f32 v142, v233, v142
    v_mfma_f32_16x16x32_bf16 v[52:55], v[116:119], a[128:131], v[52:55]
    s_mov_b32 m0, s84
    s_add_u32 s83, s76, s90
    buffer_load_dwordx4 v158, s[60:63], s83 offen lds
    v_mfma_f32_16x16x32_bf16 v[184:187], v[68:71], a[120:123], v[184:187]
    v_add_f32 v143, v233, v143
    v_add_f32 v144, v233, v144
    v_mfma_f32_16x16x32_bf16 v[200:203], v[68:71], a[128:131], v[200:203]
    v_add_f32 v145, v233, v145
    v_add_f32 v146, v233, v146
    v_mfma_f32_16x16x32_bf16 v[40:43], v[68:71], a[136:139], v[40:43]
    ds_read_b128 v[68:71], v120 offset:2048
    v_add_f32 v147, v233, v147
    v_add_f32 v148, v233, v148
    v_mfma_f32_16x16x32_bf16 v[56:59], v[116:119], a[136:139], v[56:59]
    buffer_load_dwordx4 v159, s[60:63], s83 offen offset:1024 lds
    v_add_f32 v149, v233, v149
    v_add_f32 v150, v233, v150
    v_mfma_f32_16x16x32_bf16 v[188:191], v[72:75], a[120:123], v[188:191]
    s_mov_b64 s[56:57], s[26:27]
    s_sub_u32 s60, s28, 2048
    s_subb_u32 s61, s29, 0
    v_mfma_f32_16x16x32_bf16 v[204:207], v[72:75], a[128:131], v[204:207]
    s_mov_b32 s62, 821248
    v_bfe_u32 v230, v152, 4, 1
    v_lshlrev_b32 v159, 1, v230
    v_mfma_f32_16x16x32_bf16 v[44:47], v[72:75], a[136:139], v[44:47]
    ds_read_b128 v[72:75], v121 offset:2048
    global_load_dword v224, v169, s[50:51] sc1
    v_and_b32 v231, 3, v152
    v_xor_b32 v159, v159, v231
    v_mfma_f32_16x16x32_bf16 v[176:179], v[76:79], a[124:127], v[176:179]
    global_load_dwordx2 v[170:171], v168, s[50:51] sc1
    v_lshrrev_b32 v231, 5, v152
    v_lshl_add_u32 v159, v231, 2, v159
    s_mul_i32 s3, s78, 102400
    s_mul_i32 s4, s77, 320
    s_add_u32 s3, s3, s4
    v_mfma_f32_16x16x32_bf16 v[192:195], v[76:79], a[132:135], v[192:195]
    s_waitcnt vmcnt(14)
    ds_read_b128 a[160:163], v156 offset:4096
    ds_read_b128 a[164:167], v157 offset:4096
    v_lshl_add_u32 v159, v159, 4, s3
    v_bfe_u32 v231, v152, 2, 2
    v_mfma_f32_16x16x32_bf16 v[32:35], v[76:79], a[140:143], v[32:35]
    ds_read_b128 v[76:79], v120 offset:4096
    v_lshl_add_u32 v231, v230, 3, v231
    s_movk_i32 s4, 1280
    v_mad_u32_u24 v159, v231, s4, v159
    s_movk_i32 s4, 10240
    v_mfma_f32_16x16x32_bf16 v[48:51], v[116:119], a[124:127], v[48:51]
    v_mad_u32_u24 v158, v230, s4, v159
    s_lshl_b32 s3, s79, 4
    s_and_b32 s3, s3, 128
    s_lshl_b32 s4, s80, 6
    v_mfma_f32_16x16x32_bf16 v[180:183], v[80:83], a[124:127], v[180:183]
    s_add_u32 s16, s3, s4
    s_xor_b32 s17, s16, 128
    s_lshl_b32 s4, s4, 2
    v_mfma_f32_16x16x32_bf16 v[196:199], v[80:83], a[132:135], v[196:199]
    s_xor_b32 s44, s4, 256
    s_add_u32 s83, s12, s15
    v_add_u32 v175, s83, v153
    global_load_dwordx4 v[252:255], v175, s[42:43]
    v_add_f32 v151, v233, v151
    v_fma_f32 v0, v0, v108, 1.0
    v_mfma_f32_16x16x32_bf16 v[36:39], v[80:83], a[140:143], v[36:39]
    ds_read_b128 v[80:83], v121 offset:4096
    s_add_u32 s83, s12, s14
    v_add_u32 v175, s83, v153
    global_load_dwordx4 v[244:247], v175, s[42:43]
    v_fma_f32 v1, v1, v108, 1.0
    v_fma_f32 v2, v2, v108, 1.0
    v_mfma_f32_16x16x32_bf16 v[52:55], v[116:119], a[132:135], v[52:55]
    s_add_u32 s83, s12, s14
    v_add_u32 v175, s83, v153
    v_add_u32 v175, 4096, v175
    global_load_dwordx4 v[248:251], v175, s[42:43]
    v_fma_f32 v3, v3, v108, 1.0
    v_fma_f32 v4, v4, v108, 1.0
    s_waitcnt lgkmcnt(8)
    v_mfma_f32_16x16x32_bf16 v[184:187], v[84:87], a[124:127], v[184:187]
    global_load_dword a255, v227, s[50:51] sc1
    v_fma_f32 v5, v5, v108, 1.0
    v_fma_f32 v6, v6, v108, 1.0
    v_mfma_f32_16x16x32_bf16 v[200:203], v[84:87], a[132:135], v[200:203]
    s_waitcnt vmcnt(16)
    ds_read_b128 a[168:171], v156 offset:6144
    ds_read_b128 a[172:175], v157 offset:6144
    v_mfma_f32_16x16x32_bf16 v[40:43], v[84:87], a[140:143], v[40:43]
    ds_read_b128 v[84:87], v120 offset:6144
    v_fma_f32 v7, v7, v108, 1.0
    v_fma_f32 v8, v8, v108, 1.0
    v_mfma_f32_16x16x32_bf16 v[56:59], v[116:119], a[140:143], v[56:59]
    s_waitcnt vmcnt(14)
    ds_read_b128 a[176:179], v156 offset:8192
    ds_read_b128 a[180:183], v157 offset:8192
    v_mfma_f32_16x16x32_bf16 v[188:191], v[88:91], a[124:127], v[188:191]
    v_fma_f32 v9, v9, v108, 1.0
    v_fma_f32 v10, v10, v108, 1.0
    v_mfma_f32_16x16x32_bf16 v[204:207], v[88:91], a[132:135], v[204:207]
    v_fma_f32 v11, v11, v108, 1.0
    v_fma_f32 v12, v12, v108, 1.0
    v_mfma_f32_16x16x32_bf16 v[44:47], v[88:91], a[140:143], v[44:47]
    ds_read_b128 v[88:91], v121 offset:6144
    s_waitcnt lgkmcnt(8)
    v_mfma_f32_16x16x32_bf16 v[176:179], v[60:63], a[160:163], v[176:179]
    ds_read_b64 v[112:113], v154 offset:7680
    v_fma_f32 v13, v13, v108, 1.0
    v_fma_f32 v14, v14, v108, 1.0
    s_waitcnt lgkmcnt(5)
    v_mfma_f32_16x16x32_bf16 v[192:195], v[60:63], a[168:171], v[192:195]
    ds_read_b64 v[114:115], v155 offset:7680
    v_fma_f32 v15, v15, v108, 1.0
    v_fma_f32 v16, v16, v108, 1.0
    s_waitcnt lgkmcnt(3)
    v_mfma_f32_16x16x32_bf16 v[32:35], v[60:63], a[176:179], v[32:35]
    ds_read_b128 v[60:63], v122 offset:49152
    ds_read_b64 v[100:101], v154 offset:8320
    v_fma_f32 v17, v17, v108, 1.0
    v_fma_f32 v18, v18, v108, 1.0
    v_mfma_f32_16x16x32_bf16 v[48:51], v[116:119], a[160:163], v[48:51]
    ds_read_b64 v[102:103], v154 offset:8960
    v_fma_f32 v19, v19, v108, 1.0
    v_mul_f32 v132, v0, v132
    v_mfma_f32_16x16x32_bf16 v[176:179], v[64:67], a[164:167], v[176:179]
    ds_read_b64 v[104:105], v155 offset:8320
    v_mul_f32 v133, v1, v133
    v_mul_f32 v134, v2, v134
    v_mfma_f32_16x16x32_bf16 v[192:195], v[64:67], a[172:175], v[192:195]
    ds_read_b64 v[106:107], v155 offset:8960
    v_mul_f32 v135, v3, v135
    v_mul_f32 v136, v4, v136
    v_mfma_f32_16x16x32_bf16 v[32:35], v[64:67], a[180:183], v[32:35]
    ds_read_b128 v[64:67], v122 offset:51200
    v_mul_f32 v137, v5, v137
    v_mul_f32 v138, v6, v138
    v_mfma_f32_16x16x32_bf16 v[48:51], v[116:119], a[164:167], v[48:51]
    v_mul_f32 v139, v7, v139
    v_mul_f32 v140, v8, v140
    v_mfma_f32_16x16x32_bf16 v[180:183], v[68:71], a[160:163], v[180:183]
    s_nop 0
    ds_write_b128 v220, v[32:35] offset:0
    v_mul_f32 v141, v9, v141
    v_mul_f32 v142, v10, v142
    v_mfma_f32_16x16x32_bf16 v[196:199], v[68:71], a[168:171], v[196:199]
    s_waitcnt vmcnt(12)
    ds_read_b128 a[144:147], v156 offset:10240
    ds_read_b128 a[148:151], v157 offset:10240
    v_mfma_f32_16x16x32_bf16 v[36:39], v[68:71], a[176:179], v[36:39]
    ds_read_b128 v[68:71], v122 offset:53248
    v_mul_f32 v143, v11, v143
    v_mul_f32 v144, v12, v144
    v_mfma_f32_16x16x32_bf16 v[52:55], v[116:119], a[168:171], v[52:55]
    v_mul_f32 v145, v13, v145
    v_mul_f32 v146, v14, v146
    v_mfma_f32_16x16x32_bf16 v[180:183], v[72:75], a[164:167], v[180:183]
    s_mov_b64 exec, 0xffff
    ds_write_b32 v126, v232 offset:1024
    ds_write2st64_b32 v126, v233, v108 offset1:1
    ds_write2st64_b32 v127, v233, v108 offset1:1
    s_mov_b64 exec, -1
    v_mfma_f32_16x16x32_bf16 v[196:199], v[72:75], a[172:175], v[196:199]
    s_waitcnt lgkmcnt(13)
    v_mul_f32 v147, v15, v147
    v_mul_f32 v148, v16, v148
    v_mfma_f32_16x16x32_bf16 v[36:39], v[72:75], a[180:183], v[36:39]
    ds_read_b128 v[72:75], v122 offset:55296
    v_mul_f32 v149, v17, v149
    v_mul_f32 v150, v18, v150
    v_mfma_f32_16x16x32_bf16 v[52:55], v[116:119], a[172:175], v[52:55]
    v_mul_f32 v151, v19, v151
    v_xor_b32 v115, v163, v115
    v_mfma_f32_16x16x32_bf16 v[184:187], v[76:79], a[160:163], v[184:187]
    s_waitcnt vmcnt(10)
    ds_read_b128 a[152:155], v156 offset:12288
    ds_read_b128 a[156:159], v157 offset:12288
    v_mfma_f32_16x16x32_bf16 v[200:203], v[76:79], a[168:171], v[200:203]
    ds_write_b128 v220, v[36:39] offset:1024
    s_waitcnt lgkmcnt(12)
    v_xor_b32 v105, v163, v105
    v_xor_b32 v107, v163, v107
    v_mfma_f32_16x16x32_bf16 v[40:43], v[76:79], a[176:179], v[40:43]
    ds_read_b128 v[76:79], v123 offset:49152
    v_mfma_f32_16x16x32_bf16 v[56:59], v[116:119], a[176:179], v[56:59]
    v_mfma_f32_16x16x32_bf16 v[184:187], v[80:83], a[164:167], v[184:187]
    v_mfma_f32_16x16x32_bf16 v[200:203], v[80:83], a[172:175], v[200:203]
    v_mfma_f32_16x16x32_bf16 v[40:43], v[80:83], a[180:183], v[40:43]
    ds_read_b128 v[80:83], v123 offset:51200
    v_mfma_f32_16x16x32_bf16 v[56:59], v[116:119], a[180:183], v[56:59]
    v_mfma_f32_16x16x32_bf16 v[188:191], v[84:87], a[160:163], v[188:191]
    s_waitcnt vmcnt(8)
    ds_read_b128 a[184:187], v156 offset:14336
    ds_read_b128 a[188:191], v157 offset:14336
    v_mfma_f32_16x16x32_bf16 v[204:207], v[84:87], a[168:171], v[204:207]
    s_nop 0
    ds_write_b128 v220, v[40:43] offset:2048
    v_mfma_f32_16x16x32_bf16 v[44:47], v[84:87], a[176:179], v[44:47]
    ds_read_b128 v[84:87], v123 offset:53248
    v_mfma_f32_16x16x32_bf16 v[188:191], v[88:91], a[164:167], v[188:191]
    v_mfma_f32_16x16x32_bf16 v[204:207], v[88:91], a[172:175], v[204:207]
    v_mfma_f32_16x16x32_bf16 v[44:47], v[88:91], a[180:183], v[44:47]
    ds_read_b128 v[88:91], v123 offset:55296
    s_waitcnt lgkmcnt(15)
    v_mfma_f32_16x16x32_bf16 v[176:179], v[60:63], a[144:147], v[176:179]
    s_waitcnt lgkmcnt(8)
    v_mfma_f32_16x16x32_bf16 v[192:195], v[60:63], a[152:155], v[192:195]
    v_add_u32 v122, 0x10000, v122
    v_add_u32 v123, 0x10000, v123
    ds_read_b128 v[60:63], v122 offset:0
    ds_write_b128 v220, v[44:47] offset:3072
    v_mfma_f32_16x16x32_bf16 v[48:51], v[116:119], a[144:147], v[48:51]
    s_waitcnt vmcnt(6)
    ds_read_b128 a[192:195], v156 offset:0
    ds_read_b128 a[196:199], v157 offset:0
    v_mfma_f32_16x16x32_bf16 v[180:183], v[64:67], a[144:147], v[180:183]
    v_and_b32 v226, 3, v152
    v_lshl_add_u32 v156, v226, 6, s84
    v_mfma_f32_16x16x32_bf16 v[196:199], v[64:67], a[152:155], v[196:199]
    ds_read_b128 v[64:67], v123 offset:0
    s_mov_b64 exec, 0xffff
    ds_write_b32 v225, v56
    s_mov_b64 exec, -1
    v_bfe_u32 v226, v152, 2, 1
    v_lshl_add_u32 v156, v226, 10, v156
    v_mfma_f32_16x16x32_bf16 v[52:55], v[116:119], a[152:155], v[52:55]
    v_bfe_u32 v226, v152, 3, 1
    v_lshl_add_u32 v156, v226, 8, v156
    v_mfma_f32_16x16x32_bf16 v[184:187], v[68:71], a[144:147], v[184:187]
    s_waitcnt vmcnt(4)
    L_kf:
    v_xor_b32 v224, s82, v224
    v_xor_b32 v170, s82, v170
    v_xor_b32 v171, s82, v171
    v_max3_u32 v170, v170, v171, v224
    v_cmp_lt_u32 vcc, 7, v170
    s_cbranch_vccnz L_kf_re
    v_cmp_ne_u32 vcc, s89, v224
    s_lshl_b32 s5, s77, 10
    s_cmp_eq_u32 vcc_hi, 0
    s_cselect_b32 s88, 1, 0

    s_add_u32 m0, s5, 26112
    s_add_u32 s83, s5, s15
    buffer_load_dwordx4 v153, s[68:71], s83 offen sc1 lds
    v_lshlrev_b32 v226, 1, v226
    v_bfe_u32 v221, v152, 4, 1
    v_mfma_f32_16x16x32_bf16 v[200:203], v[68:71], a[152:155], v[200:203]
    ds_read_b128 v[68:71], v122 offset:2048
    v_xor_b32 v226, v226, v221
    v_lshl_add_u32 v156, v226, 4, v156
    v_mfma_f32_16x16x32_bf16 v[188:191], v[72:75], a[144:147], v[188:191]
    s_add_u32 m0, s5, 16896
    s_add_u32 s83, s5, s14
    buffer_load_dwordx4 v153, s[68:71], s83 offen sc1 lds
    v_lshrrev_b32 v226, 5, v152
    v_lshl_add_u32 v156, v226, 11, v156
    v_mfma_f32_16x16x32_bf16 v[204:207], v[72:75], a[152:155], v[204:207]
    ds_read_b128 v[72:75], v123 offset:2048
    v_xor_b32 v157, 32, v156
    s_waitcnt lgkmcnt(13)
    v_mfma_f32_16x16x32_bf16 v[176:179], v[76:79], a[148:151], v[176:179]
    s_lshl_b32 s3, s78, 2
    s_add_u32 s3, s3, s77
    s_lshl_b32 s3, s3, 13
    s_waitcnt lgkmcnt(0)
    s_barrier
    v_mfma_f32_16x16x32_bf16 v[192:195], v[76:79], a[156:159], v[192:195]
    ds_read_b128 v[76:79], v122 offset:4096
    s_add_u32 s3, s3, 9437184
    ds_read2st64_b32 v[16:17], v218 offset0:0 offset1:32
    v_mov_b32 v36, s30
    v_mfma_f32_16x16x32_bf16 v[48:51], v[116:119], a[148:151], v[48:51]
    s_add_u32 s92, s50, s3
    s_addc_u32 s93, s51, 0
    s_movk_i32 s94, 8192
    s_waitcnt vmcnt(4)
    v_mov_b32_dpp v36, v247 wave_shr:1 row_mask:0xf bank_mask:0xf
    v_alignbit_b32 v33, v245, v244, 16
    v_mfma_f32_16x16x32_bf16 v[180:183], v[80:83], a[148:151], v[180:183]
    s_sub_u32 s21, 31, s79
    s_lshl_b32 s21, s21, 8
    ds_read2st64_b32 v[18:19], v219 offset0:0 offset1:32
    v_alignbit_b32 v34, v246, v245, 16
    v_alignbit_b32 v35, v247, v246, 16
    v_mfma_f32_16x16x32_bf16 v[196:199], v[80:83], a[156:159], v[196:199]
    ds_read_b128 v[80:83], v123 offset:4096
    s_add_u32 m0, s5, 21504
    s_add_u32 s83, s5, s14
    s_add_u32 s83, s83, 4096
    buffer_load_dwordx4 v153, s[68:71], s83 offen sc1 lds
    v_alignbit_b32 v32, v244, v36, 16
    v_mov_b32 v40, s31
    v_mfma_f32_16x16x32_bf16 v[52:55], v[116:119], a[156:159], v[52:55]
    ds_read2st64_b32 v[20:21], v218 offset0:4 offset1:36
    s_waitcnt vmcnt(4)
    v_mov_b32_dpp v40, v251 wave_shr:1 row_mask:0xf bank_mask:0xf
    v_alignbit_b32 v37, v249, v248, 16
    v_mfma_f32_16x16x32_bf16 v[184:187], v[84:87], a[148:151], v[184:187]
    s_add_u32 m0, s84, 4096
    s_add_u32 s83, s16, 81920
    buffer_load_dwordx4 v159, s[56:59], s83 offen offset:0 lds
    v_alignbit_b32 v38, v250, v249, 16
    v_alignbit_b32 v39, v251, v250, 16
    v_mfma_f32_16x16x32_bf16 v[200:203], v[84:87], a[156:159], v[200:203]
    ds_read_b128 v[84:87], v122 offset:6144
    ds_read2st64_b32 v[22:23], v219 offset0:4 offset1:36
    v_alignbit_b32 v36, v248, v40, 16
    v_mov_b32 v44, s32
    v_mfma_f32_16x16x32_bf16 v[188:191], v[88:91], a[148:151], v[188:191]
    s_nop 0
    v_mov_b32_dpp v44, v255 wave_shr:1 row_mask:0xf bank_mask:0xf
    v_alignbit_b32 v41, v253, v252, 16
    v_mfma_f32_16x16x32_bf16 v[204:207], v[88:91], a[156:159], v[204:207]
    ds_read_b128 v[88:91], v123 offset:6144
    ds_read2st64_b32 v[24:25], v218 offset0:8 offset1:40
    v_alignbit_b32 v42, v254, v253, 16
    v_alignbit_b32 v43, v255, v254, 16
    v_mfma_f32_16x16x32_bf16 v[176:179], v[60:63], a[184:187], v[176:179]
    buffer_load_dwordx4 v159, s[60:63], s83 offen offset:2048 lds
    v_alignbit_b32 v40, v252, v44, 16
    v_mfma_f32_16x16x32_bf16 v[192:195], v[60:63], a[192:195], v[192:195]
    ds_read2st64_b32 v[26:27], v219 offset0:8 offset1:40
    v_mfma_f32_16x16x32_bf16 v[48:51], v[116:119], a[184:187], v[48:51]
    v_mfma_f32_16x16x32_bf16 v[176:179], v[64:67], a[188:191], v[176:179]
    ds_read2st64_b32 v[28:29], v218 offset0:12 offset1:44
    v_mfma_f32_16x16x32_bf16 v[192:195], v[64:67], a[196:199], v[192:195]
    s_add_u32 s83, s83, 4096
    buffer_load_dwordx4 v159, s[56:59], s83 offen offset:1024 lds
    ds_write_b64 v173, v[228:229]
    v_mfma_f32_16x16x32_bf16 v[48:51], v[116:119], a[188:191], v[48:51]
    ds_read2st64_b32 v[30:31], v219 offset0:12 offset1:44
    v_mfma_f32_16x16x32_bf16 v[180:183], v[68:71], a[184:187], v[180:183]
    ds_read2_b32 v[230:231], v222 offset1:32
    v_and_b32 v120, 1, v152
    v_mul_u32_u24 v120, 640, v120
    v_add_u32 v120, v155, v120
    v_mfma_f32_16x16x32_bf16 v[196:199], v[68:71], a[192:195], v[196:199]
    ds_read_b128 v[92:95], v217 offset:768
    ds_read2_b32 v[124:125], v154 offset1:160
    ds_read2_b32 v[126:127], v154 offset0:1 offset1:161
    ds_read_b64 v[128:129], v155 offset:0
    v_mfma_f32_16x16x32_bf16 v[52:55], v[116:119], a[192:195], v[52:55]
    ds_read_b128 v[96:99], v217 offset:784
    buffer_load_dwordx4 v159, s[60:63], s83 offen offset:3072 lds
    s_mov_b64 exec, 0x7fff
    ds_write_b32 v172, v228
    s_mov_b64 exec, -1
    v_mfma_f32_16x16x32_bf16 v[180:183], v[72:75], a[188:191], v[180:183]
    ds_read_b128 v[212:215], v217 offset:528
    ds_read_b64 v[130:131], v120 offset:0
    v_mfma_f32_16x16x32_bf16 v[196:199], v[72:75], a[196:199], v[196:199]
    ds_read_b128 v[208:211], v217 offset:512
    s_waitcnt lgkmcnt(10)
    v_add_f32 v16, v16, v17
    v_add_f32 v18, v18, v19
    v_mfma_f32_16x16x32_bf16 v[52:55], v[116:119], a[196:199], v[52:55]
    ds_read_b128 v[0:3], v216 offset:0
    v_add_f32 v20, v20, v21
    v_add_f32 v22, v22, v23
    v_mfma_f32_16x16x32_bf16 v[184:187], v[76:79], a[184:187], v[184:187]
    ds_read_b128 v[4:7], v216 offset:256
    global_load_dword a255, v242, s[46:47] offset:-2048
    ds_write_b128 v243, v[244:247] offset:38560
    v_add_f32 v24, v24, v25
    v_add_f32 v26, v26, v27
    v_mfma_f32_16x16x32_bf16 v[200:203], v[76:79], a[192:195], v[200:203]
    ds_read_b128 v[8:11], v216 offset:16
    v_add_f32 v28, v28, v29
    v_add_f32 v30, v30, v31
    v_mfma_f32_16x16x32_bf16 v[184:187], v[80:83], a[188:191], v[184:187]
    ds_read_b128 v[12:15], v216 offset:272
    s_waitcnt lgkmcnt(5)
    v_add_f32 v162, v230, v231
    v_fma_f32 v208, v208, v162, v16
    v_mfma_f32_16x16x32_bf16 v[200:203], v[80:83], a[196:199], v[200:203]
    global_load_dword a255, v242, s[46:47] offset:-1024
    v_fma_f32 v209, v209, v162, v18
    v_fma_f32 v210, v210, v162, v20
    v_mfma_f32_16x16x32_bf16 v[188:191], v[84:87], a[184:187], v[188:191]
    ds_write_b128 v243, v[32:35] offset:42720
    v_fma_f32 v211, v211, v162, v22
    v_fma_f32 v212, v212, v162, v24
    v_mfma_f32_16x16x32_bf16 v[204:207], v[84:87], a[192:195], v[204:207]
    v_fma_f32 v213, v213, v162, v26
    v_fma_f32 v214, v214, v162, v28
    v_mfma_f32_16x16x32_bf16 v[188:191], v[88:91], a[188:191], v[188:191]
    global_load_dword a255, v242, s[46:47] offset:0
    v_fma_f32 v215, v215, v162, v30
    v_mul_f32 v208, v92, v208
    v_mfma_f32_16x16x32_bf16 v[204:207], v[88:91], a[196:199], v[204:207]
    v_mul_f32 v209, v93, v209
    v_mul_f32 v210, v94, v210
    v_mul_f32 v211, v95, v211
    v_mul_f32 v212, v96, v212
    global_load_dword a255, v242, s[46:47] offset:1024
    v_mul_f32 v213, v97, v213
    v_mul_f32 v214, v98, v214
    v_mul_f32 v215, v99, v215
    v_mov_b32 v160, v48
    v_mov_b32 v161, v52
    global_load_dword a255, v242, s[46:47] offset:2048
    s_waitcnt lgkmcnt(4)
    v_pk_fma_f32 v[176:177], v[0:1], v[160:161], v[176:177] op_sel_hi:[1,0,1]
    v_pk_fma_f32 v[192:193], v[0:1], v[160:161], v[192:193] op_sel:[0,1,0]
    v_fma_f32 v241, v114, v208, v209
    v_pk_fma_f32 v[178:179], v[2:3], v[160:161], v[178:179] op_sel_hi:[1,0,1]
    v_pk_fma_f32 v[194:195], v[2:3], v[160:161], v[194:195] op_sel:[0,1,0]
    v_pk_mul_f32 v[176:177], v[4:5], v[176:177]
    v_fmac_f32_dpp v241, v208, v115 row_ror:8 row_mask:0xf bank_mask:0xf
    v_pk_mul_f32 v[192:193], v[4:5], v[192:193]
    v_pk_mul_f32 v[178:179], v[6:7], v[178:179]
    v_pk_mul_f32 v[194:195], v[6:7], v[194:195]
    v_fma_f32 v240, v114, v241, v210
    ds_read_b128 v[0:3], v216 offset:32
    ds_read_b128 v[4:7], v216 offset:288
    v_pk_fma_f32 v[236:237], v[176:177], v[112:113], v[178:179] op_sel_hi:[1,0,1]
    v_fmac_f32_dpp v240, v241, v115 row_ror:8 row_mask:0xf bank_mask:0xf
    v_pk_fma_f32 v[238:239], v[192:193], v[112:113], v[194:195] op_sel_hi:[1,0,1]
    v_pk_fma_f32 v[236:237], v[192:193], v[112:113], v[236:237] op_sel:[0,1,0] neg_lo:[1,0,0] neg_hi:[1,0,0]
    v_pk_fma_f32 v[238:239], v[176:177], v[112:113], v[238:239] op_sel:[0,1,0]
    s_waitcnt lgkmcnt(3)
    v_pk_fma_f32 v[180:181], v[8:9], v[160:161], v[180:181] op_sel_hi:[1,0,1]
    v_pk_fma_f32 v[196:197], v[8:9], v[160:161], v[196:197] op_sel:[0,1,0]
    v_fma_f32 v241, v114, v240, v211
    v_pk_fma_f32 v[182:183], v[10:11], v[160:161], v[182:183] op_sel_hi:[1,0,1]
    v_pk_fma_f32 v[198:199], v[10:11], v[160:161], v[198:199] op_sel:[0,1,0]
    v_pk_mul_f32 v[180:181], v[12:13], v[180:181]
    v_fmac_f32_dpp v241, v240, v115 row_ror:8 row_mask:0xf bank_mask:0xf
    v_pk_mul_f32 v[196:197], v[12:13], v[196:197]
    v_pk_mul_f32 v[182:183], v[14:15], v[182:183]
    v_pk_mul_f32 v[198:199], v[14:15], v[198:199]
    v_fma_f32 v240, v114, v241, v212
    ds_read_b128 v[8:11], v216 offset:48
    ds_read_b128 v[12:15], v216 offset:304
    v_pk_fma_f32 v[232:233], v[236:237], v[112:113], v[180:181] op_sel_hi:[1,0,1]
    v_fmac_f32_dpp v240, v241, v115 row_ror:8 row_mask:0xf bank_mask:0xf
    v_pk_fma_f32 v[234:235], v[238:239], v[112:113], v[196:197] op_sel_hi:[1,0,1]
    v_pk_fma_f32 v[232:233], v[238:239], v[112:113], v[232:233] op_sel:[0,1,0] neg_lo:[1,0,0] neg_hi:[1,0,0]
    v_pk_fma_f32 v[234:235], v[236:237], v[112:113], v[234:235] op_sel:[0,1,0]
    v_pk_fma_f32 v[236:237], v[232:233], v[112:113], v[182:183] op_sel_hi:[1,0,1]
    v_pk_fma_f32 v[238:239], v[234:235], v[112:113], v[198:199] op_sel_hi:[1,0,1]
    v_pk_fma_f32 v[236:237], v[234:235], v[112:113], v[236:237] op_sel:[0,1,0] neg_lo:[1,0,0] neg_hi:[1,0,0]
    v_pk_fma_f32 v[238:239], v[232:233], v[112:113], v[238:239] op_sel:[0,1,0]
    s_waitcnt lgkmcnt(2)
    v_pk_fma_f32 v[184:185], v[0:1], v[160:161], v[184:185] op_sel_hi:[1,0,1]
    v_pk_fma_f32 v[200:201], v[0:1], v[160:161], v[200:201] op_sel:[0,1,0]
    v_fma_f32 v241, v114, v240, v213
    v_pk_fma_f32 v[186:187], v[2:3], v[160:161], v[186:187] op_sel_hi:[1,0,1]
    v_pk_fma_f32 v[202:203], v[2:3], v[160:161], v[202:203] op_sel:[0,1,0]
    v_pk_mul_f32 v[184:185], v[4:5], v[184:185]
    v_fmac_f32_dpp v241, v240, v115 row_ror:8 row_mask:0xf bank_mask:0xf
    v_pk_mul_f32 v[200:201], v[4:5], v[200:201]
    v_pk_mul_f32 v[186:187], v[6:7], v[186:187]
    v_pk_mul_f32 v[202:203], v[6:7], v[202:203]
    v_fma_f32 v240, v114, v241, v214
    v_pk_fma_f32 v[232:233], v[236:237], v[112:113], v[184:185] op_sel_hi:[1,0,1]
    v_pk_fma_f32 v[234:235], v[238:239], v[112:113], v[200:201] op_sel_hi:[1,0,1]
    v_pk_fma_f32 v[232:233], v[238:239], v[112:113], v[232:233] op_sel:[0,1,0] neg_lo:[1,0,0] neg_hi:[1,0,0]
    v_fmac_f32_dpp v240, v241, v115 row_ror:8 row_mask:0xf bank_mask:0xf
    v_pk_fma_f32 v[234:235], v[236:237], v[112:113], v[234:235] op_sel:[0,1,0]
    v_pk_fma_f32 v[236:237], v[232:233], v[112:113], v[186:187] op_sel_hi:[1,0,1]
    v_pk_fma_f32 v[238:239], v[234:235], v[112:113], v[202:203] op_sel_hi:[1,0,1]
    v_pk_fma_f32 v[236:237], v[234:235], v[112:113], v[236:237] op_sel:[0,1,0] neg_lo:[1,0,0] neg_hi:[1,0,0]
    v_pk_fma_f32 v[238:239], v[232:233], v[112:113], v[238:239] op_sel:[0,1,0]
    s_waitcnt lgkmcnt(0)
    v_pk_fma_f32 v[188:189], v[8:9], v[160:161], v[188:189] op_sel_hi:[1,0,1]
    v_pk_fma_f32 v[204:205], v[8:9], v[160:161], v[204:205] op_sel:[0,1,0]
    v_fma_f32 v241, v114, v240, v215
    v_pk_fma_f32 v[190:191], v[10:11], v[160:161], v[190:191] op_sel_hi:[1,0,1]
    v_pk_fma_f32 v[206:207], v[10:11], v[160:161], v[206:207] op_sel:[0,1,0]
    v_pk_mul_f32 v[188:189], v[12:13], v[188:189]
    v_fmac_f32_dpp v241, v240, v115 row_ror:8 row_mask:0xf bank_mask:0xf
    v_pk_mul_f32 v[204:205], v[12:13], v[204:205]
    v_pk_mul_f32 v[190:191], v[14:15], v[190:191]
    v_pk_mul_f32 v[206:207], v[14:15], v[206:207]
    v_pk_fma_f32 v[232:233], v[236:237], v[112:113], v[188:189] op_sel_hi:[1,0,1]
    v_pk_fma_f32 v[234:235], v[238:239], v[112:113], v[204:205] op_sel_hi:[1,0,1]
    v_pk_fma_f32 v[232:233], v[238:239], v[112:113], v[232:233] op_sel:[0,1,0] neg_lo:[1,0,0] neg_hi:[1,0,0]
    v_pk_fma_f32 v[234:235], v[236:237], v[112:113], v[234:235] op_sel:[0,1,0]
    v_pk_fma_f32 v[236:237], v[232:233], v[112:113], v[190:191] op_sel_hi:[1,0,1]
    v_pk_fma_f32 v[238:239], v[234:235], v[112:113], v[206:207] op_sel_hi:[1,0,1]
    v_pk_fma_f32 v[236:237], v[234:235], v[112:113], v[236:237] op_sel:[0,1,0] neg_lo:[1,0,0] neg_hi:[1,0,0]
    v_pk_fma_f32 v[238:239], v[232:233], v[112:113], v[238:239] op_sel:[0,1,0]
    v_mul_f32 v219, v104, v241
    v_fma_f32 v216, v100, v236, v237
    v_fma_f32 v217, v100, v238, v239
    v_fmac_f32_dpp v219, v241, v105 row_ror:8 row_mask:0xf bank_mask:0xf
    v_mov_b32_dpp v218, v241 quad_perm:[1,1,3,3] row_mask:0xf bank_mask:0xf
    v_fma_f32 v216, -v101, v238, v216
    v_fmac_f32 v217, v101, v236
    v_add_f32_dpp v218, v219, v218 quad_perm:[0,0,2,2] row_mask:0xf bank_mask:0xf
    v_mov_b64 v[224:225], v[216:217]
    v_mov_b32 v226, v218
    v_mov_b32 v231, s82
    v_permlane32_swap_b32 v216, v224
    v_permlane32_swap_b32 v217, v225
    v_permlane32_swap_b32 v218, v226
    v_mov_b64 v[220:221], v[216:217]
    v_mov_b32 v222, v218
    v_mov_b64 v[228:229], v[224:225]
    v_mov_b32 v230, v226

    v_permlane16_swap_b32 v218, v222
    v_permlane16_swap_b32 v216, v220
    v_permlane16_swap_b32 v217, v221
    v_permlane16_swap_b32 v226, v230
    v_fmac_f32_dpp v222, v218, v107 row_ror:8 row_mask:0xf bank_mask:0xf
    v_pk_fma_f32 v[220:221], v[216:217], v[102:103], v[220:221] op_sel_hi:[1,0,1]
    v_permlane16_swap_b32 v224, v228
    v_fmac_f32 v222, v106, v218
    v_pk_fma_f32 v[220:221], v[216:217], v[102:103], v[220:221] op_sel:[1,1,0] op_sel_hi:[0,1,1] neg_lo:[1,0,0]
    v_permlane16_swap_b32 v225, v229
    v_fmac_f32_dpp v226, v222, v107 row_ror:8 row_mask:0xf bank_mask:0xf
    v_fmac_f32 v226, v106, v222
    v_pk_fma_f32 v[224:225], v[220:221], v[102:103], v[224:225] op_sel_hi:[1,0,1]
    v_pk_fma_f32 v[224:225], v[220:221], v[102:103], v[224:225] op_sel:[1,1,0] op_sel_hi:[0,1,1] neg_lo:[1,0,0]
    v_fmac_f32_dpp v230, v226, v107 row_ror:8 row_mask:0xf bank_mask:0xf
    v_fmac_f32 v230, v106, v226
    v_pk_fma_f32 v[228:229], v[224:225], v[102:103], v[228:229] op_sel_hi:[1,0,1]
    v_pk_fma_f32 v[228:229], v[224:225], v[102:103], v[228:229] op_sel:[1,1,0] op_sel_hi:[0,1,1] neg_lo:[1,0,0]
    s_mov_b64 exec, 0xffff
    buffer_store_dwordx4 v[228:231], v153, s[92:95], s21 offen sc1
    s_mov_b64 exec, -1
    ds_write_b128 v243, v[248:251] offset:46880
    s_add_u32 m0, s84, 8192
    s_add_u32 s83, s17, 81920
    buffer_load_dwordx4 v159, s[56:59], s83 offen offset:0 lds
    ds_write_b128 v243, v[36:39] offset:51040
    buffer_load_dwordx4 v159, s[60:63], s83 offen offset:2048 lds
    ds_write_b128 v243, v[252:255] offset:30240
    ds_write_b128 v243, v[40:43] offset:34400
    s_waitcnt vmcnt(12)
    s_mul_i32 s3, s81, 8064
    s_lshl_b32 s4, s80, 7
    s_add_u32 s3, s3, s4
    s_add_u32 s3, s3, 8320
    v_add_u32 v166, s3, v164
    s_mul_i32 s3, s81, 4864
    s_sub_u32 s3, s3, s4
    s_sub_u32 s3, s3, 9344
    v_add_u32 v167, s3, v165
    v_add_u32 v48, 1024, v164
    v_add_u32 v49, 2048, v164
    v_add_u32 v50, 3072, v164
    s_waitcnt lgkmcnt(0)
    s_barrier
    ds_read2_b32 v[60:61], v164 offset0:128 offset1:129
    v_mov_b32 v219, 0
    ds_read2_b32 v[62:63], v164 offset0:130 offset1:131
    s_add_u32 s83, s83, 4096
    buffer_load_dwordx4 v159, s[56:59], s83 offen offset:1024 lds
    v_xor_b32 v128, v163, v128
    v_xor_b32 v130, v163, v130
    ds_read_b128 v[64:67], v165 offset:3136
    v_mov_b32_dpp v216, v220 quad_perm:[0,1,2,3] row_mask:4 bank_mask:0xf
    v_mov_b32_dpp v217, v221 quad_perm:[0,1,2,3] row_mask:4 bank_mask:0xf
    ds_read2_b32 v[68:69], v164 offset0:0 offset1:1
    v_mov_b32_dpp v218, v222 quad_perm:[0,1,2,3] row_mask:4 bank_mask:0xf
    v_mov_b32_dpp v216, v224 quad_perm:[0,1,2,3] row_mask:8 bank_mask:0xf
    ds_read2_b32 v[70:71], v164 offset0:2 offset1:3
    v_mov_b32_dpp v217, v225 quad_perm:[0,1,2,3] row_mask:8 bank_mask:0xf
    buffer_load_dwordx4 v159, s[60:63], s83 offen offset:3072 lds
    v_mov_b32_dpp v218, v226 quad_perm:[0,1,2,3] row_mask:8 bank_mask:0xf
    ds_read_b128 v[72:75], v165 offset:2624
    v_mov_b32_dpp v216, v219 quad_perm:[0,1,2,3] row_mask:1 bank_mask:0xf
    v_mov_b32_dpp v217, v219 quad_perm:[0,1,2,3] row_mask:1 bank_mask:0xf
    ds_read_b128 v[76:79], v165 offset:1600
    v_mov_b32_dpp v218, v219 quad_perm:[0,1,2,3] row_mask:1 bank_mask:0xf
    v_mul_f32_dpp v223, -v241, v129 row_ror:8 row_mask:0xf bank_mask:0xf
    ds_read_b128 v[80:83], v165 offset:3648
    v_fma_f32 v223, -v128, v241, v223
    v_mul_f32_dpp v252, -v218, v131 row_ror:8 row_mask:0xf bank_mask:0xf
    s_add_u32 m0, s84, 12288
    s_add_u32 s83, s44, 81920
    s_mov_b32 exec_hi, 0
    buffer_load_dwordx4 v159, s[56:59], s83 offen offset:0 lds
    s_mov_b32 exec_hi, -1
    ds_read_b128 v[84:87], v165 offset:1088
    v_pk_mul_f32 v[248:249], v[124:125], v[216:217] op_sel_hi:[1,0]
    v_pk_mul_f32 v[250:251], v[124:125], v[216:217] op_sel:[0,1]
    ds_read2_b32 v[88:89], v48 offset0:0 offset1:1
    v_pk_fma_f32 v[248:249], v[126:127], v[216:217], v[248:249] op_sel:[0,1,0] neg_lo:[1,0,0] neg_hi:[1,0,0]
    v_pk_fma_f32 v[250:251], v[126:127], v[216:217], v[250:251] op_sel_hi:[1,0,1]
    ds_read2_b32 v[90:91], v48 offset0:2 offset1:3
    v_fma_f32 v252, -v130, v218, v252
    v_fmac_f32 v249, v124, v236
    ds_read_b128 v[92:95], v165 offset:2112
    s_mov_b32 exec_hi, 0
    buffer_load_dwordx4 v159, s[60:63], s83 offen offset:2048 lds
    s_mov_b32 exec_hi, -1
    v_fmac_f32 v251, v124, v238
    v_fma_f32 v249, -v126, v238, v249
    ds_read2_b32 v[96:97], v49 offset0:0 offset1:1
    v_fmac_f32 v251, v126, v236
    v_mov_b32_dpp v219, v223 quad_perm:[0,0,2,2] row_mask:0xf bank_mask:0xf
    ds_read2_b32 v[98:99], v49 offset0:2 offset1:3
    s_mov_b32 exec_lo, 0xaaaaaaaa
    s_mov_b32 exec_hi, 0xaaaaaaaa
    v_add_f32 v252, v252, v219
    s_mov_b64 exec, -1
    v_lshrrev_b32 v29, 4, v152
    ds_read_b128 v[100:103], v165 offset:576
    v_and_b32 v253, 0xf0, v153
    s_add_u32 s83, s83, 4096
    s_mov_b32 exec_hi, 0
    buffer_load_dwordx4 v159, s[56:59], s83 offen offset:1024 lds
    s_mov_b32 exec_hi, -1
    v_lshl_add_u32 v253, v29, 11, v253
    ds_read2_b32 v[104:105], v48 offset0:128 offset1:129
    v_add_u32 v253, s21, v253
    v_lshlrev_b32 v29, 3, v29
    ds_read2_b32 v[106:107], v48 offset0:130 offset1:131
    v_sub_u32 v29, s79, v29
    v_med3_i32 v29, v29, 0, 8
    ds_read_b128 v[108:111], v165 offset:64
    v_mul_lo_u32 v254, v29, s82
    v_mul_f32_dpp v2, -v208, v129 row_ror:8 row_mask:0xf bank_mask:0xf
    s_mov_b32 exec_hi, 0
    buffer_load_dwordx4 v159, s[60:63], s83 offen offset:3072 lds
    s_mov_b32 exec_hi, -1
    v_lshrrev_b32 v159, 5, v152
    v_mul_u32_u24 v159, 5056, v159
    v_add_u32 v159, v158, v159
    ds_read2_b32 v[112:113], v49 offset0:128 offset1:129
    v_pk_mul_f32 v[0:1], v[176:177], v[126:127] op_sel_hi:[1,0]
    v_pk_mul_f32 v[176:177], v[176:177], v[124:125] op_sel_hi:[1,0]
    ds_read2_b32 v[114:115], v49 offset0:130 offset1:131
    v_pk_fma_f32 v[176:177], v[192:193], v[126:127], v[176:177] op_sel_hi:[1,0,1] neg_lo:[1,0,0] neg_hi:[1,0,0]
    v_pk_fma_f32 v[192:193], v[192:193], v[124:125], v[0:1] op_sel_hi:[1,0,1]
    ds_read2_b32 v[116:117], v50 offset0:0 offset1:1
    v_fma_f32 v208, -v128, v208, v2
    v_mul_f32_dpp v2, -v209, v129 row_ror:8 row_mask:0xf bank_mask:0xf
    ds_read2_b32 v[118:119], v50 offset0:2 offset1:3
    s_add_u32 m0, s84, 0
    s_add_u32 s83, s17, 0
    buffer_load_dwordx4 v158, s[56:59], s83 offen offset:0 lds
    v_pk_mul_f32 v[0:1], v[178:179], v[126:127] op_sel_hi:[1,0]
    v_pk_mul_f32 v[178:179], v[178:179], v[124:125] op_sel_hi:[1,0]
    ds_read2_b32 v[120:121], v50 offset0:128 offset1:129
    v_pk_fma_f32 v[178:179], v[194:195], v[126:127], v[178:179] op_sel_hi:[1,0,1] neg_lo:[1,0,0] neg_hi:[1,0,0]
    v_pk_fma_f32 v[194:195], v[194:195], v[124:125], v[0:1] op_sel_hi:[1,0,1]
    ds_read2_b32 v[122:123], v50 offset0:130 offset1:131
    v_fma_f32 v209, -v128, v209, v2
    v_mul_f32_dpp v2, -v210, v129 row_ror:8 row_mask:0xf bank_mask:0xf
    v_pk_mul_f32 v[0:1], v[180:181], v[126:127] op_sel_hi:[1,0]
    v_pk_mul_f32 v[180:181], v[180:181], v[124:125] op_sel_hi:[1,0]
    buffer_load_dwordx4 v158, s[60:63], s83 offen offset:2048 lds
    v_pk_fma_f32 v[180:181], v[196:197], v[126:127], v[180:181] op_sel_hi:[1,0,1] neg_lo:[1,0,0] neg_hi:[1,0,0]
    v_pk_fma_f32 v[196:197], v[196:197], v[124:125], v[0:1] op_sel_hi:[1,0,1]
    v_fma_f32 v210, -v128, v210, v2
    v_mul_f32_dpp v2, -v211, v129 row_ror:8 row_mask:0xf bank_mask:0xf
    v_pk_mul_f32 v[0:1], v[182:183], v[126:127] op_sel_hi:[1,0]
    v_pk_mul_f32 v[182:183], v[182:183], v[124:125] op_sel_hi:[1,0]
    v_pk_fma_f32 v[182:183], v[198:199], v[126:127], v[182:183] op_sel_hi:[1,0,1] neg_lo:[1,0,0] neg_hi:[1,0,0]
    v_pk_fma_f32 v[198:199], v[198:199], v[124:125], v[0:1] op_sel_hi:[1,0,1]
    v_fma_f32 v211, -v128, v211, v2
    v_mul_f32_dpp v2, -v212, v129 row_ror:8 row_mask:0xf bank_mask:0xf
    s_add_u32 s83, s83, 9216
    buffer_load_dwordx4 v158, s[56:59], s83 offen offset:1024 lds
    v_pk_mul_f32 v[0:1], v[184:185], v[126:127] op_sel_hi:[1,0]
    v_pk_mul_f32 v[184:185], v[184:185], v[124:125] op_sel_hi:[1,0]
    v_pk_fma_f32 v[184:185], v[200:201], v[126:127], v[184:185] op_sel_hi:[1,0,1] neg_lo:[1,0,0] neg_hi:[1,0,0]
    v_pk_fma_f32 v[200:201], v[200:201], v[124:125], v[0:1] op_sel_hi:[1,0,1]
    v_fma_f32 v212, -v128, v212, v2
    v_mul_f32_dpp v2, -v213, v129 row_ror:8 row_mask:0xf bank_mask:0xf
    v_pk_mul_f32 v[0:1], v[186:187], v[126:127] op_sel_hi:[1,0]
    v_pk_mul_f32 v[186:187], v[186:187], v[124:125] op_sel_hi:[1,0]
    v_pk_fma_f32 v[186:187], v[202:203], v[126:127], v[186:187] op_sel_hi:[1,0,1] neg_lo:[1,0,0] neg_hi:[1,0,0]
    v_pk_fma_f32 v[202:203], v[202:203], v[124:125], v[0:1] op_sel_hi:[1,0,1]
    buffer_load_dwordx4 v158, s[60:63], s83 offen offset:3072 lds
    v_fma_f32 v213, -v128, v213, v2
    v_mul_f32_dpp v2, -v214, v129 row_ror:8 row_mask:0xf bank_mask:0xf
    v_pk_mul_f32 v[0:1], v[188:189], v[126:127] op_sel_hi:[1,0]
    v_pk_mul_f32 v[188:189], v[188:189], v[124:125] op_sel_hi:[1,0]
    v_pk_fma_f32 v[188:189], v[204:205], v[126:127], v[188:189] op_sel_hi:[1,0,1] neg_lo:[1,0,0] neg_hi:[1,0,0]
    v_pk_fma_f32 v[204:205], v[204:205], v[124:125], v[0:1] op_sel_hi:[1,0,1]
    v_fma_f32 v214, -v128, v214, v2
    v_mul_f32_dpp v2, -v215, v129 row_ror:8 row_mask:0xf bank_mask:0xf
    v_pk_mul_f32 v[0:1], v[190:191], v[126:127] op_sel_hi:[1,0]
    v_pk_mul_f32 v[190:191], v[190:191], v[124:125] op_sel_hi:[1,0]
    v_pk_fma_f32 v[190:191], v[206:207], v[126:127], v[190:191] op_sel_hi:[1,0,1] neg_lo:[1,0,0] neg_hi:[1,0,0]
    v_pk_fma_f32 v[206:207], v[206:207], v[124:125], v[0:1] op_sel_hi:[1,0,1]
    v_fma_f32 v215, -v128, v215, v2
    v_add_u32 v129, 1024, v166
    v_add_u32 v130, 2048, v166
    v_add_u32 v131, 3072, v166
    s_cmp_lg_u32 s13, 0
    s_cbranch_scc1 Lv_1
    s_waitcnt lgkmcnt(15)
    s_waitcnt lgkmcnt(9)
    v_mfma_f32_16x16x32_bf16 v[44:47], v[68:71], v[100:103], 0
    buffer_load_dwordx4 v[244:247], v253, s[92:95], 0 offen offset:2048 sc1
    s_waitcnt vmcnt(19)
    v_lshrrev_b32 v29, 4, v152
    v_mul_u32_u24 v29, 640, v29
    v_mfma_f32_16x16x32_bf16 v[32:35], v[60:63], v[72:75], 0
    buffer_load_dwordx4 v[240:243], v253, s[92:95], 0 offen offset:1792 sc1
    ds_read_b128 a[200:203], v156 offset:4096
    v_add_u32 v30, v154, v29
    v_add_u32 v31, v155, v29
    s_waitcnt lgkmcnt(3)
    v_mfma_f32_16x16x32_bf16 v[32:35], v[116:119], v[108:111], v[32:35]
    ds_read_b64 v[4:5], v154 offset:9600
    ds_read_b64 v[6:7], v155 offset:9600
    ds_read_b64 v[8:9], v30 offset:5120
    ds_read_b64 v[10:11], v31 offset:5120
    buffer_load_dwordx4 v[236:239], v253, s[92:95], 0 offen offset:1536 sc1
    ds_read_b128 a[204:207], v157 offset:4096
    v_add_u32 v30, v30, v29
    v_add_u32 v31, v31, v29
    v_mfma_f32_16x16x32_bf16 v[32:35], v[68:71], v[64:67], v[32:35]
    buffer_load_dwordx4 v[232:235], v253, s[92:95], 0 offen offset:1280 sc1
    ds_read_b128 a[208:211], v156 offset:4608
    v_and_b32 v29, 1, v152
    v_mul_u32_u24 v29, 640, v29
    v_mfma_f32_16x16x32_bf16 v[36:39], v[60:63], v[64:67], 0
    ds_read_b128 v[64:67], v165 offset:3072
    buffer_load_dwordx4 v[228:231], v253, s[92:95], 0 offen offset:1024 sc1
    ds_read_b128 a[212:215], v157 offset:4608
    v_add_u32 v31, v31, v29
    v_mfma_f32_16x16x32_bf16 v[36:39], v[88:91], v[72:75], v[36:39]
    ds_read_b128 v[72:75], v165 offset:2560
    ds_read2_b32 v[12:13], v30 offset1:160
    ds_read2_b32 v[14:15], v30 offset0:1 offset1:161
    ds_read_b64 v[16:17], v31 offset:0
    buffer_load_dwordx4 v[224:227], v253, s[92:95], 0 offen offset:768 sc1
    s_waitcnt lgkmcnt(13)
    v_mfma_f32_16x16x32_bf16 v[36:39], v[120:123], v[108:111], v[36:39]
    ds_read2_b32 v[120:121], v50 offset0:144 offset1:145
    ds_read2_b32 v[122:123], v50 offset0:146 offset1:147
    ds_read_b64 v[18:19], v154 offset:7680
    ds_read_b64 v[20:21], v155 offset:7680
    buffer_load_dwordx4 v[220:223], v253, s[92:95], 0 offen offset:512 sc1
    v_mfma_f32_16x16x32_bf16 v[44:47], v[60:63], v[108:111], v[44:47]
    ds_read2_b32 v[60:61], v164 offset0:144 offset1:145
    ds_read2_b32 v[62:63], v164 offset0:146 offset1:147
    s_add_u32 s6, s100, 71680
    buffer_load_dwordx4 v[216:219], v253, s[92:95], 0 offen offset:256 sc1
    v_bfe_u32 v29, v152, 4, 1
    v_lshlrev_b32 v29, 6, v29
    v_mfma_f32_16x16x32_bf16 v[40:43], v[68:71], v[108:111], 0
    ds_read_b128 v[108:111], v165 offset:0
    s_waitcnt lgkmcnt(11)
    s_add_u32 m0, s84, 4096
    s_add_u32 s83, s17, 5120
    buffer_load_dwordx4 v158, s[56:59], s83 offen offset:0 lds
    v_xor_b32 v22, v29, v153
    v_add_u32 v22, s6, v22
    v_mfma_f32_16x16x32_bf16 v[36:39], v[68:71], v[80:83], v[36:39]
    ds_read2_b32 v[68:69], v164 offset0:16 offset1:17
    ds_read2_b32 v[70:71], v164 offset0:18 offset1:19
    ds_read_b128 v[80:83], v165 offset:3584
    v_and_b32 v24, 3, v152
    v_lshl_add_u32 v24, v24, 8, s6
    v_mfma_f32_16x16x32_bf16 v[32:35], v[88:91], v[92:95], v[32:35]
    ds_read2_b32 v[88:89], v48 offset0:16 offset1:17
    ds_read2_b32 v[90:91], v48 offset0:18 offset1:19
    v_lshl_add_u32 v24, v29, 1, v24
    v_bfe_u32 v29, v152, 2, 2
    v_mfma_f32_16x16x32_bf16 v[36:39], v[104:107], v[92:95], v[36:39]
    ds_read_b128 v[92:95], v165 offset:2048
    v_lshl_add_u32 v24, v29, 4, v24
    v_lshrrev_b32 v23, 5, v152
    v_mfma_f32_16x16x32_bf16 v[36:39], v[96:99], v[76:79], v[36:39]
    buffer_load_dwordx4 v158, s[60:63], s83 offen offset:2048 lds
    v_lshl_add_u32 v24, v23, 3, v24
    v_and_b32 v29, 1, v152
    v_mfma_f32_16x16x32_bf16 v[32:35], v[104:107], v[76:79], v[32:35]
    ds_read2_b32 v[104:105], v48 offset0:144 offset1:145
    ds_read2_b32 v[106:107], v48 offset0:146 offset1:147
    ds_read_b128 v[76:79], v165 offset:1536
    v_lshl_add_u32 v24, v29, 6, v24
    v_xor_b32 v25, 64, v24
    v_mfma_f32_16x16x32_bf16 v[36:39], v[112:115], v[84:87], v[36:39]
    s_lshl_b32 s3, s77, 10
    s_add_u32 s3, s3, 94016
    v_lshl_add_u32 v26, v29, 2, s3
    v_lshlrev_b32 v28, 5, v29
    v_mfma_f32_16x16x32_bf16 v[32:35], v[96:99], v[84:87], v[32:35]
    ds_read2_b32 v[96:97], v49 offset0:16 offset1:17
    ds_read2_b32 v[98:99], v49 offset0:18 offset1:19
    ds_read_b128 v[84:87], v165 offset:1024
    v_bfe_u32 v29, v152, 1, 3
    v_lshl_add_u32 v26, v29, 5, v26
    v_mfma_f32_16x16x32_bf16 v[36:39], v[116:119], v[100:103], v[36:39]
    ds_read2_b32 v[116:117], v50 offset0:16 offset1:17
    ds_read2_b32 v[118:119], v50 offset0:18 offset1:19
    s_add_u32 s83, s83, 9216
    buffer_load_dwordx4 v158, s[56:59], s83 offen offset:1024 lds
    v_and_b32 v29, 1, v29
    v_lshl_add_u32 v28, v29, 4, v28
    v_mfma_f32_16x16x32_bf16 v[32:35], v[112:115], v[100:103], v[32:35]
    ds_read2_b32 v[112:113], v49 offset0:144 offset1:145
    ds_read2_b32 v[114:115], v49 offset0:146 offset1:147
    ds_read_b128 v[100:103], v165 offset:512
    v_and_b32 v29, 0xc0, v153
    v_add_u32 v28, v29, v28
    s_waitcnt lgkmcnt(15)
    v_mfma_f32_16x16x32_bf16 v[32:35], v[60:63], v[72:75], v[32:35]
    v_lshrrev_b32 v29, 4, v152
    v_lshl_add_u32 v26, v29, 3, v26
    v_mfma_f32_16x16x32_bf16 v[40:43], v[68:71], v[108:111], v[40:43]
    v_lshl_add_u32 v27, v29, 7, s3
    v_lshl_add_u32 v27, v152, 3, v27
    s_waitcnt lgkmcnt(14)
    v_mfma_f32_16x16x32_bf16 v[36:39], v[68:71], v[80:83], v[36:39]
    ds_read_b128 v[80:83], v167 offset:3776
    buffer_load_dwordx4 v158, s[60:63], s83 offen offset:3072 lds
    v_mul_u32_u24 v29, 40960, v29
    v_add_u32 v28, v29, v28
    v_mfma_f32_16x16x32_bf16 v[32:35], v[68:71], v[64:67], v[32:35]
    v_xor_b32 v7, v163, v7
    v_xor_b32 v11, v163, v11
    v_mfma_f32_16x16x32_bf16 v[36:39], v[60:63], v[64:67], v[36:39]
    ds_read_b128 v[64:67], v167 offset:3264
    v_xor_b32 v16, v163, v16
    v_xor_b32 v21, v163, v21
    v_mfma_f32_16x16x32_bf16 v[44:47], v[60:63], v[108:111], v[44:47]
    ds_read2_b32 v[60:61], v166 offset0:128 offset1:129
    ds_read2_b32 v[62:63], v166 offset0:130 offset1:131
    s_lshl_b32 s3, s77, 10
    s_add_u32 s3, s3, 0
    v_add_u32 v170, s3, v153
    s_waitcnt lgkmcnt(15)
    v_mfma_f32_16x16x32_bf16 v[36:39], v[88:91], v[72:75], v[36:39]
    ds_read_b128 v[72:75], v167 offset:2752
    s_waitcnt lgkmcnt(11)
    v_mfma_f32_16x16x32_bf16 v[36:39], v[96:99], v[76:79], v[36:39]
    s_waitcnt lgkmcnt(8)
    v_mfma_f32_16x16x32_bf16 v[32:35], v[116:119], v[108:111], v[32:35]
    s_waitcnt lgkmcnt(5)
    v_mfma_f32_16x16x32_bf16 v[44:47], v[68:71], v[100:103], v[44:47]
    ds_read2_b32 v[68:69], v166 offset0:0 offset1:1
    ds_read2_b32 v[70:71], v166 offset0:2 offset1:3
    v_mfma_f32_16x16x32_bf16 v[32:35], v[104:107], v[76:79], v[32:35]
    ds_read_b128 v[76:79], v167 offset:1728
    v_mfma_f32_16x16x32_bf16 v[32:35], v[96:99], v[84:87], v[32:35]
    ds_read2_b32 v[96:97], v130 offset0:0 offset1:1
    ds_read2_b32 v[98:99], v130 offset0:2 offset1:3
    v_mfma_f32_16x16x32_bf16 v[36:39], v[112:115], v[84:87], v[36:39]
    ds_read_b128 v[84:87], v167 offset:1216
    v_mfma_f32_16x16x32_bf16 v[32:35], v[88:91], v[92:95], v[32:35]
    ds_read2_b32 v[88:89], v129 offset0:0 offset1:1
    ds_read2_b32 v[90:91], v129 offset0:2 offset1:3
    v_mfma_f32_16x16x32_bf16 v[36:39], v[120:123], v[108:111], v[36:39]
    ds_read_b128 v[108:111], v167 offset:192
    ds_read2_b32 v[120:121], v131 offset0:128 offset1:129
    ds_read2_b32 v[122:123], v131 offset0:130 offset1:131
    v_mfma_f32_16x16x32_bf16 v[36:39], v[104:107], v[92:95], v[36:39]
    ds_read_b128 v[92:95], v167 offset:2240
    ds_read2_b32 v[104:105], v129 offset0:128 offset1:129
    ds_read2_b32 v[106:107], v129 offset0:130 offset1:131
    v_mfma_f32_16x16x32_bf16 v[32:35], v[112:115], v[100:103], v[32:35]
    ds_read2_b32 v[112:113], v130 offset0:128 offset1:129
    ds_read2_b32 v[114:115], v130 offset0:130 offset1:131
    v_mfma_f32_16x16x32_bf16 v[36:39], v[116:119], v[100:103], v[36:39]
    ds_read_b128 v[100:103], v167 offset:704
    ds_read2_b32 v[116:117], v131 offset0:0 offset1:1
    ds_read2_b32 v[118:119], v131 offset0:2 offset1:3
    s_branch Lw_1
Lv_1:
    s_waitcnt lgkmcnt(15)
    v_mfma_f32_16x16x32_bf16 v[32:35], v[60:63], v[76:79], 0
    buffer_load_dwordx4 v[244:247], v253, s[92:95], 0 offen offset:2048 sc1
    s_waitcnt vmcnt(19)
    v_lshrrev_b32 v29, 4, v152
    v_mul_u32_u24 v29, 640, v29
    v_mfma_f32_16x16x32_bf16 v[44:47], v[60:63], v[84:87], 0
    buffer_load_dwordx4 v[240:243], v253, s[92:95], 0 offen offset:1792 sc1
    ds_read_b128 a[200:203], v156 offset:4096
    v_add_u32 v30, v154, v29
    v_add_u32 v31, v155, v29
    v_mfma_f32_16x16x32_bf16 v[36:39], v[68:71], v[72:75], 0
    ds_read_b128 v[72:75], v165 offset:2560
    ds_read_b128 v[64:67], v167 offset:3264
    ds_read_b128 v[80:83], v167 offset:3776
    ds_read2_b32 v[116:117], v131 offset0:0 offset1:1
    ds_read2_b32 v[118:119], v131 offset0:2 offset1:3
    ds_read2_b32 v[120:121], v131 offset0:128 offset1:129
    ds_read2_b32 v[122:123], v131 offset0:130 offset1:131
    buffer_load_dwordx4 v[236:239], v253, s[92:95], 0 offen offset:1536 sc1
    ds_read_b128 a[204:207], v157 offset:4096
    v_mfma_f32_16x16x32_bf16 v[44:47], v[68:71], v[76:79], v[44:47]
    ds_read_b64 v[4:5], v154 offset:9600
    ds_read_b64 v[6:7], v155 offset:9600
    ds_read_b64 v[8:9], v30 offset:5120
    ds_read_b64 v[10:11], v31 offset:5120
    buffer_load_dwordx4 v[232:235], v253, s[92:95], 0 offen offset:1280 sc1
    ds_read_b128 a[208:211], v156 offset:4608
    v_add_u32 v30, v30, v29
    v_add_u32 v31, v31, v29
    s_waitcnt lgkmcnt(15)
    v_mfma_f32_16x16x32_bf16 v[40:43], v[60:63], v[100:103], 0
    buffer_load_dwordx4 v[228:231], v253, s[92:95], 0 offen offset:1024 sc1
    ds_read_b128 a[212:215], v157 offset:4608
    v_and_b32 v29, 1, v152
    v_mul_u32_u24 v29, 640, v29
    v_mfma_f32_16x16x32_bf16 v[36:39], v[60:63], v[92:95], v[36:39]
    ds_read2_b32 v[60:61], v164 offset0:144 offset1:145
    ds_read2_b32 v[62:63], v164 offset0:146 offset1:147
    buffer_load_dwordx4 v[224:227], v253, s[92:95], 0 offen offset:768 sc1
    v_add_u32 v31, v31, v29
    v_mfma_f32_16x16x32_bf16 v[36:39], v[104:107], v[84:87], v[36:39]
    ds_read2_b32 v[12:13], v30 offset1:160
    ds_read2_b32 v[14:15], v30 offset0:1 offset1:161
    ds_read_b64 v[16:17], v31 offset:0
    ds_read_b64 v[18:19], v154 offset:7680
    buffer_load_dwordx4 v[220:223], v253, s[92:95], 0 offen offset:512 sc1
    v_mfma_f32_16x16x32_bf16 v[40:43], v[68:71], v[84:87], v[40:43]
    ds_read_b64 v[20:21], v155 offset:7680
    s_add_u32 s6, s100, 71680
    buffer_load_dwordx4 v[216:219], v253, s[92:95], 0 offen offset:256 sc1
    v_bfe_u32 v29, v152, 4, 1
    v_lshlrev_b32 v29, 6, v29
    v_mfma_f32_16x16x32_bf16 v[36:39], v[88:91], v[76:79], v[36:39]
    ds_read_b128 v[76:79], v165 offset:1536
    s_waitcnt lgkmcnt(8)
    s_add_u32 m0, s84, 4096
    s_add_u32 s83, s17, 5120
    buffer_load_dwordx4 v158, s[56:59], s83 offen offset:0 lds
    v_xor_b32 v22, v29, v153
    v_add_u32 v22, s6, v22
    v_mfma_f32_16x16x32_bf16 v[32:35], v[68:71], v[92:95], v[32:35]
    ds_read2_b32 v[68:69], v164 offset0:16 offset1:17
    ds_read2_b32 v[70:71], v164 offset0:18 offset1:19
    ds_read_b128 v[92:95], v165 offset:2048
    v_and_b32 v24, 3, v152
    v_lshl_add_u32 v24, v24, 8, s6
    v_mfma_f32_16x16x32_bf16 v[32:35], v[104:107], v[100:103], v[32:35]
    v_lshl_add_u32 v24, v29, 1, v24
    v_bfe_u32 v29, v152, 2, 2
    v_mfma_f32_16x16x32_bf16 v[40:43], v[88:91], v[108:111], v[40:43]
    v_lshl_add_u32 v24, v29, 4, v24
    v_lshrrev_b32 v23, 5, v152
    v_mfma_f32_16x16x32_bf16 v[32:35], v[88:91], v[84:87], v[32:35]
    ds_read_b128 v[84:87], v165 offset:1024
    buffer_load_dwordx4 v158, s[60:63], s83 offen offset:2048 lds
    v_lshl_add_u32 v24, v23, 3, v24
    v_and_b32 v29, 1, v152
    v_mfma_f32_16x16x32_bf16 v[36:39], v[96:99], v[100:103], v[36:39]
    v_lshl_add_u32 v24, v29, 6, v24
    v_xor_b32 v25, 64, v24
    v_mfma_f32_16x16x32_bf16 v[44:47], v[88:91], v[100:103], v[44:47]
    ds_read2_b32 v[88:89], v48 offset0:16 offset1:17
    ds_read2_b32 v[90:91], v48 offset0:18 offset1:19
    ds_read_b128 v[100:103], v165 offset:512
    s_lshl_b32 s3, s77, 10
    v_mfma_f32_16x16x32_bf16 v[32:35], v[96:99], v[108:111], v[32:35]
    ds_read2_b32 v[96:97], v49 offset0:16 offset1:17
    ds_read2_b32 v[98:99], v49 offset0:18 offset1:19
    s_add_u32 s3, s3, 94016
    v_lshl_add_u32 v26, v29, 2, s3
    v_lshlrev_b32 v28, 5, v29
    v_mfma_f32_16x16x32_bf16 v[36:39], v[112:115], v[108:111], v[36:39]
    ds_read2_b32 v[112:113], v49 offset0:144 offset1:145
    ds_read2_b32 v[114:115], v49 offset0:146 offset1:147
    s_add_u32 s83, s83, 9216
    buffer_load_dwordx4 v158, s[56:59], s83 offen offset:1024 lds
    v_bfe_u32 v29, v152, 1, 3
    v_lshl_add_u32 v26, v29, 5, v26
    v_mfma_f32_16x16x32_bf16 v[44:47], v[104:107], v[108:111], v[44:47]
    ds_read2_b32 v[104:105], v48 offset0:144 offset1:145
    ds_read2_b32 v[106:107], v48 offset0:146 offset1:147
    ds_read_b128 v[108:111], v165 offset:0
    v_and_b32 v29, 1, v29
    v_lshl_add_u32 v28, v29, 4, v28
    s_waitcnt lgkmcnt(15)
    s_waitcnt lgkmcnt(14)
    v_mfma_f32_16x16x32_bf16 v[32:35], v[60:63], v[76:79], v[32:35]
    v_and_b32 v29, 0xc0, v153
    v_add_u32 v28, v29, v28
    s_waitcnt lgkmcnt(12)
    v_mfma_f32_16x16x32_bf16 v[36:39], v[68:71], v[72:75], v[36:39]
    ds_read_b128 v[72:75], v167 offset:2752
    v_lshrrev_b32 v29, 4, v152
    v_lshl_add_u32 v26, v29, 3, v26
    s_waitcnt lgkmcnt(12)
    v_mfma_f32_16x16x32_bf16 v[32:35], v[68:71], v[92:95], v[32:35]
    buffer_load_dwordx4 v158, s[60:63], s83 offen offset:3072 lds
    v_lshl_add_u32 v27, v29, 7, s3
    v_lshl_add_u32 v27, v152, 3, v27
    v_mfma_f32_16x16x32_bf16 v[36:39], v[60:63], v[92:95], v[36:39]
    ds_read_b128 v[92:95], v167 offset:2240
    v_mul_u32_u24 v29, 40960, v29
    v_add_u32 v28, v29, v28
    s_waitcnt lgkmcnt(12)
    v_mfma_f32_16x16x32_bf16 v[40:43], v[68:71], v[84:87], v[40:43]
    v_xor_b32 v7, v163, v7
    v_xor_b32 v11, v163, v11
    v_mfma_f32_16x16x32_bf16 v[44:47], v[68:71], v[76:79], v[44:47]
    ds_read2_b32 v[68:69], v166 offset0:0 offset1:1
    ds_read2_b32 v[70:71], v166 offset0:2 offset1:3
    v_xor_b32 v16, v163, v16
    v_xor_b32 v21, v163, v21
    s_waitcnt lgkmcnt(12)
    v_mfma_f32_16x16x32_bf16 v[36:39], v[88:91], v[76:79], v[36:39]
    ds_read_b128 v[76:79], v167 offset:1728
    s_lshl_b32 s3, s77, 10
    s_add_u32 s3, s3, 0
    v_add_u32 v170, s3, v153
    v_mfma_f32_16x16x32_bf16 v[44:47], v[60:63], v[84:87], v[44:47]
    s_waitcnt lgkmcnt(12)
    v_mfma_f32_16x16x32_bf16 v[40:43], v[60:63], v[100:103], v[40:43]
    ds_read2_b32 v[60:61], v166 offset0:128 offset1:129
    ds_read2_b32 v[62:63], v166 offset0:130 offset1:131
    v_mfma_f32_16x16x32_bf16 v[44:47], v[88:91], v[100:103], v[44:47]
    s_waitcnt lgkmcnt(8)
    s_waitcnt lgkmcnt(7)
    v_mfma_f32_16x16x32_bf16 v[44:47], v[104:107], v[108:111], v[44:47]
    v_mfma_f32_16x16x32_bf16 v[40:43], v[88:91], v[108:111], v[40:43]
    v_mfma_f32_16x16x32_bf16 v[32:35], v[88:91], v[84:87], v[32:35]
    ds_read2_b32 v[88:89], v129 offset0:0 offset1:1
    ds_read2_b32 v[90:91], v129 offset0:2 offset1:3
    v_mfma_f32_16x16x32_bf16 v[36:39], v[104:107], v[84:87], v[36:39]
    ds_read_b128 v[84:87], v167 offset:1216
    v_mfma_f32_16x16x32_bf16 v[32:35], v[96:99], v[108:111], v[32:35]
    v_mfma_f32_16x16x32_bf16 v[32:35], v[104:107], v[100:103], v[32:35]
    ds_read2_b32 v[104:105], v129 offset0:128 offset1:129
    ds_read2_b32 v[106:107], v129 offset0:130 offset1:131
    v_mfma_f32_16x16x32_bf16 v[36:39], v[112:115], v[108:111], v[36:39]
    ds_read_b128 v[108:111], v167 offset:192
    ds_read2_b32 v[112:113], v130 offset0:128 offset1:129
    ds_read2_b32 v[114:115], v130 offset0:130 offset1:131
    v_mfma_f32_16x16x32_bf16 v[36:39], v[96:99], v[100:103], v[36:39]
    ds_read2_b32 v[96:97], v130 offset0:0 offset1:1
    ds_read2_b32 v[98:99], v130 offset0:2 offset1:3
    ds_read_b128 v[100:103], v167 offset:704
Lw_1:
L_cchk0:
    s_waitcnt vmcnt(10)
    v_fmac_f32_dpp v242, v246, v7 row_ror:8 row_mask:0xf bank_mask:0xf
    v_fmac_f32 v242, v6, v246
    v_pk_fma_f32 v[240:241], v[244:245], v[4:5], v[240:241] op_sel_hi:[1,0,1]
    v_pk_fma_f32 v[240:241], v[244:245], v[4:5], v[240:241] op_sel:[1,1,0] op_sel_hi:[0,1,1] neg_lo:[1,0,0]
    s_waitcnt vmcnt(9)
    v_add3_u32 v169, v247, v243, v239
    v_fmac_f32_dpp v238, v242, v7 row_ror:8 row_mask:0xf bank_mask:0xf
    v_fmac_f32 v238, v6, v242
    v_pk_fma_f32 v[236:237], v[240:241], v[4:5], v[236:237] op_sel_hi:[1,0,1]
    v_pk_fma_f32 v[236:237], v[240:241], v[4:5], v[236:237] op_sel:[1,1,0] op_sel_hi:[0,1,1] neg_lo:[1,0,0]
    s_waitcnt vmcnt(8)
    v_fmac_f32_dpp v234, v238, v7 row_ror:8 row_mask:0xf bank_mask:0xf
    v_fmac_f32 v234, v6, v238
    v_pk_fma_f32 v[232:233], v[236:237], v[4:5], v[232:233] op_sel_hi:[1,0,1]
    v_pk_fma_f32 v[232:233], v[236:237], v[4:5], v[232:233] op_sel:[1,1,0] op_sel_hi:[0,1,1] neg_lo:[1,0,0]
    s_waitcnt vmcnt(7)
    v_add3_u32 v169, v169, v235, v231
    v_fmac_f32_dpp v230, v234, v7 row_ror:8 row_mask:0xf bank_mask:0xf
    v_fmac_f32 v230, v6, v234
    v_pk_fma_f32 v[228:229], v[232:233], v[4:5], v[228:229] op_sel_hi:[1,0,1]
    v_pk_fma_f32 v[228:229], v[232:233], v[4:5], v[228:229] op_sel:[1,1,0] op_sel_hi:[0,1,1] neg_lo:[1,0,0]
    s_waitcnt vmcnt(6)
    v_fmac_f32_dpp v226, v230, v7 row_ror:8 row_mask:0xf bank_mask:0xf
    v_fmac_f32 v226, v6, v230
    v_pk_fma_f32 v[224:225], v[228:229], v[4:5], v[224:225] op_sel_hi:[1,0,1]
    v_pk_fma_f32 v[224:225], v[228:229], v[4:5], v[224:225] op_sel:[1,1,0] op_sel_hi:[0,1,1] neg_lo:[1,0,0]
    s_waitcnt vmcnt(5)
    v_add3_u32 v169, v169, v227, v223
    v_fmac_f32_dpp v222, v226, v7 row_ror:8 row_mask:0xf bank_mask:0xf
    v_fmac_f32 v222, v6, v226
    v_pk_fma_f32 v[220:221], v[224:225], v[4:5], v[220:221] op_sel_hi:[1,0,1]
    v_pk_fma_f32 v[220:221], v[224:225], v[4:5], v[220:221] op_sel:[1,1,0] op_sel_hi:[0,1,1] neg_lo:[1,0,0]
    s_waitcnt vmcnt(4)
    v_add_u32 v169, v169, v219
    v_cmp_ne_u32 vcc, v169, v254
    v_fmac_f32_dpp v218, v222, v7 row_ror:8 row_mask:0xf bank_mask:0xf
    v_fmac_f32 v218, v6, v222
    v_pk_fma_f32 v[216:217], v[220:221], v[4:5], v[216:217] op_sel_hi:[1,0,1]
    v_pk_fma_f32 v[216:217], v[220:221], v[4:5], v[216:217] op_sel:[1,1,0] op_sel_hi:[0,1,1] neg_lo:[1,0,0]
    s_cbranch_vccnz L_cre0
    v_mul_f32_dpp v222, v218, v11 row_ror:8 row_mask:0xf bank_mask:0xf
    v_pk_mul_f32 v[220:221], v[216:217], v[8:9] op_sel_hi:[1,0]
    v_fmac_f32 v222, v10, v218
    v_pk_fma_f32 v[220:221], v[216:217], v[8:9], v[220:221] op_sel:[1,1,0] op_sel_hi:[0,1,1] neg_lo:[1,0,0]

    v_mov_b32 v226, v222
    v_mov_b64 v[224:225], v[220:221]
    s_nop 0
    v_permlane32_swap_b32 v222, v226
    v_permlane32_swap_b32 v220, v224
    v_permlane32_swap_b32 v221, v225
    v_add_f32 v222, v222, v226
    v_pk_add_f32 v[220:221], v[220:221], v[224:225]

    v_mov_b32 v226, v222
    v_mov_b64 v[224:225], v[220:221]
    s_nop 0
    v_permlane16_swap_b32 v222, v226
    v_permlane16_swap_b32 v220, v224
    v_permlane16_swap_b32 v221, v225
    v_add_f32 v222, v222, v226
    v_pk_add_f32 v[220:221], v[220:221], v[224:225]

    v_fma_f32 v252, -v16, v222, v252
    v_pk_fma_f32 v[248:249], v[12:13], v[220:221], v[248:249] op_sel_hi:[1,0,1]
    v_pk_fma_f32 v[250:251], v[12:13], v[220:221], v[250:251] op_sel:[0,1,0]
    v_fmac_f32_dpp v252, -v222, v17 row_ror:8 row_mask:0xf bank_mask:0xf
    v_pk_fma_f32 v[248:249], v[14:15], v[220:221], v[248:249] op_sel:[0,1,0] neg_lo:[1,0,0] neg_hi:[1,0,0]
    v_pk_fma_f32 v[250:251], v[14:15], v[220:221], v[250:251] op_sel_hi:[1,0,1]

    s_cmp_eq_u32 s88, 0
    s_cbranch_scc1 L_p2s0
    v_fmac_f32_dpp v208, -v252, v21 row_ror:8 row_mask:0xf bank_mask:0xf
    v_fmac_f32 v208, v20, v252
    v_pk_fma_f32 v[176:177], v[248:249], v[18:19], v[176:177] op_sel_hi:[1,0,1]
    v_pk_fma_f32 v[192:193], v[250:251], v[18:19], v[192:193] op_sel_hi:[1,0,1]
    v_fmac_f32_dpp v209, -v208, v21 row_ror:8 row_mask:0xf bank_mask:0xf
    v_fmac_f32 v209, v20, v208
    v_pk_fma_f32 v[176:177], v[250:251], v[18:19], v[176:177] op_sel:[0,1,0] neg_lo:[1,0,0] neg_hi:[1,0,0]
    v_pk_fma_f32 v[192:193], v[248:249], v[18:19], v[192:193] op_sel:[0,1,0]
    v_fmac_f32_dpp v210, -v209, v21 row_ror:8 row_mask:0xf bank_mask:0xf
    v_fmac_f32 v210, v20, v209
    v_pk_fma_f32 v[178:179], v[176:177], v[18:19], v[178:179] op_sel_hi:[1,0,1]
    v_pk_fma_f32 v[194:195], v[192:193], v[18:19], v[194:195] op_sel_hi:[1,0,1]
    v_fmac_f32_dpp v211, -v210, v21 row_ror:8 row_mask:0xf bank_mask:0xf
    v_fmac_f32 v211, v20, v210
    v_pk_fma_f32 v[178:179], v[192:193], v[18:19], v[178:179] op_sel:[0,1,0] neg_lo:[1,0,0] neg_hi:[1,0,0]
    v_pk_fma_f32 v[194:195], v[176:177], v[18:19], v[194:195] op_sel:[0,1,0]
    v_cvt_pk_bf16_f32 v232, v176, v177
    v_cvt_pk_bf16_f32 v233, v178, v179
    v_cvt_pk_bf16_f32 v234, -v192, -v193
    v_cvt_pk_bf16_f32 v235, -v194, -v195

    ds_write_b128 v22, v[232:235] offset:0
    ds_read_b64_tr_b16 v[216:217], v24 offset:0
    ds_read_b64_tr_b16 v[218:219], v25 offset:0
    v_fmac_f32_dpp v212, -v211, v21 row_ror:8 row_mask:0xf bank_mask:0xf
    v_fmac_f32 v212, v20, v211
    v_pk_fma_f32 v[180:181], v[178:179], v[18:19], v[180:181] op_sel_hi:[1,0,1]
    v_pk_fma_f32 v[196:197], v[194:195], v[18:19], v[196:197] op_sel_hi:[1,0,1]
    v_fmac_f32_dpp v213, -v212, v21 row_ror:8 row_mask:0xf bank_mask:0xf
    v_fmac_f32 v213, v20, v212
    v_pk_fma_f32 v[180:181], v[194:195], v[18:19], v[180:181] op_sel:[0,1,0] neg_lo:[1,0,0] neg_hi:[1,0,0]
    v_pk_fma_f32 v[196:197], v[178:179], v[18:19], v[196:197] op_sel:[0,1,0]
    v_fmac_f32_dpp v214, -v213, v21 row_ror:8 row_mask:0xf bank_mask:0xf
    v_fmac_f32 v214, v20, v213
    v_pk_fma_f32 v[182:183], v[180:181], v[18:19], v[182:183] op_sel_hi:[1,0,1]
    v_pk_fma_f32 v[198:199], v[196:197], v[18:19], v[198:199] op_sel_hi:[1,0,1]
    v_fmac_f32_dpp v215, -v214, v21 row_ror:8 row_mask:0xf bank_mask:0xf
    v_fmac_f32 v215, v20, v214
    v_pk_fma_f32 v[182:183], v[196:197], v[18:19], v[182:183] op_sel:[0,1,0] neg_lo:[1,0,0] neg_hi:[1,0,0]
    v_pk_fma_f32 v[198:199], v[180:181], v[18:19], v[198:199] op_sel:[0,1,0]
    v_cvt_pk_bf16_f32 v236, v180, v181
    v_cvt_pk_bf16_f32 v237, v182, v183
    v_cvt_pk_bf16_f32 v238, -v196, -v197
    v_cvt_pk_bf16_f32 v239, -v198, -v199

    ds_write_b128 v22, v[236:239] offset:1024
    ds_read_b64_tr_b16 v[220:221], v24 offset:1024
    ds_read_b64_tr_b16 v[222:223], v25 offset:1024
    v_pk_fma_f32 v[184:185], v[182:183], v[18:19], v[184:185] op_sel_hi:[1,0,1]
    v_pk_fma_f32 v[200:201], v[198:199], v[18:19], v[200:201] op_sel_hi:[1,0,1]
    v_pk_fma_f32 v[184:185], v[198:199], v[18:19], v[184:185] op_sel:[0,1,0] neg_lo:[1,0,0] neg_hi:[1,0,0]
    v_pk_fma_f32 v[200:201], v[182:183], v[18:19], v[200:201] op_sel:[0,1,0]
    v_cvt_pk_bf16_f32 v240, v208, v209
    v_cvt_pk_bf16_f32 v241, v210, v211
    v_cvt_pk_bf16_f32 v242, v212, v213
    v_cvt_pk_bf16_f32 v243, v214, v215
    ds_write2st64_b32 v26, v240, v241 offset0:0 offset1:1
    ds_write2st64_b32 v26, v242, v243 offset0:2 offset1:3
    ds_read_b64_tr_b16 v[244:245], v27 offset:0
    ds_read_b64_tr_b16 v[246:247], v27 offset:128
    v_pk_fma_f32 v[186:187], v[184:185], v[18:19], v[186:187] op_sel_hi:[1,0,1]
    v_pk_fma_f32 v[202:203], v[200:201], v[18:19], v[202:203] op_sel_hi:[1,0,1]
    v_pk_fma_f32 v[186:187], v[200:201], v[18:19], v[186:187] op_sel:[0,1,0] neg_lo:[1,0,0] neg_hi:[1,0,0]
    v_pk_fma_f32 v[202:203], v[184:185], v[18:19], v[202:203] op_sel:[0,1,0]
    v_cvt_pk_bf16_f32 v232, v184, v185
    v_cvt_pk_bf16_f32 v233, v186, v187
    v_cvt_pk_bf16_f32 v234, -v200, -v201
    v_cvt_pk_bf16_f32 v235, -v202, -v203

    ds_write_b128 v22, v[232:235] offset:0
    ds_read_b64_tr_b16 v[224:225], v24 offset:0
    ds_read_b64_tr_b16 v[226:227], v25 offset:0
    s_waitcnt lgkmcnt(10)
    v_and_b32 v216, -2, v216
    v_and_b32 v218, -2, v218
    buffer_store_dwordx4 v[216:219], v153, s[64:67], s36 offen
    v_pk_fma_f32 v[188:189], v[186:187], v[18:19], v[188:189] op_sel_hi:[1,0,1]
    v_pk_fma_f32 v[204:205], v[202:203], v[18:19], v[204:205] op_sel_hi:[1,0,1]
    v_pk_fma_f32 v[188:189], v[202:203], v[18:19], v[188:189] op_sel:[0,1,0] neg_lo:[1,0,0] neg_hi:[1,0,0]
    v_pk_fma_f32 v[204:205], v[186:187], v[18:19], v[204:205] op_sel:[0,1,0]
    v_pk_fma_f32 v[190:191], v[188:189], v[18:19], v[190:191] op_sel_hi:[1,0,1]
    v_pk_fma_f32 v[206:207], v[204:205], v[18:19], v[206:207] op_sel_hi:[1,0,1]
    v_pk_fma_f32 v[190:191], v[204:205], v[18:19], v[190:191] op_sel:[0,1,0] neg_lo:[1,0,0] neg_hi:[1,0,0]
    v_pk_fma_f32 v[206:207], v[188:189], v[18:19], v[206:207] op_sel:[0,1,0]
    v_cvt_pk_bf16_f32 v236, v188, v189
    v_cvt_pk_bf16_f32 v237, v190, v191
    v_cvt_pk_bf16_f32 v238, -v204, -v205
    v_cvt_pk_bf16_f32 v239, -v206, -v207

    ds_write_b128 v22, v[236:239] offset:1024
    ds_read_b64_tr_b16 v[228:229], v24 offset:1024
    ds_read_b64_tr_b16 v[230:231], v25 offset:1024
    s_waitcnt lgkmcnt(10)
    v_and_b32 v220, -2, v220
    v_and_b32 v222, -2, v222
    buffer_store_dwordx4 v[220:223], v153, s[64:67], s18 offen
    s_waitcnt lgkmcnt(6)
    v_and_or_b32 v244, v244, -2, v23
    v_and_or_b32 v246, v246, -2, v23
    buffer_store_dwordx2 v[244:245], v28, s[64:67], s37 offen offset:0
    buffer_store_dwordx2 v[246:247], v28, s[64:67], s37 offen offset:512
    s_waitcnt lgkmcnt(3)
    v_or_b32 v224, 1, v224
    v_or_b32 v226, 1, v226
    buffer_store_dwordx4 v[224:227], v153, s[64:67], s19 offen
    s_waitcnt lgkmcnt(0)
    v_or_b32 v228, 1, v228
    v_or_b32 v230, 1, v230
    buffer_store_dwordx4 v[228:231], v153, s[64:67], s20 offen
L_p2e0:
    v_mfma_f32_16x16x32_bf16 v[28:31], v[60:63], v[64:67], 0
    ds_write_b128 v170, v[32:35] offset:0
    v_mfma_f32_16x16x32_bf16 v[20:23], v[68:71], v[72:75], 0
    ds_read_b128 a[216:219], v156 offset:8192
    s_lshl_b32 s8, s79, 13
    s_and_b32 s7, s91, 31
    s_lshl_b32 s7, s7, 2
    s_add_u32 s8, s8, 11272192
    s_add_u32 s7, s7, s8
    v_mov_b32 v169, s7
    v_mov_b32 v173, s82
    v_mfma_f32_16x16x32_bf16 v[16:19], v[60:63], v[76:79], 0
    ds_read_b128 a[220:223], v157 offset:8192
    v_mfma_f32_16x16x32_bf16 v[12:15], v[68:71], v[76:79], 0
    ds_read_b128 a[224:227], v156 offset:8704
    ds_write_b128 v170, v[36:39] offset:4096
    v_mfma_f32_16x16x32_bf16 v[28:31], v[68:71], v[80:83], v[28:31]
    ds_read_b128 v[80:83], v167 offset:3712
    ds_read_b128 a[228:231], v157 offset:8704
    v_mfma_f32_16x16x32_bf16 v[8:11], v[68:71], v[84:87], 0
    v_mfma_f32_16x16x32_bf16 v[16:19], v[88:91], v[84:87], v[16:19]
    ds_write_b128 v170, v[40:43] offset:8192
    v_mfma_f32_16x16x32_bf16 v[20:23], v[60:63], v[92:95], v[20:23]
    s_mov_b32 s13, 40960
    s_mul_i32 s5, s77, 40960
    v_mfma_f32_16x16x32_bf16 v[28:31], v[88:91], v[72:75], v[28:31]
    s_waitcnt lgkmcnt(1)
    s_add_u32 m0, s84, 8192
    s_add_u32 s83, s17, 40960
    buffer_load_dwordx4 v158, s[56:59], s83 offen offset:0 lds
    v_mfma_f32_16x16x32_bf16 v[24:27], v[68:71], v[64:67], 0
    ds_read_b128 v[64:67], v167 offset:3200
    ds_write_b128 v170, v[44:47] offset:12288
    v_mfma_f32_16x16x32_bf16 v[16:19], v[68:71], v[92:95], v[16:19]
    v_and_b32 v172, 15, v152
    v_lshrrev_b32 v164, 4, v152
    v_mfma_f32_16x16x32_bf16 v[28:31], v[96:99], v[76:79], v[28:31]
    v_lshlrev_b32 v164, 3, v164
    v_lshl_add_u32 v164, v172, 5, v164
    v_mfma_f32_16x16x32_bf16 v[12:15], v[60:63], v[84:87], v[12:15]
    buffer_load_dwordx4 v158, s[60:63], s83 offen offset:2048 lds
    v_xor_b32 v172, 8, v164
    v_mfma_f32_16x16x32_bf16 v[24:27], v[88:91], v[92:95], v[24:27]
    ds_read_b128 a[248:251], v156 offset:12288
    s_lshl_b32 s6, s77, 12
    s_add_u32 s6, s6, 0
    v_add_u32 v170, s6, v153
    v_mfma_f32_16x16x32_bf16 v[8:11], v[60:63], v[100:103], v[8:11]
    ds_read_b128 a[252:255], v157 offset:12288
    s_add_u32 s3, s40, 26112
    v_add_u32 v171, s3, v172
    v_mfma_f32_16x16x32_bf16 v[20:23], v[88:91], v[76:79], v[20:23]
    s_lshl_b32 s22, s16, 5
    s_add_u32 s22, s22, s5
    v_mfma_f32_16x16x32_bf16 v[12:15], v[88:91], v[100:103], v[12:15]
    s_add_u32 s83, s83, 9216
    buffer_load_dwordx4 v158, s[56:59], s83 offen offset:1024 lds
    v_mfma_f32_16x16x32_bf16 v[24:27], v[60:63], v[72:75], v[24:27]
    ds_read_b128 v[72:75], v167 offset:2688
    v_mfma_f32_16x16x32_bf16 v[24:27], v[104:107], v[76:79], v[24:27]
    ds_read_b128 v[76:79], v167 offset:1664
    s_waitcnt lgkmcnt(4)
    s_barrier
    v_mfma_f32_16x16x32_bf16 v[4:7], v[60:63], v[108:111], 0
    ds_read2_b32 v[60:61], v166 offset0:144 offset1:145
    ds_read2_b32 v[62:63], v166 offset0:146 offset1:147
    ds_read_b128 v[32:35], v170 offset:0
    v_mfma_f32_16x16x32_bf16 v[4:7], v[68:71], v[100:103], v[4:7]
    buffer_load_dwordx4 v158, s[60:63], s83 offen offset:3072 lds
    ds_read_b128 v[36:39], v170 offset:1024
    v_mfma_f32_16x16x32_bf16 v[0:3], v[68:71], v[108:111], 0
    ds_read2_b32 v[68:69], v166 offset0:16 offset1:17
    ds_read2_b32 v[70:71], v166 offset0:18 offset1:19
    ds_read_b128 v[40:43], v170 offset:2048
    v_mfma_f32_16x16x32_bf16 v[28:31], v[112:115], v[84:87], v[28:31]
    ds_read_b128 v[44:47], v170 offset:3072
    v_mfma_f32_16x16x32_bf16 v[28:31], v[116:119], v[100:103], v[28:31]
    ds_read_b64 v[48:49], v171
    s_lshl_b32 s23, s17, 5
    v_mfma_f32_16x16x32_bf16 v[24:27], v[96:99], v[84:87], v[24:27]
    s_waitcnt lgkmcnt(11)
    s_add_u32 m0, s84, 12288
    s_add_u32 s83, s17, 46080
    buffer_load_dwordx4 v158, s[56:59], s83 offen offset:0 lds
    v_mfma_f32_16x16x32_bf16 v[20:23], v[104:107], v[84:87], v[20:23]
    ds_read_b128 v[84:87], v167 offset:1152
    s_add_u32 s3, s40, s15
    s_add_u32 s3, s3, 3145728
    v_add_u32 v171, s3, v164
    v_and_b32 v57, 8, v164
    v_mfma_f32_16x16x32_bf16 v[8:11], v[88:91], v[108:111], v[8:11]
    ds_read2_b32 v[88:89], v129 offset0:16 offset1:17
    ds_read2_b32 v[90:91], v129 offset0:18 offset1:19
    v_and_b32 v164, 0x1f0, v164
    v_lshl_add_u32 v164, v57, 6, v164
    v_mfma_f32_16x16x32_bf16 v[28:31], v[104:107], v[92:95], v[28:31]
    ds_read_b128 v[92:95], v167 offset:2176
    s_add_u32 s23, s23, s5
    v_mfma_f32_16x16x32_bf16 v[20:23], v[112:115], v[108:111], v[20:23]
    buffer_load_dwordx4 v158, s[60:63], s83 offen offset:2048 lds
    v_mfma_f32_16x16x32_bf16 v[16:19], v[96:99], v[108:111], v[16:19]
    ds_read_b128 a[232:235], v156 offset:0
    s_waitcnt lgkmcnt(6)
    v_add_f32 v32, v32, v36
    v_add_f32 v33, v33, v37
    v_mfma_f32_16x16x32_bf16 v[24:27], v[116:119], v[108:111], v[24:27]
    ds_read2_b32 v[116:117], v131 offset0:16 offset1:17
    ds_read2_b32 v[118:119], v131 offset0:18 offset1:19
    ds_read_b128 a[236:239], v157 offset:0
    s_waitcnt vmcnt(6)
    s_cmp_eq_u32 s88, 0
    s_cbranch_scc1 Lss_1
    global_store_dword v169, v173, s[50:51]
Lsd_2:
    v_add_f32 v34, v34, v38
    v_add_f32 v35, v35, v39
    v_mfma_f32_16x16x32_bf16 v[20:23], v[96:99], v[100:103], v[20:23]
    ds_read2_b32 v[96:97], v130 offset0:16 offset1:17
    ds_read2_b32 v[98:99], v130 offset0:18 offset1:19
    ds_read_b128 a[240:243], v156 offset:512
    v_add_f32 v40, v40, v44
    v_add_f32 v41, v41, v45
    v_mfma_f32_16x16x32_bf16 v[16:19], v[104:107], v[100:103], v[16:19]
    s_add_u32 s83, s83, 9216
    buffer_load_dwordx4 v158, s[56:59], s83 offen offset:1024 lds
    ds_read_b128 a[244:247], v157 offset:512
    v_add_f32 v42, v42, v46
    v_add_f32 v43, v43, v47
    v_mfma_f32_16x16x32_bf16 v[12:15], v[104:107], v[108:111], v[12:15]
    ds_read2_b32 v[104:105], v129 offset0:144 offset1:145
    ds_read2_b32 v[106:107], v129 offset0:146 offset1:147
    v_add_f32 v32, v32, v40
    v_add_f32 v33, v33, v41
    v_mfma_f32_16x16x32_bf16 v[24:27], v[112:115], v[100:103], v[24:27]
    ds_read2_b32 v[112:113], v130 offset0:144 offset1:145
    ds_read2_b32 v[114:115], v130 offset0:146 offset1:147
    ds_read_b128 v[100:103], v167 offset:640
    v_add_f32 v34, v34, v42
    v_add_f32 v35, v35, v43
    v_mfma_f32_16x16x32_bf16 v[28:31], v[120:123], v[108:111], v[28:31]
    ds_read2_b32 v[120:121], v131 offset0:144 offset1:145
    ds_read2_b32 v[122:123], v131 offset0:146 offset1:147
    ds_read_b128 v[108:111], v167 offset:128
    v_and_b32 v173, 31, v152
    v_lshl_add_u32 v173, v173, 2, s8
    v_mfma_f32_16x16x32_bf16 v[28:31], v[60:63], v[64:67], v[28:31]
    buffer_load_dwordx4 v158, s[60:63], s83 offen offset:3072 lds
    s_waitcnt lgkmcnt(15)
    v_and_b32 v36, s86, v49
    v_lshlrev_b32 v37, 16, v49
    v_mfma_f32_16x16x32_bf16 v[20:23], v[68:71], v[72:75], v[20:23]
    v_and_b32 v38, s86, v48
    v_lshlrev_b32 v39, 16, v48
    v_mfma_f32_16x16x32_bf16 v[16:19], v[60:63], v[76:79], v[16:19]
    v_mul_f32 v36, s35, v36
    v_mul_f32 v37, s35, v37
    v_mfma_f32_16x16x32_bf16 v[12:15], v[68:71], v[76:79], v[12:15]
    v_mul_f32 v38, s35, v38
    v_mul_f32 v39, s35, v39
    v_mfma_f32_16x16x32_bf16 v[28:31], v[68:71], v[80:83], v[28:31]
    ds_read_b128 v[80:83], v167 offset:3648
    s_waitcnt lgkmcnt(9)
    s_add_u32 m0, s84, 0
    s_add_u32 s83, s44, 0
    buffer_load_dwordx4 v159, s[56:59], s83 offen offset:0 lds
    v_cvt_pk_bf16_f32 v36, 0, v36
    v_cvt_pk_bf16_f32 v37, 0, v37
    v_mfma_f32_16x16x32_bf16 v[8:11], v[68:71], v[84:87], v[8:11]
    v_cvt_pk_bf16_f32 v38, 0, v38
    v_cvt_pk_bf16_f32 v39, 0, v39
    v_mfma_f32_16x16x32_bf16 v[16:19], v[88:91], v[84:87], v[16:19]
    v_cvt_pk_bf16_f32 v32, 0, v32
    v_cvt_pk_bf16_f32 v33, 0, v33
    v_mfma_f32_16x16x32_bf16 v[20:23], v[60:63], v[92:95], v[20:23]
    v_cvt_pk_bf16_f32 v34, 0, v34
    v_cvt_pk_bf16_f32 v35, 0, v35
    v_mfma_f32_16x16x32_bf16 v[28:31], v[88:91], v[72:75], v[28:31]
    buffer_load_dwordx4 v159, s[60:63], s83 offen offset:2048 lds
    v_add_f32 v32, v32, v36
    v_add_f32 v33, v33, v37
    v_mfma_f32_16x16x32_bf16 v[24:27], v[68:71], v[64:67], v[24:27]
    ds_read_b128 v[64:67], v167 offset:3136
    ds_read_b128 v[176:179], v156 offset:4096
    v_add_f32 v34, v34, v38
    v_add_f32 v35, v35, v39
    v_mfma_f32_16x16x32_bf16 v[16:19], v[68:71], v[92:95], v[16:19]
    ds_read_b128 v[180:183], v157 offset:4096
    v_cvt_pk_bf16_f32 v58, v32, v33
    v_cvt_pk_bf16_f32 v59, v34, v35
    v_mfma_f32_16x16x32_bf16 v[28:31], v[96:99], v[76:79], v[28:31]
    ds_read_b128 v[184:187], v156 offset:4608
    global_store_dwordx2 v171, v[58:59], s[50:51] sc1
    v_mfma_f32_16x16x32_bf16 v[12:15], v[60:63], v[84:87], v[12:15]
    s_add_u32 s83, s83, 9216
    buffer_load_dwordx4 v159, s[56:59], s83 offen offset:1024 lds
    ds_read_b128 v[188:191], v157 offset:4608
    v_mfma_f32_16x16x32_bf16 v[24:27], v[88:91], v[92:95], v[24:27]
    s_mul_i32 s3, s81, 4608
    s_lshl_b32 s4, s80, 10
    s_add_u32 s3, s3, 16896
    s_waitcnt lgkmcnt(9)
    v_mfma_f32_16x16x32_bf16 v[8:11], v[60:63], v[100:103], v[8:11]
    s_add_u32 s9, s3, s4
    s_sub_u32 s3, s3, s4
    v_add_u32 v57, s9, v172
    v_add_u32 v171, s3, v172
    v_mfma_f32_16x16x32_bf16 v[20:23], v[88:91], v[76:79], v[20:23]
    ds_read_b64 v[44:45], v57 offset:0
    ds_read_b64 v[46:47], v57 offset:512
    ds_read_b64 v[48:49], v171 offset:3072
    v_mfma_f32_16x16x32_bf16 v[12:15], v[88:91], v[100:103], v[12:15]
    buffer_load_dwordx4 v159, s[60:63], s83 offen offset:3072 lds
    ds_read_b64 v[50:51], v171 offset:3584
    v_add_u32 v170, 65536, v170
    v_xor_b32 v171, 0x1000, v170
    v_mfma_f32_16x16x32_bf16 v[24:27], v[60:63], v[72:75], v[24:27]
    ds_read_b128 v[72:75], v167 offset:2624
    s_mul_i32 s3, s79, 163840
    s_mul_i32 s4, s77, 10240
    v_mfma_f32_16x16x32_bf16 v[24:27], v[104:107], v[76:79], v[24:27]
    ds_read_b128 v[76:79], v167 offset:1600
    s_add_u32 s3, s3, s4
    v_add_u32 v175, s3, v153
    s_waitcnt lgkmcnt(12)
    v_mfma_f32_16x16x32_bf16 v[4:7], v[60:63], v[108:111], v[4:7]
    ds_read2_b32 v[60:61], v166 offset0:160 offset1:161
    ds_read2_b32 v[62:63], v166 offset0:162 offset1:163
    s_waitcnt lgkmcnt(6)
    v_and_b32 v52, s86, v45
    v_lshlrev_b32 v53, 16, v45
    v_mfma_f32_16x16x32_bf16 v[4:7], v[68:71], v[100:103], v[4:7]
    s_add_u32 m0, s84, 4096
    s_add_u32 s83, s44, 40960
    buffer_load_dwordx4 v159, s[56:59], s83 offen offset:0 lds
    v_and_b32 v54, s86, v44
    v_lshlrev_b32 v55, 16, v44
    v_mfma_f32_16x16x32_bf16 v[0:3], v[68:71], v[108:111], v[0:3]
    ds_read2_b32 v[68:69], v166 offset0:32 offset1:33
    ds_read2_b32 v[70:71], v166 offset0:34 offset1:35
    v_and_b32 v56, s86, v47
    v_lshlrev_b32 v57, 16, v47
    v_mfma_f32_16x16x32_bf16 v[28:31], v[112:115], v[84:87], v[28:31]
    v_and_b32 v58, s86, v46
    v_lshlrev_b32 v59, 16, v46
    v_mfma_f32_16x16x32_bf16 v[28:31], v[116:119], v[100:103], v[28:31]
    v_mul_f32 v52, s34, v52
    v_mul_f32 v53, s34, v53
    v_mfma_f32_16x16x32_bf16 v[24:27], v[96:99], v[84:87], v[24:27]
    buffer_load_dwordx4 v159, s[60:63], s83 offen offset:2048 lds
    s_waitcnt vmcnt(12)
    v_mul_f32 v54, s34, v54
    v_mul_f32 v55, s34, v55
    v_mfma_f32_16x16x32_bf16 v[20:23], v[104:107], v[84:87], v[20:23]
    ds_read_b128 v[84:87], v167 offset:1088
    ds_read_b128 v[192:195], v156 offset:8192
    v_mul_f32 v56, s34, v56
    v_mul_f32 v57, s34, v57
    v_mfma_f32_16x16x32_bf16 v[8:11], v[88:91], v[108:111], v[8:11]
    ds_read2_b32 v[88:89], v129 offset0:32 offset1:33
    ds_read2_b32 v[90:91], v129 offset0:34 offset1:35
    ds_read_b128 v[196:199], v157 offset:8192
    v_mul_f32 v58, s34, v58
    v_mul_f32 v59, s34, v59
    v_mfma_f32_16x16x32_bf16 v[28:31], v[104:107], v[92:95], v[28:31]
    ds_read_b128 v[92:95], v167 offset:2112
    ds_read_b128 v[200:203], v156 offset:8704
    v_cvt_pk_bf16_f32 v52, 0, v52
    v_cvt_pk_bf16_f32 v53, 0, v53
    v_mfma_f32_16x16x32_bf16 v[20:23], v[112:115], v[108:111], v[20:23]
    s_add_u32 s83, s83, 9216
    buffer_load_dwordx4 v159, s[56:59], s83 offen offset:1024 lds
    ds_read_b128 v[204:207], v157 offset:8704
    v_cvt_pk_bf16_f32 v54, 0, v54
    v_cvt_pk_bf16_f32 v55, 0, v55
    v_mfma_f32_16x16x32_bf16 v[16:19], v[96:99], v[108:111], v[16:19]
    v_cvt_pk_bf16_f32 v56, 0, v56
    v_cvt_pk_bf16_f32 v57, 0, v57
    v_mfma_f32_16x16x32_bf16 v[24:27], v[116:119], v[108:111], v[24:27]
    ds_read2_b32 v[116:117], v131 offset0:32 offset1:33
    ds_read2_b32 v[118:119], v131 offset0:34 offset1:35
    v_cvt_pk_bf16_f32 v58, 0, v58
    v_cvt_pk_bf16_f32 v59, 0, v59
    v_mfma_f32_16x16x32_bf16 v[20:23], v[96:99], v[100:103], v[20:23]
    ds_read2_b32 v[96:97], v130 offset0:32 offset1:33
    ds_read2_b32 v[98:99], v130 offset0:34 offset1:35
    s_waitcnt lgkmcnt(15)
    v_and_b32 v32, s86, v49
    v_lshlrev_b32 v33, 16, v49
    v_mfma_f32_16x16x32_bf16 v[16:19], v[104:107], v[100:103], v[16:19]
    buffer_load_dwordx4 v159, s[60:63], s83 offen offset:3072 lds
    v_and_b32 v34, s86, v48
    v_lshlrev_b32 v35, 16, v48
    v_mfma_f32_16x16x32_bf16 v[12:15], v[104:107], v[108:111], v[12:15]
    ds_read2_b32 v[104:105], v129 offset0:160 offset1:161
    ds_read2_b32 v[106:107], v129 offset0:162 offset1:163
    v_and_b32 v36, s86, v51
    v_lshlrev_b32 v37, 16, v51
    v_mfma_f32_16x16x32_bf16 v[24:27], v[112:115], v[100:103], v[24:27]
    ds_read2_b32 v[112:113], v130 offset0:160 offset1:161
    ds_read2_b32 v[114:115], v130 offset0:162 offset1:163
    ds_read_b128 v[100:103], v167 offset:576
    v_and_b32 v38, s86, v50
    v_lshlrev_b32 v39, 16, v50
    v_mfma_f32_16x16x32_bf16 v[28:31], v[120:123], v[108:111], v[28:31]
    ds_read2_b32 v[120:121], v131 offset0:160 offset1:161
    ds_read2_b32 v[122:123], v131 offset0:162 offset1:163
    ds_read_b128 v[108:111], v167 offset:64
    v_mul_f32 v32, s34, v32
    v_mul_f32 v33, s34, v33
    s_waitcnt lgkmcnt(15)
    v_mfma_f32_16x16x32_bf16 v[28:31], v[60:63], v[64:67], v[28:31]
    s_waitcnt lgkmcnt(12)
    s_add_u32 m0, s84, 8192
    s_add_u32 s83, s16, 40960
    buffer_load_dwordx4 v158, s[56:59], s83 offen offset:0 lds
    v_mul_f32 v34, s34, v34
    v_mul_f32 v35, s34, v35
    v_mfma_f32_16x16x32_bf16 v[20:23], v[68:71], v[72:75], v[20:23]
    v_mul_f32 v36, s34, v36
    v_mul_f32 v37, s34, v37
    v_mfma_f32_16x16x32_bf16 v[16:19], v[60:63], v[76:79], v[16:19]
    v_mul_f32 v38, s34, v38
    v_mul_f32 v39, s34, v39
    v_mfma_f32_16x16x32_bf16 v[12:15], v[68:71], v[76:79], v[12:15]
    v_cvt_pk_bf16_f32 v32, 0, v32
    v_cvt_pk_bf16_f32 v33, 0, v33
    v_mfma_f32_16x16x32_bf16 v[28:31], v[68:71], v[80:83], v[28:31]
    ds_read_b128 v[80:83], v167 offset:3584
    buffer_load_dwordx4 v158, s[60:63], s83 offen offset:2048 lds
    s_waitcnt vmcnt(11)
    v_cvt_pk_bf16_f32 v34, 0, v34
    v_cvt_pk_bf16_f32 v35, 0, v35
    v_mfma_f32_16x16x32_bf16 v[8:11], v[68:71], v[84:87], v[8:11]
    ds_read_b128 v[208:211], v156 offset:12288
    v_cvt_pk_bf16_f32 v36, 0, v36
    v_cvt_pk_bf16_f32 v37, 0, v37
    v_mfma_f32_16x16x32_bf16 v[16:19], v[88:91], v[84:87], v[16:19]
    ds_read_b128 v[212:215], v157 offset:12288
    v_cvt_pk_bf16_f32 v38, 0, v38
    v_cvt_pk_bf16_f32 v39, 0, v39
    v_mfma_f32_16x16x32_bf16 v[20:23], v[60:63], v[92:95], v[20:23]
    ds_read_b128 v[216:219], v156 offset:12800
    s_lshl_b32 s24, s44, 5
    v_mfma_f32_16x16x32_bf16 v[28:31], v[88:91], v[72:75], v[28:31]
    s_add_u32 s83, s83, 9216
    buffer_load_dwordx4 v158, s[56:59], s83 offen offset:1024 lds
    ds_read_b128 v[220:223], v157 offset:12800
    global_load_dword v169, v173, s[50:51] sc1
    v_mfma_f32_16x16x32_bf16 v[24:27], v[68:71], v[64:67], v[24:27]
    ds_read_b128 v[64:67], v167 offset:3072
    s_add_u32 s24, s24, s5
    v_mfma_f32_16x16x32_bf16 v[16:19], v[68:71], v[92:95], v[16:19]
    s_waitcnt lgkmcnt(14)
    v_mfma_f32_16x16x32_bf16 v[28:31], v[96:99], v[76:79], v[28:31]
    s_cmp_eq_u32 s77, 3
    s_cselect_b32 s5, -122880, s13
    v_mfma_f32_16x16x32_bf16 v[12:15], v[60:63], v[84:87], v[12:15]
    buffer_load_dwordx4 v158, s[60:63], s83 offen offset:3072 lds
    s_add_u32 s25, s22, s5
    v_mfma_f32_16x16x32_bf16 v[24:27], v[88:91], v[92:95], v[24:27]
    s_add_u32 s26, s23, s5
    s_waitcnt lgkmcnt(9)
    v_mfma_f32_16x16x32_bf16 v[8:11], v[60:63], v[100:103], v[8:11]
    s_add_u32 s27, s24, s5
    v_mfma_f32_16x16x32_bf16 v[20:23], v[88:91], v[76:79], v[20:23]
    s_cmp_eq_u32 s77, 2
    s_cselect_b32 s5, -122880, s13
    v_mfma_f32_16x16x32_bf16 v[12:15], v[88:91], v[100:103], v[12:15]
    s_waitcnt lgkmcnt(1)
    s_add_u32 m0, s84, 12288
    s_add_u32 s83, s16, 46080
    buffer_load_dwordx4 v158, s[56:59], s83 offen offset:0 lds
    v_mfma_f32_16x16x32_bf16 v[24:27], v[60:63], v[72:75], v[24:27]
    ds_read_b128 v[72:75], v167 offset:2560
    v_mfma_f32_16x16x32_bf16 v[24:27], v[104:107], v[76:79], v[24:27]
    ds_read_b128 v[76:79], v167 offset:1536
    v_mfma_f32_16x16x32_bf16 v[4:7], v[60:63], v[108:111], v[4:7]
    ds_read2_b32 v[60:61], v166 offset0:176 offset1:177
    ds_read2_b32 v[62:63], v166 offset0:178 offset1:179
    v_mfma_f32_16x16x32_bf16 v[4:7], v[68:71], v[100:103], v[4:7]
    buffer_load_dwordx4 v158, s[60:63], s83 offen offset:2048 lds
    s_add_u32 s28, s25, s5
    v_mfma_f32_16x16x32_bf16 v[0:3], v[68:71], v[108:111], v[0:3]
    ds_read2_b32 v[68:69], v166 offset0:48 offset1:49
    ds_read2_b32 v[70:71], v166 offset0:50 offset1:51
    v_mfma_f32_16x16x32_bf16 v[28:31], v[112:115], v[84:87], v[28:31]
    s_add_u32 s29, s26, s5
    v_mfma_f32_16x16x32_bf16 v[28:31], v[116:119], v[100:103], v[28:31]
    s_add_u32 s30, s27, s5
    v_mfma_f32_16x16x32_bf16 v[24:27], v[96:99], v[84:87], v[24:27]
    s_add_u32 s83, s83, 9216
    buffer_load_dwordx4 v158, s[56:59], s83 offen offset:1024 lds
    v_mfma_f32_16x16x32_bf16 v[20:23], v[104:107], v[84:87], v[20:23]
    ds_read_b128 v[84:87], v167 offset:1024
    v_mfma_f32_16x16x32_bf16 v[8:11], v[88:91], v[108:111], v[8:11]
    ds_read2_b32 v[88:89], v129 offset0:48 offset1:49
    ds_read2_b32 v[90:91], v129 offset0:50 offset1:51
    v_mfma_f32_16x16x32_bf16 v[28:31], v[104:107], v[92:95], v[28:31]
    ds_read_b128 v[92:95], v167 offset:2048
    v_mfma_f32_16x16x32_bf16 v[20:23], v[112:115], v[108:111], v[20:23]
    buffer_load_dwordx4 v158, s[60:63], s83 offen offset:3072 lds
    v_mfma_f32_16x16x32_bf16 v[16:19], v[96:99], v[108:111], v[16:19]
    s_cmp_eq_u32 s77, 1
    s_cselect_b32 s5, -122880, s13
    v_mfma_f32_16x16x32_bf16 v[24:27], v[116:119], v[108:111], v[24:27]
    ds_read2_b32 v[116:117], v131 offset0:48 offset1:49
    ds_read2_b32 v[118:119], v131 offset0:50 offset1:51
    v_mfma_f32_16x16x32_bf16 v[20:23], v[96:99], v[100:103], v[20:23]
    ds_read2_b32 v[96:97], v130 offset0:48 offset1:49
    ds_read2_b32 v[98:99], v130 offset0:50 offset1:51
    v_mfma_f32_16x16x32_bf16 v[16:19], v[104:107], v[100:103], v[16:19]
    s_add_u32 s31, s28, s5
    s_add_u32 s32, s29, s5
    v_mfma_f32_16x16x32_bf16 v[12:15], v[104:107], v[108:111], v[12:15]
    ds_read2_b32 v[104:105], v129 offset0:176 offset1:177
    ds_read2_b32 v[106:107], v129 offset0:178 offset1:179
    v_mfma_f32_16x16x32_bf16 v[24:27], v[112:115], v[100:103], v[24:27]
    ds_read2_b32 v[112:113], v130 offset0:176 offset1:177
    ds_read2_b32 v[114:115], v130 offset0:178 offset1:179
    ds_read_b128 v[100:103], v167 offset:512
    v_mfma_f32_16x16x32_bf16 v[28:31], v[120:123], v[108:111], v[28:31]
    ds_read2_b32 v[120:121], v131 offset0:176 offset1:177
    ds_read2_b32 v[122:123], v131 offset0:178 offset1:179
    ds_read_b128 v[108:111], v167 offset:0
    s_add_u32 s33, s30, s5
    s_getpc_b64 s[4:5]
L_pc2:
    s_lshr_b32 s3, s2, 3
    s_lshl_b32 s3, s3, 2
    s_add_u32 s3, s3, s77
    s_lshl_b32 s3, s3, 8
    v_and_b32 v168, 1, v152
    v_lshl_add_u32 v168, v168, 7, s3
    v_min_u32 v168, L_last-L_pc2, v168
    global_load_dword v168, v168, s[4:5]
    s_cmp_lg_u32 s80, 0
    s_cbranch_scc1 Lv_2
    s_waitcnt lgkmcnt(15)
    v_mfma_f32_16x16x32_bf16 v[16:19], v[60:63], v[76:79], v[16:19]
    s_waitcnt vmcnt(14)
    v_mfma_f32_16x16x32_bf16 v[20:23], v[68:71], v[72:75], v[20:23]
    ds_read_b128 v[224:227], v156 offset:0
    v_mfma_f32_16x16x32_bf16 v[12:15], v[68:71], v[76:79], v[12:15]
    ds_read_b128 v[232:235], v156 offset:512
    v_mfma_f32_16x16x32_bf16 v[12:15], v[60:63], v[84:87], v[12:15]
    ds_read_b128 v[228:231], v157 offset:0
    s_waitcnt lgkmcnt(15)
    v_mfma_f32_16x16x32_bf16 v[20:23], v[88:91], v[76:79], v[20:23]
    ds_read_b128 v[236:239], v157 offset:512
    v_mfma_f32_16x16x32_bf16 v[20:23], v[60:63], v[92:95], v[20:23]
    v_mfma_f32_16x16x32_bf16 v[8:11], v[68:71], v[84:87], v[8:11]
    v_mfma_f32_16x16x32_bf16 v[16:19], v[88:91], v[84:87], v[16:19]
    s_waitcnt lgkmcnt(0)
    s_add_u32 m0, s84, 0
    s_add_u32 s83, s16, 0
    buffer_load_dwordx4 v158, s[56:59], s83 offen offset:0 lds
    v_mfma_f32_16x16x32_bf16 v[16:19], v[68:71], v[92:95], v[16:19]
    v_mfma_f32_16x16x32_bf16 v[20:23], v[104:107], v[84:87], v[20:23]
    v_mfma_f32_16x16x32_bf16 v[20:23], v[96:99], v[100:103], v[20:23]
    v_mfma_f32_16x16x32_bf16 v[16:19], v[104:107], v[100:103], v[16:19]
    buffer_load_dwordx4 v158, s[60:63], s83 offen offset:2048 lds
    s_waitcnt vmcnt(12)
    v_mfma_f32_16x16x32_bf16 v[8:11], v[60:63], v[100:103], v[8:11]
    ds_read_b128 v[240:243], v156 offset:4096
    s_waitcnt vmcnt(8)
L_fh0:
    v_cmp_ne_u32 vcc, s82, v169
    s_cbranch_vccnz L_fh_re0
    v_mfma_f32_16x16x32_bf16 v[16:19], v[96:99], v[108:111], v[16:19]
    ds_read_b128 v[248:251], v156 offset:4608
    v_mfma_f32_16x16x32_bf16 v[12:15], v[88:91], v[100:103], v[12:15]
    ds_read_b128 v[244:247], v157 offset:4096
    buffer_load_dwordx4 v[40:43], v175, s[64:67], s23 offen offset:0 sc1
    v_mfma_f32_16x16x32_bf16 v[8:11], v[88:91], v[108:111], v[8:11]
    s_add_u32 s83, s83, 9216
    buffer_load_dwordx4 v158, s[56:59], s83 offen offset:1024 lds
    ds_read_b128 v[252:255], v157 offset:4608
    v_mfma_f32_16x16x32_bf16 v[12:15], v[104:107], v[108:111], v[12:15]
    ds_write_b128 v170, v[16:19] offset:2048
    buffer_load_dwordx4 v[44:47], v175, s[64:67], s23 offen offset:1024 sc1
    v_mfma_f32_16x16x32_bf16 v[20:23], v[112:115], v[108:111], v[20:23]
    v_mfma_f32_16x16x32_bf16 v[28:31], v[120:123], v[108:111], v[28:31]
    ds_write_b128 v170, v[8:11] offset:0
    buffer_load_dwordx4 v[48:51], v175, s[64:67], s23 offen offset:2048 sc1
    v_mfma_f32_16x16x32_bf16 v[28:31], v[68:71], v[80:83], v[28:31]
    s_nop 0
    ds_write_b128 v170, v[12:15] offset:1024
    buffer_load_dwordx4 v158, s[60:63], s83 offen offset:3072 lds
    v_mfma_f32_16x16x32_bf16 v[24:27], v[116:119], v[108:111], v[24:27]
    ds_write_b128 v170, v[20:23] offset:3072
    buffer_load_dwordx4 v[120:123], v175, s[64:67], s22 offen offset:0 sc1
    v_mfma_f32_16x16x32_bf16 v[28:31], v[116:119], v[100:103], v[28:31]
    v_mfma_f32_16x16x32_bf16 v[24:27], v[68:71], v[64:67], v[24:27]
    v_mfma_f32_16x16x32_bf16 v[28:31], v[60:63], v[64:67], v[28:31]
    s_waitcnt lgkmcnt(4)
    s_add_u32 m0, s84, 4096
    s_add_u32 s83, s16, 5120
    buffer_load_dwordx4 v158, s[56:59], s83 offen offset:0 lds
    buffer_load_dwordx4 v[80:83], v175, s[64:67], s25 offen offset:0 sc1
    v_mfma_f32_16x16x32_bf16 v[0:3], v[68:71], v[108:111], v[0:3]
    v_mfma_f32_16x16x32_bf16 v[4:7], v[68:71], v[100:103], v[4:7]
    v_mfma_f32_16x16x32_bf16 v[4:7], v[60:63], v[108:111], v[4:7]
    buffer_load_dwordx4 v[116:119], v175, s[64:67], s28 offen offset:0 sc1
    v_mfma_f32_16x16x32_bf16 v[24:27], v[112:115], v[100:103], v[24:27]
    buffer_load_dwordx4 v158, s[60:63], s83 offen offset:2048 lds
    v_mfma_f32_16x16x32_bf16 v[24:27], v[60:63], v[72:75], v[24:27]
    v_mfma_f32_16x16x32_bf16 v[28:31], v[112:115], v[84:87], v[28:31]
    buffer_load_dwordx4 v[64:67], v175, s[64:67], s31 offen offset:0 sc1
    s_waitcnt lgkmcnt(0)
    s_barrier
    v_mfma_f32_16x16x32_bf16 v[28:31], v[88:91], v[72:75], v[28:31]
    ds_read_b128 v[8:11], v171 offset:0
    v_mfma_f32_16x16x32_bf16 v[24:27], v[96:99], v[84:87], v[24:27]
    ds_read_b128 v[12:15], v171 offset:1024
    s_add_u32 s83, s83, 9216
    buffer_load_dwordx4 v158, s[56:59], s83 offen offset:1024 lds
    v_mfma_f32_16x16x32_bf16 v[24:27], v[88:91], v[92:95], v[24:27]
    ds_read_b128 v[16:19], v171 offset:2048
    v_mfma_f32_16x16x32_bf16 v[24:27], v[104:107], v[76:79], v[24:27]
    ds_read_b128 v[20:23], v171 offset:3072
    v_mfma_f32_16x16x32_bf16 v[28:31], v[96:99], v[76:79], v[28:31]
    v_mfma_f32_16x16x32_bf16 v[28:31], v[104:107], v[92:95], v[28:31]
    buffer_load_dwordx4 v158, s[60:63], s83 offen offset:3072 lds
    s_branch Lw_2
Lv_2:
    s_waitcnt lgkmcnt(15)
    v_mfma_f32_16x16x32_bf16 v[24:27], v[68:71], v[64:67], v[24:27]
    s_waitcnt vmcnt(14)
    v_mfma_f32_16x16x32_bf16 v[28:31], v[60:63], v[64:67], v[28:31]
    ds_read_b128 v[224:227], v156 offset:0
    v_mfma_f32_16x16x32_bf16 v[24:27], v[60:63], v[72:75], v[24:27]
    ds_read_b128 v[232:235], v156 offset:512
    v_mfma_f32_16x16x32_bf16 v[28:31], v[68:71], v[80:83], v[28:31]
    ds_read_b128 v[228:231], v157 offset:0
    s_waitcnt lgkmcnt(15)
    v_mfma_f32_16x16x32_bf16 v[28:31], v[88:91], v[72:75], v[28:31]
    ds_read_b128 v[236:239], v157 offset:512
    v_mfma_f32_16x16x32_bf16 v[24:27], v[88:91], v[92:95], v[24:27]
    s_waitcnt lgkmcnt(12)
    v_mfma_f32_16x16x32_bf16 v[28:31], v[96:99], v[76:79], v[28:31]
    v_mfma_f32_16x16x32_bf16 v[24:27], v[96:99], v[84:87], v[24:27]
    s_waitcnt lgkmcnt(0)
    s_add_u32 m0, s84, 0
    s_add_u32 s83, s16, 0
    buffer_load_dwordx4 v158, s[56:59], s83 offen offset:0 lds
    v_mfma_f32_16x16x32_bf16 v[24:27], v[104:107], v[76:79], v[24:27]
    v_mfma_f32_16x16x32_bf16 v[28:31], v[104:107], v[92:95], v[28:31]
    v_mfma_f32_16x16x32_bf16 v[4:7], v[68:71], v[100:103], v[4:7]
    v_mfma_f32_16x16x32_bf16 v[28:31], v[116:119], v[100:103], v[28:31]
    buffer_load_dwordx4 v158, s[60:63], s83 offen offset:2048 lds
    s_waitcnt vmcnt(12)
    v_mfma_f32_16x16x32_bf16 v[4:7], v[60:63], v[108:111], v[4:7]
    ds_read_b128 v[240:243], v156 offset:4096
    s_waitcnt vmcnt(8)
L_fh1:
    v_cmp_ne_u32 vcc, s82, v169
    s_cbranch_vccnz L_fh_re1
    v_mfma_f32_16x16x32_bf16 v[0:3], v[68:71], v[108:111], v[0:3]
    ds_read_b128 v[248:251], v156 offset:4608
    v_mfma_f32_16x16x32_bf16 v[24:27], v[112:115], v[100:103], v[24:27]
    ds_read_b128 v[244:247], v157 offset:4096
    buffer_load_dwordx4 v[40:43], v175, s[64:67], s23 offen offset:0 sc1
    v_mfma_f32_16x16x32_bf16 v[24:27], v[116:119], v[108:111], v[24:27]
    ds_write_b128 v170, v[4:7] offset:1024
    s_add_u32 s83, s83, 9216
    buffer_load_dwordx4 v158, s[56:59], s83 offen offset:1024 lds
    ds_read_b128 v[252:255], v157 offset:4608
    v_mfma_f32_16x16x32_bf16 v[28:31], v[120:123], v[108:111], v[28:31]
    ds_write_b128 v170, v[0:3] offset:0
    buffer_load_dwordx4 v[44:47], v175, s[64:67], s23 offen offset:1024 sc1
    v_mfma_f32_16x16x32_bf16 v[28:31], v[112:115], v[84:87], v[28:31]
    v_mfma_f32_16x16x32_bf16 v[12:15], v[60:63], v[84:87], v[12:15]
    ds_write_b128 v170, v[24:27] offset:2048
    buffer_load_dwordx4 v[48:51], v175, s[64:67], s23 offen offset:2048 sc1
    v_mfma_f32_16x16x32_bf16 v[12:15], v[88:91], v[100:103], v[12:15]
    buffer_load_dwordx4 v158, s[60:63], s83 offen offset:3072 lds
    v_mfma_f32_16x16x32_bf16 v[12:15], v[104:107], v[108:111], v[12:15]
    s_nop 1
    ds_write_b128 v170, v[28:31] offset:3072
    buffer_load_dwordx4 v[120:123], v175, s[64:67], s22 offen offset:0 sc1
    v_mfma_f32_16x16x32_bf16 v[8:11], v[88:91], v[108:111], v[8:11]
    v_mfma_f32_16x16x32_bf16 v[8:11], v[68:71], v[84:87], v[8:11]
    v_mfma_f32_16x16x32_bf16 v[12:15], v[68:71], v[76:79], v[12:15]
    s_waitcnt lgkmcnt(3)
    s_add_u32 m0, s84, 4096
    s_add_u32 s83, s16, 5120
    buffer_load_dwordx4 v158, s[56:59], s83 offen offset:0 lds
    buffer_load_dwordx4 v[80:83], v175, s[64:67], s25 offen offset:0 sc1
    v_mfma_f32_16x16x32_bf16 v[8:11], v[60:63], v[100:103], v[8:11]
    v_mfma_f32_16x16x32_bf16 v[16:19], v[96:99], v[108:111], v[16:19]
    v_mfma_f32_16x16x32_bf16 v[16:19], v[68:71], v[92:95], v[16:19]
    buffer_load_dwordx4 v[116:119], v175, s[64:67], s28 offen offset:0 sc1
    v_mfma_f32_16x16x32_bf16 v[20:23], v[104:107], v[84:87], v[20:23]
    buffer_load_dwordx4 v158, s[60:63], s83 offen offset:2048 lds
    v_mfma_f32_16x16x32_bf16 v[20:23], v[88:91], v[76:79], v[20:23]
    v_mfma_f32_16x16x32_bf16 v[20:23], v[60:63], v[92:95], v[20:23]
    buffer_load_dwordx4 v[64:67], v175, s[64:67], s31 offen offset:0 sc1
    s_waitcnt lgkmcnt(0)
    s_barrier
    v_mfma_f32_16x16x32_bf16 v[16:19], v[104:107], v[100:103], v[16:19]
    ds_read_b128 v[0:3], v171 offset:0
    v_mfma_f32_16x16x32_bf16 v[16:19], v[60:63], v[76:79], v[16:19]
    ds_read_b128 v[4:7], v171 offset:1024
    s_add_u32 s83, s83, 9216
    buffer_load_dwordx4 v158, s[56:59], s83 offen offset:1024 lds
    v_mfma_f32_16x16x32_bf16 v[20:23], v[68:71], v[72:75], v[20:23]
    ds_read_b128 v[24:27], v171 offset:2048
    v_mfma_f32_16x16x32_bf16 v[16:19], v[88:91], v[84:87], v[16:19]
    ds_read_b128 v[28:31], v171 offset:3072
    v_mfma_f32_16x16x32_bf16 v[20:23], v[112:115], v[108:111], v[20:23]
    v_mfma_f32_16x16x32_bf16 v[20:23], v[96:99], v[100:103], v[20:23]
    buffer_load_dwordx4 v158, s[60:63], s83 offen offset:3072 lds
Lw_2:
    s_waitcnt vmcnt(12)
    v_mfma_f32_16x16x32_bf16 v[132:135], a[232:235], v[40:43], v[132:135]
    s_waitcnt lgkmcnt(2)
    v_add_f32 v0, v0, v8
    v_add_f32 v1, v1, v9
    v_mfma_f32_16x16x32_bf16 v[136:139], v[176:179], v[40:43], v[136:139]
    v_add_f32 v2, v2, v10
    v_add_f32 v3, v3, v11
    v_mfma_f32_16x16x32_bf16 v[140:143], v[192:195], v[40:43], v[140:143]
    buffer_load_dwordx4 v[60:63], v175, s[64:67], s22 offen offset:1024 sc1
    v_add_f32 v4, v4, v12
    v_add_f32 v5, v5, v13
    v_mfma_f32_16x16x32_bf16 v[144:147], v[208:211], v[40:43], v[144:147]
    v_add_f32 v6, v6, v14
    v_add_f32 v7, v7, v15
    v_mfma_f32_16x16x32_bf16 v[148:151], a[216:219], v[40:43], v[148:151]
    v_cvt_pk_bf16_f32 v0, 0, v0
    v_cvt_pk_bf16_f32 v1, 0, v1
    s_waitcnt vmcnt(11)
    v_mfma_f32_16x16x32_bf16 v[132:135], a[236:239], v[44:47], v[132:135]
    v_cvt_pk_bf16_f32 v2, 0, v2
    v_cvt_pk_bf16_f32 v3, 0, v3
    v_mfma_f32_16x16x32_bf16 v[136:139], v[180:183], v[44:47], v[136:139]
    buffer_load_dwordx4 v[68:71], v175, s[64:67], s25 offen offset:1024 sc1
    v_cvt_pk_bf16_f32 v4, 0, v4
    v_cvt_pk_bf16_f32 v5, 0, v5
    v_mfma_f32_16x16x32_bf16 v[140:143], v[196:199], v[44:47], v[140:143]
    v_cvt_pk_bf16_f32 v6, 0, v6
    v_cvt_pk_bf16_f32 v7, 0, v7
    v_mfma_f32_16x16x32_bf16 v[144:147], v[212:215], v[44:47], v[144:147]
    ds_read_b128 v[124:127], v156 offset:8192
    v_add_f32 v0, v0, v52
    v_add_f32 v1, v1, v53
    v_mfma_f32_16x16x32_bf16 v[148:151], a[220:223], v[44:47], v[148:151]
    v_add_f32 v2, v2, v54
    v_add_f32 v3, v3, v55
    s_waitcnt vmcnt(11)
    v_mfma_f32_16x16x32_bf16 v[132:135], a[240:243], v[48:51], v[132:135]
    buffer_load_dwordx4 v[72:75], v175, s[64:67], s28 offen offset:1024 sc1
    v_add_f32 v4, v4, v56
    v_add_f32 v5, v5, v57
    v_mfma_f32_16x16x32_bf16 v[136:139], v[184:187], v[48:51], v[136:139]
    v_add_f32 v6, v6, v58
    v_add_f32 v7, v7, v59
    v_mfma_f32_16x16x32_bf16 v[140:143], v[200:203], v[48:51], v[140:143]
    ds_read_b128 v[128:131], v156 offset:12288
    v_cvt_pk_bf16_f32 v170, v0, v1
    v_cvt_pk_bf16_f32 v171, v2, v3
    v_mfma_f32_16x16x32_bf16 v[144:147], v[216:219], v[48:51], v[144:147]
    v_cvt_pk_bf16_f32 v172, v4, v5
    v_cvt_pk_bf16_f32 v173, v6, v7
    v_mfma_f32_16x16x32_bf16 v[148:151], a[224:227], v[48:51], v[148:151]
    buffer_load_dwordx4 v[76:79], v175, s[64:67], s31 offen offset:1024 sc1
    v_permlane16_swap_b32 v170, v172
    s_waitcnt vmcnt(9)
    v_mfma_f32_16x16x32_bf16 v[148:151], a[200:203], v[120:123], v[148:151]
    v_permlane16_swap_b32 v171, v173
    v_mfma_f32_16x16x32_bf16 v[40:43], a[200:203], v[80:83], 0
    ds_read_b128 v[112:115], v156 offset:0
    s_waitcnt lgkmcnt(3)
    v_add_f32 v16, v16, v24
    v_add_f32 v17, v17, v25
    s_waitcnt vmcnt(6)
    v_mfma_f32_16x16x32_bf16 v[44:47], a[200:203], v[116:119], 0
    v_add_f32 v18, v18, v26
    v_add_f32 v19, v19, v27
    v_mfma_f32_16x16x32_bf16 v[48:51], a[200:203], v[64:67], 0
    buffer_load_dwordx4 v[84:87], v175, s[64:67], s22 offen offset:2048 sc1
    v_add_f32 v20, v20, v28
    v_add_f32 v21, v21, v29
    s_waitcnt lgkmcnt(2)
    v_mfma_f32_16x16x32_bf16 v[140:143], v[124:127], v[120:123], v[140:143]
    v_add_f32 v22, v22, v30
    v_add_f32 v23, v23, v31
    v_mfma_f32_16x16x32_bf16 v[52:55], v[124:127], v[80:83], 0
    v_cvt_pk_bf16_f32 v16, 0, v16
    v_cvt_pk_bf16_f32 v17, 0, v17
    v_mfma_f32_16x16x32_bf16 v[56:59], v[124:127], v[116:119], 0
    v_cvt_pk_bf16_f32 v18, 0, v18
    v_cvt_pk_bf16_f32 v19, 0, v19
    v_mfma_f32_16x16x32_bf16 v[0:3], v[124:127], v[64:67], 0
    s_waitcnt vmcnt(5)
    ds_read_b128 v[124:127], v156 offset:4096
    buffer_load_dwordx4 v[88:91], v175, s[64:67], s25 offen offset:2048 sc1
    v_cvt_pk_bf16_f32 v20, 0, v20
    v_cvt_pk_bf16_f32 v21, 0, v21
    s_waitcnt lgkmcnt(2)
    v_mfma_f32_16x16x32_bf16 v[144:147], v[128:131], v[120:123], v[144:147]
    v_cvt_pk_bf16_f32 v22, 0, v22
    v_cvt_pk_bf16_f32 v23, 0, v23
    v_mfma_f32_16x16x32_bf16 v[4:7], v[128:131], v[80:83], 0
    v_add_f32 v16, v16, v32
    v_add_f32 v17, v17, v33
    v_mfma_f32_16x16x32_bf16 v[8:11], v[128:131], v[116:119], 0
    v_add_f32 v18, v18, v34
    v_add_f32 v19, v19, v35
    v_mfma_f32_16x16x32_bf16 v[12:15], v[128:131], v[64:67], 0
    ds_read_b128 v[128:131], v157 offset:8192
    buffer_load_dwordx4 v[92:95], v175, s[64:67], s28 offen offset:2048 sc1
    v_add_f32 v20, v20, v36
    v_add_f32 v21, v21, v37
    s_waitcnt lgkmcnt(2)
    v_mfma_f32_16x16x32_bf16 v[132:135], v[112:115], v[120:123], v[132:135]
    v_add_f32 v22, v22, v38
    v_add_f32 v23, v23, v39
    v_mfma_f32_16x16x32_bf16 v[28:31], v[112:115], v[80:83], 0
    v_cvt_pk_bf16_f32 v166, v16, v17
    v_cvt_pk_bf16_f32 v167, v18, v19
    v_mfma_f32_16x16x32_bf16 v[32:35], v[112:115], v[116:119], 0
    v_cvt_pk_bf16_f32 v168, v20, v21
    v_cvt_pk_bf16_f32 v169, v22, v23
    v_mfma_f32_16x16x32_bf16 v[36:39], v[112:115], v[64:67], 0
    ds_read_b128 v[112:115], v157 offset:12288
    buffer_load_dwordx4 v[96:99], v175, s[64:67], s31 offen offset:2048 sc1
    v_permlane16_swap_b32 v166, v168
    s_waitcnt lgkmcnt(2)
    v_mfma_f32_16x16x32_bf16 v[136:139], v[124:127], v[120:123], v[136:139]
    v_permlane16_swap_b32 v167, v169
    v_mfma_f32_16x16x32_bf16 v[16:19], v[124:127], v[80:83], 0
    v_mfma_f32_16x16x32_bf16 v[20:23], v[124:127], v[116:119], 0
    v_mfma_f32_16x16x32_bf16 v[24:27], v[124:127], v[64:67], 0
    ds_read_b128 v[124:127], v157 offset:0
    buffer_load_dwordx4 v[100:103], v175, s[64:67], s22 offen offset:3072 sc1
    s_waitcnt vmcnt(7)
    v_mfma_f32_16x16x32_bf16 v[148:151], a[204:207], v[60:63], v[148:151]
    v_mfma_f32_16x16x32_bf16 v[40:43], a[204:207], v[68:71], v[40:43]
    buffer_store_dwordx4 v[170:173], v164, s[68:71], s38 offen sc1
    buffer_store_dwordx4 v[166:169], v164, s[68:71], s39 offen sc1
    s_waitcnt vmcnt(7)
    v_mfma_f32_16x16x32_bf16 v[44:47], a[204:207], v[72:75], v[44:47]
    v_mfma_f32_16x16x32_bf16 v[48:51], a[204:207], v[76:79], v[48:51]
    buffer_load_dwordx4 v[104:107], v175, s[64:67], s25 offen offset:3072 sc1
    s_waitcnt lgkmcnt(2)
    v_mfma_f32_16x16x32_bf16 v[140:143], v[128:131], v[60:63], v[140:143]
    s_movk_i32 s9, 0x70
    v_lshrrev_b32 v164, 3, v152
    v_mfma_f32_16x16x32_bf16 v[52:55], v[128:131], v[68:71], v[52:55]
    v_lshlrev_b32 v164, 12, v164
    v_and_or_b32 v164, v153, s9, v164
    v_mfma_f32_16x16x32_bf16 v[56:59], v[128:131], v[72:75], v[56:59]
    s_mul_i32 s6, s78, 327680
    s_lshl_b32 s5, s79, 7
    v_mfma_f32_16x16x32_bf16 v[0:3], v[128:131], v[76:79], v[0:3]
    ds_read_b128 v[128:131], v157 offset:4096
    buffer_load_dwordx4 v[108:111], v175, s[64:67], s28 offen offset:3072 sc1
    s_waitcnt lgkmcnt(2)
    v_mfma_f32_16x16x32_bf16 v[144:147], v[112:115], v[60:63], v[144:147]
    s_add_u32 s6, s6, s5
    s_lshl_b32 s5, s77, 14
    v_mfma_f32_16x16x32_bf16 v[4:7], v[112:115], v[68:71], v[4:7]
    s_add_u32 s7, s6, s5
    s_add_u32 s7, s7, 262144
    v_mfma_f32_16x16x32_bf16 v[8:11], v[112:115], v[72:75], v[8:11]
    s_lshl_b32 s5, s77, 16
    s_add_u32 s6, s6, s5
    v_mfma_f32_16x16x32_bf16 v[12:15], v[112:115], v[76:79], v[12:15]
    ds_read_b128 v[112:115], v156 offset:8704
    buffer_load_dwordx4 v[120:123], v175, s[64:67], s31 offen offset:3072 sc1
    s_waitcnt lgkmcnt(2)
    v_mfma_f32_16x16x32_bf16 v[132:135], v[124:127], v[60:63], v[132:135]
    s_mov_b32 s5, 3145728
    s_add_u32 s6, s6, s5
    v_mfma_f32_16x16x32_bf16 v[28:31], v[124:127], v[68:71], v[28:31]
    s_add_u32 s7, s7, s5
    s_lshl_b32 s5, s77, 9
    v_mfma_f32_16x16x32_bf16 v[32:35], v[124:127], v[72:75], v[32:35]
    s_mul_i32 s4, s77, 15360
    v_add_u32 v154, s4, v153
    v_mfma_f32_16x16x32_bf16 v[36:39], v[124:127], v[76:79], v[36:39]
    ds_read_b128 v[124:127], v156 offset:12800
    buffer_load_dwordx4 v[80:83], v175, s[64:67], s26 offen offset:0 sc1
    s_waitcnt lgkmcnt(2)
    v_mfma_f32_16x16x32_bf16 v[136:139], v[128:131], v[60:63], v[136:139]
    v_and_b32 v155, 0xf0, v153
    v_lshrrev_b32 v163, 4, v152
    v_mfma_f32_16x16x32_bf16 v[16:19], v[128:131], v[68:71], v[16:19]
    v_lshl_add_u32 v163, v163, 9, v155
    v_lshrrev_b32 v172, 5, v152
    v_mfma_f32_16x16x32_bf16 v[20:23], v[128:131], v[72:75], v[20:23]
    v_lshl_add_u32 v155, v172, 3, v155
    v_mfma_f32_16x16x32_bf16 v[24:27], v[128:131], v[76:79], v[24:27]
    ds_read_b128 v[128:131], v156 offset:512
    buffer_load_dwordx4 v[116:119], v175, s[64:67], s26 offen offset:1024 sc1
    s_waitcnt vmcnt(10)
    v_mfma_f32_16x16x32_bf16 v[148:151], a[208:211], v[84:87], v[148:151]
    s_lshl_b32 s4, s78, 8
    v_add_u32 v155, s4, v155
    v_mfma_f32_16x16x32_bf16 v[40:43], a[208:211], v[88:91], v[40:43]
    s_lshl_b32 s4, s79, 13
    s_waitcnt vmcnt(8)
    v_mfma_f32_16x16x32_bf16 v[44:47], a[208:211], v[92:95], v[44:47]
    s_add_u32 s4, s4, s100
    s_add_u32 s4, s4, 10485760
    v_mfma_f32_16x16x32_bf16 v[48:51], a[208:211], v[96:99], v[48:51]
    buffer_load_dwordx4 v[64:67], v175, s[64:67], s26 offen offset:2048 sc1
    s_waitcnt lgkmcnt(2)
    v_mfma_f32_16x16x32_bf16 v[140:143], v[112:115], v[84:87], v[140:143]
    s_add_u32 s98, s50, s4
    s_addc_u32 s99, s51, 0
    v_mfma_f32_16x16x32_bf16 v[52:55], v[112:115], v[88:91], v[52:55]
    s_add_u32 s4, s100, 61440
    v_lshl_add_u32 v170, v152, 3, s4
    v_mfma_f32_16x16x32_bf16 v[56:59], v[112:115], v[92:95], v[56:59]
    s_add_u32 s4, s5, 69632
    v_lshl_add_u32 v171, v152, 3, s4
    v_mfma_f32_16x16x32_bf16 v[0:3], v[112:115], v[96:99], v[0:3]
    ds_read_b128 v[112:115], v156 offset:4608
    buffer_load_dwordx4 v[60:63], v175, s[64:67], s26 offen offset:3072 sc1
    s_waitcnt lgkmcnt(2)
    v_mfma_f32_16x16x32_bf16 v[144:147], v[124:127], v[84:87], v[144:147]
    v_mfma_f32_16x16x32_bf16 v[4:7], v[124:127], v[88:91], v[4:7]
    v_mfma_f32_16x16x32_bf16 v[8:11], v[124:127], v[92:95], v[8:11]
    v_mfma_f32_16x16x32_bf16 v[12:15], v[124:127], v[96:99], v[12:15]
    ds_read_b128 v[124:127], v157 offset:8704
    buffer_load_dwordx4 v[68:71], v175, s[64:67], s27 offen offset:0 sc1
    s_waitcnt lgkmcnt(2)
    v_mfma_f32_16x16x32_bf16 v[132:135], v[128:131], v[84:87], v[132:135]
    v_mfma_f32_16x16x32_bf16 v[28:31], v[128:131], v[88:91], v[28:31]
    v_mfma_f32_16x16x32_bf16 v[32:35], v[128:131], v[92:95], v[32:35]
    v_mfma_f32_16x16x32_bf16 v[36:39], v[128:131], v[96:99], v[36:39]
    ds_read_b128 v[128:131], v157 offset:12800
    buffer_load_dwordx4 v[72:75], v175, s[64:67], s27 offen offset:1024 sc1
    s_waitcnt lgkmcnt(2)
    v_mfma_f32_16x16x32_bf16 v[136:139], v[112:115], v[84:87], v[136:139]
    v_mfma_f32_16x16x32_bf16 v[16:19], v[112:115], v[88:91], v[16:19]
    v_mfma_f32_16x16x32_bf16 v[20:23], v[112:115], v[92:95], v[20:23]
    v_mfma_f32_16x16x32_bf16 v[24:27], v[112:115], v[96:99], v[24:27]
    ds_read_b128 v[112:115], v157 offset:512
    buffer_load_dwordx4 v[76:79], v175, s[64:67], s29 offen offset:0 sc1
    s_waitcnt vmcnt(9)
    v_mfma_f32_16x16x32_bf16 v[148:151], a[212:215], v[100:103], v[148:151]
    v_mfma_f32_16x16x32_bf16 v[40:43], a[212:215], v[104:107], v[40:43]
    s_waitcnt vmcnt(7)
    v_mfma_f32_16x16x32_bf16 v[44:47], a[212:215], v[108:111], v[44:47]
    v_mfma_f32_16x16x32_bf16 v[48:51], a[212:215], v[120:123], v[48:51]
    buffer_load_dwordx4 v[84:87], v175, s[64:67], s29 offen offset:1024 sc1
    s_waitcnt lgkmcnt(2)
    v_mfma_f32_16x16x32_bf16 v[140:143], v[124:127], v[100:103], v[140:143]
    v_mfma_f32_16x16x32_bf16 v[52:55], v[124:127], v[104:107], v[52:55]
    v_mfma_f32_16x16x32_bf16 v[56:59], v[124:127], v[108:111], v[56:59]
    v_mfma_f32_16x16x32_bf16 v[0:3], v[124:127], v[120:123], v[0:3]
    ds_read_b128 v[124:127], v157 offset:4608
    buffer_load_dwordx4 v[88:91], v175, s[64:67], s29 offen offset:2048 sc1
    s_waitcnt lgkmcnt(2)
    v_mfma_f32_16x16x32_bf16 v[144:147], v[128:131], v[100:103], v[144:147]
    v_mfma_f32_16x16x32_bf16 v[4:7], v[128:131], v[104:107], v[4:7]
    v_mfma_f32_16x16x32_bf16 v[8:11], v[128:131], v[108:111], v[8:11]
    v_mfma_f32_16x16x32_bf16 v[12:15], v[128:131], v[120:123], v[12:15]
    buffer_load_dwordx4 v[92:95], v175, s[64:67], s29 offen offset:3072 sc1
    s_waitcnt lgkmcnt(1)
    v_mfma_f32_16x16x32_bf16 v[132:135], v[112:115], v[100:103], v[132:135]
    v_mfma_f32_16x16x32_bf16 v[28:31], v[112:115], v[104:107], v[28:31]
    v_mfma_f32_16x16x32_bf16 v[32:35], v[112:115], v[108:111], v[32:35]
    v_mfma_f32_16x16x32_bf16 v[36:39], v[112:115], v[120:123], v[36:39]
    buffer_load_dwordx4 v[96:99], v175, s[64:67], s30 offen offset:0 sc1
    s_waitcnt lgkmcnt(0)
    v_mfma_f32_16x16x32_bf16 v[136:139], v[124:127], v[100:103], v[136:139]
    v_mfma_f32_16x16x32_bf16 v[16:19], v[124:127], v[104:107], v[16:19]
    v_mfma_f32_16x16x32_bf16 v[20:23], v[124:127], v[108:111], v[20:23]
    v_mfma_f32_16x16x32_bf16 v[24:27], v[124:127], v[120:123], v[24:27]
    buffer_load_dwordx4 v[100:103], v175, s[64:67], s30 offen offset:1024 sc1
    s_waitcnt vmcnt(10)
    v_mfma_f32_16x16x32_bf16 v[28:31], a[232:235], v[80:83], v[28:31]
    v_mfma_f32_16x16x32_bf16 v[28:31], a[236:239], v[116:119], v[28:31]
    s_waitcnt vmcnt(8)
    v_mfma_f32_16x16x32_bf16 v[28:31], a[240:243], v[64:67], v[28:31]
    v_mfma_f32_16x16x32_bf16 v[28:31], a[244:247], v[60:63], v[28:31]
    buffer_load_dwordx4 v[104:107], v175, s[64:67], s32 offen offset:0 sc1
    s_waitcnt vmcnt(7)
    v_mfma_f32_16x16x32_bf16 v[28:31], v[224:227], v[68:71], v[28:31]
    s_add_u32 s3, s77, 1
    s_and_b32 s3, s3, 3
    v_mfma_f32_16x16x32_bf16 v[28:31], v[228:231], v[72:75], v[28:31]
    s_mul_i32 s3, s3, 15360
    v_add_u32 v165, s3, v153
    v_mfma_f32_16x16x32_bf16 v[16:19], v[176:179], v[80:83], v[16:19]
    v_mfma_f32_16x16x32_bf16 v[16:19], v[180:183], v[116:119], v[16:19]
    buffer_load_dwordx4 v[108:111], v175, s[64:67], s32 offen offset:1024 sc1
    s_mul_i32 s8, s79, 163840
    v_mov_b64 v[112:113], 0
    v_mov_b64 v[114:115], 0
    v_mfma_f32_16x16x32_bf16 v[16:19], v[184:187], v[64:67], v[16:19]
    s_mul_i32 s12, s77, 20480
    s_mul_i32 s9, s78, 2560
    v_mov_b64 v[124:125], 0
    v_mov_b64 v[126:127], 0
    v_mfma_f32_16x16x32_bf16 v[16:19], v[188:191], v[60:63], v[16:19]
    ds_write_b128 v165, v[28:31] offset:0
    s_add_u32 s9, s9, s8
    v_mov_b64 v[128:129], 0
    v_mov_b64 v[130:131], 0
    v_mfma_f32_16x16x32_bf16 v[16:19], v[232:235], v[68:71], v[16:19]
    s_lshl_b32 s85, s85, 4
    s_lshl_b32 s90, s90, 4
    v_mfma_f32_16x16x32_bf16 v[16:19], v[236:239], v[72:75], v[16:19]
    buffer_load_dwordx4 v[120:123], v175, s[64:67], s32 offen offset:2048 sc1
    s_lshl_b32 s72, s72, 4
    v_mfma_f32_16x16x32_bf16 v[52:55], v[192:195], v[80:83], v[52:55]
    s_add_u32 s72, s72, s8
    s_lshl_b32 s73, s73, 4
    v_mfma_f32_16x16x32_bf16 v[52:55], v[196:199], v[116:119], v[52:55]
    s_add_u32 s73, s73, s8
    s_lshl_b32 s74, s74, 4
    v_mfma_f32_16x16x32_bf16 v[52:55], v[200:203], v[64:67], v[52:55]
    s_add_u32 s74, s74, s8
    s_lshl_b32 s75, s75, 4
    v_mfma_f32_16x16x32_bf16 v[52:55], v[204:207], v[60:63], v[52:55]
    ds_write_b128 v165, v[16:19] offset:1024
    s_add_u32 s75, s75, s8
    v_mfma_f32_16x16x32_bf16 v[52:55], v[240:243], v[68:71], v[52:55]
    s_lshl_b32 s76, s76, 4
    s_add_u32 s76, s76, s8
    v_mfma_f32_16x16x32_bf16 v[52:55], v[244:247], v[72:75], v[52:55]
    s_lshl_b32 s8, s81, 13
    v_add_u32 v158, s8, v153
    v_mfma_f32_16x16x32_bf16 v[4:7], v[208:211], v[80:83], v[4:7]
    v_xor_b32 v159, 0x2000, v158
    v_add_u32 v173, s12, v153
    v_mfma_f32_16x16x32_bf16 v[4:7], v[212:215], v[116:119], v[4:7]
    s_add_u32 s12, s12, s9
    v_mfma_f32_16x16x32_bf16 v[4:7], v[216:219], v[64:67], v[4:7]
    v_mfma_f32_16x16x32_bf16 v[4:7], v[220:223], v[60:63], v[4:7]
    ds_write_b128 v165, v[52:55] offset:2048
    v_mfma_f32_16x16x32_bf16 v[4:7], v[248:251], v[68:71], v[4:7]
    v_mfma_f32_16x16x32_bf16 v[4:7], v[252:255], v[72:75], v[4:7]
    v_mfma_f32_16x16x32_bf16 v[40:43], a[216:219], v[80:83], v[40:43]
    buffer_load_dwordx4 v[80:83], v175, s[64:67], s32 offen offset:3072 sc1
    v_mfma_f32_16x16x32_bf16 v[40:43], a[220:223], v[116:119], v[40:43]
    v_mfma_f32_16x16x32_bf16 v[40:43], a[224:227], v[64:67], v[40:43]
    v_mfma_f32_16x16x32_bf16 v[40:43], a[228:231], v[60:63], v[40:43]
    s_nop 2
    ds_write_b128 v165, v[4:7] offset:3072
    v_mfma_f32_16x16x32_bf16 v[40:43], a[248:251], v[68:71], v[40:43]
    buffer_load_dwordx4 v[116:119], v175, s[64:67], s33 offen offset:0 sc1
    v_mfma_f32_16x16x32_bf16 v[40:43], a[252:255], v[72:75], v[40:43]
    s_waitcnt vmcnt(9)
    v_mfma_f32_16x16x32_bf16 v[32:35], a[232:235], v[76:79], v[32:35]
    v_mfma_f32_16x16x32_bf16 v[32:35], a[236:239], v[84:87], v[32:35]
    s_waitcnt vmcnt(7)
    v_mfma_f32_16x16x32_bf16 v[32:35], a[240:243], v[88:91], v[32:35]
    buffer_load_dwordx4 v[64:67], v175, s[64:67], s33 offen offset:1024 sc1
    v_mfma_f32_16x16x32_bf16 v[32:35], a[244:247], v[92:95], v[32:35]
    s_nop 0
    ds_write_b128 v165, v[40:43] offset:4096
    s_waitcnt vmcnt(6)
    v_mfma_f32_16x16x32_bf16 v[32:35], v[224:227], v[96:99], v[32:35]
    s_add_u32 s3, s77, 2
    s_and_b32 s3, s3, 3
    v_mfma_f32_16x16x32_bf16 v[32:35], v[228:231], v[100:103], v[32:35]
    s_mul_i32 s3, s3, 15360
    v_add_u32 v165, s3, v153
    v_mfma_f32_16x16x32_bf16 v[20:23], v[176:179], v[76:79], v[20:23]
    buffer_load_dwordx4 v[60:63], v175, s[64:67], s23 offen offset:3072 sc1
    v_mfma_f32_16x16x32_bf16 v[20:23], v[180:183], v[84:87], v[20:23]
    v_mfma_f32_16x16x32_bf16 v[20:23], v[184:187], v[88:91], v[20:23]
    v_mfma_f32_16x16x32_bf16 v[20:23], v[188:191], v[92:95], v[20:23]
    s_nop 0
    ds_write_b128 v165, v[32:35] offset:5120
    v_mfma_f32_16x16x32_bf16 v[20:23], v[232:235], v[96:99], v[20:23]
    buffer_load_dwordx4 v[68:71], v175, s[64:67], s24 offen offset:0 sc1
    v_mfma_f32_16x16x32_bf16 v[20:23], v[236:239], v[100:103], v[20:23]
    v_mfma_f32_16x16x32_bf16 v[56:59], v[192:195], v[76:79], v[56:59]
    v_mfma_f32_16x16x32_bf16 v[56:59], v[196:199], v[84:87], v[56:59]
    v_mfma_f32_16x16x32_bf16 v[56:59], v[200:203], v[88:91], v[56:59]
    buffer_load_dwordx4 v[72:75], v175, s[64:67], s24 offen offset:1024 sc1
    v_mfma_f32_16x16x32_bf16 v[56:59], v[204:207], v[92:95], v[56:59]
    s_nop 2
    ds_write_b128 v165, v[20:23] offset:6144
    s_lshl_b32 s8, s77, 2
    v_mfma_f32_16x16x32_bf16 v[56:59], v[240:243], v[96:99], v[56:59]
    s_add_u32 s8, s8, 61440
    v_bfe_u32 v172, v152, 2, 2
    v_mfma_f32_16x16x32_bf16 v[56:59], v[244:247], v[100:103], v[56:59]
    v_lshl_add_u32 v166, v172, 5, s8
    v_bfe_u32 v172, v152, 0, 1
    v_mfma_f32_16x16x32_bf16 v[8:11], v[208:211], v[76:79], v[8:11]
    v_lshl_add_u32 v166, v172, 4, v166
    v_bfe_u32 v172, v152, 1, 1
    v_mfma_f32_16x16x32_bf16 v[8:11], v[212:215], v[84:87], v[8:11]
    v_lshl_add_u32 v166, v172, 1, v166
    v_lshrrev_b32 v172, 4, v152
    v_mfma_f32_16x16x32_bf16 v[8:11], v[216:219], v[88:91], v[8:11]
    v_lshl_add_u32 v167, v172, 9, v166
    v_lshl_add_u32 v166, v172, 10, v166
    v_mfma_f32_16x16x32_bf16 v[8:11], v[220:223], v[92:95], v[8:11]
    ds_write_b128 v165, v[56:59] offset:7168
    v_mfma_f32_16x16x32_bf16 v[8:11], v[248:251], v[96:99], v[8:11]
    v_mfma_f32_16x16x32_bf16 v[8:11], v[252:255], v[100:103], v[8:11]
    v_mfma_f32_16x16x32_bf16 v[44:47], a[216:219], v[76:79], v[44:47]
    v_mfma_f32_16x16x32_bf16 v[44:47], a[220:223], v[84:87], v[44:47]
    v_mfma_f32_16x16x32_bf16 v[44:47], a[224:227], v[88:91], v[44:47]
    v_mfma_f32_16x16x32_bf16 v[44:47], a[228:231], v[92:95], v[44:47]
    s_nop 3
    ds_write_b128 v165, v[8:11] offset:8192
    v_mfma_f32_16x16x32_bf16 v[44:47], a[248:251], v[96:99], v[44:47]
    v_mfma_f32_16x16x32_bf16 v[44:47], a[252:255], v[100:103], v[44:47]
    s_waitcnt vmcnt(7)
    v_mfma_f32_16x16x32_bf16 v[36:39], a[232:235], v[104:107], v[36:39]
    v_mfma_f32_16x16x32_bf16 v[36:39], a[236:239], v[108:111], v[36:39]
    s_waitcnt vmcnt(5)
    v_mfma_f32_16x16x32_bf16 v[36:39], a[240:243], v[120:123], v[36:39]
    v_mfma_f32_16x16x32_bf16 v[36:39], a[244:247], v[80:83], v[36:39]
    s_nop 1
    ds_write_b128 v165, v[44:47] offset:9216
    s_waitcnt vmcnt(3)
    v_mfma_f32_16x16x32_bf16 v[36:39], v[224:227], v[116:119], v[36:39]
    s_add_u32 s3, s77, 3
    s_and_b32 s3, s3, 3
    v_mfma_f32_16x16x32_bf16 v[36:39], v[228:231], v[64:67], v[36:39]
    s_mul_i32 s3, s3, 15360
    v_add_u32 v165, s3, v153
    v_mfma_f32_16x16x32_bf16 v[24:27], v[176:179], v[104:107], v[24:27]
    v_mfma_f32_16x16x32_bf16 v[24:27], v[180:183], v[108:111], v[24:27]
    v_mfma_f32_16x16x32_bf16 v[24:27], v[184:187], v[120:123], v[24:27]
    v_mfma_f32_16x16x32_bf16 v[24:27], v[188:191], v[80:83], v[24:27]
    s_nop 1
    ds_write_b128 v165, v[36:39] offset:10240
    v_mfma_f32_16x16x32_bf16 v[24:27], v[232:235], v[116:119], v[24:27]
    v_mfma_f32_16x16x32_bf16 v[24:27], v[236:239], v[64:67], v[24:27]
    s_waitcnt lgkmcnt(1)
    s_barrier
    v_mfma_f32_16x16x32_bf16 v[0:3], v[192:195], v[104:107], v[0:3]
    ds_read_b128 v[28:31], v154 offset:0
    v_mfma_f32_16x16x32_bf16 v[0:3], v[196:199], v[108:111], v[0:3]
    ds_read_b128 v[16:19], v154 offset:1024
    s_add_u32 m0, s100, 61440
    s_nop 0
    buffer_load_dwordx4 v164, s[68:71], s6 offen sc1 lds
    v_mfma_f32_16x16x32_bf16 v[0:3], v[200:203], v[120:123], v[0:3]
    ds_read_b128 v[52:55], v154 offset:2048
    v_mfma_f32_16x16x32_bf16 v[0:3], v[204:207], v[80:83], v[0:3]
    ds_read_b128 v[4:7], v154 offset:3072
    ds_write_b128 v165, v[24:27] offset:11264
    v_mfma_f32_16x16x32_bf16 v[0:3], v[240:243], v[116:119], v[0:3]
    ds_read_b128 v[40:43], v154 offset:4096
    s_add_u32 m0, s100, 62464
    s_add_u32 s83, s6, 32768
    buffer_load_dwordx4 v164, s[68:71], s83 offen sc1 lds
    v_mfma_f32_16x16x32_bf16 v[0:3], v[244:247], v[64:67], v[0:3]
    ds_read_b128 v[32:35], v154 offset:5120
    v_mfma_f32_16x16x32_bf16 v[12:15], v[208:211], v[104:107], v[12:15]
    ds_read_b128 v[20:23], v154 offset:6144
    s_waitcnt lgkmcnt(7)
    v_add_f32 v132, v132, v28
    v_add_f32 v133, v133, v29
    v_mfma_f32_16x16x32_bf16 v[12:15], v[212:215], v[108:111], v[12:15]
    ds_read_b128 v[56:59], v154 offset:7168
    s_add_u32 m0, s5, 69632
    s_mov_b32 exec_hi, 0
    buffer_load_dwordx4 v164, s[68:71], s7 offen sc1 lds
    s_mov_b32 exec_hi, -1
    v_add_f32 v134, v134, v30
    v_add_f32 v135, v135, v31
    v_mfma_f32_16x16x32_bf16 v[12:15], v[216:219], v[120:123], v[12:15]
    ds_read_b128 v[8:11], v154 offset:8192
    s_waitcnt lgkmcnt(8)
    v_add_f32 v136, v136, v16
    v_add_f32 v137, v137, v17
    v_mfma_f32_16x16x32_bf16 v[12:15], v[220:223], v[80:83], v[12:15]
    ds_read_b128 v[44:47], v154 offset:9216
    ds_write_b128 v165, v[0:3] offset:12288
    v_add_f32 v138, v138, v18
    v_add_f32 v139, v139, v19
    v_mfma_f32_16x16x32_bf16 v[12:15], v[248:251], v[116:119], v[12:15]
    s_waitcnt lgkmcnt(9)
    v_add_f32 v140, v140, v52
    v_add_f32 v141, v141, v53
    v_mfma_f32_16x16x32_bf16 v[12:15], v[252:255], v[64:67], v[12:15]
    v_add_f32 v142, v142, v54
    v_add_f32 v143, v143, v55
    v_mfma_f32_16x16x32_bf16 v[48:51], a[216:219], v[104:107], v[48:51]
    s_waitcnt lgkmcnt(8)
    v_add_f32 v144, v144, v4
    v_add_f32 v145, v145, v5
    v_mfma_f32_16x16x32_bf16 v[48:51], a[220:223], v[108:111], v[48:51]
    v_add_f32 v146, v146, v6
    v_add_f32 v147, v147, v7
    v_mfma_f32_16x16x32_bf16 v[48:51], a[224:227], v[120:123], v[48:51]
    s_waitcnt lgkmcnt(6)
    v_add_f32 v148, v148, v40
    v_add_f32 v149, v149, v41
    v_mfma_f32_16x16x32_bf16 v[48:51], a[228:231], v[80:83], v[48:51]
    ds_write_b128 v165, v[12:15] offset:13312
    v_add_f32 v150, v150, v42
    v_add_f32 v151, v151, v43
    v_mfma_f32_16x16x32_bf16 v[48:51], a[248:251], v[116:119], v[48:51]
    v_mfma_f32_16x16x32_bf16 v[48:51], a[252:255], v[64:67], v[48:51]
    s_waitcnt lgkmcnt(6)
    s_waitcnt vmcnt(5)
    v_mfma_f32_16x16x32_bf16 v[32:35], a[244:247], v[60:63], v[32:35]
    s_waitcnt vmcnt(4)
    v_mfma_f32_16x16x32_bf16 v[32:35], v[224:227], v[68:71], v[32:35]
    s_waitcnt vmcnt(3)
    v_mfma_f32_16x16x32_bf16 v[32:35], v[228:231], v[72:75], v[32:35]
    v_mov_b64 v[116:117], 0
    v_mov_b64 v[118:119], 0
    s_waitcnt lgkmcnt(5)
    v_mfma_f32_16x16x32_bf16 v[20:23], v[188:191], v[60:63], v[20:23]
    ds_write_b128 v165, v[48:51] offset:14336
    v_mov_b64 v[120:121], 0
    v_mov_b64 v[122:123], 0
    v_mfma_f32_16x16x32_bf16 v[20:23], v[232:235], v[68:71], v[20:23]
    v_mfma_f32_16x16x32_bf16 v[20:23], v[236:239], v[72:75], v[20:23]
    s_waitcnt lgkmcnt(5)
    v_mfma_f32_16x16x32_bf16 v[56:59], v[204:207], v[60:63], v[56:59]
    v_mfma_f32_16x16x32_bf16 v[56:59], v[240:243], v[68:71], v[56:59]
    v_mfma_f32_16x16x32_bf16 v[56:59], v[244:247], v[72:75], v[56:59]
    s_waitcnt lgkmcnt(0)
    s_barrier
    v_mfma_f32_16x16x32_bf16 v[8:11], v[220:223], v[60:63], v[8:11]
    ds_read_b128 v[28:31], v154 offset:10240
    v_mfma_f32_16x16x32_bf16 v[8:11], v[248:251], v[68:71], v[8:11]
    ds_read_b128 v[16:19], v154 offset:11264
    v_mfma_f32_16x16x32_bf16 v[8:11], v[252:255], v[72:75], v[8:11]
    ds_read_b128 v[52:55], v154 offset:12288
    v_mfma_f32_16x16x32_bf16 v[44:47], a[228:231], v[60:63], v[44:47]
    ds_read_b128 v[4:7], v154 offset:13312
    v_mfma_f32_16x16x32_bf16 v[44:47], a[248:251], v[68:71], v[44:47]
    ds_read_b128 v[40:43], v154 offset:14336
    v_mfma_f32_16x16x32_bf16 v[44:47], a[252:255], v[72:75], v[44:47]
    v_pk_add_f32 v[132:133], v[132:133], v[32:33]
    v_pk_add_f32 v[134:135], v[134:135], v[34:35]
    v_pk_add_f32 v[136:137], v[136:137], v[20:21]
    v_pk_add_f32 v[138:139], v[138:139], v[22:23]
    v_pk_add_f32 v[140:141], v[140:141], v[56:57]
    v_pk_add_f32 v[142:143], v[142:143], v[58:59]
    v_pk_add_f32 v[144:145], v[144:145], v[8:9]
    v_pk_add_f32 v[146:147], v[146:147], v[10:11]
    v_pk_add_f32 v[148:149], v[148:149], v[44:45]
    v_pk_add_f32 v[150:151], v[150:151], v[46:47]
    s_waitcnt lgkmcnt(4)
    v_pk_add_f32 v[132:133], v[132:133], v[28:29]
    v_pk_add_f32 v[134:135], v[134:135], v[30:31]
    s_waitcnt lgkmcnt(3)
    v_pk_add_f32 v[136:137], v[136:137], v[16:17]
    v_pk_add_f32 v[138:139], v[138:139], v[18:19]
    s_waitcnt lgkmcnt(2)
    v_pk_add_f32 v[140:141], v[140:141], v[52:53]
    v_pk_add_f32 v[142:143], v[142:143], v[54:55]
    s_waitcnt lgkmcnt(1)
    v_pk_add_f32 v[144:145], v[144:145], v[4:5]
    v_pk_add_f32 v[146:147], v[146:147], v[6:7]
    s_waitcnt lgkmcnt(0)
    v_pk_add_f32 v[148:149], v[148:149], v[40:41]
    v_pk_add_f32 v[150:151], v[150:151], v[42:43]
    v_pk_add_f32 v[4:5], v[132:133], v[134:135]
    v_pk_mul_f32 v[6:7], v[132:133], v[132:133]
    v_pk_fma_f32 v[6:7], v[134:135], v[134:135], v[6:7]
    v_pk_fma_f32 v[6:7], v[136:137], v[136:137], v[6:7]
    v_pk_add_f32 v[4:5], v[4:5], v[136:137]
    v_pk_fma_f32 v[6:7], v[138:139], v[138:139], v[6:7]
    v_pk_add_f32 v[4:5], v[4:5], v[138:139]
    v_pk_fma_f32 v[6:7], v[140:141], v[140:141], v[6:7]
    v_pk_add_f32 v[4:5], v[4:5], v[140:141]
    v_pk_fma_f32 v[6:7], v[142:143], v[142:143], v[6:7]
    v_pk_add_f32 v[4:5], v[4:5], v[142:143]
    v_pk_fma_f32 v[6:7], v[144:145], v[144:145], v[6:7]
    v_pk_add_f32 v[4:5], v[4:5], v[144:145]
    v_pk_fma_f32 v[6:7], v[146:147], v[146:147], v[6:7]
    v_pk_add_f32 v[4:5], v[4:5], v[146:147]
    v_pk_fma_f32 v[6:7], v[148:149], v[148:149], v[6:7]
    v_pk_add_f32 v[4:5], v[4:5], v[148:149]
    v_pk_fma_f32 v[6:7], v[150:151], v[150:151], v[6:7]
    v_pk_add_f32 v[4:5], v[4:5], v[150:151]
    v_add_f32 v6, v6, v7
    v_add_f32 v4, v4, v5
    v_mov_b32 v1, s82
    s_nop 0
    v_permlane32_swap_b32 v4, v6
    v_add_f32 v4, v4, v6
    v_mov_b32 v6, v4
    s_nop 1
    v_permlane16_swap_b32 v4, v6
    v_add_f32 v0, v4, v6

    s_cmp_eq_u32 s88, 0
    s_cbranch_scc1 Lss_3
    global_store_dwordx2 v155, v[0:1], s[98:99]
Lsd_4:
    s_waitcnt vmcnt(1)
    ds_read2st64_b32 v[8:9], v170 offset1:2
    ds_read2st64_b32 v[10:11], v170 offset0:4 offset1:6
    ds_read_b32 v12, v171
    v_and_b32 v84, 0xf0, v153
    v_lshrrev_b32 v85, 5, v152
    v_lshl_add_u32 v84, v85, 8, v84
    v_bfe_u32 v85, v152, 2, 3
    v_mul_u32_u24 v85, 2560, v85
    v_and_b32 v86, 3, v152
    v_min_u32 v86, 2, v86
    v_lshl_add_u32 v85, v86, 10, v85
    s_mul_i32 s3, s78, 2560
    s_sub_u32 s3, s12, s3
    v_add_u32 v85, s3, v85
    s_waitcnt lgkmcnt(0)
    v_max3_u32 v169, v8, v9, v10
    v_max3_u32 v169, v169, v11, v12
    v_cmp_eq_u32 s[96:97], -1, v169
    s_cmp_lg_u64 s[96:97], 0
    s_cbranch_scc1 L_gcr
L_gc:
    global_load_dwordx4 v[0:3], v163, s[98:99] sc1
    global_load_dwordx4 v[4:7], v163, s[98:99] offset:256 sc1
    s_barrier
    ds_read_u16_d16_hi v112, v166 offset:0
    ds_read_u16_d16_hi v113, v166 offset:128
    ds_read_u16_d16_hi v114, v166 offset:256
    ds_read_u16_d16_hi v115, v166 offset:384
    ds_read_u16_d16_hi v116, v166 offset:512
    ds_read_u16_d16_hi v117, v166 offset:640
    ds_read_u16_d16_hi v118, v166 offset:768
    ds_read_u16_d16_hi v119, v166 offset:896
    ds_read_u16_d16_hi v120, v166 offset:4096
    ds_read_u16_d16_hi v121, v166 offset:4224
    ds_read_u16_d16_hi v122, v166 offset:4352
    ds_read_u16_d16_hi v123, v166 offset:4480
    ds_read_u16_d16_hi v124, v166 offset:4608
    ds_read_u16_d16_hi v125, v166 offset:4736
    ds_read_u16_d16_hi v126, v166 offset:4864
    ds_read_u16_d16_hi v127, v166 offset:4992
    ds_read_u16_d16_hi v128, v167 offset:8192
    ds_read_u16_d16_hi v129, v167 offset:8320
    ds_read_u16_d16_hi v130, v167 offset:8448
    ds_read_u16_d16_hi v131, v167 offset:8576
    s_waitcnt lgkmcnt(0)
    s_waitcnt vmcnt(0)
    L_s1:
    v_min3_u32 v168, v1, v3, v5
    v_max3_u32 v1, v1, v3, v5
    v_min3_u32 v168, v168, v7, s82
    v_max3_u32 v1, v1, v7, s82
    v_cmp_ne_u32 vcc, v168, v1

    s_cbranch_vccz L_s1r
    s_sub_u32 s101, s101, 1
    s_cbranch_scc1 L_end
    global_load_dwordx4 v[0:3], v163, s[98:99] sc1
    global_load_dwordx4 v[4:7], v163, s[98:99] offset:256 sc1
    s_waitcnt vmcnt(0)
    s_branch L_s1
L_s1r:
    v_add_f32 v0, v0, v4
    v_add_f32 v2, v2, v6
    s_nop 1
    v_permlane32_swap_b32 v0, v2
    v_add_f32 v0, v0, v2
    v_mov_b32 v2, v0
    s_nop 1
    v_permlane16_swap_b32 v0, v2
    v_add_f32 v0, v0, v2
    v_mov_b32 v2, v0
    s_nop 1
    v_permlane32_swap_b32 v0, v2
    v_mul_f32 v0, 0x3acccccd, v0
    v_mov_b32 v166, 0x3727c5ac
    v_fmac_f32 v166, 0x3acccccd, v2
    v_fma_f32 v166, -v0, v0, v166
    v_max_f32 v166, 0x3727c5ac, v166
    v_rsq_f32 v166, v166
    s_nop 0
    v_mul_f32_e64 v167, -v0, v166
    v_pk_fma_f32 v[32:33], v[148:149], v[166:167], v[166:167] op_sel:[0,0,1] op_sel_hi:[1,0,1]
    v_pk_fma_f32 v[34:35], v[150:151], v[166:167], v[166:167] op_sel:[0,0,1] op_sel_hi:[1,0,1]
    v_pk_fma_f32 v[16:17], v[132:133], v[166:167], v[166:167] op_sel:[0,0,1] op_sel_hi:[1,0,1]
    v_pk_fma_f32 v[18:19], v[134:135], v[166:167], v[166:167] op_sel:[0,0,1] op_sel_hi:[1,0,1]
    v_pk_fma_f32 v[20:21], v[136:137], v[166:167], v[166:167] op_sel:[0,0,1] op_sel_hi:[1,0,1]
    v_pk_fma_f32 v[22:23], v[138:139], v[166:167], v[166:167] op_sel:[0,0,1] op_sel_hi:[1,0,1]
    v_pk_fma_f32 v[24:25], v[140:141], v[166:167], v[166:167] op_sel:[0,0,1] op_sel_hi:[1,0,1]
    v_pk_fma_f32 v[26:27], v[142:143], v[166:167], v[166:167] op_sel:[0,0,1] op_sel_hi:[1,0,1]
    v_pk_fma_f32 v[28:29], v[144:145], v[166:167], v[166:167] op_sel:[0,0,1] op_sel_hi:[1,0,1]
    v_pk_fma_f32 v[30:31], v[146:147], v[166:167], v[166:167] op_sel:[0,0,1] op_sel_hi:[1,0,1]
    v_pk_fma_f32 v[148:149], v[32:33], v[128:129], v[148:149]
    v_pk_fma_f32 v[150:151], v[34:35], v[130:131], v[150:151]
    v_pk_fma_f32 v[132:133], v[16:17], v[112:113], v[132:133]
    v_pk_fma_f32 v[134:135], v[18:19], v[114:115], v[134:135]
    v_pk_fma_f32 v[136:137], v[20:21], v[116:117], v[136:137]
    v_pk_fma_f32 v[138:139], v[22:23], v[118:119], v[138:139]
    v_pk_fma_f32 v[140:141], v[24:25], v[120:121], v[140:141]
    v_pk_fma_f32 v[142:143], v[26:27], v[122:123], v[142:143]
    v_pk_fma_f32 v[144:145], v[28:29], v[124:125], v[144:145]
    v_pk_fma_f32 v[146:147], v[30:31], v[126:127], v[146:147]
    v_cvt_pk_bf16_f32 v44, v148, v149
    v_cvt_pk_bf16_f32 v45, v150, v151
    v_or_b32 v44, 1, v44
    v_cvt_pk_bf16_f32 v36, v132, v133
    v_cvt_pk_bf16_f32 v37, v134, v135
    v_or_b32 v36, 1, v36
    v_permlane16_swap_b32 v44, v46
    v_permlane16_swap_b32 v45, v47
    v_cvt_pk_bf16_f32 v38, v136, v137
    v_cvt_pk_bf16_f32 v39, v138, v139
    v_or_b32 v38, 1, v38
    v_cvt_pk_bf16_f32 v40, v140, v141
    v_cvt_pk_bf16_f32 v41, v142, v143
    v_or_b32 v40, 1, v40
    v_cvt_pk_bf16_f32 v42, v144, v145
    v_cvt_pk_bf16_f32 v43, v146, v147
    v_or_b32 v42, 1, v42
    s_cmp_eq_u32 s88, 0
    s_cbranch_scc1 Lss_5
    buffer_store_dwordx4 v[36:39], v153, s[64:67], s12 offen
    buffer_store_dwordx4 v[40:43], v153, s[64:67], s12 offen offset:1024
    s_mov_b32 exec_lo, 0xffff
    s_mov_b32 exec_hi, 0xffff
    buffer_store_dwordx4 v[44:47], v84, s[64:67], s12 offen offset:2048
Lsd_6:
    s_mov_b64 exec, -1
    v_pk_add_f32 v[4:5], v[132:133], v[134:135]
    v_pk_mul_f32 v[6:7], v[132:133], v[132:133]
    v_pk_fma_f32 v[6:7], v[134:135], v[134:135], v[6:7]
    v_pk_fma_f32 v[6:7], v[136:137], v[136:137], v[6:7]
    v_pk_add_f32 v[4:5], v[4:5], v[136:137]
    v_pk_fma_f32 v[6:7], v[138:139], v[138:139], v[6:7]
    v_pk_add_f32 v[4:5], v[4:5], v[138:139]
    v_pk_fma_f32 v[6:7], v[140:141], v[140:141], v[6:7]
    v_pk_add_f32 v[4:5], v[4:5], v[140:141]
    v_pk_fma_f32 v[6:7], v[142:143], v[142:143], v[6:7]
    v_pk_add_f32 v[4:5], v[4:5], v[142:143]
    v_pk_fma_f32 v[6:7], v[144:145], v[144:145], v[6:7]
    v_pk_add_f32 v[4:5], v[4:5], v[144:145]
    v_pk_fma_f32 v[6:7], v[146:147], v[146:147], v[6:7]
    v_pk_add_f32 v[4:5], v[4:5], v[146:147]
    v_pk_fma_f32 v[6:7], v[148:149], v[148:149], v[6:7]
    v_pk_add_f32 v[4:5], v[4:5], v[148:149]
    v_pk_fma_f32 v[6:7], v[150:151], v[150:151], v[6:7]
    v_pk_add_f32 v[4:5], v[4:5], v[150:151]
    v_add_f32 v6, v6, v7
    v_add_f32 v4, v4, v5
    v_mov_b32 v1, s82
    s_nop 0
    v_permlane32_swap_b32 v4, v6
    v_add_f32 v4, v4, v6
    v_mov_b32 v6, v4
    s_nop 1
    v_permlane16_swap_b32 v4, v6
    v_add_f32 v0, v4, v6

    s_add_u32 s98, s98, 0x40000
    s_addc_u32 s99, s99, 0
    s_cmp_eq_u32 s88, 0
    s_cbranch_scc1 Lss_7
    global_store_dwordx2 v155, v[0:1], s[98:99]
Lsd_8:
    v_bfe_u32 v122, v152, 2, 2
    s_lshl_b32 s3, s77, 4
    s_add_u32 s3, s3, 92160
    v_lshl_add_u32 v120, v122, 6, s3
    s_lshl_b32 s3, s77, 3
    s_add_u32 s3, s3, 92672
    v_lshl_add_u32 v121, v122, 6, s3
    v_bfe_u32 v122, v152, 0, 2
    v_lshl_add_u32 v120, v122, 2, v120
    v_bfe_u32 v122, v152, 0, 1
    v_lshl_add_u32 v121, v122, 5, v121
    v_bfe_u32 v122, v152, 1, 1
    v_lshl_add_u32 v121, v122, 2, v121
    v_and_b32 v122, 15, v152
    s_lshl_b32 s3, s77, 7
    s_add_u32 s3, s3, 81920
    v_lshl_add_u32 v165, v122, 3, s3
    v_bfe_u32 v171, v152, 1, 2
    s_lshl_b32 s3, s77, 5
    s_add_u32 s3, s3, 82432
    v_lshl_add_u32 v171, v171, 3, s3
    v_not_b32 v122, v152
    v_lshlrev_b32 v122, 28, v122
    v_and_b32 v170, 0x80000000, v122
    v_lshrrev_b32 v122, 4, v152
    s_mov_b32 s3, 92160
    v_lshl_add_u32 v164, v122, 6, s3
    v_and_b32 v48, 1, v152
    v_lshl_add_u32 v50, v48, 5, v164
    v_lshlrev_b32 v48, 2, v48
    v_lshl_add_u32 v48, v122, 8, v48
    v_and_b32 v122, 1, v122
    v_xor_b32 v122, s77, v122
    v_lshl_add_u32 v48, v122, 6, v48
    v_bfe_u32 v122, v152, 1, 2
    v_lshl_add_u32 v48, v122, 4, v48
    v_bfe_u32 v122, v152, 3, 1
    v_lshlrev_b32 v122, 12, v122
    s_mov_b32 s3, 0
    v_add3_u32 v48, v122, v48, s3
    v_xor_b32 v49, 8, v48
    ds_read_b64 v[128:129], v165 offset:7680
    ds_read_b64 v[130:131], v171 offset:7680
    s_lshl_b32 s3, s78, 2
    s_add_u32 s3, s3, s77
    s_lshl_b32 s3, s3, 13
    s_add_u32 s3, s3, 9699328
    s_add_u32 s92, s50, s3
    s_addc_u32 s93, s51, 0
    s_movk_i32 s94, 8192
    s_sub_u32 s21, 31, s79
    s_lshl_b32 s21, s21, 8
    s_lshl_b32 s3, s77, 12
    v_and_b32 v52, 16, v152
    v_lshlrev_b32 v52, 2, v52
    v_xor_b32 v52, v52, v153
    v_add_u32 v52, s3, v52
    s_waitcnt lgkmcnt(0)
    v_xor_b32 v131, v170, v131
L_xp:
    s_sub_u32 s101, s101, 1
    s_cbranch_scc1 L_end
    buffer_load_dword v168, v85, s[64:67], 0 offen sc1
    s_add_u32 m0, s100, 0
    s_nop 0
    buffer_load_dwordx4 v173, s[64:67], s72 offen offset:0 sc1 lds
    s_add_u32 m0, s100, 8192
    s_add_u32 s83, s72, 10240
    buffer_load_dwordx4 v173, s[64:67], s83 offen offset:0 sc1 lds
    s_add_u32 m0, s100, 0
    s_nop 0
    buffer_load_dwordx4 v173, s[64:67], s72 offen offset:1024 sc1 lds
    s_add_u32 m0, s100, 8192
    s_add_u32 s83, s72, 10240
    buffer_load_dwordx4 v173, s[64:67], s83 offen offset:1024 sc1 lds
    s_waitcnt vmcnt(4)
    v_and_b32 v168, 1, v168
    v_cmp_ne_u32 vcc, 1, v168
    s_cbranch_vccnz L_xp
    s_waitcnt vmcnt(2)
    s_barrier
    ds_read_b128 v[56:59], v158 offset:0
    ds_read_b128 v[60:63], v158 offset:2048
    ds_read_b128 v[64:67], v158 offset:4096
    ds_read_b128 v[68:71], v158 offset:6144
    s_add_u32 m0, s100, 16384
    s_nop 0
    buffer_load_dwordx4 v173, s[64:67], s73 offen offset:0 sc1 lds
    buffer_load_dwordx4 v173, s[64:67], s73 offen offset:1024 sc1 lds
    s_add_u32 m0, s100, 24576
    s_add_u32 s83, s73, 10240
    buffer_load_dwordx4 v173, s[64:67], s83 offen offset:0 sc1 lds
    buffer_load_dwordx4 v173, s[64:67], s83 offen offset:1024 sc1 lds
    s_waitcnt vmcnt(4)
    s_barrier
    ds_read_b128 v[72:75], v158 offset:1024
    ds_read_b128 v[76:79], v158 offset:3072
    ds_read_b128 v[80:83], v158 offset:5120
    ds_read_b128 v[84:87], v158 offset:7168
    ds_read_b128 v[88:91], v159 offset:0
    ds_read_b128 v[92:95], v159 offset:2048
    ds_read_b128 v[96:99], v159 offset:4096
    ds_read_b128 v[100:103], v159 offset:6144
    s_waitcnt lgkmcnt(8)
    v_bitop3_b32 v169, v56, v60, v64 bitop3:128
    v_bitop3_b32 v169, v169, v68, 1 bitop3:128
    v_cmp_ne_u32 vcc, 1, v169
    s_cbranch_vccnz L_xc0r
L_xc0:
    v_mfma_f32_16x16x32_bf16 v[0:3], v[56:59], a[0:3], 0
    s_add_u32 m0, s100, 32768
    s_nop 0
    buffer_load_dwordx4 v173, s[64:67], s74 offen offset:0 sc1 lds
    v_mfma_f32_16x16x32_bf16 v[16:19], v[56:59], a[8:11], 0
    v_mfma_f32_16x16x32_bf16 v[32:35], v[56:59], a[16:19], 0
    ds_read_b128 v[56:59], v159 offset:1024
    v_mfma_f32_16x16x32_bf16 v[4:7], v[60:63], a[0:3], 0
    buffer_load_dwordx4 v173, s[64:67], s74 offen offset:1024 sc1 lds
    v_mfma_f32_16x16x32_bf16 v[20:23], v[60:63], a[8:11], 0
    v_mfma_f32_16x16x32_bf16 v[36:39], v[60:63], a[16:19], 0
    ds_read_b128 v[60:63], v159 offset:3072
    v_mfma_f32_16x16x32_bf16 v[8:11], v[64:67], a[0:3], 0
    s_add_u32 m0, s100, 40960
    s_add_u32 s83, s74, 10240
    buffer_load_dwordx4 v173, s[64:67], s83 offen offset:0 sc1 lds
    v_mfma_f32_16x16x32_bf16 v[24:27], v[64:67], a[8:11], 0
    s_waitcnt lgkmcnt(6)
    v_bitop3_b32 v169, v72, v76, v80 bitop3:128
    v_bitop3_b32 v169, v169, v84, 1 bitop3:128
    v_mfma_f32_16x16x32_bf16 v[40:43], v[64:67], a[16:19], 0
    ds_read_b128 v[64:67], v159 offset:5120
    v_cmp_ne_u32 vcc, 1, v169
    v_mfma_f32_16x16x32_bf16 v[12:15], v[68:71], a[0:3], 0
    buffer_load_dwordx4 v173, s[64:67], s83 offen offset:1024 sc1 lds
    v_mfma_f32_16x16x32_bf16 v[28:31], v[68:71], a[8:11], 0
    v_mfma_f32_16x16x32_bf16 v[44:47], v[68:71], a[16:19], 0
    ds_read_b128 v[68:71], v159 offset:7168
    s_cbranch_vccnz L_xc1r
L_xc1:
    v_mfma_f32_16x16x32_bf16 v[0:3], v[72:75], a[4:7], v[0:3]
    global_load_dwordx4 v[104:107], v163, s[98:99] sc1
    v_mfma_f32_16x16x32_bf16 v[16:19], v[72:75], a[12:15], v[16:19]
    v_mfma_f32_16x16x32_bf16 v[32:35], v[72:75], a[20:23], v[32:35]
    global_load_dwordx4 v[108:111], v163, s[98:99] offset:256 sc1
    v_mfma_f32_16x16x32_bf16 v[4:7], v[76:79], a[4:7], v[4:7]
    v_mfma_f32_16x16x32_bf16 v[20:23], v[76:79], a[12:15], v[20:23]
    s_add_u32 m0, s100, 49152
    s_nop 0
    buffer_load_dwordx4 v173, s[64:67], s75 offen offset:0 sc1 lds
    v_mfma_f32_16x16x32_bf16 v[36:39], v[76:79], a[20:23], v[36:39]
    v_mfma_f32_16x16x32_bf16 v[8:11], v[80:83], a[4:7], v[8:11]
    v_mfma_f32_16x16x32_bf16 v[24:27], v[80:83], a[12:15], v[24:27]
    buffer_load_dwordx4 v173, s[64:67], s75 offen offset:1024 sc1 lds
    s_waitcnt lgkmcnt(4)
    v_bitop3_b32 v169, v88, v92, v96 bitop3:128
    v_bitop3_b32 v169, v169, v100, 1 bitop3:128
    v_mfma_f32_16x16x32_bf16 v[40:43], v[80:83], a[20:23], v[40:43]
    v_cmp_ne_u32 vcc, 1, v169
    v_mfma_f32_16x16x32_bf16 v[12:15], v[84:87], a[4:7], v[12:15]
    v_mfma_f32_16x16x32_bf16 v[28:31], v[84:87], a[12:15], v[28:31]
    s_add_u32 m0, s100, 57344
    s_add_u32 s83, s75, 10240
    buffer_load_dwordx4 v173, s[64:67], s83 offen offset:0 sc1 lds
    v_mfma_f32_16x16x32_bf16 v[44:47], v[84:87], a[20:23], v[44:47]
    s_cbranch_vccnz L_xc2r
L_xc2:
    v_mfma_f32_16x16x32_bf16 v[0:3], v[88:91], a[24:27], v[0:3]
    v_mfma_f32_16x16x32_bf16 v[16:19], v[88:91], a[32:35], v[16:19]
    buffer_load_dwordx4 v173, s[64:67], s83 offen offset:1024 sc1 lds
    v_mfma_f32_16x16x32_bf16 v[4:7], v[92:95], a[24:27], v[4:7]
    v_mfma_f32_16x16x32_bf16 v[20:23], v[92:95], a[32:35], v[20:23]
    s_waitcnt lgkmcnt(0)
    v_bitop3_b32 v169, v56, v60, v64 bitop3:128
    v_bitop3_b32 v169, v169, v68, 1 bitop3:128
    v_mfma_f32_16x16x32_bf16 v[8:11], v[96:99], a[24:27], v[8:11]
    s_add_u32 m0, s100, 65536
    s_nop 0
    buffer_load_dwordx4 v173, s[64:67], s76 offen offset:0 sc1 lds
    v_cmp_ne_u32 vcc, 1, v169
    v_mfma_f32_16x16x32_bf16 v[24:27], v[96:99], a[32:35], v[24:27]
    v_mfma_f32_16x16x32_bf16 v[12:15], v[100:103], a[24:27], v[12:15]
    s_waitcnt vmcnt(7)
    s_barrier
    v_add_u32 v158, 0x4000, v158
    v_add_u32 v159, 0x4000, v159
    ds_read_b128 v[72:75], v158 offset:0
    ds_read_b128 v[76:79], v158 offset:4096
    v_mfma_f32_16x16x32_bf16 v[28:31], v[100:103], a[32:35], v[28:31]
    buffer_load_dwordx4 v173, s[64:67], s76 offen offset:1024 sc1 lds
    ds_read_b128 v[80:83], v158 offset:2048
    ds_read_b128 v[84:87], v158 offset:6144
    s_cbranch_vccnz L_xc3r
L_xc3:
    v_mfma_f32_16x16x32_bf16 v[0:3], v[56:59], a[28:31], v[0:3]
    ds_read_b128 v[88:91], v158 offset:1024
    ds_read_b128 v[92:95], v158 offset:5120
    v_mfma_f32_16x16x32_bf16 v[16:19], v[56:59], a[36:39], v[16:19]
    ds_read_b128 v[96:99], v158 offset:3072
    ds_read_b128 v[100:103], v158 offset:7168
    v_mfma_f32_16x16x32_bf16 v[4:7], v[60:63], a[28:31], v[4:7]
    s_add_u32 m0, s100, 73728
    s_add_u32 s83, s76, 10240
    buffer_load_dwordx4 v173, s[64:67], s83 offen offset:0 sc1 lds
    ds_read_b128 v[56:59], v158 offset:16384
    v_mfma_f32_16x16x32_bf16 v[20:23], v[60:63], a[36:39], v[20:23]
    ds_read_b128 v[60:63], v158 offset:20480
    s_waitcnt lgkmcnt(6)
    v_bitop3_b32 v169, v72, v76, v80 bitop3:128
    v_bitop3_b32 v169, v169, v84, 1 bitop3:128
    v_mfma_f32_16x16x32_bf16 v[8:11], v[64:67], a[28:31], v[8:11]
    v_cmp_ne_u32 vcc, 1, v169
    v_mfma_f32_16x16x32_bf16 v[24:27], v[64:67], a[36:39], v[24:27]
    buffer_load_dwordx4 v173, s[64:67], s83 offen offset:1024 sc1 lds
    ds_read_b128 v[64:67], v158 offset:18432
    v_mfma_f32_16x16x32_bf16 v[12:15], v[68:71], a[28:31], v[12:15]
    v_mfma_f32_16x16x32_bf16 v[28:31], v[68:71], a[36:39], v[28:31]
    ds_read_b128 v[68:71], v158 offset:22528
    s_cbranch_vccnz L_xc4r
L_xc4:
    v_mfma_f32_16x16x32_bf16 v[0:3], v[72:75], a[40:43], v[0:3]
    v_mfma_f32_16x16x32_bf16 v[16:19], v[72:75], a[48:51], v[16:19]
    v_mfma_f32_16x16x32_bf16 v[32:35], v[72:75], a[56:59], v[32:35]
    ds_read_b128 v[72:75], v158 offset:17408
    v_mfma_f32_16x16x32_bf16 v[40:43], v[76:79], a[56:59], v[40:43]
    ds_read_b128 v[76:79], v158 offset:21504
    s_waitcnt lgkmcnt(6)
    v_bitop3_b32 v169, v88, v92, v96 bitop3:128
    v_bitop3_b32 v169, v169, v100, 1 bitop3:128
    v_mfma_f32_16x16x32_bf16 v[4:7], v[80:83], a[40:43], v[4:7]
    v_cmp_ne_u32 vcc, 1, v169
    v_mfma_f32_16x16x32_bf16 v[20:23], v[80:83], a[48:51], v[20:23]
    v_mfma_f32_16x16x32_bf16 v[36:39], v[80:83], a[56:59], v[36:39]
    ds_read_b128 v[80:83], v158 offset:19456
    v_mfma_f32_16x16x32_bf16 v[44:47], v[84:87], a[56:59], v[44:47]
    ds_read_b128 v[84:87], v158 offset:23552
    s_cbranch_vccnz L_xc5r
L_xc5:
    v_mfma_f32_16x16x32_bf16 v[0:3], v[88:91], a[44:47], v[0:3]
    v_mfma_f32_16x16x32_bf16 v[16:19], v[88:91], a[52:55], v[16:19]
    v_mfma_f32_16x16x32_bf16 v[32:35], v[88:91], a[60:63], v[32:35]
    v_mfma_f32_16x16x32_bf16 v[40:43], v[92:95], a[60:63], v[40:43]
    s_waitcnt lgkmcnt(4)
    v_bitop3_b32 v169, v56, v60, v64 bitop3:128
    v_bitop3_b32 v169, v169, v68, 1 bitop3:128
    v_mfma_f32_16x16x32_bf16 v[4:7], v[96:99], a[44:47], v[4:7]
    v_cmp_ne_u32 vcc, 1, v169
    v_mfma_f32_16x16x32_bf16 v[20:23], v[96:99], a[52:55], v[20:23]
    v_mfma_f32_16x16x32_bf16 v[36:39], v[96:99], a[60:63], v[36:39]
    v_mfma_f32_16x16x32_bf16 v[44:47], v[100:103], a[60:63], v[44:47]
    s_cbranch_vccnz L_xc6r
L_xc6:
    v_mfma_f32_16x16x32_bf16 v[0:3], v[56:59], a[80:83], v[0:3]
    v_mfma_f32_16x16x32_bf16 v[16:19], v[56:59], a[88:91], v[16:19]
    s_waitcnt vmcnt(8)
    L_s2:
    v_min3_u32 v168, v105, v107, v109
    v_max3_u32 v105, v105, v107, v109
    v_min3_u32 v168, v168, v111, s82
    v_max3_u32 v105, v105, v111, s82
    v_cmp_ne_u32 vcc, v168, v105

    s_cbranch_vccnz L_s2r
    v_mfma_f32_16x16x32_bf16 v[32:35], v[56:59], a[96:99], v[32:35]
    v_add_f32 v104, v104, v108
    v_add_f32 v106, v106, v110
    v_mfma_f32_16x16x32_bf16 v[40:43], v[60:63], a[96:99], v[40:43]
    s_waitcnt lgkmcnt(0)
    v_bitop3_b32 v169, v72, v76, v80 bitop3:128
    v_bitop3_b32 v169, v169, v84, 1 bitop3:128
    v_mfma_f32_16x16x32_bf16 v[4:7], v[64:67], a[80:83], v[4:7]
    v_cmp_ne_u32 vcc, 1, v169
    v_permlane32_swap_b32 v104, v106
    v_mfma_f32_16x16x32_bf16 v[20:23], v[64:67], a[88:91], v[20:23]
    v_add_f32 v104, v104, v106
    v_mov_b32 v106, v104
    v_mfma_f32_16x16x32_bf16 v[36:39], v[64:67], a[96:99], v[36:39]
    s_waitcnt vmcnt(0)
    s_barrier
    ds_read_b128 v[88:91], v158 offset:32768
    ds_read_b128 v[92:95], v158 offset:36864
    v_permlane16_swap_b32 v104, v106
    v_add_f32 v104, v104, v106
    v_mfma_f32_16x16x32_bf16 v[44:47], v[68:71], a[96:99], v[44:47]
    ds_read_b128 v[96:99], v158 offset:34816
    ds_read_b128 v[100:103], v158 offset:38912
    v_mov_b32 v106, v104
    s_nop 1
    v_permlane32_swap_b32 v104, v106
    s_cbranch_vccnz L_xc7r
L_xc7:
    v_mfma_f32_16x16x32_bf16 v[0:3], v[72:75], a[84:87], v[0:3]
    ds_read_b128 v[56:59], v158 offset:33792
    ds_read_b128 v[60:63], v158 offset:37888
    v_mul_f32 v104, 0x3acccccd, v104
    v_mov_b32 v166, 0x3727c5ac
    v_mfma_f32_16x16x32_bf16 v[16:19], v[72:75], a[92:95], v[16:19]
    ds_read_b128 v[64:67], v158 offset:35840
    ds_read_b128 v[68:71], v158 offset:39936
    v_fmac_f32 v166, 0x3acccccd, v106
    v_fma_f32 v166, -v104, v104, v166
    v_mfma_f32_16x16x32_bf16 v[32:35], v[72:75], a[100:103], v[32:35]
    ds_read_b128 v[72:75], v158 offset:53248
    v_max_f32 v166, 0x3727c5ac, v166
    v_rsq_f32 v166, v166
    v_mfma_f32_16x16x32_bf16 v[40:43], v[76:79], a[100:103], v[40:43]
    ds_read_b128 v[76:79], v158 offset:54272
    s_waitcnt lgkmcnt(6)
    v_bitop3_b32 v169, v88, v92, v96 bitop3:128
    v_bitop3_b32 v169, v169, v100, 1 bitop3:128
    v_mfma_f32_16x16x32_bf16 v[4:7], v[80:83], a[84:87], v[4:7]
    v_cmp_ne_u32 vcc, 1, v169
    v_mul_f32_e64 v167, -v104, v166
    v_mfma_f32_16x16x32_bf16 v[20:23], v[80:83], a[92:95], v[20:23]
    v_xor_b32 v104, 0x80000000, v104
    v_mfma_f32_16x16x32_bf16 v[36:39], v[80:83], a[100:103], v[36:39]
    ds_read_b128 v[80:83], v158 offset:49152
    v_mfma_f32_16x16x32_bf16 v[44:47], v[84:87], a[100:103], v[44:47]
    ds_read_b128 v[84:87], v158 offset:50176
    s_cbranch_vccnz L_xc8r
L_xc8:
    v_mfma_f32_16x16x32_bf16 v[0:3], v[88:91], a[120:123], v[0:3]
    s_mov_b64 exec, 0xffff
    ds_write2st64_b32 v120, v104, v166 offset1:1
    ds_write2st64_b32 v121, v104, v166 offset1:1
    s_mov_b64 exec, -1
    v_mfma_f32_16x16x32_bf16 v[16:19], v[88:91], a[128:131], v[16:19]
    s_add_u32 s98, s98, 0x40000
    s_addc_u32 s99, s99, 0
    v_mfma_f32_16x16x32_bf16 v[32:35], v[88:91], a[136:139], v[32:35]
    ds_read_b128 v[88:91], v158 offset:55296
    v_mfma_f32_16x16x32_bf16 v[40:43], v[92:95], a[136:139], v[40:43]
    ds_read_b128 v[92:95], v158 offset:56320
    s_waitcnt lgkmcnt(8)
    v_bitop3_b32 v169, v56, v60, v64 bitop3:128
    v_bitop3_b32 v169, v169, v68, 1 bitop3:128
    v_mfma_f32_16x16x32_bf16 v[4:7], v[96:99], a[120:123], v[4:7]
    v_cmp_ne_u32 vcc, 1, v169
    v_mfma_f32_16x16x32_bf16 v[20:23], v[96:99], a[128:131], v[20:23]
    v_mfma_f32_16x16x32_bf16 v[36:39], v[96:99], a[136:139], v[36:39]
    ds_read_b128 v[96:99], v158 offset:51200
    v_mfma_f32_16x16x32_bf16 v[44:47], v[100:103], a[136:139], v[44:47]
    ds_read_b128 v[100:103], v158 offset:52224
    s_cbranch_vccnz L_xc9r
L_xc9:
    v_mfma_f32_16x16x32_bf16 v[0:3], v[56:59], a[124:127], v[0:3]
    v_mfma_f32_16x16x32_bf16 v[16:19], v[56:59], a[132:135], v[16:19]
    v_mfma_f32_16x16x32_bf16 v[32:35], v[56:59], a[140:143], v[32:35]
    ds_read_b128 v[56:59], v159 offset:0
    v_mfma_f32_16x16x32_bf16 v[40:43], v[60:63], a[140:143], v[40:43]
    ds_read_b128 v[60:63], v159 offset:1024
    s_waitcnt lgkmcnt(8)
    v_bitop3_b32 v169, v72, v76, v80 bitop3:128
    v_bitop3_b32 v169, v169, v84, 1 bitop3:128
    v_mfma_f32_16x16x32_bf16 v[4:7], v[64:67], a[124:127], v[4:7]
    v_cmp_ne_u32 vcc, 1, v169
    v_mfma_f32_16x16x32_bf16 v[20:23], v[64:67], a[132:135], v[20:23]
    v_mfma_f32_16x16x32_bf16 v[36:39], v[64:67], a[140:143], v[36:39]
    ds_read_b128 v[64:67], v159 offset:16384
    v_mfma_f32_16x16x32_bf16 v[44:47], v[68:71], a[140:143], v[44:47]
    ds_read_b128 v[68:71], v159 offset:17408
    s_cbranch_vccnz L_xc10r
L_xc10:
    v_mfma_f32_16x16x32_bf16 v[40:43], v[72:75], a[176:179], v[40:43]
    ds_read_b128 v[72:75], v159 offset:32768
    v_mfma_f32_16x16x32_bf16 v[40:43], v[76:79], a[180:183], v[40:43]
    ds_read_b128 v[76:79], v159 offset:33792
    v_mfma_f32_16x16x32_bf16 v[0:3], v[80:83], a[160:163], v[0:3]
    v_mfma_f32_16x16x32_bf16 v[16:19], v[80:83], a[168:171], v[16:19]
    s_waitcnt lgkmcnt(6)
    v_bitop3_b32 v169, v88, v92, v96 bitop3:128
    v_bitop3_b32 v169, v169, v100, 1 bitop3:128
    v_mfma_f32_16x16x32_bf16 v[32:35], v[80:83], a[176:179], v[32:35]
    s_nop 0
    ds_write_b128 v52, v[40:43] offset:2048
    ds_read_b128 v[80:83], v159 offset:49152
    v_cmp_ne_u32 vcc, 1, v169
    v_mfma_f32_16x16x32_bf16 v[0:3], v[84:87], a[164:167], v[0:3]
    v_mfma_f32_16x16x32_bf16 v[16:19], v[84:87], a[172:175], v[16:19]
    v_mfma_f32_16x16x32_bf16 v[32:35], v[84:87], a[180:183], v[32:35]
    ds_read_b128 v[84:87], v159 offset:50176
    s_cbranch_vccnz L_xc11r
L_xc11:
    v_mfma_f32_16x16x32_bf16 v[44:47], v[88:91], a[176:179], v[44:47]
    v_mfma_f32_16x16x32_bf16 v[44:47], v[92:95], a[180:183], v[44:47]
    v_mfma_f32_16x16x32_bf16 v[4:7], v[96:99], a[160:163], v[4:7]
    s_nop 2
    ds_write_b128 v52, v[32:35] offset:0
    v_mfma_f32_16x16x32_bf16 v[20:23], v[96:99], a[168:171], v[20:23]
    s_waitcnt lgkmcnt(6)
    v_bitop3_b32 v169, v56, v60, v64 bitop3:128
    v_bitop3_b32 v169, v169, v68, 1 bitop3:128
    v_cmp_ne_u32 vcc, 1, v169
    v_mfma_f32_16x16x32_bf16 v[36:39], v[96:99], a[176:179], v[36:39]
    v_mfma_f32_16x16x32_bf16 v[4:7], v[100:103], a[164:167], v[4:7]
    ds_write_b128 v52, v[44:47] offset:3072
    v_mfma_f32_16x16x32_bf16 v[20:23], v[100:103], a[172:175], v[20:23]
    v_mfma_f32_16x16x32_bf16 v[36:39], v[100:103], a[180:183], v[36:39]
    s_cbranch_vccnz L_xc12r
L_xc12:
    v_mfma_f32_16x16x32_bf16 v[0:3], v[56:59], a[64:67], v[0:3]
    v_mfma_f32_16x16x32_bf16 v[16:19], v[56:59], a[72:75], v[16:19]
    ds_read_b128 v[56:59], v159 offset:2048
    v_mfma_f32_16x16x32_bf16 v[0:3], v[60:63], a[68:71], v[0:3]
    s_nop 2
    ds_write_b128 v52, v[36:39] offset:1024
    v_mfma_f32_16x16x32_bf16 v[16:19], v[60:63], a[76:79], v[16:19]
    ds_read_b128 v[60:63], v159 offset:3072
    s_waitcnt lgkmcnt(5)
    v_bitop3_b32 v169, v72, v76, v80 bitop3:128
    v_bitop3_b32 v169, v169, v84, 1 bitop3:128
    v_cmp_ne_u32 vcc, 1, v169
    v_mfma_f32_16x16x32_bf16 v[0:3], v[64:67], a[104:107], v[0:3]
    v_mfma_f32_16x16x32_bf16 v[16:19], v[64:67], a[112:115], v[16:19]
    ds_read_b128 v[64:67], v159 offset:18432
    v_mfma_f32_16x16x32_bf16 v[0:3], v[68:71], a[108:111], v[0:3]
    v_mfma_f32_16x16x32_bf16 v[16:19], v[68:71], a[116:119], v[16:19]
    ds_read_b128 v[68:71], v159 offset:19456
    s_cbranch_vccnz L_xc13r
L_xc13:
    v_mfma_f32_16x16x32_bf16 v[0:3], v[72:75], a[144:147], v[0:3]
    v_mfma_f32_16x16x32_bf16 v[16:19], v[72:75], a[152:155], v[16:19]
    ds_read_b128 v[72:75], v159 offset:34816
    v_mfma_f32_16x16x32_bf16 v[0:3], v[76:79], a[148:151], v[0:3]
    v_mfma_f32_16x16x32_bf16 v[16:19], v[76:79], a[156:159], v[16:19]
    ds_read_b128 v[76:79], v159 offset:35840
    s_waitcnt lgkmcnt(2)
    v_bitop3_b32 v169, v56, v60, v64 bitop3:128
    v_bitop3_b32 v169, v169, v68, 1 bitop3:128
    v_cmp_ne_u32 vcc, 1, v169
    s_barrier
    v_mfma_f32_16x16x32_bf16 v[0:3], v[80:83], a[184:187], v[0:3]
    ds_read_b128 v[104:107], v164 offset:0
    v_mfma_f32_16x16x32_bf16 v[16:19], v[80:83], a[192:195], v[16:19]
    ds_read_b128 v[80:83], v159 offset:51200
    ds_read_b128 v[108:111], v164 offset:256
    v_mfma_f32_16x16x32_bf16 v[0:3], v[84:87], a[188:191], v[0:3]
    ds_read_b128 v[112:115], v164 offset:16
    v_mfma_f32_16x16x32_bf16 v[16:19], v[84:87], a[196:199], v[16:19]
    ds_read_b128 v[84:87], v159 offset:52224
    ds_read_b128 v[116:119], v164 offset:272
    s_cbranch_vccnz L_xc14r
L_xc14:
    v_mfma_f32_16x16x32_bf16 v[4:7], v[56:59], a[64:67], v[4:7]
    ds_read2st64_b32 v[32:33], v48 offset0:0 offset1:32
    v_mfma_f32_16x16x32_bf16 v[20:23], v[56:59], a[72:75], v[20:23]
    ds_read_b128 v[56:59], v159 offset:4096
    v_mfma_f32_16x16x32_bf16 v[4:7], v[60:63], a[68:71], v[4:7]
    ds_read2st64_b32 v[34:35], v49 offset0:0 offset1:32
    v_mfma_f32_16x16x32_bf16 v[20:23], v[60:63], a[76:79], v[20:23]
    ds_read_b128 v[60:63], v159 offset:5120
    s_waitcnt lgkmcnt(5)
    v_bitop3_b32 v169, v72, v76, v80 bitop3:128
    v_bitop3_b32 v169, v169, v84, 1 bitop3:128
    v_cmp_ne_u32 vcc, 1, v169
    v_mfma_f32_16x16x32_bf16 v[4:7], v[64:67], a[104:107], v[4:7]
    ds_read2st64_b32 v[36:37], v48 offset0:4 offset1:36
    v_mfma_f32_16x16x32_bf16 v[20:23], v[64:67], a[112:115], v[20:23]
    ds_read_b128 v[64:67], v159 offset:20480
    v_mfma_f32_16x16x32_bf16 v[4:7], v[68:71], a[108:111], v[4:7]
    ds_read2st64_b32 v[38:39], v49 offset0:4 offset1:36
    v_fmac_f32 v0, v104, v160
    v_mfma_f32_16x16x32_bf16 v[20:23], v[68:71], a[116:119], v[20:23]
    ds_read_b128 v[68:71], v159 offset:21504
    s_cbranch_vccnz L_xc15r
L_xc15:
    v_mfma_f32_16x16x32_bf16 v[4:7], v[72:75], a[144:147], v[4:7]
    ds_read2st64_b32 v[40:41], v48 offset0:8 offset1:40
    v_fmac_f32 v1, v105, v160
    v_mfma_f32_16x16x32_bf16 v[20:23], v[72:75], a[152:155], v[20:23]
    ds_read_b128 v[72:75], v159 offset:36864
    v_fmac_f32 v16, v104, v161
    v_mfma_f32_16x16x32_bf16 v[4:7], v[76:79], a[148:151], v[4:7]
    ds_read2st64_b32 v[42:43], v49 offset0:8 offset1:40
    v_fmac_f32 v17, v105, v161
    v_mfma_f32_16x16x32_bf16 v[20:23], v[76:79], a[156:159], v[20:23]
    ds_read_b128 v[76:79], v159 offset:37888
    v_mul_f32 v0, v108, v0
    v_mfma_f32_16x16x32_bf16 v[4:7], v[80:83], a[184:187], v[4:7]
    ds_read2st64_b32 v[44:45], v48 offset0:12 offset1:44
    v_mul_f32 v1, v109, v1
    v_mfma_f32_16x16x32_bf16 v[20:23], v[80:83], a[192:195], v[20:23]
    ds_read_b128 v[80:83], v159 offset:53248
    v_mul_f32 v16, v108, v16
    v_mfma_f32_16x16x32_bf16 v[4:7], v[84:87], a[188:191], v[4:7]
    ds_read2st64_b32 v[46:47], v49 offset0:12 offset1:44
    v_mul_f32 v17, v109, v17
    v_mfma_f32_16x16x32_bf16 v[20:23], v[84:87], a[196:199], v[20:23]
    ds_read_b128 v[84:87], v159 offset:54272
    ds_read_b128 v[88:91], v50 offset:768
    s_waitcnt lgkmcnt(13)
    v_mfma_f32_16x16x32_bf16 v[8:11], v[56:59], a[64:67], v[8:11]
    ds_read_b128 v[92:95], v50 offset:784
    v_fmac_f32 v2, v106, v160
    v_mfma_f32_16x16x32_bf16 v[24:27], v[56:59], a[72:75], v[24:27]
    ds_read_b128 v[56:59], v158 offset:4096
    ds_read_b128 v[52:55], v50 offset:528
    v_mfma_f32_16x16x32_bf16 v[8:11], v[60:63], a[68:71], v[8:11]
    ds_read_b128 v[48:51], v50 offset:512
    v_fmac_f32 v3, v107, v160
    v_mfma_f32_16x16x32_bf16 v[24:27], v[60:63], a[76:79], v[24:27]
    ds_read_b128 v[60:63], v158 offset:5120
    ds_read_b64 v[96:97], v165 offset:8320
    s_waitcnt lgkmcnt(15)
    v_mfma_f32_16x16x32_bf16 v[8:11], v[64:67], a[104:107], v[8:11]
    ds_read_b64 v[98:99], v165 offset:8960
    v_fmac_f32 v18, v106, v161
    v_mfma_f32_16x16x32_bf16 v[24:27], v[64:67], a[112:115], v[24:27]
    ds_read_b128 v[64:67], v158 offset:20480
    ds_read_b64 v[100:101], v171 offset:8320
    v_mfma_f32_16x16x32_bf16 v[8:11], v[68:71], a[108:111], v[8:11]
    ds_read_b64 v[102:103], v171 offset:8960
    v_fmac_f32 v19, v107, v161
    v_mfma_f32_16x16x32_bf16 v[24:27], v[68:71], a[116:119], v[24:27]
    ds_read_b128 v[68:71], v158 offset:21504
    s_waitcnt lgkmcnt(15)
    v_mfma_f32_16x16x32_bf16 v[8:11], v[72:75], a[144:147], v[8:11]
    v_mul_f32 v2, v110, v2
    v_mul_f32 v3, v111, v3
    v_mfma_f32_16x16x32_bf16 v[24:27], v[72:75], a[152:155], v[24:27]
    ds_read_b128 v[72:75], v158 offset:36864
    v_mul_f32 v18, v110, v18
    v_mfma_f32_16x16x32_bf16 v[8:11], v[76:79], a[148:151], v[8:11]
    s_waitcnt lgkmcnt(14)
    v_add_f32 v32, v32, v33
    v_mfma_f32_16x16x32_bf16 v[24:27], v[76:79], a[156:159], v[24:27]
    ds_read_b128 v[76:79], v158 offset:37888
    s_waitcnt lgkmcnt(14)
    v_mfma_f32_16x16x32_bf16 v[8:11], v[80:83], a[184:187], v[8:11]
    v_add_f32 v34, v34, v35
    v_add_f32 v36, v36, v37
    v_mfma_f32_16x16x32_bf16 v[24:27], v[80:83], a[192:195], v[24:27]
    ds_read_b128 v[80:83], v158 offset:53248
    v_add_f32 v38, v38, v39
    v_mfma_f32_16x16x32_bf16 v[8:11], v[84:87], a[188:191], v[8:11]
    v_add_f32 v40, v40, v41
    v_add_f32 v42, v42, v43
    v_mfma_f32_16x16x32_bf16 v[24:27], v[84:87], a[196:199], v[24:27]
    ds_read_b128 v[84:87], v158 offset:54272
    s_waitcnt lgkmcnt(10)
    v_mfma_f32_16x16x32_bf16 v[8:11], v[56:59], a[40:43], v[8:11]
    v_add_f32 v44, v44, v45
    v_add_f32 v46, v46, v47
    v_mfma_f32_16x16x32_bf16 v[24:27], v[56:59], a[48:51], v[24:27]
    ds_read_b128 v[56:59], v159 offset:6144
    v_mfma_f32_16x16x32_bf16 v[8:11], v[60:63], a[44:47], v[8:11]
    v_fma_f32 v48, v48, v162, v32
    v_fma_f32 v49, v49, v162, v34
    v_mfma_f32_16x16x32_bf16 v[24:27], v[60:63], a[52:55], v[24:27]
    ds_read_b128 v[60:63], v159 offset:7168
    s_waitcnt lgkmcnt(6)
    v_mfma_f32_16x16x32_bf16 v[8:11], v[64:67], a[80:83], v[8:11]
    v_fma_f32 v50, v50, v162, v36
    v_fma_f32 v51, v51, v162, v38
    v_mfma_f32_16x16x32_bf16 v[24:27], v[64:67], a[88:91], v[24:27]
    ds_read_b128 v[64:67], v159 offset:22528
    v_fma_f32 v52, v52, v162, v40
    v_mfma_f32_16x16x32_bf16 v[8:11], v[68:71], a[84:87], v[8:11]
    v_fma_f32 v53, v53, v162, v42
    v_fma_f32 v54, v54, v162, v44
    v_mfma_f32_16x16x32_bf16 v[24:27], v[68:71], a[92:95], v[24:27]
    ds_read_b128 v[68:71], v159 offset:23552
    s_waitcnt lgkmcnt(6)
    v_mfma_f32_16x16x32_bf16 v[8:11], v[72:75], a[120:123], v[8:11]
    v_fma_f32 v55, v55, v162, v46
    v_mul_f32 v48, v88, v48
    v_mfma_f32_16x16x32_bf16 v[24:27], v[72:75], a[128:131], v[24:27]
    ds_read_b128 v[72:75], v159 offset:38912
    v_mul_f32 v49, v89, v49
    v_mfma_f32_16x16x32_bf16 v[8:11], v[76:79], a[124:127], v[8:11]
    v_mul_f32 v50, v90, v50
    v_mul_f32 v51, v91, v51
    v_mfma_f32_16x16x32_bf16 v[24:27], v[76:79], a[132:135], v[24:27]
    ds_read_b128 v[76:79], v159 offset:39936
    s_waitcnt lgkmcnt(6)
    v_mfma_f32_16x16x32_bf16 v[8:11], v[80:83], a[160:163], v[8:11]
    v_mul_f32 v52, v92, v52
    v_mul_f32 v53, v93, v53
    v_mfma_f32_16x16x32_bf16 v[24:27], v[80:83], a[168:171], v[24:27]
    ds_read_b128 v[80:83], v159 offset:55296
    v_mul_f32 v54, v94, v54
    v_mfma_f32_16x16x32_bf16 v[8:11], v[84:87], a[164:167], v[8:11]
    v_mul_f32 v55, v95, v55
    v_mul_f32 v19, v111, v19
    v_mfma_f32_16x16x32_bf16 v[24:27], v[84:87], a[172:175], v[24:27]
    ds_read_b128 v[84:87], v159 offset:56320
    s_waitcnt lgkmcnt(6)
    v_mfma_f32_16x16x32_bf16 v[12:15], v[56:59], a[64:67], v[12:15]
    v_xor_b32 v101, v170, v101
    v_mfma_f32_16x16x32_bf16 v[28:31], v[56:59], a[72:75], v[28:31]
    ds_read_b128 v[56:59], v158 offset:6144
    v_xor_b32 v103, v170, v103
    v_mfma_f32_16x16x32_bf16 v[12:15], v[60:63], a[68:71], v[12:15]
    v_fma_f32 v173, v130, v48, v49
    s_nop 1
    v_fmac_f32_dpp v173, v48, v131 row_ror:8 row_mask:0xf bank_mask:0xf
    v_mfma_f32_16x16x32_bf16 v[28:31], v[60:63], a[76:79], v[28:31]
    ds_read_b128 v[60:63], v158 offset:7168
    s_waitcnt lgkmcnt(6)
    v_mfma_f32_16x16x32_bf16 v[12:15], v[64:67], a[104:107], v[12:15]
    v_fma_f32 v172, v130, v173, v50
    s_nop 1
    v_fmac_f32_dpp v172, v173, v131 row_ror:8 row_mask:0xf bank_mask:0xf
    v_mfma_f32_16x16x32_bf16 v[28:31], v[64:67], a[112:115], v[28:31]
    ds_read_b128 v[64:67], v158 offset:22528
    v_fma_f32 v173, v130, v172, v51
    v_mfma_f32_16x16x32_bf16 v[12:15], v[68:71], a[108:111], v[12:15]
    s_nop 0
    v_fmac_f32_dpp v173, v172, v131 row_ror:8 row_mask:0xf bank_mask:0xf
    v_fma_f32 v172, v130, v173, v52
    v_mfma_f32_16x16x32_bf16 v[28:31], v[68:71], a[116:119], v[28:31]
    ds_read_b128 v[68:71], v158 offset:23552
    s_waitcnt lgkmcnt(6)
    v_mfma_f32_16x16x32_bf16 v[12:15], v[72:75], a[144:147], v[12:15]
    v_fmac_f32_dpp v172, v173, v131 row_ror:8 row_mask:0xf bank_mask:0xf
    v_fma_f32 v173, v130, v172, v53
    v_mfma_f32_16x16x32_bf16 v[28:31], v[72:75], a[152:155], v[28:31]
    ds_read_b128 v[72:75], v158 offset:38912
    v_fmac_f32_dpp v173, v172, v131 row_ror:8 row_mask:0xf bank_mask:0xf
    v_mfma_f32_16x16x32_bf16 v[12:15], v[76:79], a[148:151], v[12:15]
    v_fma_f32 v172, v130, v173, v54
    s_nop 1
    v_fmac_f32_dpp v172, v173, v131 row_ror:8 row_mask:0xf bank_mask:0xf
    v_mfma_f32_16x16x32_bf16 v[28:31], v[76:79], a[156:159], v[28:31]
    ds_read_b128 v[76:79], v158 offset:39936
    s_waitcnt lgkmcnt(6)
    v_mfma_f32_16x16x32_bf16 v[12:15], v[80:83], a[184:187], v[12:15]
    v_fma_f32 v173, v130, v172, v55
    s_nop 1
    v_fmac_f32_dpp v173, v172, v131 row_ror:8 row_mask:0xf bank_mask:0xf
    v_mfma_f32_16x16x32_bf16 v[28:31], v[80:83], a[192:195], v[28:31]
    ds_read_b128 v[80:83], v158 offset:55296
    ds_read_b128 v[104:107], v164 offset:32
    v_mfma_f32_16x16x32_bf16 v[12:15], v[84:87], a[188:191], v[12:15]
    ds_read_b128 v[108:111], v164 offset:288
    v_mfma_f32_16x16x32_bf16 v[28:31], v[84:87], a[196:199], v[28:31]
    ds_read_b128 v[84:87], v158 offset:56320
    s_waitcnt lgkmcnt(8)
    v_mfma_f32_16x16x32_bf16 v[12:15], v[56:59], a[40:43], v[12:15]
    v_fma_f32 v124, v0, v128, v2
    v_fma_f32 v125, v1, v128, v3
    v_mfma_f32_16x16x32_bf16 v[28:31], v[56:59], a[48:51], v[28:31]
    v_fma_f32 v126, v16, v128, v18
    v_fma_f32 v127, v17, v128, v19
    v_mfma_f32_16x16x32_bf16 v[12:15], v[60:63], a[44:47], v[12:15]
    v_fma_f32 v124, -v16, v129, v124
    v_fma_f32 v125, -v17, v129, v125
    v_mfma_f32_16x16x32_bf16 v[28:31], v[60:63], a[52:55], v[28:31]
    v_fmac_f32 v126, v0, v129
    s_waitcnt lgkmcnt(6)
    v_mfma_f32_16x16x32_bf16 v[12:15], v[64:67], a[80:83], v[12:15]
    v_fmac_f32 v127, v1, v129
    v_mfma_f32_16x16x32_bf16 v[28:31], v[64:67], a[88:91], v[28:31]
    v_fmac_f32 v4, v112, v160
    v_mfma_f32_16x16x32_bf16 v[12:15], v[68:71], a[84:87], v[12:15]
    v_fmac_f32 v5, v113, v160
    v_fmac_f32 v20, v112, v161
    v_mfma_f32_16x16x32_bf16 v[28:31], v[68:71], a[92:95], v[28:31]
    v_fmac_f32 v21, v113, v161
    s_waitcnt lgkmcnt(4)
    v_mfma_f32_16x16x32_bf16 v[12:15], v[72:75], a[120:123], v[12:15]
    v_mul_f32 v4, v116, v4
    v_mul_f32 v5, v117, v5
    v_mfma_f32_16x16x32_bf16 v[28:31], v[72:75], a[128:131], v[28:31]
    v_mul_f32 v20, v116, v20
    v_mul_f32 v21, v117, v21
    v_mfma_f32_16x16x32_bf16 v[12:15], v[76:79], a[124:127], v[12:15]
    v_fmac_f32 v6, v114, v160
    v_fmac_f32 v7, v115, v160
    v_mfma_f32_16x16x32_bf16 v[28:31], v[76:79], a[132:135], v[28:31]
    v_fmac_f32 v22, v114, v161
    s_waitcnt lgkmcnt(0)
    v_mfma_f32_16x16x32_bf16 v[12:15], v[80:83], a[160:163], v[12:15]
    v_fmac_f32 v23, v115, v161
    v_mul_f32 v6, v118, v6
    v_mfma_f32_16x16x32_bf16 v[28:31], v[80:83], a[168:171], v[28:31]
    v_mul_f32 v7, v119, v7
    v_mul_f32 v22, v118, v22
    v_mfma_f32_16x16x32_bf16 v[12:15], v[84:87], a[164:167], v[12:15]
    v_mul_f32 v23, v119, v23
    v_mfma_f32_16x16x32_bf16 v[28:31], v[84:87], a[172:175], v[28:31]
    ds_read_b128 v[112:115], v164 offset:48
    ds_read_b128 v[116:119], v164 offset:304
    v_pk_fma_f32 v[120:121], v[124:125], v[128:129], v[4:5] op_sel_hi:[1,0,1]
    v_pk_fma_f32 v[122:123], v[126:127], v[128:129], v[20:21] op_sel_hi:[1,0,1]
    v_pk_fma_f32 v[120:121], v[126:127], v[128:129], v[120:121] op_sel:[0,1,0] neg_lo:[1,0,0] neg_hi:[1,0,0]
    v_pk_fma_f32 v[122:123], v[124:125], v[128:129], v[122:123] op_sel:[0,1,0]
    v_pk_fma_f32 v[124:125], v[120:121], v[128:129], v[6:7] op_sel_hi:[1,0,1]
    v_pk_fma_f32 v[126:127], v[122:123], v[128:129], v[22:23] op_sel_hi:[1,0,1]
    v_pk_fma_f32 v[124:125], v[122:123], v[128:129], v[124:125] op_sel:[0,1,0] neg_lo:[1,0,0] neg_hi:[1,0,0]
    v_pk_fma_f32 v[126:127], v[120:121], v[128:129], v[126:127] op_sel:[0,1,0]
    v_pk_fma_f32 v[8:9], v[104:105], v[160:161], v[8:9] op_sel_hi:[1,0,1]
    v_pk_fma_f32 v[24:25], v[104:105], v[160:161], v[24:25] op_sel:[0,1,0]
    v_pk_fma_f32 v[10:11], v[106:107], v[160:161], v[10:11] op_sel_hi:[1,0,1]
    v_pk_fma_f32 v[26:27], v[106:107], v[160:161], v[26:27] op_sel:[0,1,0]
    v_pk_mul_f32 v[8:9], v[108:109], v[8:9]
    v_pk_mul_f32 v[24:25], v[108:109], v[24:25]
    v_pk_mul_f32 v[10:11], v[110:111], v[10:11]
    v_pk_mul_f32 v[26:27], v[110:111], v[26:27]
    v_pk_fma_f32 v[120:121], v[124:125], v[128:129], v[8:9] op_sel_hi:[1,0,1]
    v_pk_fma_f32 v[122:123], v[126:127], v[128:129], v[24:25] op_sel_hi:[1,0,1]
    v_pk_fma_f32 v[120:121], v[126:127], v[128:129], v[120:121] op_sel:[0,1,0] neg_lo:[1,0,0] neg_hi:[1,0,0]
    v_pk_fma_f32 v[122:123], v[124:125], v[128:129], v[122:123] op_sel:[0,1,0]
    v_pk_fma_f32 v[124:125], v[120:121], v[128:129], v[10:11] op_sel_hi:[1,0,1]
    v_pk_fma_f32 v[126:127], v[122:123], v[128:129], v[26:27] op_sel_hi:[1,0,1]
    v_pk_fma_f32 v[124:125], v[122:123], v[128:129], v[124:125] op_sel:[0,1,0] neg_lo:[1,0,0] neg_hi:[1,0,0]
    v_pk_fma_f32 v[126:127], v[120:121], v[128:129], v[126:127] op_sel:[0,1,0]
    s_waitcnt lgkmcnt(0)
    v_pk_fma_f32 v[12:13], v[112:113], v[160:161], v[12:13] op_sel_hi:[1,0,1]
    v_pk_fma_f32 v[28:29], v[112:113], v[160:161], v[28:29] op_sel:[0,1,0]
    v_pk_fma_f32 v[14:15], v[114:115], v[160:161], v[14:15] op_sel_hi:[1,0,1]
    v_pk_fma_f32 v[30:31], v[114:115], v[160:161], v[30:31] op_sel:[0,1,0]
    v_pk_mul_f32 v[12:13], v[116:117], v[12:13]
    v_pk_mul_f32 v[28:29], v[116:117], v[28:29]
    v_pk_mul_f32 v[14:15], v[118:119], v[14:15]
    v_pk_mul_f32 v[30:31], v[118:119], v[30:31]
    v_pk_fma_f32 v[120:121], v[124:125], v[128:129], v[12:13] op_sel_hi:[1,0,1]
    v_pk_fma_f32 v[122:123], v[126:127], v[128:129], v[28:29] op_sel_hi:[1,0,1]
    v_pk_fma_f32 v[120:121], v[126:127], v[128:129], v[120:121] op_sel:[0,1,0] neg_lo:[1,0,0] neg_hi:[1,0,0]
    v_pk_fma_f32 v[122:123], v[124:125], v[128:129], v[122:123] op_sel:[0,1,0]
    v_pk_fma_f32 v[124:125], v[120:121], v[128:129], v[14:15] op_sel_hi:[1,0,1]
    v_pk_fma_f32 v[126:127], v[122:123], v[128:129], v[30:31] op_sel_hi:[1,0,1]
    v_pk_fma_f32 v[124:125], v[122:123], v[128:129], v[124:125] op_sel:[0,1,0] neg_lo:[1,0,0] neg_hi:[1,0,0]
    v_pk_fma_f32 v[126:127], v[120:121], v[128:129], v[126:127] op_sel:[0,1,0]
    v_mul_f32 v59, v100, v173
    v_fma_f32 v56, v96, v124, v125
    v_fma_f32 v57, v96, v126, v127
    v_fmac_f32_dpp v59, v173, v101 row_ror:8 row_mask:0xf bank_mask:0xf
    v_mov_b32_dpp v58, v173 quad_perm:[1,1,3,3] row_mask:0xf bank_mask:0xf
    v_fma_f32 v56, -v97, v126, v56
    v_fmac_f32 v57, v97, v124
    v_add_f32_dpp v58, v59, v58 quad_perm:[0,0,2,2] row_mask:0xf bank_mask:0xf
    v_mov_b64 v[64:65], v[56:57]
    v_mov_b32 v66, v58
    v_mov_b32 v71, s82
    v_permlane32_swap_b32 v56, v64
    v_permlane32_swap_b32 v57, v65
    v_permlane32_swap_b32 v58, v66
    v_mov_b64 v[60:61], v[56:57]
    v_mov_b32 v62, v58
    v_mov_b64 v[68:69], v[64:65]
    v_mov_b32 v70, v66

    v_permlane16_swap_b32 v58, v62
    v_permlane16_swap_b32 v56, v60
    v_permlane16_swap_b32 v57, v61
    v_permlane16_swap_b32 v66, v70
    v_fmac_f32_dpp v62, v58, v103 row_ror:8 row_mask:0xf bank_mask:0xf
    v_pk_fma_f32 v[60:61], v[56:57], v[98:99], v[60:61] op_sel_hi:[1,0,1]
    v_permlane16_swap_b32 v64, v68
    v_fmac_f32 v62, v102, v58
    v_pk_fma_f32 v[60:61], v[56:57], v[98:99], v[60:61] op_sel:[1,1,0] op_sel_hi:[0,1,1] neg_lo:[1,0,0]
    v_permlane16_swap_b32 v65, v69
    v_fmac_f32_dpp v66, v62, v103 row_ror:8 row_mask:0xf bank_mask:0xf
    v_fmac_f32 v66, v102, v62
    v_pk_fma_f32 v[64:65], v[60:61], v[98:99], v[64:65] op_sel_hi:[1,0,1]
    v_pk_fma_f32 v[64:65], v[60:61], v[98:99], v[64:65] op_sel:[1,1,0] op_sel_hi:[0,1,1] neg_lo:[1,0,0]
    v_fmac_f32_dpp v70, v66, v103 row_ror:8 row_mask:0xf bank_mask:0xf
    v_fmac_f32 v70, v102, v66
    v_pk_fma_f32 v[68:69], v[64:65], v[98:99], v[68:69] op_sel_hi:[1,0,1]
    v_pk_fma_f32 v[68:69], v[64:65], v[98:99], v[68:69] op_sel:[1,1,0] op_sel_hi:[0,1,1] neg_lo:[1,0,0]
    s_mov_b64 exec, 0xffff
    buffer_store_dwordx4 v[68:71], v153, s[92:95], s21 offen sc1
    s_mov_b64 exec, -1
    v_and_b32 v110, 1, v152
    v_mul_u32_u24 v110, 640, v110
    v_add_u32 v110, v171, v110
    ds_read2_b32 v[72:73], v165 offset1:160
    ds_read2_b32 v[74:75], v165 offset0:1 offset1:161
    ds_read_b64 v[76:77], v171 offset:0
    ds_read_b64 v[78:79], v110 offset:0
    v_lshrrev_b32 v109, 4, v152
    s_mov_b32 s4, 93696
    v_lshl_add_u32 v108, v109, 5, s4
    v_lshl_add_u32 v109, v109, 4, s4
    ds_read_b128 v[88:91], v108 offset:0
    ds_read_b128 v[92:95], v108 offset:16
    ds_read_b128 v[96:99], v108 offset:128
    ds_read_b128 v[100:103], v108 offset:144
    ds_read_b128 v[104:107], v109 offset:256
    s_lshl_b32 s8, s79, 13
    s_add_u32 s8, s8, 11272192
    s_and_b32 s4, s91, 31
    s_lshl_b32 s4, s4, 2
    s_add_u32 s4, s4, s8
    v_mov_b32 v110, s4
    s_not_b32 s13, s82
    v_mov_b32 v111, s13
    v_and_b32 v87, 31, v152
    v_lshl_add_u32 v87, v87, 2, s8
    s_cmp_eq_u32 s88, 0
    s_cbranch_scc1 Lss_9
    global_store_dword v110, v111, s[50:51]
Lsd_10:
    s_movk_i32 s9, 0x70
    v_lshrrev_b32 v164, 3, v152
    v_lshlrev_b32 v164, 12, v164
    v_and_or_b32 v164, v153, s9, v164
    s_mul_i32 s6, s78, 327680
    s_lshl_b32 s5, s79, 7
    s_add_u32 s6, s6, s5
    s_lshl_b32 s5, s77, 14
    s_add_u32 s7, s6, s5
    s_add_u32 s7, s7, 262144
    s_lshl_b32 s5, s77, 16
    s_add_u32 s6, s6, s5
    s_mov_b32 s5, 3145728
    s_add_u32 s6, s6, s5
    s_add_u32 s7, s7, s5
    s_lshl_b32 s5, s77, 9
    s_barrier
    s_add_u32 m0, s100, 61440
    s_nop 0
    buffer_load_dwordx4 v164, s[68:71], s6 offen sc1 lds
    s_add_u32 m0, s100, 62464
    s_add_u32 s83, s6, 32768
    buffer_load_dwordx4 v164, s[68:71], s83 offen sc1 lds
    s_add_u32 m0, s5, 69632
    s_mov_b32 exec_hi, 0
    buffer_load_dwordx4 v164, s[68:71], s7 offen sc1 lds
    s_mov_b32 exec_hi, -1
    v_mov_b32 v59, 0
    s_waitcnt lgkmcnt(5)
    v_xor_b32 v76, v170, v76
    v_xor_b32 v78, v170, v78
    v_mov_b32_dpp v56, v60 quad_perm:[0,1,2,3] row_mask:4 bank_mask:0xf
    v_mov_b32_dpp v57, v61 quad_perm:[0,1,2,3] row_mask:4 bank_mask:0xf
    v_mov_b32_dpp v58, v62 quad_perm:[0,1,2,3] row_mask:4 bank_mask:0xf
    v_mov_b32_dpp v56, v64 quad_perm:[0,1,2,3] row_mask:8 bank_mask:0xf
    v_mov_b32_dpp v57, v65 quad_perm:[0,1,2,3] row_mask:8 bank_mask:0xf
    v_mov_b32_dpp v58, v66 quad_perm:[0,1,2,3] row_mask:8 bank_mask:0xf
    v_mov_b32_dpp v56, v59 quad_perm:[0,1,2,3] row_mask:1 bank_mask:0xf
    v_mov_b32_dpp v57, v59 quad_perm:[0,1,2,3] row_mask:1 bank_mask:0xf
    v_mov_b32_dpp v58, v59 quad_perm:[0,1,2,3] row_mask:1 bank_mask:0xf
    v_mul_f32_dpp v63, -v173, v77 row_ror:8 row_mask:0xf bank_mask:0xf
    v_fma_f32 v63, -v76, v173, v63
    v_mul_f32_dpp v84, -v58, v79 row_ror:8 row_mask:0xf bank_mask:0xf
    v_pk_mul_f32 v[80:81], v[72:73], v[56:57] op_sel_hi:[1,0]
    v_pk_mul_f32 v[82:83], v[72:73], v[56:57] op_sel:[0,1]
    v_pk_fma_f32 v[80:81], v[74:75], v[56:57], v[80:81] op_sel:[0,1,0] neg_lo:[1,0,0] neg_hi:[1,0,0]
    v_pk_fma_f32 v[82:83], v[74:75], v[56:57], v[82:83] op_sel_hi:[1,0,1]
    v_fma_f32 v84, -v78, v58, v84
    v_fmac_f32 v81, v72, v124
    v_fmac_f32 v83, v72, v126
    v_fma_f32 v81, -v74, v126, v81
    v_fmac_f32 v83, v74, v124
    v_mov_b32_dpp v59, v63 quad_perm:[0,0,2,2] row_mask:0xf bank_mask:0xf
    s_mov_b32 exec_lo, 0xaaaaaaaa
    s_mov_b32 exec_hi, 0xaaaaaaaa
    v_add_f32 v84, v84, v59
    s_mov_b64 exec, -1
    s_waitcnt lgkmcnt(0)
    v_pk_fma_f32 v[112:113], v[132:133], v[166:167], v[166:167] op_sel:[0,0,1] op_sel_hi:[1,0,1]
    v_pk_fma_f32 v[114:115], v[134:135], v[166:167], v[166:167] op_sel:[0,0,1] op_sel_hi:[1,0,1]
    v_pk_fma_f32 v[132:133], v[112:113], v[88:89], v[132:133]
    v_pk_fma_f32 v[134:135], v[114:115], v[90:91], v[134:135]
    v_pk_fma_f32 v[112:113], v[136:137], v[166:167], v[166:167] op_sel:[0,0,1] op_sel_hi:[1,0,1]
    v_pk_fma_f32 v[114:115], v[138:139], v[166:167], v[166:167] op_sel:[0,0,1] op_sel_hi:[1,0,1]
    v_pk_fma_f32 v[136:137], v[112:113], v[92:93], v[136:137]
    v_pk_fma_f32 v[138:139], v[114:115], v[94:95], v[138:139]
    v_pk_fma_f32 v[112:113], v[140:141], v[166:167], v[166:167] op_sel:[0,0,1] op_sel_hi:[1,0,1]
    v_pk_fma_f32 v[114:115], v[142:143], v[166:167], v[166:167] op_sel:[0,0,1] op_sel_hi:[1,0,1]
    v_pk_fma_f32 v[140:141], v[112:113], v[96:97], v[140:141]
    v_pk_fma_f32 v[142:143], v[114:115], v[98:99], v[142:143]
    v_pk_fma_f32 v[112:113], v[144:145], v[166:167], v[166:167] op_sel:[0,0,1] op_sel_hi:[1,0,1]
    v_pk_fma_f32 v[114:115], v[146:147], v[166:167], v[166:167] op_sel:[0,0,1] op_sel_hi:[1,0,1]
    v_pk_fma_f32 v[144:145], v[112:113], v[100:101], v[144:145]
    v_pk_fma_f32 v[146:147], v[114:115], v[102:103], v[146:147]
    v_pk_fma_f32 v[112:113], v[148:149], v[166:167], v[166:167] op_sel:[0,0,1] op_sel_hi:[1,0,1]
    v_pk_fma_f32 v[114:115], v[150:151], v[166:167], v[166:167] op_sel:[0,0,1] op_sel_hi:[1,0,1]
    v_pk_fma_f32 v[148:149], v[112:113], v[104:105], v[148:149]
    v_pk_fma_f32 v[150:151], v[114:115], v[106:107], v[150:151]
    v_lshrrev_b32 v120, 4, v152
    v_and_b32 v85, 0xf0, v153
    v_lshl_add_u32 v85, v120, 11, v85
    v_add_u32 v85, s21, v85
    v_lshlrev_b32 v120, 3, v120
    v_sub_u32 v120, s79, v120
    v_med3_i32 v120, v120, 0, 8
    v_mul_lo_u32 v86, v120, s82
    v_lshrrev_b32 v120, 4, v152
    v_mul_u32_u24 v120, 640, v120
    v_add_u32 v121, v165, v120
    v_add_u32 v122, v171, v120
    ds_read_b64 v[32:33], v165 offset:9600
    ds_read_b64 v[34:35], v171 offset:9600
    ds_read_b64 v[36:37], v121 offset:5120
    ds_read_b64 v[38:39], v122 offset:5120
    v_add_u32 v121, v121, v120
    v_add_u32 v122, v122, v120
    v_and_b32 v120, 1, v152
    v_mul_u32_u24 v120, 640, v120
    v_add_u32 v122, v122, v120
    ds_read2_b32 v[40:41], v121 offset1:160
    ds_read2_b32 v[42:43], v121 offset0:1 offset1:161
    ds_read_b64 v[44:45], v122 offset:0
    v_mul_f32_dpp v126, -v48, v77 row_ror:8 row_mask:0xf bank_mask:0xf
    v_pk_mul_f32 v[124:125], v[0:1], v[74:75] op_sel_hi:[1,0]
    v_pk_mul_f32 v[0:1], v[0:1], v[72:73] op_sel_hi:[1,0]
    v_pk_fma_f32 v[0:1], v[16:17], v[74:75], v[0:1] op_sel_hi:[1,0,1] neg_lo:[1,0,0] neg_hi:[1,0,0]
    v_pk_fma_f32 v[16:17], v[16:17], v[72:73], v[124:125] op_sel_hi:[1,0,1]
    v_fma_f32 v48, -v76, v48, v126
    v_mul_f32_dpp v126, -v49, v77 row_ror:8 row_mask:0xf bank_mask:0xf
    v_pk_mul_f32 v[124:125], v[2:3], v[74:75] op_sel_hi:[1,0]
    v_pk_mul_f32 v[2:3], v[2:3], v[72:73] op_sel_hi:[1,0]
    v_pk_fma_f32 v[2:3], v[18:19], v[74:75], v[2:3] op_sel_hi:[1,0,1] neg_lo:[1,0,0] neg_hi:[1,0,0]
    v_pk_fma_f32 v[18:19], v[18:19], v[72:73], v[124:125] op_sel_hi:[1,0,1]
    v_fma_f32 v49, -v76, v49, v126
    v_mul_f32_dpp v126, -v50, v77 row_ror:8 row_mask:0xf bank_mask:0xf
    v_pk_mul_f32 v[124:125], v[4:5], v[74:75] op_sel_hi:[1,0]
    v_pk_mul_f32 v[4:5], v[4:5], v[72:73] op_sel_hi:[1,0]
    v_pk_fma_f32 v[4:5], v[20:21], v[74:75], v[4:5] op_sel_hi:[1,0,1] neg_lo:[1,0,0] neg_hi:[1,0,0]
    v_pk_fma_f32 v[20:21], v[20:21], v[72:73], v[124:125] op_sel_hi:[1,0,1]
    v_fma_f32 v50, -v76, v50, v126
    v_mul_f32_dpp v126, -v51, v77 row_ror:8 row_mask:0xf bank_mask:0xf
    v_pk_mul_f32 v[124:125], v[6:7], v[74:75] op_sel_hi:[1,0]
    v_pk_mul_f32 v[6:7], v[6:7], v[72:73] op_sel_hi:[1,0]
    v_pk_fma_f32 v[6:7], v[22:23], v[74:75], v[6:7] op_sel_hi:[1,0,1] neg_lo:[1,0,0] neg_hi:[1,0,0]
    v_pk_fma_f32 v[22:23], v[22:23], v[72:73], v[124:125] op_sel_hi:[1,0,1]
    v_fma_f32 v51, -v76, v51, v126
    v_mul_f32_dpp v126, -v52, v77 row_ror:8 row_mask:0xf bank_mask:0xf
    v_pk_mul_f32 v[124:125], v[8:9], v[74:75] op_sel_hi:[1,0]
    v_pk_mul_f32 v[8:9], v[8:9], v[72:73] op_sel_hi:[1,0]
    v_pk_fma_f32 v[8:9], v[24:25], v[74:75], v[8:9] op_sel_hi:[1,0,1] neg_lo:[1,0,0] neg_hi:[1,0,0]
    v_pk_fma_f32 v[24:25], v[24:25], v[72:73], v[124:125] op_sel_hi:[1,0,1]
    v_fma_f32 v52, -v76, v52, v126
    v_mul_f32_dpp v126, -v53, v77 row_ror:8 row_mask:0xf bank_mask:0xf
    v_pk_mul_f32 v[124:125], v[10:11], v[74:75] op_sel_hi:[1,0]
    v_pk_mul_f32 v[10:11], v[10:11], v[72:73] op_sel_hi:[1,0]
    v_pk_fma_f32 v[10:11], v[26:27], v[74:75], v[10:11] op_sel_hi:[1,0,1] neg_lo:[1,0,0] neg_hi:[1,0,0]
    v_pk_fma_f32 v[26:27], v[26:27], v[72:73], v[124:125] op_sel_hi:[1,0,1]
    v_fma_f32 v53, -v76, v53, v126
    buffer_load_dwordx4 v[116:119], v85, s[92:95], 0 offen offset:2048 sc1
    v_mul_f32_dpp v126, -v54, v77 row_ror:8 row_mask:0xf bank_mask:0xf
    v_pk_mul_f32 v[124:125], v[12:13], v[74:75] op_sel_hi:[1,0]
    v_pk_mul_f32 v[12:13], v[12:13], v[72:73] op_sel_hi:[1,0]
    v_pk_fma_f32 v[12:13], v[28:29], v[74:75], v[12:13] op_sel_hi:[1,0,1] neg_lo:[1,0,0] neg_hi:[1,0,0]
    v_pk_fma_f32 v[28:29], v[28:29], v[72:73], v[124:125] op_sel_hi:[1,0,1]
    v_fma_f32 v54, -v76, v54, v126
    buffer_load_dwordx4 v[112:115], v85, s[92:95], 0 offen offset:1792 sc1
    v_mul_f32_dpp v126, -v55, v77 row_ror:8 row_mask:0xf bank_mask:0xf
    v_pk_mul_f32 v[124:125], v[14:15], v[74:75] op_sel_hi:[1,0]
    v_pk_mul_f32 v[14:15], v[14:15], v[72:73] op_sel_hi:[1,0]
    v_pk_fma_f32 v[14:15], v[30:31], v[74:75], v[14:15] op_sel_hi:[1,0,1] neg_lo:[1,0,0] neg_hi:[1,0,0]
    v_pk_fma_f32 v[30:31], v[30:31], v[72:73], v[124:125] op_sel_hi:[1,0,1]
    v_fma_f32 v55, -v76, v55, v126
    buffer_load_dwordx4 v[108:111], v85, s[92:95], 0 offen offset:1536 sc1
    s_waitcnt lgkmcnt(0)
    v_xor_b32 v35, v170, v35
    v_xor_b32 v39, v170, v39
    v_xor_b32 v44, v170, v44
    s_add_u32 s6, s100, 71680
    v_bfe_u32 v63, v152, 4, 1
    buffer_load_dwordx4 v[104:107], v85, s[92:95], 0 offen offset:1280 sc1
    v_lshlrev_b32 v63, 6, v63
    v_xor_b32 v56, v63, v153
    v_add_u32 v56, s6, v56
    v_and_b32 v58, 3, v152
    v_lshl_add_u32 v58, v58, 8, s6
    v_lshl_add_u32 v58, v63, 1, v58
    buffer_load_dwordx4 v[100:103], v85, s[92:95], 0 offen offset:1024 sc1
    v_bfe_u32 v63, v152, 2, 2
    v_lshl_add_u32 v58, v63, 4, v58
    v_lshrrev_b32 v57, 5, v152
    v_lshl_add_u32 v58, v57, 3, v58
    v_and_b32 v63, 1, v152
    v_lshl_add_u32 v58, v63, 6, v58
    buffer_load_dwordx4 v[96:99], v85, s[92:95], 0 offen offset:768 sc1
    v_xor_b32 v59, 64, v58
    s_lshl_b32 s3, s77, 10
    s_add_u32 s3, s3, 94016
    v_lshl_add_u32 v60, v63, 2, s3
    v_lshlrev_b32 v62, 5, v63
    v_bfe_u32 v63, v152, 1, 3
    buffer_load_dwordx4 v[92:95], v85, s[92:95], 0 offen offset:512 sc1
    v_lshl_add_u32 v60, v63, 5, v60
    v_and_b32 v63, 1, v63
    v_lshl_add_u32 v62, v63, 4, v62
    v_and_b32 v63, 0xc0, v153
    v_add_u32 v62, v63, v62
    v_lshrrev_b32 v63, 4, v152
    buffer_load_dwordx4 v[88:91], v85, s[92:95], 0 offen offset:256 sc1
    v_lshl_add_u32 v60, v63, 3, v60
    v_lshl_add_u32 v61, v63, 7, s3
    v_lshl_add_u32 v61, v152, 3, v61
    v_mul_u32_u24 v63, 40960, v63
    v_add_u32 v62, v63, v62
    v_and_b32 v120, 15, v152
    global_load_dword v64, v87, s[50:51] sc1
    v_min_u32 v120, 9, v120
    v_lshrrev_b32 v121, 4, v152
    v_mul_u32_u24 v121, 40960, v121
    v_lshl_add_u32 v120, v120, 10, v121
    v_sub_u32 v121, v175, v153
    v_add_u32 v158, v120, v121
L_cchk1:
    s_waitcnt vmcnt(7)
    v_fmac_f32_dpp v114, v118, v35 row_ror:8 row_mask:0xf bank_mask:0xf
    v_fmac_f32 v114, v34, v118
    v_pk_fma_f32 v[112:113], v[116:117], v[32:33], v[112:113] op_sel_hi:[1,0,1]
    v_pk_fma_f32 v[112:113], v[116:117], v[32:33], v[112:113] op_sel:[1,1,0] op_sel_hi:[0,1,1] neg_lo:[1,0,0]
    s_waitcnt vmcnt(6)
    v_add3_u32 v169, v119, v115, v111
    v_fmac_f32_dpp v110, v114, v35 row_ror:8 row_mask:0xf bank_mask:0xf
    v_fmac_f32 v110, v34, v114
    v_pk_fma_f32 v[108:109], v[112:113], v[32:33], v[108:109] op_sel_hi:[1,0,1]
    v_pk_fma_f32 v[108:109], v[112:113], v[32:33], v[108:109] op_sel:[1,1,0] op_sel_hi:[0,1,1] neg_lo:[1,0,0]
    s_waitcnt vmcnt(5)
    v_fmac_f32_dpp v106, v110, v35 row_ror:8 row_mask:0xf bank_mask:0xf
    v_fmac_f32 v106, v34, v110
    v_pk_fma_f32 v[104:105], v[108:109], v[32:33], v[104:105] op_sel_hi:[1,0,1]
    v_pk_fma_f32 v[104:105], v[108:109], v[32:33], v[104:105] op_sel:[1,1,0] op_sel_hi:[0,1,1] neg_lo:[1,0,0]
    s_waitcnt vmcnt(4)
    v_add3_u32 v169, v169, v107, v103
    v_fmac_f32_dpp v102, v106, v35 row_ror:8 row_mask:0xf bank_mask:0xf
    v_fmac_f32 v102, v34, v106
    v_pk_fma_f32 v[100:101], v[104:105], v[32:33], v[100:101] op_sel_hi:[1,0,1]
    v_pk_fma_f32 v[100:101], v[104:105], v[32:33], v[100:101] op_sel:[1,1,0] op_sel_hi:[0,1,1] neg_lo:[1,0,0]
    s_waitcnt vmcnt(3)
    v_fmac_f32_dpp v98, v102, v35 row_ror:8 row_mask:0xf bank_mask:0xf
    v_fmac_f32 v98, v34, v102
    v_pk_fma_f32 v[96:97], v[100:101], v[32:33], v[96:97] op_sel_hi:[1,0,1]
    v_pk_fma_f32 v[96:97], v[100:101], v[32:33], v[96:97] op_sel:[1,1,0] op_sel_hi:[0,1,1] neg_lo:[1,0,0]
    s_waitcnt vmcnt(2)
    v_add3_u32 v169, v169, v99, v95
    v_fmac_f32_dpp v94, v98, v35 row_ror:8 row_mask:0xf bank_mask:0xf
    v_fmac_f32 v94, v34, v98
    v_pk_fma_f32 v[92:93], v[96:97], v[32:33], v[92:93] op_sel_hi:[1,0,1]
    v_pk_fma_f32 v[92:93], v[96:97], v[32:33], v[92:93] op_sel:[1,1,0] op_sel_hi:[0,1,1] neg_lo:[1,0,0]
    s_waitcnt vmcnt(1)
    v_add_u32 v169, v169, v91
    v_cmp_ne_u32 vcc, v169, v86
    v_fmac_f32_dpp v90, v94, v35 row_ror:8 row_mask:0xf bank_mask:0xf
    v_fmac_f32 v90, v34, v94
    v_pk_fma_f32 v[88:89], v[92:93], v[32:33], v[88:89] op_sel_hi:[1,0,1]
    v_pk_fma_f32 v[88:89], v[92:93], v[32:33], v[88:89] op_sel:[1,1,0] op_sel_hi:[0,1,1] neg_lo:[1,0,0]
    s_cbranch_vccnz L_cre1
    v_mul_f32_dpp v94, v90, v39 row_ror:8 row_mask:0xf bank_mask:0xf
    v_pk_mul_f32 v[92:93], v[88:89], v[36:37] op_sel_hi:[1,0]
    v_fmac_f32 v94, v38, v90
    v_pk_fma_f32 v[92:93], v[88:89], v[36:37], v[92:93] op_sel:[1,1,0] op_sel_hi:[0,1,1] neg_lo:[1,0,0]

    v_mov_b32 v98, v94
    v_mov_b64 v[96:97], v[92:93]
    s_nop 0
    v_permlane32_swap_b32 v94, v98
    v_permlane32_swap_b32 v92, v96
    v_permlane32_swap_b32 v93, v97
    v_add_f32 v94, v94, v98
    v_pk_add_f32 v[92:93], v[92:93], v[96:97]

    v_mov_b32 v98, v94
    v_mov_b64 v[96:97], v[92:93]
    s_nop 0
    v_permlane16_swap_b32 v94, v98
    v_permlane16_swap_b32 v92, v96
    v_permlane16_swap_b32 v93, v97
    v_add_f32 v94, v94, v98
    v_pk_add_f32 v[92:93], v[92:93], v[96:97]

    v_fma_f32 v84, -v44, v94, v84
    v_pk_fma_f32 v[80:81], v[40:41], v[92:93], v[80:81] op_sel_hi:[1,0,1]
    v_pk_fma_f32 v[82:83], v[40:41], v[92:93], v[82:83] op_sel:[0,1,0]
    v_fmac_f32_dpp v84, -v94, v45 row_ror:8 row_mask:0xf bank_mask:0xf
    v_pk_fma_f32 v[80:81], v[42:43], v[92:93], v[80:81] op_sel:[0,1,0] neg_lo:[1,0,0] neg_hi:[1,0,0]
    v_pk_fma_f32 v[82:83], v[42:43], v[92:93], v[82:83] op_sel_hi:[1,0,1]

    s_waitcnt vmcnt(0)
L_xr:
    v_cmp_ne_u32 vcc, s13, v64
    s_cbranch_vccnz L_xr_re
    s_cmp_eq_u32 s88, 0
    s_cbranch_scc1 L_p2s1
    v_fmac_f32_dpp v48, -v84, v131 row_ror:8 row_mask:0xf bank_mask:0xf
    v_fmac_f32 v48, v130, v84
    v_pk_fma_f32 v[0:1], v[80:81], v[128:129], v[0:1] op_sel_hi:[1,0,1]
    v_pk_fma_f32 v[16:17], v[82:83], v[128:129], v[16:17] op_sel_hi:[1,0,1]
    v_fmac_f32_dpp v49, -v48, v131 row_ror:8 row_mask:0xf bank_mask:0xf
    v_fmac_f32 v49, v130, v48
    v_pk_fma_f32 v[0:1], v[82:83], v[128:129], v[0:1] op_sel:[0,1,0] neg_lo:[1,0,0] neg_hi:[1,0,0]
    v_pk_fma_f32 v[16:17], v[80:81], v[128:129], v[16:17] op_sel:[0,1,0]
    v_fmac_f32_dpp v50, -v49, v131 row_ror:8 row_mask:0xf bank_mask:0xf
    v_fmac_f32 v50, v130, v49
    v_pk_fma_f32 v[2:3], v[0:1], v[128:129], v[2:3] op_sel_hi:[1,0,1]
    v_pk_fma_f32 v[18:19], v[16:17], v[128:129], v[18:19] op_sel_hi:[1,0,1]
    v_fmac_f32_dpp v51, -v50, v131 row_ror:8 row_mask:0xf bank_mask:0xf
    v_fmac_f32 v51, v130, v50
    v_pk_fma_f32 v[2:3], v[16:17], v[128:129], v[2:3] op_sel:[0,1,0] neg_lo:[1,0,0] neg_hi:[1,0,0]
    v_pk_fma_f32 v[18:19], v[0:1], v[128:129], v[18:19] op_sel:[0,1,0]
    v_cvt_pk_bf16_f32 v104, v0, v1
    v_cvt_pk_bf16_f32 v105, v2, v3
    v_cvt_pk_bf16_f32 v106, -v16, -v17
    v_cvt_pk_bf16_f32 v107, -v18, -v19

    ds_write_b128 v56, v[104:107] offset:0
    ds_read_b64_tr_b16 v[88:89], v58 offset:0
    ds_read_b64_tr_b16 v[90:91], v59 offset:0
    v_fmac_f32_dpp v52, -v51, v131 row_ror:8 row_mask:0xf bank_mask:0xf
    v_fmac_f32 v52, v130, v51
    v_pk_fma_f32 v[4:5], v[2:3], v[128:129], v[4:5] op_sel_hi:[1,0,1]
    v_pk_fma_f32 v[20:21], v[18:19], v[128:129], v[20:21] op_sel_hi:[1,0,1]
    v_fmac_f32_dpp v53, -v52, v131 row_ror:8 row_mask:0xf bank_mask:0xf
    v_fmac_f32 v53, v130, v52
    v_pk_fma_f32 v[4:5], v[18:19], v[128:129], v[4:5] op_sel:[0,1,0] neg_lo:[1,0,0] neg_hi:[1,0,0]
    v_pk_fma_f32 v[20:21], v[2:3], v[128:129], v[20:21] op_sel:[0,1,0]
    v_fmac_f32_dpp v54, -v53, v131 row_ror:8 row_mask:0xf bank_mask:0xf
    v_fmac_f32 v54, v130, v53
    v_pk_fma_f32 v[6:7], v[4:5], v[128:129], v[6:7] op_sel_hi:[1,0,1]
    v_pk_fma_f32 v[22:23], v[20:21], v[128:129], v[22:23] op_sel_hi:[1,0,1]
    v_fmac_f32_dpp v55, -v54, v131 row_ror:8 row_mask:0xf bank_mask:0xf
    v_fmac_f32 v55, v130, v54
    v_pk_fma_f32 v[6:7], v[20:21], v[128:129], v[6:7] op_sel:[0,1,0] neg_lo:[1,0,0] neg_hi:[1,0,0]
    v_pk_fma_f32 v[22:23], v[4:5], v[128:129], v[22:23] op_sel:[0,1,0]
    v_cvt_pk_bf16_f32 v108, v4, v5
    v_cvt_pk_bf16_f32 v109, v6, v7
    v_cvt_pk_bf16_f32 v110, -v20, -v21
    v_cvt_pk_bf16_f32 v111, -v22, -v23

    ds_write_b128 v56, v[108:111] offset:1024
    ds_read_b64_tr_b16 v[92:93], v58 offset:1024
    ds_read_b64_tr_b16 v[94:95], v59 offset:1024
    v_pk_fma_f32 v[8:9], v[6:7], v[128:129], v[8:9] op_sel_hi:[1,0,1]
    v_pk_fma_f32 v[24:25], v[22:23], v[128:129], v[24:25] op_sel_hi:[1,0,1]
    v_pk_fma_f32 v[8:9], v[22:23], v[128:129], v[8:9] op_sel:[0,1,0] neg_lo:[1,0,0] neg_hi:[1,0,0]
    v_pk_fma_f32 v[24:25], v[6:7], v[128:129], v[24:25] op_sel:[0,1,0]
    v_cvt_pk_bf16_f32 v112, v48, v49
    v_cvt_pk_bf16_f32 v113, v50, v51
    v_cvt_pk_bf16_f32 v114, v52, v53
    v_cvt_pk_bf16_f32 v115, v54, v55
    ds_write2st64_b32 v60, v112, v113 offset0:0 offset1:1
    ds_write2st64_b32 v60, v114, v115 offset0:2 offset1:3
    ds_read_b64_tr_b16 v[116:117], v61 offset:0
    ds_read_b64_tr_b16 v[118:119], v61 offset:128
    v_pk_fma_f32 v[10:11], v[8:9], v[128:129], v[10:11] op_sel_hi:[1,0,1]
    v_pk_fma_f32 v[26:27], v[24:25], v[128:129], v[26:27] op_sel_hi:[1,0,1]
    v_pk_fma_f32 v[10:11], v[24:25], v[128:129], v[10:11] op_sel:[0,1,0] neg_lo:[1,0,0] neg_hi:[1,0,0]
    v_pk_fma_f32 v[26:27], v[8:9], v[128:129], v[26:27] op_sel:[0,1,0]
    v_cvt_pk_bf16_f32 v104, v8, v9
    v_cvt_pk_bf16_f32 v105, v10, v11
    v_cvt_pk_bf16_f32 v106, -v24, -v25
    v_cvt_pk_bf16_f32 v107, -v26, -v27

    ds_write_b128 v56, v[104:107] offset:0
    ds_read_b64_tr_b16 v[96:97], v58 offset:0
    ds_read_b64_tr_b16 v[98:99], v59 offset:0
    s_waitcnt lgkmcnt(10)
    v_and_b32 v88, -2, v88
    v_and_b32 v90, -2, v90
    buffer_store_dwordx4 v[88:91], v153, s[64:67], s36 offen
    v_pk_fma_f32 v[12:13], v[10:11], v[128:129], v[12:13] op_sel_hi:[1,0,1]
    v_pk_fma_f32 v[28:29], v[26:27], v[128:129], v[28:29] op_sel_hi:[1,0,1]
    v_pk_fma_f32 v[12:13], v[26:27], v[128:129], v[12:13] op_sel:[0,1,0] neg_lo:[1,0,0] neg_hi:[1,0,0]
    v_pk_fma_f32 v[28:29], v[10:11], v[128:129], v[28:29] op_sel:[0,1,0]
    v_pk_fma_f32 v[14:15], v[12:13], v[128:129], v[14:15] op_sel_hi:[1,0,1]
    v_pk_fma_f32 v[30:31], v[28:29], v[128:129], v[30:31] op_sel_hi:[1,0,1]
    v_pk_fma_f32 v[14:15], v[28:29], v[128:129], v[14:15] op_sel:[0,1,0] neg_lo:[1,0,0] neg_hi:[1,0,0]
    v_pk_fma_f32 v[30:31], v[12:13], v[128:129], v[30:31] op_sel:[0,1,0]
    v_cvt_pk_bf16_f32 v108, v12, v13
    v_cvt_pk_bf16_f32 v109, v14, v15
    v_cvt_pk_bf16_f32 v110, -v28, -v29
    v_cvt_pk_bf16_f32 v111, -v30, -v31

    ds_write_b128 v56, v[108:111] offset:1024
    ds_read_b64_tr_b16 v[100:101], v58 offset:1024
    ds_read_b64_tr_b16 v[102:103], v59 offset:1024
    s_waitcnt lgkmcnt(10)
    v_and_b32 v92, -2, v92
    v_and_b32 v94, -2, v94
    buffer_store_dwordx4 v[92:95], v153, s[64:67], s18 offen
    s_waitcnt lgkmcnt(6)
    v_and_b32 v116, -2, v116
    v_and_b32 v118, -2, v118
    buffer_store_dwordx2 v[116:117], v62, s[64:67], s37 offen offset:0
    buffer_store_dwordx2 v[118:119], v62, s[64:67], s37 offen offset:512
    s_waitcnt lgkmcnt(3)
    v_and_b32 v96, -2, v96
    v_and_b32 v98, -2, v98
    buffer_store_dwordx4 v[96:99], v153, s[64:67], s19 offen
    s_waitcnt lgkmcnt(0)
    v_and_b32 v100, -2, v100
    v_and_b32 v102, -2, v102
    buffer_store_dwordx4 v[100:103], v153, s[64:67], s20 offen
L_p2e1:
    s_lshl_b32 s8, s77, 2
    s_add_u32 s8, s8, 61440
    v_bfe_u32 v121, v152, 4, 2
    v_lshl_add_u32 v120, v121, 5, s8
    v_bfe_u32 v121, v152, 2, 1
    v_lshl_add_u32 v120, v121, 4, v120
    v_bfe_u32 v121, v152, 3, 1
    v_lshl_add_u32 v120, v121, 1, v120
    v_and_b32 v121, 3, v152
    v_lshl_add_u32 v120, v121, 9, v120
    s_barrier
    v_accvgpr_write_b32 a0, 0
    v_accvgpr_write_b32 a1, 0
    v_accvgpr_write_b32 a2, 0
    ds_read_u16_d16_hi a0, v120 offset:0
    v_accvgpr_write_b32 a3, 0
    ds_read_u16_d16_hi a1, v120 offset:128
    v_accvgpr_write_b32 a4, 0
    ds_read_u16_d16_hi a2, v120 offset:256
    v_accvgpr_write_b32 a5, 0
    ds_read_u16_d16_hi a3, v120 offset:384
    v_accvgpr_write_b32 a6, 0
    ds_read_u16_d16_hi a4, v120 offset:2048
    v_accvgpr_write_b32 a7, 0
    ds_read_u16_d16_hi a5, v120 offset:2176
    v_accvgpr_write_b32 a8, 0
    ds_read_u16_d16_hi a6, v120 offset:2304
    v_accvgpr_write_b32 a9, 0
    ds_read_u16_d16_hi a7, v120 offset:2432
    v_accvgpr_write_b32 a10, 0
    ds_read_u16_d16_hi a8, v120 offset:4096
    v_accvgpr_write_b32 a11, 0
    ds_read_u16_d16_hi a9, v120 offset:4224
    v_accvgpr_write_b32 a12, 0
    ds_read_u16_d16_hi a10, v120 offset:4352
    v_accvgpr_write_b32 a13, 0
    ds_read_u16_d16_hi a11, v120 offset:4480
    v_accvgpr_write_b32 a14, 0
    ds_read_u16_d16_hi a12, v120 offset:6144
    v_accvgpr_write_b32 a15, 0
    ds_read_u16_d16_hi a13, v120 offset:6272
    v_accvgpr_write_b32 a16, 0
    ds_read_u16_d16_hi a14, v120 offset:6400
    v_accvgpr_write_b32 a17, 0
    ds_read_u16_d16_hi a15, v120 offset:6528
    v_accvgpr_write_b32 a18, 0
    ds_read_u16_d16_hi a16, v120 offset:8192
    v_accvgpr_write_b32 a19, 0
    ds_read_u16_d16_hi a17, v120 offset:8320
    ds_read_u16_d16_hi a18, v120 offset:8448
    ds_read_u16_d16_hi a19, v120 offset:8576
L_hp:
    s_sub_u32 s101, s101, 1
    s_cbranch_scc1 L_end
    buffer_load_dwordx4 v[40:43], v175, s[64:67], s23 offen offset:0 sc1
    buffer_load_dwordx4 v[44:47], v175, s[64:67], s23 offen offset:1024 sc1
    buffer_load_dwordx4 v[48:51], v175, s[64:67], s23 offen offset:2048 sc1
    buffer_load_dwordx4 v[120:123], v175, s[64:67], s22 offen offset:0 sc1
    buffer_load_dwordx4 v[80:83], v175, s[64:67], s25 offen offset:0 sc1
    buffer_load_dwordx4 v[116:119], v175, s[64:67], s28 offen offset:0 sc1
    buffer_load_dwordx4 v[64:67], v175, s[64:67], s31 offen offset:0 sc1
    s_waitcnt vmcnt(4)
    v_bitop3_b32 v169, v40, v42, v44 bitop3:254
    v_bitop3_b32 v169, v169, v46, v48 bitop3:254
    v_bitop3_b32 v169, v169, v50, 1 bitop3:168
    v_cmp_ne_u32 vcc, 0, v169
    s_cbranch_vccnz Lh1c0r
Lh1c0:
    v_mfma_f32_16x16x32_bf16 v[132:135], a[232:235], v[40:43], v[132:135]
    buffer_load_dwordx4 v[60:63], v175, s[64:67], s22 offen offset:1024 sc1
    v_mfma_f32_16x16x32_bf16 v[136:139], v[176:179], v[40:43], v[136:139]
    v_mfma_f32_16x16x32_bf16 v[140:143], v[192:195], v[40:43], v[140:143]
    v_mfma_f32_16x16x32_bf16 v[144:147], v[208:211], v[40:43], v[144:147]
    v_mfma_f32_16x16x32_bf16 v[148:151], a[216:219], v[40:43], v[148:151]
    buffer_load_dwordx4 v[68:71], v175, s[64:67], s25 offen offset:1024 sc1
    v_mfma_f32_16x16x32_bf16 v[132:135], a[236:239], v[44:47], v[132:135]
    v_mfma_f32_16x16x32_bf16 v[136:139], v[180:183], v[44:47], v[136:139]
    v_mfma_f32_16x16x32_bf16 v[140:143], v[196:199], v[44:47], v[140:143]
    v_mfma_f32_16x16x32_bf16 v[144:147], v[212:215], v[44:47], v[144:147]
    ds_read_b128 v[124:127], v156 offset:8192
    buffer_load_dwordx4 v[72:75], v175, s[64:67], s28 offen offset:1024 sc1
    s_waitcnt vmcnt(3)
    v_bitop3_b32 v169, v120, v122, v80 bitop3:254
    v_bitop3_b32 v169, v169, v82, v116 bitop3:254
    v_mfma_f32_16x16x32_bf16 v[148:151], a[220:223], v[44:47], v[148:151]
    v_bitop3_b32 v169, v169, v118, v64 bitop3:254
    v_bitop3_b32 v169, v169, v66, 1 bitop3:168
    v_mfma_f32_16x16x32_bf16 v[132:135], a[240:243], v[48:51], v[132:135]
    v_cmp_ne_u32 vcc, 0, v169
    v_mfma_f32_16x16x32_bf16 v[136:139], v[184:187], v[48:51], v[136:139]
    v_mfma_f32_16x16x32_bf16 v[140:143], v[200:203], v[48:51], v[140:143]
    ds_read_b128 v[128:131], v156 offset:12288
    buffer_load_dwordx4 v[76:79], v175, s[64:67], s31 offen offset:1024 sc1
    v_mfma_f32_16x16x32_bf16 v[144:147], v[216:219], v[48:51], v[144:147]
    v_mfma_f32_16x16x32_bf16 v[148:151], a[224:227], v[48:51], v[148:151]
    s_cbranch_vccnz Lh1c1r
Lh1c1:
    v_mfma_f32_16x16x32_bf16 v[148:151], a[200:203], v[120:123], v[148:151]
    v_mfma_f32_16x16x32_bf16 v[40:43], a[200:203], v[80:83], 0
    ds_read_b128 v[112:115], v156 offset:0
    buffer_load_dwordx4 v[84:87], v175, s[64:67], s22 offen offset:2048 sc1
    v_mfma_f32_16x16x32_bf16 v[44:47], a[200:203], v[116:119], 0
    v_mfma_f32_16x16x32_bf16 v[48:51], a[200:203], v[64:67], 0
    s_waitcnt lgkmcnt(2)
    v_mfma_f32_16x16x32_bf16 v[140:143], v[124:127], v[120:123], v[140:143]
    v_mfma_f32_16x16x32_bf16 v[52:55], v[124:127], v[80:83], 0
    buffer_load_dwordx4 v[88:91], v175, s[64:67], s25 offen offset:2048 sc1
    v_mfma_f32_16x16x32_bf16 v[56:59], v[124:127], v[116:119], 0
    v_mfma_f32_16x16x32_bf16 v[0:3], v[124:127], v[64:67], 0
    ds_read_b128 v[124:127], v156 offset:4096
    s_waitcnt lgkmcnt(2)
    v_mfma_f32_16x16x32_bf16 v[144:147], v[128:131], v[120:123], v[144:147]
    v_mfma_f32_16x16x32_bf16 v[4:7], v[128:131], v[80:83], 0
    buffer_load_dwordx4 v[92:95], v175, s[64:67], s28 offen offset:2048 sc1
    v_mfma_f32_16x16x32_bf16 v[8:11], v[128:131], v[116:119], 0
    v_mfma_f32_16x16x32_bf16 v[12:15], v[128:131], v[64:67], 0
    ds_read_b128 v[128:131], v157 offset:8192
    s_waitcnt lgkmcnt(2)
    v_mfma_f32_16x16x32_bf16 v[132:135], v[112:115], v[120:123], v[132:135]
    v_mfma_f32_16x16x32_bf16 v[28:31], v[112:115], v[80:83], 0
    buffer_load_dwordx4 v[96:99], v175, s[64:67], s31 offen offset:2048 sc1
    s_waitcnt vmcnt(4)
    v_bitop3_b32 v169, v60, v62, v68 bitop3:254
    v_bitop3_b32 v169, v169, v70, v72 bitop3:254
    v_mfma_f32_16x16x32_bf16 v[32:35], v[112:115], v[116:119], 0
    v_bitop3_b32 v169, v169, v74, v76 bitop3:254
    v_bitop3_b32 v169, v169, v78, 1 bitop3:168
    v_mfma_f32_16x16x32_bf16 v[36:39], v[112:115], v[64:67], 0
    ds_read_b128 v[112:115], v157 offset:12288
    v_cmp_ne_u32 vcc, 0, v169
    s_waitcnt lgkmcnt(2)
    v_mfma_f32_16x16x32_bf16 v[136:139], v[124:127], v[120:123], v[136:139]
    v_mfma_f32_16x16x32_bf16 v[16:19], v[124:127], v[80:83], 0
    buffer_load_dwordx4 v[100:103], v175, s[64:67], s22 offen offset:3072 sc1
    v_mfma_f32_16x16x32_bf16 v[20:23], v[124:127], v[116:119], 0
    v_mfma_f32_16x16x32_bf16 v[24:27], v[124:127], v[64:67], 0
    ds_read_b128 v[124:127], v157 offset:0
    s_cbranch_vccnz Lh1c2r
Lh1c2:
    v_mfma_f32_16x16x32_bf16 v[148:151], a[204:207], v[60:63], v[148:151]
    v_mfma_f32_16x16x32_bf16 v[40:43], a[204:207], v[68:71], v[40:43]
    buffer_load_dwordx4 v[104:107], v175, s[64:67], s25 offen offset:3072 sc1
    v_mfma_f32_16x16x32_bf16 v[44:47], a[204:207], v[72:75], v[44:47]
    v_mfma_f32_16x16x32_bf16 v[48:51], a[204:207], v[76:79], v[48:51]
    s_waitcnt lgkmcnt(2)
    v_mfma_f32_16x16x32_bf16 v[140:143], v[128:131], v[60:63], v[140:143]
    v_mfma_f32_16x16x32_bf16 v[52:55], v[128:131], v[68:71], v[52:55]
    buffer_load_dwordx4 v[108:111], v175, s[64:67], s28 offen offset:3072 sc1
    v_mfma_f32_16x16x32_bf16 v[56:59], v[128:131], v[72:75], v[56:59]
    v_mfma_f32_16x16x32_bf16 v[0:3], v[128:131], v[76:79], v[0:3]
    ds_read_b128 v[128:131], v157 offset:4096
    s_waitcnt lgkmcnt(2)
    v_mfma_f32_16x16x32_bf16 v[144:147], v[112:115], v[60:63], v[144:147]
    v_mfma_f32_16x16x32_bf16 v[4:7], v[112:115], v[68:71], v[4:7]
    buffer_load_dwordx4 v[120:123], v175, s[64:67], s31 offen offset:3072 sc1
    v_mfma_f32_16x16x32_bf16 v[8:11], v[112:115], v[72:75], v[8:11]
    v_mfma_f32_16x16x32_bf16 v[12:15], v[112:115], v[76:79], v[12:15]
    ds_read_b128 v[112:115], v156 offset:8704
    s_waitcnt lgkmcnt(2)
    v_mfma_f32_16x16x32_bf16 v[132:135], v[124:127], v[60:63], v[132:135]
    v_mfma_f32_16x16x32_bf16 v[28:31], v[124:127], v[68:71], v[28:31]
    buffer_load_dwordx4 v[80:83], v175, s[64:67], s26 offen offset:0 sc1
    s_waitcnt vmcnt(5)
    v_bitop3_b32 v169, v84, v86, v88 bitop3:254
    v_bitop3_b32 v169, v169, v90, v92 bitop3:254
    v_mfma_f32_16x16x32_bf16 v[32:35], v[124:127], v[72:75], v[32:35]
    v_bitop3_b32 v169, v169, v94, v96 bitop3:254
    v_bitop3_b32 v169, v169, v98, 1 bitop3:168
    v_mfma_f32_16x16x32_bf16 v[36:39], v[124:127], v[76:79], v[36:39]
    ds_read_b128 v[124:127], v156 offset:12800
    v_cmp_ne_u32 vcc, 0, v169
    s_waitcnt lgkmcnt(2)
    v_mfma_f32_16x16x32_bf16 v[136:139], v[128:131], v[60:63], v[136:139]
    v_mfma_f32_16x16x32_bf16 v[16:19], v[128:131], v[68:71], v[16:19]
    buffer_load_dwordx4 v[116:119], v175, s[64:67], s26 offen offset:1024 sc1
    v_mfma_f32_16x16x32_bf16 v[20:23], v[128:131], v[72:75], v[20:23]
    v_mfma_f32_16x16x32_bf16 v[24:27], v[128:131], v[76:79], v[24:27]
    ds_read_b128 v[128:131], v156 offset:512
    s_cbranch_vccnz Lh1c3r
Lh1c3:
    v_mfma_f32_16x16x32_bf16 v[148:151], a[208:211], v[84:87], v[148:151]
    v_mfma_f32_16x16x32_bf16 v[40:43], a[208:211], v[88:91], v[40:43]
    buffer_load_dwordx4 v[64:67], v175, s[64:67], s26 offen offset:2048 sc1
    v_mfma_f32_16x16x32_bf16 v[44:47], a[208:211], v[92:95], v[44:47]
    v_mfma_f32_16x16x32_bf16 v[48:51], a[208:211], v[96:99], v[48:51]
    s_waitcnt lgkmcnt(2)
    v_mfma_f32_16x16x32_bf16 v[140:143], v[112:115], v[84:87], v[140:143]
    v_mfma_f32_16x16x32_bf16 v[52:55], v[112:115], v[88:91], v[52:55]
    buffer_load_dwordx4 v[60:63], v175, s[64:67], s26 offen offset:3072 sc1
    v_mfma_f32_16x16x32_bf16 v[56:59], v[112:115], v[92:95], v[56:59]
    v_mfma_f32_16x16x32_bf16 v[0:3], v[112:115], v[96:99], v[0:3]
    ds_read_b128 v[112:115], v156 offset:4608
    s_waitcnt lgkmcnt(2)
    v_mfma_f32_16x16x32_bf16 v[144:147], v[124:127], v[84:87], v[144:147]
    v_mfma_f32_16x16x32_bf16 v[4:7], v[124:127], v[88:91], v[4:7]
    buffer_load_dwordx4 v[68:71], v175, s[64:67], s27 offen offset:0 sc1
    v_mfma_f32_16x16x32_bf16 v[8:11], v[124:127], v[92:95], v[8:11]
    v_mfma_f32_16x16x32_bf16 v[12:15], v[124:127], v[96:99], v[12:15]
    ds_read_b128 v[124:127], v157 offset:8704
    s_waitcnt lgkmcnt(2)
    v_mfma_f32_16x16x32_bf16 v[132:135], v[128:131], v[84:87], v[132:135]
    v_mfma_f32_16x16x32_bf16 v[28:31], v[128:131], v[88:91], v[28:31]
    buffer_load_dwordx4 v[72:75], v175, s[64:67], s27 offen offset:1024 sc1
    s_waitcnt vmcnt(6)
    v_bitop3_b32 v169, v100, v102, v104 bitop3:254
    v_bitop3_b32 v169, v169, v106, v108 bitop3:254
    v_mfma_f32_16x16x32_bf16 v[32:35], v[128:131], v[92:95], v[32:35]
    v_bitop3_b32 v169, v169, v110, v120 bitop3:254
    v_bitop3_b32 v169, v169, v122, 1 bitop3:168
    v_mfma_f32_16x16x32_bf16 v[36:39], v[128:131], v[96:99], v[36:39]
    ds_read_b128 v[128:131], v157 offset:12800
    v_cmp_ne_u32 vcc, 0, v169
    s_waitcnt lgkmcnt(2)
    v_mfma_f32_16x16x32_bf16 v[136:139], v[112:115], v[84:87], v[136:139]
    v_mfma_f32_16x16x32_bf16 v[16:19], v[112:115], v[88:91], v[16:19]
    buffer_load_dwordx4 v[76:79], v175, s[64:67], s29 offen offset:0 sc1
    v_mfma_f32_16x16x32_bf16 v[20:23], v[112:115], v[92:95], v[20:23]
    v_mfma_f32_16x16x32_bf16 v[24:27], v[112:115], v[96:99], v[24:27]
    ds_read_b128 v[112:115], v157 offset:512
    s_cbranch_vccnz Lh1c4r
Lh1c4:
    v_mfma_f32_16x16x32_bf16 v[148:151], a[212:215], v[100:103], v[148:151]
    v_mfma_f32_16x16x32_bf16 v[40:43], a[212:215], v[104:107], v[40:43]
    buffer_load_dwordx4 v[84:87], v175, s[64:67], s29 offen offset:1024 sc1
    v_mfma_f32_16x16x32_bf16 v[44:47], a[212:215], v[108:111], v[44:47]
    v_mfma_f32_16x16x32_bf16 v[48:51], a[212:215], v[120:123], v[48:51]
    s_waitcnt lgkmcnt(2)
    v_mfma_f32_16x16x32_bf16 v[140:143], v[124:127], v[100:103], v[140:143]
    v_mfma_f32_16x16x32_bf16 v[52:55], v[124:127], v[104:107], v[52:55]
    buffer_load_dwordx4 v[88:91], v175, s[64:67], s29 offen offset:2048 sc1
    v_mfma_f32_16x16x32_bf16 v[56:59], v[124:127], v[108:111], v[56:59]
    v_mfma_f32_16x16x32_bf16 v[0:3], v[124:127], v[120:123], v[0:3]
    ds_read_b128 v[124:127], v157 offset:4608
    s_waitcnt lgkmcnt(2)
    v_mfma_f32_16x16x32_bf16 v[144:147], v[128:131], v[100:103], v[144:147]
    v_mfma_f32_16x16x32_bf16 v[4:7], v[128:131], v[104:107], v[4:7]
    buffer_load_dwordx4 v[92:95], v175, s[64:67], s29 offen offset:3072 sc1
    v_mfma_f32_16x16x32_bf16 v[8:11], v[128:131], v[108:111], v[8:11]
    v_mfma_f32_16x16x32_bf16 v[12:15], v[128:131], v[120:123], v[12:15]
    s_waitcnt lgkmcnt(1)
    v_mfma_f32_16x16x32_bf16 v[132:135], v[112:115], v[100:103], v[132:135]
    v_mfma_f32_16x16x32_bf16 v[28:31], v[112:115], v[104:107], v[28:31]
    buffer_load_dwordx4 v[96:99], v175, s[64:67], s30 offen offset:0 sc1
    s_waitcnt vmcnt(5)
    v_bitop3_b32 v169, v80, v82, v116 bitop3:254
    v_bitop3_b32 v169, v169, v118, v64 bitop3:254
    v_mfma_f32_16x16x32_bf16 v[32:35], v[112:115], v[108:111], v[32:35]
    v_bitop3_b32 v169, v169, v66, v60 bitop3:254
    v_bitop3_b32 v169, v169, v62, v68 bitop3:254
    v_mfma_f32_16x16x32_bf16 v[36:39], v[112:115], v[120:123], v[36:39]
    v_bitop3_b32 v169, v169, v70, v72 bitop3:254
    v_bitop3_b32 v169, v169, v74, 1 bitop3:168
    s_waitcnt lgkmcnt(0)
    v_mfma_f32_16x16x32_bf16 v[136:139], v[124:127], v[100:103], v[136:139]
    v_cmp_ne_u32 vcc, 0, v169
    v_mfma_f32_16x16x32_bf16 v[16:19], v[124:127], v[104:107], v[16:19]
    buffer_load_dwordx4 v[100:103], v175, s[64:67], s30 offen offset:1024 sc1
    v_mfma_f32_16x16x32_bf16 v[20:23], v[124:127], v[108:111], v[20:23]
    v_mfma_f32_16x16x32_bf16 v[24:27], v[124:127], v[120:123], v[24:27]
    s_cbranch_vccnz Lh1c5r
Lh1c5:
    v_mfma_f32_16x16x32_bf16 v[28:31], a[232:235], v[80:83], v[28:31]
    v_mfma_f32_16x16x32_bf16 v[28:31], a[236:239], v[116:119], v[28:31]
    buffer_load_dwordx4 v[104:107], v175, s[64:67], s32 offen offset:0 sc1
    v_mfma_f32_16x16x32_bf16 v[28:31], a[240:243], v[64:67], v[28:31]
    v_mfma_f32_16x16x32_bf16 v[28:31], a[244:247], v[60:63], v[28:31]
    v_mfma_f32_16x16x32_bf16 v[28:31], v[224:227], v[68:71], v[28:31]
    s_add_u32 s3, s77, 1
    s_and_b32 s3, s3, 3
    v_mfma_f32_16x16x32_bf16 v[28:31], v[228:231], v[72:75], v[28:31]
    s_mul_i32 s3, s3, 15360
    buffer_load_dwordx4 v[108:111], v175, s[64:67], s32 offen offset:1024 sc1
    v_add_u32 v165, s3, v153
    v_mfma_f32_16x16x32_bf16 v[16:19], v[176:179], v[80:83], v[16:19]
    s_mul_i32 s8, s77, 15360
    s_movk_i32 s9, 320
    v_mfma_f32_16x16x32_bf16 v[16:19], v[180:183], v[116:119], v[16:19]
    v_and_b32 v124, 15, v152
    v_lshrrev_b32 v112, 4, v152
    v_mfma_f32_16x16x32_bf16 v[16:19], v[184:187], v[64:67], v[16:19]
    v_bfe_u32 v113, v152, 1, 2
    v_mov_b32 v114, s8
    v_mfma_f32_16x16x32_bf16 v[16:19], v[188:191], v[60:63], v[16:19]
    ds_write_b128 v165, v[28:31] offset:0
    buffer_load_dwordx4 v[120:123], v175, s[64:67], s32 offen offset:2048 sc1
    v_mfma_f32_16x16x32_bf16 v[16:19], v[232:235], v[68:71], v[16:19]
    v_mad_u32_u24 v124, v124, s9, v114
    v_xor_b32 v126, v112, v113
    v_mfma_f32_16x16x32_bf16 v[16:19], v[236:239], v[72:75], v[16:19]
    v_lshl_add_u32 v126, v126, 4, v124
    v_lshrrev_b32 v115, 1, v112
    v_mfma_f32_16x16x32_bf16 v[52:55], v[192:195], v[80:83], v[52:55]
    v_lshl_add_u32 v124, v115, 6, v124
    v_and_b32 v115, 1, v112
    v_mfma_f32_16x16x32_bf16 v[52:55], v[196:199], v[116:119], v[52:55]
    v_lshlrev_b32 v115, 1, v115
    v_xor_b32 v115, v115, v113
    v_mfma_f32_16x16x32_bf16 v[52:55], v[200:203], v[64:67], v[52:55]
    v_lshl_add_u32 v124, v115, 4, v124
    v_xor_b32 v125, 16, v124
    v_mfma_f32_16x16x32_bf16 v[52:55], v[204:207], v[60:63], v[52:55]
    ds_write_b128 v165, v[16:19] offset:1024
    v_lshrrev_b32 v115, 2, v152
    v_mfma_f32_16x16x32_bf16 v[52:55], v[240:243], v[68:71], v[52:55]
    v_mad_u32_u24 v127, v115, s9, v114
    v_bfe_u32 v113, v152, 3, 2
    v_mfma_f32_16x16x32_bf16 v[52:55], v[244:247], v[72:75], v[52:55]
    v_and_b32 v114, 3, v152
    v_xor_b32 v113, v113, v114
    v_mfma_f32_16x16x32_bf16 v[4:7], v[208:211], v[80:83], v[4:7]
    v_lshl_add_u32 v127, v113, 4, v127
    v_mfma_f32_16x16x32_bf16 v[4:7], v[212:215], v[116:119], v[4:7]
    s_lshl_b32 s8, s77, 4
    s_add_u32 s8, s8, 93184
    v_mfma_f32_16x16x32_bf16 v[4:7], v[216:219], v[64:67], v[4:7]
    v_lshl_add_u32 v128, v112, 6, s8
    v_and_b32 v115, 3, v115
    v_mfma_f32_16x16x32_bf16 v[4:7], v[220:223], v[60:63], v[4:7]
    ds_write_b128 v165, v[52:55] offset:2048
    v_lshl_add_u32 v128, v115, 2, v128
    v_mfma_f32_16x16x32_bf16 v[4:7], v[248:251], v[68:71], v[4:7]
    v_lshl_add_u32 v112, v112, 2, v114
    v_lshlrev_b32 v163, 4, v112
    v_mfma_f32_16x16x32_bf16 v[4:7], v[252:255], v[72:75], v[4:7]
    s_waitcnt vmcnt(3)
    v_bitop3_b32 v169, v76, v78, v84 bitop3:254
    v_bitop3_b32 v169, v169, v86, v88 bitop3:254
    v_mfma_f32_16x16x32_bf16 v[40:43], a[216:219], v[80:83], v[40:43]
    buffer_load_dwordx4 v[80:83], v175, s[64:67], s32 offen offset:3072 sc1
    v_bitop3_b32 v169, v169, v90, v92 bitop3:254
    v_bitop3_b32 v169, v169, v94, v96 bitop3:254
    v_mfma_f32_16x16x32_bf16 v[40:43], a[220:223], v[116:119], v[40:43]
    v_bitop3_b32 v169, v169, v98, v100 bitop3:254
    v_bitop3_b32 v169, v169, v102, 1 bitop3:168
    v_mfma_f32_16x16x32_bf16 v[40:43], a[224:227], v[64:67], v[40:43]
    v_cmp_ne_u32 vcc, 0, v169
    v_lshl_add_u32 v163, v115, 9, v163
    v_mfma_f32_16x16x32_bf16 v[40:43], a[228:231], v[60:63], v[40:43]
    ds_write_b128 v165, v[4:7] offset:3072
    ds_read_b32 v128, v128
    v_mfma_f32_16x16x32_bf16 v[40:43], a[248:251], v[68:71], v[40:43]
    buffer_load_dwordx4 v[116:119], v175, s[64:67], s33 offen offset:0 sc1
    s_lshl_b32 s8, s77, 2
    v_mfma_f32_16x16x32_bf16 v[40:43], a[252:255], v[72:75], v[40:43]
    s_cbranch_vccnz Lh1c6r
Lh1c6:
    s_add_u32 s8, s8, 0
    v_mfma_f32_16x16x32_bf16 v[32:35], a[232:235], v[76:79], v[32:35]
    v_bfe_u32 v113, v152, 4, 2
    v_lshl_add_u32 v131, v113, 5, s8
    v_mfma_f32_16x16x32_bf16 v[32:35], a[236:239], v[84:87], v[32:35]
    v_bfe_u32 v113, v152, 2, 1
    v_lshl_add_u32 v131, v113, 4, v131
    v_mfma_f32_16x16x32_bf16 v[32:35], a[240:243], v[88:91], v[32:35]
    buffer_load_dwordx4 v[64:67], v175, s[64:67], s33 offen offset:1024 sc1
    v_bfe_u32 v113, v152, 3, 1
    v_mfma_f32_16x16x32_bf16 v[32:35], a[244:247], v[92:95], v[32:35]
    ds_write_b128 v165, v[40:43] offset:4096
    v_lshl_add_u32 v131, v113, 1, v131
    v_mfma_f32_16x16x32_bf16 v[32:35], v[224:227], v[96:99], v[32:35]
    s_add_u32 s3, s77, 2
    s_and_b32 s3, s3, 3
    v_mfma_f32_16x16x32_bf16 v[32:35], v[228:231], v[100:103], v[32:35]
    s_mul_i32 s3, s3, 15360
    v_add_u32 v165, s3, v153
    v_mfma_f32_16x16x32_bf16 v[20:23], v[176:179], v[76:79], v[20:23]
    buffer_load_dwordx4 v[60:63], v175, s[64:67], s23 offen offset:3072 sc1
    s_mul_i32 s8, s79, 163840
    v_mfma_f32_16x16x32_bf16 v[20:23], v[180:183], v[84:87], v[20:23]
    s_mul_i32 s9, s78, 320
    s_add_u32 s8, s8, s9
    v_mfma_f32_16x16x32_bf16 v[20:23], v[184:187], v[88:91], v[20:23]
    v_mul_u32_u24 v131, 1280, v131
    v_lshl_add_u32 v131, v114, 4, v131
    v_mfma_f32_16x16x32_bf16 v[20:23], v[188:191], v[92:95], v[20:23]
    ds_write_b128 v165, v[32:35] offset:5120
    v_add_u32 v131, s8, v131
    v_mfma_f32_16x16x32_bf16 v[20:23], v[232:235], v[96:99], v[20:23]
    buffer_load_dwordx4 v[68:71], v175, s[64:67], s24 offen offset:0 sc1
    v_mfma_f32_16x16x32_bf16 v[20:23], v[236:239], v[100:103], v[20:23]
    v_mfma_f32_16x16x32_bf16 v[56:59], v[192:195], v[76:79], v[56:59]
    v_mfma_f32_16x16x32_bf16 v[56:59], v[196:199], v[84:87], v[56:59]
    v_mfma_f32_16x16x32_bf16 v[56:59], v[200:203], v[88:91], v[56:59]
    buffer_load_dwordx4 v[72:75], v175, s[64:67], s24 offen offset:1024 sc1
    v_mfma_f32_16x16x32_bf16 v[56:59], v[204:207], v[92:95], v[56:59]
    s_nop 2
    ds_write_b128 v165, v[20:23] offset:6144
    v_mfma_f32_16x16x32_bf16 v[56:59], v[240:243], v[96:99], v[56:59]
    v_mfma_f32_16x16x32_bf16 v[56:59], v[244:247], v[100:103], v[56:59]
    v_mfma_f32_16x16x32_bf16 v[8:11], v[208:211], v[76:79], v[8:11]
    v_mfma_f32_16x16x32_bf16 v[8:11], v[212:215], v[84:87], v[8:11]
    v_mfma_f32_16x16x32_bf16 v[8:11], v[216:219], v[88:91], v[8:11]
    v_mfma_f32_16x16x32_bf16 v[8:11], v[220:223], v[92:95], v[8:11]
    s_nop 3
    ds_write_b128 v165, v[56:59] offset:7168
    v_mfma_f32_16x16x32_bf16 v[8:11], v[248:251], v[96:99], v[8:11]
    v_mfma_f32_16x16x32_bf16 v[8:11], v[252:255], v[100:103], v[8:11]
    s_waitcnt vmcnt(3)
    v_bitop3_b32 v169, v104, v106, v108 bitop3:254
    v_bitop3_b32 v169, v169, v110, v120 bitop3:254
    v_mfma_f32_16x16x32_bf16 v[44:47], a[216:219], v[76:79], v[44:47]
    v_bitop3_b32 v169, v169, v122, v80 bitop3:254
    v_bitop3_b32 v169, v169, v82, v116 bitop3:254
    v_mfma_f32_16x16x32_bf16 v[44:47], a[220:223], v[84:87], v[44:47]
    v_bitop3_b32 v169, v169, v118, v64 bitop3:254
    v_bitop3_b32 v169, v169, v66, 1 bitop3:168
    v_mfma_f32_16x16x32_bf16 v[44:47], a[224:227], v[88:91], v[44:47]
    v_cmp_ne_u32 vcc, 0, v169
    v_mfma_f32_16x16x32_bf16 v[44:47], a[228:231], v[92:95], v[44:47]
    ds_write_b128 v165, v[8:11] offset:8192
    v_mfma_f32_16x16x32_bf16 v[44:47], a[248:251], v[96:99], v[44:47]
    v_mfma_f32_16x16x32_bf16 v[44:47], a[252:255], v[100:103], v[44:47]
    s_cbranch_vccnz Lh1c7r
Lh1c7:
    v_mfma_f32_16x16x32_bf16 v[36:39], a[232:235], v[104:107], v[36:39]
    v_mfma_f32_16x16x32_bf16 v[36:39], a[236:239], v[108:111], v[36:39]
    v_mfma_f32_16x16x32_bf16 v[36:39], a[240:243], v[120:123], v[36:39]
    v_mfma_f32_16x16x32_bf16 v[36:39], a[244:247], v[80:83], v[36:39]
    s_nop 2
    ds_write_b128 v165, v[44:47] offset:9216
    v_mfma_f32_16x16x32_bf16 v[36:39], v[224:227], v[116:119], v[36:39]
    s_add_u32 s3, s77, 3
    s_and_b32 s3, s3, 3
    v_mfma_f32_16x16x32_bf16 v[36:39], v[228:231], v[64:67], v[36:39]
    s_mul_i32 s3, s3, 15360
    v_add_u32 v165, s3, v153
    v_mfma_f32_16x16x32_bf16 v[24:27], v[176:179], v[104:107], v[24:27]
    v_mfma_f32_16x16x32_bf16 v[24:27], v[180:183], v[108:111], v[24:27]
    v_mfma_f32_16x16x32_bf16 v[24:27], v[184:187], v[120:123], v[24:27]
    v_mfma_f32_16x16x32_bf16 v[24:27], v[188:191], v[80:83], v[24:27]
    s_nop 1
    ds_write_b128 v165, v[36:39] offset:10240
    v_mfma_f32_16x16x32_bf16 v[24:27], v[232:235], v[116:119], v[24:27]
    v_mfma_f32_16x16x32_bf16 v[24:27], v[236:239], v[64:67], v[24:27]
    s_waitcnt lgkmcnt(1)
    s_barrier
    v_mfma_f32_16x16x32_bf16 v[0:3], v[192:195], v[104:107], v[0:3]
    ds_read_b128 v[28:31], v154 offset:0
    v_mfma_f32_16x16x32_bf16 v[0:3], v[196:199], v[108:111], v[0:3]
    ds_read_b128 v[16:19], v154 offset:1024
    v_mfma_f32_16x16x32_bf16 v[0:3], v[200:203], v[120:123], v[0:3]
    ds_read_b128 v[52:55], v154 offset:2048
    v_mfma_f32_16x16x32_bf16 v[0:3], v[204:207], v[80:83], v[0:3]
    ds_read_b128 v[4:7], v154 offset:3072
    ds_write_b128 v165, v[24:27] offset:11264
    v_mfma_f32_16x16x32_bf16 v[0:3], v[240:243], v[116:119], v[0:3]
    ds_read_b128 v[40:43], v154 offset:4096
    v_mfma_f32_16x16x32_bf16 v[0:3], v[244:247], v[64:67], v[0:3]
    ds_read_b128 v[32:35], v154 offset:5120
    v_mfma_f32_16x16x32_bf16 v[12:15], v[208:211], v[104:107], v[12:15]
    ds_read_b128 v[20:23], v154 offset:6144
    s_waitcnt lgkmcnt(7)
    v_add_f32 v132, v132, v28
    v_add_f32 v133, v133, v29
    v_mfma_f32_16x16x32_bf16 v[12:15], v[212:215], v[108:111], v[12:15]
    ds_read_b128 v[56:59], v154 offset:7168
    v_add_f32 v134, v134, v30
    v_add_f32 v135, v135, v31
    v_mfma_f32_16x16x32_bf16 v[12:15], v[216:219], v[120:123], v[12:15]
    ds_read_b128 v[8:11], v154 offset:8192
    s_waitcnt lgkmcnt(8)
    v_add_f32 v136, v136, v16
    v_add_f32 v137, v137, v17
    v_mfma_f32_16x16x32_bf16 v[12:15], v[220:223], v[80:83], v[12:15]
    ds_read_b128 v[44:47], v154 offset:9216
    ds_write_b128 v165, v[0:3] offset:12288
    v_add_f32 v138, v138, v18
    v_add_f32 v139, v139, v19
    v_mfma_f32_16x16x32_bf16 v[12:15], v[248:251], v[116:119], v[12:15]
    s_waitcnt lgkmcnt(9)
    v_add_f32 v140, v140, v52
    v_add_f32 v141, v141, v53
    v_mfma_f32_16x16x32_bf16 v[12:15], v[252:255], v[64:67], v[12:15]
    s_waitcnt vmcnt(0)
    v_add_f32 v142, v142, v54
    v_add_f32 v143, v143, v55
    v_bitop3_b32 v169, v60, v62, v68 bitop3:254
    v_mfma_f32_16x16x32_bf16 v[48:51], a[216:219], v[104:107], v[48:51]
    s_waitcnt lgkmcnt(8)
    v_add_f32 v144, v144, v4
    v_add_f32 v145, v145, v5
    v_bitop3_b32 v169, v169, v70, v72 bitop3:254
    v_mfma_f32_16x16x32_bf16 v[48:51], a[220:223], v[108:111], v[48:51]
    v_add_f32 v146, v146, v6
    v_add_f32 v147, v147, v7
    v_bitop3_b32 v169, v169, v74, 1 bitop3:168
    v_mfma_f32_16x16x32_bf16 v[48:51], a[224:227], v[120:123], v[48:51]
    s_waitcnt lgkmcnt(6)
    v_add_f32 v148, v148, v40
    v_add_f32 v149, v149, v41
    v_cmp_ne_u32 vcc, 0, v169
    v_mfma_f32_16x16x32_bf16 v[48:51], a[228:231], v[80:83], v[48:51]
    ds_write_b128 v165, v[12:15] offset:13312
    v_add_f32 v150, v150, v42
    v_add_f32 v151, v151, v43
    v_mfma_f32_16x16x32_bf16 v[48:51], a[248:251], v[116:119], v[48:51]
    v_mfma_f32_16x16x32_bf16 v[48:51], a[252:255], v[64:67], v[48:51]
    s_cbranch_vccnz Lh1c8r
Lh1c8:
    s_waitcnt lgkmcnt(6)
    v_mfma_f32_16x16x32_bf16 v[32:35], a[244:247], v[60:63], v[32:35]
    v_mfma_f32_16x16x32_bf16 v[32:35], v[224:227], v[68:71], v[32:35]
    v_mfma_f32_16x16x32_bf16 v[32:35], v[228:231], v[72:75], v[32:35]
    s_waitcnt lgkmcnt(5)
    v_mfma_f32_16x16x32_bf16 v[20:23], v[188:191], v[60:63], v[20:23]
    s_nop 0
    ds_write_b128 v165, v[48:51] offset:14336
    v_mfma_f32_16x16x32_bf16 v[20:23], v[232:235], v[68:71], v[20:23]
    v_mfma_f32_16x16x32_bf16 v[20:23], v[236:239], v[72:75], v[20:23]
    s_waitcnt lgkmcnt(5)
    v_mfma_f32_16x16x32_bf16 v[56:59], v[204:207], v[60:63], v[56:59]
    v_mfma_f32_16x16x32_bf16 v[56:59], v[240:243], v[68:71], v[56:59]
    v_mfma_f32_16x16x32_bf16 v[56:59], v[244:247], v[72:75], v[56:59]
    s_waitcnt lgkmcnt(0)
    s_barrier
    v_mfma_f32_16x16x32_bf16 v[8:11], v[220:223], v[60:63], v[8:11]
    ds_read_b128 v[28:31], v154 offset:10240
    v_mfma_f32_16x16x32_bf16 v[8:11], v[248:251], v[68:71], v[8:11]
    ds_read_b128 v[16:19], v154 offset:11264
    v_mfma_f32_16x16x32_bf16 v[8:11], v[252:255], v[72:75], v[8:11]
    ds_read_b128 v[52:55], v154 offset:12288
    v_mfma_f32_16x16x32_bf16 v[44:47], a[228:231], v[60:63], v[44:47]
    ds_read_b128 v[4:7], v154 offset:13312
    v_mfma_f32_16x16x32_bf16 v[44:47], a[248:251], v[68:71], v[44:47]
    ds_read_b128 v[40:43], v154 offset:14336
    v_mfma_f32_16x16x32_bf16 v[44:47], a[252:255], v[72:75], v[44:47]
    v_pk_add_f32 v[132:133], v[132:133], v[32:33]
    v_pk_add_f32 v[134:135], v[134:135], v[34:35]
    v_pk_add_f32 v[136:137], v[136:137], v[20:21]
    v_pk_add_f32 v[138:139], v[138:139], v[22:23]
    v_pk_add_f32 v[140:141], v[140:141], v[56:57]
    v_pk_add_f32 v[142:143], v[142:143], v[58:59]
    v_pk_add_f32 v[144:145], v[144:145], v[8:9]
    v_pk_add_f32 v[146:147], v[146:147], v[10:11]
    v_pk_add_f32 v[148:149], v[148:149], v[44:45]
    v_pk_add_f32 v[150:151], v[150:151], v[46:47]
    s_waitcnt lgkmcnt(4)
    v_pk_add_f32 v[132:133], v[132:133], v[28:29]
    v_pk_add_f32 v[134:135], v[134:135], v[30:31]
    s_waitcnt lgkmcnt(3)
    v_pk_add_f32 v[136:137], v[136:137], v[16:17]
    v_pk_add_f32 v[138:139], v[138:139], v[18:19]
    s_waitcnt lgkmcnt(2)
    v_pk_add_f32 v[140:141], v[140:141], v[52:53]
    v_pk_add_f32 v[142:143], v[142:143], v[54:55]
    s_waitcnt lgkmcnt(1)
    v_pk_add_f32 v[144:145], v[144:145], v[4:5]
    v_pk_add_f32 v[146:147], v[146:147], v[6:7]
    s_waitcnt lgkmcnt(0)
    v_pk_add_f32 v[148:149], v[148:149], v[40:41]
    v_pk_add_f32 v[150:151], v[150:151], v[42:43]
    v_pk_add_f32 v[4:5], v[132:133], v[134:135]
    v_pk_mul_f32 v[6:7], v[132:133], v[132:133]
    v_pk_fma_f32 v[6:7], v[134:135], v[134:135], v[6:7]
    v_pk_fma_f32 v[6:7], v[136:137], v[136:137], v[6:7]
    v_pk_add_f32 v[4:5], v[4:5], v[136:137]
    v_pk_fma_f32 v[6:7], v[138:139], v[138:139], v[6:7]
    v_pk_add_f32 v[4:5], v[4:5], v[138:139]
    v_pk_fma_f32 v[6:7], v[140:141], v[140:141], v[6:7]
    v_pk_add_f32 v[4:5], v[4:5], v[140:141]
    v_pk_fma_f32 v[6:7], v[142:143], v[142:143], v[6:7]
    v_pk_add_f32 v[4:5], v[4:5], v[142:143]
    v_pk_fma_f32 v[6:7], v[144:145], v[144:145], v[6:7]
    v_pk_add_f32 v[4:5], v[4:5], v[144:145]
    v_pk_fma_f32 v[6:7], v[146:147], v[146:147], v[6:7]
    v_pk_add_f32 v[4:5], v[4:5], v[146:147]
    v_pk_fma_f32 v[6:7], v[148:149], v[148:149], v[6:7]
    v_pk_add_f32 v[4:5], v[4:5], v[148:149]
    v_pk_fma_f32 v[6:7], v[150:151], v[150:151], v[6:7]
    v_pk_add_f32 v[4:5], v[4:5], v[150:151]
    v_add_f32 v6, v6, v7
    v_add_f32 v4, v4, v5
    v_mov_b32 v1, s82
    s_nop 0
    v_permlane32_swap_b32 v4, v6
    v_add_f32 v4, v4, v6
    v_mov_b32 v6, v4
    s_nop 1
    v_permlane16_swap_b32 v4, v6
    v_add_f32 v0, v4, v6

    s_cmp_eq_u32 s88, 0
    s_cbranch_scc1 Lss_11
    global_store_dwordx2 v155, v[0:1], s[98:99]
Lsd_12:
    ds_write_b128 v124, v[132:135] offset:0
    v_accvgpr_read_b32 v84, a0
    v_accvgpr_read_b32 v85, a1
    ds_write_b128 v125, v[136:139] offset:0
    v_accvgpr_read_b32 v88, a4
    v_accvgpr_read_b32 v89, a5
    ds_write_b128 v124, v[140:143] offset:128
    v_accvgpr_read_b32 v92, a8
    v_accvgpr_read_b32 v93, a9
    ds_write_b128 v125, v[144:147] offset:128
    v_accvgpr_read_b32 v96, a12
    v_accvgpr_read_b32 v97, a13
    ds_write_b128 v126, v[148:151] offset:256
    v_accvgpr_read_b32 v100, a16
    v_accvgpr_read_b32 v101, a17
    ds_read_b128 v[20:23], v127 offset:0
    ds_read_b128 v[24:27], v127 offset:64
    ds_read_b128 v[28:31], v127 offset:128
    ds_read_b128 v[32:35], v127 offset:192
    ds_read_b128 v[36:39], v127 offset:256
    v_accvgpr_read_b32 v86, a2
    v_accvgpr_read_b32 v87, a3
    v_accvgpr_read_b32 v90, a6
    v_accvgpr_read_b32 v91, a7
    v_accvgpr_read_b32 v94, a10
    v_accvgpr_read_b32 v95, a11
    v_accvgpr_read_b32 v98, a14
    v_accvgpr_read_b32 v99, a15
    v_accvgpr_read_b32 v102, a18
    v_accvgpr_read_b32 v103, a19
    global_load_dwordx4 v[0:3], v163, s[98:99] sc1
    global_load_dwordx4 v[4:7], v163, s[98:99] offset:256 sc1
    s_waitcnt lgkmcnt(4)
    v_pk_add_f32 v[60:61], v[20:21], v[128:129] op_sel_hi:[1,0]
    v_pk_add_f32 v[62:63], v[22:23], v[128:129] op_sel_hi:[1,0]
    s_waitcnt lgkmcnt(3)
    v_pk_add_f32 v[64:65], v[24:25], v[128:129] op_sel_hi:[1,0]
    v_pk_add_f32 v[66:67], v[26:27], v[128:129] op_sel_hi:[1,0]
    s_waitcnt lgkmcnt(2)
    v_pk_add_f32 v[68:69], v[28:29], v[128:129] op_sel_hi:[1,0]
    v_pk_add_f32 v[70:71], v[30:31], v[128:129] op_sel_hi:[1,0]
    s_waitcnt lgkmcnt(1)
    v_pk_add_f32 v[72:73], v[32:33], v[128:129] op_sel_hi:[1,0]
    v_pk_add_f32 v[74:75], v[34:35], v[128:129] op_sel_hi:[1,0]
    s_waitcnt lgkmcnt(0)
    v_pk_add_f32 v[76:77], v[36:37], v[128:129] op_sel_hi:[1,0]
    v_pk_add_f32 v[78:79], v[38:39], v[128:129] op_sel_hi:[1,0]
    s_waitcnt vmcnt(0)
    L_s3:
    v_min3_u32 v168, v1, v3, v5
    v_max3_u32 v1, v1, v3, v5
    v_min3_u32 v168, v168, v7, s82
    v_max3_u32 v1, v1, v7, s82
    v_cmp_ne_u32 vcc, v168, v1

    s_cbranch_vccz L_s3r
    s_sub_u32 s101, s101, 1
    s_cbranch_scc1 L_end
    global_load_dwordx4 v[0:3], v163, s[98:99] sc1
    global_load_dwordx4 v[4:7], v163, s[98:99] offset:256 sc1
    s_waitcnt vmcnt(0)
    s_branch L_s3
L_s3r:
    v_add_f32 v0, v0, v4
    v_add_f32 v2, v2, v6
    s_nop 0
    v_add_f32_dpp v0, v0, v0 row_ror:4 row_mask:0xf bank_mask:0xf
    v_add_f32_dpp v2, v2, v2 row_ror:4 row_mask:0xf bank_mask:0xf
    s_nop 0
    v_add_f32_dpp v0, v0, v0 row_ror:8 row_mask:0xf bank_mask:0xf
    v_add_f32_dpp v2, v2, v2 row_ror:8 row_mask:0xf bank_mask:0xf
    s_nop 0
    v_mov_b32_dpp v4, v0 quad_perm:[0,0,0,0] row_mask:0xf bank_mask:1
    v_mov_b32_dpp v6, v2 quad_perm:[0,0,0,0] row_mask:0xf bank_mask:1
    s_nop 0
    v_mov_b32_dpp v4, v0 quad_perm:[1,1,1,1] row_mask:0xf bank_mask:2
    v_mov_b32_dpp v6, v2 quad_perm:[1,1,1,1] row_mask:0xf bank_mask:2
    s_nop 0
    v_mov_b32_dpp v4, v0 quad_perm:[2,2,2,2] row_mask:0xf bank_mask:4
    v_mov_b32_dpp v6, v2 quad_perm:[2,2,2,2] row_mask:0xf bank_mask:4
    s_nop 0
    v_mov_b32_dpp v4, v0 quad_perm:[3,3,3,3] row_mask:0xf bank_mask:8
    v_mov_b32_dpp v6, v2 quad_perm:[3,3,3,3] row_mask:0xf bank_mask:8
    v_mul_f32 v4, 0x3acccccd, v4
    v_mov_b32 v166, 0x3727c5ac
    v_fmac_f32 v166, 0x3acccccd, v6
    v_fma_f32 v166, -v4, v4, v166
    v_max_f32 v166, 0x3727c5ac, v166
    v_rsq_f32 v166, v166
    s_nop 0
    v_mul_f32_e64 v167, -v4, v166
    v_pk_fma_f32 v[20:21], v[20:21], v[166:167], v[166:167] op_sel:[0,0,1] op_sel_hi:[1,0,1]
    v_pk_fma_f32 v[22:23], v[22:23], v[166:167], v[166:167] op_sel:[0,0,1] op_sel_hi:[1,0,1]
    v_pk_fma_f32 v[60:61], v[20:21], v[84:85], v[60:61]
    v_pk_fma_f32 v[62:63], v[22:23], v[86:87], v[62:63]
    global_store_dwordx4 v131, v[60:63], s[46:47] offset:0
    v_pk_fma_f32 v[24:25], v[24:25], v[166:167], v[166:167] op_sel:[0,0,1] op_sel_hi:[1,0,1]
    v_pk_fma_f32 v[26:27], v[26:27], v[166:167], v[166:167] op_sel:[0,0,1] op_sel_hi:[1,0,1]
    v_pk_fma_f32 v[64:65], v[24:25], v[88:89], v[64:65]
    v_pk_fma_f32 v[66:67], v[26:27], v[90:91], v[66:67]
    global_store_dwordx4 v131, v[64:67], s[46:47] offset:64
    v_pk_fma_f32 v[28:29], v[28:29], v[166:167], v[166:167] op_sel:[0,0,1] op_sel_hi:[1,0,1]
    v_pk_fma_f32 v[30:31], v[30:31], v[166:167], v[166:167] op_sel:[0,0,1] op_sel_hi:[1,0,1]
    v_pk_fma_f32 v[68:69], v[28:29], v[92:93], v[68:69]
    v_pk_fma_f32 v[70:71], v[30:31], v[94:95], v[70:71]
    global_store_dwordx4 v131, v[68:71], s[46:47] offset:128
    v_pk_fma_f32 v[32:33], v[32:33], v[166:167], v[166:167] op_sel:[0,0,1] op_sel_hi:[1,0,1]
    v_pk_fma_f32 v[34:35], v[34:35], v[166:167], v[166:167] op_sel:[0,0,1] op_sel_hi:[1,0,1]
    v_pk_fma_f32 v[72:73], v[32:33], v[96:97], v[72:73]
    v_pk_fma_f32 v[74:75], v[34:35], v[98:99], v[74:75]
    global_store_dwordx4 v131, v[72:75], s[46:47] offset:192
    v_pk_fma_f32 v[36:37], v[36:37], v[166:167], v[166:167] op_sel:[0,0,1] op_sel_hi:[1,0,1]
    v_pk_fma_f32 v[38:39], v[38:39], v[166:167], v[166:167] op_sel:[0,0,1] op_sel_hi:[1,0,1]
    v_pk_fma_f32 v[76:77], v[36:37], v[100:101], v[76:77]
    v_pk_fma_f32 v[78:79], v[38:39], v[102:103], v[78:79]
    global_store_dwordx4 v131, v[76:79], s[46:47] offset:256
L_end:
    s_endpgm
L_nonce_re:
    s_sub_u32 s101, s101, 1
    s_cbranch_scc1 L_end
    global_load_dword v224, v224, s[48:49] sc1
    s_waitcnt vmcnt(0)
    s_branch L_nonce
L_kf_re:
    s_sub_u32 s101, s101, 1
    s_cbranch_scc1 L_end
    global_load_dword v224, v169, s[50:51] sc1
    global_load_dwordx2 v[170:171], v168, s[50:51] sc1
    s_waitcnt vmcnt(0)
    s_branch L_kf
L_cre0:
    s_sub_u32 s101, s101, 1
    s_cbranch_scc1 L_end
    buffer_load_dwordx4 v[244:247], v253, s[92:95], 0 offen offset:2048 sc1
    buffer_load_dwordx4 v[240:243], v253, s[92:95], 0 offen offset:1792 sc1
    buffer_load_dwordx4 v[236:239], v253, s[92:95], 0 offen offset:1536 sc1
    buffer_load_dwordx4 v[232:235], v253, s[92:95], 0 offen offset:1280 sc1
    buffer_load_dwordx4 v[228:231], v253, s[92:95], 0 offen offset:1024 sc1
    buffer_load_dwordx4 v[224:227], v253, s[92:95], 0 offen offset:768 sc1
    buffer_load_dwordx4 v[220:223], v253, s[92:95], 0 offen offset:512 sc1
    buffer_load_dwordx4 v[216:219], v253, s[92:95], 0 offen offset:256 sc1
    s_waitcnt vmcnt(0)
    s_branch L_cchk0
L_p2s0:
    v_fmac_f32_dpp v208, -v252, v21 row_ror:8 row_mask:0xf bank_mask:0xf
    v_fmac_f32 v208, v20, v252
    v_pk_fma_f32 v[176:177], v[248:249], v[18:19], v[176:177] op_sel_hi:[1,0,1]
    v_pk_fma_f32 v[192:193], v[250:251], v[18:19], v[192:193] op_sel_hi:[1,0,1]
    v_fmac_f32_dpp v209, -v208, v21 row_ror:8 row_mask:0xf bank_mask:0xf
    v_fmac_f32 v209, v20, v208
    v_pk_fma_f32 v[176:177], v[250:251], v[18:19], v[176:177] op_sel:[0,1,0] neg_lo:[1,0,0] neg_hi:[1,0,0]
    v_pk_fma_f32 v[192:193], v[248:249], v[18:19], v[192:193] op_sel:[0,1,0]
    v_fmac_f32_dpp v210, -v209, v21 row_ror:8 row_mask:0xf bank_mask:0xf
    v_fmac_f32 v210, v20, v209
    v_pk_fma_f32 v[178:179], v[176:177], v[18:19], v[178:179] op_sel_hi:[1,0,1]
    v_pk_fma_f32 v[194:195], v[192:193], v[18:19], v[194:195] op_sel_hi:[1,0,1]
    v_fmac_f32_dpp v211, -v210, v21 row_ror:8 row_mask:0xf bank_mask:0xf
    v_fmac_f32 v211, v20, v210
    v_pk_fma_f32 v[178:179], v[192:193], v[18:19], v[178:179] op_sel:[0,1,0] neg_lo:[1,0,0] neg_hi:[1,0,0]
    v_pk_fma_f32 v[194:195], v[176:177], v[18:19], v[194:195] op_sel:[0,1,0]
    v_cvt_pk_bf16_f32 v232, v176, v177
    v_cvt_pk_bf16_f32 v233, v178, v179
    v_cvt_pk_bf16_f32 v234, -v192, -v193
    v_cvt_pk_bf16_f32 v235, -v194, -v195

    ds_write_b128 v22, v[232:235] offset:0
    ds_read_b64_tr_b16 v[216:217], v24 offset:0
    ds_read_b64_tr_b16 v[218:219], v25 offset:0
    v_fmac_f32_dpp v212, -v211, v21 row_ror:8 row_mask:0xf bank_mask:0xf
    v_fmac_f32 v212, v20, v211
    v_pk_fma_f32 v[180:181], v[178:179], v[18:19], v[180:181] op_sel_hi:[1,0,1]
    v_pk_fma_f32 v[196:197], v[194:195], v[18:19], v[196:197] op_sel_hi:[1,0,1]
    v_fmac_f32_dpp v213, -v212, v21 row_ror:8 row_mask:0xf bank_mask:0xf
    v_fmac_f32 v213, v20, v212
    v_pk_fma_f32 v[180:181], v[194:195], v[18:19], v[180:181] op_sel:[0,1,0] neg_lo:[1,0,0] neg_hi:[1,0,0]
    v_pk_fma_f32 v[196:197], v[178:179], v[18:19], v[196:197] op_sel:[0,1,0]
    v_fmac_f32_dpp v214, -v213, v21 row_ror:8 row_mask:0xf bank_mask:0xf
    v_fmac_f32 v214, v20, v213
    v_pk_fma_f32 v[182:183], v[180:181], v[18:19], v[182:183] op_sel_hi:[1,0,1]
    v_pk_fma_f32 v[198:199], v[196:197], v[18:19], v[198:199] op_sel_hi:[1,0,1]
    v_fmac_f32_dpp v215, -v214, v21 row_ror:8 row_mask:0xf bank_mask:0xf
    v_fmac_f32 v215, v20, v214
    v_pk_fma_f32 v[182:183], v[196:197], v[18:19], v[182:183] op_sel:[0,1,0] neg_lo:[1,0,0] neg_hi:[1,0,0]
    v_pk_fma_f32 v[198:199], v[180:181], v[18:19], v[198:199] op_sel:[0,1,0]
    v_cvt_pk_bf16_f32 v236, v180, v181
    v_cvt_pk_bf16_f32 v237, v182, v183
    v_cvt_pk_bf16_f32 v238, -v196, -v197
    v_cvt_pk_bf16_f32 v239, -v198, -v199

    ds_write_b128 v22, v[236:239] offset:1024
    ds_read_b64_tr_b16 v[220:221], v24 offset:1024
    ds_read_b64_tr_b16 v[222:223], v25 offset:1024
    v_pk_fma_f32 v[184:185], v[182:183], v[18:19], v[184:185] op_sel_hi:[1,0,1]
    v_pk_fma_f32 v[200:201], v[198:199], v[18:19], v[200:201] op_sel_hi:[1,0,1]
    v_pk_fma_f32 v[184:185], v[198:199], v[18:19], v[184:185] op_sel:[0,1,0] neg_lo:[1,0,0] neg_hi:[1,0,0]
    v_pk_fma_f32 v[200:201], v[182:183], v[18:19], v[200:201] op_sel:[0,1,0]
    v_cvt_pk_bf16_f32 v240, v208, v209
    v_cvt_pk_bf16_f32 v241, v210, v211
    v_cvt_pk_bf16_f32 v242, v212, v213
    v_cvt_pk_bf16_f32 v243, v214, v215
    ds_write2st64_b32 v26, v240, v241 offset0:0 offset1:1
    ds_write2st64_b32 v26, v242, v243 offset0:2 offset1:3
    ds_read_b64_tr_b16 v[244:245], v27 offset:0
    ds_read_b64_tr_b16 v[246:247], v27 offset:128
    v_pk_fma_f32 v[186:187], v[184:185], v[18:19], v[186:187] op_sel_hi:[1,0,1]
    v_pk_fma_f32 v[202:203], v[200:201], v[18:19], v[202:203] op_sel_hi:[1,0,1]
    v_pk_fma_f32 v[186:187], v[200:201], v[18:19], v[186:187] op_sel:[0,1,0] neg_lo:[1,0,0] neg_hi:[1,0,0]
    v_pk_fma_f32 v[202:203], v[184:185], v[18:19], v[202:203] op_sel:[0,1,0]
    v_cvt_pk_bf16_f32 v232, v184, v185
    v_cvt_pk_bf16_f32 v233, v186, v187
    v_cvt_pk_bf16_f32 v234, -v200, -v201
    v_cvt_pk_bf16_f32 v235, -v202, -v203

    ds_write_b128 v22, v[232:235] offset:0
    ds_read_b64_tr_b16 v[224:225], v24 offset:0
    ds_read_b64_tr_b16 v[226:227], v25 offset:0
    s_waitcnt lgkmcnt(10)
    v_and_b32 v216, -2, v216
    v_and_b32 v218, -2, v218
    buffer_store_dwordx4 v[216:219], v153, s[64:67], s36 offen sc1
    v_pk_fma_f32 v[188:189], v[186:187], v[18:19], v[188:189] op_sel_hi:[1,0,1]
    v_pk_fma_f32 v[204:205], v[202:203], v[18:19], v[204:205] op_sel_hi:[1,0,1]
    v_pk_fma_f32 v[188:189], v[202:203], v[18:19], v[188:189] op_sel:[0,1,0] neg_lo:[1,0,0] neg_hi:[1,0,0]
    v_pk_fma_f32 v[204:205], v[186:187], v[18:19], v[204:205] op_sel:[0,1,0]
    v_pk_fma_f32 v[190:191], v[188:189], v[18:19], v[190:191] op_sel_hi:[1,0,1]
    v_pk_fma_f32 v[206:207], v[204:205], v[18:19], v[206:207] op_sel_hi:[1,0,1]
    v_pk_fma_f32 v[190:191], v[204:205], v[18:19], v[190:191] op_sel:[0,1,0] neg_lo:[1,0,0] neg_hi:[1,0,0]
    v_pk_fma_f32 v[206:207], v[188:189], v[18:19], v[206:207] op_sel:[0,1,0]
    v_cvt_pk_bf16_f32 v236, v188, v189
    v_cvt_pk_bf16_f32 v237, v190, v191
    v_cvt_pk_bf16_f32 v238, -v204, -v205
    v_cvt_pk_bf16_f32 v239, -v206, -v207

    ds_write_b128 v22, v[236:239] offset:1024
    ds_read_b64_tr_b16 v[228:229], v24 offset:1024
    ds_read_b64_tr_b16 v[230:231], v25 offset:1024
    s_waitcnt lgkmcnt(10)
    v_and_b32 v220, -2, v220
    v_and_b32 v222, -2, v222
    buffer_store_dwordx4 v[220:223], v153, s[64:67], s18 offen sc1
    s_waitcnt lgkmcnt(6)
    v_and_or_b32 v244, v244, -2, v23
    v_and_or_b32 v246, v246, -2, v23
    buffer_store_dwordx2 v[244:245], v28, s[64:67], s37 offen offset:0 sc1
    buffer_store_dwordx2 v[246:247], v28, s[64:67], s37 offen offset:512 sc1
    s_waitcnt lgkmcnt(3)
    v_or_b32 v224, 1, v224
    v_or_b32 v226, 1, v226
    buffer_store_dwordx4 v[224:227], v153, s[64:67], s19 offen sc1
    s_waitcnt lgkmcnt(0)
    v_or_b32 v228, 1, v228
    v_or_b32 v230, 1, v230
    buffer_store_dwordx4 v[228:231], v153, s[64:67], s20 offen sc1
    s_branch L_p2e0
Lss_1:
    global_store_dword v169, v173, s[50:51] sc1
    s_branch Lsd_2
L_fh_re0:
    s_sub_u32 s101, s101, 1
    s_cbranch_scc1 L_end
    global_load_dword v169, v173, s[50:51] sc1
    s_waitcnt vmcnt(0)
    s_branch L_fh0
L_fh_re1:
    s_sub_u32 s101, s101, 1
    s_cbranch_scc1 L_end
    global_load_dword v169, v173, s[50:51] sc1
    s_waitcnt vmcnt(0)
    s_branch L_fh1
Lss_3:
    global_store_dwordx2 v155, v[0:1], s[98:99] sc1
    s_branch Lsd_4
L_gcr:
    s_sub_u32 s101, s101, 1
    s_cbranch_scc1 L_end
    s_add_u32 m0, s100, 61440
    s_nop 0
    buffer_load_dwordx4 v164, s[68:71], s6 offen sc1 lds
    s_add_u32 m0, s100, 62464
    s_add_u32 s83, s6, 32768
    buffer_load_dwordx4 v164, s[68:71], s83 offen sc1 lds
    s_add_u32 m0, s5, 69632
    s_mov_b32 exec_hi, 0
    buffer_load_dwordx4 v164, s[68:71], s7 offen sc1 lds
    s_mov_b32 exec_hi, -1
    s_waitcnt vmcnt(0)
    ds_read2st64_b32 v[8:9], v170 offset1:2
    ds_read2st64_b32 v[10:11], v170 offset0:4 offset1:6
    ds_read_b32 v12, v171
    s_waitcnt lgkmcnt(0)
    v_max3_u32 v169, v8, v9, v10
    v_max3_u32 v169, v169, v11, v12
    v_cmp_eq_u32 vcc, -1, v169
    s_cbranch_vccnz L_gcr
    s_branch L_gc
Lss_5:
    buffer_store_dwordx4 v[36:39], v153, s[64:67], s12 offen sc1
    buffer_store_dwordx4 v[40:43], v153, s[64:67], s12 offen offset:1024 sc1
    s_mov_b32 exec_lo, 0xffff
    s_mov_b32 exec_hi, 0xffff
    buffer_store_dwordx4 v[44:47], v84, s[64:67], s12 offen offset:2048 sc1
    s_branch Lsd_6
Lss_7:
    global_store_dwordx2 v155, v[0:1], s[98:99] sc1
    s_branch Lsd_8
L_xc0r:
    s_sub_u32 s101, s101, 1
    s_cbranch_scc1 L_end
    s_mov_b32 s97, m0
    s_lshl_b32 m0, s81, 13
    s_add_u32 m0, m0, 0
    s_add_u32 s96, s72, s85
    s_add_u32 s96, s96, 0
    buffer_load_dwordx4 v153, s[64:67], s96 offen offset:0 sc1 lds
    s_lshl_b32 m0, s81, 13
    s_add_u32 m0, m0, 2048
    s_add_u32 s96, s72, s85
    s_add_u32 s96, s96, 20480
    buffer_load_dwordx4 v153, s[64:67], s96 offen offset:0 sc1 lds
    s_lshl_b32 m0, s81, 13
    s_add_u32 m0, m0, 4096
    s_add_u32 s96, s72, s85
    s_add_u32 s96, s96, 40960
    buffer_load_dwordx4 v153, s[64:67], s96 offen offset:0 sc1 lds
    s_lshl_b32 m0, s81, 13
    s_add_u32 m0, m0, 6144
    s_add_u32 s96, s72, s85
    s_add_u32 s96, s96, 61440
    buffer_load_dwordx4 v153, s[64:67], s96 offen offset:0 sc1 lds
    s_mov_b32 m0, s97
    s_waitcnt vmcnt(0)
    v_and_b32 v169, 0x23ff, v158
    v_add_u32 v169, 0, v169
    ds_read_b128 v[56:59], v169 offset:0
    v_and_b32 v169, 0x23ff, v158
    v_add_u32 v169, 0, v169
    ds_read_b128 v[60:63], v169 offset:2048
    v_and_b32 v169, 0x23ff, v158
    v_add_u32 v169, 0, v169
    ds_read_b128 v[64:67], v169 offset:4096
    v_and_b32 v169, 0x23ff, v158
    v_add_u32 v169, 0, v169
    ds_read_b128 v[68:71], v169 offset:6144
    s_waitcnt lgkmcnt(0)
    v_bitop3_b32 v169, v56, v60, v64 bitop3:128
    v_bitop3_b32 v169, v169, v68, 1 bitop3:128
    v_cmp_ne_u32 vcc, 1, v169
    s_cbranch_vccnz L_xc0r
    s_branch L_xc0
L_xc1r:
    s_sub_u32 s101, s101, 1
    s_cbranch_scc1 L_end
    s_mov_b32 s97, m0
    s_lshl_b32 m0, s81, 13
    s_add_u32 m0, m0, 0
    s_add_u32 s96, s72, s85
    s_add_u32 s96, s96, 0
    buffer_load_dwordx4 v153, s[64:67], s96 offen offset:1024 sc1 lds
    s_lshl_b32 m0, s81, 13
    s_add_u32 m0, m0, 2048
    s_add_u32 s96, s72, s85
    s_add_u32 s96, s96, 20480
    buffer_load_dwordx4 v153, s[64:67], s96 offen offset:1024 sc1 lds
    s_lshl_b32 m0, s81, 13
    s_add_u32 m0, m0, 4096
    s_add_u32 s96, s72, s85
    s_add_u32 s96, s96, 40960
    buffer_load_dwordx4 v153, s[64:67], s96 offen offset:1024 sc1 lds
    s_lshl_b32 m0, s81, 13
    s_add_u32 m0, m0, 6144
    s_add_u32 s96, s72, s85
    s_add_u32 s96, s96, 61440
    buffer_load_dwordx4 v153, s[64:67], s96 offen offset:1024 sc1 lds
    s_mov_b32 m0, s97
    s_waitcnt vmcnt(0)
    v_and_b32 v169, 0x23ff, v158
    v_add_u32 v169, 0, v169
    ds_read_b128 v[72:75], v169 offset:1024
    v_and_b32 v169, 0x23ff, v158
    v_add_u32 v169, 0, v169
    ds_read_b128 v[76:79], v169 offset:3072
    v_and_b32 v169, 0x23ff, v158
    v_add_u32 v169, 0, v169
    ds_read_b128 v[80:83], v169 offset:5120
    v_and_b32 v169, 0x23ff, v158
    v_add_u32 v169, 0, v169
    ds_read_b128 v[84:87], v169 offset:7168
    s_waitcnt lgkmcnt(0)
    v_bitop3_b32 v169, v72, v76, v80 bitop3:128
    v_bitop3_b32 v169, v169, v84, 1 bitop3:128
    v_cmp_ne_u32 vcc, 1, v169
    s_cbranch_vccnz L_xc1r
    s_branch L_xc1
L_xc2r:
    s_sub_u32 s101, s101, 1
    s_cbranch_scc1 L_end
    s_mov_b32 s97, m0
    s_lshl_b32 m0, s81, 13
    s_xor_b32 m0, m0, 0x2000
    s_add_u32 m0, m0, 0
    s_add_u32 s96, s72, s90
    s_add_u32 s96, s96, 0
    buffer_load_dwordx4 v153, s[64:67], s96 offen offset:0 sc1 lds
    s_lshl_b32 m0, s81, 13
    s_xor_b32 m0, m0, 0x2000
    s_add_u32 m0, m0, 2048
    s_add_u32 s96, s72, s90
    s_add_u32 s96, s96, 20480
    buffer_load_dwordx4 v153, s[64:67], s96 offen offset:0 sc1 lds
    s_lshl_b32 m0, s81, 13
    s_xor_b32 m0, m0, 0x2000
    s_add_u32 m0, m0, 4096
    s_add_u32 s96, s72, s90
    s_add_u32 s96, s96, 40960
    buffer_load_dwordx4 v153, s[64:67], s96 offen offset:0 sc1 lds
    s_lshl_b32 m0, s81, 13
    s_xor_b32 m0, m0, 0x2000
    s_add_u32 m0, m0, 6144
    s_add_u32 s96, s72, s90
    s_add_u32 s96, s96, 61440
    buffer_load_dwordx4 v153, s[64:67], s96 offen offset:0 sc1 lds
    s_mov_b32 m0, s97
    s_waitcnt vmcnt(0)
    v_and_b32 v169, 0x23ff, v159
    v_add_u32 v169, 0, v169
    ds_read_b128 v[88:91], v169 offset:0
    v_and_b32 v169, 0x23ff, v159
    v_add_u32 v169, 0, v169
    ds_read_b128 v[92:95], v169 offset:2048
    v_and_b32 v169, 0x23ff, v159
    v_add_u32 v169, 0, v169
    ds_read_b128 v[96:99], v169 offset:4096
    v_and_b32 v169, 0x23ff, v159
    v_add_u32 v169, 0, v169
    ds_read_b128 v[100:103], v169 offset:6144
    s_waitcnt lgkmcnt(0)
    v_bitop3_b32 v169, v88, v92, v96 bitop3:128
    v_bitop3_b32 v169, v169, v100, 1 bitop3:128
    v_cmp_ne_u32 vcc, 1, v169
    s_cbranch_vccnz L_xc2r
    s_branch L_xc2
L_xc3r:
    s_sub_u32 s101, s101, 1
    s_cbranch_scc1 L_end
    s_mov_b32 s97, m0
    s_lshl_b32 m0, s81, 13
    s_xor_b32 m0, m0, 0x2000
    s_add_u32 m0, m0, 0
    s_add_u32 s96, s72, s90
    s_add_u32 s96, s96, 0
    buffer_load_dwordx4 v153, s[64:67], s96 offen offset:1024 sc1 lds
    s_lshl_b32 m0, s81, 13
    s_xor_b32 m0, m0, 0x2000
    s_add_u32 m0, m0, 2048
    s_add_u32 s96, s72, s90
    s_add_u32 s96, s96, 20480
    buffer_load_dwordx4 v153, s[64:67], s96 offen offset:1024 sc1 lds
    s_lshl_b32 m0, s81, 13
    s_xor_b32 m0, m0, 0x2000
    s_add_u32 m0, m0, 4096
    s_add_u32 s96, s72, s90
    s_add_u32 s96, s96, 40960
    buffer_load_dwordx4 v153, s[64:67], s96 offen offset:1024 sc1 lds
    s_lshl_b32 m0, s81, 13
    s_xor_b32 m0, m0, 0x2000
    s_add_u32 m0, m0, 6144
    s_add_u32 s96, s72, s90
    s_add_u32 s96, s96, 61440
    buffer_load_dwordx4 v153, s[64:67], s96 offen offset:1024 sc1 lds
    s_mov_b32 m0, s97
    s_waitcnt vmcnt(0)
    v_and_b32 v169, 0x23ff, v159
    v_add_u32 v169, 0, v169
    ds_read_b128 v[56:59], v169 offset:1024
    v_and_b32 v169, 0x23ff, v159
    v_add_u32 v169, 0, v169
    ds_read_b128 v[60:63], v169 offset:3072
    v_and_b32 v169, 0x23ff, v159
    v_add_u32 v169, 0, v169
    ds_read_b128 v[64:67], v169 offset:5120
    v_and_b32 v169, 0x23ff, v159
    v_add_u32 v169, 0, v169
    ds_read_b128 v[68:71], v169 offset:7168
    s_waitcnt lgkmcnt(0)
    v_bitop3_b32 v169, v56, v60, v64 bitop3:128
    v_bitop3_b32 v169, v169, v68, 1 bitop3:128
    v_cmp_ne_u32 vcc, 1, v169
    s_cbranch_vccnz L_xc3r
    s_branch L_xc3
L_xc4r:
    s_sub_u32 s101, s101, 1
    s_cbranch_scc1 L_end
    s_mov_b32 s97, m0
    s_lshl_b32 m0, s81, 13
    s_add_u32 m0, m0, 16384
    s_add_u32 s96, s73, s85
    s_add_u32 s96, s96, 0
    buffer_load_dwordx4 v153, s[64:67], s96 offen offset:0 sc1 lds
    s_lshl_b32 m0, s81, 13
    s_add_u32 m0, m0, 20480
    s_add_u32 s96, s73, s85
    s_add_u32 s96, s96, 40960
    buffer_load_dwordx4 v153, s[64:67], s96 offen offset:0 sc1 lds
    s_lshl_b32 m0, s81, 13
    s_add_u32 m0, m0, 18432
    s_add_u32 s96, s73, s85
    s_add_u32 s96, s96, 20480
    buffer_load_dwordx4 v153, s[64:67], s96 offen offset:0 sc1 lds
    s_lshl_b32 m0, s81, 13
    s_add_u32 m0, m0, 22528
    s_add_u32 s96, s73, s85
    s_add_u32 s96, s96, 61440
    buffer_load_dwordx4 v153, s[64:67], s96 offen offset:0 sc1 lds
    s_mov_b32 m0, s97
    s_waitcnt vmcnt(0)
    v_and_b32 v169, 0x23ff, v158
    v_add_u32 v169, 16384, v169
    ds_read_b128 v[72:75], v169 offset:0
    v_and_b32 v169, 0x23ff, v158
    v_add_u32 v169, 16384, v169
    ds_read_b128 v[76:79], v169 offset:4096
    v_and_b32 v169, 0x23ff, v158
    v_add_u32 v169, 16384, v169
    ds_read_b128 v[80:83], v169 offset:2048
    v_and_b32 v169, 0x23ff, v158
    v_add_u32 v169, 16384, v169
    ds_read_b128 v[84:87], v169 offset:6144
    s_waitcnt lgkmcnt(0)
    v_bitop3_b32 v169, v72, v76, v80 bitop3:128
    v_bitop3_b32 v169, v169, v84, 1 bitop3:128
    v_cmp_ne_u32 vcc, 1, v169
    s_cbranch_vccnz L_xc4r
    s_branch L_xc4
L_xc5r:
    s_sub_u32 s101, s101, 1
    s_cbranch_scc1 L_end
    s_mov_b32 s97, m0
    s_lshl_b32 m0, s81, 13
    s_add_u32 m0, m0, 16384
    s_add_u32 s96, s73, s85
    s_add_u32 s96, s96, 0
    buffer_load_dwordx4 v153, s[64:67], s96 offen offset:1024 sc1 lds
    s_lshl_b32 m0, s81, 13
    s_add_u32 m0, m0, 20480
    s_add_u32 s96, s73, s85
    s_add_u32 s96, s96, 40960
    buffer_load_dwordx4 v153, s[64:67], s96 offen offset:1024 sc1 lds
    s_lshl_b32 m0, s81, 13
    s_add_u32 m0, m0, 18432
    s_add_u32 s96, s73, s85
    s_add_u32 s96, s96, 20480
    buffer_load_dwordx4 v153, s[64:67], s96 offen offset:1024 sc1 lds
    s_lshl_b32 m0, s81, 13
    s_add_u32 m0, m0, 22528
    s_add_u32 s96, s73, s85
    s_add_u32 s96, s96, 61440
    buffer_load_dwordx4 v153, s[64:67], s96 offen offset:1024 sc1 lds
    s_mov_b32 m0, s97
    s_waitcnt vmcnt(0)
    v_and_b32 v169, 0x23ff, v158
    v_add_u32 v169, 16384, v169
    ds_read_b128 v[88:91], v169 offset:1024
    v_and_b32 v169, 0x23ff, v158
    v_add_u32 v169, 16384, v169
    ds_read_b128 v[92:95], v169 offset:5120
    v_and_b32 v169, 0x23ff, v158
    v_add_u32 v169, 16384, v169
    ds_read_b128 v[96:99], v169 offset:3072
    v_and_b32 v169, 0x23ff, v158
    v_add_u32 v169, 16384, v169
    ds_read_b128 v[100:103], v169 offset:7168
    s_waitcnt lgkmcnt(0)
    v_bitop3_b32 v169, v88, v92, v96 bitop3:128
    v_bitop3_b32 v169, v169, v100, 1 bitop3:128
    v_cmp_ne_u32 vcc, 1, v169
    s_cbranch_vccnz L_xc5r
    s_branch L_xc5
L_xc6r:
    s_sub_u32 s101, s101, 1
    s_cbranch_scc1 L_end
    s_mov_b32 s97, m0
    s_lshl_b32 m0, s81, 13
    s_add_u32 m0, m0, 32768
    s_add_u32 s96, s74, s85
    s_add_u32 s96, s96, 0
    buffer_load_dwordx4 v153, s[64:67], s96 offen offset:0 sc1 lds
    s_lshl_b32 m0, s81, 13
    s_add_u32 m0, m0, 36864
    s_add_u32 s96, s74, s85
    s_add_u32 s96, s96, 40960
    buffer_load_dwordx4 v153, s[64:67], s96 offen offset:0 sc1 lds
    s_lshl_b32 m0, s81, 13
    s_add_u32 m0, m0, 34816
    s_add_u32 s96, s74, s85
    s_add_u32 s96, s96, 20480
    buffer_load_dwordx4 v153, s[64:67], s96 offen offset:0 sc1 lds
    s_lshl_b32 m0, s81, 13
    s_add_u32 m0, m0, 38912
    s_add_u32 s96, s74, s85
    s_add_u32 s96, s96, 61440
    buffer_load_dwordx4 v153, s[64:67], s96 offen offset:0 sc1 lds
    s_mov_b32 m0, s97
    s_waitcnt vmcnt(0)
    v_and_b32 v169, 0x23ff, v158
    v_add_u32 v169, 32768, v169
    ds_read_b128 v[56:59], v169 offset:0
    v_and_b32 v169, 0x23ff, v158
    v_add_u32 v169, 32768, v169
    ds_read_b128 v[60:63], v169 offset:4096
    v_and_b32 v169, 0x23ff, v158
    v_add_u32 v169, 32768, v169
    ds_read_b128 v[64:67], v169 offset:2048
    v_and_b32 v169, 0x23ff, v158
    v_add_u32 v169, 32768, v169
    ds_read_b128 v[68:71], v169 offset:6144
    s_waitcnt lgkmcnt(0)
    v_bitop3_b32 v169, v56, v60, v64 bitop3:128
    v_bitop3_b32 v169, v169, v68, 1 bitop3:128
    v_cmp_ne_u32 vcc, 1, v169
    s_cbranch_vccnz L_xc6r
    s_branch L_xc6
L_s2r:
    s_sub_u32 s101, s101, 1
    s_cbranch_scc1 L_end
    global_load_dwordx4 v[104:107], v163, s[98:99] sc1
    global_load_dwordx4 v[108:111], v163, s[98:99] offset:256 sc1
    s_waitcnt vmcnt(0)
    s_branch L_s2
L_xc7r:
    s_sub_u32 s101, s101, 1
    s_cbranch_scc1 L_end
    s_mov_b32 s97, m0
    s_lshl_b32 m0, s81, 13
    s_add_u32 m0, m0, 32768
    s_add_u32 s96, s74, s85
    s_add_u32 s96, s96, 0
    buffer_load_dwordx4 v153, s[64:67], s96 offen offset:1024 sc1 lds
    s_lshl_b32 m0, s81, 13
    s_add_u32 m0, m0, 36864
    s_add_u32 s96, s74, s85
    s_add_u32 s96, s96, 40960
    buffer_load_dwordx4 v153, s[64:67], s96 offen offset:1024 sc1 lds
    s_lshl_b32 m0, s81, 13
    s_add_u32 m0, m0, 34816
    s_add_u32 s96, s74, s85
    s_add_u32 s96, s96, 20480
    buffer_load_dwordx4 v153, s[64:67], s96 offen offset:1024 sc1 lds
    s_lshl_b32 m0, s81, 13
    s_add_u32 m0, m0, 38912
    s_add_u32 s96, s74, s85
    s_add_u32 s96, s96, 61440
    buffer_load_dwordx4 v153, s[64:67], s96 offen offset:1024 sc1 lds
    s_mov_b32 m0, s97
    s_waitcnt vmcnt(0)
    v_and_b32 v169, 0x23ff, v158
    v_add_u32 v169, 32768, v169
    ds_read_b128 v[72:75], v169 offset:1024
    v_and_b32 v169, 0x23ff, v158
    v_add_u32 v169, 32768, v169
    ds_read_b128 v[76:79], v169 offset:5120
    v_and_b32 v169, 0x23ff, v158
    v_add_u32 v169, 32768, v169
    ds_read_b128 v[80:83], v169 offset:3072
    v_and_b32 v169, 0x23ff, v158
    v_add_u32 v169, 32768, v169
    ds_read_b128 v[84:87], v169 offset:7168
    s_waitcnt lgkmcnt(0)
    v_bitop3_b32 v169, v72, v76, v80 bitop3:128
    v_bitop3_b32 v169, v169, v84, 1 bitop3:128
    v_cmp_ne_u32 vcc, 1, v169
    s_cbranch_vccnz L_xc7r
    s_branch L_xc7
L_xc8r:
    s_sub_u32 s101, s101, 1
    s_cbranch_scc1 L_end
    s_mov_b32 s97, m0
    s_lshl_b32 m0, s81, 13
    s_add_u32 m0, m0, 49152
    s_add_u32 s96, s75, s85
    s_add_u32 s96, s96, 0
    buffer_load_dwordx4 v153, s[64:67], s96 offen offset:0 sc1 lds
    s_lshl_b32 m0, s81, 13
    s_add_u32 m0, m0, 53248
    s_add_u32 s96, s75, s85
    s_add_u32 s96, s96, 40960
    buffer_load_dwordx4 v153, s[64:67], s96 offen offset:0 sc1 lds
    s_lshl_b32 m0, s81, 13
    s_add_u32 m0, m0, 51200
    s_add_u32 s96, s75, s85
    s_add_u32 s96, s96, 20480
    buffer_load_dwordx4 v153, s[64:67], s96 offen offset:0 sc1 lds
    s_lshl_b32 m0, s81, 13
    s_add_u32 m0, m0, 55296
    s_add_u32 s96, s75, s85
    s_add_u32 s96, s96, 61440
    buffer_load_dwordx4 v153, s[64:67], s96 offen offset:0 sc1 lds
    s_mov_b32 m0, s97
    s_waitcnt vmcnt(0)
    v_and_b32 v169, 0x23ff, v158
    v_add_u32 v169, 49152, v169
    ds_read_b128 v[88:91], v169 offset:0
    v_and_b32 v169, 0x23ff, v158
    v_add_u32 v169, 49152, v169
    ds_read_b128 v[92:95], v169 offset:4096
    v_and_b32 v169, 0x23ff, v158
    v_add_u32 v169, 49152, v169
    ds_read_b128 v[96:99], v169 offset:2048
    v_and_b32 v169, 0x23ff, v158
    v_add_u32 v169, 49152, v169
    ds_read_b128 v[100:103], v169 offset:6144
    s_waitcnt lgkmcnt(0)
    v_bitop3_b32 v169, v88, v92, v96 bitop3:128
    v_bitop3_b32 v169, v169, v100, 1 bitop3:128
    v_cmp_ne_u32 vcc, 1, v169
    s_cbranch_vccnz L_xc8r
    s_branch L_xc8
L_xc9r:
    s_sub_u32 s101, s101, 1
    s_cbranch_scc1 L_end
    s_mov_b32 s97, m0
    s_lshl_b32 m0, s81, 13
    s_add_u32 m0, m0, 49152
    s_add_u32 s96, s75, s85
    s_add_u32 s96, s96, 0
    buffer_load_dwordx4 v153, s[64:67], s96 offen offset:1024 sc1 lds
    s_lshl_b32 m0, s81, 13
    s_add_u32 m0, m0, 53248
    s_add_u32 s96, s75, s85
    s_add_u32 s96, s96, 40960
    buffer_load_dwordx4 v153, s[64:67], s96 offen offset:1024 sc1 lds
    s_lshl_b32 m0, s81, 13
    s_add_u32 m0, m0, 51200
    s_add_u32 s96, s75, s85
    s_add_u32 s96, s96, 20480
    buffer_load_dwordx4 v153, s[64:67], s96 offen offset:1024 sc1 lds
    s_lshl_b32 m0, s81, 13
    s_add_u32 m0, m0, 55296
    s_add_u32 s96, s75, s85
    s_add_u32 s96, s96, 61440
    buffer_load_dwordx4 v153, s[64:67], s96 offen offset:1024 sc1 lds
    s_mov_b32 m0, s97
    s_waitcnt vmcnt(0)
    v_and_b32 v169, 0x23ff, v158
    v_add_u32 v169, 49152, v169
    ds_read_b128 v[56:59], v169 offset:1024
    v_and_b32 v169, 0x23ff, v158
    v_add_u32 v169, 49152, v169
    ds_read_b128 v[60:63], v169 offset:5120
    v_and_b32 v169, 0x23ff, v158
    v_add_u32 v169, 49152, v169
    ds_read_b128 v[64:67], v169 offset:3072
    v_and_b32 v169, 0x23ff, v158
    v_add_u32 v169, 49152, v169
    ds_read_b128 v[68:71], v169 offset:7168
    s_waitcnt lgkmcnt(0)
    v_bitop3_b32 v169, v56, v60, v64 bitop3:128
    v_bitop3_b32 v169, v169, v68, 1 bitop3:128
    v_cmp_ne_u32 vcc, 1, v169
    s_cbranch_vccnz L_xc9r
    s_branch L_xc9
L_xc10r:
    s_sub_u32 s101, s101, 1
    s_cbranch_scc1 L_end
    s_mov_b32 s97, m0
    s_lshl_b32 m0, s81, 13
    s_add_u32 m0, m0, 69632
    s_add_u32 s96, s76, s85
    s_add_u32 s96, s96, 40960
    buffer_load_dwordx4 v153, s[64:67], s96 offen offset:0 sc1 lds
    s_lshl_b32 m0, s81, 13
    s_add_u32 m0, m0, 69632
    s_add_u32 s96, s76, s85
    s_add_u32 s96, s96, 40960
    buffer_load_dwordx4 v153, s[64:67], s96 offen offset:1024 sc1 lds
    s_lshl_b32 m0, s81, 13
    s_add_u32 m0, m0, 65536
    s_add_u32 s96, s76, s85
    s_add_u32 s96, s96, 0
    buffer_load_dwordx4 v153, s[64:67], s96 offen offset:0 sc1 lds
    s_lshl_b32 m0, s81, 13
    s_add_u32 m0, m0, 65536
    s_add_u32 s96, s76, s85
    s_add_u32 s96, s96, 0
    buffer_load_dwordx4 v153, s[64:67], s96 offen offset:1024 sc1 lds
    s_mov_b32 m0, s97
    s_waitcnt vmcnt(0)
    v_and_b32 v169, 0x23ff, v158
    v_add_u32 v169, 65536, v169
    ds_read_b128 v[72:75], v169 offset:4096
    v_and_b32 v169, 0x23ff, v158
    v_add_u32 v169, 65536, v169
    ds_read_b128 v[76:79], v169 offset:5120
    v_and_b32 v169, 0x23ff, v158
    v_add_u32 v169, 65536, v169
    ds_read_b128 v[80:83], v169 offset:0
    v_and_b32 v169, 0x23ff, v158
    v_add_u32 v169, 65536, v169
    ds_read_b128 v[84:87], v169 offset:1024
    s_waitcnt lgkmcnt(0)
    v_bitop3_b32 v169, v72, v76, v80 bitop3:128
    v_bitop3_b32 v169, v169, v84, 1 bitop3:128
    v_cmp_ne_u32 vcc, 1, v169
    s_cbranch_vccnz L_xc10r
    s_branch L_xc10
L_xc11r:
    s_sub_u32 s101, s101, 1
    s_cbranch_scc1 L_end
    s_mov_b32 s97, m0
    s_lshl_b32 m0, s81, 13
    s_add_u32 m0, m0, 71680
    s_add_u32 s96, s76, s85
    s_add_u32 s96, s96, 61440
    buffer_load_dwordx4 v153, s[64:67], s96 offen offset:0 sc1 lds
    s_lshl_b32 m0, s81, 13
    s_add_u32 m0, m0, 71680
    s_add_u32 s96, s76, s85
    s_add_u32 s96, s96, 61440
    buffer_load_dwordx4 v153, s[64:67], s96 offen offset:1024 sc1 lds
    s_lshl_b32 m0, s81, 13
    s_add_u32 m0, m0, 67584
    s_add_u32 s96, s76, s85
    s_add_u32 s96, s96, 20480
    buffer_load_dwordx4 v153, s[64:67], s96 offen offset:0 sc1 lds
    s_lshl_b32 m0, s81, 13
    s_add_u32 m0, m0, 67584
    s_add_u32 s96, s76, s85
    s_add_u32 s96, s96, 20480
    buffer_load_dwordx4 v153, s[64:67], s96 offen offset:1024 sc1 lds
    s_mov_b32 m0, s97
    s_waitcnt vmcnt(0)
    v_and_b32 v169, 0x23ff, v158
    v_add_u32 v169, 65536, v169
    ds_read_b128 v[88:91], v169 offset:6144
    v_and_b32 v169, 0x23ff, v158
    v_add_u32 v169, 65536, v169
    ds_read_b128 v[92:95], v169 offset:7168
    v_and_b32 v169, 0x23ff, v158
    v_add_u32 v169, 65536, v169
    ds_read_b128 v[96:99], v169 offset:2048
    v_and_b32 v169, 0x23ff, v158
    v_add_u32 v169, 65536, v169
    ds_read_b128 v[100:103], v169 offset:3072
    s_waitcnt lgkmcnt(0)
    v_bitop3_b32 v169, v88, v92, v96 bitop3:128
    v_bitop3_b32 v169, v169, v100, 1 bitop3:128
    v_cmp_ne_u32 vcc, 1, v169
    s_cbranch_vccnz L_xc11r
    s_branch L_xc11
L_xc12r:
    s_sub_u32 s101, s101, 1
    s_cbranch_scc1 L_end
    s_mov_b32 s97, m0
    s_lshl_b32 m0, s81, 13
    s_xor_b32 m0, m0, 0x2000
    s_add_u32 m0, m0, 16384
    s_add_u32 s96, s73, s90
    s_add_u32 s96, s96, 0
    buffer_load_dwordx4 v153, s[64:67], s96 offen offset:0 sc1 lds
    s_lshl_b32 m0, s81, 13
    s_xor_b32 m0, m0, 0x2000
    s_add_u32 m0, m0, 16384
    s_add_u32 s96, s73, s90
    s_add_u32 s96, s96, 0
    buffer_load_dwordx4 v153, s[64:67], s96 offen offset:1024 sc1 lds
    s_lshl_b32 m0, s81, 13
    s_xor_b32 m0, m0, 0x2000
    s_add_u32 m0, m0, 32768
    s_add_u32 s96, s74, s90
    s_add_u32 s96, s96, 0
    buffer_load_dwordx4 v153, s[64:67], s96 offen offset:0 sc1 lds
    s_lshl_b32 m0, s81, 13
    s_xor_b32 m0, m0, 0x2000
    s_add_u32 m0, m0, 32768
    s_add_u32 s96, s74, s90
    s_add_u32 s96, s96, 0
    buffer_load_dwordx4 v153, s[64:67], s96 offen offset:1024 sc1 lds
    s_mov_b32 m0, s97
    s_waitcnt vmcnt(0)
    v_and_b32 v169, 0x23ff, v159
    v_add_u32 v169, 16384, v169
    ds_read_b128 v[56:59], v169 offset:0
    v_and_b32 v169, 0x23ff, v159
    v_add_u32 v169, 16384, v169
    ds_read_b128 v[60:63], v169 offset:1024
    v_and_b32 v169, 0x23ff, v159
    v_add_u32 v169, 32768, v169
    ds_read_b128 v[64:67], v169 offset:0
    v_and_b32 v169, 0x23ff, v159
    v_add_u32 v169, 32768, v169
    ds_read_b128 v[68:71], v169 offset:1024
    s_waitcnt lgkmcnt(0)
    v_bitop3_b32 v169, v56, v60, v64 bitop3:128
    v_bitop3_b32 v169, v169, v68, 1 bitop3:128
    v_cmp_ne_u32 vcc, 1, v169
    s_cbranch_vccnz L_xc12r
    s_branch L_xc12
L_xc13r:
    s_sub_u32 s101, s101, 1
    s_cbranch_scc1 L_end
    s_mov_b32 s97, m0
    s_lshl_b32 m0, s81, 13
    s_xor_b32 m0, m0, 0x2000
    s_add_u32 m0, m0, 49152
    s_add_u32 s96, s75, s90
    s_add_u32 s96, s96, 0
    buffer_load_dwordx4 v153, s[64:67], s96 offen offset:0 sc1 lds
    s_lshl_b32 m0, s81, 13
    s_xor_b32 m0, m0, 0x2000
    s_add_u32 m0, m0, 49152
    s_add_u32 s96, s75, s90
    s_add_u32 s96, s96, 0
    buffer_load_dwordx4 v153, s[64:67], s96 offen offset:1024 sc1 lds
    s_lshl_b32 m0, s81, 13
    s_xor_b32 m0, m0, 0x2000
    s_add_u32 m0, m0, 65536
    s_add_u32 s96, s76, s90
    s_add_u32 s96, s96, 0
    buffer_load_dwordx4 v153, s[64:67], s96 offen offset:0 sc1 lds
    s_lshl_b32 m0, s81, 13
    s_xor_b32 m0, m0, 0x2000
    s_add_u32 m0, m0, 65536
    s_add_u32 s96, s76, s90
    s_add_u32 s96, s96, 0
    buffer_load_dwordx4 v153, s[64:67], s96 offen offset:1024 sc1 lds
    s_mov_b32 m0, s97
    s_waitcnt vmcnt(0)
    v_and_b32 v169, 0x23ff, v159
    v_add_u32 v169, 49152, v169
    ds_read_b128 v[72:75], v169 offset:0
    v_and_b32 v169, 0x23ff, v159
    v_add_u32 v169, 49152, v169
    ds_read_b128 v[76:79], v169 offset:1024
    v_and_b32 v169, 0x23ff, v159
    v_add_u32 v169, 65536, v169
    ds_read_b128 v[80:83], v169 offset:0
    v_and_b32 v169, 0x23ff, v159
    v_add_u32 v169, 65536, v169
    ds_read_b128 v[84:87], v169 offset:1024
    s_waitcnt lgkmcnt(0)
    v_bitop3_b32 v169, v72, v76, v80 bitop3:128
    v_bitop3_b32 v169, v169, v84, 1 bitop3:128
    v_cmp_ne_u32 vcc, 1, v169
    s_cbranch_vccnz L_xc13r
    s_branch L_xc13
L_xc14r:
    s_sub_u32 s101, s101, 1
    s_cbranch_scc1 L_end
    s_mov_b32 s97, m0
    s_lshl_b32 m0, s81, 13
    s_xor_b32 m0, m0, 0x2000
    s_add_u32 m0, m0, 18432
    s_add_u32 s96, s73, s90
    s_add_u32 s96, s96, 20480
    buffer_load_dwordx4 v153, s[64:67], s96 offen offset:0 sc1 lds
    s_lshl_b32 m0, s81, 13
    s_xor_b32 m0, m0, 0x2000
    s_add_u32 m0, m0, 18432
    s_add_u32 s96, s73, s90
    s_add_u32 s96, s96, 20480
    buffer_load_dwordx4 v153, s[64:67], s96 offen offset:1024 sc1 lds
    s_lshl_b32 m0, s81, 13
    s_xor_b32 m0, m0, 0x2000
    s_add_u32 m0, m0, 34816
    s_add_u32 s96, s74, s90
    s_add_u32 s96, s96, 20480
    buffer_load_dwordx4 v153, s[64:67], s96 offen offset:0 sc1 lds
    s_lshl_b32 m0, s81, 13
    s_xor_b32 m0, m0, 0x2000
    s_add_u32 m0, m0, 34816
    s_add_u32 s96, s74, s90
    s_add_u32 s96, s96, 20480
    buffer_load_dwordx4 v153, s[64:67], s96 offen offset:1024 sc1 lds
    s_mov_b32 m0, s97
    s_waitcnt vmcnt(0)
    v_and_b32 v169, 0x23ff, v159
    v_add_u32 v169, 16384, v169
    ds_read_b128 v[56:59], v169 offset:2048
    v_and_b32 v169, 0x23ff, v159
    v_add_u32 v169, 16384, v169
    ds_read_b128 v[60:63], v169 offset:3072
    v_and_b32 v169, 0x23ff, v159
    v_add_u32 v169, 32768, v169
    ds_read_b128 v[64:67], v169 offset:2048
    v_and_b32 v169, 0x23ff, v159
    v_add_u32 v169, 32768, v169
    ds_read_b128 v[68:71], v169 offset:3072
    s_waitcnt lgkmcnt(0)
    v_bitop3_b32 v169, v56, v60, v64 bitop3:128
    v_bitop3_b32 v169, v169, v68, 1 bitop3:128
    v_cmp_ne_u32 vcc, 1, v169
    s_cbranch_vccnz L_xc14r
    s_branch L_xc14
L_xc15r:
    s_sub_u32 s101, s101, 1
    s_cbranch_scc1 L_end
    s_mov_b32 s97, m0
    s_lshl_b32 m0, s81, 13
    s_xor_b32 m0, m0, 0x2000
    s_add_u32 m0, m0, 51200
    s_add_u32 s96, s75, s90
    s_add_u32 s96, s96, 20480
    buffer_load_dwordx4 v153, s[64:67], s96 offen offset:0 sc1 lds
    s_lshl_b32 m0, s81, 13
    s_xor_b32 m0, m0, 0x2000
    s_add_u32 m0, m0, 51200
    s_add_u32 s96, s75, s90
    s_add_u32 s96, s96, 20480
    buffer_load_dwordx4 v153, s[64:67], s96 offen offset:1024 sc1 lds
    s_lshl_b32 m0, s81, 13
    s_xor_b32 m0, m0, 0x2000
    s_add_u32 m0, m0, 67584
    s_add_u32 s96, s76, s90
    s_add_u32 s96, s96, 20480
    buffer_load_dwordx4 v153, s[64:67], s96 offen offset:0 sc1 lds
    s_lshl_b32 m0, s81, 13
    s_xor_b32 m0, m0, 0x2000
    s_add_u32 m0, m0, 67584
    s_add_u32 s96, s76, s90
    s_add_u32 s96, s96, 20480
    buffer_load_dwordx4 v153, s[64:67], s96 offen offset:1024 sc1 lds
    s_mov_b32 m0, s97
    s_waitcnt vmcnt(0)
    v_and_b32 v169, 0x23ff, v159
    v_add_u32 v169, 49152, v169
    ds_read_b128 v[72:75], v169 offset:2048
    v_and_b32 v169, 0x23ff, v159
    v_add_u32 v169, 49152, v169
    ds_read_b128 v[76:79], v169 offset:3072
    v_and_b32 v169, 0x23ff, v159
    v_add_u32 v169, 65536, v169
    ds_read_b128 v[80:83], v169 offset:2048
    v_and_b32 v169, 0x23ff, v159
    v_add_u32 v169, 65536, v169
    ds_read_b128 v[84:87], v169 offset:3072
    s_waitcnt lgkmcnt(0)
    v_bitop3_b32 v169, v72, v76, v80 bitop3:128
    v_bitop3_b32 v169, v169, v84, 1 bitop3:128
    v_cmp_ne_u32 vcc, 1, v169
    s_cbranch_vccnz L_xc15r
    s_branch L_xc15
Lss_9:
    global_store_dword v110, v111, s[50:51] sc1
    s_branch Lsd_10
L_cre1:
    s_sub_u32 s101, s101, 1
    s_cbranch_scc1 L_end
    buffer_load_dwordx4 v[116:119], v85, s[92:95], 0 offen offset:2048 sc1
    buffer_load_dwordx4 v[112:115], v85, s[92:95], 0 offen offset:1792 sc1
    buffer_load_dwordx4 v[108:111], v85, s[92:95], 0 offen offset:1536 sc1
    buffer_load_dwordx4 v[104:107], v85, s[92:95], 0 offen offset:1280 sc1
    buffer_load_dwordx4 v[100:103], v85, s[92:95], 0 offen offset:1024 sc1
    buffer_load_dwordx4 v[96:99], v85, s[92:95], 0 offen offset:768 sc1
    buffer_load_dwordx4 v[92:95], v85, s[92:95], 0 offen offset:512 sc1
    buffer_load_dwordx4 v[88:91], v85, s[92:95], 0 offen offset:256 sc1
    s_waitcnt vmcnt(0)
    s_branch L_cchk1
L_xr_re:
    s_sub_u32 s101, s101, 1
    s_cbranch_scc1 L_end
    global_load_dword v64, v87, s[50:51] sc1
    s_waitcnt vmcnt(0)
    s_branch L_xr
L_p2s1:
    v_fmac_f32_dpp v48, -v84, v131 row_ror:8 row_mask:0xf bank_mask:0xf
    v_fmac_f32 v48, v130, v84
    v_pk_fma_f32 v[0:1], v[80:81], v[128:129], v[0:1] op_sel_hi:[1,0,1]
    v_pk_fma_f32 v[16:17], v[82:83], v[128:129], v[16:17] op_sel_hi:[1,0,1]
    v_fmac_f32_dpp v49, -v48, v131 row_ror:8 row_mask:0xf bank_mask:0xf
    v_fmac_f32 v49, v130, v48
    v_pk_fma_f32 v[0:1], v[82:83], v[128:129], v[0:1] op_sel:[0,1,0] neg_lo:[1,0,0] neg_hi:[1,0,0]
    v_pk_fma_f32 v[16:17], v[80:81], v[128:129], v[16:17] op_sel:[0,1,0]
    v_fmac_f32_dpp v50, -v49, v131 row_ror:8 row_mask:0xf bank_mask:0xf
    v_fmac_f32 v50, v130, v49
    v_pk_fma_f32 v[2:3], v[0:1], v[128:129], v[2:3] op_sel_hi:[1,0,1]
    v_pk_fma_f32 v[18:19], v[16:17], v[128:129], v[18:19] op_sel_hi:[1,0,1]
    v_fmac_f32_dpp v51, -v50, v131 row_ror:8 row_mask:0xf bank_mask:0xf
    v_fmac_f32 v51, v130, v50
    v_pk_fma_f32 v[2:3], v[16:17], v[128:129], v[2:3] op_sel:[0,1,0] neg_lo:[1,0,0] neg_hi:[1,0,0]
    v_pk_fma_f32 v[18:19], v[0:1], v[128:129], v[18:19] op_sel:[0,1,0]
    v_cvt_pk_bf16_f32 v104, v0, v1
    v_cvt_pk_bf16_f32 v105, v2, v3
    v_cvt_pk_bf16_f32 v106, -v16, -v17
    v_cvt_pk_bf16_f32 v107, -v18, -v19

    ds_write_b128 v56, v[104:107] offset:0
    ds_read_b64_tr_b16 v[88:89], v58 offset:0
    ds_read_b64_tr_b16 v[90:91], v59 offset:0
    v_fmac_f32_dpp v52, -v51, v131 row_ror:8 row_mask:0xf bank_mask:0xf
    v_fmac_f32 v52, v130, v51
    v_pk_fma_f32 v[4:5], v[2:3], v[128:129], v[4:5] op_sel_hi:[1,0,1]
    v_pk_fma_f32 v[20:21], v[18:19], v[128:129], v[20:21] op_sel_hi:[1,0,1]
    v_fmac_f32_dpp v53, -v52, v131 row_ror:8 row_mask:0xf bank_mask:0xf
    v_fmac_f32 v53, v130, v52
    v_pk_fma_f32 v[4:5], v[18:19], v[128:129], v[4:5] op_sel:[0,1,0] neg_lo:[1,0,0] neg_hi:[1,0,0]
    v_pk_fma_f32 v[20:21], v[2:3], v[128:129], v[20:21] op_sel:[0,1,0]
    v_fmac_f32_dpp v54, -v53, v131 row_ror:8 row_mask:0xf bank_mask:0xf
    v_fmac_f32 v54, v130, v53
    v_pk_fma_f32 v[6:7], v[4:5], v[128:129], v[6:7] op_sel_hi:[1,0,1]
    v_pk_fma_f32 v[22:23], v[20:21], v[128:129], v[22:23] op_sel_hi:[1,0,1]
    v_fmac_f32_dpp v55, -v54, v131 row_ror:8 row_mask:0xf bank_mask:0xf
    v_fmac_f32 v55, v130, v54
    v_pk_fma_f32 v[6:7], v[20:21], v[128:129], v[6:7] op_sel:[0,1,0] neg_lo:[1,0,0] neg_hi:[1,0,0]
    v_pk_fma_f32 v[22:23], v[4:5], v[128:129], v[22:23] op_sel:[0,1,0]
    v_cvt_pk_bf16_f32 v108, v4, v5
    v_cvt_pk_bf16_f32 v109, v6, v7
    v_cvt_pk_bf16_f32 v110, -v20, -v21
    v_cvt_pk_bf16_f32 v111, -v22, -v23

    ds_write_b128 v56, v[108:111] offset:1024
    ds_read_b64_tr_b16 v[92:93], v58 offset:1024
    ds_read_b64_tr_b16 v[94:95], v59 offset:1024
    v_pk_fma_f32 v[8:9], v[6:7], v[128:129], v[8:9] op_sel_hi:[1,0,1]
    v_pk_fma_f32 v[24:25], v[22:23], v[128:129], v[24:25] op_sel_hi:[1,0,1]
    v_pk_fma_f32 v[8:9], v[22:23], v[128:129], v[8:9] op_sel:[0,1,0] neg_lo:[1,0,0] neg_hi:[1,0,0]
    v_pk_fma_f32 v[24:25], v[6:7], v[128:129], v[24:25] op_sel:[0,1,0]
    v_cvt_pk_bf16_f32 v112, v48, v49
    v_cvt_pk_bf16_f32 v113, v50, v51
    v_cvt_pk_bf16_f32 v114, v52, v53
    v_cvt_pk_bf16_f32 v115, v54, v55
    ds_write2st64_b32 v60, v112, v113 offset0:0 offset1:1
    ds_write2st64_b32 v60, v114, v115 offset0:2 offset1:3
    ds_read_b64_tr_b16 v[116:117], v61 offset:0
    ds_read_b64_tr_b16 v[118:119], v61 offset:128
    v_pk_fma_f32 v[10:11], v[8:9], v[128:129], v[10:11] op_sel_hi:[1,0,1]
    v_pk_fma_f32 v[26:27], v[24:25], v[128:129], v[26:27] op_sel_hi:[1,0,1]
    v_pk_fma_f32 v[10:11], v[24:25], v[128:129], v[10:11] op_sel:[0,1,0] neg_lo:[1,0,0] neg_hi:[1,0,0]
    v_pk_fma_f32 v[26:27], v[8:9], v[128:129], v[26:27] op_sel:[0,1,0]
    v_cvt_pk_bf16_f32 v104, v8, v9
    v_cvt_pk_bf16_f32 v105, v10, v11
    v_cvt_pk_bf16_f32 v106, -v24, -v25
    v_cvt_pk_bf16_f32 v107, -v26, -v27

    ds_write_b128 v56, v[104:107] offset:0
    ds_read_b64_tr_b16 v[96:97], v58 offset:0
    ds_read_b64_tr_b16 v[98:99], v59 offset:0
    s_waitcnt lgkmcnt(10)
    v_and_b32 v88, -2, v88
    v_and_b32 v90, -2, v90
    buffer_store_dwordx4 v[88:91], v153, s[64:67], s36 offen sc1
    v_pk_fma_f32 v[12:13], v[10:11], v[128:129], v[12:13] op_sel_hi:[1,0,1]
    v_pk_fma_f32 v[28:29], v[26:27], v[128:129], v[28:29] op_sel_hi:[1,0,1]
    v_pk_fma_f32 v[12:13], v[26:27], v[128:129], v[12:13] op_sel:[0,1,0] neg_lo:[1,0,0] neg_hi:[1,0,0]
    v_pk_fma_f32 v[28:29], v[10:11], v[128:129], v[28:29] op_sel:[0,1,0]
    v_pk_fma_f32 v[14:15], v[12:13], v[128:129], v[14:15] op_sel_hi:[1,0,1]
    v_pk_fma_f32 v[30:31], v[28:29], v[128:129], v[30:31] op_sel_hi:[1,0,1]
    v_pk_fma_f32 v[14:15], v[28:29], v[128:129], v[14:15] op_sel:[0,1,0] neg_lo:[1,0,0] neg_hi:[1,0,0]
    v_pk_fma_f32 v[30:31], v[12:13], v[128:129], v[30:31] op_sel:[0,1,0]
    v_cvt_pk_bf16_f32 v108, v12, v13
    v_cvt_pk_bf16_f32 v109, v14, v15
    v_cvt_pk_bf16_f32 v110, -v28, -v29
    v_cvt_pk_bf16_f32 v111, -v30, -v31

    ds_write_b128 v56, v[108:111] offset:1024
    ds_read_b64_tr_b16 v[100:101], v58 offset:1024
    ds_read_b64_tr_b16 v[102:103], v59 offset:1024
    s_waitcnt lgkmcnt(10)
    v_and_b32 v92, -2, v92
    v_and_b32 v94, -2, v94
    buffer_store_dwordx4 v[92:95], v153, s[64:67], s18 offen sc1
    s_waitcnt lgkmcnt(6)
    v_and_b32 v116, -2, v116
    v_and_b32 v118, -2, v118
    buffer_store_dwordx2 v[116:117], v62, s[64:67], s37 offen offset:0 sc1
    buffer_store_dwordx2 v[118:119], v62, s[64:67], s37 offen offset:512 sc1
    s_waitcnt lgkmcnt(3)
    v_and_b32 v96, -2, v96
    v_and_b32 v98, -2, v98
    buffer_store_dwordx4 v[96:99], v153, s[64:67], s19 offen sc1
    s_waitcnt lgkmcnt(0)
    v_and_b32 v100, -2, v100
    v_and_b32 v102, -2, v102
    buffer_store_dwordx4 v[100:103], v153, s[64:67], s20 offen sc1
    s_branch L_p2e1
Lh1c0r:
    s_sub_u32 s101, s101, 1
    s_cbranch_scc1 L_end
    buffer_load_dwordx4 v[40:43], v175, s[64:67], s23 offen offset:0 sc1
    buffer_load_dwordx4 v[44:47], v175, s[64:67], s23 offen offset:1024 sc1
    buffer_load_dwordx4 v[48:51], v175, s[64:67], s23 offen offset:2048 sc1
    buffer_load_dwordx4 v[120:123], v175, s[64:67], s22 offen offset:0 sc1
    buffer_load_dwordx4 v[80:83], v175, s[64:67], s25 offen offset:0 sc1
    buffer_load_dwordx4 v[116:119], v175, s[64:67], s28 offen offset:0 sc1
    buffer_load_dwordx4 v[64:67], v175, s[64:67], s31 offen offset:0 sc1
    s_waitcnt vmcnt(0)
    v_bitop3_b32 v169, v40, v42, v44 bitop3:254
    v_bitop3_b32 v169, v169, v46, v48 bitop3:254
    v_bitop3_b32 v169, v169, v50, 1 bitop3:168
    v_cmp_ne_u32 vcc, 0, v169
    s_cbranch_vccnz Lh1c0r
    s_branch Lh1c0
Lh1c1r:
    s_sub_u32 s101, s101, 1
    s_cbranch_scc1 L_end
    buffer_load_dwordx4 v[120:123], v175, s[64:67], s22 offen offset:0 sc1
    buffer_load_dwordx4 v[80:83], v175, s[64:67], s25 offen offset:0 sc1
    buffer_load_dwordx4 v[116:119], v175, s[64:67], s28 offen offset:0 sc1
    buffer_load_dwordx4 v[64:67], v175, s[64:67], s31 offen offset:0 sc1
    buffer_load_dwordx4 v[60:63], v175, s[64:67], s22 offen offset:1024 sc1
    buffer_load_dwordx4 v[68:71], v175, s[64:67], s25 offen offset:1024 sc1
    buffer_load_dwordx4 v[72:75], v175, s[64:67], s28 offen offset:1024 sc1
    buffer_load_dwordx4 v[76:79], v175, s[64:67], s31 offen offset:1024 sc1
    s_waitcnt vmcnt(0)
    v_bitop3_b32 v169, v120, v122, v80 bitop3:254
    v_bitop3_b32 v169, v169, v82, v116 bitop3:254
    v_bitop3_b32 v169, v169, v118, v64 bitop3:254
    v_bitop3_b32 v169, v169, v66, 1 bitop3:168
    v_cmp_ne_u32 vcc, 0, v169
    s_cbranch_vccnz Lh1c1r
    s_branch Lh1c1
Lh1c2r:
    s_sub_u32 s101, s101, 1
    s_cbranch_scc1 L_end
    buffer_load_dwordx4 v[60:63], v175, s[64:67], s22 offen offset:1024 sc1
    buffer_load_dwordx4 v[68:71], v175, s[64:67], s25 offen offset:1024 sc1
    buffer_load_dwordx4 v[72:75], v175, s[64:67], s28 offen offset:1024 sc1
    buffer_load_dwordx4 v[76:79], v175, s[64:67], s31 offen offset:1024 sc1
    buffer_load_dwordx4 v[84:87], v175, s[64:67], s22 offen offset:2048 sc1
    buffer_load_dwordx4 v[88:91], v175, s[64:67], s25 offen offset:2048 sc1
    buffer_load_dwordx4 v[92:95], v175, s[64:67], s28 offen offset:2048 sc1
    buffer_load_dwordx4 v[96:99], v175, s[64:67], s31 offen offset:2048 sc1
    buffer_load_dwordx4 v[100:103], v175, s[64:67], s22 offen offset:3072 sc1
    s_waitcnt vmcnt(0)
    v_bitop3_b32 v169, v60, v62, v68 bitop3:254
    v_bitop3_b32 v169, v169, v70, v72 bitop3:254
    v_bitop3_b32 v169, v169, v74, v76 bitop3:254
    v_bitop3_b32 v169, v169, v78, 1 bitop3:168
    v_cmp_ne_u32 vcc, 0, v169
    s_cbranch_vccnz Lh1c2r
    s_branch Lh1c2
Lh1c3r:
    s_sub_u32 s101, s101, 1
    s_cbranch_scc1 L_end
    buffer_load_dwordx4 v[84:87], v175, s[64:67], s22 offen offset:2048 sc1
    buffer_load_dwordx4 v[88:91], v175, s[64:67], s25 offen offset:2048 sc1
    buffer_load_dwordx4 v[92:95], v175, s[64:67], s28 offen offset:2048 sc1
    buffer_load_dwordx4 v[96:99], v175, s[64:67], s31 offen offset:2048 sc1
    buffer_load_dwordx4 v[100:103], v175, s[64:67], s22 offen offset:3072 sc1
    buffer_load_dwordx4 v[104:107], v175, s[64:67], s25 offen offset:3072 sc1
    buffer_load_dwordx4 v[108:111], v175, s[64:67], s28 offen offset:3072 sc1
    buffer_load_dwordx4 v[120:123], v175, s[64:67], s31 offen offset:3072 sc1
    buffer_load_dwordx4 v[80:83], v175, s[64:67], s26 offen offset:0 sc1
    buffer_load_dwordx4 v[116:119], v175, s[64:67], s26 offen offset:1024 sc1
    s_waitcnt vmcnt(0)
    v_bitop3_b32 v169, v84, v86, v88 bitop3:254
    v_bitop3_b32 v169, v169, v90, v92 bitop3:254
    v_bitop3_b32 v169, v169, v94, v96 bitop3:254
    v_bitop3_b32 v169, v169, v98, 1 bitop3:168
    v_cmp_ne_u32 vcc, 0, v169
    s_cbranch_vccnz Lh1c3r
    s_branch Lh1c3
Lh1c4r:
    s_sub_u32 s101, s101, 1
    s_cbranch_scc1 L_end
    buffer_load_dwordx4 v[100:103], v175, s[64:67], s22 offen offset:3072 sc1
    buffer_load_dwordx4 v[104:107], v175, s[64:67], s25 offen offset:3072 sc1
    buffer_load_dwordx4 v[108:111], v175, s[64:67], s28 offen offset:3072 sc1
    buffer_load_dwordx4 v[120:123], v175, s[64:67], s31 offen offset:3072 sc1
    buffer_load_dwordx4 v[80:83], v175, s[64:67], s26 offen offset:0 sc1
    buffer_load_dwordx4 v[116:119], v175, s[64:67], s26 offen offset:1024 sc1
    buffer_load_dwordx4 v[64:67], v175, s[64:67], s26 offen offset:2048 sc1
    buffer_load_dwordx4 v[60:63], v175, s[64:67], s26 offen offset:3072 sc1
    buffer_load_dwordx4 v[68:71], v175, s[64:67], s27 offen offset:0 sc1
    buffer_load_dwordx4 v[72:75], v175, s[64:67], s27 offen offset:1024 sc1
    buffer_load_dwordx4 v[76:79], v175, s[64:67], s29 offen offset:0 sc1
    s_waitcnt vmcnt(0)
    v_bitop3_b32 v169, v100, v102, v104 bitop3:254
    v_bitop3_b32 v169, v169, v106, v108 bitop3:254
    v_bitop3_b32 v169, v169, v110, v120 bitop3:254
    v_bitop3_b32 v169, v169, v122, 1 bitop3:168
    v_cmp_ne_u32 vcc, 0, v169
    s_cbranch_vccnz Lh1c4r
    s_branch Lh1c4
Lh1c5r:
    s_sub_u32 s101, s101, 1
    s_cbranch_scc1 L_end
    buffer_load_dwordx4 v[80:83], v175, s[64:67], s26 offen offset:0 sc1
    buffer_load_dwordx4 v[116:119], v175, s[64:67], s26 offen offset:1024 sc1
    buffer_load_dwordx4 v[64:67], v175, s[64:67], s26 offen offset:2048 sc1
    buffer_load_dwordx4 v[60:63], v175, s[64:67], s26 offen offset:3072 sc1
    buffer_load_dwordx4 v[68:71], v175, s[64:67], s27 offen offset:0 sc1
    buffer_load_dwordx4 v[72:75], v175, s[64:67], s27 offen offset:1024 sc1
    buffer_load_dwordx4 v[76:79], v175, s[64:67], s29 offen offset:0 sc1
    buffer_load_dwordx4 v[84:87], v175, s[64:67], s29 offen offset:1024 sc1
    buffer_load_dwordx4 v[88:91], v175, s[64:67], s29 offen offset:2048 sc1
    buffer_load_dwordx4 v[92:95], v175, s[64:67], s29 offen offset:3072 sc1
    buffer_load_dwordx4 v[96:99], v175, s[64:67], s30 offen offset:0 sc1
    buffer_load_dwordx4 v[100:103], v175, s[64:67], s30 offen offset:1024 sc1
    s_waitcnt vmcnt(0)
    v_bitop3_b32 v169, v80, v82, v116 bitop3:254
    v_bitop3_b32 v169, v169, v118, v64 bitop3:254
    v_bitop3_b32 v169, v169, v66, v60 bitop3:254
    v_bitop3_b32 v169, v169, v62, v68 bitop3:254
    v_bitop3_b32 v169, v169, v70, v72 bitop3:254
    v_bitop3_b32 v169, v169, v74, 1 bitop3:168
    v_cmp_ne_u32 vcc, 0, v169
    s_cbranch_vccnz Lh1c5r
    s_branch Lh1c5
Lh1c6r:
    s_sub_u32 s101, s101, 1
    s_cbranch_scc1 L_end
    buffer_load_dwordx4 v[76:79], v175, s[64:67], s29 offen offset:0 sc1
    buffer_load_dwordx4 v[84:87], v175, s[64:67], s29 offen offset:1024 sc1
    buffer_load_dwordx4 v[88:91], v175, s[64:67], s29 offen offset:2048 sc1
    buffer_load_dwordx4 v[92:95], v175, s[64:67], s29 offen offset:3072 sc1
    buffer_load_dwordx4 v[96:99], v175, s[64:67], s30 offen offset:0 sc1
    buffer_load_dwordx4 v[100:103], v175, s[64:67], s30 offen offset:1024 sc1
    buffer_load_dwordx4 v[104:107], v175, s[64:67], s32 offen offset:0 sc1
    buffer_load_dwordx4 v[108:111], v175, s[64:67], s32 offen offset:1024 sc1
    buffer_load_dwordx4 v[120:123], v175, s[64:67], s32 offen offset:2048 sc1
    buffer_load_dwordx4 v[80:83], v175, s[64:67], s32 offen offset:3072 sc1
    buffer_load_dwordx4 v[116:119], v175, s[64:67], s33 offen offset:0 sc1
    s_waitcnt vmcnt(0)
    v_bitop3_b32 v169, v76, v78, v84 bitop3:254
    v_bitop3_b32 v169, v169, v86, v88 bitop3:254
    v_bitop3_b32 v169, v169, v90, v92 bitop3:254
    v_bitop3_b32 v169, v169, v94, v96 bitop3:254
    v_bitop3_b32 v169, v169, v98, v100 bitop3:254
    v_bitop3_b32 v169, v169, v102, 1 bitop3:168
    v_cmp_ne_u32 vcc, 0, v169
    s_cbranch_vccnz Lh1c6r
    s_branch Lh1c6
Lh1c7r:
    s_sub_u32 s101, s101, 1
    s_cbranch_scc1 L_end
    buffer_load_dwordx4 v[104:107], v175, s[64:67], s32 offen offset:0 sc1
    buffer_load_dwordx4 v[108:111], v175, s[64:67], s32 offen offset:1024 sc1
    buffer_load_dwordx4 v[120:123], v175, s[64:67], s32 offen offset:2048 sc1
    buffer_load_dwordx4 v[80:83], v175, s[64:67], s32 offen offset:3072 sc1
    buffer_load_dwordx4 v[116:119], v175, s[64:67], s33 offen offset:0 sc1
    buffer_load_dwordx4 v[64:67], v175, s[64:67], s33 offen offset:1024 sc1
    buffer_load_dwordx4 v[60:63], v175, s[64:67], s23 offen offset:3072 sc1
    buffer_load_dwordx4 v[68:71], v175, s[64:67], s24 offen offset:0 sc1
    buffer_load_dwordx4 v[72:75], v175, s[64:67], s24 offen offset:1024 sc1
    s_waitcnt vmcnt(0)
    v_bitop3_b32 v169, v104, v106, v108 bitop3:254
    v_bitop3_b32 v169, v169, v110, v120 bitop3:254
    v_bitop3_b32 v169, v169, v122, v80 bitop3:254
    v_bitop3_b32 v169, v169, v82, v116 bitop3:254
    v_bitop3_b32 v169, v169, v118, v64 bitop3:254
    v_bitop3_b32 v169, v169, v66, 1 bitop3:168
    v_cmp_ne_u32 vcc, 0, v169
    s_cbranch_vccnz Lh1c7r
    s_branch Lh1c7
Lh1c8r:
    s_sub_u32 s101, s101, 1
    s_cbranch_scc1 L_end
    buffer_load_dwordx4 v[60:63], v175, s[64:67], s23 offen offset:3072 sc1
    buffer_load_dwordx4 v[68:71], v175, s[64:67], s24 offen offset:0 sc1
    buffer_load_dwordx4 v[72:75], v175, s[64:67], s24 offen offset:1024 sc1
    s_waitcnt vmcnt(0)
    v_bitop3_b32 v169, v60, v62, v68 bitop3:254
    v_bitop3_b32 v169, v169, v70, v72 bitop3:254
    v_bitop3_b32 v169, v169, v74, 1 bitop3:168
    v_cmp_ne_u32 vcc, 0, v169
    s_cbranch_vccnz Lh1c8r
    s_branch Lh1c8
Lss_11:
    global_store_dwordx2 v155, v[0:1], s[98:99] sc1
    s_branch Lsd_12
L_last:
    s_endpgm
.section .rodata,"a"
.p2align 6
.amdhsa_kernel interleave_layers__ssm_conv_s5__ssm_conv_h3__prompt_kernel
  .amdhsa_next_free_vgpr 512
  .amdhsa_next_free_sgpr 102
  .amdhsa_accum_offset 256
  .amdhsa_group_segment_fixed_size 0
  .amdhsa_kernarg_size 144
  .amdhsa_user_sgpr_count 2
  .amdhsa_user_sgpr_kernarg_segment_ptr 1
  .amdhsa_system_sgpr_workgroup_id_x 1
.end_amdhsa_kernel
```
